```python
import torch

def _softmax(x, axis=-1):
    return torch.softmax(x, dim=axis)

def _gelu(x):
    return torch.nn.functional.gelu(x, approximate='tanh')

def _silu(x):
    return torch.nn.functional.silu(x)

def _sigmoid(x):
    return torch.sigmoid(x)

def _layernorm(x, axis=-1, eps=1e-05):
    m = x.mean(dim=axis, keepdim=True)
    v = x.var(dim=axis, keepdim=True, unbiased=False)
    return (x - m) / torch.sqrt(v + eps)

def _scatter_add(tgt, idx, src, axis=0):
    return tgt.clone().index_add_(axis, idx, src)

def _segment_sum(src, seg, n):
    out = torch.zeros((n,) + src.shape[1:], dtype=src.dtype)
    return out.index_add_(0, seg, src)

def _pad(x, pw):
    flat = tuple((v for pair in reversed(pw) for v in pair))
    return torch.nn.functional.pad(x, flat)
kernel_name = 'adaLN_cond__sliding_local_dilated__glu_gated_swiglu__prompt'

def setup_inputs():

    _w = lambda a: (lambda t: t.to(torch.bfloat16) if t.is_floating_point() else t)(torch.as_tensor(a))

    def _A_setup():
        B, S, D = (1, 2048, 1024)
        return {'x': _w((lambda *s: torch.randn(*s, dtype=torch.bfloat16) * 0.05)(B, S, D)), 'wqkv': _w((lambda *s: torch.randn(*s, dtype=torch.bfloat16) * 0.05)(D, 3 * D)), 'wo': _w((lambda *s: torch.randn(*s, dtype=torch.bfloat16) * 0.05)(D, D))}
    _A_in = _A_setup()

    def _B_setup():
        B, S, D, F = (1, 2048, 1024, 3584)
        return {'x': _w((lambda *s: torch.randn(*s, dtype=torch.bfloat16) * 0.05)(B, S, D)), 'w1': _w((lambda *s: torch.randn(*s, dtype=torch.bfloat16) * 0.8)(D, F) * (2.0 / D) ** 0.5), 'w3': _w((lambda *s: torch.randn(*s, dtype=torch.bfloat16) * 0.8)(D, F) * (2.0 / D) ** 0.5), 'w2': _w((lambda *s: torch.randn(*s, dtype=torch.bfloat16) * 0.8)(F, D) * (2.0 / F) ** 0.5)}
    _B_in = _B_setup()
    return {'A_x': _A_in['x'], 'A_wqkv': _A_in['wqkv'], 'A_wo': _A_in['wo'], 'B_x': _B_in['x'], 'B_w1': _B_in['w1'], 'B_w3': _B_in['w3'], 'B_w2': _B_in['w2'], 'c': _w((lambda *s: torch.randn(*s, dtype=torch.bfloat16) * 0.1)(1, 1024) * 8.0), 'w_mod': _w((lambda *s: torch.randn(*s, dtype=torch.bfloat16) * 0.1)(1024, 6 * 1024) * 1024 ** (-0.5) * 8.0)}

def reference(A_x, A_wqkv, A_wo, B_x, B_w1, B_w3, B_w2, c, w_mod):

    def _A_ref(x, wqkv, wo):
        B, S, D = x.shape
        H = 32
        Dh = D // H
        W, dil = (8, 2)
        qkv = (lambda x, *d: x.permute(*d))((x @ wqkv).reshape(B, S, 3, H, Dh), 2, 0, 3, 1, 4)
        q, k, v = (qkv[0], qkv[1], qkv[2])
        scale = Dh ** (-0.5)
        pos = torch.arange(S)
        off = torch.arange(W) * dil
        idx = pos[:, None] - off[None, :]
        mask = idx >= 0
        idx_c = torch.where(mask, idx, 0).reshape(-1)
        kg = k[:, :, idx_c, :].reshape(B, H, S, W, Dh)
        vg = v[:, :, idx_c, :].reshape(B, H, S, W, Dh)
        logits = torch.einsum('bhsd,bhswd->bhsw', q, kg) * scale
        logits = torch.where(mask[None, None, :, :], logits, -1000000000.0)
        attn = _softmax(logits, axis=-1)
        o = torch.einsum('bhsw,bhswd->bhsd', attn, vg)
        return (lambda x, *d: x.permute(*d))(o, 0, 2, 1, 3).reshape(B, S, D) @ wo

    def _B_ref(x, w1, w3, w2):
        gate = torch.einsum('bsd,df->bsf', x, w1)
        up = torch.einsum('bsd,df->bsf', x, w3)
        h = _silu(gate) * up
        out = torch.einsum('bsf,fd->bsd', h, w2)
        return out
    x = A_x
    mod = (_silu(c) @ w_mod).reshape(c.shape[0], 6, 1, -1)
    sa, ca, ga, sb, cb, gb = (mod[:, 0].clone(), mod[:, 1].clone(), mod[:, 2].clone(), mod[:, 3].clone(), mod[:, 4].clone(), mod[:, 5].clone())
    h = _layernorm(x, axis=-1) * (1 + ca) + sa
    x = x + ga * _A_ref(h, A_wqkv, A_wo)
    h = _layernorm(x, axis=-1) * (1 + cb) + sb
    x = x + gb * _B_ref(h, B_w1, B_w3, B_w2)
    return x
```

```asm
; @launch kernel=front_kernel grid=(256,1,1) block=(512,1,1) lds=4096
; @launch kernel=mod1_kernel grid=(256,1,1) block=(512,1,1) lds=1024
; @launch kernel=qkv_kernel grid=(256,1,1) block=(512,1,1) lds=131072
; @launch kernel=wo_kernel grid=(256,1,1) block=(512,1,1) lds=147456
; @launch kernel=ln2_kernel grid=(512,1,1) block=(256,1,1) lds=0
; @launch kernel=gd_kernel grid=(256,1,1) block=(512,1,1) lds=163840
.amdgcn_target "amdgcn-amd-amdhsa--gfx950"
.text
.globl front_kernel
.p2align 8
.type front_kernel,@function
front_kernel:
    s_cmp_ge_u32 s2, 256
    s_cbranch_scc1 front_kernel_end
    s_load_dwordx4 s[4:7], s[0:1], 56
    s_load_dwordx4 s[8:11], s[0:1], 0
    s_load_dwordx2 s[40:41], s[0:1], 88
    s_and_b32 s3, s2, 7
    s_lshr_b32 s42, s2, 4
    s_lshl_b32 s42, s42, 3
    s_or_b32 s50, s3, s42
    v_and_b32 v1, 63, v0
    s_bitcmp1_b32 s2, 3
    s_cbranch_scc1 front_kernel_stats
    s_and_b32 s3, s50, 31
    s_lshl_b32 s42, s3, 7
    s_lshr_b32 s43, s50, 5
    s_lshl_b32 s44, s43, 8
    s_lshl_b32 s45, s43, 13
    s_lshl_b32 s3, s3, 8
    s_add_u32 s45, s45, s3
    v_lshrrev_b32 v40, 3, v0
    v_add_u32 v40, s44, v40
    v_lshlrev_b32 v5, 1, v40
    s_movk_i32 s48, 12288
    v_mul_lo_u32 v40, s48, v40
    v_and_b32 v4, 7, v0
    v_lshl_add_u32 v40, v4, 4, v40
    v_add_u32 v4, s42, v40
    s_waitcnt lgkmcnt(0)
    s_mov_b32 s12, s4
    s_mov_b32 s13, s5
    s_mov_b32 s14, 0x800
    s_mov_b32 s15, 0x20000
    s_mov_b32 s16, s6
    s_mov_b32 s17, s7
    s_mov_b32 s18, 0xc00000
    s_mov_b32 s19, 0x20000
    buffer_load_ushort v8, v5, s[12:15], 0 offen offset:0
    buffer_load_ushort v9, v5, s[12:15], 0 offen offset:128
    buffer_load_ushort v10, v5, s[12:15], 0 offen offset:256
    buffer_load_ushort v11, v5, s[12:15], 0 offen offset:384
    s_mov_b32 s48, 0x0
    buffer_load_dwordx4 v[16:19], v4, s[16:19], s48 offen
    s_mov_b32 s48, 0xc0000
    buffer_load_dwordx4 v[20:23], v4, s[16:19], s48 offen
    s_mov_b32 s48, 0x180000
    buffer_load_dwordx4 v[24:27], v4, s[16:19], s48 offen
    s_mov_b32 s48, 0x240000
    buffer_load_dwordx4 v[28:31], v4, s[16:19], s48 offen
    s_add_u32 s20, s40, 0x10000
    s_addc_u32 s21, s41, 0
    s_mov_b32 s22, 0x8000
    s_mov_b32 s23, 0x20000
    s_waitcnt vmcnt(4)
    v_lshlrev_b32 v8, 16, v8
    v_lshlrev_b32 v9, 16, v9
    v_lshlrev_b32 v10, 16, v10
    v_lshlrev_b32 v11, 16, v11
    v_mul_f32 v40, 0xbfb8aa3b, v8
    v_mul_f32 v41, 0xbfb8aa3b, v9
    v_mul_f32 v42, 0xbfb8aa3b, v10
    v_mul_f32 v43, 0xbfb8aa3b, v11
    v_exp_f32 v40, v40
    v_exp_f32 v41, v41
    v_exp_f32 v42, v42
    v_exp_f32 v43, v43
    v_add_f32 v40, 1.0, v40
    v_add_f32 v41, 1.0, v41
    v_add_f32 v42, 1.0, v42
    v_add_f32 v43, 1.0, v43
    v_rcp_f32 v40, v40
    v_rcp_f32 v41, v41
    v_rcp_f32 v42, v42
    v_rcp_f32 v43, v43
    v_mul_f32 v8, v8, v40
    v_mul_f32 v9, v9, v41
    v_mul_f32 v10, v10, v42
    v_mul_f32 v11, v11, v43
    v_cvt_pk_bf16_f32 v40, v8, v8
    v_lshlrev_b32 v8, 16, v40
    v_cvt_pk_bf16_f32 v41, v9, v9
    v_lshlrev_b32 v9, 16, v41
    v_cvt_pk_bf16_f32 v42, v10, v10
    v_lshlrev_b32 v10, 16, v42
    v_cvt_pk_bf16_f32 v43, v11, v11
    v_lshlrev_b32 v11, 16, v43
    s_waitcnt vmcnt(3)
    v_lshlrev_b32 v40, 16, v16
    v_and_b32 v41, 0xffff0000, v16
    v_lshlrev_b32 v42, 16, v17
    v_and_b32 v43, 0xffff0000, v17
    v_lshlrev_b32 v44, 16, v18
    v_and_b32 v45, 0xffff0000, v18
    v_lshlrev_b32 v46, 16, v19
    v_and_b32 v47, 0xffff0000, v19
    v_mul_f32 v32, v8, v40
    v_mul_f32 v33, v8, v41
    v_mul_f32 v34, v8, v42
    v_mul_f32 v35, v8, v43
    v_mul_f32 v36, v8, v44
    v_mul_f32 v37, v8, v45
    v_mul_f32 v38, v8, v46
    v_mul_f32 v39, v8, v47
    s_waitcnt vmcnt(2)
    v_lshlrev_b32 v40, 16, v20
    v_and_b32 v41, 0xffff0000, v20
    v_lshlrev_b32 v42, 16, v21
    v_and_b32 v43, 0xffff0000, v21
    v_lshlrev_b32 v44, 16, v22
    v_and_b32 v45, 0xffff0000, v22
    v_lshlrev_b32 v46, 16, v23
    v_and_b32 v47, 0xffff0000, v23
    v_fmac_f32 v32, v9, v40
    v_fmac_f32 v33, v9, v41
    v_fmac_f32 v34, v9, v42
    v_fmac_f32 v35, v9, v43
    v_fmac_f32 v36, v9, v44
    v_fmac_f32 v37, v9, v45
    v_fmac_f32 v38, v9, v46
    v_fmac_f32 v39, v9, v47
    s_waitcnt vmcnt(1)
    v_lshlrev_b32 v40, 16, v24
    v_and_b32 v41, 0xffff0000, v24
    v_lshlrev_b32 v42, 16, v25
    v_and_b32 v43, 0xffff0000, v25
    v_lshlrev_b32 v44, 16, v26
    v_and_b32 v45, 0xffff0000, v26
    v_lshlrev_b32 v46, 16, v27
    v_and_b32 v47, 0xffff0000, v27
    v_fmac_f32 v32, v10, v40
    v_fmac_f32 v33, v10, v41
    v_fmac_f32 v34, v10, v42
    v_fmac_f32 v35, v10, v43
    v_fmac_f32 v36, v10, v44
    v_fmac_f32 v37, v10, v45
    v_fmac_f32 v38, v10, v46
    v_fmac_f32 v39, v10, v47
    s_waitcnt vmcnt(0)
    v_lshlrev_b32 v40, 16, v28
    v_and_b32 v41, 0xffff0000, v28
    v_lshlrev_b32 v42, 16, v29
    v_and_b32 v43, 0xffff0000, v29
    v_lshlrev_b32 v44, 16, v30
    v_and_b32 v45, 0xffff0000, v30
    v_lshlrev_b32 v46, 16, v31
    v_and_b32 v47, 0xffff0000, v31
    v_fmac_f32 v32, v11, v40
    v_fmac_f32 v33, v11, v41
    v_fmac_f32 v34, v11, v42
    v_fmac_f32 v35, v11, v43
    v_fmac_f32 v36, v11, v44
    v_fmac_f32 v37, v11, v45
    v_fmac_f32 v38, v11, v46
    v_fmac_f32 v39, v11, v47
    v_add_f32_dpp v32, v32, v32 row_ror:8 row_mask:0xf bank_mask:0xf
    v_add_f32_dpp v33, v33, v33 row_ror:8 row_mask:0xf bank_mask:0xf
    v_add_f32_dpp v34, v34, v34 row_ror:8 row_mask:0xf bank_mask:0xf
    v_add_f32_dpp v35, v35, v35 row_ror:8 row_mask:0xf bank_mask:0xf
    v_add_f32_dpp v36, v36, v36 row_ror:8 row_mask:0xf bank_mask:0xf
    v_add_f32_dpp v37, v37, v37 row_ror:8 row_mask:0xf bank_mask:0xf
    v_add_f32_dpp v38, v38, v38 row_ror:8 row_mask:0xf bank_mask:0xf
    v_add_f32_dpp v39, v39, v39 row_ror:8 row_mask:0xf bank_mask:0xf
    v_mov_b32 v40, v32
    v_mov_b32 v41, v33
    v_mov_b32 v42, v34
    v_mov_b32 v43, v35
    v_mov_b32 v44, v36
    v_mov_b32 v45, v37
    v_mov_b32 v46, v38
    v_mov_b32 v47, v39
    v_permlane32_swap_b32 v32, v40
    v_permlane32_swap_b32 v33, v41
    v_permlane32_swap_b32 v34, v42
    v_permlane32_swap_b32 v35, v43
    v_permlane32_swap_b32 v36, v44
    v_permlane32_swap_b32 v37, v45
    v_permlane32_swap_b32 v38, v46
    v_permlane32_swap_b32 v39, v47
    v_add_f32 v32, v32, v40
    v_add_f32 v33, v33, v41
    v_add_f32 v34, v34, v42
    v_add_f32 v35, v35, v43
    v_add_f32 v36, v36, v44
    v_add_f32 v37, v37, v45
    v_add_f32 v38, v38, v46
    v_add_f32 v39, v39, v47
    v_mov_b32 v40, v32
    v_mov_b32 v41, v33
    v_mov_b32 v42, v34
    v_mov_b32 v43, v35
    v_mov_b32 v44, v36
    v_mov_b32 v45, v37
    v_mov_b32 v46, v38
    v_mov_b32 v47, v39
    v_permlane16_swap_b32 v32, v40
    v_permlane16_swap_b32 v33, v41
    v_permlane16_swap_b32 v34, v42
    v_permlane16_swap_b32 v35, v43
    v_permlane16_swap_b32 v36, v44
    v_permlane16_swap_b32 v37, v45
    v_permlane16_swap_b32 v38, v46
    v_permlane16_swap_b32 v39, v47
    v_add_f32 v32, v32, v40
    v_add_f32 v33, v33, v41
    v_add_f32 v34, v34, v42
    v_add_f32 v35, v35, v43
    v_add_f32 v36, v36, v44
    v_add_f32 v37, v37, v45
    v_add_f32 v38, v38, v46
    v_add_f32 v39, v39, v47
    v_lshrrev_b32 v40, 6, v0
    v_lshlrev_b32 v40, 8, v40
    v_and_b32 v41, 7, v0
    v_lshl_add_u32 v40, v41, 5, v40
    ds_write_b128 v40, v[32:35] offset:0
    ds_write_b128 v40, v[36:39] offset:16
    v_and_b32 v41, 63, v0
    v_lshlrev_b32 v41, 2, v41
    v_add_u32 v42, 0, v41
    s_waitcnt lgkmcnt(0)
    s_barrier
    v_cmp_gt_u32 vcc, 64, v0
    s_nop 3
    s_and_saveexec_b64 s[46:47], vcc
    s_cbranch_execz front_kernel_gskip
    ds_read_b32 v32, v42 offset:0
    ds_read_b32 v33, v42 offset:256
    ds_read_b32 v34, v42 offset:512
    ds_read_b32 v35, v42 offset:768
    ds_read_b32 v36, v42 offset:1024
    ds_read_b32 v37, v42 offset:1280
    ds_read_b32 v38, v42 offset:1536
    ds_read_b32 v39, v42 offset:1792
    s_waitcnt lgkmcnt(0)
    v_add_f32 v32, v32, v33
    v_add_f32 v34, v34, v35
    v_add_f32 v36, v36, v37
    v_add_f32 v38, v38, v39
    v_add_f32 v32, v32, v34
    v_add_f32 v36, v36, v38
    v_add_f32 v32, v32, v36
    buffer_store_dword v32, v41, s[20:23], s45 offen
front_kernel_gskip:
    s_mov_b64 exec, -1
    s_branch front_kernel_fin
front_kernel_stats:
    v_lshrrev_b32 v2, 6, v0
    s_lshl_b32 s3, s50, 4
    v_lshl_add_u32 v2, v2, 1, s3
    v_lshlrev_b32 v3, 11, v2
    v_lshl_add_u32 v3, v1, 4, v3
    v_lshlrev_b32 v2, 3, v2
    s_waitcnt lgkmcnt(0)
    s_mov_b32 s24, s8
    s_mov_b32 s25, s9
    s_mov_b32 s26, 0x400000
    s_mov_b32 s27, 0x20000
    buffer_load_dwordx4 v[8:11], v3, s[24:27], 0 offen offset:0
    buffer_load_dwordx4 v[12:15], v3, s[24:27], 0 offen offset:1024
    buffer_load_dwordx4 v[16:19], v3, s[24:27], 0 offen offset:2048
    buffer_load_dwordx4 v[20:23], v3, s[24:27], 0 offen offset:3072
    s_add_u32 s28, s40, 0x40000
    s_addc_u32 s29, s41, 0
    s_mov_b32 s30, 0x4000
    s_mov_b32 s31, 0x20000
    s_waitcnt vmcnt(0)
    v_lshlrev_b32 v24, 16, v8
    v_and_b32 v25, 0xffff0000, v8
    v_lshlrev_b32 v26, 16, v9
    v_and_b32 v27, 0xffff0000, v9
    v_lshlrev_b32 v28, 16, v10
    v_and_b32 v29, 0xffff0000, v10
    v_lshlrev_b32 v30, 16, v11
    v_and_b32 v31, 0xffff0000, v11
    v_lshlrev_b32 v32, 16, v12
    v_and_b32 v33, 0xffff0000, v12
    v_lshlrev_b32 v34, 16, v13
    v_and_b32 v35, 0xffff0000, v13
    v_lshlrev_b32 v36, 16, v14
    v_and_b32 v37, 0xffff0000, v14
    v_lshlrev_b32 v38, 16, v15
    v_and_b32 v39, 0xffff0000, v15
    v_lshlrev_b32 v40, 16, v16
    v_and_b32 v41, 0xffff0000, v16
    v_lshlrev_b32 v42, 16, v17
    v_and_b32 v43, 0xffff0000, v17
    v_lshlrev_b32 v44, 16, v18
    v_and_b32 v45, 0xffff0000, v18
    v_lshlrev_b32 v46, 16, v19
    v_and_b32 v47, 0xffff0000, v19
    v_lshlrev_b32 v48, 16, v20
    v_and_b32 v49, 0xffff0000, v20
    v_lshlrev_b32 v50, 16, v21
    v_and_b32 v51, 0xffff0000, v21
    v_lshlrev_b32 v52, 16, v22
    v_and_b32 v53, 0xffff0000, v22
    v_lshlrev_b32 v54, 16, v23
    v_and_b32 v55, 0xffff0000, v23
    v_add_f32 v56, v24, v25
    v_add_f32 v57, v26, v27
    v_add_f32 v60, v40, v41
    v_add_f32 v61, v42, v43
    v_add_f32 v56, v56, v28
    v_add_f32 v57, v57, v29
    v_add_f32 v60, v60, v44
    v_add_f32 v61, v61, v45
    v_add_f32 v56, v56, v30
    v_add_f32 v57, v57, v31
    v_add_f32 v60, v60, v46
    v_add_f32 v61, v61, v47
    v_add_f32 v56, v56, v32
    v_add_f32 v57, v57, v33
    v_add_f32 v60, v60, v48
    v_add_f32 v61, v61, v49
    v_add_f32 v56, v56, v34
    v_add_f32 v57, v57, v35
    v_add_f32 v60, v60, v50
    v_add_f32 v61, v61, v51
    v_add_f32 v56, v56, v36
    v_add_f32 v57, v57, v37
    v_add_f32 v60, v60, v52
    v_add_f32 v61, v61, v53
    v_add_f32 v56, v56, v38
    v_add_f32 v57, v57, v39
    v_add_f32 v60, v60, v54
    v_add_f32 v61, v61, v55
    v_add_f32 v56, v56, v57
    v_add_f32 v60, v60, v61
    s_nop 0
    v_add_f32_dpp v56, v56, v56 quad_perm:[1,0,3,2] row_mask:0xf bank_mask:0xf
    v_add_f32_dpp v60, v60, v60 quad_perm:[1,0,3,2] row_mask:0xf bank_mask:0xf
    s_nop 0
    v_add_f32_dpp v56, v56, v56 quad_perm:[2,3,0,1] row_mask:0xf bank_mask:0xf
    v_add_f32_dpp v60, v60, v60 quad_perm:[2,3,0,1] row_mask:0xf bank_mask:0xf
    s_nop 0
    v_add_f32_dpp v56, v56, v56 row_half_mirror row_mask:0xf bank_mask:0xf
    v_add_f32_dpp v60, v60, v60 row_half_mirror row_mask:0xf bank_mask:0xf
    s_nop 0
    v_add_f32_dpp v56, v56, v56 row_mirror row_mask:0xf bank_mask:0xf
    v_add_f32_dpp v60, v60, v60 row_mirror row_mask:0xf bank_mask:0xf
    v_mov_b32 v58, v56
    v_mov_b32 v62, v60
    s_nop 0
    v_permlane32_swap_b32 v56, v58
    v_permlane32_swap_b32 v60, v62
    v_add_f32 v56, v56, v58
    v_add_f32 v60, v60, v62
    v_mov_b32 v58, v56
    v_mov_b32 v62, v60
    s_nop 0
    v_permlane16_swap_b32 v56, v58
    v_permlane16_swap_b32 v60, v62
    v_add_f32 v56, v56, v58
    v_add_f32 v60, v60, v62
    v_mul_f32 v56, 0x3a800000, v56
    v_mul_f32 v60, 0x3a800000, v60
    v_sub_f32 v58, v24, v56
    v_mul_f32 v57, v58, v58
    v_sub_f32 v62, v40, v60
    v_mul_f32 v61, v62, v62
    v_sub_f32 v59, v25, v56
    v_fmac_f32 v57, v59, v59
    v_sub_f32 v63, v41, v60
    v_fmac_f32 v61, v63, v63
    v_sub_f32 v58, v26, v56
    v_fmac_f32 v57, v58, v58
    v_sub_f32 v62, v42, v60
    v_fmac_f32 v61, v62, v62
    v_sub_f32 v59, v27, v56
    v_fmac_f32 v57, v59, v59
    v_sub_f32 v63, v43, v60
    v_fmac_f32 v61, v63, v63
    v_sub_f32 v58, v28, v56
    v_fmac_f32 v57, v58, v58
    v_sub_f32 v62, v44, v60
    v_fmac_f32 v61, v62, v62
    v_sub_f32 v59, v29, v56
    v_fmac_f32 v57, v59, v59
    v_sub_f32 v63, v45, v60
    v_fmac_f32 v61, v63, v63
    v_sub_f32 v58, v30, v56
    v_fmac_f32 v57, v58, v58
    v_sub_f32 v62, v46, v60
    v_fmac_f32 v61, v62, v62
    v_sub_f32 v59, v31, v56
    v_fmac_f32 v57, v59, v59
    v_sub_f32 v63, v47, v60
    v_fmac_f32 v61, v63, v63
    v_sub_f32 v58, v32, v56
    v_fmac_f32 v57, v58, v58
    v_sub_f32 v62, v48, v60
    v_fmac_f32 v61, v62, v62
    v_sub_f32 v59, v33, v56
    v_fmac_f32 v57, v59, v59
    v_sub_f32 v63, v49, v60
    v_fmac_f32 v61, v63, v63
    v_sub_f32 v58, v34, v56
    v_fmac_f32 v57, v58, v58
    v_sub_f32 v62, v50, v60
    v_fmac_f32 v61, v62, v62
    v_sub_f32 v59, v35, v56
    v_fmac_f32 v57, v59, v59
    v_sub_f32 v63, v51, v60
    v_fmac_f32 v61, v63, v63
    v_sub_f32 v58, v36, v56
    v_fmac_f32 v57, v58, v58
    v_sub_f32 v62, v52, v60
    v_fmac_f32 v61, v62, v62
    v_sub_f32 v59, v37, v56
    v_fmac_f32 v57, v59, v59
    v_sub_f32 v63, v53, v60
    v_fmac_f32 v61, v63, v63
    v_sub_f32 v58, v38, v56
    v_fmac_f32 v57, v58, v58
    v_sub_f32 v62, v54, v60
    v_fmac_f32 v61, v62, v62
    v_sub_f32 v59, v39, v56
    v_fmac_f32 v57, v59, v59
    v_sub_f32 v63, v55, v60
    v_fmac_f32 v61, v63, v63
    v_add_f32_dpp v57, v57, v57 quad_perm:[1,0,3,2] row_mask:0xf bank_mask:0xf
    s_nop 0
    v_add_f32_dpp v61, v61, v61 quad_perm:[1,0,3,2] row_mask:0xf bank_mask:0xf
    v_add_f32_dpp v57, v57, v57 quad_perm:[2,3,0,1] row_mask:0xf bank_mask:0xf
    s_nop 0
    v_add_f32_dpp v61, v61, v61 quad_perm:[2,3,0,1] row_mask:0xf bank_mask:0xf
    v_add_f32_dpp v57, v57, v57 row_half_mirror row_mask:0xf bank_mask:0xf
    s_nop 0
    v_add_f32_dpp v61, v61, v61 row_half_mirror row_mask:0xf bank_mask:0xf
    v_add_f32_dpp v57, v57, v57 row_mirror row_mask:0xf bank_mask:0xf
    s_nop 0
    v_add_f32_dpp v61, v61, v61 row_mirror row_mask:0xf bank_mask:0xf
    v_mov_b32 v58, v57
    v_mov_b32 v62, v61
    s_nop 0
    v_permlane32_swap_b32 v57, v58
    v_permlane32_swap_b32 v61, v62
    v_add_f32 v57, v57, v58
    v_add_f32 v61, v61, v62
    v_mov_b32 v58, v57
    v_mov_b32 v62, v61
    s_nop 0
    v_permlane16_swap_b32 v57, v58
    v_permlane16_swap_b32 v61, v62
    v_add_f32 v57, v57, v58
    v_add_f32 v61, v61, v62
    v_mul_f32 v57, 0x3a800000, v57
    v_mul_f32 v61, 0x3a800000, v61
    v_cvt_pk_bf16_f32 v58, v56, v57
    v_lshlrev_b32 v56, 16, v58
    v_and_b32 v57, 0xffff0000, v58
    v_cvt_pk_bf16_f32 v62, v60, v61
    v_lshlrev_b32 v60, 16, v62
    v_and_b32 v61, 0xffff0000, v62
    v_add_f32 v57, 0x3727c5ac, v57
    v_add_f32 v61, 0x3727c5ac, v61
    v_cvt_pk_bf16_f32 v58, v57, v57
    v_lshlrev_b32 v57, 16, v58
    v_cvt_pk_bf16_f32 v62, v61, v61
    v_lshlrev_b32 v61, 16, v62
    v_sqrt_f32 v57, v57
    v_sqrt_f32 v61, v61
    v_cvt_pk_bf16_f32 v58, v57, v57
    v_lshlrev_b32 v57, 16, v58
    v_cvt_pk_bf16_f32 v62, v61, v61
    v_lshlrev_b32 v61, 16, v62
    v_rcp_f32 v57, v57
    v_rcp_f32 v61, v61
    v_mov_b32 v58, v60
    v_mov_b32 v59, v61
    v_cmp_eq_u32 vcc, 0, v1
    s_nop 3
    s_and_saveexec_b64 s[46:47], vcc
    buffer_store_dwordx4 v[56:59], v2, s[28:31], 0 offen
front_kernel_fin:
front_kernel_end:
    s_endpgm
.globl mod1_kernel
.p2align 8
.type mod1_kernel,@function
mod1_kernel:
    s_cmp_ge_u32 s2, 256
    s_cbranch_scc1 mod1_kernel_end
    s_load_dwordx4 s[8:11], s[0:1], 0
    s_load_dwordx2 s[40:41], s[0:1], 88
    s_lshr_b32 s3, s2, 4
    s_lshl_b32 s3, s3, 7
    s_and_b32 s60, s2, 15
    v_lshrrev_b32 v1, 3, v0
    v_add_u32 v1, s3, v1
    v_lshlrev_b32 v2, 3, v1
    s_movk_i32 s3, 2176
    v_mul_lo_u32 v60, s3, v1
    v_lshlrev_b32 v1, 11, v1
    v_and_b32 v3, 7, v0
    s_lshl_b32 s3, s60, 7
    v_lshl_add_u32 v4, v3, 4, s3
    v_add_u32 v1, v4, v1
    v_add_u32 v60, v4, v60
    v_and_b32 v4, 63, v0
    v_bfe_u32 v5, v0, 6, 1
    v_lshlrev_b32 v5, 12, v5
    v_lshl_add_u32 v5, v4, 2, v5
    s_lshl_b32 s3, s60, 8
    v_add_u32 v5, s3, v5
    s_lshl_b32 s3, s2, 9
    v_add_lshl_u32 v6, v0, s3, 4
    s_mov_b32 s64, 0
    s_mov_b32 s65, 8192
    s_mov_b32 s66, 16384
    s_mov_b32 s67, 24576
    s_mov_b32 s72, 0x20000
    s_mov_b32 s76, 0x22000
    s_waitcnt lgkmcnt(0)
    s_add_u32 s32, s40, 0x10000
    s_addc_u32 s33, s41, 0
    s_mov_b32 s34, 0x8000
    s_mov_b32 s35, 0x20000
    s_add_u32 s28, s40, 0x40000
    s_addc_u32 s29, s41, 0
    s_mov_b32 s30, 0x4000
    s_mov_b32 s31, 0x20000
    s_mov_b32 s24, s8
    s_mov_b32 s25, s9
    s_mov_b32 s26, 0x400000
    s_mov_b32 s27, 0x20000
    buffer_load_dword v8, v5, s[32:35], s64 offen
    buffer_load_dword v9, v5, s[32:35], s65 offen
    buffer_load_dword v10, v5, s[32:35], s66 offen
    buffer_load_dword v11, v5, s[32:35], s67 offen
    buffer_load_dwordx2 v[16:17], v2, s[28:31], 0 offen offset:0
    buffer_load_dwordx2 v[18:19], v2, s[28:31], 0 offen offset:512
    buffer_load_dwordx4 v[24:27], v1, s[24:27], 0 offen
    buffer_load_dwordx4 v[28:31], v1, s[24:27], s72 offen
    s_mov_b32 s12, s10
    s_mov_b32 s13, s11
    s_mov_b32 s14, 0x200000
    s_mov_b32 s15, 0x20000
    s_mov_b32 s3, 0x0
    buffer_load_dword v7, v6, s[12:15], s3 offen
    s_add_u32 s36, s40, 0x100000
    s_addc_u32 s37, s41, 0
    s_mov_b32 s38, 0x440000
    s_mov_b32 s39, 0x20000
    s_add_u32 s16, s40, 0x50000
    s_addc_u32 s17, s41, 0
    s_mov_b32 s18, 0x4000
    s_mov_b32 s19, 0x20000
    s_lshl_b32 s3, s2, 11
    v_lshl_add_u32 v61, v0, 2, s3
    v_mov_b32 v62, 0
    buffer_store_dword v62, v61, s[16:19], 0 offen
    s_waitcnt vmcnt(6)
    v_add_f32 v8, v8, v9
    v_add_f32 v10, v10, v11
    v_add_f32 v8, v8, v10
    v_cvt_pk_bf16_f32 v9, v8, v8
    v_lshlrev_b32 v8, 16, v9
    v_bfe_u32 v9, v0, 6, 1
    v_cvt_f32_u32 v9, v9
    v_add_f32 v8, v8, v9
    v_cvt_pk_bf16_f32 v9, v8, v8
    v_lshlrev_b32 v8, 16, v9
    v_and_b32 v9, 127, v0
    v_lshlrev_b32 v9, 2, v9
    ds_write_b32 v9, v8
    v_lshlrev_b32 v9, 5, v3
    s_waitcnt lgkmcnt(0)
    s_barrier
    ds_read_b128 v[32:35], v9
    ds_read_b128 v[36:39], v9 offset:16
    ds_read_b128 v[40:43], v9 offset:256
    ds_read_b128 v[44:47], v9 offset:272
    s_waitcnt vmcnt(2) lgkmcnt(0)
    v_lshlrev_b32 v48, 16, v24
    v_and_b32 v49, 0xffff0000, v24
    v_lshlrev_b32 v50, 16, v25
    v_and_b32 v51, 0xffff0000, v25
    v_lshlrev_b32 v52, 16, v26
    v_and_b32 v53, 0xffff0000, v26
    v_lshlrev_b32 v54, 16, v27
    v_and_b32 v55, 0xffff0000, v27
    v_sub_f32 v48, v48, v16
    v_sub_f32 v49, v49, v16
    v_sub_f32 v50, v50, v16
    v_sub_f32 v51, v51, v16
    v_sub_f32 v52, v52, v16
    v_sub_f32 v53, v53, v16
    v_sub_f32 v54, v54, v16
    v_sub_f32 v55, v55, v16
    v_cvt_pk_bf16_f32 v56, v48, v49
    v_lshlrev_b32 v48, 16, v56
    v_and_b32 v49, 0xffff0000, v56
    v_cvt_pk_bf16_f32 v57, v50, v51
    v_lshlrev_b32 v50, 16, v57
    v_and_b32 v51, 0xffff0000, v57
    v_cvt_pk_bf16_f32 v58, v52, v53
    v_lshlrev_b32 v52, 16, v58
    v_and_b32 v53, 0xffff0000, v58
    v_cvt_pk_bf16_f32 v59, v54, v55
    v_lshlrev_b32 v54, 16, v59
    v_and_b32 v55, 0xffff0000, v59
    v_mul_f32 v48, v48, v17
    v_mul_f32 v49, v49, v17
    v_mul_f32 v50, v50, v17
    v_mul_f32 v51, v51, v17
    v_mul_f32 v52, v52, v17
    v_mul_f32 v53, v53, v17
    v_mul_f32 v54, v54, v17
    v_mul_f32 v55, v55, v17
    v_cvt_pk_bf16_f32 v56, v48, v49
    v_lshlrev_b32 v48, 16, v56
    v_and_b32 v49, 0xffff0000, v56
    v_cvt_pk_bf16_f32 v57, v50, v51
    v_lshlrev_b32 v50, 16, v57
    v_and_b32 v51, 0xffff0000, v57
    v_cvt_pk_bf16_f32 v58, v52, v53
    v_lshlrev_b32 v52, 16, v58
    v_and_b32 v53, 0xffff0000, v58
    v_cvt_pk_bf16_f32 v59, v54, v55
    v_lshlrev_b32 v54, 16, v59
    v_and_b32 v55, 0xffff0000, v59
    v_mul_f32 v48, v48, v40
    v_mul_f32 v49, v49, v41
    v_mul_f32 v50, v50, v42
    v_mul_f32 v51, v51, v43
    v_mul_f32 v52, v52, v44
    v_mul_f32 v53, v53, v45
    v_mul_f32 v54, v54, v46
    v_mul_f32 v55, v55, v47
    v_cvt_pk_bf16_f32 v56, v48, v49
    v_lshlrev_b32 v48, 16, v56
    v_and_b32 v49, 0xffff0000, v56
    v_cvt_pk_bf16_f32 v57, v50, v51
    v_lshlrev_b32 v50, 16, v57
    v_and_b32 v51, 0xffff0000, v57
    v_cvt_pk_bf16_f32 v58, v52, v53
    v_lshlrev_b32 v52, 16, v58
    v_and_b32 v53, 0xffff0000, v58
    v_cvt_pk_bf16_f32 v59, v54, v55
    v_lshlrev_b32 v54, 16, v59
    v_and_b32 v55, 0xffff0000, v59
    v_add_f32 v48, v48, v32
    v_add_f32 v49, v49, v33
    v_add_f32 v50, v50, v34
    v_add_f32 v51, v51, v35
    v_add_f32 v52, v52, v36
    v_add_f32 v53, v53, v37
    v_add_f32 v54, v54, v38
    v_add_f32 v55, v55, v39
    v_cvt_pk_bf16_f32 v24, v48, v49
    v_cvt_pk_bf16_f32 v25, v50, v51
    v_cvt_pk_bf16_f32 v26, v52, v53
    v_cvt_pk_bf16_f32 v27, v54, v55
    buffer_store_dwordx4 v[24:27], v60, s[36:39], 0 offen
    v_lshlrev_b32 v48, 16, v28
    v_and_b32 v49, 0xffff0000, v28
    v_lshlrev_b32 v50, 16, v29
    v_and_b32 v51, 0xffff0000, v29
    v_lshlrev_b32 v52, 16, v30
    v_and_b32 v53, 0xffff0000, v30
    v_lshlrev_b32 v54, 16, v31
    v_and_b32 v55, 0xffff0000, v31
    v_sub_f32 v48, v48, v18
    v_sub_f32 v49, v49, v18
    v_sub_f32 v50, v50, v18
    v_sub_f32 v51, v51, v18
    v_sub_f32 v52, v52, v18
    v_sub_f32 v53, v53, v18
    v_sub_f32 v54, v54, v18
    v_sub_f32 v55, v55, v18
    v_cvt_pk_bf16_f32 v56, v48, v49
    v_lshlrev_b32 v48, 16, v56
    v_and_b32 v49, 0xffff0000, v56
    v_cvt_pk_bf16_f32 v57, v50, v51
    v_lshlrev_b32 v50, 16, v57
    v_and_b32 v51, 0xffff0000, v57
    v_cvt_pk_bf16_f32 v58, v52, v53
    v_lshlrev_b32 v52, 16, v58
    v_and_b32 v53, 0xffff0000, v58
    v_cvt_pk_bf16_f32 v59, v54, v55
    v_lshlrev_b32 v54, 16, v59
    v_and_b32 v55, 0xffff0000, v59
    v_mul_f32 v48, v48, v19
    v_mul_f32 v49, v49, v19
    v_mul_f32 v50, v50, v19
    v_mul_f32 v51, v51, v19
    v_mul_f32 v52, v52, v19
    v_mul_f32 v53, v53, v19
    v_mul_f32 v54, v54, v19
    v_mul_f32 v55, v55, v19
    v_cvt_pk_bf16_f32 v56, v48, v49
    v_lshlrev_b32 v48, 16, v56
    v_and_b32 v49, 0xffff0000, v56
    v_cvt_pk_bf16_f32 v57, v50, v51
    v_lshlrev_b32 v50, 16, v57
    v_and_b32 v51, 0xffff0000, v57
    v_cvt_pk_bf16_f32 v58, v52, v53
    v_lshlrev_b32 v52, 16, v58
    v_and_b32 v53, 0xffff0000, v58
    v_cvt_pk_bf16_f32 v59, v54, v55
    v_lshlrev_b32 v54, 16, v59
    v_and_b32 v55, 0xffff0000, v59
    v_mul_f32 v48, v48, v40
    v_mul_f32 v49, v49, v41
    v_mul_f32 v50, v50, v42
    v_mul_f32 v51, v51, v43
    v_mul_f32 v52, v52, v44
    v_mul_f32 v53, v53, v45
    v_mul_f32 v54, v54, v46
    v_mul_f32 v55, v55, v47
    v_cvt_pk_bf16_f32 v56, v48, v49
    v_lshlrev_b32 v48, 16, v56
    v_and_b32 v49, 0xffff0000, v56
    v_cvt_pk_bf16_f32 v57, v50, v51
    v_lshlrev_b32 v50, 16, v57
    v_and_b32 v51, 0xffff0000, v57
    v_cvt_pk_bf16_f32 v58, v52, v53
    v_lshlrev_b32 v52, 16, v58
    v_and_b32 v53, 0xffff0000, v58
    v_cvt_pk_bf16_f32 v59, v54, v55
    v_lshlrev_b32 v54, 16, v59
    v_and_b32 v55, 0xffff0000, v59
    v_add_f32 v48, v48, v32
    v_add_f32 v49, v49, v33
    v_add_f32 v50, v50, v34
    v_add_f32 v51, v51, v35
    v_add_f32 v52, v52, v36
    v_add_f32 v53, v53, v37
    v_add_f32 v54, v54, v38
    v_add_f32 v55, v55, v39
    v_cvt_pk_bf16_f32 v28, v48, v49
    v_cvt_pk_bf16_f32 v29, v50, v51
    v_cvt_pk_bf16_f32 v30, v52, v53
    v_cvt_pk_bf16_f32 v31, v54, v55
    buffer_store_dwordx4 v[28:31], v60, s[36:39], s76 offen
mod1_kernel_end:
    s_endpgm
.globl qkv_kernel
.p2align 8
.type qkv_kernel,@function
qkv_kernel:
    s_cmp_ge_u32 s2, 256
    s_cbranch_scc1 qkv_kernel_end
    s_load_dwordx4 s[4:7], s[0:1], 8
    s_load_dwordx2 s[8:9], s[0:1], 88
    s_load_dwordx4 s[80:83], s[0:1], 56
    v_lshrrev_b32 v2, 6, v0
    v_and_b32 v1, 63, v0
    v_readfirstlane_b32 s28, v2
    s_and_b32 s3, s2, 7
    s_lshr_b32 s44, s2, 3
    s_and_b32 s45, s3, 1
    s_lshl_b32 s45, s45, 3
    s_and_b32 s46, s44, 7
    s_add_u32 s32, s45, s46
    s_lshr_b32 s45, s3, 1
    s_lshl_b32 s45, s45, 2
    s_lshr_b32 s46, s44, 3
    s_add_u32 s33, s45, s46
    s_lshl_b32 s32, s32, 7
    s_cmp_ge_u32 s28, 4
    s_cbranch_scc1 qkv_kernel_L
    s_mov_b32 s29, 0
    s_lshr_b32 s30, s28, 1
    s_and_b32 s31, s28, 1
    s_mov_b32 s35, 0
    v_and_b32 v214, 15, v1
    v_lshrrev_b32 v215, 4, v1
    s_lshl_b32 s44, s29, 2
    v_add_u32 v216, s44, v215
    v_lshrrev_b32 v217, 1, v214
    v_xor_b32 v216, v216, v217
    v_lshlrev_b32 v216, 4, v216
    v_lshl_add_u32 v216, v214, 7, v216
    s_lshl_b32 s44, s30, 13
    v_add_u32 v222, s44, v216
    v_bfe_u32 v214, v1, 2, 2
    v_lshl_add_u32 v216, v215, 3, v214
    s_lshl_b32 s44, s29, 5
    v_add_u32 v216, s44, v216
    v_mul_u32_u24 v216, 384, v216
    v_and_b32 v217, 3, v1
    v_lshl_add_u32 v216, v217, 3, v216
    v_add_u32 v216, 18432, v216
    v_lshrrev_b32 v214, 1, v214
    v_and_b32 v215, 1, v215
    v_lshl_or_b32 v214, v215, 1, v214
    s_lshl_b32 s44, s31, 1
    v_xor_b32 v214, s44, v214
    v_lshl_add_u32 v223, v214, 5, v216
    v_xor_b32 v214, 1, v214
    v_lshl_add_u32 v224, v214, 5, v216
    v_xor_b32 v211, 64, v222
    v_and_b32 v214, 15, v1
    v_lshrrev_b32 v215, 4, v1
    v_lshlrev_b32 v215, 2, v215
    v_sub_u32 v215, v214, v215
    s_mov_b32 s44, 0x80000001
    v_sub_u32 v216, -2, v215
    v_and_b32 v216, s44, v216
    v_cmp_eq_u32 s[56:57], 0, v216
    v_subrev_u32 v216, 0, v215
    v_and_b32 v216, s44, v216
    v_cmp_eq_u32 s[64:65], 0, v216
    v_sub_u32 v216, -1, v215
    v_and_b32 v216, s44, v216
    v_cmp_eq_u32 s[58:59], 0, v216
    v_subrev_u32 v216, 1, v215
    v_and_b32 v216, s44, v216
    v_cmp_eq_u32 s[66:67], 0, v216
    v_sub_u32 v216, 0, v215
    v_and_b32 v216, s44, v216
    v_cmp_eq_u32 s[60:61], 0, v216
    v_subrev_u32 v216, 2, v215
    v_and_b32 v216, s44, v216
    v_cmp_eq_u32 s[68:69], 0, v216
    v_sub_u32 v216, 1, v215
    v_and_b32 v216, s44, v216
    v_cmp_eq_u32 s[62:63], 0, v216
    v_subrev_u32 v216, 3, v215
    v_and_b32 v216, s44, v216
    v_cmp_eq_u32 s[70:71], 0, v216
    s_lshl_b32 s44, s30, 6
    s_add_u32 s47, s44, s32
    v_add_u32 v214, s47, v214
    s_movk_i32 s44, 2176
    v_mul_lo_u32 v214, s44, v214
    v_bfe_u32 v215, v1, 4, 1
    v_lshlrev_b32 v215, 4, v215
    v_bfe_u32 v216, v1, 5, 1
    v_lshl_or_b32 v215, v216, 3, v215
    s_lshl_b32 s44, s33, 6
    s_lshl_b32 s45, s31, 5
    s_add_u32 s44, s44, s45
    v_add_u32 v215, s44, v215
    v_lshl_add_u32 v225, v215, 1, v214
    s_cmp_eq_u32 s47, 0
    s_cselect_b64 s[72:73], 0, s[56:57]
    s_cselect_b64 s[74:75], 0, s[58:59]
    s_cselect_b64 s[76:77], 0, s[60:61]
    s_cselect_b64 s[78:79], 0, s[62:63]
    s_lshl_b32 s44, s2, 8
    v_add_lshl_u32 v212, v0, s44, 5
    s_waitcnt lgkmcnt(0)
    s_add_u32 s20, s8, 0x600000
    s_addc_u32 s21, s9, 0
    s_mov_b32 s22, 0x440000
    s_mov_b32 s23, 0x20000
    s_barrier
    v_add_u32 v208, s35, v222
    v_add_u32 v209, s35, v223
    v_add_u32 v210, s35, v224
    ds_read_b128 v[120:123], v208 offset:0
    ds_read_b64_tr_b16 v[148:149], v209 offset:128
    ds_read_b64_tr_b16 v[150:151], v209 offset:1664
    ds_read_b64_tr_b16 v[152:153], v210 offset:128
    ds_read_b64_tr_b16 v[154:155], v210 offset:1664
    ds_read_b64_tr_b16 v[156:157], v209 offset:256
    ds_read_b64_tr_b16 v[158:159], v209 offset:1792
    ds_read_b64_tr_b16 v[160:161], v210 offset:256
    ds_read_b64_tr_b16 v[162:163], v210 offset:1792
    ds_read_b128 v[124:127], v208 offset:2048
    ds_read_b64_tr_b16 v[140:141], v209 offset:0
    ds_read_b64_tr_b16 v[142:143], v209 offset:1536
    ds_read_b64_tr_b16 v[144:145], v210 offset:0
    ds_read_b64_tr_b16 v[146:147], v210 offset:1536
    ds_read_b128 v[128:131], v208 offset:4096
    ds_read_b128 v[132:135], v208 offset:6144
    ds_read_b128 v[136:139], v208 offset:8192
    v_add_u32 v208, s35, v211
    s_add_u32 s35, s35, 43008
    s_cmp_ge_u32 s35, 129024
    s_cselect_b32 s35, 0, s35
    s_waitcnt lgkmcnt(0)
    v_mfma_f32_16x16x32_bf16 v[40:43], v[148:151], v[120:123], 0
    ds_read_b128 v[164:167], v208 offset:0
    s_mov_b32 s40, s4
    s_mov_b32 s41, s5
    s_mov_b32 s42, 0x400000
    s_mov_b32 s43, 0x20000
    s_mov_b32 s44, 0x200000
    buffer_load_dword v213, v212, s[40:43], s44 offen
    v_mfma_f32_16x16x32_bf16 v[44:47], v[152:155], v[120:123], 0
    ds_read_b64_tr_b16 v[192:193], v209 offset:12416
    v_mfma_f32_16x16x32_bf16 v[80:83], v[120:123], v[156:159], 0
    ds_read_b64_tr_b16 v[194:195], v209 offset:13952
    v_mfma_f32_16x16x32_bf16 v[84:87], v[120:123], v[160:163], 0
    ds_read_b64_tr_b16 v[196:197], v210 offset:12416
    v_mfma_f32_16x16x32_bf16 v[48:51], v[148:151], v[124:127], 0
    ds_read_b64_tr_b16 v[198:199], v210 offset:13952
    v_mfma_f32_16x16x32_bf16 v[52:55], v[152:155], v[124:127], 0
    v_mfma_f32_16x16x32_bf16 v[88:91], v[124:127], v[156:159], 0
    ds_read_b64_tr_b16 v[200:201], v209 offset:12544
    v_mfma_f32_16x16x32_bf16 v[92:95], v[124:127], v[160:163], 0
    ds_read_b64_tr_b16 v[202:203], v209 offset:14080
    v_mfma_f32_16x16x32_bf16 v[8:11], v[140:143], v[124:127], 0
    ds_read_b64_tr_b16 v[204:205], v210 offset:12544
    v_mfma_f32_16x16x32_bf16 v[12:15], v[144:147], v[124:127], 0
    ds_read_b64_tr_b16 v[206:207], v210 offset:14080
    v_mfma_f32_16x16x32_bf16 v[56:59], v[148:151], v[128:131], 0
    v_mfma_f32_16x16x32_bf16 v[60:63], v[152:155], v[128:131], 0
    ds_read_b128 v[168:171], v208 offset:2048
    v_mfma_f32_16x16x32_bf16 v[96:99], v[128:131], v[156:159], 0
    ds_read_b64_tr_b16 v[184:185], v209 offset:12288
    v_mfma_f32_16x16x32_bf16 v[100:103], v[128:131], v[160:163], 0
    ds_read_b64_tr_b16 v[186:187], v209 offset:13824
    v_mfma_f32_16x16x32_bf16 v[16:19], v[140:143], v[128:131], 0
    ds_read_b64_tr_b16 v[188:189], v210 offset:12288
    v_mfma_f32_16x16x32_bf16 v[20:23], v[144:147], v[128:131], 0
    v_mfma_f32_16x16x32_bf16 v[64:67], v[148:151], v[132:135], 0
    ds_read_b64_tr_b16 v[190:191], v210 offset:13824
    v_mfma_f32_16x16x32_bf16 v[68:71], v[152:155], v[132:135], 0
    ds_read_b128 v[172:175], v208 offset:4096
    v_mfma_f32_16x16x32_bf16 v[104:107], v[132:135], v[156:159], 0
    ds_read_b128 v[176:179], v208 offset:6144
    v_mfma_f32_16x16x32_bf16 v[108:111], v[132:135], v[160:163], 0
    ds_read_b128 v[180:183], v208 offset:8192
    v_mfma_f32_16x16x32_bf16 v[24:27], v[140:143], v[132:135], 0
    v_mfma_f32_16x16x32_bf16 v[28:31], v[144:147], v[132:135], 0
    v_add_u32 v208, s35, v222
    v_mfma_f32_16x16x32_bf16 v[72:75], v[148:151], v[136:139], 0
    v_mfma_f32_16x16x32_bf16 v[76:79], v[152:155], v[136:139], 0
    v_add_u32 v209, s35, v223
    v_mfma_f32_16x16x32_bf16 v[112:115], v[136:139], v[156:159], 0
    v_mfma_f32_16x16x32_bf16 v[116:119], v[136:139], v[160:163], 0
    v_add_u32 v210, s35, v224
    v_mfma_f32_16x16x32_bf16 v[32:35], v[140:143], v[136:139], 0
    v_mfma_f32_16x16x32_bf16 v[36:39], v[144:147], v[136:139], 0
    s_waitcnt lgkmcnt(0)
    v_mfma_f32_16x16x32_bf16 v[40:43], v[192:195], v[164:167], v[40:43]
    s_barrier
    v_mfma_f32_16x16x32_bf16 v[44:47], v[196:199], v[164:167], v[44:47]
    ds_read_b128 v[120:123], v208 offset:0
    v_mfma_f32_16x16x32_bf16 v[80:83], v[164:167], v[200:203], v[80:83]
    ds_read_b64_tr_b16 v[148:149], v209 offset:128
    v_mfma_f32_16x16x32_bf16 v[84:87], v[164:167], v[204:207], v[84:87]
    ds_read_b64_tr_b16 v[150:151], v209 offset:1664
    v_mfma_f32_16x16x32_bf16 v[48:51], v[192:195], v[168:171], v[48:51]
    ds_read_b64_tr_b16 v[152:153], v210 offset:128
    v_mfma_f32_16x16x32_bf16 v[52:55], v[196:199], v[168:171], v[52:55]
    ds_read_b64_tr_b16 v[154:155], v210 offset:1664
    v_mfma_f32_16x16x32_bf16 v[88:91], v[168:171], v[200:203], v[88:91]
    ds_read_b64_tr_b16 v[156:157], v209 offset:256
    v_mfma_f32_16x16x32_bf16 v[92:95], v[168:171], v[204:207], v[92:95]
    v_mfma_f32_16x16x32_bf16 v[8:11], v[184:187], v[168:171], v[8:11]
    ds_read_b64_tr_b16 v[158:159], v209 offset:1792
    v_mfma_f32_16x16x32_bf16 v[12:15], v[188:191], v[168:171], v[12:15]
    ds_read_b64_tr_b16 v[160:161], v210 offset:256
    v_mfma_f32_16x16x32_bf16 v[56:59], v[192:195], v[172:175], v[56:59]
    ds_read_b64_tr_b16 v[162:163], v210 offset:1792
    v_mfma_f32_16x16x32_bf16 v[60:63], v[196:199], v[172:175], v[60:63]
    ds_read_b128 v[124:127], v208 offset:2048
    v_mfma_f32_16x16x32_bf16 v[96:99], v[172:175], v[200:203], v[96:99]
    ds_read_b64_tr_b16 v[140:141], v209 offset:0
    v_mfma_f32_16x16x32_bf16 v[100:103], v[172:175], v[204:207], v[100:103]
    ds_read_b64_tr_b16 v[142:143], v209 offset:1536
    v_mfma_f32_16x16x32_bf16 v[16:19], v[184:187], v[172:175], v[16:19]
    v_mfma_f32_16x16x32_bf16 v[20:23], v[188:191], v[172:175], v[20:23]
    ds_read_b64_tr_b16 v[144:145], v210 offset:0
    v_mfma_f32_16x16x32_bf16 v[64:67], v[192:195], v[176:179], v[64:67]
    ds_read_b64_tr_b16 v[146:147], v210 offset:1536
    v_mfma_f32_16x16x32_bf16 v[68:71], v[196:199], v[176:179], v[68:71]
    ds_read_b128 v[128:131], v208 offset:4096
    v_mfma_f32_16x16x32_bf16 v[104:107], v[176:179], v[200:203], v[104:107]
    ds_read_b128 v[132:135], v208 offset:6144
    v_mfma_f32_16x16x32_bf16 v[108:111], v[176:179], v[204:207], v[108:111]
    ds_read_b128 v[136:139], v208 offset:8192
    v_mfma_f32_16x16x32_bf16 v[24:27], v[184:187], v[176:179], v[24:27]
    v_mfma_f32_16x16x32_bf16 v[28:31], v[188:191], v[176:179], v[28:31]
    v_add_u32 v208, s35, v211
    v_mfma_f32_16x16x32_bf16 v[72:75], v[192:195], v[180:183], v[72:75]
    v_mfma_f32_16x16x32_bf16 v[76:79], v[196:199], v[180:183], v[76:79]
    v_mfma_f32_16x16x32_bf16 v[112:115], v[180:183], v[200:203], v[112:115]
    v_mfma_f32_16x16x32_bf16 v[116:119], v[180:183], v[204:207], v[116:119]
    v_mfma_f32_16x16x32_bf16 v[32:35], v[184:187], v[180:183], v[32:35]
    s_add_u32 s35, s35, 43008
    s_cmp_ge_u32 s35, 129024
    s_cselect_b32 s35, 0, s35
    v_mfma_f32_16x16x32_bf16 v[36:39], v[188:191], v[180:183], v[36:39]
    s_waitcnt lgkmcnt(0)
    v_mfma_f32_16x16x32_bf16 v[40:43], v[148:151], v[120:123], v[40:43]
    ds_read_b128 v[164:167], v208 offset:0
    s_mov_b32 s40, s4
    s_mov_b32 s41, s5
    s_mov_b32 s42, 0x600000
    s_mov_b32 s43, 0x20000
    s_mov_b32 s44, 0x400000
    buffer_load_dword v213, v212, s[40:43], s44 offen
    v_mfma_f32_16x16x32_bf16 v[44:47], v[152:155], v[120:123], v[44:47]
    ds_read_b64_tr_b16 v[192:193], v209 offset:12416
    v_mfma_f32_16x16x32_bf16 v[80:83], v[120:123], v[156:159], v[80:83]
    ds_read_b64_tr_b16 v[194:195], v209 offset:13952
    v_mfma_f32_16x16x32_bf16 v[84:87], v[120:123], v[160:163], v[84:87]
    ds_read_b64_tr_b16 v[196:197], v210 offset:12416
    v_mfma_f32_16x16x32_bf16 v[48:51], v[148:151], v[124:127], v[48:51]
    ds_read_b64_tr_b16 v[198:199], v210 offset:13952
    v_mfma_f32_16x16x32_bf16 v[52:55], v[152:155], v[124:127], v[52:55]
    v_mfma_f32_16x16x32_bf16 v[88:91], v[124:127], v[156:159], v[88:91]
    ds_read_b64_tr_b16 v[200:201], v209 offset:12544
    v_mfma_f32_16x16x32_bf16 v[92:95], v[124:127], v[160:163], v[92:95]
    ds_read_b64_tr_b16 v[202:203], v209 offset:14080
    v_mfma_f32_16x16x32_bf16 v[8:11], v[140:143], v[124:127], v[8:11]
    ds_read_b64_tr_b16 v[204:205], v210 offset:12544
    v_mfma_f32_16x16x32_bf16 v[12:15], v[144:147], v[124:127], v[12:15]
    ds_read_b64_tr_b16 v[206:207], v210 offset:14080
    v_mfma_f32_16x16x32_bf16 v[56:59], v[148:151], v[128:131], v[56:59]
    v_mfma_f32_16x16x32_bf16 v[60:63], v[152:155], v[128:131], v[60:63]
    ds_read_b128 v[168:171], v208 offset:2048
    v_mfma_f32_16x16x32_bf16 v[96:99], v[128:131], v[156:159], v[96:99]
    ds_read_b64_tr_b16 v[184:185], v209 offset:12288
    v_mfma_f32_16x16x32_bf16 v[100:103], v[128:131], v[160:163], v[100:103]
    ds_read_b64_tr_b16 v[186:187], v209 offset:13824
    v_mfma_f32_16x16x32_bf16 v[16:19], v[140:143], v[128:131], v[16:19]
    s_movk_i32 s36, 14
qkv_kernel_C_loop0:
    ds_read_b64_tr_b16 v[188:189], v210 offset:12288
    v_mfma_f32_16x16x32_bf16 v[20:23], v[144:147], v[128:131], v[20:23]
    v_mfma_f32_16x16x32_bf16 v[64:67], v[148:151], v[132:135], v[64:67]
    ds_read_b64_tr_b16 v[190:191], v210 offset:13824
    v_mfma_f32_16x16x32_bf16 v[68:71], v[152:155], v[132:135], v[68:71]
    ds_read_b128 v[172:175], v208 offset:4096
    v_mfma_f32_16x16x32_bf16 v[104:107], v[132:135], v[156:159], v[104:107]
    ds_read_b128 v[176:179], v208 offset:6144
    v_mfma_f32_16x16x32_bf16 v[108:111], v[132:135], v[160:163], v[108:111]
    ds_read_b128 v[180:183], v208 offset:8192
    v_mfma_f32_16x16x32_bf16 v[24:27], v[140:143], v[132:135], v[24:27]
    v_mfma_f32_16x16x32_bf16 v[28:31], v[144:147], v[132:135], v[28:31]
    v_add_u32 v208, s35, v222
    v_mfma_f32_16x16x32_bf16 v[72:75], v[148:151], v[136:139], v[72:75]
    v_mfma_f32_16x16x32_bf16 v[76:79], v[152:155], v[136:139], v[76:79]
    v_add_u32 v209, s35, v223
    v_mfma_f32_16x16x32_bf16 v[112:115], v[136:139], v[156:159], v[112:115]
    v_mfma_f32_16x16x32_bf16 v[116:119], v[136:139], v[160:163], v[116:119]
    v_add_u32 v210, s35, v224
    v_mfma_f32_16x16x32_bf16 v[32:35], v[140:143], v[136:139], v[32:35]
    v_mfma_f32_16x16x32_bf16 v[36:39], v[144:147], v[136:139], v[36:39]
    s_waitcnt lgkmcnt(0)
    v_mfma_f32_16x16x32_bf16 v[40:43], v[192:195], v[164:167], v[40:43]
    s_barrier
    v_mfma_f32_16x16x32_bf16 v[44:47], v[196:199], v[164:167], v[44:47]
    ds_read_b128 v[120:123], v208 offset:0
    v_mfma_f32_16x16x32_bf16 v[80:83], v[164:167], v[200:203], v[80:83]
    ds_read_b64_tr_b16 v[148:149], v209 offset:128
    v_mfma_f32_16x16x32_bf16 v[84:87], v[164:167], v[204:207], v[84:87]
    ds_read_b64_tr_b16 v[150:151], v209 offset:1664
    v_mfma_f32_16x16x32_bf16 v[48:51], v[192:195], v[168:171], v[48:51]
    ds_read_b64_tr_b16 v[152:153], v210 offset:128
    v_mfma_f32_16x16x32_bf16 v[52:55], v[196:199], v[168:171], v[52:55]
    ds_read_b64_tr_b16 v[154:155], v210 offset:1664
    v_mfma_f32_16x16x32_bf16 v[88:91], v[168:171], v[200:203], v[88:91]
    ds_read_b64_tr_b16 v[156:157], v209 offset:256
    v_mfma_f32_16x16x32_bf16 v[92:95], v[168:171], v[204:207], v[92:95]
    v_mfma_f32_16x16x32_bf16 v[8:11], v[184:187], v[168:171], v[8:11]
    ds_read_b64_tr_b16 v[158:159], v209 offset:1792
    v_mfma_f32_16x16x32_bf16 v[12:15], v[188:191], v[168:171], v[12:15]
    ds_read_b64_tr_b16 v[160:161], v210 offset:256
    v_mfma_f32_16x16x32_bf16 v[56:59], v[192:195], v[172:175], v[56:59]
    ds_read_b64_tr_b16 v[162:163], v210 offset:1792
    v_mfma_f32_16x16x32_bf16 v[60:63], v[196:199], v[172:175], v[60:63]
    ds_read_b128 v[124:127], v208 offset:2048
    v_mfma_f32_16x16x32_bf16 v[96:99], v[172:175], v[200:203], v[96:99]
    ds_read_b64_tr_b16 v[140:141], v209 offset:0
    v_mfma_f32_16x16x32_bf16 v[100:103], v[172:175], v[204:207], v[100:103]
    ds_read_b64_tr_b16 v[142:143], v209 offset:1536
    v_mfma_f32_16x16x32_bf16 v[16:19], v[184:187], v[172:175], v[16:19]
    v_mfma_f32_16x16x32_bf16 v[20:23], v[188:191], v[172:175], v[20:23]
    ds_read_b64_tr_b16 v[144:145], v210 offset:0
    v_mfma_f32_16x16x32_bf16 v[64:67], v[192:195], v[176:179], v[64:67]
    ds_read_b64_tr_b16 v[146:147], v210 offset:1536
    v_mfma_f32_16x16x32_bf16 v[68:71], v[196:199], v[176:179], v[68:71]
    ds_read_b128 v[128:131], v208 offset:4096
    v_mfma_f32_16x16x32_bf16 v[104:107], v[176:179], v[200:203], v[104:107]
    ds_read_b128 v[132:135], v208 offset:6144
    v_mfma_f32_16x16x32_bf16 v[108:111], v[176:179], v[204:207], v[108:111]
    ds_read_b128 v[136:139], v208 offset:8192
    v_mfma_f32_16x16x32_bf16 v[24:27], v[184:187], v[176:179], v[24:27]
    v_mfma_f32_16x16x32_bf16 v[28:31], v[188:191], v[176:179], v[28:31]
    v_add_u32 v208, s35, v211
    v_mfma_f32_16x16x32_bf16 v[72:75], v[192:195], v[180:183], v[72:75]
    v_mfma_f32_16x16x32_bf16 v[76:79], v[196:199], v[180:183], v[76:79]
    v_mfma_f32_16x16x32_bf16 v[112:115], v[180:183], v[200:203], v[112:115]
    v_mfma_f32_16x16x32_bf16 v[116:119], v[180:183], v[204:207], v[116:119]
    v_mfma_f32_16x16x32_bf16 v[32:35], v[184:187], v[180:183], v[32:35]
    s_add_u32 s35, s35, 43008
    s_cmp_ge_u32 s35, 129024
    s_cselect_b32 s35, 0, s35
    v_mfma_f32_16x16x32_bf16 v[36:39], v[188:191], v[180:183], v[36:39]
    s_waitcnt lgkmcnt(0)
    v_mfma_f32_16x16x32_bf16 v[40:43], v[148:151], v[120:123], v[40:43]
    ds_read_b128 v[164:167], v208 offset:0
    v_mfma_f32_16x16x32_bf16 v[44:47], v[152:155], v[120:123], v[44:47]
    ds_read_b64_tr_b16 v[192:193], v209 offset:12416
    v_mfma_f32_16x16x32_bf16 v[80:83], v[120:123], v[156:159], v[80:83]
    ds_read_b64_tr_b16 v[194:195], v209 offset:13952
    v_mfma_f32_16x16x32_bf16 v[84:87], v[120:123], v[160:163], v[84:87]
    ds_read_b64_tr_b16 v[196:197], v210 offset:12416
    v_mfma_f32_16x16x32_bf16 v[48:51], v[148:151], v[124:127], v[48:51]
    ds_read_b64_tr_b16 v[198:199], v210 offset:13952
    v_mfma_f32_16x16x32_bf16 v[52:55], v[152:155], v[124:127], v[52:55]
    v_mfma_f32_16x16x32_bf16 v[88:91], v[124:127], v[156:159], v[88:91]
    ds_read_b64_tr_b16 v[200:201], v209 offset:12544
    v_mfma_f32_16x16x32_bf16 v[92:95], v[124:127], v[160:163], v[92:95]
    ds_read_b64_tr_b16 v[202:203], v209 offset:14080
    v_mfma_f32_16x16x32_bf16 v[8:11], v[140:143], v[124:127], v[8:11]
    ds_read_b64_tr_b16 v[204:205], v210 offset:12544
    v_mfma_f32_16x16x32_bf16 v[12:15], v[144:147], v[124:127], v[12:15]
    ds_read_b64_tr_b16 v[206:207], v210 offset:14080
    v_mfma_f32_16x16x32_bf16 v[56:59], v[148:151], v[128:131], v[56:59]
    v_mfma_f32_16x16x32_bf16 v[60:63], v[152:155], v[128:131], v[60:63]
    ds_read_b128 v[168:171], v208 offset:2048
    v_mfma_f32_16x16x32_bf16 v[96:99], v[128:131], v[156:159], v[96:99]
    ds_read_b64_tr_b16 v[184:185], v209 offset:12288
    v_mfma_f32_16x16x32_bf16 v[100:103], v[128:131], v[160:163], v[100:103]
    s_sub_u32 s36, s36, 1
    s_cmp_lg_u32 s36, 0
    ds_read_b64_tr_b16 v[186:187], v209 offset:13824
    v_mfma_f32_16x16x32_bf16 v[16:19], v[140:143], v[128:131], v[16:19]
    s_cbranch_scc1 qkv_kernel_C_loop0
    ds_read_b64_tr_b16 v[188:189], v210 offset:12288
    v_mfma_f32_16x16x32_bf16 v[20:23], v[144:147], v[128:131], v[20:23]
    v_mfma_f32_16x16x32_bf16 v[64:67], v[148:151], v[132:135], v[64:67]
    ds_read_b64_tr_b16 v[190:191], v210 offset:13824
    v_mfma_f32_16x16x32_bf16 v[68:71], v[152:155], v[132:135], v[68:71]
    ds_read_b128 v[172:175], v208 offset:4096
    v_mfma_f32_16x16x32_bf16 v[104:107], v[132:135], v[156:159], v[104:107]
    ds_read_b128 v[176:179], v208 offset:6144
    v_mfma_f32_16x16x32_bf16 v[108:111], v[132:135], v[160:163], v[108:111]
    ds_read_b128 v[180:183], v208 offset:8192
    v_mfma_f32_16x16x32_bf16 v[24:27], v[140:143], v[132:135], v[24:27]
    v_mfma_f32_16x16x32_bf16 v[28:31], v[144:147], v[132:135], v[28:31]
    v_mfma_f32_16x16x32_bf16 v[72:75], v[148:151], v[136:139], v[72:75]
    v_mfma_f32_16x16x32_bf16 v[76:79], v[152:155], v[136:139], v[76:79]
    v_mfma_f32_16x16x32_bf16 v[112:115], v[136:139], v[156:159], v[112:115]
    v_mfma_f32_16x16x32_bf16 v[116:119], v[136:139], v[160:163], v[116:119]
    v_mfma_f32_16x16x32_bf16 v[32:35], v[140:143], v[136:139], v[32:35]
    v_mfma_f32_16x16x32_bf16 v[36:39], v[144:147], v[136:139], v[36:39]
    s_waitcnt lgkmcnt(0)
    v_mfma_f32_16x16x32_bf16 v[40:43], v[192:195], v[164:167], v[40:43]
    v_mfma_f32_16x16x32_bf16 v[44:47], v[196:199], v[164:167], v[44:47]
    v_mfma_f32_16x16x32_bf16 v[80:83], v[164:167], v[200:203], v[80:83]
    v_mfma_f32_16x16x32_bf16 v[84:87], v[164:167], v[204:207], v[84:87]
    v_mfma_f32_16x16x32_bf16 v[48:51], v[192:195], v[168:171], v[48:51]
    v_mfma_f32_16x16x32_bf16 v[52:55], v[196:199], v[168:171], v[52:55]
    v_mfma_f32_16x16x32_bf16 v[88:91], v[168:171], v[200:203], v[88:91]
    v_mfma_f32_16x16x32_bf16 v[92:95], v[168:171], v[204:207], v[92:95]
    v_mfma_f32_16x16x32_bf16 v[8:11], v[184:187], v[168:171], v[8:11]
    v_mfma_f32_16x16x32_bf16 v[12:15], v[188:191], v[168:171], v[12:15]
    v_mfma_f32_16x16x32_bf16 v[56:59], v[192:195], v[172:175], v[56:59]
    v_mfma_f32_16x16x32_bf16 v[60:63], v[196:199], v[172:175], v[60:63]
    v_mfma_f32_16x16x32_bf16 v[96:99], v[172:175], v[200:203], v[96:99]
    v_mfma_f32_16x16x32_bf16 v[100:103], v[172:175], v[204:207], v[100:103]
    v_mfma_f32_16x16x32_bf16 v[16:19], v[184:187], v[172:175], v[16:19]
    v_mfma_f32_16x16x32_bf16 v[20:23], v[188:191], v[172:175], v[20:23]
    v_mfma_f32_16x16x32_bf16 v[64:67], v[192:195], v[176:179], v[64:67]
    v_mfma_f32_16x16x32_bf16 v[68:71], v[196:199], v[176:179], v[68:71]
    v_mfma_f32_16x16x32_bf16 v[104:107], v[176:179], v[200:203], v[104:107]
    v_mfma_f32_16x16x32_bf16 v[108:111], v[176:179], v[204:207], v[108:111]
    v_mfma_f32_16x16x32_bf16 v[24:27], v[184:187], v[176:179], v[24:27]
    v_mfma_f32_16x16x32_bf16 v[28:31], v[188:191], v[176:179], v[28:31]
    v_mfma_f32_16x16x32_bf16 v[72:75], v[192:195], v[180:183], v[72:75]
    v_mfma_f32_16x16x32_bf16 v[76:79], v[196:199], v[180:183], v[76:79]
    v_mfma_f32_16x16x32_bf16 v[112:115], v[180:183], v[200:203], v[112:115]
    v_mfma_f32_16x16x32_bf16 v[116:119], v[180:183], v[204:207], v[116:119]
    v_mfma_f32_16x16x32_bf16 v[32:35], v[184:187], v[180:183], v[32:35]
    v_mfma_f32_16x16x32_bf16 v[36:39], v[188:191], v[180:183], v[36:39]
    s_waitcnt lgkmcnt(0)
    v_cvt_pk_bf16_f32 v120, v40, v41
    v_cvt_pk_bf16_f32 v121, v42, v43
    v_cvt_pk_bf16_f32 v122, v44, v45
    v_cvt_pk_bf16_f32 v123, v46, v47
    v_cvt_pk_bf16_f32 v124, v48, v49
    v_cvt_pk_bf16_f32 v125, v50, v51
    v_cvt_pk_bf16_f32 v126, v52, v53
    v_cvt_pk_bf16_f32 v127, v54, v55
    v_cvt_pk_bf16_f32 v140, v8, v9
    v_cvt_pk_bf16_f32 v141, v10, v11
    v_cvt_pk_bf16_f32 v142, v12, v13
    v_cvt_pk_bf16_f32 v143, v14, v15
    v_cvt_pk_bf16_f32 v128, v56, v57
    v_cvt_pk_bf16_f32 v129, v58, v59
    v_cvt_pk_bf16_f32 v130, v60, v61
    v_cvt_pk_bf16_f32 v131, v62, v63
    v_cvt_pk_bf16_f32 v144, v16, v17
    v_cvt_pk_bf16_f32 v145, v18, v19
    v_cvt_pk_bf16_f32 v146, v20, v21
    v_cvt_pk_bf16_f32 v147, v22, v23
    v_cvt_pk_bf16_f32 v132, v64, v65
    v_cvt_pk_bf16_f32 v133, v66, v67
    v_cvt_pk_bf16_f32 v134, v68, v69
    v_cvt_pk_bf16_f32 v135, v70, v71
    v_cvt_pk_bf16_f32 v148, v24, v25
    v_cvt_pk_bf16_f32 v149, v26, v27
    v_cvt_pk_bf16_f32 v150, v28, v29
    v_cvt_pk_bf16_f32 v151, v30, v31
    v_cvt_pk_bf16_f32 v136, v72, v73
    v_cvt_pk_bf16_f32 v137, v74, v75
    v_cvt_pk_bf16_f32 v138, v76, v77
    v_cvt_pk_bf16_f32 v139, v78, v79
    v_cvt_pk_bf16_f32 v152, v32, v33
    v_cvt_pk_bf16_f32 v153, v34, v35
    v_cvt_pk_bf16_f32 v154, v36, v37
    v_cvt_pk_bf16_f32 v155, v38, v39
    v_mfma_f32_16x16x32_bf16 v[8:11], v[120:123], v[140:143], 0
    v_mfma_f32_16x16x32_bf16 v[12:15], v[124:127], v[140:143], 0
    v_mfma_f32_16x16x32_bf16 v[16:19], v[124:127], v[144:147], 0
    v_mfma_f32_16x16x32_bf16 v[20:23], v[128:131], v[144:147], 0
    v_mfma_f32_16x16x32_bf16 v[24:27], v[128:131], v[148:151], 0
    v_mfma_f32_16x16x32_bf16 v[28:31], v[132:135], v[148:151], 0
    v_mfma_f32_16x16x32_bf16 v[32:35], v[132:135], v[152:155], 0
    v_mfma_f32_16x16x32_bf16 v[36:39], v[136:139], v[152:155], 0
    v_cvt_pk_bf16_f32 v156, v80, v81
    v_cvt_pk_bf16_f32 v157, v82, v83
    v_cvt_pk_bf16_f32 v166, v84, v85
    v_cvt_pk_bf16_f32 v167, v86, v87
    v_cvt_pk_bf16_f32 v158, v88, v89
    v_cvt_pk_bf16_f32 v159, v90, v91
    v_cvt_pk_bf16_f32 v168, v92, v93
    v_cvt_pk_bf16_f32 v169, v94, v95
    v_cvt_pk_bf16_f32 v160, v96, v97
    v_cvt_pk_bf16_f32 v161, v98, v99
    v_cvt_pk_bf16_f32 v170, v100, v101
    v_cvt_pk_bf16_f32 v171, v102, v103
    v_cvt_pk_bf16_f32 v162, v104, v105
    v_cvt_pk_bf16_f32 v163, v106, v107
    v_cvt_pk_bf16_f32 v172, v108, v109
    v_cvt_pk_bf16_f32 v173, v110, v111
    v_cvt_pk_bf16_f32 v164, v112, v113
    v_cvt_pk_bf16_f32 v165, v114, v115
    v_cvt_pk_bf16_f32 v174, v116, v117
    v_cvt_pk_bf16_f32 v175, v118, v119
    s_mov_b32 s44, 0x3e8293ee
    s_mov_b32 s45, 0x3e8293ee
    v_mov_b32 v217, 0xf149f2ca
    v_pk_mul_f32 v[8:9], v[8:9], s[44:45]
    v_pk_mul_f32 v[10:11], v[10:11], s[44:45]
    v_pk_mul_f32 v[12:13], v[12:13], s[44:45]
    v_pk_mul_f32 v[14:15], v[14:15], s[44:45]
    v_pk_mul_f32 v[16:17], v[16:17], s[44:45]
    v_pk_mul_f32 v[18:19], v[18:19], s[44:45]
    v_pk_mul_f32 v[20:21], v[20:21], s[44:45]
    v_pk_mul_f32 v[22:23], v[22:23], s[44:45]
    v_pk_mul_f32 v[24:25], v[24:25], s[44:45]
    v_pk_mul_f32 v[26:27], v[26:27], s[44:45]
    v_pk_mul_f32 v[28:29], v[28:29], s[44:45]
    v_pk_mul_f32 v[30:31], v[30:31], s[44:45]
    v_pk_mul_f32 v[32:33], v[32:33], s[44:45]
    v_pk_mul_f32 v[34:35], v[34:35], s[44:45]
    v_pk_mul_f32 v[36:37], v[36:37], s[44:45]
    v_pk_mul_f32 v[38:39], v[38:39], s[44:45]
    v_cndmask_b32 v8, v217, v8, s[72:73]
    v_cndmask_b32 v12, v217, v12, s[64:65]
    v_cndmask_b32 v9, v217, v9, s[74:75]
    v_cndmask_b32 v13, v217, v13, s[66:67]
    v_cndmask_b32 v10, v217, v10, s[76:77]
    v_cndmask_b32 v14, v217, v14, s[68:69]
    v_cndmask_b32 v11, v217, v11, s[78:79]
    v_cndmask_b32 v15, v217, v15, s[70:71]
    v_cndmask_b32 v16, v217, v16, s[56:57]
    v_cndmask_b32 v20, v217, v20, s[64:65]
    v_cndmask_b32 v17, v217, v17, s[58:59]
    v_cndmask_b32 v21, v217, v21, s[66:67]
    v_cndmask_b32 v18, v217, v18, s[60:61]
    v_cndmask_b32 v22, v217, v22, s[68:69]
    v_cndmask_b32 v19, v217, v19, s[62:63]
    v_cndmask_b32 v23, v217, v23, s[70:71]
    v_cndmask_b32 v24, v217, v24, s[56:57]
    v_cndmask_b32 v28, v217, v28, s[64:65]
    v_cndmask_b32 v25, v217, v25, s[58:59]
    v_cndmask_b32 v29, v217, v29, s[66:67]
    v_cndmask_b32 v26, v217, v26, s[60:61]
    v_cndmask_b32 v30, v217, v30, s[68:69]
    v_cndmask_b32 v27, v217, v27, s[62:63]
    v_cndmask_b32 v31, v217, v31, s[70:71]
    v_cndmask_b32 v32, v217, v32, s[56:57]
    v_cndmask_b32 v36, v217, v36, s[64:65]
    v_cndmask_b32 v33, v217, v33, s[58:59]
    v_cndmask_b32 v37, v217, v37, s[66:67]
    v_cndmask_b32 v34, v217, v34, s[60:61]
    v_cndmask_b32 v38, v217, v38, s[68:69]
    v_cndmask_b32 v35, v217, v35, s[62:63]
    v_cndmask_b32 v39, v217, v39, s[70:71]
    v_max3_f32 v192, v8, v9, v10
    v_max3_f32 v196, v11, v12, v13
    v_max3_f32 v193, v16, v17, v18
    v_max3_f32 v197, v19, v20, v21
    v_max3_f32 v194, v24, v25, v26
    v_max3_f32 v198, v27, v28, v29
    v_max3_f32 v195, v32, v33, v34
    v_max3_f32 v199, v35, v36, v37
    v_max3_f32 v192, v192, v14, v15
    v_max3_f32 v193, v193, v22, v23
    v_max3_f32 v194, v194, v30, v31
    v_max3_f32 v195, v195, v38, v39
    v_max_f32 v192, v192, v196
    v_max_f32 v193, v193, v197
    v_max_f32 v194, v194, v198
    v_max_f32 v195, v195, v199
    v_mov_b32 v196, v192
    v_mov_b32 v197, v193
    v_mov_b32 v198, v194
    v_mov_b32 v199, v195
    v_permlane32_swap_b32 v192, v196
    v_permlane32_swap_b32 v193, v197
    v_permlane32_swap_b32 v194, v198
    v_permlane32_swap_b32 v195, v199
    v_max_f32 v192, v192, v196
    v_max_f32 v193, v193, v197
    v_max_f32 v194, v194, v198
    v_max_f32 v195, v195, v199
    v_mov_b32 v196, v192
    v_mov_b32 v197, v193
    v_mov_b32 v198, v194
    v_mov_b32 v199, v195
    v_permlane16_swap_b32 v192, v196
    v_permlane16_swap_b32 v193, v197
    v_permlane16_swap_b32 v194, v198
    v_permlane16_swap_b32 v195, v199
    v_max_f32 v192, v192, v196
    v_max_f32 v193, v193, v197
    v_max_f32 v194, v194, v198
    v_max_f32 v195, v195, v199
    v_sub_f32 v8, v8, v192
    v_sub_f32 v9, v9, v192
    v_sub_f32 v10, v10, v192
    v_sub_f32 v11, v11, v192
    v_sub_f32 v12, v12, v192
    v_sub_f32 v13, v13, v192
    v_sub_f32 v14, v14, v192
    v_sub_f32 v15, v15, v192
    v_sub_f32 v16, v16, v193
    v_sub_f32 v17, v17, v193
    v_sub_f32 v18, v18, v193
    v_sub_f32 v19, v19, v193
    v_sub_f32 v20, v20, v193
    v_sub_f32 v21, v21, v193
    v_sub_f32 v22, v22, v193
    v_sub_f32 v23, v23, v193
    v_sub_f32 v24, v24, v194
    v_sub_f32 v25, v25, v194
    v_sub_f32 v26, v26, v194
    v_sub_f32 v27, v27, v194
    v_sub_f32 v28, v28, v194
    v_sub_f32 v29, v29, v194
    v_sub_f32 v30, v30, v194
    v_sub_f32 v31, v31, v194
    v_sub_f32 v32, v32, v195
    v_sub_f32 v33, v33, v195
    v_sub_f32 v34, v34, v195
    v_sub_f32 v35, v35, v195
    v_sub_f32 v36, v36, v195
    v_sub_f32 v37, v37, v195
    v_sub_f32 v38, v38, v195
    v_sub_f32 v39, v39, v195
    v_exp_f32 v8, v8
    v_exp_f32 v9, v9
    v_exp_f32 v10, v10
    v_exp_f32 v11, v11
    v_exp_f32 v12, v12
    v_exp_f32 v13, v13
    v_exp_f32 v14, v14
    v_exp_f32 v15, v15
    v_exp_f32 v16, v16
    v_exp_f32 v17, v17
    v_exp_f32 v18, v18
    v_exp_f32 v19, v19
    v_exp_f32 v20, v20
    v_exp_f32 v21, v21
    v_exp_f32 v22, v22
    v_exp_f32 v23, v23
    v_exp_f32 v24, v24
    v_exp_f32 v25, v25
    v_exp_f32 v26, v26
    v_exp_f32 v27, v27
    v_exp_f32 v28, v28
    v_exp_f32 v29, v29
    v_exp_f32 v30, v30
    v_exp_f32 v31, v31
    v_exp_f32 v32, v32
    v_exp_f32 v33, v33
    v_exp_f32 v34, v34
    v_exp_f32 v35, v35
    v_exp_f32 v36, v36
    v_exp_f32 v37, v37
    v_exp_f32 v38, v38
    v_exp_f32 v39, v39
    v_pk_add_f32 v[200:201], v[8:9], v[10:11]
    v_pk_add_f32 v[202:203], v[16:17], v[18:19]
    v_pk_add_f32 v[204:205], v[24:25], v[26:27]
    v_pk_add_f32 v[206:207], v[32:33], v[34:35]
    v_pk_add_f32 v[200:201], v[200:201], v[12:13]
    v_pk_add_f32 v[202:203], v[202:203], v[20:21]
    v_pk_add_f32 v[204:205], v[204:205], v[28:29]
    v_pk_add_f32 v[206:207], v[206:207], v[36:37]
    v_pk_add_f32 v[200:201], v[200:201], v[14:15]
    v_pk_add_f32 v[202:203], v[202:203], v[22:23]
    v_pk_add_f32 v[204:205], v[204:205], v[30:31]
    v_pk_add_f32 v[206:207], v[206:207], v[38:39]
    v_add_f32 v200, v200, v201
    v_add_f32 v202, v202, v203
    v_add_f32 v204, v204, v205
    v_add_f32 v206, v206, v207
    v_mov_b32 v196, v200
    v_mov_b32 v197, v202
    v_mov_b32 v198, v204
    v_mov_b32 v199, v206
    v_permlane32_swap_b32 v200, v196
    v_permlane32_swap_b32 v202, v197
    v_permlane32_swap_b32 v204, v198
    v_permlane32_swap_b32 v206, v199
    v_add_f32 v200, v200, v196
    v_add_f32 v202, v202, v197
    v_add_f32 v204, v204, v198
    v_add_f32 v206, v206, v199
    v_mov_b32 v196, v200
    v_mov_b32 v197, v202
    v_mov_b32 v198, v204
    v_mov_b32 v199, v206
    v_permlane16_swap_b32 v200, v196
    v_permlane16_swap_b32 v202, v197
    v_permlane16_swap_b32 v204, v198
    v_permlane16_swap_b32 v206, v199
    v_add_f32 v200, v200, v196
    v_add_f32 v202, v202, v197
    v_add_f32 v204, v204, v198
    v_add_f32 v206, v206, v199
    v_rcp_f32 v200, v200
    v_rcp_f32 v202, v202
    v_rcp_f32 v204, v204
    v_rcp_f32 v206, v206
    v_mov_b32 v201, v200
    v_mov_b32 v203, v202
    v_mov_b32 v205, v204
    v_mov_b32 v207, v206
    v_pk_mul_f32 v[8:9], v[8:9], v[200:201]
    v_pk_mul_f32 v[10:11], v[10:11], v[200:201]
    v_pk_mul_f32 v[12:13], v[12:13], v[200:201]
    v_pk_mul_f32 v[14:15], v[14:15], v[200:201]
    v_pk_mul_f32 v[16:17], v[16:17], v[202:203]
    v_pk_mul_f32 v[18:19], v[18:19], v[202:203]
    v_pk_mul_f32 v[20:21], v[20:21], v[202:203]
    v_pk_mul_f32 v[22:23], v[22:23], v[202:203]
    v_pk_mul_f32 v[24:25], v[24:25], v[204:205]
    v_pk_mul_f32 v[26:27], v[26:27], v[204:205]
    v_pk_mul_f32 v[28:29], v[28:29], v[204:205]
    v_pk_mul_f32 v[30:31], v[30:31], v[204:205]
    v_pk_mul_f32 v[32:33], v[32:33], v[206:207]
    v_pk_mul_f32 v[34:35], v[34:35], v[206:207]
    v_pk_mul_f32 v[36:37], v[36:37], v[206:207]
    v_pk_mul_f32 v[38:39], v[38:39], v[206:207]
    v_cvt_pk_bf16_f32 v176, v8, v9
    v_cvt_pk_bf16_f32 v177, v10, v11
    v_cvt_pk_bf16_f32 v178, v12, v13
    v_cvt_pk_bf16_f32 v179, v14, v15
    v_cvt_pk_bf16_f32 v180, v16, v17
    v_cvt_pk_bf16_f32 v181, v18, v19
    v_cvt_pk_bf16_f32 v182, v20, v21
    v_cvt_pk_bf16_f32 v183, v22, v23
    v_cvt_pk_bf16_f32 v184, v24, v25
    v_cvt_pk_bf16_f32 v185, v26, v27
    v_cvt_pk_bf16_f32 v186, v28, v29
    v_cvt_pk_bf16_f32 v187, v30, v31
    v_cvt_pk_bf16_f32 v188, v32, v33
    v_cvt_pk_bf16_f32 v189, v34, v35
    v_cvt_pk_bf16_f32 v190, v36, v37
    v_cvt_pk_bf16_f32 v191, v38, v39
    v_mfma_f32_16x16x32_bf16 v[40:43], v[156:159], v[176:179], 0
    v_mfma_f32_16x16x32_bf16 v[44:47], v[166:169], v[176:179], 0
    v_mfma_f32_16x16x32_bf16 v[48:51], v[158:161], v[180:183], 0
    v_mfma_f32_16x16x32_bf16 v[52:55], v[168:171], v[180:183], 0
    v_mfma_f32_16x16x32_bf16 v[56:59], v[160:163], v[184:187], 0
    v_mfma_f32_16x16x32_bf16 v[60:63], v[170:173], v[184:187], 0
    v_mfma_f32_16x16x32_bf16 v[64:67], v[162:165], v[188:191], 0
    v_mfma_f32_16x16x32_bf16 v[68:71], v[172:175], v[188:191], 0
    s_mov_b32 s44, 0x0
    s_mov_b32 s45, 0x8800
    s_mov_b32 s46, 0x11000
    s_mov_b32 s47, 0x19800
    v_cvt_pk_bf16_f32 v120, v40, v41
    v_cvt_pk_bf16_f32 v121, v42, v43
    v_cvt_pk_bf16_f32 v122, v44, v45
    v_cvt_pk_bf16_f32 v123, v46, v47
    v_cvt_pk_bf16_f32 v124, v48, v49
    v_cvt_pk_bf16_f32 v125, v50, v51
    v_cvt_pk_bf16_f32 v126, v52, v53
    v_cvt_pk_bf16_f32 v127, v54, v55
    v_cvt_pk_bf16_f32 v128, v56, v57
    v_cvt_pk_bf16_f32 v129, v58, v59
    v_cvt_pk_bf16_f32 v130, v60, v61
    v_cvt_pk_bf16_f32 v131, v62, v63
    v_cvt_pk_bf16_f32 v132, v64, v65
    v_cvt_pk_bf16_f32 v133, v66, v67
    v_cvt_pk_bf16_f32 v134, v68, v69
    v_cvt_pk_bf16_f32 v135, v70, v71
    v_permlane16_swap_b32 v120, v122
    v_permlane16_swap_b32 v121, v123
    v_permlane16_swap_b32 v124, v126
    v_permlane16_swap_b32 v125, v127
    v_permlane16_swap_b32 v128, v130
    v_permlane16_swap_b32 v129, v131
    v_permlane16_swap_b32 v132, v134
    v_permlane16_swap_b32 v133, v135
    buffer_store_dwordx4 v[120:123], v225, s[20:23], s44 offen
    buffer_store_dwordx4 v[124:127], v225, s[20:23], s45 offen
    buffer_store_dwordx4 v[128:131], v225, s[20:23], s46 offen
    buffer_store_dwordx4 v[132:135], v225, s[20:23], s47 offen
    s_branch qkv_kernel_fin
qkv_kernel_L:
    s_sub_u32 s28, s28, 4
    s_mov_b32 s24, -1
    s_mov_b32 s25, 0
    s_mov_b32 s34, 0
    s_mov_b32 s38, 0
    s_mov_b32 s39, 0
    s_mul_i32 s48, s28, 4608
    s_add_u32 s49, s48, 1024
    s_add_u32 s50, s48, 2048
    s_add_u32 s51, s48, 3072
    s_add_u32 s52, s48, 4096
    s_mul_i32 s53, s28, 6144
    s_add_u32 s53, s53, 18432
    s_add_u32 s54, s53, 1024
    s_add_u32 s55, s53, 2048
    s_add_u32 s56, s53, 3072
    s_add_u32 s57, s53, 4096
    s_add_u32 s58, s53, 5120
    s_lshl_b32 s45, s33, 7
    s_mul_i32 s46, s28, 98304
    s_add_u32 s45, s45, s46
    s_movk_i32 s44, 6144
    v_add_u32 v214, 0, v1
    v_mul_u32_u24 v215, 0xab, v214
    v_lshrrev_b32 v215, 12, v215
    v_mul_u32_u24 v216, 24, v215
    v_sub_u32 v214, v214, v216
    v_and_b32 v216, 2, v215
    v_lshrrev_b32 v217, 3, v215
    v_lshl_or_b32 v216, v217, 2, v216
    v_xor_b32 v214, v214, v216
    v_mul_u32_u24 v215, s44, v215
    v_lshrrev_b32 v216, 3, v214
    v_lshl_add_u32 v215, v216, 11, v215
    v_and_b32 v214, 7, v214
    v_lshl_add_u32 v215, v214, 4, v215
    v_add_u32 v13, s45, v215
    v_add_u32 v214, 64, v1
    v_mul_u32_u24 v215, 0xab, v214
    v_lshrrev_b32 v215, 12, v215
    v_mul_u32_u24 v216, 24, v215
    v_sub_u32 v214, v214, v216
    v_and_b32 v216, 2, v215
    v_lshrrev_b32 v217, 3, v215
    v_lshl_or_b32 v216, v217, 2, v216
    v_xor_b32 v214, v214, v216
    v_mul_u32_u24 v215, s44, v215
    v_lshrrev_b32 v216, 3, v214
    v_lshl_add_u32 v215, v216, 11, v215
    v_and_b32 v214, 7, v214
    v_lshl_add_u32 v215, v214, 4, v215
    v_add_u32 v14, s45, v215
    v_add_u32 v214, 128, v1
    v_mul_u32_u24 v215, 0xab, v214
    v_lshrrev_b32 v215, 12, v215
    v_mul_u32_u24 v216, 24, v215
    v_sub_u32 v214, v214, v216
    v_and_b32 v216, 2, v215
    v_lshrrev_b32 v217, 3, v215
    v_lshl_or_b32 v216, v217, 2, v216
    v_xor_b32 v214, v214, v216
    v_mul_u32_u24 v215, s44, v215
    v_lshrrev_b32 v216, 3, v214
    v_lshl_add_u32 v215, v216, 11, v215
    v_and_b32 v214, 7, v214
    v_lshl_add_u32 v215, v214, 4, v215
    v_add_u32 v15, s45, v215
    v_add_u32 v214, 192, v1
    v_mul_u32_u24 v215, 0xab, v214
    v_lshrrev_b32 v215, 12, v215
    v_mul_u32_u24 v216, 24, v215
    v_sub_u32 v214, v214, v216
    v_and_b32 v216, 2, v215
    v_lshrrev_b32 v217, 3, v215
    v_lshl_or_b32 v216, v217, 2, v216
    v_xor_b32 v214, v214, v216
    v_mul_u32_u24 v215, s44, v215
    v_lshrrev_b32 v216, 3, v214
    v_lshl_add_u32 v215, v216, 11, v215
    v_and_b32 v214, 7, v214
    v_lshl_add_u32 v215, v214, 4, v215
    v_add_u32 v16, s45, v215
    v_add_u32 v214, 256, v1
    v_mul_u32_u24 v215, 0xab, v214
    v_lshrrev_b32 v215, 12, v215
    v_mul_u32_u24 v216, 24, v215
    v_sub_u32 v214, v214, v216
    v_and_b32 v216, 2, v215
    v_lshrrev_b32 v217, 3, v215
    v_lshl_or_b32 v216, v217, 2, v216
    v_xor_b32 v214, v214, v216
    v_mul_u32_u24 v215, s44, v215
    v_lshrrev_b32 v216, 3, v214
    v_lshl_add_u32 v215, v216, 11, v215
    v_and_b32 v214, 7, v214
    v_lshl_add_u32 v215, v214, 4, v215
    v_add_u32 v17, s45, v215
    v_add_u32 v214, 320, v1
    v_mul_u32_u24 v215, 0xab, v214
    v_lshrrev_b32 v215, 12, v215
    v_mul_u32_u24 v216, 24, v215
    v_sub_u32 v214, v214, v216
    v_and_b32 v216, 2, v215
    v_lshrrev_b32 v217, 3, v215
    v_lshl_or_b32 v216, v217, 2, v216
    v_xor_b32 v214, v214, v216
    v_mul_u32_u24 v215, s44, v215
    v_lshrrev_b32 v216, 3, v214
    v_lshl_add_u32 v215, v216, 11, v215
    v_and_b32 v214, 7, v214
    v_lshl_add_u32 v215, v214, 4, v215
    v_add_u32 v18, s45, v215
    s_mul_i32 s46, s28, 36
    s_add_u32 s45, s46, s32
    s_sub_u32 s45, s45, 16
    v_and_b32 v216, 7, v1
    v_lshrrev_b32 v217, 3, v1
    s_movk_i32 s44, 2176
    v_add_u32 v215, s46, v217
    v_bfe_u32 v215, v215, 1, 3
    v_xor_b32 v215, v215, v216
    v_add_u32 v214, s45, v217
    v_max_i32 v214, 0, v214
    v_mul_lo_u32 v214, s44, v214
    v_lshl_add_u32 v8, v215, 4, v214
    v_add_u32 v215, s46, v217
    v_add_u32 v215, 8, v215
    v_bfe_u32 v215, v215, 1, 3
    v_xor_b32 v215, v215, v216
    v_add_u32 v214, s45, v217
    v_add_u32 v214, 8, v214
    v_max_i32 v214, 0, v214
    v_mul_lo_u32 v214, s44, v214
    v_lshl_add_u32 v9, v215, 4, v214
    v_add_u32 v215, s46, v217
    v_add_u32 v215, 16, v215
    v_bfe_u32 v215, v215, 1, 3
    v_xor_b32 v215, v215, v216
    v_add_u32 v214, s45, v217
    v_add_u32 v214, 16, v214
    v_max_i32 v214, 0, v214
    v_mul_lo_u32 v214, s44, v214
    v_lshl_add_u32 v10, v215, 4, v214
    v_add_u32 v215, s46, v217
    v_add_u32 v215, 24, v215
    v_bfe_u32 v215, v215, 1, 3
    v_xor_b32 v215, v215, v216
    v_add_u32 v214, s45, v217
    v_add_u32 v214, 24, v214
    v_max_i32 v214, 0, v214
    v_mul_lo_u32 v214, s44, v214
    v_lshl_add_u32 v11, v215, 4, v214
    v_add_u32 v215, s46, v217
    v_add_u32 v215, 32, v215
    v_bfe_u32 v215, v215, 1, 3
    v_xor_b32 v215, v215, v216
    v_add_u32 v214, s45, v217
    v_add_u32 v214, 32, v214
    v_max_i32 v214, 0, v214
    v_mul_lo_u32 v214, s44, v214
    v_lshl_add_u32 v12, v215, 4, v214
    s_waitcnt lgkmcnt(0)
    s_add_u32 s12, s8, 0x100000
    s_addc_u32 s13, s9, 0
    s_mov_b32 s14, 0x440000
    s_mov_b32 s15, 0x20000
    s_mov_b32 s16, s4
    s_mov_b32 s17, s5
    s_mov_b32 s18, 0x600000
    s_mov_b32 s19, 0x20000
    s_add_u32 m0, s34, s53
    s_nop 0
    buffer_load_dwordx4 v13, s[16:19], s39 offen lds
    s_add_u32 m0, s34, s54
    s_nop 0
    buffer_load_dwordx4 v14, s[16:19], s39 offen lds
    s_add_u32 m0, s34, s55
    s_nop 0
    buffer_load_dwordx4 v15, s[16:19], s39 offen lds
    s_add_u32 m0, s34, s56
    s_nop 0
    buffer_load_dwordx4 v16, s[16:19], s39 offen lds
    s_add_u32 m0, s34, s57
    s_nop 0
    buffer_load_dwordx4 v17, s[16:19], s39 offen lds
    s_add_u32 m0, s34, s58
    s_nop 0
    buffer_load_dwordx4 v18, s[16:19], s39 offen lds
    s_add_u32 m0, s34, s48
    s_nop 0
    buffer_load_dwordx4 v8, s[12:15], s38 offen lds
    s_add_u32 m0, s34, s49
    s_nop 0
    buffer_load_dwordx4 v9, s[12:15], s38 offen lds
    s_add_u32 m0, s34, s50
    s_nop 0
    buffer_load_dwordx4 v10, s[12:15], s38 offen lds
    s_add_u32 m0, s34, s51
    s_nop 0
    buffer_load_dwordx4 v11, s[12:15], s38 offen lds
    s_mov_b64 exec, s[24:25]
    s_add_u32 m0, s34, s52
    s_nop 0
    buffer_load_dwordx4 v12, s[12:15], s38 offen lds
    s_mov_b64 exec, -1
    s_add_u32 s38, s38, 0x80
    s_add_u32 s39, s39, 0x60000
    s_add_u32 s34, s34, 43008
    s_cmp_ge_u32 s34, 129024
    s_cselect_b32 s34, 0, s34
    s_add_u32 m0, s34, s53
    s_nop 0
    buffer_load_dwordx4 v13, s[16:19], s39 offen lds
    s_add_u32 m0, s34, s54
    s_nop 0
    buffer_load_dwordx4 v14, s[16:19], s39 offen lds
    s_add_u32 m0, s34, s55
    s_nop 0
    buffer_load_dwordx4 v15, s[16:19], s39 offen lds
    s_add_u32 m0, s34, s56
    s_nop 0
    buffer_load_dwordx4 v16, s[16:19], s39 offen lds
    s_add_u32 m0, s34, s57
    s_nop 0
    buffer_load_dwordx4 v17, s[16:19], s39 offen lds
    s_add_u32 m0, s34, s58
    s_nop 0
    buffer_load_dwordx4 v18, s[16:19], s39 offen lds
    s_add_u32 m0, s34, s48
    s_nop 0
    buffer_load_dwordx4 v8, s[12:15], s38 offen lds
    s_add_u32 m0, s34, s49
    s_nop 0
    buffer_load_dwordx4 v9, s[12:15], s38 offen lds
    s_add_u32 m0, s34, s50
    s_nop 0
    buffer_load_dwordx4 v10, s[12:15], s38 offen lds
    s_add_u32 m0, s34, s51
    s_nop 0
    buffer_load_dwordx4 v11, s[12:15], s38 offen lds
    s_mov_b64 exec, s[24:25]
    s_add_u32 m0, s34, s52
    s_nop 0
    buffer_load_dwordx4 v12, s[12:15], s38 offen lds
    s_mov_b64 exec, -1
    s_add_u32 s38, s38, 0x80
    s_add_u32 s39, s39, 0x60000
    s_add_u32 s34, s34, 43008
    s_cmp_ge_u32 s34, 129024
    s_cselect_b32 s34, 0, s34
    s_add_u32 m0, s34, s53
    s_nop 0
    buffer_load_dwordx4 v13, s[16:19], s39 offen lds
    s_add_u32 m0, s34, s54
    s_nop 0
    buffer_load_dwordx4 v14, s[16:19], s39 offen lds
    s_add_u32 m0, s34, s55
    s_nop 0
    buffer_load_dwordx4 v15, s[16:19], s39 offen lds
    s_add_u32 m0, s34, s56
    s_nop 0
    buffer_load_dwordx4 v16, s[16:19], s39 offen lds
    s_add_u32 m0, s34, s57
    s_nop 0
    buffer_load_dwordx4 v17, s[16:19], s39 offen lds
    s_add_u32 m0, s34, s58
    s_nop 0
    buffer_load_dwordx4 v18, s[16:19], s39 offen lds
    s_add_u32 m0, s34, s48
    s_nop 0
    buffer_load_dwordx4 v8, s[12:15], s38 offen lds
    s_add_u32 m0, s34, s49
    s_nop 0
    buffer_load_dwordx4 v9, s[12:15], s38 offen lds
    s_add_u32 m0, s34, s50
    s_nop 0
    buffer_load_dwordx4 v10, s[12:15], s38 offen lds
    s_add_u32 m0, s34, s51
    s_nop 0
    buffer_load_dwordx4 v11, s[12:15], s38 offen lds
    s_mov_b64 exec, s[24:25]
    s_add_u32 m0, s34, s52
    s_nop 0
    buffer_load_dwordx4 v12, s[12:15], s38 offen lds
    s_mov_b64 exec, -1
    s_add_u32 s38, s38, 0x80
    s_add_u32 s39, s39, 0x60000
    s_add_u32 s34, s34, 43008
    s_cmp_ge_u32 s34, 129024
    s_cselect_b32 s34, 0, s34
    v_mov_b32 v80, 130048
    v_mov_b32 v81, 0
    ds_write_b32 v80, v81
    s_waitcnt vmcnt(22) lgkmcnt(0)
    s_barrier
    s_movk_i32 s36, 6
qkv_kernel_L_loop0:
    s_waitcnt vmcnt(11)
    s_barrier
    s_add_u32 m0, s34, s53
    s_nop 0
    buffer_load_dwordx4 v13, s[16:19], s39 offen lds
    s_add_u32 m0, s34, s54
    s_nop 0
    buffer_load_dwordx4 v14, s[16:19], s39 offen lds
    s_add_u32 m0, s34, s55
    s_nop 0
    buffer_load_dwordx4 v15, s[16:19], s39 offen lds
    s_add_u32 m0, s34, s56
    s_nop 0
    buffer_load_dwordx4 v16, s[16:19], s39 offen lds
    s_add_u32 m0, s34, s57
    s_nop 0
    buffer_load_dwordx4 v17, s[16:19], s39 offen lds
    s_add_u32 m0, s34, s58
    s_nop 0
    buffer_load_dwordx4 v18, s[16:19], s39 offen lds
    s_add_u32 m0, s34, s48
    s_nop 0
    buffer_load_dwordx4 v8, s[12:15], s38 offen lds
    s_add_u32 m0, s34, s49
    s_nop 0
    buffer_load_dwordx4 v9, s[12:15], s38 offen lds
    s_add_u32 m0, s34, s50
    s_nop 0
    buffer_load_dwordx4 v10, s[12:15], s38 offen lds
    s_add_u32 m0, s34, s51
    s_nop 0
    buffer_load_dwordx4 v11, s[12:15], s38 offen lds
    s_mov_b64 exec, s[24:25]
    s_add_u32 m0, s34, s52
    s_nop 0
    buffer_load_dwordx4 v12, s[12:15], s38 offen lds
    s_mov_b64 exec, -1
    s_add_u32 s38, s38, 0x80
    s_add_u32 s39, s39, 0x60000
    s_add_u32 s34, s34, 43008
    s_cmp_ge_u32 s34, 129024
    s_cselect_b32 s34, 0, s34
    s_waitcnt vmcnt(11)
    s_barrier
    s_add_u32 m0, s34, s53
    s_nop 0
    buffer_load_dwordx4 v13, s[16:19], s39 offen lds
    s_add_u32 m0, s34, s54
    s_nop 0
    buffer_load_dwordx4 v14, s[16:19], s39 offen lds
    s_add_u32 m0, s34, s55
    s_nop 0
    buffer_load_dwordx4 v15, s[16:19], s39 offen lds
    s_add_u32 m0, s34, s56
    s_nop 0
    buffer_load_dwordx4 v16, s[16:19], s39 offen lds
    s_add_u32 m0, s34, s57
    s_nop 0
    buffer_load_dwordx4 v17, s[16:19], s39 offen lds
    s_add_u32 m0, s34, s58
    s_nop 0
    buffer_load_dwordx4 v18, s[16:19], s39 offen lds
    s_add_u32 m0, s34, s48
    s_nop 0
    buffer_load_dwordx4 v8, s[12:15], s38 offen lds
    s_add_u32 m0, s34, s49
    s_nop 0
    buffer_load_dwordx4 v9, s[12:15], s38 offen lds
    s_add_u32 m0, s34, s50
    s_nop 0
    buffer_load_dwordx4 v10, s[12:15], s38 offen lds
    s_add_u32 m0, s34, s51
    s_nop 0
    buffer_load_dwordx4 v11, s[12:15], s38 offen lds
    s_mov_b64 exec, s[24:25]
    s_add_u32 m0, s34, s52
    s_nop 0
    buffer_load_dwordx4 v12, s[12:15], s38 offen lds
    s_mov_b64 exec, -1
    s_add_u32 s38, s38, 0x80
    s_add_u32 s39, s39, 0x60000
    s_add_u32 s34, s34, 43008
    s_cmp_ge_u32 s34, 129024
    s_cselect_b32 s34, 0, s34
    s_sub_u32 s36, s36, 1
    s_cmp_lg_u32 s36, 0
    s_cbranch_scc1 qkv_kernel_L_loop0
    s_waitcnt vmcnt(11)
    s_barrier
    s_add_u32 m0, s34, s53
    s_nop 0
    buffer_load_dwordx4 v13, s[16:19], s39 offen lds
    s_add_u32 m0, s34, s54
    s_nop 0
    buffer_load_dwordx4 v14, s[16:19], s39 offen lds
    s_add_u32 m0, s34, s55
    s_nop 0
    buffer_load_dwordx4 v15, s[16:19], s39 offen lds
    s_add_u32 m0, s34, s56
    s_nop 0
    buffer_load_dwordx4 v16, s[16:19], s39 offen lds
    s_add_u32 m0, s34, s57
    s_nop 0
    buffer_load_dwordx4 v17, s[16:19], s39 offen lds
    s_add_u32 m0, s34, s58
    s_nop 0
    buffer_load_dwordx4 v18, s[16:19], s39 offen lds
    s_add_u32 m0, s34, s48
    s_nop 0
    buffer_load_dwordx4 v8, s[12:15], s38 offen lds
    s_add_u32 m0, s34, s49
    s_nop 0
    buffer_load_dwordx4 v9, s[12:15], s38 offen lds
    s_add_u32 m0, s34, s50
    s_nop 0
    buffer_load_dwordx4 v10, s[12:15], s38 offen lds
    s_add_u32 m0, s34, s51
    s_nop 0
    buffer_load_dwordx4 v11, s[12:15], s38 offen lds
    s_mov_b64 exec, s[24:25]
    s_add_u32 m0, s34, s52
    s_nop 0
    buffer_load_dwordx4 v12, s[12:15], s38 offen lds
    s_mov_b64 exec, -1
    s_add_u32 s38, s38, 0x80
    s_add_u32 s39, s39, 0x60000
    s_add_u32 s34, s34, 43008
    s_cmp_ge_u32 s34, 129024
    s_cselect_b32 s34, 0, s34
    s_waitcnt vmcnt(11)
    s_barrier
    v_and_b32 v24, 255, v0
    s_lshr_b32 s44, s2, 6
    s_lshl_b32 s45, s44, 8
    s_and_b32 s46, s2, 63
    s_lshl_b32 s47, s46, 7
    s_add_u32 s47, s47, 4096
    s_lshl_b32 s44, s44, 14
    s_lshl_b32 s46, s46, 8
    s_add_u32 s84, s44, s46
    v_lshrrev_b32 v80, 3, v24
    v_add_u32 v80, s45, v80
    v_lshlrev_b32 v26, 1, v80
    s_movk_i32 s44, 12288
    v_mul_lo_u32 v80, s44, v80
    v_and_b32 v25, 7, v0
    v_lshl_add_u32 v80, v25, 4, v80
    v_add_u32 v25, s47, v80
    s_mov_b32 s60, s82
    s_mov_b32 s61, s83
    s_mov_b32 s62, 0xc00000
    s_mov_b32 s63, 0x20000
    s_mov_b32 s64, s80
    s_mov_b32 s65, s81
    s_mov_b32 s66, 0x800
    s_mov_b32 s67, 0x20000
    s_add_u32 s68, s8, 0x20000
    s_addc_u32 s69, s9, 0
    s_mov_b32 s70, 0x10000
    s_mov_b32 s71, 0x20000
    buffer_load_ushort v32, v26, s[64:67], 0 offen offset:0
    buffer_load_ushort v33, v26, s[64:67], 0 offen offset:64
    buffer_load_ushort v34, v26, s[64:67], 0 offen offset:128
    buffer_load_ushort v35, v26, s[64:67], 0 offen offset:192
    buffer_load_ushort v36, v26, s[64:67], 0 offen offset:256
    buffer_load_ushort v37, v26, s[64:67], 0 offen offset:320
    buffer_load_ushort v38, v26, s[64:67], 0 offen offset:384
    buffer_load_ushort v39, v26, s[64:67], 0 offen offset:448
    s_mov_b32 s44, 0x0
    buffer_load_dwordx4 v[40:43], v25, s[60:63], s44 offen
    s_mov_b32 s44, 0x60000
    buffer_load_dwordx4 v[44:47], v25, s[60:63], s44 offen
    s_mov_b32 s44, 0xc0000
    buffer_load_dwordx4 v[48:51], v25, s[60:63], s44 offen
    s_mov_b32 s44, 0x120000
    buffer_load_dwordx4 v[52:55], v25, s[60:63], s44 offen
    s_mov_b32 s44, 0x180000
    buffer_load_dwordx4 v[56:59], v25, s[60:63], s44 offen
    s_mov_b32 s44, 0x1e0000
    buffer_load_dwordx4 v[60:63], v25, s[60:63], s44 offen
    s_mov_b32 s44, 0x240000
    buffer_load_dwordx4 v[64:67], v25, s[60:63], s44 offen
    s_mov_b32 s44, 0x2a0000
    buffer_load_dwordx4 v[68:71], v25, s[60:63], s44 offen
    s_lshl_b32 s44, s2, 8
    v_add_lshl_u32 v212, v24, s44, 5
    s_mov_b32 s40, s6
    s_mov_b32 s41, s7
    s_mov_b32 s42, 0x200000
    s_mov_b32 s43, 0x20000
    s_mov_b32 s44, 0x0
    buffer_load_dword v213, v212, s[40:43], s44 offen
    s_waitcnt vmcnt(17)
    s_barrier
    s_waitcnt vmcnt(9)
    v_lshlrev_b32 v32, 16, v32
    v_lshlrev_b32 v33, 16, v33
    v_lshlrev_b32 v34, 16, v34
    v_lshlrev_b32 v35, 16, v35
    v_lshlrev_b32 v36, 16, v36
    v_lshlrev_b32 v37, 16, v37
    v_lshlrev_b32 v38, 16, v38
    v_lshlrev_b32 v39, 16, v39
    v_mul_f32 v80, 0xbfb8aa3b, v32
    v_mul_f32 v81, 0xbfb8aa3b, v33
    v_mul_f32 v82, 0xbfb8aa3b, v34
    v_mul_f32 v83, 0xbfb8aa3b, v35
    v_mul_f32 v84, 0xbfb8aa3b, v36
    v_mul_f32 v85, 0xbfb8aa3b, v37
    v_mul_f32 v86, 0xbfb8aa3b, v38
    v_mul_f32 v87, 0xbfb8aa3b, v39
    v_exp_f32 v80, v80
    v_exp_f32 v81, v81
    v_exp_f32 v82, v82
    v_exp_f32 v83, v83
    v_exp_f32 v84, v84
    v_exp_f32 v85, v85
    v_exp_f32 v86, v86
    v_exp_f32 v87, v87
    v_add_f32 v80, 1.0, v80
    v_add_f32 v81, 1.0, v81
    v_add_f32 v82, 1.0, v82
    v_add_f32 v83, 1.0, v83
    v_add_f32 v84, 1.0, v84
    v_add_f32 v85, 1.0, v85
    v_add_f32 v86, 1.0, v86
    v_add_f32 v87, 1.0, v87
    v_rcp_f32 v80, v80
    v_rcp_f32 v81, v81
    v_rcp_f32 v82, v82
    v_rcp_f32 v83, v83
    v_rcp_f32 v84, v84
    v_rcp_f32 v85, v85
    v_rcp_f32 v86, v86
    v_rcp_f32 v87, v87
    v_mul_f32 v32, v32, v80
    v_mul_f32 v33, v33, v81
    v_mul_f32 v34, v34, v82
    v_mul_f32 v35, v35, v83
    v_mul_f32 v36, v36, v84
    v_mul_f32 v37, v37, v85
    v_mul_f32 v38, v38, v86
    v_mul_f32 v39, v39, v87
    v_cvt_pk_bf16_f32 v80, v32, v32
    v_lshlrev_b32 v32, 16, v80
    v_cvt_pk_bf16_f32 v81, v33, v33
    v_lshlrev_b32 v33, 16, v81
    v_cvt_pk_bf16_f32 v82, v34, v34
    v_lshlrev_b32 v34, 16, v82
    v_cvt_pk_bf16_f32 v83, v35, v35
    v_lshlrev_b32 v35, 16, v83
    v_cvt_pk_bf16_f32 v84, v36, v36
    v_lshlrev_b32 v36, 16, v84
    v_cvt_pk_bf16_f32 v85, v37, v37
    v_lshlrev_b32 v37, 16, v85
    v_cvt_pk_bf16_f32 v86, v38, v38
    v_lshlrev_b32 v38, 16, v86
    v_cvt_pk_bf16_f32 v87, v39, v39
    v_lshlrev_b32 v39, 16, v87
    s_waitcnt vmcnt(8)
    v_lshlrev_b32 v80, 16, v40
    v_and_b32 v81, 0xffff0000, v40
    v_lshlrev_b32 v82, 16, v41
    v_and_b32 v83, 0xffff0000, v41
    v_lshlrev_b32 v84, 16, v42
    v_and_b32 v85, 0xffff0000, v42
    v_lshlrev_b32 v86, 16, v43
    v_and_b32 v87, 0xffff0000, v43
    v_mul_f32 v72, v32, v80
    v_mul_f32 v73, v32, v81
    v_mul_f32 v74, v32, v82
    v_mul_f32 v75, v32, v83
    v_mul_f32 v76, v32, v84
    v_mul_f32 v77, v32, v85
    v_mul_f32 v78, v32, v86
    v_mul_f32 v79, v32, v87
    s_waitcnt vmcnt(7)
    v_lshlrev_b32 v80, 16, v44
    v_and_b32 v81, 0xffff0000, v44
    v_lshlrev_b32 v82, 16, v45
    v_and_b32 v83, 0xffff0000, v45
    v_lshlrev_b32 v84, 16, v46
    v_and_b32 v85, 0xffff0000, v46
    v_lshlrev_b32 v86, 16, v47
    v_and_b32 v87, 0xffff0000, v47
    v_fmac_f32 v72, v33, v80
    v_fmac_f32 v73, v33, v81
    v_fmac_f32 v74, v33, v82
    v_fmac_f32 v75, v33, v83
    v_fmac_f32 v76, v33, v84
    v_fmac_f32 v77, v33, v85
    v_fmac_f32 v78, v33, v86
    v_fmac_f32 v79, v33, v87
    s_waitcnt vmcnt(6)
    v_lshlrev_b32 v80, 16, v48
    v_and_b32 v81, 0xffff0000, v48
    v_lshlrev_b32 v82, 16, v49
    v_and_b32 v83, 0xffff0000, v49
    v_lshlrev_b32 v84, 16, v50
    v_and_b32 v85, 0xffff0000, v50
    v_lshlrev_b32 v86, 16, v51
    v_and_b32 v87, 0xffff0000, v51
    v_fmac_f32 v72, v34, v80
    v_fmac_f32 v73, v34, v81
    v_fmac_f32 v74, v34, v82
    v_fmac_f32 v75, v34, v83
    v_fmac_f32 v76, v34, v84
    v_fmac_f32 v77, v34, v85
    v_fmac_f32 v78, v34, v86
    v_fmac_f32 v79, v34, v87
    s_waitcnt vmcnt(5)
    v_lshlrev_b32 v80, 16, v52
    v_and_b32 v81, 0xffff0000, v52
    v_lshlrev_b32 v82, 16, v53
    v_and_b32 v83, 0xffff0000, v53
    v_lshlrev_b32 v84, 16, v54
    v_and_b32 v85, 0xffff0000, v54
    v_lshlrev_b32 v86, 16, v55
    v_and_b32 v87, 0xffff0000, v55
    v_fmac_f32 v72, v35, v80
    v_fmac_f32 v73, v35, v81
    v_fmac_f32 v74, v35, v82
    v_fmac_f32 v75, v35, v83
    v_fmac_f32 v76, v35, v84
    v_fmac_f32 v77, v35, v85
    v_fmac_f32 v78, v35, v86
    v_fmac_f32 v79, v35, v87
    s_waitcnt vmcnt(4)
    v_lshlrev_b32 v80, 16, v56
    v_and_b32 v81, 0xffff0000, v56
    v_lshlrev_b32 v82, 16, v57
    v_and_b32 v83, 0xffff0000, v57
    v_lshlrev_b32 v84, 16, v58
    v_and_b32 v85, 0xffff0000, v58
    v_lshlrev_b32 v86, 16, v59
    v_and_b32 v87, 0xffff0000, v59
    v_fmac_f32 v72, v36, v80
    v_fmac_f32 v73, v36, v81
    v_fmac_f32 v74, v36, v82
    v_fmac_f32 v75, v36, v83
    v_fmac_f32 v76, v36, v84
    v_fmac_f32 v77, v36, v85
    v_fmac_f32 v78, v36, v86
    v_fmac_f32 v79, v36, v87
    s_waitcnt vmcnt(3)
    v_lshlrev_b32 v80, 16, v60
    v_and_b32 v81, 0xffff0000, v60
    v_lshlrev_b32 v82, 16, v61
    v_and_b32 v83, 0xffff0000, v61
    v_lshlrev_b32 v84, 16, v62
    v_and_b32 v85, 0xffff0000, v62
    v_lshlrev_b32 v86, 16, v63
    v_and_b32 v87, 0xffff0000, v63
    v_fmac_f32 v72, v37, v80
    v_fmac_f32 v73, v37, v81
    v_fmac_f32 v74, v37, v82
    v_fmac_f32 v75, v37, v83
    v_fmac_f32 v76, v37, v84
    v_fmac_f32 v77, v37, v85
    v_fmac_f32 v78, v37, v86
    v_fmac_f32 v79, v37, v87
    s_waitcnt vmcnt(2)
    v_lshlrev_b32 v80, 16, v64
    v_and_b32 v81, 0xffff0000, v64
    v_lshlrev_b32 v82, 16, v65
    v_and_b32 v83, 0xffff0000, v65
    v_lshlrev_b32 v84, 16, v66
    v_and_b32 v85, 0xffff0000, v66
    v_lshlrev_b32 v86, 16, v67
    v_and_b32 v87, 0xffff0000, v67
    v_fmac_f32 v72, v38, v80
    v_fmac_f32 v73, v38, v81
    v_fmac_f32 v74, v38, v82
    v_fmac_f32 v75, v38, v83
    v_fmac_f32 v76, v38, v84
    v_fmac_f32 v77, v38, v85
    v_fmac_f32 v78, v38, v86
    v_fmac_f32 v79, v38, v87
    s_waitcnt vmcnt(1)
    v_lshlrev_b32 v80, 16, v68
    v_and_b32 v81, 0xffff0000, v68
    v_lshlrev_b32 v82, 16, v69
    v_and_b32 v83, 0xffff0000, v69
    v_lshlrev_b32 v84, 16, v70
    v_and_b32 v85, 0xffff0000, v70
    v_lshlrev_b32 v86, 16, v71
    v_and_b32 v87, 0xffff0000, v71
    v_fmac_f32 v72, v39, v80
    v_fmac_f32 v73, v39, v81
    v_fmac_f32 v74, v39, v82
    v_fmac_f32 v75, v39, v83
    v_fmac_f32 v76, v39, v84
    v_fmac_f32 v77, v39, v85
    v_fmac_f32 v78, v39, v86
    v_fmac_f32 v79, v39, v87
    v_add_f32_dpp v72, v72, v72 row_ror:8 row_mask:0xf bank_mask:0xf
    v_add_f32_dpp v73, v73, v73 row_ror:8 row_mask:0xf bank_mask:0xf
    v_add_f32_dpp v74, v74, v74 row_ror:8 row_mask:0xf bank_mask:0xf
    v_add_f32_dpp v75, v75, v75 row_ror:8 row_mask:0xf bank_mask:0xf
    v_add_f32_dpp v76, v76, v76 row_ror:8 row_mask:0xf bank_mask:0xf
    v_add_f32_dpp v77, v77, v77 row_ror:8 row_mask:0xf bank_mask:0xf
    v_add_f32_dpp v78, v78, v78 row_ror:8 row_mask:0xf bank_mask:0xf
    v_add_f32_dpp v79, v79, v79 row_ror:8 row_mask:0xf bank_mask:0xf
    v_mov_b32 v80, v72
    v_mov_b32 v81, v73
    v_mov_b32 v82, v74
    v_mov_b32 v83, v75
    v_mov_b32 v84, v76
    v_mov_b32 v85, v77
    v_mov_b32 v86, v78
    v_mov_b32 v87, v79
    v_permlane32_swap_b32 v72, v80
    v_permlane32_swap_b32 v73, v81
    v_permlane32_swap_b32 v74, v82
    v_permlane32_swap_b32 v75, v83
    v_permlane32_swap_b32 v76, v84
    v_permlane32_swap_b32 v77, v85
    v_permlane32_swap_b32 v78, v86
    v_permlane32_swap_b32 v79, v87
    v_add_f32 v72, v72, v80
    v_add_f32 v73, v73, v81
    v_add_f32 v74, v74, v82
    v_add_f32 v75, v75, v83
    v_add_f32 v76, v76, v84
    v_add_f32 v77, v77, v85
    v_add_f32 v78, v78, v86
    v_add_f32 v79, v79, v87
    v_mov_b32 v80, v72
    v_mov_b32 v81, v73
    v_mov_b32 v82, v74
    v_mov_b32 v83, v75
    v_mov_b32 v84, v76
    v_mov_b32 v85, v77
    v_mov_b32 v86, v78
    v_mov_b32 v87, v79
    v_permlane16_swap_b32 v72, v80
    v_permlane16_swap_b32 v73, v81
    v_permlane16_swap_b32 v74, v82
    v_permlane16_swap_b32 v75, v83
    v_permlane16_swap_b32 v76, v84
    v_permlane16_swap_b32 v77, v85
    v_permlane16_swap_b32 v78, v86
    v_permlane16_swap_b32 v79, v87
    v_add_f32 v72, v72, v80
    v_add_f32 v73, v73, v81
    v_add_f32 v74, v74, v82
    v_add_f32 v75, v75, v83
    v_add_f32 v76, v76, v84
    v_add_f32 v77, v77, v85
    v_add_f32 v78, v78, v86
    v_add_f32 v79, v79, v87
    s_lshl_b32 s44, s28, 8
    s_add_u32 s44, s44, 129024
    v_and_b32 v80, 7, v0
    v_lshl_add_u32 v80, v80, 5, s44
    ds_write_b128 v80, v[72:75]
    ds_write_b128 v80, v[76:79] offset:16
    v_mov_b32 v81, 130048
    v_mov_b32 v82, 1
    s_waitcnt lgkmcnt(0)
    v_cmp_eq_u32 vcc, 0, v1
    s_nop 3
    s_and_saveexec_b64 s[46:47], vcc
    ds_add_rtn_u32 v83, v81, v82
    s_waitcnt lgkmcnt(0)
    v_readfirstlane_b32 s44, v83
    s_mov_b64 exec, -1
    s_nop 2
    s_cmp_lg_u32 s44, 3
    s_cbranch_scc1 qkv_kernel_fin
    v_lshlrev_b32 v80, 2, v1
    v_add_u32 v81, 129024, v80
    ds_read_b32 v72, v81 offset:0
    ds_read_b32 v73, v81 offset:256
    ds_read_b32 v74, v81 offset:512
    ds_read_b32 v75, v81 offset:768
    s_waitcnt lgkmcnt(0)
    v_add_f32 v72, v72, v73
    v_add_f32 v74, v74, v75
    v_add_f32 v72, v72, v74
    buffer_store_dword v72, v80, s[68:71], s84 offen
qkv_kernel_fin:
qkv_kernel_end:
    s_endpgm
.globl wo_kernel
.p2align 8
.type wo_kernel,@function
wo_kernel:
    s_cmp_ge_u32 s2, 256
    s_cbranch_scc1 wo_kernel_end
    s_load_dwordx2 s[4:5], s[0:1], 16
    s_load_dwordx2 s[8:9], s[0:1], 88
    s_load_dwordx2 s[6:7], s[0:1], 0
    s_load_dwordx4 s[64:67], s[0:1], 32
    v_lshrrev_b32 v2, 6, v0
    v_and_b32 v1, 63, v0
    v_readfirstlane_b32 s28, v2
    s_and_b32 s3, s2, 7
    s_lshr_b32 s44, s2, 3
    s_and_b32 s45, s3, 1
    s_lshl_b32 s45, s45, 3
    s_and_b32 s46, s44, 7
    s_add_u32 s32, s45, s46
    s_lshr_b32 s45, s3, 1
    s_lshl_b32 s45, s45, 2
    s_lshr_b32 s46, s44, 3
    s_add_u32 s33, s45, s46
    s_lshl_b32 s32, s32, 7
    s_lshl_b32 s33, s33, 6
    s_cmp_ge_u32 s28, 4
    s_cbranch_scc1 wo_kernel_L
    s_mov_b32 s29, 0
    s_lshr_b32 s30, s28, 1
    s_and_b32 s31, s28, 1
    s_mov_b32 s35, 0
    v_and_b32 v98, 15, v1
    v_lshrrev_b32 v99, 4, v1
    s_lshl_b32 s44, s29, 2
    v_add_u32 v100, s44, v99
    v_lshrrev_b32 v101, 1, v98
    v_xor_b32 v100, v100, v101
    v_lshlrev_b32 v100, 4, v100
    v_lshl_add_u32 v100, v98, 7, v100
    s_lshl_b32 s44, s30, 13
    v_add_u32 v106, s44, v100
    v_bfe_u32 v98, v1, 2, 2
    v_lshl_add_u32 v100, v99, 3, v98
    s_lshl_b32 s44, s29, 5
    v_add_u32 v100, s44, v100
    v_mul_u32_u24 v100, 128, v100
    v_and_b32 v101, 3, v1
    v_lshl_add_u32 v100, v101, 3, v100
    v_add_u32 v100, 16384, v100
    v_lshrrev_b32 v98, 1, v98
    v_and_b32 v99, 1, v99
    v_lshl_or_b32 v98, v99, 1, v98
    s_lshl_b32 s44, s31, 1
    v_xor_b32 v98, s44, v98
    v_lshl_add_u32 v107, v98, 5, v100
    v_xor_b32 v98, 1, v98
    v_lshl_add_u32 v108, v98, 5, v100
    v_xor_b32 v97, 64, v106
    v_and_b32 v98, 15, v1
    s_lshl_b32 s44, s30, 6
    s_add_u32 s44, s44, s32
    v_add_u32 v98, s44, v98
    v_lshlrev_b32 v98, 11, v98
    v_bfe_u32 v99, v1, 4, 1
    v_lshlrev_b32 v99, 4, v99
    v_bfe_u32 v100, v1, 5, 1
    v_lshl_or_b32 v99, v100, 3, v99
    s_lshl_b32 s44, s31, 5
    s_add_u32 s44, s44, s33
    v_add_u32 v99, s44, v99
    v_lshl_add_u32 v109, v99, 1, v98
    v_lshlrev_b32 v110, 2, v99
    s_mov_b32 s40, 0x0
    s_mov_b32 s41, 0x8000
    s_mov_b32 s42, 0x10000
    s_mov_b32 s43, 0x18000
    s_waitcnt lgkmcnt(0)
    s_mov_b32 s20, s6
    s_mov_b32 s21, s7
    s_mov_b32 s22, 0x400000
    s_mov_b32 s23, 0x20000
    s_add_u32 s24, s8, 0xb00000
    s_addc_u32 s25, s9, 0
    s_mov_b32 s26, 0x400000
    s_mov_b32 s27, 0x20000
    s_add_u32 s60, s8, 0x20000
    s_addc_u32 s61, s9, 0
    s_mov_b32 s62, 0x10000
    s_mov_b32 s63, 0x20000
    s_barrier
    v_add_u32 v94, s35, v106
    v_add_u32 v95, s35, v107
    v_add_u32 v96, s35, v108
    ds_read_b128 v[40:43], v94 offset:0
    ds_read_b64_tr_b16 v[56:57], v95 offset:0
    ds_read_b64_tr_b16 v[58:59], v95 offset:512
    ds_read_b64_tr_b16 v[60:61], v96 offset:0
    ds_read_b64_tr_b16 v[62:63], v96 offset:512
    ds_read_b128 v[44:47], v94 offset:2048
    ds_read_b128 v[48:51], v94 offset:4096
    ds_read_b128 v[52:55], v94 offset:6144
    v_add_u32 v94, s35, v97
    s_add_u32 s35, s35, 24576
    s_cmp_ge_u32 s35, 147456
    s_cselect_b32 s35, 0, s35
    s_waitcnt lgkmcnt(0)
    v_mfma_f32_16x16x32_bf16 v[8:11], v[56:59], v[40:43], 0
    ds_read_b128 v[64:67], v94 offset:0
    ds_read_b64_tr_b16 v[80:81], v95 offset:4096
    v_mfma_f32_16x16x32_bf16 v[12:15], v[60:63], v[40:43], 0
    ds_read_b64_tr_b16 v[82:83], v95 offset:4608
    v_mfma_f32_16x16x32_bf16 v[16:19], v[56:59], v[44:47], 0
    ds_read_b64_tr_b16 v[84:85], v96 offset:4096
    v_mfma_f32_16x16x32_bf16 v[20:23], v[60:63], v[44:47], 0
    ds_read_b64_tr_b16 v[86:87], v96 offset:4608
    ds_read_b128 v[68:71], v94 offset:2048
    v_mfma_f32_16x16x32_bf16 v[24:27], v[56:59], v[48:51], 0
    ds_read_b128 v[72:75], v94 offset:4096
    v_mfma_f32_16x16x32_bf16 v[28:31], v[60:63], v[48:51], 0
    ds_read_b128 v[76:79], v94 offset:6144
    v_mfma_f32_16x16x32_bf16 v[32:35], v[56:59], v[52:55], 0
    v_add_u32 v94, s35, v106
    v_add_u32 v95, s35, v107
    v_mfma_f32_16x16x32_bf16 v[36:39], v[60:63], v[52:55], 0
    v_add_u32 v96, s35, v108
    s_waitcnt lgkmcnt(0)
    v_mfma_f32_16x16x32_bf16 v[8:11], v[80:83], v[64:67], v[8:11]
    s_barrier
    v_mfma_f32_16x16x32_bf16 v[12:15], v[84:87], v[64:67], v[12:15]
    ds_read_b128 v[40:43], v94 offset:0
    ds_read_b64_tr_b16 v[56:57], v95 offset:0
    v_mfma_f32_16x16x32_bf16 v[16:19], v[80:83], v[68:71], v[16:19]
    ds_read_b64_tr_b16 v[58:59], v95 offset:512
    ds_read_b64_tr_b16 v[60:61], v96 offset:0
    v_mfma_f32_16x16x32_bf16 v[20:23], v[84:87], v[68:71], v[20:23]
    ds_read_b64_tr_b16 v[62:63], v96 offset:512
    v_mfma_f32_16x16x32_bf16 v[24:27], v[80:83], v[72:75], v[24:27]
    s_movk_i32 s36, 9
wo_kernel_C_loop0:
    ds_read_b128 v[44:47], v94 offset:2048
    ds_read_b128 v[48:51], v94 offset:4096
    v_mfma_f32_16x16x32_bf16 v[28:31], v[84:87], v[72:75], v[28:31]
    ds_read_b128 v[52:55], v94 offset:6144
    v_mfma_f32_16x16x32_bf16 v[32:35], v[80:83], v[76:79], v[32:35]
    v_add_u32 v94, s35, v97
    s_add_u32 s35, s35, 24576
    s_cmp_ge_u32 s35, 147456
    s_cselect_b32 s35, 0, s35
    v_mfma_f32_16x16x32_bf16 v[36:39], v[84:87], v[76:79], v[36:39]
    s_waitcnt lgkmcnt(0)
    v_mfma_f32_16x16x32_bf16 v[8:11], v[56:59], v[40:43], v[8:11]
    ds_read_b128 v[64:67], v94 offset:0
    ds_read_b64_tr_b16 v[80:81], v95 offset:4096
    v_mfma_f32_16x16x32_bf16 v[12:15], v[60:63], v[40:43], v[12:15]
    ds_read_b64_tr_b16 v[82:83], v95 offset:4608
    v_mfma_f32_16x16x32_bf16 v[16:19], v[56:59], v[44:47], v[16:19]
    ds_read_b64_tr_b16 v[84:85], v96 offset:4096
    v_mfma_f32_16x16x32_bf16 v[20:23], v[60:63], v[44:47], v[20:23]
    ds_read_b64_tr_b16 v[86:87], v96 offset:4608
    ds_read_b128 v[68:71], v94 offset:2048
    v_mfma_f32_16x16x32_bf16 v[24:27], v[56:59], v[48:51], v[24:27]
    ds_read_b128 v[72:75], v94 offset:4096
    v_mfma_f32_16x16x32_bf16 v[28:31], v[60:63], v[48:51], v[28:31]
    ds_read_b128 v[76:79], v94 offset:6144
    v_mfma_f32_16x16x32_bf16 v[32:35], v[56:59], v[52:55], v[32:35]
    v_add_u32 v94, s35, v106
    v_add_u32 v95, s35, v107
    v_mfma_f32_16x16x32_bf16 v[36:39], v[60:63], v[52:55], v[36:39]
    v_add_u32 v96, s35, v108
    s_waitcnt lgkmcnt(0)
    v_mfma_f32_16x16x32_bf16 v[8:11], v[80:83], v[64:67], v[8:11]
    s_barrier
    v_mfma_f32_16x16x32_bf16 v[12:15], v[84:87], v[64:67], v[12:15]
    ds_read_b128 v[40:43], v94 offset:0
    ds_read_b64_tr_b16 v[56:57], v95 offset:0
    v_mfma_f32_16x16x32_bf16 v[16:19], v[80:83], v[68:71], v[16:19]
    ds_read_b64_tr_b16 v[58:59], v95 offset:512
    ds_read_b64_tr_b16 v[60:61], v96 offset:0
    v_mfma_f32_16x16x32_bf16 v[20:23], v[84:87], v[68:71], v[20:23]
    s_sub_u32 s36, s36, 1
    s_cmp_lg_u32 s36, 0
    ds_read_b64_tr_b16 v[62:63], v96 offset:512
    v_mfma_f32_16x16x32_bf16 v[24:27], v[80:83], v[72:75], v[24:27]
    s_cbranch_scc1 wo_kernel_C_loop0
    ds_read_b128 v[44:47], v94 offset:2048
    ds_read_b128 v[48:51], v94 offset:4096
    v_mfma_f32_16x16x32_bf16 v[28:31], v[84:87], v[72:75], v[28:31]
    ds_read_b128 v[52:55], v94 offset:6144
    v_mfma_f32_16x16x32_bf16 v[32:35], v[80:83], v[76:79], v[32:35]
    v_add_u32 v94, s35, v97
    s_add_u32 s35, s35, 24576
    s_cmp_ge_u32 s35, 147456
    s_cselect_b32 s35, 0, s35
    v_mfma_f32_16x16x32_bf16 v[36:39], v[84:87], v[76:79], v[36:39]
    s_waitcnt lgkmcnt(0)
    v_mfma_f32_16x16x32_bf16 v[8:11], v[56:59], v[40:43], v[8:11]
    ds_read_b128 v[64:67], v94 offset:0
    ds_read_b64_tr_b16 v[80:81], v95 offset:4096
    v_mfma_f32_16x16x32_bf16 v[12:15], v[60:63], v[40:43], v[12:15]
    ds_read_b64_tr_b16 v[82:83], v95 offset:4608
    v_mfma_f32_16x16x32_bf16 v[16:19], v[56:59], v[44:47], v[16:19]
    ds_read_b64_tr_b16 v[84:85], v96 offset:4096
    v_mfma_f32_16x16x32_bf16 v[20:23], v[60:63], v[44:47], v[20:23]
    ds_read_b64_tr_b16 v[86:87], v96 offset:4608
    ds_read_b128 v[68:71], v94 offset:2048
    v_mfma_f32_16x16x32_bf16 v[24:27], v[56:59], v[48:51], v[24:27]
    ds_read_b128 v[72:75], v94 offset:4096
    v_mfma_f32_16x16x32_bf16 v[28:31], v[60:63], v[48:51], v[28:31]
    ds_read_b128 v[76:79], v94 offset:6144
    v_mfma_f32_16x16x32_bf16 v[32:35], v[56:59], v[52:55], v[32:35]
    v_add_u32 v94, s35, v106
    v_add_u32 v95, s35, v107
    v_mfma_f32_16x16x32_bf16 v[36:39], v[60:63], v[52:55], v[36:39]
    v_add_u32 v96, s35, v108
    s_waitcnt lgkmcnt(0)
    v_mfma_f32_16x16x32_bf16 v[8:11], v[80:83], v[64:67], v[8:11]
    s_barrier
    buffer_load_dwordx4 v[112:115], v109, s[20:23], s40 offen
    v_mfma_f32_16x16x32_bf16 v[12:15], v[84:87], v[64:67], v[12:15]
    ds_read_b128 v[40:43], v94 offset:0
    ds_read_b64_tr_b16 v[56:57], v95 offset:0
    buffer_load_dwordx4 v[116:119], v109, s[20:23], s41 offen
    v_mfma_f32_16x16x32_bf16 v[16:19], v[80:83], v[68:71], v[16:19]
    ds_read_b64_tr_b16 v[58:59], v95 offset:512
    ds_read_b64_tr_b16 v[60:61], v96 offset:0
    buffer_load_dwordx4 v[120:123], v109, s[20:23], s42 offen
    v_mfma_f32_16x16x32_bf16 v[20:23], v[84:87], v[68:71], v[20:23]
    ds_read_b64_tr_b16 v[62:63], v96 offset:512
    buffer_load_dwordx4 v[124:127], v109, s[20:23], s43 offen
    v_mfma_f32_16x16x32_bf16 v[24:27], v[80:83], v[72:75], v[24:27]
    ds_read_b128 v[44:47], v94 offset:2048
    ds_read_b128 v[48:51], v94 offset:4096
    s_mov_b32 s44, 0
    buffer_load_dwordx4 v[128:131], v110, s[60:63], s44 offen
    buffer_load_dwordx4 v[132:135], v110, s[60:63], s44 offen offset:16
    v_mfma_f32_16x16x32_bf16 v[28:31], v[84:87], v[72:75], v[28:31]
    ds_read_b128 v[52:55], v94 offset:6144
    s_mov_b32 s44, 16384
    buffer_load_dwordx4 v[136:139], v110, s[60:63], s44 offen
    buffer_load_dwordx4 v[140:143], v110, s[60:63], s44 offen offset:16
    v_mfma_f32_16x16x32_bf16 v[32:35], v[80:83], v[76:79], v[32:35]
    v_add_u32 v94, s35, v97
    s_add_u32 s35, s35, 24576
    s_cmp_ge_u32 s35, 147456
    s_cselect_b32 s35, 0, s35
    s_mov_b32 s44, 32768
    buffer_load_dwordx4 v[144:147], v110, s[60:63], s44 offen
    buffer_load_dwordx4 v[148:151], v110, s[60:63], s44 offen offset:16
    v_mfma_f32_16x16x32_bf16 v[36:39], v[84:87], v[76:79], v[36:39]
    s_mov_b32 s44, 49152
    buffer_load_dwordx4 v[152:155], v110, s[60:63], s44 offen
    buffer_load_dwordx4 v[156:159], v110, s[60:63], s44 offen offset:16
    s_waitcnt lgkmcnt(0)
    v_mfma_f32_16x16x32_bf16 v[8:11], v[56:59], v[40:43], v[8:11]
    ds_read_b128 v[64:67], v94 offset:0
    ds_read_b64_tr_b16 v[80:81], v95 offset:4096
    v_mfma_f32_16x16x32_bf16 v[12:15], v[60:63], v[40:43], v[12:15]
    ds_read_b64_tr_b16 v[82:83], v95 offset:4608
    v_mfma_f32_16x16x32_bf16 v[16:19], v[56:59], v[44:47], v[16:19]
    ds_read_b64_tr_b16 v[84:85], v96 offset:4096
    v_mfma_f32_16x16x32_bf16 v[20:23], v[60:63], v[44:47], v[20:23]
    ds_read_b64_tr_b16 v[86:87], v96 offset:4608
    ds_read_b128 v[68:71], v94 offset:2048
    v_mfma_f32_16x16x32_bf16 v[24:27], v[56:59], v[48:51], v[24:27]
    s_movk_i32 s36, 4
wo_kernel_C_loop1:
    ds_read_b128 v[72:75], v94 offset:4096
    v_mfma_f32_16x16x32_bf16 v[28:31], v[60:63], v[48:51], v[28:31]
    ds_read_b128 v[76:79], v94 offset:6144
    v_mfma_f32_16x16x32_bf16 v[32:35], v[56:59], v[52:55], v[32:35]
    v_add_u32 v94, s35, v106
    v_add_u32 v95, s35, v107
    v_mfma_f32_16x16x32_bf16 v[36:39], v[60:63], v[52:55], v[36:39]
    v_add_u32 v96, s35, v108
    s_waitcnt lgkmcnt(0)
    v_mfma_f32_16x16x32_bf16 v[8:11], v[80:83], v[64:67], v[8:11]
    s_barrier
    v_mfma_f32_16x16x32_bf16 v[12:15], v[84:87], v[64:67], v[12:15]
    ds_read_b128 v[40:43], v94 offset:0
    ds_read_b64_tr_b16 v[56:57], v95 offset:0
    v_mfma_f32_16x16x32_bf16 v[16:19], v[80:83], v[68:71], v[16:19]
    ds_read_b64_tr_b16 v[58:59], v95 offset:512
    ds_read_b64_tr_b16 v[60:61], v96 offset:0
    v_mfma_f32_16x16x32_bf16 v[20:23], v[84:87], v[68:71], v[20:23]
    ds_read_b64_tr_b16 v[62:63], v96 offset:512
    v_mfma_f32_16x16x32_bf16 v[24:27], v[80:83], v[72:75], v[24:27]
    ds_read_b128 v[44:47], v94 offset:2048
    ds_read_b128 v[48:51], v94 offset:4096
    v_mfma_f32_16x16x32_bf16 v[28:31], v[84:87], v[72:75], v[28:31]
    ds_read_b128 v[52:55], v94 offset:6144
    v_mfma_f32_16x16x32_bf16 v[32:35], v[80:83], v[76:79], v[32:35]
    v_add_u32 v94, s35, v97
    s_add_u32 s35, s35, 24576
    s_cmp_ge_u32 s35, 147456
    s_cselect_b32 s35, 0, s35
    v_mfma_f32_16x16x32_bf16 v[36:39], v[84:87], v[76:79], v[36:39]
    s_waitcnt lgkmcnt(0)
    v_mfma_f32_16x16x32_bf16 v[8:11], v[56:59], v[40:43], v[8:11]
    ds_read_b128 v[64:67], v94 offset:0
    ds_read_b64_tr_b16 v[80:81], v95 offset:4096
    v_mfma_f32_16x16x32_bf16 v[12:15], v[60:63], v[40:43], v[12:15]
    ds_read_b64_tr_b16 v[82:83], v95 offset:4608
    v_mfma_f32_16x16x32_bf16 v[16:19], v[56:59], v[44:47], v[16:19]
    ds_read_b64_tr_b16 v[84:85], v96 offset:4096
    v_mfma_f32_16x16x32_bf16 v[20:23], v[60:63], v[44:47], v[20:23]
    s_sub_u32 s36, s36, 1
    s_cmp_lg_u32 s36, 0
    ds_read_b64_tr_b16 v[86:87], v96 offset:4608
    ds_read_b128 v[68:71], v94 offset:2048
    v_mfma_f32_16x16x32_bf16 v[24:27], v[56:59], v[48:51], v[24:27]
    s_cbranch_scc1 wo_kernel_C_loop1
    ds_read_b128 v[72:75], v94 offset:4096
    v_mfma_f32_16x16x32_bf16 v[28:31], v[60:63], v[48:51], v[28:31]
    ds_read_b128 v[76:79], v94 offset:6144
    v_mfma_f32_16x16x32_bf16 v[32:35], v[56:59], v[52:55], v[32:35]
    v_mfma_f32_16x16x32_bf16 v[36:39], v[60:63], v[52:55], v[36:39]
    s_waitcnt lgkmcnt(0)
    v_mfma_f32_16x16x32_bf16 v[8:11], v[80:83], v[64:67], v[8:11]
    v_mfma_f32_16x16x32_bf16 v[12:15], v[84:87], v[64:67], v[12:15]
    v_mfma_f32_16x16x32_bf16 v[16:19], v[80:83], v[68:71], v[16:19]
    v_mfma_f32_16x16x32_bf16 v[20:23], v[84:87], v[68:71], v[20:23]
    v_mfma_f32_16x16x32_bf16 v[24:27], v[80:83], v[72:75], v[24:27]
    v_mfma_f32_16x16x32_bf16 v[28:31], v[84:87], v[72:75], v[28:31]
    v_mfma_f32_16x16x32_bf16 v[32:35], v[80:83], v[76:79], v[32:35]
    v_mfma_f32_16x16x32_bf16 v[36:39], v[84:87], v[76:79], v[36:39]
    s_waitcnt lgkmcnt(0)
    s_waitcnt vmcnt(0)
    v_pk_add_f32 v[128:129], v[128:129], v[136:137]
    v_pk_add_f32 v[144:145], v[144:145], v[152:153]
    v_pk_add_f32 v[130:131], v[130:131], v[138:139]
    v_pk_add_f32 v[146:147], v[146:147], v[154:155]
    v_pk_add_f32 v[132:133], v[132:133], v[140:141]
    v_pk_add_f32 v[148:149], v[148:149], v[156:157]
    v_pk_add_f32 v[134:135], v[134:135], v[142:143]
    v_pk_add_f32 v[150:151], v[150:151], v[158:159]
    v_pk_add_f32 v[128:129], v[128:129], v[144:145]
    v_pk_add_f32 v[130:131], v[130:131], v[146:147]
    v_pk_add_f32 v[132:133], v[132:133], v[148:149]
    v_pk_add_f32 v[134:135], v[134:135], v[150:151]
    v_cvt_pk_bf16_f32 v136, v128, v129
    v_lshlrev_b32 v128, 16, v136
    v_and_b32 v129, 0xffff0000, v136
    v_cvt_pk_bf16_f32 v137, v130, v131
    v_lshlrev_b32 v130, 16, v137
    v_and_b32 v131, 0xffff0000, v137
    v_cvt_pk_bf16_f32 v138, v132, v133
    v_lshlrev_b32 v132, 16, v138
    v_and_b32 v133, 0xffff0000, v138
    v_cvt_pk_bf16_f32 v139, v134, v135
    v_lshlrev_b32 v134, 16, v139
    v_and_b32 v135, 0xffff0000, v139
    v_lshlrev_b32 v40, 16, v112
    v_and_b32 v41, 0xffff0000, v112
    v_lshlrev_b32 v42, 16, v113
    v_and_b32 v43, 0xffff0000, v113
    v_lshlrev_b32 v44, 16, v114
    v_and_b32 v45, 0xffff0000, v114
    v_lshlrev_b32 v46, 16, v115
    v_and_b32 v47, 0xffff0000, v115
    v_lshlrev_b32 v48, 16, v116
    v_and_b32 v49, 0xffff0000, v116
    v_lshlrev_b32 v50, 16, v117
    v_and_b32 v51, 0xffff0000, v117
    v_lshlrev_b32 v52, 16, v118
    v_and_b32 v53, 0xffff0000, v118
    v_lshlrev_b32 v54, 16, v119
    v_and_b32 v55, 0xffff0000, v119
    v_lshlrev_b32 v56, 16, v120
    v_and_b32 v57, 0xffff0000, v120
    v_lshlrev_b32 v58, 16, v121
    v_and_b32 v59, 0xffff0000, v121
    v_lshlrev_b32 v60, 16, v122
    v_and_b32 v61, 0xffff0000, v122
    v_lshlrev_b32 v62, 16, v123
    v_and_b32 v63, 0xffff0000, v123
    v_lshlrev_b32 v64, 16, v124
    v_and_b32 v65, 0xffff0000, v124
    v_lshlrev_b32 v66, 16, v125
    v_and_b32 v67, 0xffff0000, v125
    v_lshlrev_b32 v68, 16, v126
    v_and_b32 v69, 0xffff0000, v126
    v_lshlrev_b32 v70, 16, v127
    v_and_b32 v71, 0xffff0000, v127
    v_permlane16_swap_b32 v8, v12
    v_permlane16_swap_b32 v9, v13
    v_permlane16_swap_b32 v10, v14
    v_permlane16_swap_b32 v11, v15
    v_permlane16_swap_b32 v16, v20
    v_permlane16_swap_b32 v17, v21
    v_permlane16_swap_b32 v18, v22
    v_permlane16_swap_b32 v19, v23
    v_permlane16_swap_b32 v24, v28
    v_permlane16_swap_b32 v25, v29
    v_permlane16_swap_b32 v26, v30
    v_permlane16_swap_b32 v27, v31
    v_permlane16_swap_b32 v32, v36
    v_permlane16_swap_b32 v33, v37
    v_permlane16_swap_b32 v34, v38
    v_permlane16_swap_b32 v35, v39
    v_pk_fma_f32 v[40:41], v[8:9], v[128:129], v[40:41]
    v_pk_fma_f32 v[42:43], v[10:11], v[130:131], v[42:43]
    v_pk_fma_f32 v[44:45], v[12:13], v[132:133], v[44:45]
    v_pk_fma_f32 v[46:47], v[14:15], v[134:135], v[46:47]
    v_cvt_pk_bf16_f32 v112, v40, v41
    v_cvt_pk_bf16_f32 v113, v42, v43
    v_cvt_pk_bf16_f32 v114, v44, v45
    v_cvt_pk_bf16_f32 v115, v46, v47
    buffer_store_dwordx4 v[112:115], v109, s[24:27], s40 offen
    v_pk_fma_f32 v[48:49], v[16:17], v[128:129], v[48:49]
    v_pk_fma_f32 v[50:51], v[18:19], v[130:131], v[50:51]
    v_pk_fma_f32 v[52:53], v[20:21], v[132:133], v[52:53]
    v_pk_fma_f32 v[54:55], v[22:23], v[134:135], v[54:55]
    v_cvt_pk_bf16_f32 v116, v48, v49
    v_cvt_pk_bf16_f32 v117, v50, v51
    v_cvt_pk_bf16_f32 v118, v52, v53
    v_cvt_pk_bf16_f32 v119, v54, v55
    buffer_store_dwordx4 v[116:119], v109, s[24:27], s41 offen
    v_pk_fma_f32 v[56:57], v[24:25], v[128:129], v[56:57]
    v_pk_fma_f32 v[58:59], v[26:27], v[130:131], v[58:59]
    v_pk_fma_f32 v[60:61], v[28:29], v[132:133], v[60:61]
    v_pk_fma_f32 v[62:63], v[30:31], v[134:135], v[62:63]
    v_cvt_pk_bf16_f32 v120, v56, v57
    v_cvt_pk_bf16_f32 v121, v58, v59
    v_cvt_pk_bf16_f32 v122, v60, v61
    v_cvt_pk_bf16_f32 v123, v62, v63
    buffer_store_dwordx4 v[120:123], v109, s[24:27], s42 offen
    v_pk_fma_f32 v[64:65], v[32:33], v[128:129], v[64:65]
    v_pk_fma_f32 v[66:67], v[34:35], v[130:131], v[66:67]
    v_pk_fma_f32 v[68:69], v[36:37], v[132:133], v[68:69]
    v_pk_fma_f32 v[70:71], v[38:39], v[134:135], v[70:71]
    v_cvt_pk_bf16_f32 v124, v64, v65
    v_cvt_pk_bf16_f32 v125, v66, v67
    v_cvt_pk_bf16_f32 v126, v68, v69
    v_cvt_pk_bf16_f32 v127, v70, v71
    buffer_store_dwordx4 v[124:127], v109, s[24:27], s43 offen
    s_branch wo_kernel_fin
wo_kernel_L:
    s_sub_u32 s28, s28, 4
    s_mov_b32 s34, 0
    s_mov_b32 s38, 0
    s_mov_b32 s39, 0
    s_lshl_b32 s52, s28, 12
    s_add_u32 s53, s52, 1024
    s_add_u32 s54, s52, 2048
    s_add_u32 s55, s52, 3072
    s_lshl_b32 s56, s28, 11
    s_add_u32 s56, s56, 16384
    s_add_u32 s57, s56, 1024
    s_lshl_b32 s45, s28, 5
    s_add_u32 s45, s45, s32
    v_and_b32 v100, 7, v1
    v_lshrrev_b32 v101, 3, v1
    s_movk_i32 s44, 2176
    v_lshrrev_b32 v99, 4, v1
    v_xor_b32 v99, v99, v100
    v_add_u32 v98, s45, v101
    v_mul_lo_u32 v98, s44, v98
    v_lshl_add_u32 v88, v99, 4, v98
    v_lshrrev_b32 v99, 4, v1
    v_or_b32 v99, 4, v99
    v_xor_b32 v99, v99, v100
    v_add_u32 v98, s45, v101
    v_add_u32 v98, 8, v98
    v_mul_lo_u32 v98, s44, v98
    v_lshl_add_u32 v89, v99, 4, v98
    v_lshrrev_b32 v99, 4, v1
    v_xor_b32 v99, v99, v100
    v_add_u32 v98, s45, v101
    v_add_u32 v98, 16, v98
    v_mul_lo_u32 v98, s44, v98
    v_lshl_add_u32 v90, v99, 4, v98
    v_lshrrev_b32 v99, 4, v1
    v_or_b32 v99, 4, v99
    v_xor_b32 v99, v99, v100
    v_add_u32 v98, s45, v101
    v_add_u32 v98, 24, v98
    v_mul_lo_u32 v98, s44, v98
    v_lshl_add_u32 v91, v99, 4, v98
    v_lshrrev_b32 v98, 3, v1
    s_lshl_b32 s44, s28, 4
    v_add_u32 v98, s44, v98
    v_lshlrev_b32 v98, 11, v98
    s_lshl_b32 s44, s33, 1
    v_add_u32 v98, s44, v98
    v_bfe_u32 v99, v1, 4, 1
    v_lshlrev_b32 v99, 1, v99
    v_and_b32 v100, 7, v1
    v_xor_b32 v99, v99, v100
    v_lshl_add_u32 v92, v99, 4, v98
    v_xor_b32 v99, 4, v99
    v_lshl_add_u32 v93, v99, 4, v98
    v_add_u32 v93, 16384, v93
    s_waitcnt lgkmcnt(0)
    s_add_u32 s12, s8, 0x600000
    s_addc_u32 s13, s9, 0
    s_mov_b32 s14, 0x440000
    s_mov_b32 s15, 0x20000
    s_mov_b32 s16, s4
    s_mov_b32 s17, s5
    s_mov_b32 s18, 0x200000
    s_mov_b32 s19, 0x20000
    s_add_u32 m0, s34, s56
    s_nop 0
    buffer_load_dwordx4 v92, s[16:19], s39 offen lds
    s_add_u32 m0, s34, s57
    s_nop 0
    buffer_load_dwordx4 v93, s[16:19], s39 offen lds
    s_add_u32 m0, s34, s52
    s_nop 0
    buffer_load_dwordx4 v88, s[12:15], s38 offen lds
    s_add_u32 m0, s34, s53
    s_nop 0
    buffer_load_dwordx4 v89, s[12:15], s38 offen lds
    s_add_u32 m0, s34, s54
    s_nop 0
    buffer_load_dwordx4 v90, s[12:15], s38 offen lds
    s_add_u32 m0, s34, s55
    s_nop 0
    buffer_load_dwordx4 v91, s[12:15], s38 offen lds
    s_add_u32 s38, s38, 0x80
    s_add_u32 s39, s39, 0x20000
    s_add_u32 s34, s34, 24576
    s_cmp_ge_u32 s34, 147456
    s_cselect_b32 s34, 0, s34
    s_add_u32 m0, s34, s56
    s_nop 0
    buffer_load_dwordx4 v92, s[16:19], s39 offen lds
    s_add_u32 m0, s34, s57
    s_nop 0
    buffer_load_dwordx4 v93, s[16:19], s39 offen lds
    s_add_u32 m0, s34, s52
    s_nop 0
    buffer_load_dwordx4 v88, s[12:15], s38 offen lds
    s_add_u32 m0, s34, s53
    s_nop 0
    buffer_load_dwordx4 v89, s[12:15], s38 offen lds
    s_add_u32 m0, s34, s54
    s_nop 0
    buffer_load_dwordx4 v90, s[12:15], s38 offen lds
    s_add_u32 m0, s34, s55
    s_nop 0
    buffer_load_dwordx4 v91, s[12:15], s38 offen lds
    s_add_u32 s38, s38, 0x80
    s_add_u32 s39, s39, 0x20000
    s_add_u32 s34, s34, 24576
    s_cmp_ge_u32 s34, 147456
    s_cselect_b32 s34, 0, s34
    s_add_u32 m0, s34, s56
    s_nop 0
    buffer_load_dwordx4 v92, s[16:19], s39 offen lds
    s_add_u32 m0, s34, s57
    s_nop 0
    buffer_load_dwordx4 v93, s[16:19], s39 offen lds
    s_add_u32 m0, s34, s52
    s_nop 0
    buffer_load_dwordx4 v88, s[12:15], s38 offen lds
    s_add_u32 m0, s34, s53
    s_nop 0
    buffer_load_dwordx4 v89, s[12:15], s38 offen lds
    s_add_u32 m0, s34, s54
    s_nop 0
    buffer_load_dwordx4 v90, s[12:15], s38 offen lds
    s_add_u32 m0, s34, s55
    s_nop 0
    buffer_load_dwordx4 v91, s[12:15], s38 offen lds
    s_add_u32 s38, s38, 0x80
    s_add_u32 s39, s39, 0x20000
    s_add_u32 s34, s34, 24576
    s_cmp_ge_u32 s34, 147456
    s_cselect_b32 s34, 0, s34
    s_add_u32 m0, s34, s56
    s_nop 0
    buffer_load_dwordx4 v92, s[16:19], s39 offen lds
    s_add_u32 m0, s34, s57
    s_nop 0
    buffer_load_dwordx4 v93, s[16:19], s39 offen lds
    s_add_u32 m0, s34, s52
    s_nop 0
    buffer_load_dwordx4 v88, s[12:15], s38 offen lds
    s_add_u32 m0, s34, s53
    s_nop 0
    buffer_load_dwordx4 v89, s[12:15], s38 offen lds
    s_add_u32 m0, s34, s54
    s_nop 0
    buffer_load_dwordx4 v90, s[12:15], s38 offen lds
    s_add_u32 m0, s34, s55
    s_nop 0
    buffer_load_dwordx4 v91, s[12:15], s38 offen lds
    s_add_u32 s38, s38, 0x80
    s_add_u32 s39, s39, 0x20000
    s_add_u32 s34, s34, 24576
    s_cmp_ge_u32 s34, 147456
    s_cselect_b32 s34, 0, s34
    s_add_u32 m0, s34, s56
    s_nop 0
    buffer_load_dwordx4 v92, s[16:19], s39 offen lds
    s_add_u32 m0, s34, s57
    s_nop 0
    buffer_load_dwordx4 v93, s[16:19], s39 offen lds
    s_add_u32 m0, s34, s52
    s_nop 0
    buffer_load_dwordx4 v88, s[12:15], s38 offen lds
    s_add_u32 m0, s34, s53
    s_nop 0
    buffer_load_dwordx4 v89, s[12:15], s38 offen lds
    s_add_u32 m0, s34, s54
    s_nop 0
    buffer_load_dwordx4 v90, s[12:15], s38 offen lds
    s_add_u32 m0, s34, s55
    s_nop 0
    buffer_load_dwordx4 v91, s[12:15], s38 offen lds
    s_add_u32 s38, s38, 0x80
    s_add_u32 s39, s39, 0x20000
    s_add_u32 s34, s34, 24576
    s_cmp_ge_u32 s34, 147456
    s_cselect_b32 s34, 0, s34
    s_add_u32 m0, s34, s56
    s_nop 0
    buffer_load_dwordx4 v92, s[16:19], s39 offen lds
    s_add_u32 m0, s34, s57
    s_nop 0
    buffer_load_dwordx4 v93, s[16:19], s39 offen lds
    s_add_u32 m0, s34, s52
    s_nop 0
    buffer_load_dwordx4 v88, s[12:15], s38 offen lds
    s_add_u32 m0, s34, s53
    s_nop 0
    buffer_load_dwordx4 v89, s[12:15], s38 offen lds
    s_add_u32 m0, s34, s54
    s_nop 0
    buffer_load_dwordx4 v90, s[12:15], s38 offen lds
    s_add_u32 m0, s34, s55
    s_nop 0
    buffer_load_dwordx4 v91, s[12:15], s38 offen lds
    s_add_u32 s38, s38, 0x80
    s_add_u32 s39, s39, 0x20000
    s_add_u32 s34, s34, 24576
    s_cmp_ge_u32 s34, 147456
    s_cselect_b32 s34, 0, s34
    s_waitcnt vmcnt(30) lgkmcnt(0)
    s_barrier
    s_movk_i32 s36, 5
wo_kernel_L_loop0:
    s_waitcnt vmcnt(24)
    s_barrier
    s_add_u32 m0, s34, s56
    s_nop 0
    buffer_load_dwordx4 v92, s[16:19], s39 offen lds
    s_add_u32 m0, s34, s57
    s_nop 0
    buffer_load_dwordx4 v93, s[16:19], s39 offen lds
    s_add_u32 m0, s34, s52
    s_nop 0
    buffer_load_dwordx4 v88, s[12:15], s38 offen lds
    s_add_u32 m0, s34, s53
    s_nop 0
    buffer_load_dwordx4 v89, s[12:15], s38 offen lds
    s_add_u32 m0, s34, s54
    s_nop 0
    buffer_load_dwordx4 v90, s[12:15], s38 offen lds
    s_add_u32 m0, s34, s55
    s_nop 0
    buffer_load_dwordx4 v91, s[12:15], s38 offen lds
    s_add_u32 s38, s38, 0x80
    s_add_u32 s39, s39, 0x20000
    s_add_u32 s34, s34, 24576
    s_cmp_ge_u32 s34, 147456
    s_cselect_b32 s34, 0, s34
    s_waitcnt vmcnt(24)
    s_barrier
    s_add_u32 m0, s34, s56
    s_nop 0
    buffer_load_dwordx4 v92, s[16:19], s39 offen lds
    s_add_u32 m0, s34, s57
    s_nop 0
    buffer_load_dwordx4 v93, s[16:19], s39 offen lds
    s_add_u32 m0, s34, s52
    s_nop 0
    buffer_load_dwordx4 v88, s[12:15], s38 offen lds
    s_add_u32 m0, s34, s53
    s_nop 0
    buffer_load_dwordx4 v89, s[12:15], s38 offen lds
    s_add_u32 m0, s34, s54
    s_nop 0
    buffer_load_dwordx4 v90, s[12:15], s38 offen lds
    s_add_u32 m0, s34, s55
    s_nop 0
    buffer_load_dwordx4 v91, s[12:15], s38 offen lds
    s_add_u32 s38, s38, 0x80
    s_add_u32 s39, s39, 0x20000
    s_add_u32 s34, s34, 24576
    s_cmp_ge_u32 s34, 147456
    s_cselect_b32 s34, 0, s34
    s_sub_u32 s36, s36, 1
    s_cmp_lg_u32 s36, 0
    s_cbranch_scc1 wo_kernel_L_loop0
    s_waitcnt vmcnt(24)
    s_barrier
    s_add_u32 s60, s8, 0x20000
    s_addc_u32 s61, s9, 0
    s_mov_b32 s62, 0x10000
    s_mov_b32 s63, 0x20000
    s_mov_b32 s48, s8
    s_mov_b32 s49, s9
    s_mov_b32 s50, 0x6000
    s_mov_b32 s51, 0x20000
    v_and_b32 v12, 15, v0
    s_lshl_b32 s44, s2, 4
    v_add_lshl_u32 v12, v12, s44, 2
    s_mov_b32 s44, 0
    buffer_load_dword v8, v12, s[60:63], s44 offen
    s_mov_b32 s44, 16384
    buffer_load_dword v9, v12, s[60:63], s44 offen
    s_mov_b32 s44, 32768
    buffer_load_dword v10, v12, s[60:63], s44 offen
    s_mov_b32 s44, 49152
    buffer_load_dword v11, v12, s[60:63], s44 offen
    v_and_b32 v13, 255, v0
    s_lshl_b32 s44, s2, 8
    v_add_lshl_u32 v13, v13, s44, 6
    s_mov_b32 s60, s64
    s_mov_b32 s61, s65
    s_mov_b32 s62, 0x300000
    s_mov_b32 s63, 0x20000
    s_mov_b32 s44, 0x0
    buffer_load_dword v14, v13, s[60:63], s44 offen
    s_mov_b32 s60, s66
    s_mov_b32 s61, s67
    s_mov_b32 s62, 0x300000
    s_mov_b32 s63, 0x20000
    s_mov_b32 s44, 0x0
    buffer_load_dword v14, v13, s[60:63], s44 offen
    s_waitcnt vmcnt(24)
    s_barrier
    s_waitcnt vmcnt(18)
    s_barrier
    s_waitcnt vmcnt(12)
    s_barrier
    s_waitcnt vmcnt(6)
    s_barrier
    s_waitcnt vmcnt(2)
    v_add_f32 v8, v8, v9
    v_add_f32 v10, v10, v11
    v_add_f32 v8, v8, v10
    v_cvt_pk_bf16_f32 v9, v8, v8
    v_lshlrev_b32 v8, 16, v9
    s_lshr_b32 s44, s2, 6
    s_cmp_eq_u32 s44, 2
    s_cselect_b32 s44, 1.0, 0
    v_add_f32 v8, s44, v8
    v_cvt_pk_bf16_f32 v9, v8, v8
    v_lshlrev_b32 v8, 16, v9
    s_movk_i32 s44, 8192
    s_movk_i32 s45, 272
    v_cmp_gt_u32 vcc, s45, v0
    s_nop 3
    s_and_saveexec_b64 s[46:47], vcc
    s_cbranch_execz wo_kernel_fsk
    buffer_store_dword v8, v12, s[48:51], s44 offen
wo_kernel_fsk:
    s_mov_b64 exec, -1
wo_kernel_fin:
wo_kernel_end:
    s_endpgm
.globl ln2_kernel
.p2align 8
.type ln2_kernel,@function
ln2_kernel:
    s_cmp_ge_u32 s2, 512
    s_cbranch_scc1 ln2_kernel_end
    s_load_dwordx2 s[8:9], s[0:1], 88
    s_load_dwordx4 s[4:7], s[0:1], 32
    v_and_b32 v1, 63, v0
    v_lshrrev_b32 v2, 6, v0
    s_lshl_b32 s3, s2, 2
    v_add_u32 v2, s3, v2
    s_movk_i32 s3, 2176
    v_mul_lo_u32 v14, s3, v2
    v_lshl_add_u32 v14, v1, 4, v14
    v_lshlrev_b32 v2, 11, v2
    v_lshl_add_u32 v2, v1, 4, v2
    v_lshlrev_b32 v3, 5, v1
    s_lshl_b32 s3, s2, 8
    v_add_lshl_u32 v12, v0, s3, 4
    s_movk_i32 s24, 16384
    s_movk_i32 s25, 12288
    s_waitcnt lgkmcnt(0)
    s_add_u32 s12, s8, 0xb00000
    s_addc_u32 s13, s9, 0
    s_mov_b32 s14, 0x400000
    s_mov_b32 s15, 0x20000
    s_mov_b32 s20, s8
    s_mov_b32 s21, s9
    s_mov_b32 s22, 0x6000
    s_mov_b32 s23, 0x20000
    buffer_load_dwordx4 v[4:7], v2, s[12:15], 0 offen
    buffer_load_dwordx4 v[8:11], v2, s[12:15], 0 offen offset:1024
    buffer_load_dwordx4 v[48:51], v3, s[20:23], s24 offen offset:0
    buffer_load_dwordx4 v[52:55], v3, s[20:23], s24 offen offset:16
    buffer_load_dwordx4 v[56:59], v3, s[20:23], s24 offen offset:2048
    buffer_load_dwordx4 v[60:63], v3, s[20:23], s24 offen offset:2064
    buffer_load_dwordx4 v[64:67], v3, s[20:23], s25 offen offset:0
    buffer_load_dwordx4 v[68:71], v3, s[20:23], s25 offen offset:16
    buffer_load_dwordx4 v[72:75], v3, s[20:23], s25 offen offset:2048
    buffer_load_dwordx4 v[76:79], v3, s[20:23], s25 offen offset:2064
    s_mov_b32 s28, s4
    s_mov_b32 s29, s5
    s_mov_b32 s30, 0x480000
    s_mov_b32 s31, 0x20000
    s_mov_b32 s3, 0x300000
    buffer_load_dword v13, v12, s[28:31], s3 offen
    s_mov_b32 s28, s6
    s_mov_b32 s29, s7
    s_mov_b32 s30, 0x480000
    s_mov_b32 s31, 0x20000
    s_mov_b32 s3, 0x300000
    buffer_load_dword v13, v12, s[28:31], s3 offen
    s_add_u32 s16, s8, 0x1000000
    s_addc_u32 s17, s9, 0
    s_mov_b32 s18, 0x440000
    s_mov_b32 s19, 0x20000
    s_waitcnt vmcnt(10)
    v_lshlrev_b32 v16, 16, v4
    v_and_b32 v17, 0xffff0000, v4
    v_lshlrev_b32 v18, 16, v5
    v_and_b32 v19, 0xffff0000, v5
    v_lshlrev_b32 v20, 16, v6
    v_and_b32 v21, 0xffff0000, v6
    v_lshlrev_b32 v22, 16, v7
    v_and_b32 v23, 0xffff0000, v7
    v_lshlrev_b32 v24, 16, v8
    v_and_b32 v25, 0xffff0000, v8
    v_lshlrev_b32 v26, 16, v9
    v_and_b32 v27, 0xffff0000, v9
    v_lshlrev_b32 v28, 16, v10
    v_and_b32 v29, 0xffff0000, v10
    v_lshlrev_b32 v30, 16, v11
    v_and_b32 v31, 0xffff0000, v11
    v_add_f32 v32, v16, v17
    v_add_f32 v33, v18, v19
    v_add_f32 v32, v32, v20
    v_add_f32 v33, v33, v21
    v_add_f32 v32, v32, v22
    v_add_f32 v33, v33, v23
    v_add_f32 v32, v32, v24
    v_add_f32 v33, v33, v25
    v_add_f32 v32, v32, v26
    v_add_f32 v33, v33, v27
    v_add_f32 v32, v32, v28
    v_add_f32 v33, v33, v29
    v_add_f32 v32, v32, v30
    v_add_f32 v33, v33, v31
    v_add_f32 v32, v32, v33
    s_nop 1
    v_add_f32_dpp v32, v32, v32 quad_perm:[1,0,3,2] row_mask:0xf bank_mask:0xf
    s_nop 1
    v_add_f32_dpp v32, v32, v32 quad_perm:[2,3,0,1] row_mask:0xf bank_mask:0xf
    s_nop 1
    v_add_f32_dpp v32, v32, v32 row_half_mirror row_mask:0xf bank_mask:0xf
    s_nop 1
    v_add_f32_dpp v32, v32, v32 row_mirror row_mask:0xf bank_mask:0xf
    v_mov_b32 v34, v32
    s_nop 1
    v_permlane32_swap_b32 v32, v34
    v_add_f32 v32, v32, v34
    v_mov_b32 v34, v32
    s_nop 1
    v_permlane16_swap_b32 v32, v34
    v_add_f32 v32, v32, v34
    v_mul_f32 v32, 0x3a800000, v32
    v_sub_f32 v34, v16, v32
    v_mul_f32 v33, v34, v34
    v_sub_f32 v35, v17, v32
    v_fmac_f32 v33, v35, v35
    v_sub_f32 v34, v18, v32
    v_fmac_f32 v33, v34, v34
    v_sub_f32 v35, v19, v32
    v_fmac_f32 v33, v35, v35
    v_sub_f32 v34, v20, v32
    v_fmac_f32 v33, v34, v34
    v_sub_f32 v35, v21, v32
    v_fmac_f32 v33, v35, v35
    v_sub_f32 v34, v22, v32
    v_fmac_f32 v33, v34, v34
    v_sub_f32 v35, v23, v32
    v_fmac_f32 v33, v35, v35
    v_sub_f32 v34, v24, v32
    v_fmac_f32 v33, v34, v34
    v_sub_f32 v35, v25, v32
    v_fmac_f32 v33, v35, v35
    v_sub_f32 v34, v26, v32
    v_fmac_f32 v33, v34, v34
    v_sub_f32 v35, v27, v32
    v_fmac_f32 v33, v35, v35
    v_sub_f32 v34, v28, v32
    v_fmac_f32 v33, v34, v34
    v_sub_f32 v35, v29, v32
    v_fmac_f32 v33, v35, v35
    v_sub_f32 v34, v30, v32
    v_fmac_f32 v33, v34, v34
    v_sub_f32 v35, v31, v32
    v_fmac_f32 v33, v35, v35
    s_nop 1
    v_add_f32_dpp v33, v33, v33 quad_perm:[1,0,3,2] row_mask:0xf bank_mask:0xf
    s_nop 1
    v_add_f32_dpp v33, v33, v33 quad_perm:[2,3,0,1] row_mask:0xf bank_mask:0xf
    s_nop 1
    v_add_f32_dpp v33, v33, v33 row_half_mirror row_mask:0xf bank_mask:0xf
    s_nop 1
    v_add_f32_dpp v33, v33, v33 row_mirror row_mask:0xf bank_mask:0xf
    v_mov_b32 v34, v33
    s_nop 1
    v_permlane32_swap_b32 v33, v34
    v_add_f32 v33, v33, v34
    v_mov_b32 v34, v33
    s_nop 1
    v_permlane16_swap_b32 v33, v34
    v_add_f32 v33, v33, v34
    v_mul_f32 v33, 0x3a800000, v33
    v_cvt_pk_bf16_f32 v34, v32, v33
    v_lshlrev_b32 v32, 16, v34
    v_and_b32 v33, 0xffff0000, v34
    v_add_f32 v33, 0x3727c5ac, v33
    v_cvt_pk_bf16_f32 v34, v33, v33
    v_lshlrev_b32 v33, 16, v34
    v_sqrt_f32 v33, v33
    s_nop 0
    v_cvt_pk_bf16_f32 v34, v33, v33
    v_lshlrev_b32 v33, 16, v34
    v_rcp_f32 v33, v33
    s_waitcnt vmcnt(2)
    v_sub_f32 v16, v16, v32
    v_sub_f32 v17, v17, v32
    v_sub_f32 v18, v18, v32
    v_sub_f32 v19, v19, v32
    v_sub_f32 v20, v20, v32
    v_sub_f32 v21, v21, v32
    v_sub_f32 v22, v22, v32
    v_sub_f32 v23, v23, v32
    v_sub_f32 v24, v24, v32
    v_sub_f32 v25, v25, v32
    v_sub_f32 v26, v26, v32
    v_sub_f32 v27, v27, v32
    v_sub_f32 v28, v28, v32
    v_sub_f32 v29, v29, v32
    v_sub_f32 v30, v30, v32
    v_sub_f32 v31, v31, v32
    v_cvt_pk_bf16_f32 v36, v16, v17
    v_lshlrev_b32 v16, 16, v36
    v_and_b32 v17, 0xffff0000, v36
    v_cvt_pk_bf16_f32 v37, v18, v19
    v_lshlrev_b32 v18, 16, v37
    v_and_b32 v19, 0xffff0000, v37
    v_cvt_pk_bf16_f32 v38, v20, v21
    v_lshlrev_b32 v20, 16, v38
    v_and_b32 v21, 0xffff0000, v38
    v_cvt_pk_bf16_f32 v39, v22, v23
    v_lshlrev_b32 v22, 16, v39
    v_and_b32 v23, 0xffff0000, v39
    v_cvt_pk_bf16_f32 v40, v24, v25
    v_lshlrev_b32 v24, 16, v40
    v_and_b32 v25, 0xffff0000, v40
    v_cvt_pk_bf16_f32 v41, v26, v27
    v_lshlrev_b32 v26, 16, v41
    v_and_b32 v27, 0xffff0000, v41
    v_cvt_pk_bf16_f32 v42, v28, v29
    v_lshlrev_b32 v28, 16, v42
    v_and_b32 v29, 0xffff0000, v42
    v_cvt_pk_bf16_f32 v43, v30, v31
    v_lshlrev_b32 v30, 16, v43
    v_and_b32 v31, 0xffff0000, v43
    v_mul_f32 v16, v16, v33
    v_mul_f32 v17, v17, v33
    v_mul_f32 v18, v18, v33
    v_mul_f32 v19, v19, v33
    v_mul_f32 v20, v20, v33
    v_mul_f32 v21, v21, v33
    v_mul_f32 v22, v22, v33
    v_mul_f32 v23, v23, v33
    v_mul_f32 v24, v24, v33
    v_mul_f32 v25, v25, v33
    v_mul_f32 v26, v26, v33
    v_mul_f32 v27, v27, v33
    v_mul_f32 v28, v28, v33
    v_mul_f32 v29, v29, v33
    v_mul_f32 v30, v30, v33
    v_mul_f32 v31, v31, v33
    v_cvt_pk_bf16_f32 v36, v16, v17
    v_lshlrev_b32 v16, 16, v36
    v_and_b32 v17, 0xffff0000, v36
    v_cvt_pk_bf16_f32 v37, v18, v19
    v_lshlrev_b32 v18, 16, v37
    v_and_b32 v19, 0xffff0000, v37
    v_cvt_pk_bf16_f32 v38, v20, v21
    v_lshlrev_b32 v20, 16, v38
    v_and_b32 v21, 0xffff0000, v38
    v_cvt_pk_bf16_f32 v39, v22, v23
    v_lshlrev_b32 v22, 16, v39
    v_and_b32 v23, 0xffff0000, v39
    v_cvt_pk_bf16_f32 v40, v24, v25
    v_lshlrev_b32 v24, 16, v40
    v_and_b32 v25, 0xffff0000, v40
    v_cvt_pk_bf16_f32 v41, v26, v27
    v_lshlrev_b32 v26, 16, v41
    v_and_b32 v27, 0xffff0000, v41
    v_cvt_pk_bf16_f32 v42, v28, v29
    v_lshlrev_b32 v28, 16, v42
    v_and_b32 v29, 0xffff0000, v42
    v_cvt_pk_bf16_f32 v43, v30, v31
    v_lshlrev_b32 v30, 16, v43
    v_and_b32 v31, 0xffff0000, v43
    v_mul_f32 v16, v16, v48
    v_mul_f32 v17, v17, v49
    v_mul_f32 v18, v18, v50
    v_mul_f32 v19, v19, v51
    v_mul_f32 v20, v20, v52
    v_mul_f32 v21, v21, v53
    v_mul_f32 v22, v22, v54
    v_mul_f32 v23, v23, v55
    v_mul_f32 v24, v24, v56
    v_mul_f32 v25, v25, v57
    v_mul_f32 v26, v26, v58
    v_mul_f32 v27, v27, v59
    v_mul_f32 v28, v28, v60
    v_mul_f32 v29, v29, v61
    v_mul_f32 v30, v30, v62
    v_mul_f32 v31, v31, v63
    v_cvt_pk_bf16_f32 v36, v16, v17
    v_lshlrev_b32 v16, 16, v36
    v_and_b32 v17, 0xffff0000, v36
    v_cvt_pk_bf16_f32 v37, v18, v19
    v_lshlrev_b32 v18, 16, v37
    v_and_b32 v19, 0xffff0000, v37
    v_cvt_pk_bf16_f32 v38, v20, v21
    v_lshlrev_b32 v20, 16, v38
    v_and_b32 v21, 0xffff0000, v38
    v_cvt_pk_bf16_f32 v39, v22, v23
    v_lshlrev_b32 v22, 16, v39
    v_and_b32 v23, 0xffff0000, v39
    v_cvt_pk_bf16_f32 v40, v24, v25
    v_lshlrev_b32 v24, 16, v40
    v_and_b32 v25, 0xffff0000, v40
    v_cvt_pk_bf16_f32 v41, v26, v27
    v_lshlrev_b32 v26, 16, v41
    v_and_b32 v27, 0xffff0000, v41
    v_cvt_pk_bf16_f32 v42, v28, v29
    v_lshlrev_b32 v28, 16, v42
    v_and_b32 v29, 0xffff0000, v42
    v_cvt_pk_bf16_f32 v43, v30, v31
    v_lshlrev_b32 v30, 16, v43
    v_and_b32 v31, 0xffff0000, v43
    v_add_f32 v16, v16, v64
    v_add_f32 v17, v17, v65
    v_add_f32 v18, v18, v66
    v_add_f32 v19, v19, v67
    v_add_f32 v20, v20, v68
    v_add_f32 v21, v21, v69
    v_add_f32 v22, v22, v70
    v_add_f32 v23, v23, v71
    v_add_f32 v24, v24, v72
    v_add_f32 v25, v25, v73
    v_add_f32 v26, v26, v74
    v_add_f32 v27, v27, v75
    v_add_f32 v28, v28, v76
    v_add_f32 v29, v29, v77
    v_add_f32 v30, v30, v78
    v_add_f32 v31, v31, v79
    v_cvt_pk_bf16_f32 v4, v16, v17
    v_cvt_pk_bf16_f32 v5, v18, v19
    v_cvt_pk_bf16_f32 v6, v20, v21
    v_cvt_pk_bf16_f32 v7, v22, v23
    v_cvt_pk_bf16_f32 v8, v24, v25
    v_cvt_pk_bf16_f32 v9, v26, v27
    v_cvt_pk_bf16_f32 v10, v28, v29
    v_cvt_pk_bf16_f32 v11, v30, v31
    buffer_store_dwordx4 v[4:7], v14, s[16:19], 0 offen
    buffer_store_dwordx4 v[8:11], v14, s[16:19], 0 offen offset:1024
ln2_kernel_end:
    s_endpgm
.globl gd_kernel
.p2align 8
.type gd_kernel,@function
gd_kernel:
    s_cmp_ge_u32 s2, 256
    s_cbranch_scc1 gd_kernel_end
    s_load_dwordx4 s[4:7], s[0:1], 32
    s_load_dwordx2 s[8:9], s[0:1], 88
    s_load_dwordx2 s[10:11], s[0:1], 48
    v_lshrrev_b32 v2, 6, v0
    v_and_b32 v1, 63, v0
    v_readfirstlane_b32 s56, v2
    s_and_b32 s3, s2, 7
    s_lshr_b32 s44, s2, 3
    s_and_b32 s45, s3, 1
    s_lshl_b32 s45, s45, 3
    s_and_b32 s46, s44, 7
    s_add_u32 s59, s45, s46
    s_lshr_b32 s45, s3, 1
    s_lshl_b32 s45, s45, 2
    s_lshr_b32 s46, s44, 3
    s_add_u32 s60, s45, s46
    s_lshl_b32 s59, s59, 7
    s_cmp_ge_u32 s56, 4
    s_cbranch_scc1 gd_kernel_Q
    s_lshr_b32 s57, s56, 1
    s_and_b32 s58, s56, 1
    s_mov_b32 s65, 0
    s_lshl_b32 s70, s56, 11
    v_and_b32 v2, 15, v1
    v_lshrrev_b32 v3, 4, v1
    v_lshrrev_b32 v4, 1, v2
    v_xor_b32 v4, v4, v3
    v_lshlrev_b32 v4, 4, v4
    v_lshl_add_u32 v4, v2, 7, v4
    s_lshl_b32 s76, s57, 13
    v_add_u32 v233, s76, v4
    v_xor_b32 v234, 64, v233
    v_lshrrev_b32 v3, 4, v1
    v_bfe_u32 v2, v1, 2, 2
    v_lshl_add_u32 v4, v3, 3, v2
    v_lshlrev_b32 v4, 8, v4
    v_and_b32 v5, 3, v1
    v_lshl_add_u32 v4, v5, 3, v4
    v_add_u32 v4, 16384, v4
    v_and_b32 v3, 1, v3
    v_lshl_or_b32 v2, v3, 2, v2
    s_lshl_b32 s76, s58, 2
    v_xor_b32 v2, s76, v2
    v_xor_b32 v3, 0, v2
    v_lshl_add_u32 v239, v3, 5, v4
    v_xor_b32 v3, 1, v2
    v_lshl_add_u32 v240, v3, 5, v4
    v_xor_b32 v3, 2, v2
    v_lshl_add_u32 v241, v3, 5, v4
    v_xor_b32 v3, 3, v2
    v_lshl_add_u32 v242, v3, 5, v4
    s_and_b32 s3, s2, 7
    s_lshr_b32 s76, s2, 3
    s_and_b32 s61, s76, 1
    s_and_b32 s62, s3, 3
    s_lshl_b32 s62, s62, 2
    s_bfe_u32 s77, s76, 0x20001
    s_add_u32 s62, s62, s77
    s_lshr_b32 s63, s3, 2
    s_lshl_b32 s63, s63, 2
    s_lshr_b32 s77, s76, 3
    s_add_u32 s63, s63, s77
    s_lshl_b32 s64, s62, 3
    s_add_u32 s64, s64, s63
    s_lshl_b32 s76, s2, 8
    v_add_lshl_u32 v243, v0, s76, 5
    s_mov_b32 s74, 0xbfb8aa3b
    s_mov_b32 s75, 0xbfb8aa3b
    s_waitcnt lgkmcnt(0)
    s_add_u32 s12, s8, 0x1000000
    s_addc_u32 s13, s9, 0
    s_mov_b32 s14, 0x440000
    s_mov_b32 s15, 0x20000
    s_mov_b32 s16, s4
    s_mov_b32 s17, s5
    s_mov_b32 s18, 0x700000
    s_mov_b32 s19, 0x20000
    s_mov_b32 s20, s6
    s_mov_b32 s21, s7
    s_mov_b32 s22, 0x700000
    s_mov_b32 s23, 0x20000
    s_add_u32 s24, s8, 0x1500000
    s_addc_u32 s25, s9, 0
    s_mov_b32 s26, 0xe00000
    s_mov_b32 s27, 0x20000
    s_mov_b32 s28, s10
    s_mov_b32 s29, s11
    s_mov_b32 s30, 0x700000
    s_mov_b32 s31, 0x20000
    s_add_u32 s32, s8, 0x50000
    s_addc_u32 s33, s9, 0
    s_mov_b32 s34, 0x3000
    s_mov_b32 s35, 0x20000
    s_mov_b32 s44, s8
    s_mov_b32 s45, s9
    s_mov_b32 s46, 0x6000
    s_mov_b32 s47, 0x20000
    s_add_u32 s48, s8, 0x100000
    s_addc_u32 s49, s9, 0
    s_mov_b32 s50, 0x800000
    s_mov_b32 s51, 0x20000
    s_load_dwordx2 s[40:41], s[0:1], 72
    s_mov_b32 s42, 0x400000
    s_mov_b32 s43, 0x20000
    s_cmp_eq_u32 s61, 0
    s_cselect_b32 s46, 0, s46
    v_add_u32 v232, s65, v233
    v_add_u32 v235, s65, v239
    v_add_u32 v236, s65, v240
    v_add_u32 v237, s65, v241
    v_add_u32 v238, s65, v242
    s_waitcnt lgkmcnt(0)
    s_setprio 2
    s_barrier
    ds_read_b128 v[136:139], v232 offset:0
    ds_read_b64_tr_b16 v[152:153], v235 offset:0
    ds_read_b64_tr_b16 v[154:155], v235 offset:1024
    ds_read_b64_tr_b16 v[156:157], v236 offset:0
    ds_read_b64_tr_b16 v[158:159], v236 offset:1024
    ds_read_b64_tr_b16 v[160:161], v237 offset:0
    ds_read_b64_tr_b16 v[162:163], v237 offset:1024
    ds_read_b64_tr_b16 v[164:165], v238 offset:0
    ds_read_b64_tr_b16 v[166:167], v238 offset:1024
    ds_read_b64_tr_b16 v[168:169], v235 offset:16384
    ds_read_b64_tr_b16 v[170:171], v235 offset:17408
    ds_read_b64_tr_b16 v[172:173], v236 offset:16384
    ds_read_b64_tr_b16 v[174:175], v236 offset:17408
    ds_read_b64_tr_b16 v[176:177], v237 offset:16384
    ds_read_b64_tr_b16 v[178:179], v237 offset:17408
    ds_read_b64_tr_b16 v[180:181], v238 offset:16384
    ds_read_b64_tr_b16 v[182:183], v238 offset:17408
    ds_read_b128 v[140:143], v232 offset:2048
    ds_read_b128 v[144:147], v232 offset:4096
    ds_read_b128 v[148:151], v232 offset:6144
    v_add_u32 v232, s65, v234
    s_add_u32 s65, s65, 49152
    s_cmp_ge_u32 s65, 147456
    s_cselect_b32 s65, 0, s65
    s_waitcnt lgkmcnt(0)
    v_mfma_f32_16x16x32_bf16 v[8:11], v[152:155], v[136:139], 0
    ds_read_b128 v[184:187], v232 offset:0
    v_mfma_f32_16x16x32_bf16 v[12:15], v[156:159], v[136:139], 0
    ds_read_b64_tr_b16 v[200:201], v235 offset:8192
    v_mfma_f32_16x16x32_bf16 v[16:19], v[160:163], v[136:139], 0
    ds_read_b64_tr_b16 v[202:203], v235 offset:9216
    v_mfma_f32_16x16x32_bf16 v[20:23], v[164:167], v[136:139], 0
    ds_read_b64_tr_b16 v[204:205], v236 offset:8192
    v_mfma_f32_16x16x32_bf16 v[24:27], v[168:171], v[136:139], 0
    v_mfma_f32_16x16x32_bf16 v[28:31], v[172:175], v[136:139], 0
    ds_read_b64_tr_b16 v[206:207], v236 offset:9216
    v_mfma_f32_16x16x32_bf16 v[32:35], v[176:179], v[136:139], 0
    ds_read_b64_tr_b16 v[208:209], v237 offset:8192
    v_mfma_f32_16x16x32_bf16 v[36:39], v[180:183], v[136:139], 0
    ds_read_b64_tr_b16 v[210:211], v237 offset:9216
    v_mfma_f32_16x16x32_bf16 v[40:43], v[152:155], v[140:143], 0
    ds_read_b64_tr_b16 v[212:213], v238 offset:8192
    v_mfma_f32_16x16x32_bf16 v[44:47], v[156:159], v[140:143], 0
    v_mfma_f32_16x16x32_bf16 v[48:51], v[160:163], v[140:143], 0
    ds_read_b64_tr_b16 v[214:215], v238 offset:9216
    v_mfma_f32_16x16x32_bf16 v[52:55], v[164:167], v[140:143], 0
    ds_read_b64_tr_b16 v[216:217], v235 offset:24576
    v_mfma_f32_16x16x32_bf16 v[56:59], v[168:171], v[140:143], 0
    ds_read_b64_tr_b16 v[218:219], v235 offset:25600
    v_mfma_f32_16x16x32_bf16 v[60:63], v[172:175], v[140:143], 0
    ds_read_b64_tr_b16 v[220:221], v236 offset:24576
    v_mfma_f32_16x16x32_bf16 v[64:67], v[176:179], v[140:143], 0
    v_mfma_f32_16x16x32_bf16 v[68:71], v[180:183], v[140:143], 0
    ds_read_b64_tr_b16 v[222:223], v236 offset:25600
    v_mfma_f32_16x16x32_bf16 v[72:75], v[152:155], v[144:147], 0
    ds_read_b64_tr_b16 v[224:225], v237 offset:24576
    v_mfma_f32_16x16x32_bf16 v[76:79], v[156:159], v[144:147], 0
    ds_read_b64_tr_b16 v[226:227], v237 offset:25600
    v_mfma_f32_16x16x32_bf16 v[80:83], v[160:163], v[144:147], 0
    ds_read_b64_tr_b16 v[228:229], v238 offset:24576
    v_mfma_f32_16x16x32_bf16 v[84:87], v[164:167], v[144:147], 0
    v_mfma_f32_16x16x32_bf16 v[88:91], v[168:171], v[144:147], 0
    ds_read_b64_tr_b16 v[230:231], v238 offset:25600
    v_mfma_f32_16x16x32_bf16 v[92:95], v[172:175], v[144:147], 0
    ds_read_b128 v[188:191], v232 offset:2048
    v_mfma_f32_16x16x32_bf16 v[96:99], v[176:179], v[144:147], 0
    ds_read_b128 v[192:195], v232 offset:4096
    v_mfma_f32_16x16x32_bf16 v[100:103], v[180:183], v[144:147], 0
    ds_read_b128 v[196:199], v232 offset:6144
    v_mfma_f32_16x16x32_bf16 v[104:107], v[152:155], v[148:151], 0
    v_mfma_f32_16x16x32_bf16 v[108:111], v[156:159], v[148:151], 0
    v_add_u32 v232, s65, v233
    v_mfma_f32_16x16x32_bf16 v[112:115], v[160:163], v[148:151], 0
    v_add_u32 v235, s65, v239
    v_mfma_f32_16x16x32_bf16 v[116:119], v[164:167], v[148:151], 0
    v_add_u32 v236, s65, v240
    v_mfma_f32_16x16x32_bf16 v[120:123], v[168:171], v[148:151], 0
    v_mfma_f32_16x16x32_bf16 v[124:127], v[172:175], v[148:151], 0
    v_add_u32 v237, s65, v241
    v_mfma_f32_16x16x32_bf16 v[128:131], v[176:179], v[148:151], 0
    v_add_u32 v238, s65, v242
    v_mfma_f32_16x16x32_bf16 v[132:135], v[180:183], v[148:151], 0
    s_waitcnt lgkmcnt(0)
    v_mfma_f32_16x16x32_bf16 v[8:11], v[200:203], v[184:187], v[8:11]
    s_barrier
    v_mfma_f32_16x16x32_bf16 v[12:15], v[204:207], v[184:187], v[12:15]
    ds_read_b128 v[136:139], v232 offset:0
    v_mfma_f32_16x16x32_bf16 v[16:19], v[208:211], v[184:187], v[16:19]
    ds_read_b64_tr_b16 v[152:153], v235 offset:0
    v_mfma_f32_16x16x32_bf16 v[20:23], v[212:215], v[184:187], v[20:23]
    ds_read_b64_tr_b16 v[154:155], v235 offset:1024
    v_mfma_f32_16x16x32_bf16 v[24:27], v[216:219], v[184:187], v[24:27]
    ds_read_b64_tr_b16 v[156:157], v236 offset:0
    v_mfma_f32_16x16x32_bf16 v[28:31], v[220:223], v[184:187], v[28:31]
    ds_read_b64_tr_b16 v[158:159], v236 offset:1024
    v_mfma_f32_16x16x32_bf16 v[32:35], v[224:227], v[184:187], v[32:35]
    v_mfma_f32_16x16x32_bf16 v[36:39], v[228:231], v[184:187], v[36:39]
    ds_read_b64_tr_b16 v[160:161], v237 offset:0
    v_mfma_f32_16x16x32_bf16 v[40:43], v[200:203], v[188:191], v[40:43]
    ds_read_b64_tr_b16 v[162:163], v237 offset:1024
    v_mfma_f32_16x16x32_bf16 v[44:47], v[204:207], v[188:191], v[44:47]
    ds_read_b64_tr_b16 v[164:165], v238 offset:0
    v_mfma_f32_16x16x32_bf16 v[48:51], v[208:211], v[188:191], v[48:51]
    ds_read_b64_tr_b16 v[166:167], v238 offset:1024
    v_mfma_f32_16x16x32_bf16 v[52:55], v[212:215], v[188:191], v[52:55]
    ds_read_b64_tr_b16 v[168:169], v235 offset:16384
    v_mfma_f32_16x16x32_bf16 v[56:59], v[216:219], v[188:191], v[56:59]
    v_mfma_f32_16x16x32_bf16 v[60:63], v[220:223], v[188:191], v[60:63]
    ds_read_b64_tr_b16 v[170:171], v235 offset:17408
    v_mfma_f32_16x16x32_bf16 v[64:67], v[224:227], v[188:191], v[64:67]
    ds_read_b64_tr_b16 v[172:173], v236 offset:16384
    v_mfma_f32_16x16x32_bf16 v[68:71], v[228:231], v[188:191], v[68:71]
    ds_read_b64_tr_b16 v[174:175], v236 offset:17408
    v_mfma_f32_16x16x32_bf16 v[72:75], v[200:203], v[192:195], v[72:75]
    ds_read_b64_tr_b16 v[176:177], v237 offset:16384
    v_mfma_f32_16x16x32_bf16 v[76:79], v[204:207], v[192:195], v[76:79]
    ds_read_b64_tr_b16 v[178:179], v237 offset:17408
    v_mfma_f32_16x16x32_bf16 v[80:83], v[208:211], v[192:195], v[80:83]
    v_mfma_f32_16x16x32_bf16 v[84:87], v[212:215], v[192:195], v[84:87]
    ds_read_b64_tr_b16 v[180:181], v238 offset:16384
    v_mfma_f32_16x16x32_bf16 v[88:91], v[216:219], v[192:195], v[88:91]
    ds_read_b64_tr_b16 v[182:183], v238 offset:17408
    v_mfma_f32_16x16x32_bf16 v[92:95], v[220:223], v[192:195], v[92:95]
    ds_read_b128 v[140:143], v232 offset:2048
    v_mfma_f32_16x16x32_bf16 v[96:99], v[224:227], v[192:195], v[96:99]
    ds_read_b128 v[144:147], v232 offset:4096
    v_mfma_f32_16x16x32_bf16 v[100:103], v[228:231], v[192:195], v[100:103]
    ds_read_b128 v[148:151], v232 offset:6144
    v_mfma_f32_16x16x32_bf16 v[104:107], v[200:203], v[196:199], v[104:107]
    v_mfma_f32_16x16x32_bf16 v[108:111], v[204:207], v[196:199], v[108:111]
    v_add_u32 v232, s65, v234
    v_mfma_f32_16x16x32_bf16 v[112:115], v[208:211], v[196:199], v[112:115]
    v_mfma_f32_16x16x32_bf16 v[116:119], v[212:215], v[196:199], v[116:119]
    v_mfma_f32_16x16x32_bf16 v[120:123], v[216:219], v[196:199], v[120:123]
    v_mfma_f32_16x16x32_bf16 v[124:127], v[220:223], v[196:199], v[124:127]
    v_mfma_f32_16x16x32_bf16 v[128:131], v[224:227], v[196:199], v[128:131]
    s_add_u32 s65, s65, 49152
    s_cmp_ge_u32 s65, 147456
    s_cselect_b32 s65, 0, s65
    v_mfma_f32_16x16x32_bf16 v[132:135], v[228:231], v[196:199], v[132:135]
    s_waitcnt lgkmcnt(0)
    v_mfma_f32_16x16x32_bf16 v[8:11], v[152:155], v[136:139], v[8:11]
    ds_read_b128 v[184:187], v232 offset:0
    v_mfma_f32_16x16x32_bf16 v[12:15], v[156:159], v[136:139], v[12:15]
    ds_read_b64_tr_b16 v[200:201], v235 offset:8192
    v_mfma_f32_16x16x32_bf16 v[16:19], v[160:163], v[136:139], v[16:19]
    ds_read_b64_tr_b16 v[202:203], v235 offset:9216
    v_mfma_f32_16x16x32_bf16 v[20:23], v[164:167], v[136:139], v[20:23]
    ds_read_b64_tr_b16 v[204:205], v236 offset:8192
    v_mfma_f32_16x16x32_bf16 v[24:27], v[168:171], v[136:139], v[24:27]
    v_mfma_f32_16x16x32_bf16 v[28:31], v[172:175], v[136:139], v[28:31]
    ds_read_b64_tr_b16 v[206:207], v236 offset:9216
    v_mfma_f32_16x16x32_bf16 v[32:35], v[176:179], v[136:139], v[32:35]
    ds_read_b64_tr_b16 v[208:209], v237 offset:8192
    v_mfma_f32_16x16x32_bf16 v[36:39], v[180:183], v[136:139], v[36:39]
    ds_read_b64_tr_b16 v[210:211], v237 offset:9216
    v_mfma_f32_16x16x32_bf16 v[40:43], v[152:155], v[140:143], v[40:43]
    ds_read_b64_tr_b16 v[212:213], v238 offset:8192
    v_mfma_f32_16x16x32_bf16 v[44:47], v[156:159], v[140:143], v[44:47]
    v_mfma_f32_16x16x32_bf16 v[48:51], v[160:163], v[140:143], v[48:51]
    ds_read_b64_tr_b16 v[214:215], v238 offset:9216
    v_mfma_f32_16x16x32_bf16 v[52:55], v[164:167], v[140:143], v[52:55]
    ds_read_b64_tr_b16 v[216:217], v235 offset:24576
    v_mfma_f32_16x16x32_bf16 v[56:59], v[168:171], v[140:143], v[56:59]
    ds_read_b64_tr_b16 v[218:219], v235 offset:25600
    v_mfma_f32_16x16x32_bf16 v[60:63], v[172:175], v[140:143], v[60:63]
    ds_read_b64_tr_b16 v[220:221], v236 offset:24576
    v_mfma_f32_16x16x32_bf16 v[64:67], v[176:179], v[140:143], v[64:67]
    v_mfma_f32_16x16x32_bf16 v[68:71], v[180:183], v[140:143], v[68:71]
    ds_read_b64_tr_b16 v[222:223], v236 offset:25600
    v_mfma_f32_16x16x32_bf16 v[72:75], v[152:155], v[144:147], v[72:75]
    s_movk_i32 s67, 13
gd_kernel_P_loop0:
    ds_read_b64_tr_b16 v[224:225], v237 offset:24576
    v_mfma_f32_16x16x32_bf16 v[76:79], v[156:159], v[144:147], v[76:79]
    ds_read_b64_tr_b16 v[226:227], v237 offset:25600
    v_mfma_f32_16x16x32_bf16 v[80:83], v[160:163], v[144:147], v[80:83]
    ds_read_b64_tr_b16 v[228:229], v238 offset:24576
    v_mfma_f32_16x16x32_bf16 v[84:87], v[164:167], v[144:147], v[84:87]
    v_mfma_f32_16x16x32_bf16 v[88:91], v[168:171], v[144:147], v[88:91]
    ds_read_b64_tr_b16 v[230:231], v238 offset:25600
    v_mfma_f32_16x16x32_bf16 v[92:95], v[172:175], v[144:147], v[92:95]
    ds_read_b128 v[188:191], v232 offset:2048
    v_mfma_f32_16x16x32_bf16 v[96:99], v[176:179], v[144:147], v[96:99]
    ds_read_b128 v[192:195], v232 offset:4096
    v_mfma_f32_16x16x32_bf16 v[100:103], v[180:183], v[144:147], v[100:103]
    ds_read_b128 v[196:199], v232 offset:6144
    v_mfma_f32_16x16x32_bf16 v[104:107], v[152:155], v[148:151], v[104:107]
    v_mfma_f32_16x16x32_bf16 v[108:111], v[156:159], v[148:151], v[108:111]
    v_add_u32 v232, s65, v233
    v_mfma_f32_16x16x32_bf16 v[112:115], v[160:163], v[148:151], v[112:115]
    v_add_u32 v235, s65, v239
    v_mfma_f32_16x16x32_bf16 v[116:119], v[164:167], v[148:151], v[116:119]
    v_add_u32 v236, s65, v240
    v_mfma_f32_16x16x32_bf16 v[120:123], v[168:171], v[148:151], v[120:123]
    v_mfma_f32_16x16x32_bf16 v[124:127], v[172:175], v[148:151], v[124:127]
    v_add_u32 v237, s65, v241
    v_mfma_f32_16x16x32_bf16 v[128:131], v[176:179], v[148:151], v[128:131]
    v_add_u32 v238, s65, v242
    v_mfma_f32_16x16x32_bf16 v[132:135], v[180:183], v[148:151], v[132:135]
    s_waitcnt lgkmcnt(0)
    v_mfma_f32_16x16x32_bf16 v[8:11], v[200:203], v[184:187], v[8:11]
    s_barrier
    v_mfma_f32_16x16x32_bf16 v[12:15], v[204:207], v[184:187], v[12:15]
    ds_read_b128 v[136:139], v232 offset:0
    v_mfma_f32_16x16x32_bf16 v[16:19], v[208:211], v[184:187], v[16:19]
    ds_read_b64_tr_b16 v[152:153], v235 offset:0
    v_mfma_f32_16x16x32_bf16 v[20:23], v[212:215], v[184:187], v[20:23]
    ds_read_b64_tr_b16 v[154:155], v235 offset:1024
    v_mfma_f32_16x16x32_bf16 v[24:27], v[216:219], v[184:187], v[24:27]
    ds_read_b64_tr_b16 v[156:157], v236 offset:0
    v_mfma_f32_16x16x32_bf16 v[28:31], v[220:223], v[184:187], v[28:31]
    ds_read_b64_tr_b16 v[158:159], v236 offset:1024
    v_mfma_f32_16x16x32_bf16 v[32:35], v[224:227], v[184:187], v[32:35]
    v_mfma_f32_16x16x32_bf16 v[36:39], v[228:231], v[184:187], v[36:39]
    ds_read_b64_tr_b16 v[160:161], v237 offset:0
    v_mfma_f32_16x16x32_bf16 v[40:43], v[200:203], v[188:191], v[40:43]
    ds_read_b64_tr_b16 v[162:163], v237 offset:1024
    v_mfma_f32_16x16x32_bf16 v[44:47], v[204:207], v[188:191], v[44:47]
    ds_read_b64_tr_b16 v[164:165], v238 offset:0
    v_mfma_f32_16x16x32_bf16 v[48:51], v[208:211], v[188:191], v[48:51]
    ds_read_b64_tr_b16 v[166:167], v238 offset:1024
    v_mfma_f32_16x16x32_bf16 v[52:55], v[212:215], v[188:191], v[52:55]
    ds_read_b64_tr_b16 v[168:169], v235 offset:16384
    v_mfma_f32_16x16x32_bf16 v[56:59], v[216:219], v[188:191], v[56:59]
    v_mfma_f32_16x16x32_bf16 v[60:63], v[220:223], v[188:191], v[60:63]
    ds_read_b64_tr_b16 v[170:171], v235 offset:17408
    v_mfma_f32_16x16x32_bf16 v[64:67], v[224:227], v[188:191], v[64:67]
    ds_read_b64_tr_b16 v[172:173], v236 offset:16384
    v_mfma_f32_16x16x32_bf16 v[68:71], v[228:231], v[188:191], v[68:71]
    ds_read_b64_tr_b16 v[174:175], v236 offset:17408
    v_mfma_f32_16x16x32_bf16 v[72:75], v[200:203], v[192:195], v[72:75]
    ds_read_b64_tr_b16 v[176:177], v237 offset:16384
    v_mfma_f32_16x16x32_bf16 v[76:79], v[204:207], v[192:195], v[76:79]
    ds_read_b64_tr_b16 v[178:179], v237 offset:17408
    v_mfma_f32_16x16x32_bf16 v[80:83], v[208:211], v[192:195], v[80:83]
    v_mfma_f32_16x16x32_bf16 v[84:87], v[212:215], v[192:195], v[84:87]
    ds_read_b64_tr_b16 v[180:181], v238 offset:16384
    v_mfma_f32_16x16x32_bf16 v[88:91], v[216:219], v[192:195], v[88:91]
    ds_read_b64_tr_b16 v[182:183], v238 offset:17408
    v_mfma_f32_16x16x32_bf16 v[92:95], v[220:223], v[192:195], v[92:95]
    ds_read_b128 v[140:143], v232 offset:2048
    v_mfma_f32_16x16x32_bf16 v[96:99], v[224:227], v[192:195], v[96:99]
    ds_read_b128 v[144:147], v232 offset:4096
    v_mfma_f32_16x16x32_bf16 v[100:103], v[228:231], v[192:195], v[100:103]
    ds_read_b128 v[148:151], v232 offset:6144
    v_mfma_f32_16x16x32_bf16 v[104:107], v[200:203], v[196:199], v[104:107]
    v_mfma_f32_16x16x32_bf16 v[108:111], v[204:207], v[196:199], v[108:111]
    v_add_u32 v232, s65, v234
    v_mfma_f32_16x16x32_bf16 v[112:115], v[208:211], v[196:199], v[112:115]
    v_mfma_f32_16x16x32_bf16 v[116:119], v[212:215], v[196:199], v[116:119]
    v_mfma_f32_16x16x32_bf16 v[120:123], v[216:219], v[196:199], v[120:123]
    v_mfma_f32_16x16x32_bf16 v[124:127], v[220:223], v[196:199], v[124:127]
    v_mfma_f32_16x16x32_bf16 v[128:131], v[224:227], v[196:199], v[128:131]
    s_add_u32 s65, s65, 49152
    s_cmp_ge_u32 s65, 147456
    s_cselect_b32 s65, 0, s65
    v_mfma_f32_16x16x32_bf16 v[132:135], v[228:231], v[196:199], v[132:135]
    s_waitcnt lgkmcnt(0)
    v_mfma_f32_16x16x32_bf16 v[8:11], v[152:155], v[136:139], v[8:11]
    ds_read_b128 v[184:187], v232 offset:0
    v_mfma_f32_16x16x32_bf16 v[12:15], v[156:159], v[136:139], v[12:15]
    ds_read_b64_tr_b16 v[200:201], v235 offset:8192
    v_mfma_f32_16x16x32_bf16 v[16:19], v[160:163], v[136:139], v[16:19]
    ds_read_b64_tr_b16 v[202:203], v235 offset:9216
    v_mfma_f32_16x16x32_bf16 v[20:23], v[164:167], v[136:139], v[20:23]
    ds_read_b64_tr_b16 v[204:205], v236 offset:8192
    v_mfma_f32_16x16x32_bf16 v[24:27], v[168:171], v[136:139], v[24:27]
    v_mfma_f32_16x16x32_bf16 v[28:31], v[172:175], v[136:139], v[28:31]
    ds_read_b64_tr_b16 v[206:207], v236 offset:9216
    v_mfma_f32_16x16x32_bf16 v[32:35], v[176:179], v[136:139], v[32:35]
    ds_read_b64_tr_b16 v[208:209], v237 offset:8192
    v_mfma_f32_16x16x32_bf16 v[36:39], v[180:183], v[136:139], v[36:39]
    ds_read_b64_tr_b16 v[210:211], v237 offset:9216
    v_mfma_f32_16x16x32_bf16 v[40:43], v[152:155], v[140:143], v[40:43]
    ds_read_b64_tr_b16 v[212:213], v238 offset:8192
    v_mfma_f32_16x16x32_bf16 v[44:47], v[156:159], v[140:143], v[44:47]
    v_mfma_f32_16x16x32_bf16 v[48:51], v[160:163], v[140:143], v[48:51]
    ds_read_b64_tr_b16 v[214:215], v238 offset:9216
    v_mfma_f32_16x16x32_bf16 v[52:55], v[164:167], v[140:143], v[52:55]
    ds_read_b64_tr_b16 v[216:217], v235 offset:24576
    v_mfma_f32_16x16x32_bf16 v[56:59], v[168:171], v[140:143], v[56:59]
    ds_read_b64_tr_b16 v[218:219], v235 offset:25600
    v_mfma_f32_16x16x32_bf16 v[60:63], v[172:175], v[140:143], v[60:63]
    ds_read_b64_tr_b16 v[220:221], v236 offset:24576
    v_mfma_f32_16x16x32_bf16 v[64:67], v[176:179], v[140:143], v[64:67]
    v_mfma_f32_16x16x32_bf16 v[68:71], v[180:183], v[140:143], v[68:71]
    s_sub_u32 s67, s67, 1
    ds_read_b64_tr_b16 v[222:223], v236 offset:25600
    v_mfma_f32_16x16x32_bf16 v[72:75], v[152:155], v[144:147], v[72:75]
    s_cbranch_scc0 gd_kernel_P_loop0
    ds_read_b64_tr_b16 v[224:225], v237 offset:24576
    v_mfma_f32_16x16x32_bf16 v[76:79], v[156:159], v[144:147], v[76:79]
    ds_read_b64_tr_b16 v[226:227], v237 offset:25600
    v_mfma_f32_16x16x32_bf16 v[80:83], v[160:163], v[144:147], v[80:83]
    ds_read_b64_tr_b16 v[228:229], v238 offset:24576
    v_mfma_f32_16x16x32_bf16 v[84:87], v[164:167], v[144:147], v[84:87]
    v_mfma_f32_16x16x32_bf16 v[88:91], v[168:171], v[144:147], v[88:91]
    ds_read_b64_tr_b16 v[230:231], v238 offset:25600
    v_mfma_f32_16x16x32_bf16 v[92:95], v[172:175], v[144:147], v[92:95]
    ds_read_b128 v[188:191], v232 offset:2048
    v_mfma_f32_16x16x32_bf16 v[96:99], v[176:179], v[144:147], v[96:99]
    ds_read_b128 v[192:195], v232 offset:4096
    v_mfma_f32_16x16x32_bf16 v[100:103], v[180:183], v[144:147], v[100:103]
    ds_read_b128 v[196:199], v232 offset:6144
    v_mfma_f32_16x16x32_bf16 v[104:107], v[152:155], v[148:151], v[104:107]
    v_mfma_f32_16x16x32_bf16 v[108:111], v[156:159], v[148:151], v[108:111]
    v_mfma_f32_16x16x32_bf16 v[112:115], v[160:163], v[148:151], v[112:115]
    v_mfma_f32_16x16x32_bf16 v[116:119], v[164:167], v[148:151], v[116:119]
    v_mfma_f32_16x16x32_bf16 v[120:123], v[168:171], v[148:151], v[120:123]
    v_mfma_f32_16x16x32_bf16 v[124:127], v[172:175], v[148:151], v[124:127]
    v_mfma_f32_16x16x32_bf16 v[128:131], v[176:179], v[148:151], v[128:131]
    v_mfma_f32_16x16x32_bf16 v[132:135], v[180:183], v[148:151], v[132:135]
    s_waitcnt lgkmcnt(0)
    v_mfma_f32_16x16x32_bf16 v[8:11], v[200:203], v[184:187], v[8:11]
    s_barrier
    v_mfma_f32_16x16x32_bf16 v[12:15], v[204:207], v[184:187], v[12:15]
    v_mfma_f32_16x16x32_bf16 v[16:19], v[208:211], v[184:187], v[16:19]
    v_mfma_f32_16x16x32_bf16 v[20:23], v[212:215], v[184:187], v[20:23]
    v_mfma_f32_16x16x32_bf16 v[24:27], v[216:219], v[184:187], v[24:27]
    v_mfma_f32_16x16x32_bf16 v[28:31], v[220:223], v[184:187], v[28:31]
    v_mfma_f32_16x16x32_bf16 v[32:35], v[224:227], v[184:187], v[32:35]
    v_mfma_f32_16x16x32_bf16 v[36:39], v[228:231], v[184:187], v[36:39]
    v_mfma_f32_16x16x32_bf16 v[40:43], v[200:203], v[188:191], v[40:43]
    v_mfma_f32_16x16x32_bf16 v[44:47], v[204:207], v[188:191], v[44:47]
    v_mfma_f32_16x16x32_bf16 v[48:51], v[208:211], v[188:191], v[48:51]
    v_mfma_f32_16x16x32_bf16 v[52:55], v[212:215], v[188:191], v[52:55]
    v_mfma_f32_16x16x32_bf16 v[56:59], v[216:219], v[188:191], v[56:59]
    v_mfma_f32_16x16x32_bf16 v[60:63], v[220:223], v[188:191], v[60:63]
    v_mfma_f32_16x16x32_bf16 v[64:67], v[224:227], v[188:191], v[64:67]
    v_mfma_f32_16x16x32_bf16 v[68:71], v[228:231], v[188:191], v[68:71]
    v_mfma_f32_16x16x32_bf16 v[72:75], v[200:203], v[192:195], v[72:75]
    v_mfma_f32_16x16x32_bf16 v[76:79], v[204:207], v[192:195], v[76:79]
    v_mfma_f32_16x16x32_bf16 v[80:83], v[208:211], v[192:195], v[80:83]
    v_mfma_f32_16x16x32_bf16 v[84:87], v[212:215], v[192:195], v[84:87]
    v_mfma_f32_16x16x32_bf16 v[88:91], v[216:219], v[192:195], v[88:91]
    v_mfma_f32_16x16x32_bf16 v[92:95], v[220:223], v[192:195], v[92:95]
    v_mfma_f32_16x16x32_bf16 v[96:99], v[224:227], v[192:195], v[96:99]
    v_mfma_f32_16x16x32_bf16 v[100:103], v[228:231], v[192:195], v[100:103]
    v_mfma_f32_16x16x32_bf16 v[104:107], v[200:203], v[196:199], v[104:107]
    v_mfma_f32_16x16x32_bf16 v[108:111], v[204:207], v[196:199], v[108:111]
    v_mfma_f32_16x16x32_bf16 v[112:115], v[208:211], v[196:199], v[112:115]
    v_mfma_f32_16x16x32_bf16 v[116:119], v[212:215], v[196:199], v[116:119]
    v_mfma_f32_16x16x32_bf16 v[120:123], v[216:219], v[196:199], v[120:123]
    v_mfma_f32_16x16x32_bf16 v[124:127], v[220:223], v[196:199], v[124:127]
    v_mfma_f32_16x16x32_bf16 v[128:131], v[224:227], v[196:199], v[128:131]
    v_mfma_f32_16x16x32_bf16 v[132:135], v[228:231], v[196:199], v[132:135]
    s_setprio 0
    s_lshl_b32 s77, s56, 5
    s_add_u32 s77, s77, s59
    v_and_b32 v4, 7, v1
    v_lshrrev_b32 v5, 3, v1
    s_movk_i32 s76, 2176
    v_lshrrev_b32 v3, 4, v1
    v_xor_b32 v3, v3, v4
    v_add_u32 v2, s77, v5
    v_mul_lo_u32 v2, s76, v2
    v_lshl_add_u32 v184, v3, 4, v2
    v_lshrrev_b32 v3, 4, v1
    v_or_b32 v3, 4, v3
    v_xor_b32 v3, v3, v4
    v_add_u32 v2, s77, v5
    v_add_u32 v2, 8, v2
    v_mul_lo_u32 v2, s76, v2
    v_lshl_add_u32 v185, v3, 4, v2
    v_lshrrev_b32 v3, 4, v1
    v_xor_b32 v3, v3, v4
    v_add_u32 v2, s77, v5
    v_add_u32 v2, 16, v2
    v_mul_lo_u32 v2, s76, v2
    v_lshl_add_u32 v186, v3, 4, v2
    v_lshrrev_b32 v3, 4, v1
    v_or_b32 v3, 4, v3
    v_xor_b32 v3, v3, v4
    v_add_u32 v2, s77, v5
    v_add_u32 v2, 24, v2
    v_mul_lo_u32 v2, s76, v2
    v_lshl_add_u32 v187, v3, 4, v2
    v_subrev_u32 v185, 1024, v185
    v_subrev_u32 v186, 2048, v186
    v_subrev_u32 v187, 3072, v187
    s_lshr_b32 s3, s60, 2
    s_sub_u32 s3, s60, s3
    s_add_u32 s3, s3, 16
    s_cmp_ge_u32 s2, 192
    s_lshl_b32 s77, s3, 8
    v_lshrrev_b32 v3, 4, v1
    s_lshl_b32 s76, s56, 3
    v_add_u32 v2, s76, v3
    s_and_b32 s76, s76, 8
    v_lshl_or_b32 v3, v3, 1, s76
    s_movk_i32 s76, 7168
    v_mul_u32_u24 v2, s76, v2
    v_add_u32 v2, s77, v2
    v_and_b32 v4, 15, v1
    v_xor_b32 v3, v3, v4
    v_lshl_add_u32 v188, v3, 4, v2
    v_add_u32 v189, 27648, v188
    s_cmp_ge_u32 s2, 192
    s_cselect_b32 s14, 0, s14
    s_cselect_b32 s18, 0, s18
    s_cselect_b32 s22, 0, s22
    s_add_u32 s71, s70, 147456
    s_add_u32 s66, s70, 49152
    s_bfe_u32 s38, s2, 0x30003
    s_lshr_b32 s39, s2, 6
    s_add_u32 s38, s38, s39
    s_mul_i32 s39, s38, 11
    s_lshr_b32 s39, s39, 5
    s_mul_i32 s39, s39, 3
    s_sub_u32 s38, s38, s39
    s_mov_b32 s36, 0x9a867534
    s_mov_b32 s37, 0xfecdb
    s_cmp_eq_u32 s38, 1
    s_cselect_b32 s36, 0xb9786453, s36
    s_cselect_b32 s37, 0xfdeca, s37
    s_cmp_eq_u32 s38, 2
    s_cselect_b32 s36, 0xa8975642, s36
    s_cselect_b32 s37, 0xefdbc, s37
    v_and_b32 v2, 15, v1
    v_lshlrev_b32 v2, 4, v2
    v_bfe_u32 v3, v1, 4, 1
    v_lshl_add_u32 v2, v3, 9, v2
    v_lshrrev_b32 v3, 5, v1
    v_lshl_add_u32 v198, v3, 8, v2
    s_lshr_b32 s76, s59, 4
    s_lshl_b32 s77, s57, 2
    s_add_u32 s76, s76, s77
    s_mul_i32 s76, s76, 114688
    s_lshl_b32 s77, s60, 12
    s_add_u32 s76, s76, s77
    s_lshl_b32 s77, s58, 11
    s_add_u32 s76, s76, s77
    v_add_u32 v198, s76, v198
    v_mul_f32 v216, s74, v8
    v_mul_f32 v217, s74, v9
    v_mul_f32 v218, s74, v10
    v_mul_f32 v219, s74, v11
    v_mul_f32 v220, s74, v12
    v_mul_f32 v221, s74, v13
    v_mul_f32 v222, s74, v14
    v_mul_f32 v223, s74, v15
    v_exp_f32 v216, v216
    v_exp_f32 v217, v217
    v_exp_f32 v218, v218
    v_exp_f32 v219, v219
    v_exp_f32 v220, v220
    v_exp_f32 v221, v221
    v_exp_f32 v222, v222
    v_exp_f32 v223, v223
    v_mul_f32 v8, v8, v24
    v_mul_f32 v9, v9, v25
    v_mul_f32 v10, v10, v26
    v_mul_f32 v11, v11, v27
    s_barrier
    s_and_b32 s69, s36, 15
    s_lshr_b64 s[36:37], s[36:37], 4
    s_lshl_b32 s68, s69, 7
    s_mul_i32 s69, s69, 0x70000
    s_add_u32 m0, s66, 16384
    s_nop 0
    buffer_load_dwordx4 v188, s[16:19], s69 offen offset:0 lds
    v_mul_f32 v12, v12, v28
    v_mul_f32 v13, v13, v29
    v_mul_f32 v14, v14, v30
    v_mul_f32 v15, v15, v31
    v_add_f32 v216, 1.0, v216
    buffer_load_dwordx4 v189, s[16:19], s69 offen offset:1024 lds
    v_add_f32 v217, 1.0, v217
    v_add_f32 v218, 1.0, v218
    v_add_f32 v219, 1.0, v219
    v_add_f32 v220, 1.0, v220
    v_add_f32 v221, 1.0, v221
    s_add_u32 m0, s66, 32768
    s_nop 0
    buffer_load_dwordx4 v188, s[20:23], s69 offen offset:0 lds
    v_add_f32 v222, 1.0, v222
    v_add_f32 v223, 1.0, v223
    v_rcp_f32 v216, v216
    v_rcp_f32 v217, v217
    v_rcp_f32 v218, v218
    buffer_load_dwordx4 v189, s[20:23], s69 offen offset:1024 lds
    v_rcp_f32 v219, v219
    v_rcp_f32 v220, v220
    v_rcp_f32 v221, v221
    v_rcp_f32 v222, v222
    v_rcp_f32 v223, v223
    s_add_u32 s69, s69, 0x38000
    s_add_u32 m0, s66, s70
    s_nop 0
    buffer_load_dwordx4 v184, s[12:15], s68 offen offset:0 lds
    v_mul_f32 v8, v8, v216
    v_mul_f32 v9, v9, v217
    v_mul_f32 v10, v10, v218
    v_mul_f32 v11, v11, v219
    v_mul_f32 v12, v12, v220
    buffer_load_dwordx4 v185, s[12:15], s68 offen offset:1024 lds
    v_mul_f32 v13, v13, v221
    v_mul_f32 v14, v14, v222
    v_mul_f32 v15, v15, v223
    v_cvt_pk_bf16_f32 v200, v8, v9
    v_cvt_pk_bf16_f32 v201, v10, v11
    buffer_load_dwordx4 v186, s[12:15], s68 offen offset:2048 lds
    v_cvt_pk_bf16_f32 v202, v12, v13
    v_cvt_pk_bf16_f32 v203, v14, v15
    s_nop 0
    v_permlane16_swap_b32 v200, v202
    v_permlane16_swap_b32 v201, v203
    buffer_load_dwordx4 v187, s[12:15], s68 offen offset:3072 lds
    v_mul_f32 v224, s74, v16
    v_mul_f32 v225, s74, v17
    v_mul_f32 v226, s74, v18
    v_mul_f32 v227, s74, v19
    v_mul_f32 v228, s74, v20
    s_add_u32 m0, s66, 24576
    s_nop 0
    buffer_load_dwordx4 v188, s[16:19], s69 offen offset:0 lds
    v_mul_f32 v229, s74, v21
    v_mul_f32 v230, s74, v22
    v_mul_f32 v231, s74, v23
    v_exp_f32 v224, v224
    v_exp_f32 v225, v225
    buffer_load_dwordx4 v189, s[16:19], s69 offen offset:1024 lds
    v_exp_f32 v226, v226
    v_exp_f32 v227, v227
    v_exp_f32 v228, v228
    v_exp_f32 v229, v229
    v_exp_f32 v230, v230
    s_add_u32 m0, s66, 40960
    s_nop 0
    buffer_load_dwordx4 v188, s[20:23], s69 offen offset:0 lds
    v_exp_f32 v231, v231
    v_mul_f32 v16, v16, v32
    v_mul_f32 v17, v17, v33
    v_mul_f32 v18, v18, v34
    v_mul_f32 v19, v19, v35
    buffer_load_dwordx4 v189, s[20:23], s69 offen offset:1024 lds
    v_mul_f32 v20, v20, v36
    v_mul_f32 v21, v21, v37
    v_mul_f32 v22, v22, v38
    v_mul_f32 v23, v23, v39
    v_add_f32 v224, 1.0, v224
    s_add_u32 s66, s66, 49152
    s_cmp_ge_u32 s66, s71
    s_cselect_b32 s66, s70, s66
    buffer_store_dwordx4 v[200:203], v198, s[24:27], 0 offen offset:0 sc1
    s_barrier
    s_and_b32 s69, s36, 15
    s_lshr_b64 s[36:37], s[36:37], 4
    s_lshl_b32 s68, s69, 7
    s_mul_i32 s69, s69, 0x70000
    s_add_u32 m0, s66, 16384
    s_nop 0
    buffer_load_dwordx4 v188, s[16:19], s69 offen offset:0 lds
    v_add_f32 v225, 1.0, v225
    v_add_f32 v226, 1.0, v226
    v_add_f32 v227, 1.0, v227
    v_add_f32 v228, 1.0, v228
    v_add_f32 v229, 1.0, v229
    buffer_load_dwordx4 v189, s[16:19], s69 offen offset:1024 lds
    v_add_f32 v230, 1.0, v230
    v_add_f32 v231, 1.0, v231
    v_rcp_f32 v224, v224
    v_rcp_f32 v225, v225
    v_rcp_f32 v226, v226
    s_add_u32 m0, s66, 32768
    s_nop 0
    buffer_load_dwordx4 v188, s[20:23], s69 offen offset:0 lds
    v_rcp_f32 v227, v227
    v_rcp_f32 v228, v228
    v_rcp_f32 v229, v229
    v_rcp_f32 v230, v230
    v_rcp_f32 v231, v231
    buffer_load_dwordx4 v189, s[20:23], s69 offen offset:1024 lds
    v_mul_f32 v16, v16, v224
    v_mul_f32 v17, v17, v225
    v_mul_f32 v18, v18, v226
    v_mul_f32 v19, v19, v227
    v_mul_f32 v20, v20, v228
    s_add_u32 s69, s69, 0x38000
    s_add_u32 m0, s66, s70
    s_nop 0
    buffer_load_dwordx4 v184, s[12:15], s68 offen offset:0 lds
    v_mul_f32 v21, v21, v229
    v_mul_f32 v22, v22, v230
    v_mul_f32 v23, v23, v231
    v_cvt_pk_bf16_f32 v204, v16, v17
    v_cvt_pk_bf16_f32 v205, v18, v19
    buffer_load_dwordx4 v185, s[12:15], s68 offen offset:1024 lds
    v_cvt_pk_bf16_f32 v206, v20, v21
    v_cvt_pk_bf16_f32 v207, v22, v23
    s_nop 0
    v_permlane16_swap_b32 v204, v206
    v_permlane16_swap_b32 v205, v207
    buffer_load_dwordx4 v186, s[12:15], s68 offen offset:2048 lds
    v_mul_f32 v216, s74, v40
    v_mul_f32 v217, s74, v41
    v_mul_f32 v218, s74, v42
    v_mul_f32 v219, s74, v43
    buffer_load_dwordx4 v187, s[12:15], s68 offen offset:3072 lds
    v_mul_f32 v220, s74, v44
    v_mul_f32 v221, s74, v45
    v_mul_f32 v222, s74, v46
    v_mul_f32 v223, s74, v47
    v_exp_f32 v216, v216
    s_add_u32 m0, s66, 24576
    s_nop 0
    buffer_load_dwordx4 v188, s[16:19], s69 offen offset:0 lds
    v_exp_f32 v217, v217
    v_exp_f32 v218, v218
    v_exp_f32 v219, v219
    v_exp_f32 v220, v220
    v_exp_f32 v221, v221
    buffer_load_dwordx4 v189, s[16:19], s69 offen offset:1024 lds
    v_exp_f32 v222, v222
    v_exp_f32 v223, v223
    v_mul_f32 v40, v40, v56
    v_mul_f32 v41, v41, v57
    v_mul_f32 v42, v42, v58
    s_add_u32 m0, s66, 40960
    s_nop 0
    buffer_load_dwordx4 v188, s[20:23], s69 offen offset:0 lds
    v_mul_f32 v43, v43, v59
    v_mul_f32 v44, v44, v60
    v_mul_f32 v45, v45, v61
    v_mul_f32 v46, v46, v62
    v_mul_f32 v47, v47, v63
    buffer_load_dwordx4 v189, s[20:23], s69 offen offset:1024 lds
    v_add_f32 v216, 1.0, v216
    v_add_f32 v217, 1.0, v217
    v_add_f32 v218, 1.0, v218
    v_add_f32 v219, 1.0, v219
    v_add_f32 v220, 1.0, v220
    s_add_u32 s66, s66, 49152
    s_cmp_ge_u32 s66, s71
    s_cselect_b32 s66, s70, s66
    buffer_store_dwordx4 v[204:207], v198, s[24:27], 0 offen offset:1024 sc1
    v_add_u32 v198, 114688, v198
    s_waitcnt vmcnt(14)
    s_barrier
    s_and_b32 s69, s36, 15
    s_lshr_b64 s[36:37], s[36:37], 4
    s_lshl_b32 s68, s69, 7
    s_mul_i32 s69, s69, 0x70000
    s_add_u32 m0, s66, 16384
    s_nop 0
    buffer_load_dwordx4 v188, s[16:19], s69 offen offset:0 lds
    v_add_f32 v221, 1.0, v221
    v_add_f32 v222, 1.0, v222
    v_add_f32 v223, 1.0, v223
    v_rcp_f32 v216, v216
    v_rcp_f32 v217, v217
    buffer_load_dwordx4 v189, s[16:19], s69 offen offset:1024 lds
    v_rcp_f32 v218, v218
    v_rcp_f32 v219, v219
    v_rcp_f32 v220, v220
    v_rcp_f32 v221, v221
    v_rcp_f32 v222, v222
    s_add_u32 m0, s66, 32768
    s_nop 0
    buffer_load_dwordx4 v188, s[20:23], s69 offen offset:0 lds
    v_rcp_f32 v223, v223
    v_mul_f32 v40, v40, v216
    v_mul_f32 v41, v41, v217
    v_mul_f32 v42, v42, v218
    v_mul_f32 v43, v43, v219
    buffer_load_dwordx4 v189, s[20:23], s69 offen offset:1024 lds
    v_mul_f32 v44, v44, v220
    v_mul_f32 v45, v45, v221
    v_mul_f32 v46, v46, v222
    v_mul_f32 v47, v47, v223
    v_cvt_pk_bf16_f32 v208, v40, v41
    s_add_u32 s69, s69, 0x38000
    s_add_u32 m0, s66, s70
    s_nop 0
    buffer_load_dwordx4 v184, s[12:15], s68 offen offset:0 lds
    v_cvt_pk_bf16_f32 v209, v42, v43
    v_cvt_pk_bf16_f32 v210, v44, v45
    v_cvt_pk_bf16_f32 v211, v46, v47
    s_nop 0
    v_permlane16_swap_b32 v208, v210
    v_permlane16_swap_b32 v209, v211
    buffer_load_dwordx4 v185, s[12:15], s68 offen offset:1024 lds
    v_mul_f32 v224, s74, v48
    v_mul_f32 v225, s74, v49
    v_mul_f32 v226, s74, v50
    v_mul_f32 v227, s74, v51
    buffer_load_dwordx4 v186, s[12:15], s68 offen offset:2048 lds
    v_mul_f32 v228, s74, v52
    v_mul_f32 v229, s74, v53
    v_mul_f32 v230, s74, v54
    v_mul_f32 v231, s74, v55
    v_exp_f32 v224, v224
    buffer_load_dwordx4 v187, s[12:15], s68 offen offset:3072 lds
    v_exp_f32 v225, v225
    v_exp_f32 v226, v226
    v_exp_f32 v227, v227
    v_exp_f32 v228, v228
    v_exp_f32 v229, v229
    s_add_u32 m0, s66, 24576
    s_nop 0
    buffer_load_dwordx4 v188, s[16:19], s69 offen offset:0 lds
    v_exp_f32 v230, v230
    v_exp_f32 v231, v231
    v_mul_f32 v48, v48, v64
    v_mul_f32 v49, v49, v65
    v_mul_f32 v50, v50, v66
    buffer_load_dwordx4 v189, s[16:19], s69 offen offset:1024 lds
    v_mul_f32 v51, v51, v67
    v_mul_f32 v52, v52, v68
    v_mul_f32 v53, v53, v69
    v_mul_f32 v54, v54, v70
    v_mul_f32 v55, v55, v71
    s_add_u32 m0, s66, 40960
    s_nop 0
    buffer_load_dwordx4 v188, s[20:23], s69 offen offset:0 lds
    v_add_f32 v224, 1.0, v224
    v_add_f32 v225, 1.0, v225
    v_add_f32 v226, 1.0, v226
    v_add_f32 v227, 1.0, v227
    v_add_f32 v228, 1.0, v228
    buffer_load_dwordx4 v189, s[20:23], s69 offen offset:1024 lds
    v_add_f32 v229, 1.0, v229
    v_add_f32 v230, 1.0, v230
    v_add_f32 v231, 1.0, v231
    v_rcp_f32 v224, v224
    v_rcp_f32 v225, v225
    s_add_u32 s66, s66, 49152
    s_cmp_ge_u32 s66, s71
    s_cselect_b32 s66, s70, s66
    buffer_store_dwordx4 v[208:211], v198, s[24:27], 0 offen offset:0 sc1
    s_waitcnt vmcnt(14)
    s_barrier
    s_and_b32 s69, s36, 15
    s_lshr_b64 s[36:37], s[36:37], 4
    s_lshl_b32 s68, s69, 7
    s_mul_i32 s69, s69, 0x70000
    s_add_u32 m0, s66, 16384
    s_nop 0
    buffer_load_dwordx4 v188, s[16:19], s69 offen offset:0 lds
    v_rcp_f32 v226, v226
    v_rcp_f32 v227, v227
    v_rcp_f32 v228, v228
    v_rcp_f32 v229, v229
    v_rcp_f32 v230, v230
    buffer_load_dwordx4 v189, s[16:19], s69 offen offset:1024 lds
    v_rcp_f32 v231, v231
    v_mul_f32 v48, v48, v224
    v_mul_f32 v49, v49, v225
    v_mul_f32 v50, v50, v226
    v_mul_f32 v51, v51, v227
    s_add_u32 m0, s66, 32768
    s_nop 0
    buffer_load_dwordx4 v188, s[20:23], s69 offen offset:0 lds
    v_mul_f32 v52, v52, v228
    v_mul_f32 v53, v53, v229
    v_mul_f32 v54, v54, v230
    v_mul_f32 v55, v55, v231
    v_cvt_pk_bf16_f32 v212, v48, v49
    buffer_load_dwordx4 v189, s[20:23], s69 offen offset:1024 lds
    v_cvt_pk_bf16_f32 v213, v50, v51
    v_cvt_pk_bf16_f32 v214, v52, v53
    v_cvt_pk_bf16_f32 v215, v54, v55
    s_nop 0
    v_permlane16_swap_b32 v212, v214
    v_permlane16_swap_b32 v213, v215
    s_add_u32 s69, s69, 0x38000
    s_add_u32 m0, s66, s70
    s_nop 0
    buffer_load_dwordx4 v184, s[12:15], s68 offen offset:0 lds
    v_mul_f32 v216, s74, v72
    v_mul_f32 v217, s74, v73
    v_mul_f32 v218, s74, v74
    buffer_load_dwordx4 v185, s[12:15], s68 offen offset:1024 lds
    v_mul_f32 v219, s74, v75
    v_mul_f32 v220, s74, v76
    v_mul_f32 v221, s74, v77
    v_mul_f32 v222, s74, v78
    v_mul_f32 v223, s74, v79
    buffer_load_dwordx4 v186, s[12:15], s68 offen offset:2048 lds
    v_exp_f32 v216, v216
    v_exp_f32 v217, v217
    v_exp_f32 v218, v218
    v_exp_f32 v219, v219
    v_exp_f32 v220, v220
    buffer_load_dwordx4 v187, s[12:15], s68 offen offset:3072 lds
    v_exp_f32 v221, v221
    v_exp_f32 v222, v222
    v_exp_f32 v223, v223
    v_mul_f32 v72, v72, v88
    v_mul_f32 v73, v73, v89
    s_add_u32 m0, s66, 24576
    s_nop 0
    buffer_load_dwordx4 v188, s[16:19], s69 offen offset:0 lds
    v_mul_f32 v74, v74, v90
    v_mul_f32 v75, v75, v91
    v_mul_f32 v76, v76, v92
    v_mul_f32 v77, v77, v93
    v_mul_f32 v78, v78, v94
    buffer_load_dwordx4 v189, s[16:19], s69 offen offset:1024 lds
    v_mul_f32 v79, v79, v95
    v_add_f32 v216, 1.0, v216
    v_add_f32 v217, 1.0, v217
    v_add_f32 v218, 1.0, v218
    v_add_f32 v219, 1.0, v219
    s_add_u32 m0, s66, 40960
    s_nop 0
    buffer_load_dwordx4 v188, s[20:23], s69 offen offset:0 lds
    v_add_f32 v220, 1.0, v220
    v_add_f32 v221, 1.0, v221
    v_add_f32 v222, 1.0, v222
    v_add_f32 v223, 1.0, v223
    v_rcp_f32 v216, v216
    buffer_load_dwordx4 v189, s[20:23], s69 offen offset:1024 lds
    v_rcp_f32 v217, v217
    v_rcp_f32 v218, v218
    v_rcp_f32 v219, v219
    v_rcp_f32 v220, v220
    v_rcp_f32 v221, v221
    s_add_u32 s66, s66, 49152
    s_cmp_ge_u32 s66, s71
    s_cselect_b32 s66, s70, s66
    buffer_store_dwordx4 v[212:215], v198, s[24:27], 0 offen offset:1024 sc1
    v_add_u32 v198, 114688, v198
    s_waitcnt vmcnt(14)
    s_barrier
    s_and_b32 s69, s36, 15
    s_lshr_b64 s[36:37], s[36:37], 4
    s_lshl_b32 s68, s69, 7
    s_mul_i32 s69, s69, 0x70000
    s_add_u32 m0, s66, 16384
    s_nop 0
    buffer_load_dwordx4 v188, s[16:19], s69 offen offset:0 lds
    v_rcp_f32 v222, v222
    v_rcp_f32 v223, v223
    v_mul_f32 v72, v72, v216
    v_mul_f32 v73, v73, v217
    v_mul_f32 v74, v74, v218
    buffer_load_dwordx4 v189, s[16:19], s69 offen offset:1024 lds
    v_mul_f32 v75, v75, v219
    v_mul_f32 v76, v76, v220
    v_mul_f32 v77, v77, v221
    v_mul_f32 v78, v78, v222
    v_mul_f32 v79, v79, v223
    s_add_u32 m0, s66, 32768
    s_nop 0
    buffer_load_dwordx4 v188, s[20:23], s69 offen offset:0 lds
    v_cvt_pk_bf16_f32 v200, v72, v73
    v_cvt_pk_bf16_f32 v201, v74, v75
    v_cvt_pk_bf16_f32 v202, v76, v77
    v_cvt_pk_bf16_f32 v203, v78, v79
    s_nop 0
    v_permlane16_swap_b32 v200, v202
    buffer_load_dwordx4 v189, s[20:23], s69 offen offset:1024 lds
    v_permlane16_swap_b32 v201, v203
    v_mul_f32 v224, s74, v80
    v_mul_f32 v225, s74, v81
    v_mul_f32 v226, s74, v82
    s_add_u32 s69, s69, 0x38000
    s_add_u32 m0, s66, s70
    s_nop 0
    buffer_load_dwordx4 v184, s[12:15], s68 offen offset:0 lds
    v_mul_f32 v227, s74, v83
    v_mul_f32 v228, s74, v84
    v_mul_f32 v229, s74, v85
    v_mul_f32 v230, s74, v86
    v_mul_f32 v231, s74, v87
    buffer_load_dwordx4 v185, s[12:15], s68 offen offset:1024 lds
    v_exp_f32 v224, v224
    v_exp_f32 v225, v225
    v_exp_f32 v226, v226
    v_exp_f32 v227, v227
    v_exp_f32 v228, v228
    buffer_load_dwordx4 v186, s[12:15], s68 offen offset:2048 lds
    v_exp_f32 v229, v229
    v_exp_f32 v230, v230
    v_exp_f32 v231, v231
    v_mul_f32 v80, v80, v96
    v_mul_f32 v81, v81, v97
    buffer_load_dwordx4 v187, s[12:15], s68 offen offset:3072 lds
    v_mul_f32 v82, v82, v98
    v_mul_f32 v83, v83, v99
    v_mul_f32 v84, v84, v100
    v_mul_f32 v85, v85, v101
    v_mul_f32 v86, v86, v102
    s_add_u32 m0, s66, 24576
    s_nop 0
    buffer_load_dwordx4 v188, s[16:19], s69 offen offset:0 lds
    v_mul_f32 v87, v87, v103
    v_add_f32 v224, 1.0, v224
    v_add_f32 v225, 1.0, v225
    v_add_f32 v226, 1.0, v226
    v_add_f32 v227, 1.0, v227
    buffer_load_dwordx4 v189, s[16:19], s69 offen offset:1024 lds
    v_add_f32 v228, 1.0, v228
    v_add_f32 v229, 1.0, v229
    v_add_f32 v230, 1.0, v230
    v_add_f32 v231, 1.0, v231
    v_rcp_f32 v224, v224
    s_add_u32 m0, s66, 40960
    s_nop 0
    buffer_load_dwordx4 v188, s[20:23], s69 offen offset:0 lds
    v_rcp_f32 v225, v225
    v_rcp_f32 v226, v226
    v_rcp_f32 v227, v227
    v_rcp_f32 v228, v228
    v_rcp_f32 v229, v229
    buffer_load_dwordx4 v189, s[20:23], s69 offen offset:1024 lds
    v_rcp_f32 v230, v230
    v_rcp_f32 v231, v231
    v_mul_f32 v80, v80, v224
    v_mul_f32 v81, v81, v225
    v_mul_f32 v82, v82, v226
    s_add_u32 s66, s66, 49152
    s_cmp_ge_u32 s66, s71
    s_cselect_b32 s66, s70, s66
    buffer_store_dwordx4 v[200:203], v198, s[24:27], 0 offen offset:0 sc1
    s_waitcnt vmcnt(14)
    s_barrier
    s_and_b32 s69, s36, 15
    s_lshr_b64 s[36:37], s[36:37], 4
    s_lshl_b32 s68, s69, 7
    s_mul_i32 s69, s69, 0x70000
    s_add_u32 m0, s66, 16384
    s_nop 0
    buffer_load_dwordx4 v188, s[16:19], s69 offen offset:0 lds
    v_mul_f32 v83, v83, v227
    v_mul_f32 v84, v84, v228
    v_mul_f32 v85, v85, v229
    v_mul_f32 v86, v86, v230
    v_mul_f32 v87, v87, v231
    buffer_load_dwordx4 v189, s[16:19], s69 offen offset:1024 lds
    v_cvt_pk_bf16_f32 v204, v80, v81
    v_cvt_pk_bf16_f32 v205, v82, v83
    v_cvt_pk_bf16_f32 v206, v84, v85
    v_cvt_pk_bf16_f32 v207, v86, v87
    s_nop 0
    v_permlane16_swap_b32 v204, v206
    s_add_u32 m0, s66, 32768
    s_nop 0
    buffer_load_dwordx4 v188, s[20:23], s69 offen offset:0 lds
    v_permlane16_swap_b32 v205, v207
    v_mul_f32 v216, s74, v104
    v_mul_f32 v217, s74, v105
    buffer_load_dwordx4 v189, s[20:23], s69 offen offset:1024 lds
    v_mul_f32 v218, s74, v106
    v_mul_f32 v219, s74, v107
    v_mul_f32 v220, s74, v108
    v_mul_f32 v221, s74, v109
    v_mul_f32 v222, s74, v110
    s_add_u32 s69, s69, 0x38000
    s_add_u32 m0, s66, s70
    s_nop 0
    buffer_load_dwordx4 v184, s[12:15], s68 offen offset:0 lds
    v_mul_f32 v223, s74, v111
    v_exp_f32 v216, v216
    v_exp_f32 v217, v217
    v_exp_f32 v218, v218
    v_exp_f32 v219, v219
    buffer_load_dwordx4 v185, s[12:15], s68 offen offset:1024 lds
    v_exp_f32 v220, v220
    v_exp_f32 v221, v221
    v_exp_f32 v222, v222
    v_exp_f32 v223, v223
    v_mul_f32 v104, v104, v120
    buffer_load_dwordx4 v186, s[12:15], s68 offen offset:2048 lds
    v_mul_f32 v105, v105, v121
    v_mul_f32 v106, v106, v122
    v_mul_f32 v107, v107, v123
    v_mul_f32 v108, v108, v124
    v_mul_f32 v109, v109, v125
    buffer_load_dwordx4 v187, s[12:15], s68 offen offset:3072 lds
    v_mul_f32 v110, v110, v126
    v_mul_f32 v111, v111, v127
    v_add_f32 v216, 1.0, v216
    v_add_f32 v217, 1.0, v217
    v_add_f32 v218, 1.0, v218
    s_add_u32 m0, s66, 24576
    s_nop 0
    buffer_load_dwordx4 v188, s[16:19], s69 offen offset:0 lds
    v_add_f32 v219, 1.0, v219
    v_add_f32 v220, 1.0, v220
    v_add_f32 v221, 1.0, v221
    v_add_f32 v222, 1.0, v222
    v_add_f32 v223, 1.0, v223
    buffer_load_dwordx4 v189, s[16:19], s69 offen offset:1024 lds
    v_rcp_f32 v216, v216
    v_rcp_f32 v217, v217
    v_rcp_f32 v218, v218
    v_rcp_f32 v219, v219
    v_rcp_f32 v220, v220
    s_add_u32 m0, s66, 40960
    s_nop 0
    buffer_load_dwordx4 v188, s[20:23], s69 offen offset:0 lds
    v_rcp_f32 v221, v221
    v_rcp_f32 v222, v222
    v_rcp_f32 v223, v223
    v_mul_f32 v104, v104, v216
    v_mul_f32 v105, v105, v217
    buffer_load_dwordx4 v189, s[20:23], s69 offen offset:1024 lds
    v_mul_f32 v106, v106, v218
    v_mul_f32 v107, v107, v219
    v_mul_f32 v108, v108, v220
    v_mul_f32 v109, v109, v221
    v_mul_f32 v110, v110, v222
    s_add_u32 s66, s66, 49152
    s_cmp_ge_u32 s66, s71
    s_cselect_b32 s66, s70, s66
    buffer_store_dwordx4 v[204:207], v198, s[24:27], 0 offen offset:1024 sc1
    v_add_u32 v198, 114688, v198
    s_waitcnt vmcnt(14)
    s_barrier
    s_and_b32 s69, s36, 15
    s_lshr_b64 s[36:37], s[36:37], 4
    s_lshl_b32 s68, s69, 7
    s_mul_i32 s69, s69, 0x70000
    s_add_u32 m0, s66, 16384
    s_nop 0
    buffer_load_dwordx4 v188, s[16:19], s69 offen offset:0 lds
    v_mul_f32 v111, v111, v223
    v_cvt_pk_bf16_f32 v208, v104, v105
    v_cvt_pk_bf16_f32 v209, v106, v107
    v_cvt_pk_bf16_f32 v210, v108, v109
    v_cvt_pk_bf16_f32 v211, v110, v111
    buffer_load_dwordx4 v189, s[16:19], s69 offen offset:1024 lds
    v_permlane16_swap_b32 v208, v210
    v_permlane16_swap_b32 v209, v211
    v_mul_f32 v224, s74, v112
    v_mul_f32 v225, s74, v113
    s_add_u32 m0, s66, 32768
    s_nop 0
    buffer_load_dwordx4 v188, s[20:23], s69 offen offset:0 lds
    v_mul_f32 v226, s74, v114
    v_mul_f32 v227, s74, v115
    v_mul_f32 v228, s74, v116
    v_mul_f32 v229, s74, v117
    v_mul_f32 v230, s74, v118
    buffer_load_dwordx4 v189, s[20:23], s69 offen offset:1024 lds
    v_mul_f32 v231, s74, v119
    v_exp_f32 v224, v224
    v_exp_f32 v225, v225
    v_exp_f32 v226, v226
    v_exp_f32 v227, v227
    s_add_u32 s69, s69, 0x38000
    s_add_u32 m0, s66, s70
    s_nop 0
    buffer_load_dwordx4 v184, s[12:15], s68 offen offset:0 lds
    v_exp_f32 v228, v228
    v_exp_f32 v229, v229
    v_exp_f32 v230, v230
    v_exp_f32 v231, v231
    v_mul_f32 v112, v112, v128
    buffer_load_dwordx4 v185, s[12:15], s68 offen offset:1024 lds
    v_mul_f32 v113, v113, v129
    v_mul_f32 v114, v114, v130
    v_mul_f32 v115, v115, v131
    v_mul_f32 v116, v116, v132
    v_mul_f32 v117, v117, v133
    buffer_load_dwordx4 v186, s[12:15], s68 offen offset:2048 lds
    v_mul_f32 v118, v118, v134
    v_mul_f32 v119, v119, v135
    v_add_f32 v224, 1.0, v224
    v_add_f32 v225, 1.0, v225
    v_add_f32 v226, 1.0, v226
    buffer_load_dwordx4 v187, s[12:15], s68 offen offset:3072 lds
    v_add_f32 v227, 1.0, v227
    v_add_f32 v228, 1.0, v228
    v_add_f32 v229, 1.0, v229
    v_add_f32 v230, 1.0, v230
    v_add_f32 v231, 1.0, v231
    s_add_u32 m0, s66, 24576
    s_nop 0
    buffer_load_dwordx4 v188, s[16:19], s69 offen offset:0 lds
    v_rcp_f32 v224, v224
    v_rcp_f32 v225, v225
    v_rcp_f32 v226, v226
    v_rcp_f32 v227, v227
    v_rcp_f32 v228, v228
    buffer_load_dwordx4 v189, s[16:19], s69 offen offset:1024 lds
    v_rcp_f32 v229, v229
    v_rcp_f32 v230, v230
    v_rcp_f32 v231, v231
    v_mul_f32 v112, v112, v224
    v_mul_f32 v113, v113, v225
    s_add_u32 m0, s66, 40960
    s_nop 0
    buffer_load_dwordx4 v188, s[20:23], s69 offen offset:0 lds
    v_mul_f32 v114, v114, v226
    v_mul_f32 v115, v115, v227
    v_mul_f32 v116, v116, v228
    v_mul_f32 v117, v117, v229
    v_mul_f32 v118, v118, v230
    buffer_load_dwordx4 v189, s[20:23], s69 offen offset:1024 lds
    v_mul_f32 v119, v119, v231
    v_cvt_pk_bf16_f32 v212, v112, v113
    v_cvt_pk_bf16_f32 v213, v114, v115
    v_cvt_pk_bf16_f32 v214, v116, v117
    v_cvt_pk_bf16_f32 v215, v118, v119
    s_add_u32 s66, s66, 49152
    s_cmp_ge_u32 s66, s71
    s_cselect_b32 s66, s70, s66
    buffer_store_dwordx4 v[208:211], v198, s[24:27], 0 offen offset:0 sc1
    s_waitcnt vmcnt(14)
    s_barrier
    s_and_b32 s69, s36, 15
    s_lshr_b64 s[36:37], s[36:37], 4
    s_lshl_b32 s68, s69, 7
    s_mul_i32 s69, s69, 0x70000
    s_add_u32 m0, s66, 16384
    s_nop 0
    buffer_load_dwordx4 v188, s[16:19], s69 offen offset:0 lds
    v_permlane16_swap_b32 v212, v214
    v_permlane16_swap_b32 v213, v215
    buffer_load_dwordx4 v189, s[16:19], s69 offen offset:1024 lds
    s_add_u32 m0, s66, 32768
    s_nop 0
    buffer_load_dwordx4 v188, s[20:23], s69 offen offset:0 lds
    buffer_load_dwordx4 v189, s[20:23], s69 offen offset:1024 lds
    s_add_u32 s69, s69, 0x38000
    s_add_u32 m0, s66, s70
    s_nop 0
    buffer_load_dwordx4 v184, s[12:15], s68 offen offset:0 lds
    buffer_load_dwordx4 v185, s[12:15], s68 offen offset:1024 lds
    buffer_load_dwordx4 v186, s[12:15], s68 offen offset:2048 lds
    buffer_load_dwordx4 v187, s[12:15], s68 offen offset:3072 lds
    s_add_u32 m0, s66, 24576
    s_nop 0
    buffer_load_dwordx4 v188, s[16:19], s69 offen offset:0 lds
    buffer_load_dwordx4 v189, s[16:19], s69 offen offset:1024 lds
    s_add_u32 m0, s66, 40960
    s_nop 0
    buffer_load_dwordx4 v188, s[20:23], s69 offen offset:0 lds
    buffer_load_dwordx4 v189, s[20:23], s69 offen offset:1024 lds
    s_add_u32 s66, s66, 49152
    s_cmp_ge_u32 s66, s71
    s_cselect_b32 s66, s70, s66
    buffer_store_dwordx4 v[212:215], v198, s[24:27], 0 offen offset:1024 sc1
    s_waitcnt vmcnt(14)
    s_barrier
    s_and_b32 s69, s36, 15
    s_lshr_b64 s[36:37], s[36:37], 4
    s_lshl_b32 s68, s69, 7
    s_mul_i32 s69, s69, 0x70000
    s_add_u32 m0, s66, 16384
    s_nop 0
    buffer_load_dwordx4 v188, s[16:19], s69 offen offset:0 lds
    buffer_load_dwordx4 v189, s[16:19], s69 offen offset:1024 lds
    s_add_u32 m0, s66, 32768
    s_nop 0
    buffer_load_dwordx4 v188, s[20:23], s69 offen offset:0 lds
    buffer_load_dwordx4 v189, s[20:23], s69 offen offset:1024 lds
    s_add_u32 s69, s69, 0x38000
    s_add_u32 m0, s66, s70
    s_nop 0
    buffer_load_dwordx4 v184, s[12:15], s68 offen offset:0 lds
    buffer_load_dwordx4 v185, s[12:15], s68 offen offset:1024 lds
    buffer_load_dwordx4 v186, s[12:15], s68 offen offset:2048 lds
    buffer_load_dwordx4 v187, s[12:15], s68 offen offset:3072 lds
    s_add_u32 m0, s66, 24576
    s_nop 0
    buffer_load_dwordx4 v188, s[16:19], s69 offen offset:0 lds
    buffer_load_dwordx4 v189, s[16:19], s69 offen offset:1024 lds
    s_add_u32 m0, s66, 40960
    s_nop 0
    buffer_load_dwordx4 v188, s[20:23], s69 offen offset:0 lds
    buffer_load_dwordx4 v189, s[20:23], s69 offen offset:1024 lds
    s_add_u32 s66, s66, 49152
    s_cmp_ge_u32 s66, s71
    s_cselect_b32 s66, s70, s66
    s_lshl_b32 s76, s59, 1
    s_lshl_b32 s77, s60, 4
    s_add_u32 s76, s76, s77
    s_lshl_b32 s77, s56, 2
    s_add_u32 s76, s76, s77
    v_mov_b32 v199, 4096
    s_waitcnt vmcnt(12)
    v_mov_b32 v2, 1
    s_mov_b64 exec, 1
    buffer_store_dword v2, v199, s[32:35], s76 offen sc1
    s_mov_b64 exec, -1
    s_lshl_b32 s76, s62, 3
    s_lshl_b32 s77, s56, 1
    s_add_u32 s76, s76, s77
    s_mul_i32 s76, s76, 114688
    v_lshl_add_u32 v192, v1, 4, s76
    v_add_u32 v193, 112640, v192
    s_lshl_b32 s77, s63, 8
    v_lshrrev_b32 v3, 4, v1
    s_lshl_b32 s76, s56, 4
    v_add_u32 v2, s76, v3
    s_movk_i32 s76, 2048
    v_mul_u32_u24 v2, s76, v2
    v_add_u32 v2, s77, v2
    v_lshlrev_b32 v3, 1, v3
    v_and_b32 v4, 15, v1
    v_xor_b32 v3, v3, v4
    v_lshl_add_u32 v194, v3, 4, v2
    v_add_u32 v195, 7168, v194
    v_xor_b32 v3, 8, v3
    v_lshl_add_u32 v196, v3, 4, v2
    v_add_u32 v196, 14336, v196
    v_add_u32 v197, 7168, v196
    v_lshlrev_b32 v199, 2, v1
    s_lshl_b32 s77, s62, 8
    s_add_u32 s77, s77, 4096
    s_barrier
    s_and_b32 s69, s36, 15
    s_lshr_b64 s[36:37], s[36:37], 4
    s_lshl_b32 s68, s69, 7
    s_mul_i32 s69, s69, 0x70000
    s_add_u32 m0, s66, 16384
    s_nop 0
    buffer_load_dwordx4 v188, s[16:19], s69 offen offset:0 lds
    buffer_load_dwordx4 v189, s[16:19], s69 offen offset:1024 lds
    s_add_u32 m0, s66, 32768
    s_nop 0
    buffer_load_dwordx4 v188, s[20:23], s69 offen offset:0 lds
    buffer_load_dwordx4 v189, s[20:23], s69 offen offset:1024 lds
    s_add_u32 s69, s69, 0x38000
    s_add_u32 m0, s66, s70
    s_nop 0
    buffer_load_dwordx4 v184, s[12:15], s68 offen offset:0 lds
    buffer_load_dwordx4 v185, s[12:15], s68 offen offset:1024 lds
    buffer_load_dwordx4 v186, s[12:15], s68 offen offset:2048 lds
    buffer_load_dwordx4 v187, s[12:15], s68 offen offset:3072 lds
    s_add_u32 m0, s66, 24576
    s_nop 0
    buffer_load_dwordx4 v188, s[16:19], s69 offen offset:0 lds
    buffer_load_dwordx4 v189, s[16:19], s69 offen offset:1024 lds
    s_add_u32 m0, s66, 40960
    s_nop 0
    buffer_load_dwordx4 v188, s[20:23], s69 offen offset:0 lds
    buffer_load_dwordx4 v189, s[20:23], s69 offen offset:1024 lds
    s_add_u32 s66, s66, 49152
    s_cmp_ge_u32 s66, s71
    s_cselect_b32 s66, s70, s66
    s_waitcnt vmcnt(13)
    s_barrier
    s_and_b32 s69, s36, 15
    s_lshr_b64 s[36:37], s[36:37], 4
    s_lshl_b32 s68, s69, 7
    s_mul_i32 s69, s69, 0x70000
    s_add_u32 m0, s66, 16384
    s_nop 0
    buffer_load_dwordx4 v188, s[16:19], s69 offen offset:0 lds
    buffer_load_dwordx4 v189, s[16:19], s69 offen offset:1024 lds
    s_add_u32 m0, s66, 32768
    s_nop 0
    buffer_load_dwordx4 v188, s[20:23], s69 offen offset:0 lds
    buffer_load_dwordx4 v189, s[20:23], s69 offen offset:1024 lds
    s_add_u32 s69, s69, 0x38000
    s_add_u32 m0, s66, s70
    s_nop 0
    buffer_load_dwordx4 v184, s[12:15], s68 offen offset:0 lds
    buffer_load_dwordx4 v185, s[12:15], s68 offen offset:1024 lds
    buffer_load_dwordx4 v186, s[12:15], s68 offen offset:2048 lds
    buffer_load_dwordx4 v187, s[12:15], s68 offen offset:3072 lds
    s_add_u32 m0, s66, 24576
    s_nop 0
    buffer_load_dwordx4 v188, s[16:19], s69 offen offset:0 lds
    buffer_load_dwordx4 v189, s[16:19], s69 offen offset:1024 lds
    s_add_u32 m0, s66, 40960
    s_nop 0
    buffer_load_dwordx4 v188, s[20:23], s69 offen offset:0 lds
    buffer_load_dwordx4 v189, s[20:23], s69 offen offset:1024 lds
    s_add_u32 s66, s66, 49152
    s_cmp_ge_u32 s66, s71
    s_cselect_b32 s66, s70, s66
    s_waitcnt vmcnt(12)
    s_barrier
    s_and_b32 s69, s36, 15
    s_lshr_b64 s[36:37], s[36:37], 4
    s_lshl_b32 s68, s69, 7
    s_mul_i32 s69, s69, 0x70000
    s_add_u32 m0, s66, 16384
    s_nop 0
    buffer_load_dwordx4 v188, s[16:19], s69 offen offset:0 lds
    buffer_load_dwordx4 v189, s[16:19], s69 offen offset:1024 lds
    s_add_u32 m0, s66, 32768
    s_nop 0
    buffer_load_dwordx4 v188, s[20:23], s69 offen offset:0 lds
    buffer_load_dwordx4 v189, s[20:23], s69 offen offset:1024 lds
    s_add_u32 s69, s69, 0x38000
    s_add_u32 m0, s66, s70
    s_nop 0
    buffer_load_dwordx4 v184, s[12:15], s68 offen offset:0 lds
    buffer_load_dwordx4 v185, s[12:15], s68 offen offset:1024 lds
    buffer_load_dwordx4 v186, s[12:15], s68 offen offset:2048 lds
    buffer_load_dwordx4 v187, s[12:15], s68 offen offset:3072 lds
    s_add_u32 m0, s66, 24576
    s_nop 0
    buffer_load_dwordx4 v188, s[16:19], s69 offen offset:0 lds
    buffer_load_dwordx4 v189, s[16:19], s69 offen offset:1024 lds
    s_add_u32 m0, s66, 40960
    s_nop 0
    buffer_load_dwordx4 v188, s[20:23], s69 offen offset:0 lds
    buffer_load_dwordx4 v189, s[20:23], s69 offen offset:1024 lds
    s_add_u32 s66, s66, 49152
    s_cmp_ge_u32 s66, s71
    s_cselect_b32 s66, s70, s66
    s_waitcnt vmcnt(12)
    s_barrier
    buffer_load_dword v245, v199, s[32:35], s77 offen sc1
    s_and_b32 s69, s36, 15
    s_lshr_b64 s[36:37], s[36:37], 4
    s_lshl_b32 s68, s69, 7
    s_mul_i32 s69, s69, 0x70000
    s_add_u32 m0, s66, 16384
    s_nop 0
    buffer_load_dwordx4 v188, s[16:19], s69 offen offset:0 lds
    buffer_load_dwordx4 v189, s[16:19], s69 offen offset:1024 lds
    s_add_u32 m0, s66, 32768
    s_nop 0
    buffer_load_dwordx4 v188, s[20:23], s69 offen offset:0 lds
    buffer_load_dwordx4 v189, s[20:23], s69 offen offset:1024 lds
    s_add_u32 s69, s69, 0x38000
    s_add_u32 m0, s66, s70
    s_nop 0
    buffer_load_dwordx4 v184, s[12:15], s68 offen offset:0 lds
    buffer_load_dwordx4 v185, s[12:15], s68 offen offset:1024 lds
    buffer_load_dwordx4 v186, s[12:15], s68 offen offset:2048 lds
    buffer_load_dwordx4 v187, s[12:15], s68 offen offset:3072 lds
    s_add_u32 m0, s66, 24576
    s_nop 0
    buffer_load_dwordx4 v188, s[16:19], s69 offen offset:0 lds
    buffer_load_dwordx4 v189, s[16:19], s69 offen offset:1024 lds
    s_add_u32 m0, s66, 40960
    s_nop 0
    buffer_load_dwordx4 v188, s[20:23], s69 offen offset:0 lds
    buffer_load_dwordx4 v189, s[20:23], s69 offen offset:1024 lds
    s_add_u32 s66, s66, 49152
    s_cmp_ge_u32 s66, s71
    s_cselect_b32 s66, s70, s66
    s_waitcnt vmcnt(13)
    s_barrier
    s_mov_b32 s3, 0x100000
    s_waitcnt vmcnt(12)
gd_kernel_pa_chk:
    v_cmp_ne_u32 vcc, 1, v245
    s_nop 4
    s_cbranch_vccz gd_kernel_pa_ok
    s_sub_u32 s3, s3, 1
    s_cbranch_scc1 gd_kernel_pa_ok
    s_sleep 2
    buffer_load_dword v245, v199, s[32:35], s77 offen sc1
    s_waitcnt vmcnt(0)
    s_branch gd_kernel_pa_chk
gd_kernel_pa_ok:
    s_lshl_b32 s70, s56, 12
    s_add_u32 s71, s70, 163840
    s_add_u32 s66, s70, 98304
    s_add_u32 s38, s62, s63
    s_and_b32 s38, s38, 3
    s_mov_b32 s36, 0x76453201
    s_mov_b32 s37, 0xfecdba89
    s_cmp_eq_u32 s38, 1
    s_cselect_b32 s36, 0x75643120, s36
    s_cselect_b32 s37, 0xfdecb9a8, s37
    s_cmp_eq_u32 s38, 2
    s_cselect_b32 s36, 0x67542310, s36
    s_cselect_b32 s37, 0xefdcab98, s37
    s_cmp_eq_u32 s38, 3
    s_cselect_b32 s36, 0x86534210, s36
    s_cselect_b32 s37, 0xfedbca97, s37
    s_cmp_eq_u32 s61, 0
    s_cselect_b32 s39, 16, 0
    s_and_b32 s69, s36, 15
    s_lshr_b64 s[36:37], s[36:37], 4
    s_add_u32 s69, s69, s39
    s_lshl_b32 s68, s69, 11
    s_lshl_b32 s69, s69, 17
    s_add_u32 m0, s66, 16384
    s_nop 0
    buffer_load_dwordx4 v194, s[28:31], s69 offen offset:0 lds
    buffer_load_dwordx4 v195, s[28:31], s69 offen offset:1024 lds
    buffer_load_dwordx4 v196, s[28:31], s69 offen offset:2048 lds
    buffer_load_dwordx4 v197, s[28:31], s69 offen offset:3072 lds
    s_mov_b32 m0, s66
    s_nop 0
    buffer_load_dwordx4 v192, s[24:27], s68 offen offset:0 lds
    buffer_load_dwordx4 v192, s[24:27], s68 offen offset:1024 lds
    buffer_load_dwordx4 v193, s[24:27], s68 offen offset:2048 lds
    buffer_load_dwordx4 v193, s[24:27], s68 offen offset:3072 lds
    s_add_u32 s66, s66, 32768
    s_cmp_ge_u32 s66, s71
    s_cselect_b32 s66, s70, s66
    s_and_b32 s69, s36, 15
    s_lshr_b64 s[36:37], s[36:37], 4
    s_add_u32 s69, s69, s39
    s_lshl_b32 s68, s69, 11
    s_lshl_b32 s69, s69, 17
    s_add_u32 m0, s66, 16384
    s_nop 0
    buffer_load_dwordx4 v194, s[28:31], s69 offen offset:0 lds
    buffer_load_dwordx4 v195, s[28:31], s69 offen offset:1024 lds
    buffer_load_dwordx4 v196, s[28:31], s69 offen offset:2048 lds
    buffer_load_dwordx4 v197, s[28:31], s69 offen offset:3072 lds
    s_mov_b32 m0, s66
    s_nop 0
    buffer_load_dwordx4 v192, s[24:27], s68 offen offset:0 lds
    buffer_load_dwordx4 v192, s[24:27], s68 offen offset:1024 lds
    buffer_load_dwordx4 v193, s[24:27], s68 offen offset:2048 lds
    buffer_load_dwordx4 v193, s[24:27], s68 offen offset:3072 lds
    s_add_u32 s66, s66, 32768
    s_cmp_ge_u32 s66, s71
    s_cselect_b32 s66, s70, s66
    s_lshl_b32 s76, s57, 13
    v_lshl_add_u32 v233, v1, 4, s76
    v_and_b32 v2, 15, v1
    s_lshl_b32 s76, s57, 6
    s_lshl_b32 s77, s62, 7
    s_add_u32 s76, s76, s77
    v_add_u32 v2, s76, v2
    v_lshlrev_b32 v2, 11, v2
    v_bfe_u32 v3, v1, 4, 1
    v_lshlrev_b32 v3, 4, v3
    v_bfe_u32 v4, v1, 5, 1
    v_lshl_or_b32 v3, v4, 3, v3
    s_lshl_b32 s76, s58, 6
    s_lshl_b32 s77, s63, 7
    s_add_u32 s76, s76, s77
    v_add_u32 v3, s76, v3
    v_lshl_add_u32 v184, v3, 1, v2
    v_lshlrev_b32 v185, 2, v3
    s_lshl_b32 s76, s64, 2
    s_add_u32 s76, s76, s56
    s_lshl_b32 s77, s76, 14
    v_lshl_add_u32 v186, v1, 4, s77
    s_lshl_b32 s77, s76, 2
    v_mov_b32 v187, s77
    s_mul_i32 s72, s61, 8
    s_mov_b32 s65, 98304
    s_waitcnt vmcnt(16)
    s_barrier
    s_and_b32 s69, s36, 15
    s_lshr_b64 s[36:37], s[36:37], 4
    s_add_u32 s69, s69, s39
    s_lshl_b32 s68, s69, 11
    s_lshl_b32 s69, s69, 17
    s_add_u32 m0, s66, 16384
    s_nop 0
    buffer_load_dwordx4 v194, s[28:31], s69 offen offset:0 lds
    buffer_load_dwordx4 v195, s[28:31], s69 offen offset:1024 lds
    buffer_load_dwordx4 v196, s[28:31], s69 offen offset:2048 lds
    buffer_load_dwordx4 v197, s[28:31], s69 offen offset:3072 lds
    s_mov_b32 m0, s66
    s_nop 0
    buffer_load_dwordx4 v192, s[24:27], s68 offen offset:0 lds
    buffer_load_dwordx4 v192, s[24:27], s68 offen offset:1024 lds
    buffer_load_dwordx4 v193, s[24:27], s68 offen offset:2048 lds
    buffer_load_dwordx4 v193, s[24:27], s68 offen offset:3072 lds
    s_add_u32 s66, s66, 32768
    s_cmp_ge_u32 s66, s71
    s_cselect_b32 s66, s70, s66
    v_add_u32 v232, s65, v233
    v_add_u32 v235, s65, v239
    v_add_u32 v236, s65, v240
    v_add_u32 v237, s65, v241
    v_add_u32 v238, s65, v242
    s_mov_b32 s12, 0x0
    s_mov_b32 s13, 0x8000
    s_mov_b32 s14, 0x10000
    s_mov_b32 s15, 0x18000
    s_mov_b32 s16, 0x0
    s_mov_b32 s17, 0x1000
    s_waitcnt vmcnt(16)
    s_barrier
    s_setprio 2
    ds_read_b128 v[72:75], v232 offset:0
    ds_read_b64_tr_b16 v[88:89], v235 offset:0
    ds_read_b64_tr_b16 v[90:91], v235 offset:1024
    ds_read_b64_tr_b16 v[92:93], v236 offset:0
    ds_read_b64_tr_b16 v[94:95], v236 offset:1024
    ds_read_b128 v[76:79], v232 offset:2048
    ds_read_b64_tr_b16 v[96:97], v237 offset:0
    ds_read_b64_tr_b16 v[98:99], v237 offset:1024
    ds_read_b64_tr_b16 v[100:101], v238 offset:0
    ds_read_b64_tr_b16 v[102:103], v238 offset:1024
    ds_read_b128 v[80:83], v232 offset:4096
    ds_read_b128 v[84:87], v232 offset:6144
    s_and_b32 s69, s36, 15
    s_lshr_b64 s[36:37], s[36:37], 4
    s_add_u32 s69, s69, s39
    s_lshl_b32 s68, s69, 11
    s_lshl_b32 s69, s69, 17
    s_add_u32 m0, s66, 16384
    s_nop 0
    buffer_load_dwordx4 v194, s[28:31], s69 offen offset:0 lds
    buffer_load_dwordx4 v195, s[28:31], s69 offen offset:1024 lds
    buffer_load_dwordx4 v196, s[28:31], s69 offen offset:2048 lds
    buffer_load_dwordx4 v197, s[28:31], s69 offen offset:3072 lds
    s_mov_b32 m0, s66
    s_nop 0
    buffer_load_dwordx4 v192, s[24:27], s68 offen offset:0 lds
    buffer_load_dwordx4 v192, s[24:27], s68 offen offset:1024 lds
    buffer_load_dwordx4 v193, s[24:27], s68 offen offset:2048 lds
    buffer_load_dwordx4 v193, s[24:27], s68 offen offset:3072 lds
    s_add_u32 s66, s66, 32768
    s_cmp_ge_u32 s66, s71
    s_cselect_b32 s66, s70, s66
    s_add_u32 s36, s8, 0xb00000
    s_addc_u32 s37, s9, 0
    s_mov_b32 s38, 0x400000
    s_mov_b32 s39, 0x20000
    s_cmp_eq_u32 s61, 0
    s_cselect_b32 s38, 0, s38
    s_add_u32 s65, s65, 32768
    s_cmp_ge_u32 s65, 163840
    s_cselect_b32 s65, 0, s65
    s_waitcnt lgkmcnt(0)
    v_mfma_f32_16x16x32_bf16 v[8:11], v[88:91], v[72:75], 0
    ds_read_b128 v[104:107], v232 offset:1024
    v_mfma_f32_16x16x32_bf16 v[12:15], v[92:95], v[72:75], 0
    ds_read_b64_tr_b16 v[120:121], v235 offset:8192
    v_mfma_f32_16x16x32_bf16 v[16:19], v[96:99], v[72:75], 0
    ds_read_b64_tr_b16 v[122:123], v235 offset:9216
    v_mfma_f32_16x16x32_bf16 v[20:23], v[100:103], v[72:75], 0
    ds_read_b64_tr_b16 v[124:125], v236 offset:8192
    v_mfma_f32_16x16x32_bf16 v[24:27], v[88:91], v[76:79], 0
    ds_read_b64_tr_b16 v[126:127], v236 offset:9216
    v_mfma_f32_16x16x32_bf16 v[28:31], v[92:95], v[76:79], 0
    ds_read_b128 v[108:111], v232 offset:3072
    v_mfma_f32_16x16x32_bf16 v[32:35], v[96:99], v[76:79], 0
    ds_read_b64_tr_b16 v[128:129], v237 offset:8192
    v_mfma_f32_16x16x32_bf16 v[36:39], v[100:103], v[76:79], 0
    ds_read_b64_tr_b16 v[130:131], v237 offset:9216
    v_mfma_f32_16x16x32_bf16 v[40:43], v[88:91], v[80:83], 0
    ds_read_b64_tr_b16 v[132:133], v238 offset:8192
    v_mfma_f32_16x16x32_bf16 v[44:47], v[92:95], v[80:83], 0
    ds_read_b64_tr_b16 v[134:135], v238 offset:9216
    v_mfma_f32_16x16x32_bf16 v[48:51], v[96:99], v[80:83], 0
    ds_read_b128 v[112:115], v232 offset:5120
    v_mfma_f32_16x16x32_bf16 v[52:55], v[100:103], v[80:83], 0
    ds_read_b128 v[116:119], v232 offset:7168
    v_mfma_f32_16x16x32_bf16 v[56:59], v[88:91], v[84:87], 0
    v_add_u32 v232, s65, v233
    v_add_u32 v235, s65, v239
    v_mfma_f32_16x16x32_bf16 v[60:63], v[92:95], v[84:87], 0
    v_add_u32 v236, s65, v240
    v_mfma_f32_16x16x32_bf16 v[64:67], v[96:99], v[84:87], 0
    v_add_u32 v237, s65, v241
    v_mfma_f32_16x16x32_bf16 v[68:71], v[100:103], v[84:87], 0
    v_add_u32 v238, s65, v242
    s_waitcnt lgkmcnt(0)
    v_mfma_f32_16x16x32_bf16 v[8:11], v[120:123], v[104:107], v[8:11]
    s_waitcnt vmcnt(16)
    s_barrier
    v_mfma_f32_16x16x32_bf16 v[12:15], v[124:127], v[104:107], v[12:15]
    ds_read_b128 v[72:75], v232 offset:0
    ds_read_b64_tr_b16 v[88:89], v235 offset:0
    v_mfma_f32_16x16x32_bf16 v[16:19], v[128:131], v[104:107], v[16:19]
    ds_read_b64_tr_b16 v[90:91], v235 offset:1024
    v_mfma_f32_16x16x32_bf16 v[20:23], v[132:135], v[104:107], v[20:23]
    ds_read_b64_tr_b16 v[92:93], v236 offset:0
    v_mfma_f32_16x16x32_bf16 v[24:27], v[120:123], v[108:111], v[24:27]
    ds_read_b64_tr_b16 v[94:95], v236 offset:1024
    v_mfma_f32_16x16x32_bf16 v[28:31], v[124:127], v[108:111], v[28:31]
    ds_read_b128 v[76:79], v232 offset:2048
    v_mfma_f32_16x16x32_bf16 v[32:35], v[128:131], v[108:111], v[32:35]
    ds_read_b64_tr_b16 v[96:97], v237 offset:0
    v_mfma_f32_16x16x32_bf16 v[36:39], v[132:135], v[108:111], v[36:39]
    ds_read_b64_tr_b16 v[98:99], v237 offset:1024
    v_mfma_f32_16x16x32_bf16 v[40:43], v[120:123], v[112:115], v[40:43]
    ds_read_b64_tr_b16 v[100:101], v238 offset:0
    v_mfma_f32_16x16x32_bf16 v[44:47], v[124:127], v[112:115], v[44:47]
    ds_read_b64_tr_b16 v[102:103], v238 offset:1024
    v_mfma_f32_16x16x32_bf16 v[48:51], v[128:131], v[112:115], v[48:51]
    ds_read_b128 v[80:83], v232 offset:4096
    v_mfma_f32_16x16x32_bf16 v[52:55], v[132:135], v[112:115], v[52:55]
    ds_read_b128 v[84:87], v232 offset:6144
    v_mfma_f32_16x16x32_bf16 v[56:59], v[120:123], v[116:119], v[56:59]
    v_mfma_f32_16x16x32_bf16 v[60:63], v[124:127], v[116:119], v[60:63]
    v_mfma_f32_16x16x32_bf16 v[64:67], v[128:131], v[116:119], v[64:67]
    s_add_u32 s65, s65, 32768
    s_cmp_ge_u32 s65, 163840
    s_cselect_b32 s65, 0, s65
    v_mfma_f32_16x16x32_bf16 v[68:71], v[132:135], v[116:119], v[68:71]
    s_waitcnt lgkmcnt(0)
    v_mfma_f32_16x16x32_bf16 v[8:11], v[88:91], v[72:75], v[8:11]
    ds_read_b128 v[104:107], v232 offset:1024
    v_mfma_f32_16x16x32_bf16 v[12:15], v[92:95], v[72:75], v[12:15]
    ds_read_b64_tr_b16 v[120:121], v235 offset:8192
    v_mfma_f32_16x16x32_bf16 v[16:19], v[96:99], v[72:75], v[16:19]
    ds_read_b64_tr_b16 v[122:123], v235 offset:9216
    v_mfma_f32_16x16x32_bf16 v[20:23], v[100:103], v[72:75], v[20:23]
    ds_read_b64_tr_b16 v[124:125], v236 offset:8192
    v_mfma_f32_16x16x32_bf16 v[24:27], v[88:91], v[76:79], v[24:27]
    ds_read_b64_tr_b16 v[126:127], v236 offset:9216
    v_mfma_f32_16x16x32_bf16 v[28:31], v[92:95], v[76:79], v[28:31]
    ds_read_b128 v[108:111], v232 offset:3072
    v_mfma_f32_16x16x32_bf16 v[32:35], v[96:99], v[76:79], v[32:35]
    ds_read_b64_tr_b16 v[128:129], v237 offset:8192
    v_mfma_f32_16x16x32_bf16 v[36:39], v[100:103], v[76:79], v[36:39]
    ds_read_b64_tr_b16 v[130:131], v237 offset:9216
    v_mfma_f32_16x16x32_bf16 v[40:43], v[88:91], v[80:83], v[40:43]
    ds_read_b64_tr_b16 v[132:133], v238 offset:8192
    v_mfma_f32_16x16x32_bf16 v[44:47], v[92:95], v[80:83], v[44:47]
    ds_read_b64_tr_b16 v[134:135], v238 offset:9216
    v_mfma_f32_16x16x32_bf16 v[48:51], v[96:99], v[80:83], v[48:51]
    ds_read_b128 v[112:115], v232 offset:5120
    v_mfma_f32_16x16x32_bf16 v[52:55], v[100:103], v[80:83], v[52:55]
    ds_read_b128 v[116:119], v232 offset:7168
    v_mfma_f32_16x16x32_bf16 v[56:59], v[88:91], v[84:87], v[56:59]
    v_add_u32 v232, s65, v233
    v_add_u32 v235, s65, v239
    v_mfma_f32_16x16x32_bf16 v[60:63], v[92:95], v[84:87], v[60:63]
    v_add_u32 v236, s65, v240
    v_mfma_f32_16x16x32_bf16 v[64:67], v[96:99], v[84:87], v[64:67]
    v_add_u32 v237, s65, v241
    v_mfma_f32_16x16x32_bf16 v[68:71], v[100:103], v[84:87], v[68:71]
    v_add_u32 v238, s65, v242
    s_waitcnt lgkmcnt(0)
    v_mfma_f32_16x16x32_bf16 v[8:11], v[120:123], v[104:107], v[8:11]
    s_waitcnt vmcnt(8)
    s_barrier
    v_mfma_f32_16x16x32_bf16 v[12:15], v[124:127], v[104:107], v[12:15]
    ds_read_b128 v[72:75], v232 offset:0
    ds_read_b64_tr_b16 v[88:89], v235 offset:0
    v_mfma_f32_16x16x32_bf16 v[16:19], v[128:131], v[104:107], v[16:19]
    ds_read_b64_tr_b16 v[90:91], v235 offset:1024
    v_mfma_f32_16x16x32_bf16 v[20:23], v[132:135], v[104:107], v[20:23]
    ds_read_b64_tr_b16 v[92:93], v236 offset:0
    v_mfma_f32_16x16x32_bf16 v[24:27], v[120:123], v[108:111], v[24:27]
    ds_read_b64_tr_b16 v[94:95], v236 offset:1024
    v_mfma_f32_16x16x32_bf16 v[28:31], v[124:127], v[108:111], v[28:31]
    ds_read_b128 v[76:79], v232 offset:2048
    v_mfma_f32_16x16x32_bf16 v[32:35], v[128:131], v[108:111], v[32:35]
    ds_read_b64_tr_b16 v[96:97], v237 offset:0
    v_mfma_f32_16x16x32_bf16 v[36:39], v[132:135], v[108:111], v[36:39]
    ds_read_b64_tr_b16 v[98:99], v237 offset:1024
    v_mfma_f32_16x16x32_bf16 v[40:43], v[120:123], v[112:115], v[40:43]
    ds_read_b64_tr_b16 v[100:101], v238 offset:0
    v_mfma_f32_16x16x32_bf16 v[44:47], v[124:127], v[112:115], v[44:47]
    ds_read_b64_tr_b16 v[102:103], v238 offset:1024
    v_mfma_f32_16x16x32_bf16 v[48:51], v[128:131], v[112:115], v[48:51]
    ds_read_b128 v[80:83], v232 offset:4096
    v_mfma_f32_16x16x32_bf16 v[52:55], v[132:135], v[112:115], v[52:55]
    ds_read_b128 v[84:87], v232 offset:6144
    v_mfma_f32_16x16x32_bf16 v[56:59], v[120:123], v[116:119], v[56:59]
    v_mfma_f32_16x16x32_bf16 v[60:63], v[124:127], v[116:119], v[60:63]
    v_mfma_f32_16x16x32_bf16 v[64:67], v[128:131], v[116:119], v[64:67]
    s_add_u32 s65, s65, 32768
    s_cmp_ge_u32 s65, 163840
    s_cselect_b32 s65, 0, s65
    v_mfma_f32_16x16x32_bf16 v[68:71], v[132:135], v[116:119], v[68:71]
    s_waitcnt lgkmcnt(0)
    v_mfma_f32_16x16x32_bf16 v[8:11], v[88:91], v[72:75], v[8:11]
    ds_read_b128 v[104:107], v232 offset:1024
    v_mfma_f32_16x16x32_bf16 v[12:15], v[92:95], v[72:75], v[12:15]
    ds_read_b64_tr_b16 v[120:121], v235 offset:8192
    v_mfma_f32_16x16x32_bf16 v[16:19], v[96:99], v[72:75], v[16:19]
    ds_read_b64_tr_b16 v[122:123], v235 offset:9216
    v_mfma_f32_16x16x32_bf16 v[20:23], v[100:103], v[72:75], v[20:23]
    ds_read_b64_tr_b16 v[124:125], v236 offset:8192
    v_mfma_f32_16x16x32_bf16 v[24:27], v[88:91], v[76:79], v[24:27]
    ds_read_b64_tr_b16 v[126:127], v236 offset:9216
    v_mfma_f32_16x16x32_bf16 v[28:31], v[92:95], v[76:79], v[28:31]
    ds_read_b128 v[108:111], v232 offset:3072
    v_mfma_f32_16x16x32_bf16 v[32:35], v[96:99], v[76:79], v[32:35]
    ds_read_b64_tr_b16 v[128:129], v237 offset:8192
    v_mfma_f32_16x16x32_bf16 v[36:39], v[100:103], v[76:79], v[36:39]
    ds_read_b64_tr_b16 v[130:131], v237 offset:9216
    v_mfma_f32_16x16x32_bf16 v[40:43], v[88:91], v[80:83], v[40:43]
    ds_read_b64_tr_b16 v[132:133], v238 offset:8192
    v_mfma_f32_16x16x32_bf16 v[44:47], v[92:95], v[80:83], v[44:47]
    ds_read_b64_tr_b16 v[134:135], v238 offset:9216
    v_mfma_f32_16x16x32_bf16 v[48:51], v[96:99], v[80:83], v[48:51]
    ds_read_b128 v[112:115], v232 offset:5120
    v_mfma_f32_16x16x32_bf16 v[52:55], v[100:103], v[80:83], v[52:55]
    ds_read_b128 v[116:119], v232 offset:7168
    v_mfma_f32_16x16x32_bf16 v[56:59], v[88:91], v[84:87], v[56:59]
    v_add_u32 v232, s65, v233
    v_add_u32 v235, s65, v239
    v_mfma_f32_16x16x32_bf16 v[60:63], v[92:95], v[84:87], v[60:63]
    v_add_u32 v236, s65, v240
    v_mfma_f32_16x16x32_bf16 v[64:67], v[96:99], v[84:87], v[64:67]
    v_add_u32 v237, s65, v241
    v_mfma_f32_16x16x32_bf16 v[68:71], v[100:103], v[84:87], v[68:71]
    v_add_u32 v238, s65, v242
    s_waitcnt lgkmcnt(0)
    v_mfma_f32_16x16x32_bf16 v[8:11], v[120:123], v[104:107], v[8:11]
    s_waitcnt vmcnt(0)
    s_barrier
    v_mfma_f32_16x16x32_bf16 v[12:15], v[124:127], v[104:107], v[12:15]
    ds_read_b128 v[72:75], v232 offset:0
    ds_read_b64_tr_b16 v[88:89], v235 offset:0
    v_mfma_f32_16x16x32_bf16 v[16:19], v[128:131], v[104:107], v[16:19]
    ds_read_b64_tr_b16 v[90:91], v235 offset:1024
    v_mfma_f32_16x16x32_bf16 v[20:23], v[132:135], v[104:107], v[20:23]
    ds_read_b64_tr_b16 v[92:93], v236 offset:0
    v_mfma_f32_16x16x32_bf16 v[24:27], v[120:123], v[108:111], v[24:27]
    ds_read_b64_tr_b16 v[94:95], v236 offset:1024
    v_mfma_f32_16x16x32_bf16 v[28:31], v[124:127], v[108:111], v[28:31]
    ds_read_b128 v[76:79], v232 offset:2048
    v_mfma_f32_16x16x32_bf16 v[32:35], v[128:131], v[108:111], v[32:35]
    ds_read_b64_tr_b16 v[96:97], v237 offset:0
    v_mfma_f32_16x16x32_bf16 v[36:39], v[132:135], v[108:111], v[36:39]
    ds_read_b64_tr_b16 v[98:99], v237 offset:1024
    v_mfma_f32_16x16x32_bf16 v[40:43], v[120:123], v[112:115], v[40:43]
    ds_read_b64_tr_b16 v[100:101], v238 offset:0
    v_mfma_f32_16x16x32_bf16 v[44:47], v[124:127], v[112:115], v[44:47]
    ds_read_b64_tr_b16 v[102:103], v238 offset:1024
    v_mfma_f32_16x16x32_bf16 v[48:51], v[128:131], v[112:115], v[48:51]
    ds_read_b128 v[80:83], v232 offset:4096
    v_mfma_f32_16x16x32_bf16 v[52:55], v[132:135], v[112:115], v[52:55]
    ds_read_b128 v[84:87], v232 offset:6144
    v_mfma_f32_16x16x32_bf16 v[56:59], v[120:123], v[116:119], v[56:59]
    v_mfma_f32_16x16x32_bf16 v[60:63], v[124:127], v[116:119], v[60:63]
    v_mfma_f32_16x16x32_bf16 v[64:67], v[128:131], v[116:119], v[64:67]
    s_add_u32 s65, s65, 32768
    s_cmp_ge_u32 s65, 163840
    s_cselect_b32 s65, 0, s65
    v_mfma_f32_16x16x32_bf16 v[68:71], v[132:135], v[116:119], v[68:71]
    s_waitcnt lgkmcnt(0)
    v_mfma_f32_16x16x32_bf16 v[8:11], v[88:91], v[72:75], v[8:11]
    ds_read_b128 v[104:107], v232 offset:1024
    v_mfma_f32_16x16x32_bf16 v[12:15], v[92:95], v[72:75], v[12:15]
    ds_read_b64_tr_b16 v[120:121], v235 offset:8192
    v_mfma_f32_16x16x32_bf16 v[16:19], v[96:99], v[72:75], v[16:19]
    ds_read_b64_tr_b16 v[122:123], v235 offset:9216
    v_mfma_f32_16x16x32_bf16 v[20:23], v[100:103], v[72:75], v[20:23]
    ds_read_b64_tr_b16 v[124:125], v236 offset:8192
    v_mfma_f32_16x16x32_bf16 v[24:27], v[88:91], v[76:79], v[24:27]
    ds_read_b64_tr_b16 v[126:127], v236 offset:9216
    v_mfma_f32_16x16x32_bf16 v[28:31], v[92:95], v[76:79], v[28:31]
    ds_read_b128 v[108:111], v232 offset:3072
    v_mfma_f32_16x16x32_bf16 v[32:35], v[96:99], v[76:79], v[32:35]
    ds_read_b64_tr_b16 v[128:129], v237 offset:8192
    v_mfma_f32_16x16x32_bf16 v[36:39], v[100:103], v[76:79], v[36:39]
    ds_read_b64_tr_b16 v[130:131], v237 offset:9216
    v_mfma_f32_16x16x32_bf16 v[40:43], v[88:91], v[80:83], v[40:43]
    s_add_u32 s67, s72, 15
gd_kernel_P_loop1:
    ds_read_b64_tr_b16 v[132:133], v238 offset:8192
    v_mfma_f32_16x16x32_bf16 v[44:47], v[92:95], v[80:83], v[44:47]
    ds_read_b64_tr_b16 v[134:135], v238 offset:9216
    v_mfma_f32_16x16x32_bf16 v[48:51], v[96:99], v[80:83], v[48:51]
    ds_read_b128 v[112:115], v232 offset:5120
    v_mfma_f32_16x16x32_bf16 v[52:55], v[100:103], v[80:83], v[52:55]
    ds_read_b128 v[116:119], v232 offset:7168
    v_mfma_f32_16x16x32_bf16 v[56:59], v[88:91], v[84:87], v[56:59]
    v_add_u32 v232, s65, v233
    v_add_u32 v235, s65, v239
    v_mfma_f32_16x16x32_bf16 v[60:63], v[92:95], v[84:87], v[60:63]
    v_add_u32 v236, s65, v240
    v_mfma_f32_16x16x32_bf16 v[64:67], v[96:99], v[84:87], v[64:67]
    v_add_u32 v237, s65, v241
    v_mfma_f32_16x16x32_bf16 v[68:71], v[100:103], v[84:87], v[68:71]
    v_add_u32 v238, s65, v242
    s_waitcnt lgkmcnt(0)
    v_mfma_f32_16x16x32_bf16 v[8:11], v[120:123], v[104:107], v[8:11]
    s_barrier
    v_mfma_f32_16x16x32_bf16 v[12:15], v[124:127], v[104:107], v[12:15]
    ds_read_b128 v[72:75], v232 offset:0
    ds_read_b64_tr_b16 v[88:89], v235 offset:0
    v_mfma_f32_16x16x32_bf16 v[16:19], v[128:131], v[104:107], v[16:19]
    ds_read_b64_tr_b16 v[90:91], v235 offset:1024
    v_mfma_f32_16x16x32_bf16 v[20:23], v[132:135], v[104:107], v[20:23]
    ds_read_b64_tr_b16 v[92:93], v236 offset:0
    v_mfma_f32_16x16x32_bf16 v[24:27], v[120:123], v[108:111], v[24:27]
    ds_read_b64_tr_b16 v[94:95], v236 offset:1024
    v_mfma_f32_16x16x32_bf16 v[28:31], v[124:127], v[108:111], v[28:31]
    ds_read_b128 v[76:79], v232 offset:2048
    v_mfma_f32_16x16x32_bf16 v[32:35], v[128:131], v[108:111], v[32:35]
    ds_read_b64_tr_b16 v[96:97], v237 offset:0
    v_mfma_f32_16x16x32_bf16 v[36:39], v[132:135], v[108:111], v[36:39]
    ds_read_b64_tr_b16 v[98:99], v237 offset:1024
    v_mfma_f32_16x16x32_bf16 v[40:43], v[120:123], v[112:115], v[40:43]
    ds_read_b64_tr_b16 v[100:101], v238 offset:0
    v_mfma_f32_16x16x32_bf16 v[44:47], v[124:127], v[112:115], v[44:47]
    ds_read_b64_tr_b16 v[102:103], v238 offset:1024
    v_mfma_f32_16x16x32_bf16 v[48:51], v[128:131], v[112:115], v[48:51]
    ds_read_b128 v[80:83], v232 offset:4096
    v_mfma_f32_16x16x32_bf16 v[52:55], v[132:135], v[112:115], v[52:55]
    ds_read_b128 v[84:87], v232 offset:6144
    v_mfma_f32_16x16x32_bf16 v[56:59], v[120:123], v[116:119], v[56:59]
    v_mfma_f32_16x16x32_bf16 v[60:63], v[124:127], v[116:119], v[60:63]
    v_mfma_f32_16x16x32_bf16 v[64:67], v[128:131], v[116:119], v[64:67]
    s_add_u32 s65, s65, 32768
    s_cmp_ge_u32 s65, 163840
    s_cselect_b32 s65, 0, s65
    v_mfma_f32_16x16x32_bf16 v[68:71], v[132:135], v[116:119], v[68:71]
    s_waitcnt lgkmcnt(0)
    v_mfma_f32_16x16x32_bf16 v[8:11], v[88:91], v[72:75], v[8:11]
    ds_read_b128 v[104:107], v232 offset:1024
    v_mfma_f32_16x16x32_bf16 v[12:15], v[92:95], v[72:75], v[12:15]
    ds_read_b64_tr_b16 v[120:121], v235 offset:8192
    v_mfma_f32_16x16x32_bf16 v[16:19], v[96:99], v[72:75], v[16:19]
    ds_read_b64_tr_b16 v[122:123], v235 offset:9216
    v_mfma_f32_16x16x32_bf16 v[20:23], v[100:103], v[72:75], v[20:23]
    ds_read_b64_tr_b16 v[124:125], v236 offset:8192
    v_mfma_f32_16x16x32_bf16 v[24:27], v[88:91], v[76:79], v[24:27]
    ds_read_b64_tr_b16 v[126:127], v236 offset:9216
    v_mfma_f32_16x16x32_bf16 v[28:31], v[92:95], v[76:79], v[28:31]
    ds_read_b128 v[108:111], v232 offset:3072
    v_mfma_f32_16x16x32_bf16 v[32:35], v[96:99], v[76:79], v[32:35]
    ds_read_b64_tr_b16 v[128:129], v237 offset:8192
    v_mfma_f32_16x16x32_bf16 v[36:39], v[100:103], v[76:79], v[36:39]
    s_sub_u32 s67, s67, 1
    ds_read_b64_tr_b16 v[130:131], v237 offset:9216
    v_mfma_f32_16x16x32_bf16 v[40:43], v[88:91], v[80:83], v[40:43]
    s_cbranch_scc0 gd_kernel_P_loop1
    ds_read_b64_tr_b16 v[132:133], v238 offset:8192
    v_mfma_f32_16x16x32_bf16 v[44:47], v[92:95], v[80:83], v[44:47]
    ds_read_b64_tr_b16 v[134:135], v238 offset:9216
    v_mfma_f32_16x16x32_bf16 v[48:51], v[96:99], v[80:83], v[48:51]
    ds_read_b128 v[112:115], v232 offset:5120
    v_mfma_f32_16x16x32_bf16 v[52:55], v[100:103], v[80:83], v[52:55]
    ds_read_b128 v[116:119], v232 offset:7168
    v_mfma_f32_16x16x32_bf16 v[56:59], v[88:91], v[84:87], v[56:59]
    v_add_u32 v232, s65, v233
    v_add_u32 v235, s65, v239
    v_mfma_f32_16x16x32_bf16 v[60:63], v[92:95], v[84:87], v[60:63]
    v_add_u32 v236, s65, v240
    v_mfma_f32_16x16x32_bf16 v[64:67], v[96:99], v[84:87], v[64:67]
    v_add_u32 v237, s65, v241
    v_mfma_f32_16x16x32_bf16 v[68:71], v[100:103], v[84:87], v[68:71]
    v_add_u32 v238, s65, v242
    s_waitcnt lgkmcnt(0)
    v_mfma_f32_16x16x32_bf16 v[8:11], v[120:123], v[104:107], v[8:11]
    s_barrier
    v_mfma_f32_16x16x32_bf16 v[12:15], v[124:127], v[104:107], v[12:15]
    ds_read_b128 v[72:75], v232 offset:0
    ds_read_b64_tr_b16 v[88:89], v235 offset:0
    buffer_load_dwordx4 v[136:139], v184, s[36:39], s12 offen offset:0
    v_mfma_f32_16x16x32_bf16 v[16:19], v[128:131], v[104:107], v[16:19]
    ds_read_b64_tr_b16 v[90:91], v235 offset:1024
    buffer_load_dwordx4 v[140:143], v184, s[36:39], s12 offen offset:64
    v_mfma_f32_16x16x32_bf16 v[20:23], v[132:135], v[104:107], v[20:23]
    ds_read_b64_tr_b16 v[92:93], v236 offset:0
    v_mfma_f32_16x16x32_bf16 v[24:27], v[120:123], v[108:111], v[24:27]
    ds_read_b64_tr_b16 v[94:95], v236 offset:1024
    buffer_load_dwordx4 v[144:147], v184, s[36:39], s13 offen offset:0
    v_mfma_f32_16x16x32_bf16 v[28:31], v[124:127], v[108:111], v[28:31]
    ds_read_b128 v[76:79], v232 offset:2048
    v_mfma_f32_16x16x32_bf16 v[32:35], v[128:131], v[108:111], v[32:35]
    ds_read_b64_tr_b16 v[96:97], v237 offset:0
    buffer_load_dwordx4 v[148:151], v184, s[36:39], s13 offen offset:64
    v_mfma_f32_16x16x32_bf16 v[36:39], v[132:135], v[108:111], v[36:39]
    ds_read_b64_tr_b16 v[98:99], v237 offset:1024
    buffer_load_dwordx4 v[152:155], v184, s[36:39], s14 offen offset:0
    v_mfma_f32_16x16x32_bf16 v[40:43], v[120:123], v[112:115], v[40:43]
    ds_read_b64_tr_b16 v[100:101], v238 offset:0
    v_mfma_f32_16x16x32_bf16 v[44:47], v[124:127], v[112:115], v[44:47]
    ds_read_b64_tr_b16 v[102:103], v238 offset:1024
    buffer_load_dwordx4 v[156:159], v184, s[36:39], s14 offen offset:64
    v_mfma_f32_16x16x32_bf16 v[48:51], v[128:131], v[112:115], v[48:51]
    ds_read_b128 v[80:83], v232 offset:4096
    v_mfma_f32_16x16x32_bf16 v[52:55], v[132:135], v[112:115], v[52:55]
    ds_read_b128 v[84:87], v232 offset:6144
    buffer_load_dwordx4 v[160:163], v184, s[36:39], s15 offen offset:0
    v_mfma_f32_16x16x32_bf16 v[56:59], v[120:123], v[116:119], v[56:59]
    buffer_load_dwordx4 v[164:167], v184, s[36:39], s15 offen offset:64
    v_mfma_f32_16x16x32_bf16 v[60:63], v[124:127], v[116:119], v[60:63]
    v_mfma_f32_16x16x32_bf16 v[64:67], v[128:131], v[116:119], v[64:67]
    s_add_u32 s65, s65, 32768
    s_cmp_ge_u32 s65, 163840
    s_cselect_b32 s65, 0, s65
    s_movk_i32 s76, 20480
    buffer_load_dwordx4 v[168:171], v185, s[44:47], s76 offen offset:0
    buffer_load_dwordx4 v[172:175], v185, s[44:47], s76 offen offset:16
    buffer_load_dwordx4 v[176:179], v185, s[44:47], s76 offen offset:128
    buffer_load_dwordx4 v[180:183], v185, s[44:47], s76 offen offset:144
    v_mfma_f32_16x16x32_bf16 v[68:71], v[132:135], v[116:119], v[68:71]
    s_waitcnt lgkmcnt(0)
    v_mfma_f32_16x16x32_bf16 v[8:11], v[88:91], v[72:75], v[8:11]
    ds_read_b128 v[104:107], v232 offset:1024
    v_mfma_f32_16x16x32_bf16 v[12:15], v[92:95], v[72:75], v[12:15]
    ds_read_b64_tr_b16 v[120:121], v235 offset:8192
    v_mfma_f32_16x16x32_bf16 v[16:19], v[96:99], v[72:75], v[16:19]
    ds_read_b64_tr_b16 v[122:123], v235 offset:9216
    v_mfma_f32_16x16x32_bf16 v[20:23], v[100:103], v[72:75], v[20:23]
    ds_read_b64_tr_b16 v[124:125], v236 offset:8192
    v_mfma_f32_16x16x32_bf16 v[24:27], v[88:91], v[76:79], v[24:27]
    ds_read_b64_tr_b16 v[126:127], v236 offset:9216
    v_mfma_f32_16x16x32_bf16 v[28:31], v[92:95], v[76:79], v[28:31]
    ds_read_b128 v[108:111], v232 offset:3072
    v_mfma_f32_16x16x32_bf16 v[32:35], v[96:99], v[76:79], v[32:35]
    ds_read_b64_tr_b16 v[128:129], v237 offset:8192
    v_mfma_f32_16x16x32_bf16 v[36:39], v[100:103], v[76:79], v[36:39]
    ds_read_b64_tr_b16 v[130:131], v237 offset:9216
    v_mfma_f32_16x16x32_bf16 v[40:43], v[88:91], v[80:83], v[40:43]
    s_movk_i32 s67, 1
gd_kernel_P_loop2:
    ds_read_b64_tr_b16 v[132:133], v238 offset:8192
    v_mfma_f32_16x16x32_bf16 v[44:47], v[92:95], v[80:83], v[44:47]
    ds_read_b64_tr_b16 v[134:135], v238 offset:9216
    v_mfma_f32_16x16x32_bf16 v[48:51], v[96:99], v[80:83], v[48:51]
    ds_read_b128 v[112:115], v232 offset:5120
    v_mfma_f32_16x16x32_bf16 v[52:55], v[100:103], v[80:83], v[52:55]
    ds_read_b128 v[116:119], v232 offset:7168
    v_mfma_f32_16x16x32_bf16 v[56:59], v[88:91], v[84:87], v[56:59]
    v_add_u32 v232, s65, v233
    v_add_u32 v235, s65, v239
    v_mfma_f32_16x16x32_bf16 v[60:63], v[92:95], v[84:87], v[60:63]
    v_add_u32 v236, s65, v240
    v_mfma_f32_16x16x32_bf16 v[64:67], v[96:99], v[84:87], v[64:67]
    v_add_u32 v237, s65, v241
    v_mfma_f32_16x16x32_bf16 v[68:71], v[100:103], v[84:87], v[68:71]
    v_add_u32 v238, s65, v242
    s_waitcnt lgkmcnt(0)
    v_mfma_f32_16x16x32_bf16 v[8:11], v[120:123], v[104:107], v[8:11]
    s_barrier
    v_mfma_f32_16x16x32_bf16 v[12:15], v[124:127], v[104:107], v[12:15]
    ds_read_b128 v[72:75], v232 offset:0
    ds_read_b64_tr_b16 v[88:89], v235 offset:0
    v_mfma_f32_16x16x32_bf16 v[16:19], v[128:131], v[104:107], v[16:19]
    ds_read_b64_tr_b16 v[90:91], v235 offset:1024
    v_mfma_f32_16x16x32_bf16 v[20:23], v[132:135], v[104:107], v[20:23]
    ds_read_b64_tr_b16 v[92:93], v236 offset:0
    v_mfma_f32_16x16x32_bf16 v[24:27], v[120:123], v[108:111], v[24:27]
    ds_read_b64_tr_b16 v[94:95], v236 offset:1024
    v_mfma_f32_16x16x32_bf16 v[28:31], v[124:127], v[108:111], v[28:31]
    ds_read_b128 v[76:79], v232 offset:2048
    v_mfma_f32_16x16x32_bf16 v[32:35], v[128:131], v[108:111], v[32:35]
    ds_read_b64_tr_b16 v[96:97], v237 offset:0
    v_mfma_f32_16x16x32_bf16 v[36:39], v[132:135], v[108:111], v[36:39]
    ds_read_b64_tr_b16 v[98:99], v237 offset:1024
    v_mfma_f32_16x16x32_bf16 v[40:43], v[120:123], v[112:115], v[40:43]
    ds_read_b64_tr_b16 v[100:101], v238 offset:0
    v_mfma_f32_16x16x32_bf16 v[44:47], v[124:127], v[112:115], v[44:47]
    ds_read_b64_tr_b16 v[102:103], v238 offset:1024
    v_mfma_f32_16x16x32_bf16 v[48:51], v[128:131], v[112:115], v[48:51]
    ds_read_b128 v[80:83], v232 offset:4096
    v_mfma_f32_16x16x32_bf16 v[52:55], v[132:135], v[112:115], v[52:55]
    ds_read_b128 v[84:87], v232 offset:6144
    v_mfma_f32_16x16x32_bf16 v[56:59], v[120:123], v[116:119], v[56:59]
    v_mfma_f32_16x16x32_bf16 v[60:63], v[124:127], v[116:119], v[60:63]
    v_mfma_f32_16x16x32_bf16 v[64:67], v[128:131], v[116:119], v[64:67]
    s_add_u32 s65, s65, 32768
    s_cmp_ge_u32 s65, 163840
    s_cselect_b32 s65, 0, s65
    v_mfma_f32_16x16x32_bf16 v[68:71], v[132:135], v[116:119], v[68:71]
    s_waitcnt lgkmcnt(0)
    v_mfma_f32_16x16x32_bf16 v[8:11], v[88:91], v[72:75], v[8:11]
    ds_read_b128 v[104:107], v232 offset:1024
    v_mfma_f32_16x16x32_bf16 v[12:15], v[92:95], v[72:75], v[12:15]
    ds_read_b64_tr_b16 v[120:121], v235 offset:8192
    v_mfma_f32_16x16x32_bf16 v[16:19], v[96:99], v[72:75], v[16:19]
    ds_read_b64_tr_b16 v[122:123], v235 offset:9216
    v_mfma_f32_16x16x32_bf16 v[20:23], v[100:103], v[72:75], v[20:23]
    ds_read_b64_tr_b16 v[124:125], v236 offset:8192
    v_mfma_f32_16x16x32_bf16 v[24:27], v[88:91], v[76:79], v[24:27]
    ds_read_b64_tr_b16 v[126:127], v236 offset:9216
    v_mfma_f32_16x16x32_bf16 v[28:31], v[92:95], v[76:79], v[28:31]
    ds_read_b128 v[108:111], v232 offset:3072
    v_mfma_f32_16x16x32_bf16 v[32:35], v[96:99], v[76:79], v[32:35]
    ds_read_b64_tr_b16 v[128:129], v237 offset:8192
    v_mfma_f32_16x16x32_bf16 v[36:39], v[100:103], v[76:79], v[36:39]
    s_sub_u32 s67, s67, 1
    ds_read_b64_tr_b16 v[130:131], v237 offset:9216
    v_mfma_f32_16x16x32_bf16 v[40:43], v[88:91], v[80:83], v[40:43]
    s_cbranch_scc0 gd_kernel_P_loop2
    ds_read_b64_tr_b16 v[132:133], v238 offset:8192
    v_mfma_f32_16x16x32_bf16 v[44:47], v[92:95], v[80:83], v[44:47]
    ds_read_b64_tr_b16 v[134:135], v238 offset:9216
    v_mfma_f32_16x16x32_bf16 v[48:51], v[96:99], v[80:83], v[48:51]
    ds_read_b128 v[112:115], v232 offset:5120
    v_mfma_f32_16x16x32_bf16 v[52:55], v[100:103], v[80:83], v[52:55]
    ds_read_b128 v[116:119], v232 offset:7168
    v_mfma_f32_16x16x32_bf16 v[56:59], v[88:91], v[84:87], v[56:59]
    v_add_u32 v232, s65, v233
    v_add_u32 v235, s65, v239
    v_mfma_f32_16x16x32_bf16 v[60:63], v[92:95], v[84:87], v[60:63]
    v_add_u32 v236, s65, v240
    v_mfma_f32_16x16x32_bf16 v[64:67], v[96:99], v[84:87], v[64:67]
    v_add_u32 v237, s65, v241
    v_mfma_f32_16x16x32_bf16 v[68:71], v[100:103], v[84:87], v[68:71]
    v_add_u32 v238, s65, v242
    s_waitcnt lgkmcnt(0)
    v_mfma_f32_16x16x32_bf16 v[8:11], v[120:123], v[104:107], v[8:11]
    s_barrier
    v_mfma_f32_16x16x32_bf16 v[12:15], v[124:127], v[104:107], v[12:15]
    ds_read_b128 v[72:75], v232 offset:0
    ds_read_b64_tr_b16 v[88:89], v235 offset:0
    buffer_load_dword v245, v187, s[32:35], 0 offen sc1
    v_mfma_f32_16x16x32_bf16 v[16:19], v[128:131], v[104:107], v[16:19]
    ds_read_b64_tr_b16 v[90:91], v235 offset:1024
    v_mfma_f32_16x16x32_bf16 v[20:23], v[132:135], v[104:107], v[20:23]
    ds_read_b64_tr_b16 v[92:93], v236 offset:0
    v_mfma_f32_16x16x32_bf16 v[24:27], v[120:123], v[108:111], v[24:27]
    ds_read_b64_tr_b16 v[94:95], v236 offset:1024
    v_mfma_f32_16x16x32_bf16 v[28:31], v[124:127], v[108:111], v[28:31]
    ds_read_b128 v[76:79], v232 offset:2048
    v_mfma_f32_16x16x32_bf16 v[32:35], v[128:131], v[108:111], v[32:35]
    ds_read_b64_tr_b16 v[96:97], v237 offset:0
    v_mfma_f32_16x16x32_bf16 v[36:39], v[132:135], v[108:111], v[36:39]
    ds_read_b64_tr_b16 v[98:99], v237 offset:1024
    v_mfma_f32_16x16x32_bf16 v[40:43], v[120:123], v[112:115], v[40:43]
    ds_read_b64_tr_b16 v[100:101], v238 offset:0
    v_mfma_f32_16x16x32_bf16 v[44:47], v[124:127], v[112:115], v[44:47]
    ds_read_b64_tr_b16 v[102:103], v238 offset:1024
    v_mfma_f32_16x16x32_bf16 v[48:51], v[128:131], v[112:115], v[48:51]
    ds_read_b128 v[80:83], v232 offset:4096
    v_mfma_f32_16x16x32_bf16 v[52:55], v[132:135], v[112:115], v[52:55]
    ds_read_b128 v[84:87], v232 offset:6144
    v_mfma_f32_16x16x32_bf16 v[56:59], v[120:123], v[116:119], v[56:59]
    v_mfma_f32_16x16x32_bf16 v[60:63], v[124:127], v[116:119], v[60:63]
    v_mfma_f32_16x16x32_bf16 v[64:67], v[128:131], v[116:119], v[64:67]
    s_add_u32 s65, s65, 32768
    s_cmp_ge_u32 s65, 163840
    s_cselect_b32 s65, 0, s65
    v_mfma_f32_16x16x32_bf16 v[68:71], v[132:135], v[116:119], v[68:71]
    s_waitcnt lgkmcnt(0)
    v_mfma_f32_16x16x32_bf16 v[8:11], v[88:91], v[72:75], v[8:11]
    ds_read_b128 v[104:107], v232 offset:1024
    v_mfma_f32_16x16x32_bf16 v[12:15], v[92:95], v[72:75], v[12:15]
    ds_read_b64_tr_b16 v[120:121], v235 offset:8192
    v_mfma_f32_16x16x32_bf16 v[16:19], v[96:99], v[72:75], v[16:19]
    ds_read_b64_tr_b16 v[122:123], v235 offset:9216
    v_mfma_f32_16x16x32_bf16 v[20:23], v[100:103], v[72:75], v[20:23]
    ds_read_b64_tr_b16 v[124:125], v236 offset:8192
    v_mfma_f32_16x16x32_bf16 v[24:27], v[88:91], v[76:79], v[24:27]
    ds_read_b64_tr_b16 v[126:127], v236 offset:9216
    v_mfma_f32_16x16x32_bf16 v[28:31], v[92:95], v[76:79], v[28:31]
    ds_read_b128 v[108:111], v232 offset:3072
    v_mfma_f32_16x16x32_bf16 v[32:35], v[96:99], v[76:79], v[32:35]
    ds_read_b64_tr_b16 v[128:129], v237 offset:8192
    v_mfma_f32_16x16x32_bf16 v[36:39], v[100:103], v[76:79], v[36:39]
    ds_read_b64_tr_b16 v[130:131], v237 offset:9216
    v_mfma_f32_16x16x32_bf16 v[40:43], v[88:91], v[80:83], v[40:43]
    ds_read_b64_tr_b16 v[132:133], v238 offset:8192
    v_mfma_f32_16x16x32_bf16 v[44:47], v[92:95], v[80:83], v[44:47]
    ds_read_b64_tr_b16 v[134:135], v238 offset:9216
    v_mfma_f32_16x16x32_bf16 v[48:51], v[96:99], v[80:83], v[48:51]
    ds_read_b128 v[112:115], v232 offset:5120
    v_mfma_f32_16x16x32_bf16 v[52:55], v[100:103], v[80:83], v[52:55]
    ds_read_b128 v[116:119], v232 offset:7168
    v_mfma_f32_16x16x32_bf16 v[56:59], v[88:91], v[84:87], v[56:59]
    v_mfma_f32_16x16x32_bf16 v[60:63], v[92:95], v[84:87], v[60:63]
    v_mfma_f32_16x16x32_bf16 v[64:67], v[96:99], v[84:87], v[64:67]
    v_mfma_f32_16x16x32_bf16 v[68:71], v[100:103], v[84:87], v[68:71]
    s_waitcnt lgkmcnt(0)
    v_mfma_f32_16x16x32_bf16 v[8:11], v[120:123], v[104:107], v[8:11]
    v_mfma_f32_16x16x32_bf16 v[12:15], v[124:127], v[104:107], v[12:15]
    v_mfma_f32_16x16x32_bf16 v[16:19], v[128:131], v[104:107], v[16:19]
    v_mfma_f32_16x16x32_bf16 v[20:23], v[132:135], v[104:107], v[20:23]
    v_mfma_f32_16x16x32_bf16 v[24:27], v[120:123], v[108:111], v[24:27]
    v_mfma_f32_16x16x32_bf16 v[28:31], v[124:127], v[108:111], v[28:31]
    v_mfma_f32_16x16x32_bf16 v[32:35], v[128:131], v[108:111], v[32:35]
    v_mfma_f32_16x16x32_bf16 v[36:39], v[132:135], v[108:111], v[36:39]
    v_mfma_f32_16x16x32_bf16 v[40:43], v[120:123], v[112:115], v[40:43]
    v_mfma_f32_16x16x32_bf16 v[44:47], v[124:127], v[112:115], v[44:47]
    v_mfma_f32_16x16x32_bf16 v[48:51], v[128:131], v[112:115], v[48:51]
    v_mfma_f32_16x16x32_bf16 v[52:55], v[132:135], v[112:115], v[52:55]
    v_mfma_f32_16x16x32_bf16 v[56:59], v[120:123], v[116:119], v[56:59]
    v_mfma_f32_16x16x32_bf16 v[60:63], v[124:127], v[116:119], v[60:63]
    v_mfma_f32_16x16x32_bf16 v[64:67], v[128:131], v[116:119], v[64:67]
    v_mfma_f32_16x16x32_bf16 v[68:71], v[132:135], v[116:119], v[68:71]
    s_mov_b32 s3, 0x100000
    s_cmp_lg_u32 s61, 0
    s_cbranch_scc1 gd_kernel_A
    v_cvt_pk_bf16_f32 v72, v8, v9
    v_cvt_pk_bf16_f32 v73, v10, v11
    v_cvt_pk_bf16_f32 v74, v12, v13
    v_cvt_pk_bf16_f32 v75, v14, v15
    buffer_store_dwordx4 v[72:75], v186, s[48:51], s16 offen offset:0 sc1
    v_cvt_pk_bf16_f32 v76, v16, v17
    v_cvt_pk_bf16_f32 v77, v18, v19
    v_cvt_pk_bf16_f32 v78, v20, v21
    v_cvt_pk_bf16_f32 v79, v22, v23
    buffer_store_dwordx4 v[76:79], v186, s[48:51], s16 offen offset:1024 sc1
    v_cvt_pk_bf16_f32 v80, v24, v25
    v_cvt_pk_bf16_f32 v81, v26, v27
    v_cvt_pk_bf16_f32 v82, v28, v29
    v_cvt_pk_bf16_f32 v83, v30, v31
    buffer_store_dwordx4 v[80:83], v186, s[48:51], s16 offen offset:2048 sc1
    v_cvt_pk_bf16_f32 v84, v32, v33
    v_cvt_pk_bf16_f32 v85, v34, v35
    v_cvt_pk_bf16_f32 v86, v36, v37
    v_cvt_pk_bf16_f32 v87, v38, v39
    buffer_store_dwordx4 v[84:87], v186, s[48:51], s16 offen offset:3072 sc1
    v_cvt_pk_bf16_f32 v88, v40, v41
    v_cvt_pk_bf16_f32 v89, v42, v43
    v_cvt_pk_bf16_f32 v90, v44, v45
    v_cvt_pk_bf16_f32 v91, v46, v47
    buffer_store_dwordx4 v[88:91], v186, s[48:51], s17 offen offset:0 sc1
    v_cvt_pk_bf16_f32 v92, v48, v49
    v_cvt_pk_bf16_f32 v93, v50, v51
    v_cvt_pk_bf16_f32 v94, v52, v53
    v_cvt_pk_bf16_f32 v95, v54, v55
    buffer_store_dwordx4 v[92:95], v186, s[48:51], s17 offen offset:1024 sc1
    v_cvt_pk_bf16_f32 v96, v56, v57
    v_cvt_pk_bf16_f32 v97, v58, v59
    v_cvt_pk_bf16_f32 v98, v60, v61
    v_cvt_pk_bf16_f32 v99, v62, v63
    buffer_store_dwordx4 v[96:99], v186, s[48:51], s17 offen offset:2048 sc1
    v_cvt_pk_bf16_f32 v100, v64, v65
    v_cvt_pk_bf16_f32 v101, v66, v67
    v_cvt_pk_bf16_f32 v102, v68, v69
    v_cvt_pk_bf16_f32 v103, v70, v71
    buffer_store_dwordx4 v[100:103], v186, s[48:51], s17 offen offset:3072 sc1
    v_mov_b32 v2, 1
    s_waitcnt vmcnt(0)
    s_mov_b64 exec, 1
    buffer_store_dword v2, v187, s[32:35], 0 offen sc1
    s_branch gd_kernel_fin
gd_kernel_poll:
    s_sub_u32 s3, s3, 1
    s_cbranch_scc1 gd_kernel_got
    s_sleep 1
    buffer_load_dword v245, v187, s[32:35], 0 offen sc1
gd_kernel_A:
    s_waitcnt vmcnt(0)
    v_readfirstlane_b32 s76, v245
    s_nop 3
    s_cmp_lg_u32 s76, 1
    s_cbranch_scc1 gd_kernel_poll
gd_kernel_got:
    s_nop 7
    buffer_load_dwordx4 v[72:75], v186, s[48:51], s16 offen offset:0 sc1
    buffer_load_dwordx4 v[76:79], v186, s[48:51], s16 offen offset:1024 sc1
    buffer_load_dwordx4 v[80:83], v186, s[48:51], s16 offen offset:2048 sc1
    buffer_load_dwordx4 v[84:87], v186, s[48:51], s16 offen offset:3072 sc1
    buffer_load_dwordx4 v[88:91], v186, s[48:51], s17 offen offset:0 sc1
    buffer_load_dwordx4 v[92:95], v186, s[48:51], s17 offen offset:1024 sc1
    buffer_load_dwordx4 v[96:99], v186, s[48:51], s17 offen offset:2048 sc1
    buffer_load_dwordx4 v[100:103], v186, s[48:51], s17 offen offset:3072 sc1
    s_waitcnt vmcnt(7)
    v_lshlrev_b32 v104, 16, v72
    v_and_b32 v105, 0xffff0000, v72
    v_lshlrev_b32 v106, 16, v73
    v_and_b32 v107, 0xffff0000, v73
    v_lshlrev_b32 v108, 16, v74
    v_and_b32 v109, 0xffff0000, v74
    v_lshlrev_b32 v110, 16, v75
    v_and_b32 v111, 0xffff0000, v75
    v_pk_add_f32 v[8:9], v[8:9], v[104:105]
    v_pk_add_f32 v[10:11], v[10:11], v[106:107]
    v_pk_add_f32 v[12:13], v[12:13], v[108:109]
    v_pk_add_f32 v[14:15], v[14:15], v[110:111]
    v_lshlrev_b32 v200, 16, v136
    v_and_b32 v201, 0xffff0000, v136
    v_lshlrev_b32 v202, 16, v137
    v_and_b32 v203, 0xffff0000, v137
    v_lshlrev_b32 v204, 16, v138
    v_and_b32 v205, 0xffff0000, v138
    v_lshlrev_b32 v206, 16, v139
    v_and_b32 v207, 0xffff0000, v139
    v_permlane16_swap_b32 v8, v12
    v_permlane16_swap_b32 v9, v13
    v_permlane16_swap_b32 v10, v14
    v_permlane16_swap_b32 v11, v15
    v_pk_fma_f32 v[200:201], v[8:9], v[168:169], v[200:201]
    v_pk_fma_f32 v[202:203], v[10:11], v[170:171], v[202:203]
    v_pk_fma_f32 v[204:205], v[12:13], v[172:173], v[204:205]
    v_pk_fma_f32 v[206:207], v[14:15], v[174:175], v[206:207]
    v_cvt_pk_bf16_f32 v136, v200, v201
    v_cvt_pk_bf16_f32 v137, v202, v203
    v_cvt_pk_bf16_f32 v138, v204, v205
    v_cvt_pk_bf16_f32 v139, v206, v207
    buffer_store_dwordx4 v[136:139], v184, s[40:43], s12 offen offset:0
    s_waitcnt vmcnt(7)
    v_lshlrev_b32 v112, 16, v76
    v_and_b32 v113, 0xffff0000, v76
    v_lshlrev_b32 v114, 16, v77
    v_and_b32 v115, 0xffff0000, v77
    v_lshlrev_b32 v116, 16, v78
    v_and_b32 v117, 0xffff0000, v78
    v_lshlrev_b32 v118, 16, v79
    v_and_b32 v119, 0xffff0000, v79
    v_pk_add_f32 v[16:17], v[16:17], v[112:113]
    v_pk_add_f32 v[18:19], v[18:19], v[114:115]
    v_pk_add_f32 v[20:21], v[20:21], v[116:117]
    v_pk_add_f32 v[22:23], v[22:23], v[118:119]
    v_lshlrev_b32 v200, 16, v140
    v_and_b32 v201, 0xffff0000, v140
    v_lshlrev_b32 v202, 16, v141
    v_and_b32 v203, 0xffff0000, v141
    v_lshlrev_b32 v204, 16, v142
    v_and_b32 v205, 0xffff0000, v142
    v_lshlrev_b32 v206, 16, v143
    v_and_b32 v207, 0xffff0000, v143
    v_permlane16_swap_b32 v16, v20
    v_permlane16_swap_b32 v17, v21
    v_permlane16_swap_b32 v18, v22
    v_permlane16_swap_b32 v19, v23
    v_pk_fma_f32 v[200:201], v[16:17], v[176:177], v[200:201]
    v_pk_fma_f32 v[202:203], v[18:19], v[178:179], v[202:203]
    v_pk_fma_f32 v[204:205], v[20:21], v[180:181], v[204:205]
    v_pk_fma_f32 v[206:207], v[22:23], v[182:183], v[206:207]
    v_cvt_pk_bf16_f32 v140, v200, v201
    v_cvt_pk_bf16_f32 v141, v202, v203
    v_cvt_pk_bf16_f32 v142, v204, v205
    v_cvt_pk_bf16_f32 v143, v206, v207
    buffer_store_dwordx4 v[140:143], v184, s[40:43], s12 offen offset:64
    s_waitcnt vmcnt(7)
    v_lshlrev_b32 v120, 16, v80
    v_and_b32 v121, 0xffff0000, v80
    v_lshlrev_b32 v122, 16, v81
    v_and_b32 v123, 0xffff0000, v81
    v_lshlrev_b32 v124, 16, v82
    v_and_b32 v125, 0xffff0000, v82
    v_lshlrev_b32 v126, 16, v83
    v_and_b32 v127, 0xffff0000, v83
    v_pk_add_f32 v[24:25], v[24:25], v[120:121]
    v_pk_add_f32 v[26:27], v[26:27], v[122:123]
    v_pk_add_f32 v[28:29], v[28:29], v[124:125]
    v_pk_add_f32 v[30:31], v[30:31], v[126:127]
    v_lshlrev_b32 v200, 16, v144
    v_and_b32 v201, 0xffff0000, v144
    v_lshlrev_b32 v202, 16, v145
    v_and_b32 v203, 0xffff0000, v145
    v_lshlrev_b32 v204, 16, v146
    v_and_b32 v205, 0xffff0000, v146
    v_lshlrev_b32 v206, 16, v147
    v_and_b32 v207, 0xffff0000, v147
    v_permlane16_swap_b32 v24, v28
    v_permlane16_swap_b32 v25, v29
    v_permlane16_swap_b32 v26, v30
    v_permlane16_swap_b32 v27, v31
    v_pk_fma_f32 v[200:201], v[24:25], v[168:169], v[200:201]
    v_pk_fma_f32 v[202:203], v[26:27], v[170:171], v[202:203]
    v_pk_fma_f32 v[204:205], v[28:29], v[172:173], v[204:205]
    v_pk_fma_f32 v[206:207], v[30:31], v[174:175], v[206:207]
    v_cvt_pk_bf16_f32 v144, v200, v201
    v_cvt_pk_bf16_f32 v145, v202, v203
    v_cvt_pk_bf16_f32 v146, v204, v205
    v_cvt_pk_bf16_f32 v147, v206, v207
    buffer_store_dwordx4 v[144:147], v184, s[40:43], s13 offen offset:0
    s_waitcnt vmcnt(7)
    v_lshlrev_b32 v128, 16, v84
    v_and_b32 v129, 0xffff0000, v84
    v_lshlrev_b32 v130, 16, v85
    v_and_b32 v131, 0xffff0000, v85
    v_lshlrev_b32 v132, 16, v86
    v_and_b32 v133, 0xffff0000, v86
    v_lshlrev_b32 v134, 16, v87
    v_and_b32 v135, 0xffff0000, v87
    v_pk_add_f32 v[32:33], v[32:33], v[128:129]
    v_pk_add_f32 v[34:35], v[34:35], v[130:131]
    v_pk_add_f32 v[36:37], v[36:37], v[132:133]
    v_pk_add_f32 v[38:39], v[38:39], v[134:135]
    v_lshlrev_b32 v200, 16, v148
    v_and_b32 v201, 0xffff0000, v148
    v_lshlrev_b32 v202, 16, v149
    v_and_b32 v203, 0xffff0000, v149
    v_lshlrev_b32 v204, 16, v150
    v_and_b32 v205, 0xffff0000, v150
    v_lshlrev_b32 v206, 16, v151
    v_and_b32 v207, 0xffff0000, v151
    v_permlane16_swap_b32 v32, v36
    v_permlane16_swap_b32 v33, v37
    v_permlane16_swap_b32 v34, v38
    v_permlane16_swap_b32 v35, v39
    v_pk_fma_f32 v[200:201], v[32:33], v[176:177], v[200:201]
    v_pk_fma_f32 v[202:203], v[34:35], v[178:179], v[202:203]
    v_pk_fma_f32 v[204:205], v[36:37], v[180:181], v[204:205]
    v_pk_fma_f32 v[206:207], v[38:39], v[182:183], v[206:207]
    v_cvt_pk_bf16_f32 v148, v200, v201
    v_cvt_pk_bf16_f32 v149, v202, v203
    v_cvt_pk_bf16_f32 v150, v204, v205
    v_cvt_pk_bf16_f32 v151, v206, v207
    buffer_store_dwordx4 v[148:151], v184, s[40:43], s13 offen offset:64
    s_waitcnt vmcnt(7)
    v_lshlrev_b32 v104, 16, v88
    v_and_b32 v105, 0xffff0000, v88
    v_lshlrev_b32 v106, 16, v89
    v_and_b32 v107, 0xffff0000, v89
    v_lshlrev_b32 v108, 16, v90
    v_and_b32 v109, 0xffff0000, v90
    v_lshlrev_b32 v110, 16, v91
    v_and_b32 v111, 0xffff0000, v91
    v_pk_add_f32 v[40:41], v[40:41], v[104:105]
    v_pk_add_f32 v[42:43], v[42:43], v[106:107]
    v_pk_add_f32 v[44:45], v[44:45], v[108:109]
    v_pk_add_f32 v[46:47], v[46:47], v[110:111]
    v_lshlrev_b32 v200, 16, v152
    v_and_b32 v201, 0xffff0000, v152
    v_lshlrev_b32 v202, 16, v153
    v_and_b32 v203, 0xffff0000, v153
    v_lshlrev_b32 v204, 16, v154
    v_and_b32 v205, 0xffff0000, v154
    v_lshlrev_b32 v206, 16, v155
    v_and_b32 v207, 0xffff0000, v155
    v_permlane16_swap_b32 v40, v44
    v_permlane16_swap_b32 v41, v45
    v_permlane16_swap_b32 v42, v46
    v_permlane16_swap_b32 v43, v47
    v_pk_fma_f32 v[200:201], v[40:41], v[168:169], v[200:201]
    v_pk_fma_f32 v[202:203], v[42:43], v[170:171], v[202:203]
    v_pk_fma_f32 v[204:205], v[44:45], v[172:173], v[204:205]
    v_pk_fma_f32 v[206:207], v[46:47], v[174:175], v[206:207]
    v_cvt_pk_bf16_f32 v152, v200, v201
    v_cvt_pk_bf16_f32 v153, v202, v203
    v_cvt_pk_bf16_f32 v154, v204, v205
    v_cvt_pk_bf16_f32 v155, v206, v207
    buffer_store_dwordx4 v[152:155], v184, s[40:43], s14 offen offset:0
    s_waitcnt vmcnt(7)
    v_lshlrev_b32 v112, 16, v92
    v_and_b32 v113, 0xffff0000, v92
    v_lshlrev_b32 v114, 16, v93
    v_and_b32 v115, 0xffff0000, v93
    v_lshlrev_b32 v116, 16, v94
    v_and_b32 v117, 0xffff0000, v94
    v_lshlrev_b32 v118, 16, v95
    v_and_b32 v119, 0xffff0000, v95
    v_pk_add_f32 v[48:49], v[48:49], v[112:113]
    v_pk_add_f32 v[50:51], v[50:51], v[114:115]
    v_pk_add_f32 v[52:53], v[52:53], v[116:117]
    v_pk_add_f32 v[54:55], v[54:55], v[118:119]
    v_lshlrev_b32 v200, 16, v156
    v_and_b32 v201, 0xffff0000, v156
    v_lshlrev_b32 v202, 16, v157
    v_and_b32 v203, 0xffff0000, v157
    v_lshlrev_b32 v204, 16, v158
    v_and_b32 v205, 0xffff0000, v158
    v_lshlrev_b32 v206, 16, v159
    v_and_b32 v207, 0xffff0000, v159
    v_permlane16_swap_b32 v48, v52
    v_permlane16_swap_b32 v49, v53
    v_permlane16_swap_b32 v50, v54
    v_permlane16_swap_b32 v51, v55
    v_pk_fma_f32 v[200:201], v[48:49], v[176:177], v[200:201]
    v_pk_fma_f32 v[202:203], v[50:51], v[178:179], v[202:203]
    v_pk_fma_f32 v[204:205], v[52:53], v[180:181], v[204:205]
    v_pk_fma_f32 v[206:207], v[54:55], v[182:183], v[206:207]
    v_cvt_pk_bf16_f32 v156, v200, v201
    v_cvt_pk_bf16_f32 v157, v202, v203
    v_cvt_pk_bf16_f32 v158, v204, v205
    v_cvt_pk_bf16_f32 v159, v206, v207
    buffer_store_dwordx4 v[156:159], v184, s[40:43], s14 offen offset:64
    s_waitcnt vmcnt(7)
    v_lshlrev_b32 v120, 16, v96
    v_and_b32 v121, 0xffff0000, v96
    v_lshlrev_b32 v122, 16, v97
    v_and_b32 v123, 0xffff0000, v97
    v_lshlrev_b32 v124, 16, v98
    v_and_b32 v125, 0xffff0000, v98
    v_lshlrev_b32 v126, 16, v99
    v_and_b32 v127, 0xffff0000, v99
    v_pk_add_f32 v[56:57], v[56:57], v[120:121]
    v_pk_add_f32 v[58:59], v[58:59], v[122:123]
    v_pk_add_f32 v[60:61], v[60:61], v[124:125]
    v_pk_add_f32 v[62:63], v[62:63], v[126:127]
    v_lshlrev_b32 v200, 16, v160
    v_and_b32 v201, 0xffff0000, v160
    v_lshlrev_b32 v202, 16, v161
    v_and_b32 v203, 0xffff0000, v161
    v_lshlrev_b32 v204, 16, v162
    v_and_b32 v205, 0xffff0000, v162
    v_lshlrev_b32 v206, 16, v163
    v_and_b32 v207, 0xffff0000, v163
    v_permlane16_swap_b32 v56, v60
    v_permlane16_swap_b32 v57, v61
    v_permlane16_swap_b32 v58, v62
    v_permlane16_swap_b32 v59, v63
    v_pk_fma_f32 v[200:201], v[56:57], v[168:169], v[200:201]
    v_pk_fma_f32 v[202:203], v[58:59], v[170:171], v[202:203]
    v_pk_fma_f32 v[204:205], v[60:61], v[172:173], v[204:205]
    v_pk_fma_f32 v[206:207], v[62:63], v[174:175], v[206:207]
    v_cvt_pk_bf16_f32 v160, v200, v201
    v_cvt_pk_bf16_f32 v161, v202, v203
    v_cvt_pk_bf16_f32 v162, v204, v205
    v_cvt_pk_bf16_f32 v163, v206, v207
    buffer_store_dwordx4 v[160:163], v184, s[40:43], s15 offen offset:0
    s_waitcnt vmcnt(7)
    v_lshlrev_b32 v128, 16, v100
    v_and_b32 v129, 0xffff0000, v100
    v_lshlrev_b32 v130, 16, v101
    v_and_b32 v131, 0xffff0000, v101
    v_lshlrev_b32 v132, 16, v102
    v_and_b32 v133, 0xffff0000, v102
    v_lshlrev_b32 v134, 16, v103
    v_and_b32 v135, 0xffff0000, v103
    v_pk_add_f32 v[64:65], v[64:65], v[128:129]
    v_pk_add_f32 v[66:67], v[66:67], v[130:131]
    v_pk_add_f32 v[68:69], v[68:69], v[132:133]
    v_pk_add_f32 v[70:71], v[70:71], v[134:135]
    v_lshlrev_b32 v200, 16, v164
    v_and_b32 v201, 0xffff0000, v164
    v_lshlrev_b32 v202, 16, v165
    v_and_b32 v203, 0xffff0000, v165
    v_lshlrev_b32 v204, 16, v166
    v_and_b32 v205, 0xffff0000, v166
    v_lshlrev_b32 v206, 16, v167
    v_and_b32 v207, 0xffff0000, v167
    v_permlane16_swap_b32 v64, v68
    v_permlane16_swap_b32 v65, v69
    v_permlane16_swap_b32 v66, v70
    v_permlane16_swap_b32 v67, v71
    v_pk_fma_f32 v[200:201], v[64:65], v[176:177], v[200:201]
    v_pk_fma_f32 v[202:203], v[66:67], v[178:179], v[202:203]
    v_pk_fma_f32 v[204:205], v[68:69], v[180:181], v[204:205]
    v_pk_fma_f32 v[206:207], v[70:71], v[182:183], v[206:207]
    v_cvt_pk_bf16_f32 v164, v200, v201
    v_cvt_pk_bf16_f32 v165, v202, v203
    v_cvt_pk_bf16_f32 v166, v204, v205
    v_cvt_pk_bf16_f32 v167, v206, v207
    buffer_store_dwordx4 v[164:167], v184, s[40:43], s15 offen offset:64
    s_branch gd_kernel_fin
gd_kernel_Q:
    s_setprio 0
    s_sub_u32 s56, s56, 4
    s_lshl_b32 s70, s56, 11
    s_add_u32 s71, s70, 147456
    s_mov_b32 s66, s70
    s_bfe_u32 s38, s2, 0x30003
    s_lshr_b32 s39, s2, 6
    s_add_u32 s38, s38, s39
    s_and_b32 s38, s38, 3
    s_mov_b32 s36, 0x76453210
    s_mov_b32 s37, 0xfecdba89
    s_cmp_eq_u32 s38, 1
    s_cselect_b32 s36, 0x75643120, s36
    s_cselect_b32 s37, 0xfdecb9a8, s37
    s_cmp_eq_u32 s38, 2
    s_cselect_b32 s36, 0x67542310, s36
    s_cselect_b32 s37, 0xefdcab98, s37
    s_cmp_eq_u32 s38, 3
    s_cselect_b32 s36, 0x86534210, s36
    s_cselect_b32 s37, 0xfedbca97, s37
    s_lshl_b32 s77, s60, 8
    v_lshrrev_b32 v3, 4, v1
    s_lshl_b32 s76, s56, 3
    v_add_u32 v2, s76, v3
    s_and_b32 s76, s76, 8
    v_lshl_or_b32 v3, v3, 1, s76
    s_movk_i32 s76, 7168
    v_mul_u32_u24 v2, s76, v2
    v_add_u32 v2, s77, v2
    v_and_b32 v4, 15, v1
    v_xor_b32 v3, v3, v4
    v_lshl_add_u32 v200, v3, 4, v2
    v_add_u32 v201, 27648, v200
    s_lshl_b32 s77, s56, 5
    s_add_u32 s77, s77, s59
    v_and_b32 v4, 7, v1
    v_lshrrev_b32 v5, 3, v1
    s_movk_i32 s76, 2176
    v_lshrrev_b32 v3, 4, v1
    v_xor_b32 v3, v3, v4
    v_add_u32 v2, s77, v5
    v_mul_lo_u32 v2, s76, v2
    v_lshl_add_u32 v184, v3, 4, v2
    v_lshrrev_b32 v3, 4, v1
    v_or_b32 v3, 4, v3
    v_xor_b32 v3, v3, v4
    v_add_u32 v2, s77, v5
    v_add_u32 v2, 8, v2
    v_mul_lo_u32 v2, s76, v2
    v_lshl_add_u32 v185, v3, 4, v2
    v_lshrrev_b32 v3, 4, v1
    v_xor_b32 v3, v3, v4
    v_add_u32 v2, s77, v5
    v_add_u32 v2, 16, v2
    v_mul_lo_u32 v2, s76, v2
    v_lshl_add_u32 v186, v3, 4, v2
    v_lshrrev_b32 v3, 4, v1
    v_or_b32 v3, 4, v3
    v_xor_b32 v3, v3, v4
    v_add_u32 v2, s77, v5
    v_add_u32 v2, 24, v2
    v_mul_lo_u32 v2, s76, v2
    v_lshl_add_u32 v187, v3, 4, v2
    v_subrev_u32 v185, 1024, v185
    v_subrev_u32 v186, 2048, v186
    v_subrev_u32 v187, 3072, v187
    s_waitcnt lgkmcnt(0)
    s_mov_b32 s16, s4
    s_mov_b32 s17, s5
    s_mov_b32 s18, 0x700000
    s_mov_b32 s19, 0x20000
    s_mov_b32 s20, s6
    s_mov_b32 s21, s7
    s_mov_b32 s22, 0x700000
    s_mov_b32 s23, 0x20000
    s_add_u32 s12, s8, 0x1000000
    s_addc_u32 s13, s9, 0
    s_mov_b32 s14, 0x440000
    s_mov_b32 s15, 0x20000
    s_and_b32 s69, s36, 15
    s_lshr_b64 s[36:37], s[36:37], 4
    s_lshl_b32 s68, s69, 7
    s_mul_i32 s69, s69, 0x70000
    s_add_u32 m0, s66, 16384
    s_nop 0
    buffer_load_dwordx4 v200, s[16:19], s69 offen offset:0 lds
    buffer_load_dwordx4 v201, s[16:19], s69 offen offset:1024 lds
    s_add_u32 m0, s66, 32768
    s_nop 0
    buffer_load_dwordx4 v200, s[20:23], s69 offen offset:0 lds
    buffer_load_dwordx4 v201, s[20:23], s69 offen offset:1024 lds
    s_add_u32 s69, s69, 0x38000
    s_add_u32 m0, s66, s70
    s_nop 0
    buffer_load_dwordx4 v184, s[12:15], s68 offen offset:0 lds
    buffer_load_dwordx4 v185, s[12:15], s68 offen offset:1024 lds
    buffer_load_dwordx4 v186, s[12:15], s68 offen offset:2048 lds
    buffer_load_dwordx4 v187, s[12:15], s68 offen offset:3072 lds
    s_add_u32 m0, s66, 24576
    s_nop 0
    buffer_load_dwordx4 v200, s[16:19], s69 offen offset:0 lds
    buffer_load_dwordx4 v201, s[16:19], s69 offen offset:1024 lds
    s_add_u32 m0, s66, 40960
    s_nop 0
    buffer_load_dwordx4 v200, s[20:23], s69 offen offset:0 lds
    buffer_load_dwordx4 v201, s[20:23], s69 offen offset:1024 lds
    s_add_u32 s66, s66, 49152
    s_cmp_ge_u32 s66, s71
    s_cselect_b32 s66, s70, s66
    s_and_b32 s69, s36, 15
    s_lshr_b64 s[36:37], s[36:37], 4
    s_lshl_b32 s68, s69, 7
    s_mul_i32 s69, s69, 0x70000
    s_add_u32 m0, s66, 16384
    s_nop 0
    buffer_load_dwordx4 v200, s[16:19], s69 offen offset:0 lds
    buffer_load_dwordx4 v201, s[16:19], s69 offen offset:1024 lds
    s_add_u32 m0, s66, 32768
    s_nop 0
    buffer_load_dwordx4 v200, s[20:23], s69 offen offset:0 lds
    buffer_load_dwordx4 v201, s[20:23], s69 offen offset:1024 lds
    s_add_u32 s69, s69, 0x38000
    s_add_u32 m0, s66, s70
    s_nop 0
    buffer_load_dwordx4 v184, s[12:15], s68 offen offset:0 lds
    buffer_load_dwordx4 v185, s[12:15], s68 offen offset:1024 lds
    buffer_load_dwordx4 v186, s[12:15], s68 offen offset:2048 lds
    buffer_load_dwordx4 v187, s[12:15], s68 offen offset:3072 lds
    s_add_u32 m0, s66, 24576
    s_nop 0
    buffer_load_dwordx4 v200, s[16:19], s69 offen offset:0 lds
    buffer_load_dwordx4 v201, s[16:19], s69 offen offset:1024 lds
    s_add_u32 m0, s66, 40960
    s_nop 0
    buffer_load_dwordx4 v200, s[20:23], s69 offen offset:0 lds
    buffer_load_dwordx4 v201, s[20:23], s69 offen offset:1024 lds
    s_add_u32 s66, s66, 49152
    s_cmp_ge_u32 s66, s71
    s_cselect_b32 s66, s70, s66
    s_and_b32 s69, s36, 15
    s_lshr_b64 s[36:37], s[36:37], 4
    s_lshl_b32 s68, s69, 7
    s_mul_i32 s69, s69, 0x70000
    s_add_u32 m0, s66, 16384
    s_nop 0
    buffer_load_dwordx4 v200, s[16:19], s69 offen offset:0 lds
    buffer_load_dwordx4 v201, s[16:19], s69 offen offset:1024 lds
    s_add_u32 m0, s66, 32768
    s_nop 0
    buffer_load_dwordx4 v200, s[20:23], s69 offen offset:0 lds
    buffer_load_dwordx4 v201, s[20:23], s69 offen offset:1024 lds
    s_add_u32 s69, s69, 0x38000
    s_add_u32 m0, s66, s70
    s_nop 0
    buffer_load_dwordx4 v184, s[12:15], s68 offen offset:0 lds
    buffer_load_dwordx4 v185, s[12:15], s68 offen offset:1024 lds
    buffer_load_dwordx4 v186, s[12:15], s68 offen offset:2048 lds
    buffer_load_dwordx4 v187, s[12:15], s68 offen offset:3072 lds
    s_add_u32 m0, s66, 24576
    s_nop 0
    buffer_load_dwordx4 v200, s[16:19], s69 offen offset:0 lds
    buffer_load_dwordx4 v201, s[16:19], s69 offen offset:1024 lds
    s_add_u32 m0, s66, 40960
    s_nop 0
    buffer_load_dwordx4 v200, s[20:23], s69 offen offset:0 lds
    buffer_load_dwordx4 v201, s[20:23], s69 offen offset:1024 lds
    s_add_u32 s66, s66, 49152
    s_cmp_ge_u32 s66, s71
    s_cselect_b32 s66, s70, s66
    s_lshr_b32 s57, s56, 1
    s_and_b32 s58, s56, 1
    s_mov_b32 s65, 49152
    s_lshr_b32 s3, s60, 2
    s_sub_u32 s3, s60, s3
    s_add_u32 s3, s3, 16
    s_cmp_ge_u32 s2, 192
    s_lshl_b32 s77, s3, 8
    v_lshrrev_b32 v3, 4, v1
    s_lshl_b32 s76, s56, 3
    v_add_u32 v2, s76, v3
    s_and_b32 s76, s76, 8
    v_lshl_or_b32 v3, v3, 1, s76
    s_movk_i32 s76, 7168
    v_mul_u32_u24 v2, s76, v2
    v_add_u32 v2, s77, v2
    v_and_b32 v4, 15, v1
    v_xor_b32 v3, v3, v4
    v_lshl_add_u32 v188, v3, 4, v2
    v_add_u32 v189, 27648, v188
    v_and_b32 v2, 15, v1
    v_lshrrev_b32 v3, 4, v1
    v_lshrrev_b32 v4, 1, v2
    v_xor_b32 v4, v4, v3
    v_lshlrev_b32 v4, 4, v4
    v_lshl_add_u32 v4, v2, 7, v4
    s_lshl_b32 s76, s57, 13
    v_add_u32 v233, s76, v4
    v_xor_b32 v234, 64, v233
    v_lshrrev_b32 v3, 4, v1
    v_bfe_u32 v2, v1, 2, 2
    v_mul_u32_u24 v2, 0xc0, v2
    v_lshl_add_u32 v2, v3, 11, v2
    v_and_b32 v4, 3, v1
    v_lshl_add_u32 v2, v4, 3, v2
    v_add_u32 v2, 16384, v2
    v_and_b32 v3, 1, v3
    s_cmp_eq_u32 s58, 0
    s_cselect_b32 s76, 0, 4
    v_xor_b32 v4, s76, v3
    v_lshl_add_u32 v239, v4, 5, v2
    s_cselect_b32 s76, 1, 5
    v_xor_b32 v4, s76, v3
    v_lshl_add_u32 v240, v4, 5, v2
    s_cselect_b32 s76, 2, 3
    v_xor_b32 v4, s76, v3
    v_lshl_add_u32 v241, v4, 5, v2
    v_lshrrev_b32 v3, 4, v1
    v_bfe_u32 v2, v1, 2, 2
    v_lshl_add_u32 v4, v3, 3, v2
    v_lshlrev_b32 v4, 8, v4
    v_and_b32 v5, 3, v1
    v_lshl_add_u32 v4, v5, 3, v4
    v_add_u32 v4, 16384, v4
    v_and_b32 v3, 1, v3
    v_lshl_or_b32 v2, v3, 2, v2
    s_lshl_b32 s76, s58, 2
    v_xor_b32 v2, s76, v2
    v_xor_b32 v3, 0, v2
    v_lshl_add_u32 v239, v3, 5, v4
    v_xor_b32 v3, 1, v2
    v_lshl_add_u32 v240, v3, 5, v4
    v_xor_b32 v3, 2, v2
    v_lshl_add_u32 v241, v3, 5, v4
    v_xor_b32 v3, 3, v2
    v_lshl_add_u32 v242, v3, 5, v4
    s_and_b32 s3, s2, 7
    s_lshr_b32 s76, s2, 3
    s_and_b32 s61, s76, 1
    s_and_b32 s62, s3, 3
    s_lshl_b32 s62, s62, 2
    s_bfe_u32 s77, s76, 0x20001
    s_add_u32 s62, s62, s77
    s_lshr_b32 s63, s3, 2
    s_lshl_b32 s63, s63, 2
    s_lshr_b32 s77, s76, 3
    s_add_u32 s63, s63, s77
    s_lshl_b32 s64, s62, 3
    s_add_u32 s64, s64, s63
    s_lshl_b32 s76, s62, 3
    s_lshl_b32 s77, s56, 1
    s_add_u32 s76, s76, s77
    s_mul_i32 s76, s76, 114688
    v_lshl_add_u32 v246, v1, 4, s76
    v_add_u32 v247, 112640, v246
    s_lshl_b32 s77, s63, 8
    v_lshrrev_b32 v3, 4, v1
    s_lshl_b32 s76, s56, 4
    v_add_u32 v2, s76, v3
    s_movk_i32 s76, 2048
    v_mul_u32_u24 v2, s76, v2
    v_add_u32 v2, s77, v2
    v_lshlrev_b32 v3, 1, v3
    v_and_b32 v4, 15, v1
    v_xor_b32 v3, v3, v4
    v_lshl_add_u32 v248, v3, 4, v2
    v_add_u32 v249, 7168, v248
    v_xor_b32 v3, 8, v3
    v_lshl_add_u32 v250, v3, 4, v2
    v_add_u32 v250, 14336, v250
    v_add_u32 v251, 7168, v250
    s_add_u32 s24, s8, 0x1500000
    s_addc_u32 s25, s9, 0
    s_mov_b32 s26, 0xe00000
    s_mov_b32 s27, 0x20000
    s_mov_b32 s28, s10
    s_mov_b32 s29, s11
    s_mov_b32 s30, 0x700000
    s_mov_b32 s31, 0x20000
    s_add_u32 s32, s8, 0x50000
    s_addc_u32 s33, s9, 0
    s_mov_b32 s34, 0x3000
    s_mov_b32 s35, 0x20000
    s_mov_b32 s74, 0xbfb8aa3b
    s_mov_b32 s75, 0xbfb8aa3b
    v_and_b32 v2, 255, v0
    s_lshl_b32 s76, s2, 8
    s_sub_u32 s76, s76, 49152
    v_add_lshl_u32 v243, v2, s76, 7
    s_cmp_ge_u32 s2, 192
    s_cselect_b32 s76, 0, 0x80000000
    v_and_b32 v243, 0x7fffffff, v243
    v_or_b32 v243, s76, v243
    v_min_u32 v243, 0x80000000, v243
    v_and_b32 v2, 15, v1
    v_lshlrev_b32 v2, 4, v2
    v_bfe_u32 v3, v1, 4, 1
    v_lshl_add_u32 v2, v3, 9, v2
    v_lshrrev_b32 v3, 5, v1
    v_lshl_add_u32 v198, v3, 8, v2
    s_lshr_b32 s76, s59, 4
    s_lshl_b32 s77, s57, 2
    s_add_u32 s76, s76, s77
    s_mul_i32 s76, s76, 114688
    s_mul_i32 s77, s60, 3072
    s_add_u32 s76, s76, s77
    s_add_u32 s76, s76, 65536
    s_lshl_b32 s77, s58, 11
    s_add_u32 s77, s76, s77
    v_add_u32 v198, s77, v198
    s_lshl_b32 s77, s58, 9
    s_add_u32 s76, s76, s77
    s_add_u32 s76, s76, 1024
    v_and_b32 v2, 15, v1
    v_lshl_add_u32 v2, v2, 4, s76
    v_lshrrev_b32 v3, 5, v1
    v_lshl_add_u32 v2, v3, 8, v2
    v_bfe_u32 v3, v1, 4, 1
    s_mov_b32 s76, 114688
    v_mad_u32_u24 v204, v3, s76, v2
    v_add_u32 v232, s65, v233
    v_add_u32 v235, s65, v239
    v_add_u32 v236, s65, v240
    v_add_u32 v237, s65, v241
    v_add_u32 v238, s65, v242
    s_waitcnt vmcnt(24)
    s_barrier
    s_movk_i32 s67, 12
gd_kernel_Q_loop0:
    s_waitcnt vmcnt(12)
    s_barrier
    s_and_b32 s69, s36, 15
    s_lshr_b64 s[36:37], s[36:37], 4
    s_lshl_b32 s68, s69, 7
    s_mul_i32 s69, s69, 0x70000
    s_add_u32 m0, s66, 16384
    s_nop 0
    buffer_load_dwordx4 v200, s[16:19], s69 offen offset:0 lds
    buffer_load_dwordx4 v201, s[16:19], s69 offen offset:1024 lds
    s_add_u32 m0, s66, 32768
    s_nop 0
    buffer_load_dwordx4 v200, s[20:23], s69 offen offset:0 lds
    buffer_load_dwordx4 v201, s[20:23], s69 offen offset:1024 lds
    s_add_u32 s69, s69, 0x38000
    s_add_u32 m0, s66, s70
    s_nop 0
    buffer_load_dwordx4 v184, s[12:15], s68 offen offset:0 lds
    buffer_load_dwordx4 v185, s[12:15], s68 offen offset:1024 lds
    buffer_load_dwordx4 v186, s[12:15], s68 offen offset:2048 lds
    buffer_load_dwordx4 v187, s[12:15], s68 offen offset:3072 lds
    s_add_u32 m0, s66, 24576
    s_nop 0
    buffer_load_dwordx4 v200, s[16:19], s69 offen offset:0 lds
    buffer_load_dwordx4 v201, s[16:19], s69 offen offset:1024 lds
    s_add_u32 m0, s66, 40960
    s_nop 0
    buffer_load_dwordx4 v200, s[20:23], s69 offen offset:0 lds
    buffer_load_dwordx4 v201, s[20:23], s69 offen offset:1024 lds
    s_add_u32 s66, s66, 49152
    s_cmp_ge_u32 s66, s71
    s_cselect_b32 s66, s70, s66
    s_sub_u32 s67, s67, 1
    s_cbranch_scc0 gd_kernel_Q_loop0
    s_waitcnt vmcnt(12)
    s_barrier
    s_bfe_u32 s38, s2, 0x30003
    s_lshr_b32 s39, s2, 6
    s_add_u32 s38, s38, s39
    s_mul_i32 s39, s38, 11
    s_lshr_b32 s39, s39, 5
    s_mul_i32 s39, s39, 3
    s_sub_u32 s38, s38, s39
    s_mov_b32 s36, 0x67534201
    s_mov_b32 s37, 0xfecdb9a8
    s_cmp_eq_u32 s38, 1
    s_cselect_b32 s36, 0x86453120, s36
    s_cselect_b32 s37, 0xfdecab97, s37
    s_cmp_eq_u32 s38, 2
    s_cselect_b32 s36, 0x75642310, s36
    s_cselect_b32 s37, 0xefdbca89, s37
    s_cmp_ge_u32 s2, 192
    s_cselect_b32 s14, 0, s14
    s_cselect_b32 s18, 0, s18
    s_cselect_b32 s22, 0, s22
    s_and_b32 s69, s36, 15
    s_lshr_b64 s[36:37], s[36:37], 4
    s_lshl_b32 s68, s69, 7
    s_mul_i32 s69, s69, 0x70000
    s_add_u32 m0, s66, 16384
    s_nop 0
    buffer_load_dwordx4 v188, s[16:19], s69 offen offset:0 lds
    buffer_load_dwordx4 v189, s[16:19], s69 offen offset:1024 lds
    s_add_u32 m0, s66, 32768
    s_nop 0
    buffer_load_dwordx4 v188, s[20:23], s69 offen offset:0 lds
    buffer_load_dwordx4 v189, s[20:23], s69 offen offset:1024 lds
    s_add_u32 s69, s69, 0x38000
    s_add_u32 m0, s66, s70
    s_nop 0
    buffer_load_dwordx4 v184, s[12:15], s68 offen offset:0 lds
    buffer_load_dwordx4 v185, s[12:15], s68 offen offset:1024 lds
    buffer_load_dwordx4 v186, s[12:15], s68 offen offset:2048 lds
    buffer_load_dwordx4 v187, s[12:15], s68 offen offset:3072 lds
    s_add_u32 m0, s66, 24576
    s_nop 0
    buffer_load_dwordx4 v188, s[16:19], s69 offen offset:0 lds
    buffer_load_dwordx4 v189, s[16:19], s69 offen offset:1024 lds
    s_add_u32 m0, s66, 40960
    s_nop 0
    buffer_load_dwordx4 v188, s[20:23], s69 offen offset:0 lds
    buffer_load_dwordx4 v189, s[20:23], s69 offen offset:1024 lds
    s_add_u32 s66, s66, 49152
    s_cmp_ge_u32 s66, s71
    s_cselect_b32 s66, s70, s66
    s_waitcnt vmcnt(12)
    s_barrier
    s_and_b32 s69, s36, 15
    s_lshr_b64 s[36:37], s[36:37], 4
    s_lshl_b32 s68, s69, 7
    s_mul_i32 s69, s69, 0x70000
    s_add_u32 m0, s66, 16384
    s_nop 0
    buffer_load_dwordx4 v188, s[16:19], s69 offen offset:0 lds
    buffer_load_dwordx4 v189, s[16:19], s69 offen offset:1024 lds
    s_add_u32 m0, s66, 32768
    s_nop 0
    buffer_load_dwordx4 v188, s[20:23], s69 offen offset:0 lds
    buffer_load_dwordx4 v189, s[20:23], s69 offen offset:1024 lds
    s_add_u32 s69, s69, 0x38000
    s_add_u32 m0, s66, s70
    s_nop 0
    buffer_load_dwordx4 v184, s[12:15], s68 offen offset:0 lds
    buffer_load_dwordx4 v185, s[12:15], s68 offen offset:1024 lds
    buffer_load_dwordx4 v186, s[12:15], s68 offen offset:2048 lds
    buffer_load_dwordx4 v187, s[12:15], s68 offen offset:3072 lds
    s_add_u32 m0, s66, 24576
    s_nop 0
    buffer_load_dwordx4 v188, s[16:19], s69 offen offset:0 lds
    buffer_load_dwordx4 v189, s[16:19], s69 offen offset:1024 lds
    s_add_u32 m0, s66, 40960
    s_nop 0
    buffer_load_dwordx4 v188, s[20:23], s69 offen offset:0 lds
    buffer_load_dwordx4 v189, s[20:23], s69 offen offset:1024 lds
    s_add_u32 s66, s66, 49152
    s_cmp_ge_u32 s66, s71
    s_cselect_b32 s66, s70, s66
    s_waitcnt vmcnt(12)
    s_barrier
    ds_read_b128 v[136:139], v232 offset:0
    ds_read_b64_tr_b16 v[152:153], v235 offset:0
    ds_read_b64_tr_b16 v[154:155], v235 offset:1024
    ds_read_b64_tr_b16 v[156:157], v236 offset:0
    ds_read_b64_tr_b16 v[158:159], v236 offset:1024
    ds_read_b64_tr_b16 v[160:161], v237 offset:0
    ds_read_b64_tr_b16 v[162:163], v237 offset:1024
    ds_read_b64_tr_b16 v[164:165], v238 offset:0
    ds_read_b64_tr_b16 v[166:167], v238 offset:1024
    ds_read_b64_tr_b16 v[168:169], v235 offset:16384
    ds_read_b64_tr_b16 v[170:171], v235 offset:17408
    ds_read_b64_tr_b16 v[172:173], v236 offset:16384
    ds_read_b64_tr_b16 v[174:175], v236 offset:17408
    ds_read_b64_tr_b16 v[176:177], v237 offset:16384
    ds_read_b64_tr_b16 v[178:179], v237 offset:17408
    ds_read_b64_tr_b16 v[180:181], v238 offset:16384
    ds_read_b64_tr_b16 v[182:183], v238 offset:17408
    ds_read_b128 v[140:143], v232 offset:2048
    ds_read_b128 v[144:147], v232 offset:4096
    ds_read_b128 v[148:151], v232 offset:6144
    s_and_b32 s69, s36, 15
    s_lshr_b64 s[36:37], s[36:37], 4
    s_lshl_b32 s68, s69, 7
    s_mul_i32 s69, s69, 0x70000
    s_add_u32 m0, s66, 16384
    s_nop 0
    buffer_load_dwordx4 v188, s[16:19], s69 offen offset:0 lds
    buffer_load_dwordx4 v189, s[16:19], s69 offen offset:1024 lds
    s_add_u32 m0, s66, 32768
    s_nop 0
    buffer_load_dwordx4 v188, s[20:23], s69 offen offset:0 lds
    buffer_load_dwordx4 v189, s[20:23], s69 offen offset:1024 lds
    s_add_u32 s69, s69, 0x38000
    s_add_u32 m0, s66, s70
    s_nop 0
    buffer_load_dwordx4 v184, s[12:15], s68 offen offset:0 lds
    buffer_load_dwordx4 v185, s[12:15], s68 offen offset:1024 lds
    buffer_load_dwordx4 v186, s[12:15], s68 offen offset:2048 lds
    buffer_load_dwordx4 v187, s[12:15], s68 offen offset:3072 lds
    s_add_u32 m0, s66, 24576
    s_nop 0
    buffer_load_dwordx4 v188, s[16:19], s69 offen offset:0 lds
    buffer_load_dwordx4 v189, s[16:19], s69 offen offset:1024 lds
    s_add_u32 m0, s66, 40960
    s_nop 0
    buffer_load_dwordx4 v188, s[20:23], s69 offen offset:0 lds
    buffer_load_dwordx4 v189, s[20:23], s69 offen offset:1024 lds
    s_add_u32 s66, s66, 49152
    s_cmp_ge_u32 s66, s71
    s_cselect_b32 s66, s70, s66
    s_setprio 2
    v_add_u32 v232, s65, v234
    s_add_u32 s65, s65, 49152
    s_cmp_ge_u32 s65, 147456
    s_cselect_b32 s65, 0, s65
    s_waitcnt lgkmcnt(0)
    v_mfma_f32_16x16x32_bf16 v[8:11], v[152:155], v[136:139], 0
    ds_read_b128 v[184:187], v232 offset:0
    v_mfma_f32_16x16x32_bf16 v[12:15], v[156:159], v[136:139], 0
    ds_read_b64_tr_b16 v[200:201], v235 offset:8192
    v_mfma_f32_16x16x32_bf16 v[16:19], v[160:163], v[136:139], 0
    ds_read_b64_tr_b16 v[202:203], v235 offset:9216
    v_mfma_f32_16x16x32_bf16 v[20:23], v[164:167], v[136:139], 0
    ds_read_b64_tr_b16 v[204:205], v236 offset:8192
    v_mfma_f32_16x16x32_bf16 v[24:27], v[168:171], v[136:139], 0
    v_mfma_f32_16x16x32_bf16 v[28:31], v[172:175], v[136:139], 0
    ds_read_b64_tr_b16 v[206:207], v236 offset:9216
    v_mfma_f32_16x16x32_bf16 v[32:35], v[176:179], v[136:139], 0
    ds_read_b64_tr_b16 v[208:209], v237 offset:8192
    v_mfma_f32_16x16x32_bf16 v[36:39], v[180:183], v[136:139], 0
    ds_read_b64_tr_b16 v[210:211], v237 offset:9216
    v_mfma_f32_16x16x32_bf16 v[40:43], v[152:155], v[140:143], 0
    ds_read_b64_tr_b16 v[212:213], v238 offset:8192
    v_mfma_f32_16x16x32_bf16 v[44:47], v[156:159], v[140:143], 0
    v_mfma_f32_16x16x32_bf16 v[48:51], v[160:163], v[140:143], 0
    ds_read_b64_tr_b16 v[214:215], v238 offset:9216
    v_mfma_f32_16x16x32_bf16 v[52:55], v[164:167], v[140:143], 0
    ds_read_b64_tr_b16 v[216:217], v235 offset:24576
    v_mfma_f32_16x16x32_bf16 v[56:59], v[168:171], v[140:143], 0
    ds_read_b64_tr_b16 v[218:219], v235 offset:25600
    v_mfma_f32_16x16x32_bf16 v[60:63], v[172:175], v[140:143], 0
    ds_read_b64_tr_b16 v[220:221], v236 offset:24576
    v_mfma_f32_16x16x32_bf16 v[64:67], v[176:179], v[140:143], 0
    v_mfma_f32_16x16x32_bf16 v[68:71], v[180:183], v[140:143], 0
    ds_read_b64_tr_b16 v[222:223], v236 offset:25600
    v_mfma_f32_16x16x32_bf16 v[72:75], v[152:155], v[144:147], 0
    ds_read_b64_tr_b16 v[224:225], v237 offset:24576
    v_mfma_f32_16x16x32_bf16 v[76:79], v[156:159], v[144:147], 0
    ds_read_b64_tr_b16 v[226:227], v237 offset:25600
    v_mfma_f32_16x16x32_bf16 v[80:83], v[160:163], v[144:147], 0
    ds_read_b64_tr_b16 v[228:229], v238 offset:24576
    v_mfma_f32_16x16x32_bf16 v[84:87], v[164:167], v[144:147], 0
    v_mfma_f32_16x16x32_bf16 v[88:91], v[168:171], v[144:147], 0
    ds_read_b64_tr_b16 v[230:231], v238 offset:25600
    v_mfma_f32_16x16x32_bf16 v[92:95], v[172:175], v[144:147], 0
    ds_read_b128 v[188:191], v232 offset:2048
    v_mfma_f32_16x16x32_bf16 v[96:99], v[176:179], v[144:147], 0
    ds_read_b128 v[192:195], v232 offset:4096
    v_mfma_f32_16x16x32_bf16 v[100:103], v[180:183], v[144:147], 0
    ds_read_b128 v[196:199], v232 offset:6144
    v_mfma_f32_16x16x32_bf16 v[104:107], v[152:155], v[148:151], 0
    v_mfma_f32_16x16x32_bf16 v[108:111], v[156:159], v[148:151], 0
    v_add_u32 v232, s65, v233
    v_mfma_f32_16x16x32_bf16 v[112:115], v[160:163], v[148:151], 0
    v_add_u32 v235, s65, v239
    v_mfma_f32_16x16x32_bf16 v[116:119], v[164:167], v[148:151], 0
    v_add_u32 v236, s65, v240
    v_mfma_f32_16x16x32_bf16 v[120:123], v[168:171], v[148:151], 0
    v_mfma_f32_16x16x32_bf16 v[124:127], v[172:175], v[148:151], 0
    v_add_u32 v237, s65, v241
    v_mfma_f32_16x16x32_bf16 v[128:131], v[176:179], v[148:151], 0
    v_add_u32 v238, s65, v242
    v_mfma_f32_16x16x32_bf16 v[132:135], v[180:183], v[148:151], 0
    s_waitcnt lgkmcnt(0)
    v_mfma_f32_16x16x32_bf16 v[8:11], v[200:203], v[184:187], v[8:11]
    s_waitcnt vmcnt(12)
    s_barrier
    v_mfma_f32_16x16x32_bf16 v[12:15], v[204:207], v[184:187], v[12:15]
    ds_read_b128 v[136:139], v232 offset:0
    v_mfma_f32_16x16x32_bf16 v[16:19], v[208:211], v[184:187], v[16:19]
    ds_read_b64_tr_b16 v[152:153], v235 offset:0
    v_mfma_f32_16x16x32_bf16 v[20:23], v[212:215], v[184:187], v[20:23]
    ds_read_b64_tr_b16 v[154:155], v235 offset:1024
    v_mfma_f32_16x16x32_bf16 v[24:27], v[216:219], v[184:187], v[24:27]
    ds_read_b64_tr_b16 v[156:157], v236 offset:0
    v_mfma_f32_16x16x32_bf16 v[28:31], v[220:223], v[184:187], v[28:31]
    ds_read_b64_tr_b16 v[158:159], v236 offset:1024
    v_mfma_f32_16x16x32_bf16 v[32:35], v[224:227], v[184:187], v[32:35]
    v_mfma_f32_16x16x32_bf16 v[36:39], v[228:231], v[184:187], v[36:39]
    ds_read_b64_tr_b16 v[160:161], v237 offset:0
    v_mfma_f32_16x16x32_bf16 v[40:43], v[200:203], v[188:191], v[40:43]
    ds_read_b64_tr_b16 v[162:163], v237 offset:1024
    v_mfma_f32_16x16x32_bf16 v[44:47], v[204:207], v[188:191], v[44:47]
    ds_read_b64_tr_b16 v[164:165], v238 offset:0
    v_mfma_f32_16x16x32_bf16 v[48:51], v[208:211], v[188:191], v[48:51]
    ds_read_b64_tr_b16 v[166:167], v238 offset:1024
    v_mfma_f32_16x16x32_bf16 v[52:55], v[212:215], v[188:191], v[52:55]
    ds_read_b64_tr_b16 v[168:169], v235 offset:16384
    v_mfma_f32_16x16x32_bf16 v[56:59], v[216:219], v[188:191], v[56:59]
    v_mfma_f32_16x16x32_bf16 v[60:63], v[220:223], v[188:191], v[60:63]
    ds_read_b64_tr_b16 v[170:171], v235 offset:17408
    v_mfma_f32_16x16x32_bf16 v[64:67], v[224:227], v[188:191], v[64:67]
    ds_read_b64_tr_b16 v[172:173], v236 offset:16384
    v_mfma_f32_16x16x32_bf16 v[68:71], v[228:231], v[188:191], v[68:71]
    ds_read_b64_tr_b16 v[174:175], v236 offset:17408
    v_mfma_f32_16x16x32_bf16 v[72:75], v[200:203], v[192:195], v[72:75]
    ds_read_b64_tr_b16 v[176:177], v237 offset:16384
    v_mfma_f32_16x16x32_bf16 v[76:79], v[204:207], v[192:195], v[76:79]
    ds_read_b64_tr_b16 v[178:179], v237 offset:17408
    v_mfma_f32_16x16x32_bf16 v[80:83], v[208:211], v[192:195], v[80:83]
    v_mfma_f32_16x16x32_bf16 v[84:87], v[212:215], v[192:195], v[84:87]
    ds_read_b64_tr_b16 v[180:181], v238 offset:16384
    v_mfma_f32_16x16x32_bf16 v[88:91], v[216:219], v[192:195], v[88:91]
    ds_read_b64_tr_b16 v[182:183], v238 offset:17408
    v_mfma_f32_16x16x32_bf16 v[92:95], v[220:223], v[192:195], v[92:95]
    ds_read_b128 v[140:143], v232 offset:2048
    v_mfma_f32_16x16x32_bf16 v[96:99], v[224:227], v[192:195], v[96:99]
    ds_read_b128 v[144:147], v232 offset:4096
    v_mfma_f32_16x16x32_bf16 v[100:103], v[228:231], v[192:195], v[100:103]
    ds_read_b128 v[148:151], v232 offset:6144
    v_mfma_f32_16x16x32_bf16 v[104:107], v[200:203], v[196:199], v[104:107]
    v_mfma_f32_16x16x32_bf16 v[108:111], v[204:207], v[196:199], v[108:111]
    v_add_u32 v232, s65, v234
    v_mfma_f32_16x16x32_bf16 v[112:115], v[208:211], v[196:199], v[112:115]
    v_mfma_f32_16x16x32_bf16 v[116:119], v[212:215], v[196:199], v[116:119]
    v_mfma_f32_16x16x32_bf16 v[120:123], v[216:219], v[196:199], v[120:123]
    v_mfma_f32_16x16x32_bf16 v[124:127], v[220:223], v[196:199], v[124:127]
    v_mfma_f32_16x16x32_bf16 v[128:131], v[224:227], v[196:199], v[128:131]
    s_add_u32 s65, s65, 49152
    s_cmp_ge_u32 s65, 147456
    s_cselect_b32 s65, 0, s65
    v_mfma_f32_16x16x32_bf16 v[132:135], v[228:231], v[196:199], v[132:135]
    s_waitcnt lgkmcnt(0)
    v_mfma_f32_16x16x32_bf16 v[8:11], v[152:155], v[136:139], v[8:11]
    ds_read_b128 v[184:187], v232 offset:0
    v_mfma_f32_16x16x32_bf16 v[12:15], v[156:159], v[136:139], v[12:15]
    ds_read_b64_tr_b16 v[200:201], v235 offset:8192
    v_mfma_f32_16x16x32_bf16 v[16:19], v[160:163], v[136:139], v[16:19]
    ds_read_b64_tr_b16 v[202:203], v235 offset:9216
    v_mfma_f32_16x16x32_bf16 v[20:23], v[164:167], v[136:139], v[20:23]
    ds_read_b64_tr_b16 v[204:205], v236 offset:8192
    v_mfma_f32_16x16x32_bf16 v[24:27], v[168:171], v[136:139], v[24:27]
    v_mfma_f32_16x16x32_bf16 v[28:31], v[172:175], v[136:139], v[28:31]
    ds_read_b64_tr_b16 v[206:207], v236 offset:9216
    v_mfma_f32_16x16x32_bf16 v[32:35], v[176:179], v[136:139], v[32:35]
    ds_read_b64_tr_b16 v[208:209], v237 offset:8192
    v_mfma_f32_16x16x32_bf16 v[36:39], v[180:183], v[136:139], v[36:39]
    ds_read_b64_tr_b16 v[210:211], v237 offset:9216
    v_mfma_f32_16x16x32_bf16 v[40:43], v[152:155], v[140:143], v[40:43]
    ds_read_b64_tr_b16 v[212:213], v238 offset:8192
    v_mfma_f32_16x16x32_bf16 v[44:47], v[156:159], v[140:143], v[44:47]
    v_mfma_f32_16x16x32_bf16 v[48:51], v[160:163], v[140:143], v[48:51]
    ds_read_b64_tr_b16 v[214:215], v238 offset:9216
    v_mfma_f32_16x16x32_bf16 v[52:55], v[164:167], v[140:143], v[52:55]
    ds_read_b64_tr_b16 v[216:217], v235 offset:24576
    v_mfma_f32_16x16x32_bf16 v[56:59], v[168:171], v[140:143], v[56:59]
    ds_read_b64_tr_b16 v[218:219], v235 offset:25600
    v_mfma_f32_16x16x32_bf16 v[60:63], v[172:175], v[140:143], v[60:63]
    ds_read_b64_tr_b16 v[220:221], v236 offset:24576
    v_mfma_f32_16x16x32_bf16 v[64:67], v[176:179], v[140:143], v[64:67]
    v_mfma_f32_16x16x32_bf16 v[68:71], v[180:183], v[140:143], v[68:71]
    ds_read_b64_tr_b16 v[222:223], v236 offset:25600
    v_mfma_f32_16x16x32_bf16 v[72:75], v[152:155], v[144:147], v[72:75]
    ds_read_b64_tr_b16 v[224:225], v237 offset:24576
    v_mfma_f32_16x16x32_bf16 v[76:79], v[156:159], v[144:147], v[76:79]
    ds_read_b64_tr_b16 v[226:227], v237 offset:25600
    v_mfma_f32_16x16x32_bf16 v[80:83], v[160:163], v[144:147], v[80:83]
    ds_read_b64_tr_b16 v[228:229], v238 offset:24576
    v_mfma_f32_16x16x32_bf16 v[84:87], v[164:167], v[144:147], v[84:87]
    v_mfma_f32_16x16x32_bf16 v[88:91], v[168:171], v[144:147], v[88:91]
    ds_read_b64_tr_b16 v[230:231], v238 offset:25600
    v_mfma_f32_16x16x32_bf16 v[92:95], v[172:175], v[144:147], v[92:95]
    ds_read_b128 v[188:191], v232 offset:2048
    v_mfma_f32_16x16x32_bf16 v[96:99], v[176:179], v[144:147], v[96:99]
    ds_read_b128 v[192:195], v232 offset:4096
    v_mfma_f32_16x16x32_bf16 v[100:103], v[180:183], v[144:147], v[100:103]
    ds_read_b128 v[196:199], v232 offset:6144
    v_mfma_f32_16x16x32_bf16 v[104:107], v[152:155], v[148:151], v[104:107]
    v_mfma_f32_16x16x32_bf16 v[108:111], v[156:159], v[148:151], v[108:111]
    v_add_u32 v232, s65, v233
    v_mfma_f32_16x16x32_bf16 v[112:115], v[160:163], v[148:151], v[112:115]
    v_add_u32 v235, s65, v239
    v_mfma_f32_16x16x32_bf16 v[116:119], v[164:167], v[148:151], v[116:119]
    v_add_u32 v236, s65, v240
    v_mfma_f32_16x16x32_bf16 v[120:123], v[168:171], v[148:151], v[120:123]
    v_mfma_f32_16x16x32_bf16 v[124:127], v[172:175], v[148:151], v[124:127]
    v_add_u32 v237, s65, v241
    v_mfma_f32_16x16x32_bf16 v[128:131], v[176:179], v[148:151], v[128:131]
    v_add_u32 v238, s65, v242
    v_mfma_f32_16x16x32_bf16 v[132:135], v[180:183], v[148:151], v[132:135]
    s_waitcnt lgkmcnt(0)
    v_mfma_f32_16x16x32_bf16 v[8:11], v[200:203], v[184:187], v[8:11]
    s_waitcnt vmcnt(0)
    s_barrier
    v_mfma_f32_16x16x32_bf16 v[12:15], v[204:207], v[184:187], v[12:15]
    ds_read_b128 v[136:139], v232 offset:0
    v_mfma_f32_16x16x32_bf16 v[16:19], v[208:211], v[184:187], v[16:19]
    ds_read_b64_tr_b16 v[152:153], v235 offset:0
    v_mfma_f32_16x16x32_bf16 v[20:23], v[212:215], v[184:187], v[20:23]
    ds_read_b64_tr_b16 v[154:155], v235 offset:1024
    v_mfma_f32_16x16x32_bf16 v[24:27], v[216:219], v[184:187], v[24:27]
    ds_read_b64_tr_b16 v[156:157], v236 offset:0
    v_mfma_f32_16x16x32_bf16 v[28:31], v[220:223], v[184:187], v[28:31]
    ds_read_b64_tr_b16 v[158:159], v236 offset:1024
    v_mfma_f32_16x16x32_bf16 v[32:35], v[224:227], v[184:187], v[32:35]
    v_mfma_f32_16x16x32_bf16 v[36:39], v[228:231], v[184:187], v[36:39]
    ds_read_b64_tr_b16 v[160:161], v237 offset:0
    v_mfma_f32_16x16x32_bf16 v[40:43], v[200:203], v[188:191], v[40:43]
    ds_read_b64_tr_b16 v[162:163], v237 offset:1024
    v_mfma_f32_16x16x32_bf16 v[44:47], v[204:207], v[188:191], v[44:47]
    ds_read_b64_tr_b16 v[164:165], v238 offset:0
    v_mfma_f32_16x16x32_bf16 v[48:51], v[208:211], v[188:191], v[48:51]
    ds_read_b64_tr_b16 v[166:167], v238 offset:1024
    v_mfma_f32_16x16x32_bf16 v[52:55], v[212:215], v[188:191], v[52:55]
    ds_read_b64_tr_b16 v[168:169], v235 offset:16384
    v_mfma_f32_16x16x32_bf16 v[56:59], v[216:219], v[188:191], v[56:59]
    v_mfma_f32_16x16x32_bf16 v[60:63], v[220:223], v[188:191], v[60:63]
    ds_read_b64_tr_b16 v[170:171], v235 offset:17408
    v_mfma_f32_16x16x32_bf16 v[64:67], v[224:227], v[188:191], v[64:67]
    ds_read_b64_tr_b16 v[172:173], v236 offset:16384
    v_mfma_f32_16x16x32_bf16 v[68:71], v[228:231], v[188:191], v[68:71]
    ds_read_b64_tr_b16 v[174:175], v236 offset:17408
    v_mfma_f32_16x16x32_bf16 v[72:75], v[200:203], v[192:195], v[72:75]
    ds_read_b64_tr_b16 v[176:177], v237 offset:16384
    v_mfma_f32_16x16x32_bf16 v[76:79], v[204:207], v[192:195], v[76:79]
    ds_read_b64_tr_b16 v[178:179], v237 offset:17408
    v_mfma_f32_16x16x32_bf16 v[80:83], v[208:211], v[192:195], v[80:83]
    v_mfma_f32_16x16x32_bf16 v[84:87], v[212:215], v[192:195], v[84:87]
    ds_read_b64_tr_b16 v[180:181], v238 offset:16384
    v_mfma_f32_16x16x32_bf16 v[88:91], v[216:219], v[192:195], v[88:91]
    ds_read_b64_tr_b16 v[182:183], v238 offset:17408
    v_mfma_f32_16x16x32_bf16 v[92:95], v[220:223], v[192:195], v[92:95]
    ds_read_b128 v[140:143], v232 offset:2048
    v_mfma_f32_16x16x32_bf16 v[96:99], v[224:227], v[192:195], v[96:99]
    ds_read_b128 v[144:147], v232 offset:4096
    v_mfma_f32_16x16x32_bf16 v[100:103], v[228:231], v[192:195], v[100:103]
    ds_read_b128 v[148:151], v232 offset:6144
    v_mfma_f32_16x16x32_bf16 v[104:107], v[200:203], v[196:199], v[104:107]
    v_mfma_f32_16x16x32_bf16 v[108:111], v[204:207], v[196:199], v[108:111]
    v_add_u32 v232, s65, v234
    v_mfma_f32_16x16x32_bf16 v[112:115], v[208:211], v[196:199], v[112:115]
    v_mfma_f32_16x16x32_bf16 v[116:119], v[212:215], v[196:199], v[116:119]
    v_mfma_f32_16x16x32_bf16 v[120:123], v[216:219], v[196:199], v[120:123]
    v_mfma_f32_16x16x32_bf16 v[124:127], v[220:223], v[196:199], v[124:127]
    v_mfma_f32_16x16x32_bf16 v[128:131], v[224:227], v[196:199], v[128:131]
    s_add_u32 s65, s65, 49152
    s_cmp_ge_u32 s65, 147456
    s_cselect_b32 s65, 0, s65
    v_mfma_f32_16x16x32_bf16 v[132:135], v[228:231], v[196:199], v[132:135]
    s_waitcnt lgkmcnt(0)
    v_mfma_f32_16x16x32_bf16 v[8:11], v[152:155], v[136:139], v[8:11]
    ds_read_b128 v[184:187], v232 offset:0
    v_mfma_f32_16x16x32_bf16 v[12:15], v[156:159], v[136:139], v[12:15]
    ds_read_b64_tr_b16 v[200:201], v235 offset:8192
    v_mfma_f32_16x16x32_bf16 v[16:19], v[160:163], v[136:139], v[16:19]
    ds_read_b64_tr_b16 v[202:203], v235 offset:9216
    v_mfma_f32_16x16x32_bf16 v[20:23], v[164:167], v[136:139], v[20:23]
    ds_read_b64_tr_b16 v[204:205], v236 offset:8192
    v_mfma_f32_16x16x32_bf16 v[24:27], v[168:171], v[136:139], v[24:27]
    v_mfma_f32_16x16x32_bf16 v[28:31], v[172:175], v[136:139], v[28:31]
    ds_read_b64_tr_b16 v[206:207], v236 offset:9216
    v_mfma_f32_16x16x32_bf16 v[32:35], v[176:179], v[136:139], v[32:35]
    ds_read_b64_tr_b16 v[208:209], v237 offset:8192
    v_mfma_f32_16x16x32_bf16 v[36:39], v[180:183], v[136:139], v[36:39]
    ds_read_b64_tr_b16 v[210:211], v237 offset:9216
    v_mfma_f32_16x16x32_bf16 v[40:43], v[152:155], v[140:143], v[40:43]
    ds_read_b64_tr_b16 v[212:213], v238 offset:8192
    v_mfma_f32_16x16x32_bf16 v[44:47], v[156:159], v[140:143], v[44:47]
    v_mfma_f32_16x16x32_bf16 v[48:51], v[160:163], v[140:143], v[48:51]
    ds_read_b64_tr_b16 v[214:215], v238 offset:9216
    v_mfma_f32_16x16x32_bf16 v[52:55], v[164:167], v[140:143], v[52:55]
    ds_read_b64_tr_b16 v[216:217], v235 offset:24576
    v_mfma_f32_16x16x32_bf16 v[56:59], v[168:171], v[140:143], v[56:59]
    ds_read_b64_tr_b16 v[218:219], v235 offset:25600
    v_mfma_f32_16x16x32_bf16 v[60:63], v[172:175], v[140:143], v[60:63]
    ds_read_b64_tr_b16 v[220:221], v236 offset:24576
    v_mfma_f32_16x16x32_bf16 v[64:67], v[176:179], v[140:143], v[64:67]
    v_mfma_f32_16x16x32_bf16 v[68:71], v[180:183], v[140:143], v[68:71]
    ds_read_b64_tr_b16 v[222:223], v236 offset:25600
    v_mfma_f32_16x16x32_bf16 v[72:75], v[152:155], v[144:147], v[72:75]
    ds_read_b64_tr_b16 v[224:225], v237 offset:24576
    v_mfma_f32_16x16x32_bf16 v[76:79], v[156:159], v[144:147], v[76:79]
    ds_read_b64_tr_b16 v[226:227], v237 offset:25600
    v_mfma_f32_16x16x32_bf16 v[80:83], v[160:163], v[144:147], v[80:83]
    ds_read_b64_tr_b16 v[228:229], v238 offset:24576
    v_mfma_f32_16x16x32_bf16 v[84:87], v[164:167], v[144:147], v[84:87]
    v_mfma_f32_16x16x32_bf16 v[88:91], v[168:171], v[144:147], v[88:91]
    ds_read_b64_tr_b16 v[230:231], v238 offset:25600
    v_mfma_f32_16x16x32_bf16 v[92:95], v[172:175], v[144:147], v[92:95]
    ds_read_b128 v[188:191], v232 offset:2048
    v_mfma_f32_16x16x32_bf16 v[96:99], v[176:179], v[144:147], v[96:99]
    ds_read_b128 v[192:195], v232 offset:4096
    v_mfma_f32_16x16x32_bf16 v[100:103], v[180:183], v[144:147], v[100:103]
    ds_read_b128 v[196:199], v232 offset:6144
    v_mfma_f32_16x16x32_bf16 v[104:107], v[152:155], v[148:151], v[104:107]
    v_mfma_f32_16x16x32_bf16 v[108:111], v[156:159], v[148:151], v[108:111]
    v_add_u32 v232, s65, v233
    v_mfma_f32_16x16x32_bf16 v[112:115], v[160:163], v[148:151], v[112:115]
    v_add_u32 v235, s65, v239
    v_mfma_f32_16x16x32_bf16 v[116:119], v[164:167], v[148:151], v[116:119]
    v_add_u32 v236, s65, v240
    v_mfma_f32_16x16x32_bf16 v[120:123], v[168:171], v[148:151], v[120:123]
    v_mfma_f32_16x16x32_bf16 v[124:127], v[172:175], v[148:151], v[124:127]
    v_add_u32 v237, s65, v241
    v_mfma_f32_16x16x32_bf16 v[128:131], v[176:179], v[148:151], v[128:131]
    v_add_u32 v238, s65, v242
    v_mfma_f32_16x16x32_bf16 v[132:135], v[180:183], v[148:151], v[132:135]
    s_waitcnt lgkmcnt(0)
    v_mfma_f32_16x16x32_bf16 v[8:11], v[200:203], v[184:187], v[8:11]
    s_barrier
    v_mfma_f32_16x16x32_bf16 v[12:15], v[204:207], v[184:187], v[12:15]
    ds_read_b128 v[136:139], v232 offset:0
    v_mfma_f32_16x16x32_bf16 v[16:19], v[208:211], v[184:187], v[16:19]
    ds_read_b64_tr_b16 v[152:153], v235 offset:0
    v_mfma_f32_16x16x32_bf16 v[20:23], v[212:215], v[184:187], v[20:23]
    ds_read_b64_tr_b16 v[154:155], v235 offset:1024
    v_mfma_f32_16x16x32_bf16 v[24:27], v[216:219], v[184:187], v[24:27]
    ds_read_b64_tr_b16 v[156:157], v236 offset:0
    v_mfma_f32_16x16x32_bf16 v[28:31], v[220:223], v[184:187], v[28:31]
    ds_read_b64_tr_b16 v[158:159], v236 offset:1024
    v_mfma_f32_16x16x32_bf16 v[32:35], v[224:227], v[184:187], v[32:35]
    v_mfma_f32_16x16x32_bf16 v[36:39], v[228:231], v[184:187], v[36:39]
    ds_read_b64_tr_b16 v[160:161], v237 offset:0
    v_mfma_f32_16x16x32_bf16 v[40:43], v[200:203], v[188:191], v[40:43]
    ds_read_b64_tr_b16 v[162:163], v237 offset:1024
    v_mfma_f32_16x16x32_bf16 v[44:47], v[204:207], v[188:191], v[44:47]
    ds_read_b64_tr_b16 v[164:165], v238 offset:0
    v_mfma_f32_16x16x32_bf16 v[48:51], v[208:211], v[188:191], v[48:51]
    ds_read_b64_tr_b16 v[166:167], v238 offset:1024
    v_mfma_f32_16x16x32_bf16 v[52:55], v[212:215], v[188:191], v[52:55]
    ds_read_b64_tr_b16 v[168:169], v235 offset:16384
    v_mfma_f32_16x16x32_bf16 v[56:59], v[216:219], v[188:191], v[56:59]
    v_mfma_f32_16x16x32_bf16 v[60:63], v[220:223], v[188:191], v[60:63]
    ds_read_b64_tr_b16 v[170:171], v235 offset:17408
    v_mfma_f32_16x16x32_bf16 v[64:67], v[224:227], v[188:191], v[64:67]
    ds_read_b64_tr_b16 v[172:173], v236 offset:16384
    v_mfma_f32_16x16x32_bf16 v[68:71], v[228:231], v[188:191], v[68:71]
    ds_read_b64_tr_b16 v[174:175], v236 offset:17408
    v_mfma_f32_16x16x32_bf16 v[72:75], v[200:203], v[192:195], v[72:75]
    ds_read_b64_tr_b16 v[176:177], v237 offset:16384
    v_mfma_f32_16x16x32_bf16 v[76:79], v[204:207], v[192:195], v[76:79]
    ds_read_b64_tr_b16 v[178:179], v237 offset:17408
    v_mfma_f32_16x16x32_bf16 v[80:83], v[208:211], v[192:195], v[80:83]
    v_mfma_f32_16x16x32_bf16 v[84:87], v[212:215], v[192:195], v[84:87]
    ds_read_b64_tr_b16 v[180:181], v238 offset:16384
    v_mfma_f32_16x16x32_bf16 v[88:91], v[216:219], v[192:195], v[88:91]
    ds_read_b64_tr_b16 v[182:183], v238 offset:17408
    v_mfma_f32_16x16x32_bf16 v[92:95], v[220:223], v[192:195], v[92:95]
    ds_read_b128 v[140:143], v232 offset:2048
    v_mfma_f32_16x16x32_bf16 v[96:99], v[224:227], v[192:195], v[96:99]
    ds_read_b128 v[144:147], v232 offset:4096
    v_mfma_f32_16x16x32_bf16 v[100:103], v[228:231], v[192:195], v[100:103]
    ds_read_b128 v[148:151], v232 offset:6144
    v_mfma_f32_16x16x32_bf16 v[104:107], v[200:203], v[196:199], v[104:107]
    v_mfma_f32_16x16x32_bf16 v[108:111], v[204:207], v[196:199], v[108:111]
    v_add_u32 v232, s65, v234
    v_mfma_f32_16x16x32_bf16 v[112:115], v[208:211], v[196:199], v[112:115]
    v_mfma_f32_16x16x32_bf16 v[116:119], v[212:215], v[196:199], v[116:119]
    v_mfma_f32_16x16x32_bf16 v[120:123], v[216:219], v[196:199], v[120:123]
    v_mfma_f32_16x16x32_bf16 v[124:127], v[220:223], v[196:199], v[124:127]
    v_mfma_f32_16x16x32_bf16 v[128:131], v[224:227], v[196:199], v[128:131]
    s_add_u32 s65, s65, 49152
    s_cmp_ge_u32 s65, 147456
    s_cselect_b32 s65, 0, s65
    v_mfma_f32_16x16x32_bf16 v[132:135], v[228:231], v[196:199], v[132:135]
    s_waitcnt lgkmcnt(0)
    v_mfma_f32_16x16x32_bf16 v[8:11], v[152:155], v[136:139], v[8:11]
    ds_read_b128 v[184:187], v232 offset:0
    v_mfma_f32_16x16x32_bf16 v[12:15], v[156:159], v[136:139], v[12:15]
    ds_read_b64_tr_b16 v[200:201], v235 offset:8192
    v_mfma_f32_16x16x32_bf16 v[16:19], v[160:163], v[136:139], v[16:19]
    ds_read_b64_tr_b16 v[202:203], v235 offset:9216
    v_mfma_f32_16x16x32_bf16 v[20:23], v[164:167], v[136:139], v[20:23]
    ds_read_b64_tr_b16 v[204:205], v236 offset:8192
    v_mfma_f32_16x16x32_bf16 v[24:27], v[168:171], v[136:139], v[24:27]
    v_mfma_f32_16x16x32_bf16 v[28:31], v[172:175], v[136:139], v[28:31]
    ds_read_b64_tr_b16 v[206:207], v236 offset:9216
    v_mfma_f32_16x16x32_bf16 v[32:35], v[176:179], v[136:139], v[32:35]
    ds_read_b64_tr_b16 v[208:209], v237 offset:8192
    v_mfma_f32_16x16x32_bf16 v[36:39], v[180:183], v[136:139], v[36:39]
    ds_read_b64_tr_b16 v[210:211], v237 offset:9216
    v_mfma_f32_16x16x32_bf16 v[40:43], v[152:155], v[140:143], v[40:43]
    ds_read_b64_tr_b16 v[212:213], v238 offset:8192
    v_mfma_f32_16x16x32_bf16 v[44:47], v[156:159], v[140:143], v[44:47]
    v_mfma_f32_16x16x32_bf16 v[48:51], v[160:163], v[140:143], v[48:51]
    ds_read_b64_tr_b16 v[214:215], v238 offset:9216
    v_mfma_f32_16x16x32_bf16 v[52:55], v[164:167], v[140:143], v[52:55]
    ds_read_b64_tr_b16 v[216:217], v235 offset:24576
    v_mfma_f32_16x16x32_bf16 v[56:59], v[168:171], v[140:143], v[56:59]
    ds_read_b64_tr_b16 v[218:219], v235 offset:25600
    v_mfma_f32_16x16x32_bf16 v[60:63], v[172:175], v[140:143], v[60:63]
    ds_read_b64_tr_b16 v[220:221], v236 offset:24576
    v_mfma_f32_16x16x32_bf16 v[64:67], v[176:179], v[140:143], v[64:67]
    v_mfma_f32_16x16x32_bf16 v[68:71], v[180:183], v[140:143], v[68:71]
    ds_read_b64_tr_b16 v[222:223], v236 offset:25600
    v_mfma_f32_16x16x32_bf16 v[72:75], v[152:155], v[144:147], v[72:75]
    ds_read_b64_tr_b16 v[224:225], v237 offset:24576
    v_mfma_f32_16x16x32_bf16 v[76:79], v[156:159], v[144:147], v[76:79]
    ds_read_b64_tr_b16 v[226:227], v237 offset:25600
    v_mfma_f32_16x16x32_bf16 v[80:83], v[160:163], v[144:147], v[80:83]
    ds_read_b64_tr_b16 v[228:229], v238 offset:24576
    v_mfma_f32_16x16x32_bf16 v[84:87], v[164:167], v[144:147], v[84:87]
    v_mfma_f32_16x16x32_bf16 v[88:91], v[168:171], v[144:147], v[88:91]
    ds_read_b64_tr_b16 v[230:231], v238 offset:25600
    v_mfma_f32_16x16x32_bf16 v[92:95], v[172:175], v[144:147], v[92:95]
    ds_read_b128 v[188:191], v232 offset:2048
    v_mfma_f32_16x16x32_bf16 v[96:99], v[176:179], v[144:147], v[96:99]
    ds_read_b128 v[192:195], v232 offset:4096
    v_mfma_f32_16x16x32_bf16 v[100:103], v[180:183], v[144:147], v[100:103]
    ds_read_b128 v[196:199], v232 offset:6144
    v_mfma_f32_16x16x32_bf16 v[104:107], v[152:155], v[148:151], v[104:107]
    v_mfma_f32_16x16x32_bf16 v[108:111], v[156:159], v[148:151], v[108:111]
    v_add_u32 v232, s65, v233
    v_mfma_f32_16x16x32_bf16 v[112:115], v[160:163], v[148:151], v[112:115]
    v_add_u32 v235, s65, v239
    v_mfma_f32_16x16x32_bf16 v[116:119], v[164:167], v[148:151], v[116:119]
    v_add_u32 v236, s65, v240
    v_mfma_f32_16x16x32_bf16 v[120:123], v[168:171], v[148:151], v[120:123]
    v_mfma_f32_16x16x32_bf16 v[124:127], v[172:175], v[148:151], v[124:127]
    v_add_u32 v237, s65, v241
    v_mfma_f32_16x16x32_bf16 v[128:131], v[176:179], v[148:151], v[128:131]
    v_add_u32 v238, s65, v242
    v_mfma_f32_16x16x32_bf16 v[132:135], v[180:183], v[148:151], v[132:135]
    s_waitcnt lgkmcnt(0)
    v_mfma_f32_16x16x32_bf16 v[8:11], v[200:203], v[184:187], v[8:11]
    s_barrier
    v_mfma_f32_16x16x32_bf16 v[12:15], v[204:207], v[184:187], v[12:15]
    ds_read_b128 v[136:139], v232 offset:0
    v_mfma_f32_16x16x32_bf16 v[16:19], v[208:211], v[184:187], v[16:19]
    ds_read_b64_tr_b16 v[152:153], v235 offset:0
    v_mfma_f32_16x16x32_bf16 v[20:23], v[212:215], v[184:187], v[20:23]
    ds_read_b64_tr_b16 v[154:155], v235 offset:1024
    v_mfma_f32_16x16x32_bf16 v[24:27], v[216:219], v[184:187], v[24:27]
    ds_read_b64_tr_b16 v[156:157], v236 offset:0
    v_mfma_f32_16x16x32_bf16 v[28:31], v[220:223], v[184:187], v[28:31]
    ds_read_b64_tr_b16 v[158:159], v236 offset:1024
    v_mfma_f32_16x16x32_bf16 v[32:35], v[224:227], v[184:187], v[32:35]
    v_mfma_f32_16x16x32_bf16 v[36:39], v[228:231], v[184:187], v[36:39]
    ds_read_b64_tr_b16 v[160:161], v237 offset:0
    v_mfma_f32_16x16x32_bf16 v[40:43], v[200:203], v[188:191], v[40:43]
    ds_read_b64_tr_b16 v[162:163], v237 offset:1024
    v_mfma_f32_16x16x32_bf16 v[44:47], v[204:207], v[188:191], v[44:47]
    ds_read_b64_tr_b16 v[164:165], v238 offset:0
    v_mfma_f32_16x16x32_bf16 v[48:51], v[208:211], v[188:191], v[48:51]
    ds_read_b64_tr_b16 v[166:167], v238 offset:1024
    v_mfma_f32_16x16x32_bf16 v[52:55], v[212:215], v[188:191], v[52:55]
    ds_read_b64_tr_b16 v[168:169], v235 offset:16384
    v_mfma_f32_16x16x32_bf16 v[56:59], v[216:219], v[188:191], v[56:59]
    v_mfma_f32_16x16x32_bf16 v[60:63], v[220:223], v[188:191], v[60:63]
    ds_read_b64_tr_b16 v[170:171], v235 offset:17408
    v_mfma_f32_16x16x32_bf16 v[64:67], v[224:227], v[188:191], v[64:67]
    ds_read_b64_tr_b16 v[172:173], v236 offset:16384
    v_mfma_f32_16x16x32_bf16 v[68:71], v[228:231], v[188:191], v[68:71]
    ds_read_b64_tr_b16 v[174:175], v236 offset:17408
    v_mfma_f32_16x16x32_bf16 v[72:75], v[200:203], v[192:195], v[72:75]
    ds_read_b64_tr_b16 v[176:177], v237 offset:16384
    v_mfma_f32_16x16x32_bf16 v[76:79], v[204:207], v[192:195], v[76:79]
    ds_read_b64_tr_b16 v[178:179], v237 offset:17408
    v_mfma_f32_16x16x32_bf16 v[80:83], v[208:211], v[192:195], v[80:83]
    v_mfma_f32_16x16x32_bf16 v[84:87], v[212:215], v[192:195], v[84:87]
    ds_read_b64_tr_b16 v[180:181], v238 offset:16384
    v_mfma_f32_16x16x32_bf16 v[88:91], v[216:219], v[192:195], v[88:91]
    ds_read_b64_tr_b16 v[182:183], v238 offset:17408
    v_mfma_f32_16x16x32_bf16 v[92:95], v[220:223], v[192:195], v[92:95]
    ds_read_b128 v[140:143], v232 offset:2048
    v_mfma_f32_16x16x32_bf16 v[96:99], v[224:227], v[192:195], v[96:99]
    ds_read_b128 v[144:147], v232 offset:4096
    v_mfma_f32_16x16x32_bf16 v[100:103], v[228:231], v[192:195], v[100:103]
    ds_read_b128 v[148:151], v232 offset:6144
    v_mfma_f32_16x16x32_bf16 v[104:107], v[200:203], v[196:199], v[104:107]
    v_mfma_f32_16x16x32_bf16 v[108:111], v[204:207], v[196:199], v[108:111]
    v_add_u32 v232, s65, v234
    v_mfma_f32_16x16x32_bf16 v[112:115], v[208:211], v[196:199], v[112:115]
    v_mfma_f32_16x16x32_bf16 v[116:119], v[212:215], v[196:199], v[116:119]
    v_mfma_f32_16x16x32_bf16 v[120:123], v[216:219], v[196:199], v[120:123]
    v_mfma_f32_16x16x32_bf16 v[124:127], v[220:223], v[196:199], v[124:127]
    v_mfma_f32_16x16x32_bf16 v[128:131], v[224:227], v[196:199], v[128:131]
    s_add_u32 s65, s65, 49152
    s_cmp_ge_u32 s65, 147456
    s_cselect_b32 s65, 0, s65
    v_mfma_f32_16x16x32_bf16 v[132:135], v[228:231], v[196:199], v[132:135]
    s_waitcnt lgkmcnt(0)
    v_mfma_f32_16x16x32_bf16 v[8:11], v[152:155], v[136:139], v[8:11]
    ds_read_b128 v[184:187], v232 offset:0
    v_mfma_f32_16x16x32_bf16 v[12:15], v[156:159], v[136:139], v[12:15]
    ds_read_b64_tr_b16 v[200:201], v235 offset:8192
    s_mov_b32 s52, s10
    s_mov_b32 s53, s11
    s_mov_b32 s54, 0x200000
    s_mov_b32 s55, 0x20000
    s_mov_b32 s76, 0x0
    buffer_load_dword v244, v243, s[52:55], s76 offen
    v_mfma_f32_16x16x32_bf16 v[16:19], v[160:163], v[136:139], v[16:19]
    ds_read_b64_tr_b16 v[202:203], v235 offset:9216
    v_mfma_f32_16x16x32_bf16 v[20:23], v[164:167], v[136:139], v[20:23]
    ds_read_b64_tr_b16 v[204:205], v236 offset:8192
    v_mfma_f32_16x16x32_bf16 v[24:27], v[168:171], v[136:139], v[24:27]
    v_mfma_f32_16x16x32_bf16 v[28:31], v[172:175], v[136:139], v[28:31]
    ds_read_b64_tr_b16 v[206:207], v236 offset:9216
    v_mfma_f32_16x16x32_bf16 v[32:35], v[176:179], v[136:139], v[32:35]
    ds_read_b64_tr_b16 v[208:209], v237 offset:8192
    v_mfma_f32_16x16x32_bf16 v[36:39], v[180:183], v[136:139], v[36:39]
    ds_read_b64_tr_b16 v[210:211], v237 offset:9216
    v_mfma_f32_16x16x32_bf16 v[40:43], v[152:155], v[140:143], v[40:43]
    ds_read_b64_tr_b16 v[212:213], v238 offset:8192
    v_mfma_f32_16x16x32_bf16 v[44:47], v[156:159], v[140:143], v[44:47]
    v_mfma_f32_16x16x32_bf16 v[48:51], v[160:163], v[140:143], v[48:51]
    ds_read_b64_tr_b16 v[214:215], v238 offset:9216
    v_mfma_f32_16x16x32_bf16 v[52:55], v[164:167], v[140:143], v[52:55]
    ds_read_b64_tr_b16 v[216:217], v235 offset:24576
    v_mfma_f32_16x16x32_bf16 v[56:59], v[168:171], v[140:143], v[56:59]
    ds_read_b64_tr_b16 v[218:219], v235 offset:25600
    v_mfma_f32_16x16x32_bf16 v[60:63], v[172:175], v[140:143], v[60:63]
    ds_read_b64_tr_b16 v[220:221], v236 offset:24576
    v_mfma_f32_16x16x32_bf16 v[64:67], v[176:179], v[140:143], v[64:67]
    v_mfma_f32_16x16x32_bf16 v[68:71], v[180:183], v[140:143], v[68:71]
    ds_read_b64_tr_b16 v[222:223], v236 offset:25600
    v_mfma_f32_16x16x32_bf16 v[72:75], v[152:155], v[144:147], v[72:75]
    ds_read_b64_tr_b16 v[224:225], v237 offset:24576
    v_mfma_f32_16x16x32_bf16 v[76:79], v[156:159], v[144:147], v[76:79]
    ds_read_b64_tr_b16 v[226:227], v237 offset:25600
    v_mfma_f32_16x16x32_bf16 v[80:83], v[160:163], v[144:147], v[80:83]
    ds_read_b64_tr_b16 v[228:229], v238 offset:24576
    v_mfma_f32_16x16x32_bf16 v[84:87], v[164:167], v[144:147], v[84:87]
    v_mfma_f32_16x16x32_bf16 v[88:91], v[168:171], v[144:147], v[88:91]
    ds_read_b64_tr_b16 v[230:231], v238 offset:25600
    v_mfma_f32_16x16x32_bf16 v[92:95], v[172:175], v[144:147], v[92:95]
    ds_read_b128 v[188:191], v232 offset:2048
    v_mfma_f32_16x16x32_bf16 v[96:99], v[176:179], v[144:147], v[96:99]
    ds_read_b128 v[192:195], v232 offset:4096
    v_mfma_f32_16x16x32_bf16 v[100:103], v[180:183], v[144:147], v[100:103]
    ds_read_b128 v[196:199], v232 offset:6144
    v_mfma_f32_16x16x32_bf16 v[104:107], v[152:155], v[148:151], v[104:107]
    v_mfma_f32_16x16x32_bf16 v[108:111], v[156:159], v[148:151], v[108:111]
    v_add_u32 v232, s65, v233
    v_mfma_f32_16x16x32_bf16 v[112:115], v[160:163], v[148:151], v[112:115]
    v_add_u32 v235, s65, v239
    v_mfma_f32_16x16x32_bf16 v[116:119], v[164:167], v[148:151], v[116:119]
    v_add_u32 v236, s65, v240
    v_mfma_f32_16x16x32_bf16 v[120:123], v[168:171], v[148:151], v[120:123]
    v_mfma_f32_16x16x32_bf16 v[124:127], v[172:175], v[148:151], v[124:127]
    v_add_u32 v237, s65, v241
    v_mfma_f32_16x16x32_bf16 v[128:131], v[176:179], v[148:151], v[128:131]
    v_add_u32 v238, s65, v242
    v_mfma_f32_16x16x32_bf16 v[132:135], v[180:183], v[148:151], v[132:135]
    s_waitcnt lgkmcnt(0)
    v_mfma_f32_16x16x32_bf16 v[8:11], v[200:203], v[184:187], v[8:11]
    s_barrier
    v_mfma_f32_16x16x32_bf16 v[12:15], v[204:207], v[184:187], v[12:15]
    ds_read_b128 v[136:139], v232 offset:0
    v_mfma_f32_16x16x32_bf16 v[16:19], v[208:211], v[184:187], v[16:19]
    ds_read_b64_tr_b16 v[152:153], v235 offset:0
    v_mfma_f32_16x16x32_bf16 v[20:23], v[212:215], v[184:187], v[20:23]
    ds_read_b64_tr_b16 v[154:155], v235 offset:1024
    v_mfma_f32_16x16x32_bf16 v[24:27], v[216:219], v[184:187], v[24:27]
    ds_read_b64_tr_b16 v[156:157], v236 offset:0
    v_mfma_f32_16x16x32_bf16 v[28:31], v[220:223], v[184:187], v[28:31]
    ds_read_b64_tr_b16 v[158:159], v236 offset:1024
    v_mfma_f32_16x16x32_bf16 v[32:35], v[224:227], v[184:187], v[32:35]
    v_mfma_f32_16x16x32_bf16 v[36:39], v[228:231], v[184:187], v[36:39]
    ds_read_b64_tr_b16 v[160:161], v237 offset:0
    v_mfma_f32_16x16x32_bf16 v[40:43], v[200:203], v[188:191], v[40:43]
    ds_read_b64_tr_b16 v[162:163], v237 offset:1024
    v_mfma_f32_16x16x32_bf16 v[44:47], v[204:207], v[188:191], v[44:47]
    ds_read_b64_tr_b16 v[164:165], v238 offset:0
    v_mfma_f32_16x16x32_bf16 v[48:51], v[208:211], v[188:191], v[48:51]
    ds_read_b64_tr_b16 v[166:167], v238 offset:1024
    v_mfma_f32_16x16x32_bf16 v[52:55], v[212:215], v[188:191], v[52:55]
    ds_read_b64_tr_b16 v[168:169], v235 offset:16384
    v_mfma_f32_16x16x32_bf16 v[56:59], v[216:219], v[188:191], v[56:59]
    v_mfma_f32_16x16x32_bf16 v[60:63], v[220:223], v[188:191], v[60:63]
    ds_read_b64_tr_b16 v[170:171], v235 offset:17408
    v_mfma_f32_16x16x32_bf16 v[64:67], v[224:227], v[188:191], v[64:67]
    ds_read_b64_tr_b16 v[172:173], v236 offset:16384
    v_mfma_f32_16x16x32_bf16 v[68:71], v[228:231], v[188:191], v[68:71]
    ds_read_b64_tr_b16 v[174:175], v236 offset:17408
    v_mfma_f32_16x16x32_bf16 v[72:75], v[200:203], v[192:195], v[72:75]
    ds_read_b64_tr_b16 v[176:177], v237 offset:16384
    v_mfma_f32_16x16x32_bf16 v[76:79], v[204:207], v[192:195], v[76:79]
    ds_read_b64_tr_b16 v[178:179], v237 offset:17408
    v_mfma_f32_16x16x32_bf16 v[80:83], v[208:211], v[192:195], v[80:83]
    v_mfma_f32_16x16x32_bf16 v[84:87], v[212:215], v[192:195], v[84:87]
    ds_read_b64_tr_b16 v[180:181], v238 offset:16384
    v_mfma_f32_16x16x32_bf16 v[88:91], v[216:219], v[192:195], v[88:91]
    ds_read_b64_tr_b16 v[182:183], v238 offset:17408
    v_mfma_f32_16x16x32_bf16 v[92:95], v[220:223], v[192:195], v[92:95]
    ds_read_b128 v[140:143], v232 offset:2048
    v_mfma_f32_16x16x32_bf16 v[96:99], v[224:227], v[192:195], v[96:99]
    ds_read_b128 v[144:147], v232 offset:4096
    v_mfma_f32_16x16x32_bf16 v[100:103], v[228:231], v[192:195], v[100:103]
    ds_read_b128 v[148:151], v232 offset:6144
    v_mfma_f32_16x16x32_bf16 v[104:107], v[200:203], v[196:199], v[104:107]
    v_mfma_f32_16x16x32_bf16 v[108:111], v[204:207], v[196:199], v[108:111]
    v_add_u32 v232, s65, v234
    v_mfma_f32_16x16x32_bf16 v[112:115], v[208:211], v[196:199], v[112:115]
    v_mfma_f32_16x16x32_bf16 v[116:119], v[212:215], v[196:199], v[116:119]
    v_mfma_f32_16x16x32_bf16 v[120:123], v[216:219], v[196:199], v[120:123]
    v_mfma_f32_16x16x32_bf16 v[124:127], v[220:223], v[196:199], v[124:127]
    v_mfma_f32_16x16x32_bf16 v[128:131], v[224:227], v[196:199], v[128:131]
    s_add_u32 s65, s65, 49152
    s_cmp_ge_u32 s65, 147456
    s_cselect_b32 s65, 0, s65
    v_mfma_f32_16x16x32_bf16 v[132:135], v[228:231], v[196:199], v[132:135]
    s_waitcnt lgkmcnt(0)
    v_mfma_f32_16x16x32_bf16 v[8:11], v[152:155], v[136:139], v[8:11]
    ds_read_b128 v[184:187], v232 offset:0
    v_mfma_f32_16x16x32_bf16 v[12:15], v[156:159], v[136:139], v[12:15]
    ds_read_b64_tr_b16 v[200:201], v235 offset:8192
    s_mov_b32 s52, s10
    s_mov_b32 s53, s11
    s_mov_b32 s54, 0x400000
    s_mov_b32 s55, 0x20000
    s_mov_b32 s76, 0x200000
    buffer_load_dword v244, v243, s[52:55], s76 offen
    v_mfma_f32_16x16x32_bf16 v[16:19], v[160:163], v[136:139], v[16:19]
    ds_read_b64_tr_b16 v[202:203], v235 offset:9216
    v_mfma_f32_16x16x32_bf16 v[20:23], v[164:167], v[136:139], v[20:23]
    ds_read_b64_tr_b16 v[204:205], v236 offset:8192
    v_mfma_f32_16x16x32_bf16 v[24:27], v[168:171], v[136:139], v[24:27]
    v_mfma_f32_16x16x32_bf16 v[28:31], v[172:175], v[136:139], v[28:31]
    ds_read_b64_tr_b16 v[206:207], v236 offset:9216
    v_mfma_f32_16x16x32_bf16 v[32:35], v[176:179], v[136:139], v[32:35]
    ds_read_b64_tr_b16 v[208:209], v237 offset:8192
    v_mfma_f32_16x16x32_bf16 v[36:39], v[180:183], v[136:139], v[36:39]
    ds_read_b64_tr_b16 v[210:211], v237 offset:9216
    v_mfma_f32_16x16x32_bf16 v[40:43], v[152:155], v[140:143], v[40:43]
    ds_read_b64_tr_b16 v[212:213], v238 offset:8192
    v_mfma_f32_16x16x32_bf16 v[44:47], v[156:159], v[140:143], v[44:47]
    v_mfma_f32_16x16x32_bf16 v[48:51], v[160:163], v[140:143], v[48:51]
    ds_read_b64_tr_b16 v[214:215], v238 offset:9216
    v_mfma_f32_16x16x32_bf16 v[52:55], v[164:167], v[140:143], v[52:55]
    ds_read_b64_tr_b16 v[216:217], v235 offset:24576
    v_mfma_f32_16x16x32_bf16 v[56:59], v[168:171], v[140:143], v[56:59]
    ds_read_b64_tr_b16 v[218:219], v235 offset:25600
    v_mfma_f32_16x16x32_bf16 v[60:63], v[172:175], v[140:143], v[60:63]
    ds_read_b64_tr_b16 v[220:221], v236 offset:24576
    v_mfma_f32_16x16x32_bf16 v[64:67], v[176:179], v[140:143], v[64:67]
    v_mfma_f32_16x16x32_bf16 v[68:71], v[180:183], v[140:143], v[68:71]
    ds_read_b64_tr_b16 v[222:223], v236 offset:25600
    v_mfma_f32_16x16x32_bf16 v[72:75], v[152:155], v[144:147], v[72:75]
    ds_read_b64_tr_b16 v[224:225], v237 offset:24576
    v_mfma_f32_16x16x32_bf16 v[76:79], v[156:159], v[144:147], v[76:79]
    ds_read_b64_tr_b16 v[226:227], v237 offset:25600
    v_mfma_f32_16x16x32_bf16 v[80:83], v[160:163], v[144:147], v[80:83]
    ds_read_b64_tr_b16 v[228:229], v238 offset:24576
    v_mfma_f32_16x16x32_bf16 v[84:87], v[164:167], v[144:147], v[84:87]
    v_mfma_f32_16x16x32_bf16 v[88:91], v[168:171], v[144:147], v[88:91]
    ds_read_b64_tr_b16 v[230:231], v238 offset:25600
    v_mfma_f32_16x16x32_bf16 v[92:95], v[172:175], v[144:147], v[92:95]
    ds_read_b128 v[188:191], v232 offset:2048
    v_mfma_f32_16x16x32_bf16 v[96:99], v[176:179], v[144:147], v[96:99]
    ds_read_b128 v[192:195], v232 offset:4096
    v_mfma_f32_16x16x32_bf16 v[100:103], v[180:183], v[144:147], v[100:103]
    ds_read_b128 v[196:199], v232 offset:6144
    v_mfma_f32_16x16x32_bf16 v[104:107], v[152:155], v[148:151], v[104:107]
    v_mfma_f32_16x16x32_bf16 v[108:111], v[156:159], v[148:151], v[108:111]
    v_add_u32 v232, s65, v233
    v_mfma_f32_16x16x32_bf16 v[112:115], v[160:163], v[148:151], v[112:115]
    v_add_u32 v235, s65, v239
    v_mfma_f32_16x16x32_bf16 v[116:119], v[164:167], v[148:151], v[116:119]
    v_add_u32 v236, s65, v240
    v_mfma_f32_16x16x32_bf16 v[120:123], v[168:171], v[148:151], v[120:123]
    v_mfma_f32_16x16x32_bf16 v[124:127], v[172:175], v[148:151], v[124:127]
    v_add_u32 v237, s65, v241
    v_mfma_f32_16x16x32_bf16 v[128:131], v[176:179], v[148:151], v[128:131]
    v_add_u32 v238, s65, v242
    v_mfma_f32_16x16x32_bf16 v[132:135], v[180:183], v[148:151], v[132:135]
    s_waitcnt lgkmcnt(0)
    v_mfma_f32_16x16x32_bf16 v[8:11], v[200:203], v[184:187], v[8:11]
    s_barrier
    v_mfma_f32_16x16x32_bf16 v[12:15], v[204:207], v[184:187], v[12:15]
    ds_read_b128 v[136:139], v232 offset:0
    v_mfma_f32_16x16x32_bf16 v[16:19], v[208:211], v[184:187], v[16:19]
    ds_read_b64_tr_b16 v[152:153], v235 offset:0
    v_mfma_f32_16x16x32_bf16 v[20:23], v[212:215], v[184:187], v[20:23]
    ds_read_b64_tr_b16 v[154:155], v235 offset:1024
    v_mfma_f32_16x16x32_bf16 v[24:27], v[216:219], v[184:187], v[24:27]
    ds_read_b64_tr_b16 v[156:157], v236 offset:0
    v_mfma_f32_16x16x32_bf16 v[28:31], v[220:223], v[184:187], v[28:31]
    ds_read_b64_tr_b16 v[158:159], v236 offset:1024
    v_mfma_f32_16x16x32_bf16 v[32:35], v[224:227], v[184:187], v[32:35]
    v_mfma_f32_16x16x32_bf16 v[36:39], v[228:231], v[184:187], v[36:39]
    ds_read_b64_tr_b16 v[160:161], v237 offset:0
    v_mfma_f32_16x16x32_bf16 v[40:43], v[200:203], v[188:191], v[40:43]
    ds_read_b64_tr_b16 v[162:163], v237 offset:1024
    v_mfma_f32_16x16x32_bf16 v[44:47], v[204:207], v[188:191], v[44:47]
    ds_read_b64_tr_b16 v[164:165], v238 offset:0
    v_mfma_f32_16x16x32_bf16 v[48:51], v[208:211], v[188:191], v[48:51]
    ds_read_b64_tr_b16 v[166:167], v238 offset:1024
    v_mfma_f32_16x16x32_bf16 v[52:55], v[212:215], v[188:191], v[52:55]
    ds_read_b64_tr_b16 v[168:169], v235 offset:16384
    v_mfma_f32_16x16x32_bf16 v[56:59], v[216:219], v[188:191], v[56:59]
    v_mfma_f32_16x16x32_bf16 v[60:63], v[220:223], v[188:191], v[60:63]
    ds_read_b64_tr_b16 v[170:171], v235 offset:17408
    v_mfma_f32_16x16x32_bf16 v[64:67], v[224:227], v[188:191], v[64:67]
    ds_read_b64_tr_b16 v[172:173], v236 offset:16384
    v_mfma_f32_16x16x32_bf16 v[68:71], v[228:231], v[188:191], v[68:71]
    ds_read_b64_tr_b16 v[174:175], v236 offset:17408
    v_mfma_f32_16x16x32_bf16 v[72:75], v[200:203], v[192:195], v[72:75]
    ds_read_b64_tr_b16 v[176:177], v237 offset:16384
    v_mfma_f32_16x16x32_bf16 v[76:79], v[204:207], v[192:195], v[76:79]
    ds_read_b64_tr_b16 v[178:179], v237 offset:17408
    v_mfma_f32_16x16x32_bf16 v[80:83], v[208:211], v[192:195], v[80:83]
    v_mfma_f32_16x16x32_bf16 v[84:87], v[212:215], v[192:195], v[84:87]
    ds_read_b64_tr_b16 v[180:181], v238 offset:16384
    v_mfma_f32_16x16x32_bf16 v[88:91], v[216:219], v[192:195], v[88:91]
    ds_read_b64_tr_b16 v[182:183], v238 offset:17408
    v_mfma_f32_16x16x32_bf16 v[92:95], v[220:223], v[192:195], v[92:95]
    ds_read_b128 v[140:143], v232 offset:2048
    v_mfma_f32_16x16x32_bf16 v[96:99], v[224:227], v[192:195], v[96:99]
    ds_read_b128 v[144:147], v232 offset:4096
    v_mfma_f32_16x16x32_bf16 v[100:103], v[228:231], v[192:195], v[100:103]
    ds_read_b128 v[148:151], v232 offset:6144
    v_mfma_f32_16x16x32_bf16 v[104:107], v[200:203], v[196:199], v[104:107]
    v_mfma_f32_16x16x32_bf16 v[108:111], v[204:207], v[196:199], v[108:111]
    v_add_u32 v232, s65, v234
    v_mfma_f32_16x16x32_bf16 v[112:115], v[208:211], v[196:199], v[112:115]
    v_mfma_f32_16x16x32_bf16 v[116:119], v[212:215], v[196:199], v[116:119]
    v_mfma_f32_16x16x32_bf16 v[120:123], v[216:219], v[196:199], v[120:123]
    v_mfma_f32_16x16x32_bf16 v[124:127], v[220:223], v[196:199], v[124:127]
    v_mfma_f32_16x16x32_bf16 v[128:131], v[224:227], v[196:199], v[128:131]
    s_add_u32 s65, s65, 49152
    s_cmp_ge_u32 s65, 147456
    s_cselect_b32 s65, 0, s65
    v_mfma_f32_16x16x32_bf16 v[132:135], v[228:231], v[196:199], v[132:135]
    s_waitcnt lgkmcnt(0)
    v_mfma_f32_16x16x32_bf16 v[8:11], v[152:155], v[136:139], v[8:11]
    ds_read_b128 v[184:187], v232 offset:0
    v_mfma_f32_16x16x32_bf16 v[12:15], v[156:159], v[136:139], v[12:15]
    ds_read_b64_tr_b16 v[200:201], v235 offset:8192
    s_mov_b32 s52, s10
    s_mov_b32 s53, s11
    s_mov_b32 s54, 0x600000
    s_mov_b32 s55, 0x20000
    s_mov_b32 s76, 0x400000
    buffer_load_dword v244, v243, s[52:55], s76 offen
    v_mfma_f32_16x16x32_bf16 v[16:19], v[160:163], v[136:139], v[16:19]
    ds_read_b64_tr_b16 v[202:203], v235 offset:9216
    v_mfma_f32_16x16x32_bf16 v[20:23], v[164:167], v[136:139], v[20:23]
    ds_read_b64_tr_b16 v[204:205], v236 offset:8192
    v_mfma_f32_16x16x32_bf16 v[24:27], v[168:171], v[136:139], v[24:27]
    v_mfma_f32_16x16x32_bf16 v[28:31], v[172:175], v[136:139], v[28:31]
    ds_read_b64_tr_b16 v[206:207], v236 offset:9216
    v_mfma_f32_16x16x32_bf16 v[32:35], v[176:179], v[136:139], v[32:35]
    ds_read_b64_tr_b16 v[208:209], v237 offset:8192
    v_mfma_f32_16x16x32_bf16 v[36:39], v[180:183], v[136:139], v[36:39]
    ds_read_b64_tr_b16 v[210:211], v237 offset:9216
    v_mfma_f32_16x16x32_bf16 v[40:43], v[152:155], v[140:143], v[40:43]
    ds_read_b64_tr_b16 v[212:213], v238 offset:8192
    v_mfma_f32_16x16x32_bf16 v[44:47], v[156:159], v[140:143], v[44:47]
    v_mfma_f32_16x16x32_bf16 v[48:51], v[160:163], v[140:143], v[48:51]
    ds_read_b64_tr_b16 v[214:215], v238 offset:9216
    v_mfma_f32_16x16x32_bf16 v[52:55], v[164:167], v[140:143], v[52:55]
    ds_read_b64_tr_b16 v[216:217], v235 offset:24576
    v_mfma_f32_16x16x32_bf16 v[56:59], v[168:171], v[140:143], v[56:59]
    ds_read_b64_tr_b16 v[218:219], v235 offset:25600
    v_mfma_f32_16x16x32_bf16 v[60:63], v[172:175], v[140:143], v[60:63]
    ds_read_b64_tr_b16 v[220:221], v236 offset:24576
    v_mfma_f32_16x16x32_bf16 v[64:67], v[176:179], v[140:143], v[64:67]
    v_mfma_f32_16x16x32_bf16 v[68:71], v[180:183], v[140:143], v[68:71]
    ds_read_b64_tr_b16 v[222:223], v236 offset:25600
    v_mfma_f32_16x16x32_bf16 v[72:75], v[152:155], v[144:147], v[72:75]
    ds_read_b64_tr_b16 v[224:225], v237 offset:24576
    v_mfma_f32_16x16x32_bf16 v[76:79], v[156:159], v[144:147], v[76:79]
    ds_read_b64_tr_b16 v[226:227], v237 offset:25600
    v_mfma_f32_16x16x32_bf16 v[80:83], v[160:163], v[144:147], v[80:83]
    ds_read_b64_tr_b16 v[228:229], v238 offset:24576
    v_mfma_f32_16x16x32_bf16 v[84:87], v[164:167], v[144:147], v[84:87]
    v_mfma_f32_16x16x32_bf16 v[88:91], v[168:171], v[144:147], v[88:91]
    ds_read_b64_tr_b16 v[230:231], v238 offset:25600
    v_mfma_f32_16x16x32_bf16 v[92:95], v[172:175], v[144:147], v[92:95]
    ds_read_b128 v[188:191], v232 offset:2048
    v_mfma_f32_16x16x32_bf16 v[96:99], v[176:179], v[144:147], v[96:99]
    ds_read_b128 v[192:195], v232 offset:4096
    v_mfma_f32_16x16x32_bf16 v[100:103], v[180:183], v[144:147], v[100:103]
    ds_read_b128 v[196:199], v232 offset:6144
    v_mfma_f32_16x16x32_bf16 v[104:107], v[152:155], v[148:151], v[104:107]
    v_mfma_f32_16x16x32_bf16 v[108:111], v[156:159], v[148:151], v[108:111]
    v_add_u32 v232, s65, v233
    v_mfma_f32_16x16x32_bf16 v[112:115], v[160:163], v[148:151], v[112:115]
    v_add_u32 v235, s65, v239
    v_mfma_f32_16x16x32_bf16 v[116:119], v[164:167], v[148:151], v[116:119]
    v_add_u32 v236, s65, v240
    v_mfma_f32_16x16x32_bf16 v[120:123], v[168:171], v[148:151], v[120:123]
    v_mfma_f32_16x16x32_bf16 v[124:127], v[172:175], v[148:151], v[124:127]
    v_add_u32 v237, s65, v241
    v_mfma_f32_16x16x32_bf16 v[128:131], v[176:179], v[148:151], v[128:131]
    v_add_u32 v238, s65, v242
    v_mfma_f32_16x16x32_bf16 v[132:135], v[180:183], v[148:151], v[132:135]
    s_waitcnt lgkmcnt(0)
    v_mfma_f32_16x16x32_bf16 v[8:11], v[200:203], v[184:187], v[8:11]
    s_barrier
    v_mfma_f32_16x16x32_bf16 v[12:15], v[204:207], v[184:187], v[12:15]
    ds_read_b128 v[136:139], v232 offset:0
    v_mfma_f32_16x16x32_bf16 v[16:19], v[208:211], v[184:187], v[16:19]
    ds_read_b64_tr_b16 v[152:153], v235 offset:0
    v_mfma_f32_16x16x32_bf16 v[20:23], v[212:215], v[184:187], v[20:23]
    ds_read_b64_tr_b16 v[154:155], v235 offset:1024
    v_mfma_f32_16x16x32_bf16 v[24:27], v[216:219], v[184:187], v[24:27]
    ds_read_b64_tr_b16 v[156:157], v236 offset:0
    v_mfma_f32_16x16x32_bf16 v[28:31], v[220:223], v[184:187], v[28:31]
    ds_read_b64_tr_b16 v[158:159], v236 offset:1024
    v_mfma_f32_16x16x32_bf16 v[32:35], v[224:227], v[184:187], v[32:35]
    v_mfma_f32_16x16x32_bf16 v[36:39], v[228:231], v[184:187], v[36:39]
    ds_read_b64_tr_b16 v[160:161], v237 offset:0
    v_mfma_f32_16x16x32_bf16 v[40:43], v[200:203], v[188:191], v[40:43]
    ds_read_b64_tr_b16 v[162:163], v237 offset:1024
    v_mfma_f32_16x16x32_bf16 v[44:47], v[204:207], v[188:191], v[44:47]
    ds_read_b64_tr_b16 v[164:165], v238 offset:0
    v_mfma_f32_16x16x32_bf16 v[48:51], v[208:211], v[188:191], v[48:51]
    ds_read_b64_tr_b16 v[166:167], v238 offset:1024
    v_mfma_f32_16x16x32_bf16 v[52:55], v[212:215], v[188:191], v[52:55]
    ds_read_b64_tr_b16 v[168:169], v235 offset:16384
    v_mfma_f32_16x16x32_bf16 v[56:59], v[216:219], v[188:191], v[56:59]
    v_mfma_f32_16x16x32_bf16 v[60:63], v[220:223], v[188:191], v[60:63]
    ds_read_b64_tr_b16 v[170:171], v235 offset:17408
    v_mfma_f32_16x16x32_bf16 v[64:67], v[224:227], v[188:191], v[64:67]
    ds_read_b64_tr_b16 v[172:173], v236 offset:16384
    v_mfma_f32_16x16x32_bf16 v[68:71], v[228:231], v[188:191], v[68:71]
    ds_read_b64_tr_b16 v[174:175], v236 offset:17408
    v_mfma_f32_16x16x32_bf16 v[72:75], v[200:203], v[192:195], v[72:75]
    ds_read_b64_tr_b16 v[176:177], v237 offset:16384
    v_mfma_f32_16x16x32_bf16 v[76:79], v[204:207], v[192:195], v[76:79]
    ds_read_b64_tr_b16 v[178:179], v237 offset:17408
    v_mfma_f32_16x16x32_bf16 v[80:83], v[208:211], v[192:195], v[80:83]
    v_mfma_f32_16x16x32_bf16 v[84:87], v[212:215], v[192:195], v[84:87]
    ds_read_b64_tr_b16 v[180:181], v238 offset:16384
    v_mfma_f32_16x16x32_bf16 v[88:91], v[216:219], v[192:195], v[88:91]
    ds_read_b64_tr_b16 v[182:183], v238 offset:17408
    v_mfma_f32_16x16x32_bf16 v[92:95], v[220:223], v[192:195], v[92:95]
    ds_read_b128 v[140:143], v232 offset:2048
    v_mfma_f32_16x16x32_bf16 v[96:99], v[224:227], v[192:195], v[96:99]
    ds_read_b128 v[144:147], v232 offset:4096
    v_mfma_f32_16x16x32_bf16 v[100:103], v[228:231], v[192:195], v[100:103]
    ds_read_b128 v[148:151], v232 offset:6144
    v_mfma_f32_16x16x32_bf16 v[104:107], v[200:203], v[196:199], v[104:107]
    v_mfma_f32_16x16x32_bf16 v[108:111], v[204:207], v[196:199], v[108:111]
    v_add_u32 v232, s65, v234
    v_mfma_f32_16x16x32_bf16 v[112:115], v[208:211], v[196:199], v[112:115]
    v_mfma_f32_16x16x32_bf16 v[116:119], v[212:215], v[196:199], v[116:119]
    v_mfma_f32_16x16x32_bf16 v[120:123], v[216:219], v[196:199], v[120:123]
    v_mfma_f32_16x16x32_bf16 v[124:127], v[220:223], v[196:199], v[124:127]
    v_mfma_f32_16x16x32_bf16 v[128:131], v[224:227], v[196:199], v[128:131]
    s_add_u32 s65, s65, 49152
    s_cmp_ge_u32 s65, 147456
    s_cselect_b32 s65, 0, s65
    v_mfma_f32_16x16x32_bf16 v[132:135], v[228:231], v[196:199], v[132:135]
    s_waitcnt lgkmcnt(0)
    v_mfma_f32_16x16x32_bf16 v[8:11], v[152:155], v[136:139], v[8:11]
    ds_read_b128 v[184:187], v232 offset:0
    v_mfma_f32_16x16x32_bf16 v[12:15], v[156:159], v[136:139], v[12:15]
    ds_read_b64_tr_b16 v[200:201], v235 offset:8192
    s_mov_b32 s52, s10
    s_mov_b32 s53, s11
    s_mov_b32 s54, 0x700000
    s_mov_b32 s55, 0x20000
    s_mov_b32 s76, 0x600000
    buffer_load_dword v244, v243, s[52:55], s76 offen
    v_mfma_f32_16x16x32_bf16 v[16:19], v[160:163], v[136:139], v[16:19]
    ds_read_b64_tr_b16 v[202:203], v235 offset:9216
    v_mfma_f32_16x16x32_bf16 v[20:23], v[164:167], v[136:139], v[20:23]
    ds_read_b64_tr_b16 v[204:205], v236 offset:8192
    v_mfma_f32_16x16x32_bf16 v[24:27], v[168:171], v[136:139], v[24:27]
    v_mfma_f32_16x16x32_bf16 v[28:31], v[172:175], v[136:139], v[28:31]
    ds_read_b64_tr_b16 v[206:207], v236 offset:9216
    v_mfma_f32_16x16x32_bf16 v[32:35], v[176:179], v[136:139], v[32:35]
    ds_read_b64_tr_b16 v[208:209], v237 offset:8192
    v_mfma_f32_16x16x32_bf16 v[36:39], v[180:183], v[136:139], v[36:39]
    ds_read_b64_tr_b16 v[210:211], v237 offset:9216
    v_mfma_f32_16x16x32_bf16 v[40:43], v[152:155], v[140:143], v[40:43]
    ds_read_b64_tr_b16 v[212:213], v238 offset:8192
    v_mfma_f32_16x16x32_bf16 v[44:47], v[156:159], v[140:143], v[44:47]
    v_mfma_f32_16x16x32_bf16 v[48:51], v[160:163], v[140:143], v[48:51]
    ds_read_b64_tr_b16 v[214:215], v238 offset:9216
    v_mfma_f32_16x16x32_bf16 v[52:55], v[164:167], v[140:143], v[52:55]
    ds_read_b64_tr_b16 v[216:217], v235 offset:24576
    v_mfma_f32_16x16x32_bf16 v[56:59], v[168:171], v[140:143], v[56:59]
    ds_read_b64_tr_b16 v[218:219], v235 offset:25600
    v_mfma_f32_16x16x32_bf16 v[60:63], v[172:175], v[140:143], v[60:63]
    ds_read_b64_tr_b16 v[220:221], v236 offset:24576
    v_mfma_f32_16x16x32_bf16 v[64:67], v[176:179], v[140:143], v[64:67]
    v_mfma_f32_16x16x32_bf16 v[68:71], v[180:183], v[140:143], v[68:71]
    ds_read_b64_tr_b16 v[222:223], v236 offset:25600
    v_mfma_f32_16x16x32_bf16 v[72:75], v[152:155], v[144:147], v[72:75]
    s_movk_i32 s67, 7
gd_kernel_Q_loop1:
    ds_read_b64_tr_b16 v[224:225], v237 offset:24576
    v_mfma_f32_16x16x32_bf16 v[76:79], v[156:159], v[144:147], v[76:79]
    ds_read_b64_tr_b16 v[226:227], v237 offset:25600
    v_mfma_f32_16x16x32_bf16 v[80:83], v[160:163], v[144:147], v[80:83]
    ds_read_b64_tr_b16 v[228:229], v238 offset:24576
    v_mfma_f32_16x16x32_bf16 v[84:87], v[164:167], v[144:147], v[84:87]
    v_mfma_f32_16x16x32_bf16 v[88:91], v[168:171], v[144:147], v[88:91]
    ds_read_b64_tr_b16 v[230:231], v238 offset:25600
    v_mfma_f32_16x16x32_bf16 v[92:95], v[172:175], v[144:147], v[92:95]
    ds_read_b128 v[188:191], v232 offset:2048
    v_mfma_f32_16x16x32_bf16 v[96:99], v[176:179], v[144:147], v[96:99]
    ds_read_b128 v[192:195], v232 offset:4096
    v_mfma_f32_16x16x32_bf16 v[100:103], v[180:183], v[144:147], v[100:103]
    ds_read_b128 v[196:199], v232 offset:6144
    v_mfma_f32_16x16x32_bf16 v[104:107], v[152:155], v[148:151], v[104:107]
    v_mfma_f32_16x16x32_bf16 v[108:111], v[156:159], v[148:151], v[108:111]
    v_add_u32 v232, s65, v233
    v_mfma_f32_16x16x32_bf16 v[112:115], v[160:163], v[148:151], v[112:115]
    v_add_u32 v235, s65, v239
    v_mfma_f32_16x16x32_bf16 v[116:119], v[164:167], v[148:151], v[116:119]
    v_add_u32 v236, s65, v240
    v_mfma_f32_16x16x32_bf16 v[120:123], v[168:171], v[148:151], v[120:123]
    v_mfma_f32_16x16x32_bf16 v[124:127], v[172:175], v[148:151], v[124:127]
    v_add_u32 v237, s65, v241
    v_mfma_f32_16x16x32_bf16 v[128:131], v[176:179], v[148:151], v[128:131]
    v_add_u32 v238, s65, v242
    v_mfma_f32_16x16x32_bf16 v[132:135], v[180:183], v[148:151], v[132:135]
    s_waitcnt lgkmcnt(0)
    v_mfma_f32_16x16x32_bf16 v[8:11], v[200:203], v[184:187], v[8:11]
    s_barrier
    v_mfma_f32_16x16x32_bf16 v[12:15], v[204:207], v[184:187], v[12:15]
    ds_read_b128 v[136:139], v232 offset:0
    v_mfma_f32_16x16x32_bf16 v[16:19], v[208:211], v[184:187], v[16:19]
    ds_read_b64_tr_b16 v[152:153], v235 offset:0
    v_mfma_f32_16x16x32_bf16 v[20:23], v[212:215], v[184:187], v[20:23]
    ds_read_b64_tr_b16 v[154:155], v235 offset:1024
    v_mfma_f32_16x16x32_bf16 v[24:27], v[216:219], v[184:187], v[24:27]
    ds_read_b64_tr_b16 v[156:157], v236 offset:0
    v_mfma_f32_16x16x32_bf16 v[28:31], v[220:223], v[184:187], v[28:31]
    ds_read_b64_tr_b16 v[158:159], v236 offset:1024
    v_mfma_f32_16x16x32_bf16 v[32:35], v[224:227], v[184:187], v[32:35]
    v_mfma_f32_16x16x32_bf16 v[36:39], v[228:231], v[184:187], v[36:39]
    ds_read_b64_tr_b16 v[160:161], v237 offset:0
    v_mfma_f32_16x16x32_bf16 v[40:43], v[200:203], v[188:191], v[40:43]
    ds_read_b64_tr_b16 v[162:163], v237 offset:1024
    v_mfma_f32_16x16x32_bf16 v[44:47], v[204:207], v[188:191], v[44:47]
    ds_read_b64_tr_b16 v[164:165], v238 offset:0
    v_mfma_f32_16x16x32_bf16 v[48:51], v[208:211], v[188:191], v[48:51]
    ds_read_b64_tr_b16 v[166:167], v238 offset:1024
    v_mfma_f32_16x16x32_bf16 v[52:55], v[212:215], v[188:191], v[52:55]
    ds_read_b64_tr_b16 v[168:169], v235 offset:16384
    v_mfma_f32_16x16x32_bf16 v[56:59], v[216:219], v[188:191], v[56:59]
    v_mfma_f32_16x16x32_bf16 v[60:63], v[220:223], v[188:191], v[60:63]
    ds_read_b64_tr_b16 v[170:171], v235 offset:17408
    v_mfma_f32_16x16x32_bf16 v[64:67], v[224:227], v[188:191], v[64:67]
    ds_read_b64_tr_b16 v[172:173], v236 offset:16384
    v_mfma_f32_16x16x32_bf16 v[68:71], v[228:231], v[188:191], v[68:71]
    ds_read_b64_tr_b16 v[174:175], v236 offset:17408
    v_mfma_f32_16x16x32_bf16 v[72:75], v[200:203], v[192:195], v[72:75]
    ds_read_b64_tr_b16 v[176:177], v237 offset:16384
    v_mfma_f32_16x16x32_bf16 v[76:79], v[204:207], v[192:195], v[76:79]
    ds_read_b64_tr_b16 v[178:179], v237 offset:17408
    v_mfma_f32_16x16x32_bf16 v[80:83], v[208:211], v[192:195], v[80:83]
    v_mfma_f32_16x16x32_bf16 v[84:87], v[212:215], v[192:195], v[84:87]
    ds_read_b64_tr_b16 v[180:181], v238 offset:16384
    v_mfma_f32_16x16x32_bf16 v[88:91], v[216:219], v[192:195], v[88:91]
    ds_read_b64_tr_b16 v[182:183], v238 offset:17408
    v_mfma_f32_16x16x32_bf16 v[92:95], v[220:223], v[192:195], v[92:95]
    ds_read_b128 v[140:143], v232 offset:2048
    v_mfma_f32_16x16x32_bf16 v[96:99], v[224:227], v[192:195], v[96:99]
    ds_read_b128 v[144:147], v232 offset:4096
    v_mfma_f32_16x16x32_bf16 v[100:103], v[228:231], v[192:195], v[100:103]
    ds_read_b128 v[148:151], v232 offset:6144
    v_mfma_f32_16x16x32_bf16 v[104:107], v[200:203], v[196:199], v[104:107]
    v_mfma_f32_16x16x32_bf16 v[108:111], v[204:207], v[196:199], v[108:111]
    v_add_u32 v232, s65, v234
    v_mfma_f32_16x16x32_bf16 v[112:115], v[208:211], v[196:199], v[112:115]
    v_mfma_f32_16x16x32_bf16 v[116:119], v[212:215], v[196:199], v[116:119]
    v_mfma_f32_16x16x32_bf16 v[120:123], v[216:219], v[196:199], v[120:123]
    v_mfma_f32_16x16x32_bf16 v[124:127], v[220:223], v[196:199], v[124:127]
    v_mfma_f32_16x16x32_bf16 v[128:131], v[224:227], v[196:199], v[128:131]
    s_add_u32 s65, s65, 49152
    s_cmp_ge_u32 s65, 147456
    s_cselect_b32 s65, 0, s65
    v_mfma_f32_16x16x32_bf16 v[132:135], v[228:231], v[196:199], v[132:135]
    s_waitcnt lgkmcnt(0)
    v_mfma_f32_16x16x32_bf16 v[8:11], v[152:155], v[136:139], v[8:11]
    ds_read_b128 v[184:187], v232 offset:0
    v_mfma_f32_16x16x32_bf16 v[12:15], v[156:159], v[136:139], v[12:15]
    ds_read_b64_tr_b16 v[200:201], v235 offset:8192
    v_mfma_f32_16x16x32_bf16 v[16:19], v[160:163], v[136:139], v[16:19]
    ds_read_b64_tr_b16 v[202:203], v235 offset:9216
    v_mfma_f32_16x16x32_bf16 v[20:23], v[164:167], v[136:139], v[20:23]
    ds_read_b64_tr_b16 v[204:205], v236 offset:8192
    v_mfma_f32_16x16x32_bf16 v[24:27], v[168:171], v[136:139], v[24:27]
    v_mfma_f32_16x16x32_bf16 v[28:31], v[172:175], v[136:139], v[28:31]
    ds_read_b64_tr_b16 v[206:207], v236 offset:9216
    v_mfma_f32_16x16x32_bf16 v[32:35], v[176:179], v[136:139], v[32:35]
    ds_read_b64_tr_b16 v[208:209], v237 offset:8192
    v_mfma_f32_16x16x32_bf16 v[36:39], v[180:183], v[136:139], v[36:39]
    ds_read_b64_tr_b16 v[210:211], v237 offset:9216
    v_mfma_f32_16x16x32_bf16 v[40:43], v[152:155], v[140:143], v[40:43]
    ds_read_b64_tr_b16 v[212:213], v238 offset:8192
    v_mfma_f32_16x16x32_bf16 v[44:47], v[156:159], v[140:143], v[44:47]
    v_mfma_f32_16x16x32_bf16 v[48:51], v[160:163], v[140:143], v[48:51]
    ds_read_b64_tr_b16 v[214:215], v238 offset:9216
    v_mfma_f32_16x16x32_bf16 v[52:55], v[164:167], v[140:143], v[52:55]
    ds_read_b64_tr_b16 v[216:217], v235 offset:24576
    v_mfma_f32_16x16x32_bf16 v[56:59], v[168:171], v[140:143], v[56:59]
    ds_read_b64_tr_b16 v[218:219], v235 offset:25600
    v_mfma_f32_16x16x32_bf16 v[60:63], v[172:175], v[140:143], v[60:63]
    ds_read_b64_tr_b16 v[220:221], v236 offset:24576
    v_mfma_f32_16x16x32_bf16 v[64:67], v[176:179], v[140:143], v[64:67]
    v_mfma_f32_16x16x32_bf16 v[68:71], v[180:183], v[140:143], v[68:71]
    s_sub_u32 s67, s67, 1
    ds_read_b64_tr_b16 v[222:223], v236 offset:25600
    v_mfma_f32_16x16x32_bf16 v[72:75], v[152:155], v[144:147], v[72:75]
    s_cbranch_scc0 gd_kernel_Q_loop1
    ds_read_b64_tr_b16 v[224:225], v237 offset:24576
    v_mfma_f32_16x16x32_bf16 v[76:79], v[156:159], v[144:147], v[76:79]
    ds_read_b64_tr_b16 v[226:227], v237 offset:25600
    v_mfma_f32_16x16x32_bf16 v[80:83], v[160:163], v[144:147], v[80:83]
    ds_read_b64_tr_b16 v[228:229], v238 offset:24576
    v_mfma_f32_16x16x32_bf16 v[84:87], v[164:167], v[144:147], v[84:87]
    v_mfma_f32_16x16x32_bf16 v[88:91], v[168:171], v[144:147], v[88:91]
    ds_read_b64_tr_b16 v[230:231], v238 offset:25600
    v_mfma_f32_16x16x32_bf16 v[92:95], v[172:175], v[144:147], v[92:95]
    ds_read_b128 v[188:191], v232 offset:2048
    v_mfma_f32_16x16x32_bf16 v[96:99], v[176:179], v[144:147], v[96:99]
    ds_read_b128 v[192:195], v232 offset:4096
    v_mfma_f32_16x16x32_bf16 v[100:103], v[180:183], v[144:147], v[100:103]
    ds_read_b128 v[196:199], v232 offset:6144
    v_mfma_f32_16x16x32_bf16 v[104:107], v[152:155], v[148:151], v[104:107]
    v_mfma_f32_16x16x32_bf16 v[108:111], v[156:159], v[148:151], v[108:111]
    v_mfma_f32_16x16x32_bf16 v[112:115], v[160:163], v[148:151], v[112:115]
    v_mfma_f32_16x16x32_bf16 v[116:119], v[164:167], v[148:151], v[116:119]
    v_mfma_f32_16x16x32_bf16 v[120:123], v[168:171], v[148:151], v[120:123]
    v_mfma_f32_16x16x32_bf16 v[124:127], v[172:175], v[148:151], v[124:127]
    v_mfma_f32_16x16x32_bf16 v[128:131], v[176:179], v[148:151], v[128:131]
    v_mfma_f32_16x16x32_bf16 v[132:135], v[180:183], v[148:151], v[132:135]
    s_waitcnt lgkmcnt(0)
    v_mfma_f32_16x16x32_bf16 v[8:11], v[200:203], v[184:187], v[8:11]
    s_barrier
    v_mfma_f32_16x16x32_bf16 v[12:15], v[204:207], v[184:187], v[12:15]
    v_mfma_f32_16x16x32_bf16 v[16:19], v[208:211], v[184:187], v[16:19]
    v_mfma_f32_16x16x32_bf16 v[20:23], v[212:215], v[184:187], v[20:23]
    v_mfma_f32_16x16x32_bf16 v[24:27], v[216:219], v[184:187], v[24:27]
    v_mfma_f32_16x16x32_bf16 v[28:31], v[220:223], v[184:187], v[28:31]
    v_mfma_f32_16x16x32_bf16 v[32:35], v[224:227], v[184:187], v[32:35]
    v_mfma_f32_16x16x32_bf16 v[36:39], v[228:231], v[184:187], v[36:39]
    v_mfma_f32_16x16x32_bf16 v[40:43], v[200:203], v[188:191], v[40:43]
    v_mfma_f32_16x16x32_bf16 v[44:47], v[204:207], v[188:191], v[44:47]
    v_mfma_f32_16x16x32_bf16 v[48:51], v[208:211], v[188:191], v[48:51]
    v_mfma_f32_16x16x32_bf16 v[52:55], v[212:215], v[188:191], v[52:55]
    v_mfma_f32_16x16x32_bf16 v[56:59], v[216:219], v[188:191], v[56:59]
    v_mfma_f32_16x16x32_bf16 v[60:63], v[220:223], v[188:191], v[60:63]
    v_mfma_f32_16x16x32_bf16 v[64:67], v[224:227], v[188:191], v[64:67]
    v_mfma_f32_16x16x32_bf16 v[68:71], v[228:231], v[188:191], v[68:71]
    v_mfma_f32_16x16x32_bf16 v[72:75], v[200:203], v[192:195], v[72:75]
    v_mfma_f32_16x16x32_bf16 v[76:79], v[204:207], v[192:195], v[76:79]
    v_mfma_f32_16x16x32_bf16 v[80:83], v[208:211], v[192:195], v[80:83]
    v_mfma_f32_16x16x32_bf16 v[84:87], v[212:215], v[192:195], v[84:87]
    v_mfma_f32_16x16x32_bf16 v[88:91], v[216:219], v[192:195], v[88:91]
    v_mfma_f32_16x16x32_bf16 v[92:95], v[220:223], v[192:195], v[92:95]
    v_mfma_f32_16x16x32_bf16 v[96:99], v[224:227], v[192:195], v[96:99]
    v_mfma_f32_16x16x32_bf16 v[100:103], v[228:231], v[192:195], v[100:103]
    v_mfma_f32_16x16x32_bf16 v[104:107], v[200:203], v[196:199], v[104:107]
    v_mfma_f32_16x16x32_bf16 v[108:111], v[204:207], v[196:199], v[108:111]
    v_mfma_f32_16x16x32_bf16 v[112:115], v[208:211], v[196:199], v[112:115]
    v_mfma_f32_16x16x32_bf16 v[116:119], v[212:215], v[196:199], v[116:119]
    v_mfma_f32_16x16x32_bf16 v[120:123], v[216:219], v[196:199], v[120:123]
    v_mfma_f32_16x16x32_bf16 v[124:127], v[220:223], v[196:199], v[124:127]
    v_mfma_f32_16x16x32_bf16 v[128:131], v[224:227], v[196:199], v[128:131]
    v_mfma_f32_16x16x32_bf16 v[132:135], v[228:231], v[196:199], v[132:135]
    s_setprio 0
    s_lshl_b32 s70, s56, 12
    s_add_u32 s71, s70, 163840
    s_add_u32 s66, s70, 65536
    s_add_u32 s38, s62, s63
    s_and_b32 s38, s38, 3
    s_mov_b32 s36, 0xba897645
    s_mov_b32 s37, 0xfecd
    s_cmp_eq_u32 s38, 1
    s_cselect_b32 s36, 0xb9a87564, s36
    s_cselect_b32 s37, 0xfdec, s37
    s_cmp_eq_u32 s38, 2
    s_cselect_b32 s36, 0xab986754, s36
    s_cselect_b32 s37, 0xefdc, s37
    s_cmp_eq_u32 s38, 3
    s_cselect_b32 s36, 0xca978653, s36
    s_cselect_b32 s37, 0xfedb, s37
    s_cmp_eq_u32 s61, 0
    s_cselect_b32 s39, 16, 0
    s_lshr_b32 s3, s60, 2
    s_sub_u32 s3, s60, s3
    s_add_u32 s3, s3, 16
    s_cmp_ge_u32 s2, 192
    v_and_b32 v2, 15, v1
    v_lshlrev_b32 v2, 4, v2
    v_bfe_u32 v3, v1, 4, 1
    v_lshl_add_u32 v2, v3, 9, v2
    v_lshrrev_b32 v3, 5, v1
    v_lshl_add_u32 v198, v3, 8, v2
    s_lshr_b32 s76, s59, 4
    s_lshl_b32 s77, s57, 2
    s_add_u32 s76, s76, s77
    s_mul_i32 s76, s76, 114688
    s_lshl_b32 s77, s3, 12
    s_add_u32 s76, s76, s77
    s_lshl_b32 s77, s58, 11
    s_add_u32 s76, s76, s77
    s_cmp_ge_u32 s2, 192
    s_cselect_b32 s76, 0x80000000, s76
    v_add_u32 v198, s76, v198
    s_and_b32 s69, s36, 15
    s_lshr_b64 s[36:37], s[36:37], 4
    s_add_u32 s69, s69, s39
    s_lshl_b32 s68, s69, 11
    s_lshl_b32 s69, s69, 17
    s_add_u32 m0, s66, 16384
    s_nop 0
    buffer_load_dwordx4 v248, s[28:31], s69 offen offset:0 lds
    v_mul_f32 v216, s74, v8
    v_mul_f32 v217, s74, v9
    v_mul_f32 v218, s74, v10
    v_mul_f32 v219, s74, v11
    v_mul_f32 v220, s74, v12
    v_mul_f32 v221, s74, v13
    v_mul_f32 v222, s74, v14
    v_mul_f32 v223, s74, v15
    v_exp_f32 v216, v216
    buffer_load_dwordx4 v249, s[28:31], s69 offen offset:1024 lds
    v_exp_f32 v217, v217
    v_exp_f32 v218, v218
    v_exp_f32 v219, v219
    v_exp_f32 v220, v220
    v_exp_f32 v221, v221
    v_exp_f32 v222, v222
    v_exp_f32 v223, v223
    v_mul_f32 v8, v8, v24
    v_mul_f32 v9, v9, v25
    buffer_load_dwordx4 v250, s[28:31], s69 offen offset:2048 lds
    v_mul_f32 v10, v10, v26
    v_mul_f32 v11, v11, v27
    v_mul_f32 v12, v12, v28
    v_mul_f32 v13, v13, v29
    v_mul_f32 v14, v14, v30
    v_mul_f32 v15, v15, v31
    v_add_f32 v216, 1.0, v216
    v_add_f32 v217, 1.0, v217
    v_add_f32 v218, 1.0, v218
    buffer_load_dwordx4 v251, s[28:31], s69 offen offset:3072 lds
    v_add_f32 v219, 1.0, v219
    v_add_f32 v220, 1.0, v220
    v_add_f32 v221, 1.0, v221
    v_add_f32 v222, 1.0, v222
    v_add_f32 v223, 1.0, v223
    v_rcp_f32 v216, v216
    v_rcp_f32 v217, v217
    v_rcp_f32 v218, v218
    v_rcp_f32 v219, v219
    s_mov_b32 m0, s66
    s_nop 0
    buffer_load_dwordx4 v246, s[24:27], s68 offen offset:0 lds
    v_rcp_f32 v220, v220
    v_rcp_f32 v221, v221
    v_rcp_f32 v222, v222
    v_rcp_f32 v223, v223
    v_mul_f32 v8, v8, v216
    v_mul_f32 v9, v9, v217
    v_mul_f32 v10, v10, v218
    v_mul_f32 v11, v11, v219
    v_mul_f32 v12, v12, v220
    buffer_load_dwordx4 v246, s[24:27], s68 offen offset:1024 lds
    v_mul_f32 v13, v13, v221
    v_mul_f32 v14, v14, v222
    v_mul_f32 v15, v15, v223
    v_cvt_pk_bf16_f32 v200, v8, v9
    v_cvt_pk_bf16_f32 v201, v10, v11
    v_cvt_pk_bf16_f32 v202, v12, v13
    v_cvt_pk_bf16_f32 v203, v14, v15
    s_nop 0
    v_permlane16_swap_b32 v200, v202
    v_permlane16_swap_b32 v201, v203
    buffer_load_dwordx4 v247, s[24:27], s68 offen offset:2048 lds
    v_mul_f32 v224, s74, v16
    v_mul_f32 v225, s74, v17
    v_mul_f32 v226, s74, v18
    v_mul_f32 v227, s74, v19
    v_mul_f32 v228, s74, v20
    v_mul_f32 v229, s74, v21
    v_mul_f32 v230, s74, v22
    v_mul_f32 v231, s74, v23
    buffer_load_dwordx4 v247, s[24:27], s68 offen offset:3072 lds
    v_exp_f32 v224, v224
    v_exp_f32 v225, v225
    v_exp_f32 v226, v226
    v_exp_f32 v227, v227
    v_exp_f32 v228, v228
    v_exp_f32 v229, v229
    v_exp_f32 v230, v230
    v_exp_f32 v231, v231
    v_mul_f32 v16, v16, v32
    s_add_u32 s66, s66, 32768
    s_cmp_ge_u32 s66, s71
    s_cselect_b32 s66, s70, s66
    buffer_store_dwordx4 v[200:203], v198, s[24:27], 0 offen offset:0 sc1
    s_mul_i32 s72, s61, 0
    s_mul_i32 s73, s61, 8
    s_barrier
    s_and_b32 s69, s36, 15
    s_lshr_b64 s[36:37], s[36:37], 4
    s_add_u32 s69, s69, s39
    s_lshl_b32 s68, s69, 11
    s_lshl_b32 s69, s69, 17
    s_add_u32 m0, s66, 16384
    s_nop 0
    buffer_load_dwordx4 v248, s[28:31], s69 offen offset:0 lds
    v_mul_f32 v17, v17, v33
    v_mul_f32 v18, v18, v34
    v_mul_f32 v19, v19, v35
    v_mul_f32 v20, v20, v36
    v_mul_f32 v21, v21, v37
    v_mul_f32 v22, v22, v38
    v_mul_f32 v23, v23, v39
    v_add_f32 v224, 1.0, v224
    v_add_f32 v225, 1.0, v225
    buffer_load_dwordx4 v249, s[28:31], s69 offen offset:1024 lds
    v_add_f32 v226, 1.0, v226
    v_add_f32 v227, 1.0, v227
    v_add_f32 v228, 1.0, v228
    v_add_f32 v229, 1.0, v229
    v_add_f32 v230, 1.0, v230
    v_add_f32 v231, 1.0, v231
    v_rcp_f32 v224, v224
    v_rcp_f32 v225, v225
    v_rcp_f32 v226, v226
    buffer_load_dwordx4 v250, s[28:31], s69 offen offset:2048 lds
    v_rcp_f32 v227, v227
    v_rcp_f32 v228, v228
    v_rcp_f32 v229, v229
    v_rcp_f32 v230, v230
    v_rcp_f32 v231, v231
    v_mul_f32 v16, v16, v224
    v_mul_f32 v17, v17, v225
    v_mul_f32 v18, v18, v226
    v_mul_f32 v19, v19, v227
    buffer_load_dwordx4 v251, s[28:31], s69 offen offset:3072 lds
    v_mul_f32 v20, v20, v228
    v_mul_f32 v21, v21, v229
    v_mul_f32 v22, v22, v230
    v_mul_f32 v23, v23, v231
    v_cvt_pk_bf16_f32 v204, v16, v17
    v_cvt_pk_bf16_f32 v205, v18, v19
    v_cvt_pk_bf16_f32 v206, v20, v21
    v_cvt_pk_bf16_f32 v207, v22, v23
    s_nop 0
    v_permlane16_swap_b32 v204, v206
    s_mov_b32 m0, s66
    s_nop 0
    buffer_load_dwordx4 v246, s[24:27], s68 offen offset:0 lds
    v_permlane16_swap_b32 v205, v207
    v_mul_f32 v216, s74, v40
    v_mul_f32 v217, s74, v41
    v_mul_f32 v218, s74, v42
    v_mul_f32 v219, s74, v43
    v_mul_f32 v220, s74, v44
    v_mul_f32 v221, s74, v45
    buffer_load_dwordx4 v246, s[24:27], s68 offen offset:1024 lds
    v_mul_f32 v222, s74, v46
    v_mul_f32 v223, s74, v47
    v_exp_f32 v216, v216
    v_exp_f32 v217, v217
    v_exp_f32 v218, v218
    v_exp_f32 v219, v219
    v_exp_f32 v220, v220
    v_exp_f32 v221, v221
    v_exp_f32 v222, v222
    buffer_load_dwordx4 v247, s[24:27], s68 offen offset:2048 lds
    v_exp_f32 v223, v223
    v_mul_f32 v40, v40, v56
    v_mul_f32 v41, v41, v57
    v_mul_f32 v42, v42, v58
    v_mul_f32 v43, v43, v59
    v_mul_f32 v44, v44, v60
    v_mul_f32 v45, v45, v61
    v_mul_f32 v46, v46, v62
    v_mul_f32 v47, v47, v63
    buffer_load_dwordx4 v247, s[24:27], s68 offen offset:3072 lds
    v_add_f32 v216, 1.0, v216
    v_add_f32 v217, 1.0, v217
    v_add_f32 v218, 1.0, v218
    v_add_f32 v219, 1.0, v219
    v_add_f32 v220, 1.0, v220
    v_add_f32 v221, 1.0, v221
    v_add_f32 v222, 1.0, v222
    v_add_f32 v223, 1.0, v223
    v_rcp_f32 v216, v216
    s_add_u32 s66, s66, 32768
    s_cmp_ge_u32 s66, s71
    s_cselect_b32 s66, s70, s66
    buffer_store_dwordx4 v[204:207], v198, s[24:27], 0 offen offset:1024 sc1
    v_add_u32 v198, 114688, v198
    s_barrier
    s_and_b32 s69, s36, 15
    s_lshr_b64 s[36:37], s[36:37], 4
    s_add_u32 s69, s69, s39
    s_lshl_b32 s68, s69, 11
    s_lshl_b32 s69, s69, 17
    s_add_u32 m0, s66, 16384
    s_nop 0
    buffer_load_dwordx4 v248, s[28:31], s69 offen offset:0 lds
    v_rcp_f32 v217, v217
    v_rcp_f32 v218, v218
    v_rcp_f32 v219, v219
    v_rcp_f32 v220, v220
    v_rcp_f32 v221, v221
    v_rcp_f32 v222, v222
    v_rcp_f32 v223, v223
    v_mul_f32 v40, v40, v216
    v_mul_f32 v41, v41, v217
    buffer_load_dwordx4 v249, s[28:31], s69 offen offset:1024 lds
    v_mul_f32 v42, v42, v218
    v_mul_f32 v43, v43, v219
    v_mul_f32 v44, v44, v220
    v_mul_f32 v45, v45, v221
    v_mul_f32 v46, v46, v222
    v_mul_f32 v47, v47, v223
    v_cvt_pk_bf16_f32 v208, v40, v41
    v_cvt_pk_bf16_f32 v209, v42, v43
    v_cvt_pk_bf16_f32 v210, v44, v45
    buffer_load_dwordx4 v250, s[28:31], s69 offen offset:2048 lds
    v_cvt_pk_bf16_f32 v211, v46, v47
    v_permlane16_swap_b32 v208, v210
    s_nop 0
    v_permlane16_swap_b32 v209, v211
    v_mul_f32 v224, s74, v48
    v_mul_f32 v225, s74, v49
    v_mul_f32 v226, s74, v50
    v_mul_f32 v227, s74, v51
    v_mul_f32 v228, s74, v52
    buffer_load_dwordx4 v251, s[28:31], s69 offen offset:3072 lds
    v_mul_f32 v229, s74, v53
    v_mul_f32 v230, s74, v54
    v_mul_f32 v231, s74, v55
    v_exp_f32 v224, v224
    v_exp_f32 v225, v225
    v_exp_f32 v226, v226
    v_exp_f32 v227, v227
    v_exp_f32 v228, v228
    v_exp_f32 v229, v229
    s_mov_b32 m0, s66
    s_nop 0
    buffer_load_dwordx4 v246, s[24:27], s68 offen offset:0 lds
    v_exp_f32 v230, v230
    v_exp_f32 v231, v231
    v_mul_f32 v48, v48, v64
    v_mul_f32 v49, v49, v65
    v_mul_f32 v50, v50, v66
    v_mul_f32 v51, v51, v67
    v_mul_f32 v52, v52, v68
    v_mul_f32 v53, v53, v69
    v_mul_f32 v54, v54, v70
    buffer_load_dwordx4 v246, s[24:27], s68 offen offset:1024 lds
    v_mul_f32 v55, v55, v71
    v_add_f32 v224, 1.0, v224
    v_add_f32 v225, 1.0, v225
    v_add_f32 v226, 1.0, v226
    v_add_f32 v227, 1.0, v227
    v_add_f32 v228, 1.0, v228
    v_add_f32 v229, 1.0, v229
    v_add_f32 v230, 1.0, v230
    v_add_f32 v231, 1.0, v231
    buffer_load_dwordx4 v247, s[24:27], s68 offen offset:2048 lds
    v_rcp_f32 v224, v224
    v_rcp_f32 v225, v225
    v_rcp_f32 v226, v226
    v_rcp_f32 v227, v227
    v_rcp_f32 v228, v228
    v_rcp_f32 v229, v229
    v_rcp_f32 v230, v230
    v_rcp_f32 v231, v231
    v_mul_f32 v48, v48, v224
    buffer_load_dwordx4 v247, s[24:27], s68 offen offset:3072 lds
    v_mul_f32 v49, v49, v225
    v_mul_f32 v50, v50, v226
    v_mul_f32 v51, v51, v227
    v_mul_f32 v52, v52, v228
    v_mul_f32 v53, v53, v229
    v_mul_f32 v54, v54, v230
    v_mul_f32 v55, v55, v231
    v_cvt_pk_bf16_f32 v212, v48, v49
    v_cvt_pk_bf16_f32 v213, v50, v51
    s_add_u32 s66, s66, 32768
    s_cmp_ge_u32 s66, s71
    s_cselect_b32 s66, s70, s66
    buffer_store_dwordx4 v[208:211], v198, s[24:27], 0 offen offset:0 sc1
    s_barrier
    s_and_b32 s69, s36, 15
    s_lshr_b64 s[36:37], s[36:37], 4
    s_add_u32 s69, s69, s39
    s_lshl_b32 s68, s69, 11
    s_lshl_b32 s69, s69, 17
    s_add_u32 m0, s66, 16384
    s_nop 0
    buffer_load_dwordx4 v248, s[28:31], s69 offen offset:0 lds
    v_cvt_pk_bf16_f32 v214, v52, v53
    v_cvt_pk_bf16_f32 v215, v54, v55
    s_nop 0
    v_permlane16_swap_b32 v212, v214
    v_permlane16_swap_b32 v213, v215
    v_mul_f32 v216, s74, v72
    v_mul_f32 v217, s74, v73
    v_mul_f32 v218, s74, v74
    buffer_load_dwordx4 v249, s[28:31], s69 offen offset:1024 lds
    v_mul_f32 v219, s74, v75
    v_mul_f32 v220, s74, v76
    v_mul_f32 v221, s74, v77
    v_mul_f32 v222, s74, v78
    v_mul_f32 v223, s74, v79
    v_exp_f32 v216, v216
    v_exp_f32 v217, v217
    v_exp_f32 v218, v218
    v_exp_f32 v219, v219
    buffer_load_dwordx4 v250, s[28:31], s69 offen offset:2048 lds
    v_exp_f32 v220, v220
    v_exp_f32 v221, v221
    v_exp_f32 v222, v222
    v_exp_f32 v223, v223
    v_mul_f32 v72, v72, v88
    v_mul_f32 v73, v73, v89
    v_mul_f32 v74, v74, v90
    v_mul_f32 v75, v75, v91
    v_mul_f32 v76, v76, v92
    buffer_load_dwordx4 v251, s[28:31], s69 offen offset:3072 lds
    v_mul_f32 v77, v77, v93
    v_mul_f32 v78, v78, v94
    v_mul_f32 v79, v79, v95
    v_add_f32 v216, 1.0, v216
    v_add_f32 v217, 1.0, v217
    v_add_f32 v218, 1.0, v218
    v_add_f32 v219, 1.0, v219
    v_add_f32 v220, 1.0, v220
    v_add_f32 v221, 1.0, v221
    s_mov_b32 m0, s66
    s_nop 0
    buffer_load_dwordx4 v246, s[24:27], s68 offen offset:0 lds
    v_add_f32 v222, 1.0, v222
    v_add_f32 v223, 1.0, v223
    v_rcp_f32 v216, v216
    v_rcp_f32 v217, v217
    v_rcp_f32 v218, v218
    v_rcp_f32 v219, v219
    v_rcp_f32 v220, v220
    v_rcp_f32 v221, v221
    v_rcp_f32 v222, v222
    buffer_load_dwordx4 v246, s[24:27], s68 offen offset:1024 lds
    v_rcp_f32 v223, v223
    v_mul_f32 v72, v72, v216
    v_mul_f32 v73, v73, v217
    v_mul_f32 v74, v74, v218
    v_mul_f32 v75, v75, v219
    v_mul_f32 v76, v76, v220
    v_mul_f32 v77, v77, v221
    v_mul_f32 v78, v78, v222
    v_mul_f32 v79, v79, v223
    buffer_load_dwordx4 v247, s[24:27], s68 offen offset:2048 lds
    v_cvt_pk_bf16_f32 v200, v72, v73
    v_cvt_pk_bf16_f32 v201, v74, v75
    v_cvt_pk_bf16_f32 v202, v76, v77
    v_cvt_pk_bf16_f32 v203, v78, v79
    s_nop 0
    v_permlane16_swap_b32 v200, v202
    v_permlane16_swap_b32 v201, v203
    v_mul_f32 v224, s74, v80
    v_mul_f32 v225, s74, v81
    buffer_load_dwordx4 v247, s[24:27], s68 offen offset:3072 lds
    v_mul_f32 v226, s74, v82
    v_mul_f32 v227, s74, v83
    v_mul_f32 v228, s74, v84
    v_mul_f32 v229, s74, v85
    v_mul_f32 v230, s74, v86
    v_mul_f32 v231, s74, v87
    v_exp_f32 v224, v224
    v_exp_f32 v225, v225
    v_exp_f32 v226, v226
    s_add_u32 s66, s66, 32768
    s_cmp_ge_u32 s66, s71
    s_cselect_b32 s66, s70, s66
    buffer_store_dwordx4 v[212:215], v198, s[24:27], 0 offen offset:1024 sc1
    v_add_u32 v198, 114688, v198
    buffer_store_dwordx4 v[200:203], v198, s[24:27], 0 offen offset:0 sc1
    s_waitcnt vmcnt(29)
    s_barrier
    s_and_b32 s69, s36, 15
    s_lshr_b64 s[36:37], s[36:37], 4
    s_add_u32 s69, s69, s39
    s_lshl_b32 s68, s69, 11
    s_lshl_b32 s69, s69, 17
    s_add_u32 m0, s66, 16384
    s_nop 0
    buffer_load_dwordx4 v248, s[28:31], s69 offen offset:0 lds
    v_exp_f32 v227, v227
    v_exp_f32 v228, v228
    v_exp_f32 v229, v229
    v_exp_f32 v230, v230
    v_exp_f32 v231, v231
    v_mul_f32 v80, v80, v96
    v_mul_f32 v81, v81, v97
    v_mul_f32 v82, v82, v98
    v_mul_f32 v83, v83, v99
    buffer_load_dwordx4 v249, s[28:31], s69 offen offset:1024 lds
    v_mul_f32 v84, v84, v100
    v_mul_f32 v85, v85, v101
    v_mul_f32 v86, v86, v102
    v_mul_f32 v87, v87, v103
    v_add_f32 v224, 1.0, v224
    v_add_f32 v225, 1.0, v225
    v_add_f32 v226, 1.0, v226
    v_add_f32 v227, 1.0, v227
    v_add_f32 v228, 1.0, v228
    buffer_load_dwordx4 v250, s[28:31], s69 offen offset:2048 lds
    v_add_f32 v229, 1.0, v229
    v_add_f32 v230, 1.0, v230
    v_add_f32 v231, 1.0, v231
    v_rcp_f32 v224, v224
    v_rcp_f32 v225, v225
    v_rcp_f32 v226, v226
    v_rcp_f32 v227, v227
    v_rcp_f32 v228, v228
    v_rcp_f32 v229, v229
    buffer_load_dwordx4 v251, s[28:31], s69 offen offset:3072 lds
    v_rcp_f32 v230, v230
    v_rcp_f32 v231, v231
    v_mul_f32 v80, v80, v224
    v_mul_f32 v81, v81, v225
    v_mul_f32 v82, v82, v226
    v_mul_f32 v83, v83, v227
    v_mul_f32 v84, v84, v228
    v_mul_f32 v85, v85, v229
    v_mul_f32 v86, v86, v230
    s_mov_b32 m0, s66
    s_nop 0
    buffer_load_dwordx4 v246, s[24:27], s68 offen offset:0 lds
    v_mul_f32 v87, v87, v231
    v_cvt_pk_bf16_f32 v204, v80, v81
    v_cvt_pk_bf16_f32 v205, v82, v83
    v_cvt_pk_bf16_f32 v206, v84, v85
    v_cvt_pk_bf16_f32 v207, v86, v87
    s_nop 0
    v_permlane16_swap_b32 v204, v206
    v_permlane16_swap_b32 v205, v207
    buffer_load_dwordx4 v246, s[24:27], s68 offen offset:1024 lds
    v_mul_f32 v216, s74, v104
    v_mul_f32 v217, s74, v105
    v_mul_f32 v218, s74, v106
    v_mul_f32 v219, s74, v107
    v_mul_f32 v220, s74, v108
    v_mul_f32 v221, s74, v109
    v_mul_f32 v222, s74, v110
    v_mul_f32 v223, s74, v111
    v_exp_f32 v216, v216
    buffer_load_dwordx4 v247, s[24:27], s68 offen offset:2048 lds
    v_exp_f32 v217, v217
    v_exp_f32 v218, v218
    v_exp_f32 v219, v219
    v_exp_f32 v220, v220
    v_exp_f32 v221, v221
    v_exp_f32 v222, v222
    v_exp_f32 v223, v223
    v_mul_f32 v104, v104, v120
    v_mul_f32 v105, v105, v121
    buffer_load_dwordx4 v247, s[24:27], s68 offen offset:3072 lds
    v_mul_f32 v106, v106, v122
    v_mul_f32 v107, v107, v123
    v_mul_f32 v108, v108, v124
    v_mul_f32 v109, v109, v125
    v_mul_f32 v110, v110, v126
    v_mul_f32 v111, v111, v127
    v_add_f32 v216, 1.0, v216
    v_add_f32 v217, 1.0, v217
    v_add_f32 v218, 1.0, v218
    s_add_u32 s66, s66, 32768
    s_cmp_ge_u32 s66, s71
    s_cselect_b32 s66, s70, s66
    buffer_store_dwordx4 v[204:207], v198, s[24:27], 0 offen offset:1024 sc1
    v_add_u32 v198, 114688, v198
    s_waitcnt vmcnt(29)
    s_barrier
    s_and_b32 s69, s36, 15
    s_lshr_b64 s[36:37], s[36:37], 4
    s_add_u32 s69, s69, s39
    s_lshl_b32 s68, s69, 11
    s_lshl_b32 s69, s69, 17
    s_add_u32 m0, s66, 16384
    s_nop 0
    buffer_load_dwordx4 v248, s[28:31], s69 offen offset:0 lds
    v_add_f32 v219, 1.0, v219
    v_add_f32 v220, 1.0, v220
    v_add_f32 v221, 1.0, v221
    v_add_f32 v222, 1.0, v222
    v_add_f32 v223, 1.0, v223
    v_rcp_f32 v216, v216
    v_rcp_f32 v217, v217
    v_rcp_f32 v218, v218
    v_rcp_f32 v219, v219
    buffer_load_dwordx4 v249, s[28:31], s69 offen offset:1024 lds
    v_rcp_f32 v220, v220
    v_rcp_f32 v221, v221
    v_rcp_f32 v222, v222
    v_rcp_f32 v223, v223
    v_mul_f32 v104, v104, v216
    v_mul_f32 v105, v105, v217
    v_mul_f32 v106, v106, v218
    v_mul_f32 v107, v107, v219
    v_mul_f32 v108, v108, v220
    buffer_load_dwordx4 v250, s[28:31], s69 offen offset:2048 lds
    v_mul_f32 v109, v109, v221
    v_mul_f32 v110, v110, v222
    v_mul_f32 v111, v111, v223
    v_cvt_pk_bf16_f32 v208, v104, v105
    v_cvt_pk_bf16_f32 v209, v106, v107
    v_cvt_pk_bf16_f32 v210, v108, v109
    v_cvt_pk_bf16_f32 v211, v110, v111
    s_nop 0
    v_permlane16_swap_b32 v208, v210
    v_permlane16_swap_b32 v209, v211
    buffer_load_dwordx4 v251, s[28:31], s69 offen offset:3072 lds
    v_mul_f32 v224, s74, v112
    v_mul_f32 v225, s74, v113
    v_mul_f32 v226, s74, v114
    v_mul_f32 v227, s74, v115
    v_mul_f32 v228, s74, v116
    v_mul_f32 v229, s74, v117
    v_mul_f32 v230, s74, v118
    v_mul_f32 v231, s74, v119
    s_mov_b32 m0, s66
    s_nop 0
    buffer_load_dwordx4 v246, s[24:27], s68 offen offset:0 lds
    v_exp_f32 v224, v224
    v_exp_f32 v225, v225
    v_exp_f32 v226, v226
    v_exp_f32 v227, v227
    v_exp_f32 v228, v228
    v_exp_f32 v229, v229
    v_exp_f32 v230, v230
    v_exp_f32 v231, v231
    v_mul_f32 v112, v112, v128
    buffer_load_dwordx4 v246, s[24:27], s68 offen offset:1024 lds
    v_mul_f32 v113, v113, v129
    v_mul_f32 v114, v114, v130
    v_mul_f32 v115, v115, v131
    v_mul_f32 v116, v116, v132
    v_mul_f32 v117, v117, v133
    v_mul_f32 v118, v118, v134
    v_mul_f32 v119, v119, v135
    v_add_f32 v224, 1.0, v224
    v_add_f32 v225, 1.0, v225
    buffer_load_dwordx4 v247, s[24:27], s68 offen offset:2048 lds
    v_add_f32 v226, 1.0, v226
    v_add_f32 v227, 1.0, v227
    v_add_f32 v228, 1.0, v228
    v_add_f32 v229, 1.0, v229
    v_add_f32 v230, 1.0, v230
    v_add_f32 v231, 1.0, v231
    v_rcp_f32 v224, v224
    v_rcp_f32 v225, v225
    v_rcp_f32 v226, v226
    buffer_load_dwordx4 v247, s[24:27], s68 offen offset:3072 lds
    v_rcp_f32 v227, v227
    v_rcp_f32 v228, v228
    v_rcp_f32 v229, v229
    v_rcp_f32 v230, v230
    v_rcp_f32 v231, v231
    v_mul_f32 v112, v112, v224
    v_mul_f32 v113, v113, v225
    v_mul_f32 v114, v114, v226
    v_mul_f32 v115, v115, v227
    s_add_u32 s66, s66, 32768
    s_cmp_ge_u32 s66, s71
    s_cselect_b32 s66, s70, s66
    buffer_store_dwordx4 v[208:211], v198, s[24:27], 0 offen offset:0 sc1
    s_waitcnt vmcnt(29)
    s_barrier
    s_and_b32 s69, s36, 15
    s_lshr_b64 s[36:37], s[36:37], 4
    s_add_u32 s69, s69, s39
    s_lshl_b32 s68, s69, 11
    s_lshl_b32 s69, s69, 17
    s_add_u32 m0, s66, 16384
    s_nop 0
    buffer_load_dwordx4 v248, s[28:31], s69 offen offset:0 lds
    v_mul_f32 v116, v116, v228
    v_mul_f32 v117, v117, v229
    v_mul_f32 v118, v118, v230
    v_mul_f32 v119, v119, v231
    v_cvt_pk_bf16_f32 v212, v112, v113
    v_cvt_pk_bf16_f32 v213, v114, v115
    v_cvt_pk_bf16_f32 v214, v116, v117
    v_cvt_pk_bf16_f32 v215, v118, v119
    s_nop 0
    v_permlane16_swap_b32 v212, v214
    buffer_load_dwordx4 v249, s[28:31], s69 offen offset:1024 lds
    v_permlane16_swap_b32 v213, v215
    buffer_load_dwordx4 v250, s[28:31], s69 offen offset:2048 lds
    buffer_load_dwordx4 v251, s[28:31], s69 offen offset:3072 lds
    s_mov_b32 m0, s66
    s_nop 0
    buffer_load_dwordx4 v246, s[24:27], s68 offen offset:0 lds
    buffer_load_dwordx4 v246, s[24:27], s68 offen offset:1024 lds
    buffer_load_dwordx4 v247, s[24:27], s68 offen offset:2048 lds
    buffer_load_dwordx4 v247, s[24:27], s68 offen offset:3072 lds
    s_add_u32 s66, s66, 32768
    s_cmp_ge_u32 s66, s71
    s_cselect_b32 s66, s70, s66
    buffer_store_dwordx4 v[212:215], v198, s[24:27], 0 offen offset:1024 sc1
    s_waitcnt vmcnt(29)
    s_barrier
    s_and_b32 s69, s36, 15
    s_lshr_b64 s[36:37], s[36:37], 4
    s_add_u32 s69, s69, s39
    s_lshl_b32 s68, s69, 11
    s_lshl_b32 s69, s69, 17
    s_add_u32 m0, s66, 16384
    s_nop 0
    buffer_load_dwordx4 v248, s[28:31], s69 offen offset:0 lds
    buffer_load_dwordx4 v249, s[28:31], s69 offen offset:1024 lds
    buffer_load_dwordx4 v250, s[28:31], s69 offen offset:2048 lds
    buffer_load_dwordx4 v251, s[28:31], s69 offen offset:3072 lds
    s_mov_b32 m0, s66
    s_nop 0
    buffer_load_dwordx4 v246, s[24:27], s68 offen offset:0 lds
    buffer_load_dwordx4 v246, s[24:27], s68 offen offset:1024 lds
    buffer_load_dwordx4 v247, s[24:27], s68 offen offset:2048 lds
    buffer_load_dwordx4 v247, s[24:27], s68 offen offset:3072 lds
    s_add_u32 s66, s66, 32768
    s_cmp_ge_u32 s66, s71
    s_cselect_b32 s66, s70, s66
    s_lshl_b32 s76, s59, 1
    s_lshl_b32 s77, s60, 4
    s_add_u32 s76, s76, s77
    s_lshl_b32 s77, s56, 2
    s_add_u32 s76, s76, s77
    v_mov_b32 v199, 8192
    s_waitcnt vmcnt(8)
    v_mov_b32 v2, 1
    s_mov_b64 exec, 1
    buffer_store_dword v2, v199, s[32:35], s76 offen sc1
    s_mov_b64 exec, -1
    v_lshlrev_b32 v199, 2, v1
    s_lshl_b32 s77, s62, 8
    s_add_u32 s77, s77, 8192
    s_movk_i32 s67, 2
gd_kernel_Q_loop2:
    s_barrier
    s_and_b32 s69, s36, 15
    s_lshr_b64 s[36:37], s[36:37], 4
    s_add_u32 s69, s69, s39
    s_lshl_b32 s68, s69, 11
    s_lshl_b32 s69, s69, 17
    s_add_u32 m0, s66, 16384
    s_nop 0
    buffer_load_dwordx4 v248, s[28:31], s69 offen offset:0 lds
    buffer_load_dwordx4 v249, s[28:31], s69 offen offset:1024 lds
    buffer_load_dwordx4 v250, s[28:31], s69 offen offset:2048 lds
    buffer_load_dwordx4 v251, s[28:31], s69 offen offset:3072 lds
    s_mov_b32 m0, s66
    s_nop 0
    buffer_load_dwordx4 v246, s[24:27], s68 offen offset:0 lds
    buffer_load_dwordx4 v246, s[24:27], s68 offen offset:1024 lds
    buffer_load_dwordx4 v247, s[24:27], s68 offen offset:2048 lds
    buffer_load_dwordx4 v247, s[24:27], s68 offen offset:3072 lds
    s_add_u32 s66, s66, 32768
    s_cmp_ge_u32 s66, s71
    s_cselect_b32 s66, s70, s66
    s_sub_u32 s67, s67, 1
    s_cbranch_scc0 gd_kernel_Q_loop2
    s_waitcnt vmcnt(25)
    s_barrier
    buffer_load_dword v245, v199, s[32:35], s77 offen sc1
    s_and_b32 s69, s36, 15
    s_lshr_b64 s[36:37], s[36:37], 4
    s_add_u32 s69, s69, s39
    s_lshl_b32 s68, s69, 11
    s_lshl_b32 s69, s69, 17
    s_add_u32 m0, s66, 16384
    s_nop 0
    buffer_load_dwordx4 v248, s[28:31], s69 offen offset:0 lds
    buffer_load_dwordx4 v249, s[28:31], s69 offen offset:1024 lds
    buffer_load_dwordx4 v250, s[28:31], s69 offen offset:2048 lds
    buffer_load_dwordx4 v251, s[28:31], s69 offen offset:3072 lds
    s_mov_b32 m0, s66
    s_nop 0
    buffer_load_dwordx4 v246, s[24:27], s68 offen offset:0 lds
    buffer_load_dwordx4 v246, s[24:27], s68 offen offset:1024 lds
    buffer_load_dwordx4 v247, s[24:27], s68 offen offset:2048 lds
    buffer_load_dwordx4 v247, s[24:27], s68 offen offset:3072 lds
    s_add_u32 s66, s66, 32768
    s_cmp_ge_u32 s66, s71
    s_cselect_b32 s66, s70, s66
    s_waitcnt vmcnt(25)
    s_barrier
    s_mov_b32 s3, 0x100000
    s_waitcnt vmcnt(8)
gd_kernel_pb_chk:
    v_cmp_ne_u32 vcc, 1, v245
    s_nop 4
    s_cbranch_vccz gd_kernel_pb_ok
    s_sub_u32 s3, s3, 1
    s_cbranch_scc1 gd_kernel_pb_ok
    s_sleep 2
    buffer_load_dword v245, v199, s[32:35], s77 offen sc1
    s_waitcnt vmcnt(0)
    s_branch gd_kernel_pb_chk
gd_kernel_pb_ok:
    s_add_u32 s38, s62, s63
    s_and_b32 s38, s38, 3
    s_mov_b32 s36, 0x76453201
    s_mov_b32 s37, 0xfecdba89
    s_cmp_eq_u32 s38, 1
    s_cselect_b32 s36, 0x75643120, s36
    s_cselect_b32 s37, 0xfdecb9a8, s37
    s_cmp_eq_u32 s38, 2
    s_cselect_b32 s36, 0x67542310, s36
    s_cselect_b32 s37, 0xefdcab98, s37
    s_cmp_eq_u32 s38, 3
    s_cselect_b32 s36, 0x86534210, s36
    s_cselect_b32 s37, 0xfedbca97, s37
    s_mov_b32 s68, 0x76453201
    s_mov_b32 s69, 0x0
    s_cmp_eq_u32 s38, 1
    s_cselect_b32 s68, 0x75643120, s68
    s_cselect_b32 s69, 0x0, s69
    s_cmp_eq_u32 s38, 2
    s_cselect_b32 s68, 0x67542310, s68
    s_cselect_b32 s69, 0x0, s69
    s_cmp_eq_u32 s38, 3
    s_cselect_b32 s68, 0x76534210, s68
    s_cselect_b32 s69, 0x0, s69
    s_cmp_eq_u32 s61, 0
    s_cselect_b64 s[36:37], s[68:69], s[36:37]
    s_cselect_b32 s39, 48, 32
    s_and_b32 s69, s36, 15
    s_lshr_b64 s[36:37], s[36:37], 4
    s_add_u32 s69, s69, s39
    s_lshl_b32 s68, s69, 11
    s_lshl_b32 s69, s69, 17
    s_add_u32 m0, s66, 16384
    s_nop 0
    buffer_load_dwordx4 v248, s[28:31], s69 offen offset:0 lds
    buffer_load_dwordx4 v249, s[28:31], s69 offen offset:1024 lds
    buffer_load_dwordx4 v250, s[28:31], s69 offen offset:2048 lds
    buffer_load_dwordx4 v251, s[28:31], s69 offen offset:3072 lds
    s_mov_b32 m0, s66
    s_nop 0
    buffer_load_dwordx4 v246, s[24:27], s68 offen offset:0 lds
    buffer_load_dwordx4 v246, s[24:27], s68 offen offset:1024 lds
    buffer_load_dwordx4 v247, s[24:27], s68 offen offset:2048 lds
    buffer_load_dwordx4 v247, s[24:27], s68 offen offset:3072 lds
    s_add_u32 s66, s66, 32768
    s_cmp_ge_u32 s66, s71
    s_cselect_b32 s66, s70, s66
    s_movk_i32 s67, 1
gd_kernel_Q_loop3:
    s_barrier
    s_and_b32 s69, s36, 15
    s_lshr_b64 s[36:37], s[36:37], 4
    s_add_u32 s69, s69, s39
    s_lshl_b32 s68, s69, 11
    s_lshl_b32 s69, s69, 17
    s_add_u32 m0, s66, 16384
    s_nop 0
    buffer_load_dwordx4 v248, s[28:31], s69 offen offset:0 lds
    buffer_load_dwordx4 v249, s[28:31], s69 offen offset:1024 lds
    buffer_load_dwordx4 v250, s[28:31], s69 offen offset:2048 lds
    buffer_load_dwordx4 v251, s[28:31], s69 offen offset:3072 lds
    s_mov_b32 m0, s66
    s_nop 0
    buffer_load_dwordx4 v246, s[24:27], s68 offen offset:0 lds
    buffer_load_dwordx4 v246, s[24:27], s68 offen offset:1024 lds
    buffer_load_dwordx4 v247, s[24:27], s68 offen offset:2048 lds
    buffer_load_dwordx4 v247, s[24:27], s68 offen offset:3072 lds
    s_add_u32 s66, s66, 32768
    s_cmp_ge_u32 s66, s71
    s_cselect_b32 s66, s70, s66
    s_sub_u32 s67, s67, 1
    s_cbranch_scc0 gd_kernel_Q_loop3
    s_add_u32 s67, s73, 4
gd_kernel_Q_loop4:
    s_waitcnt vmcnt(24)
    s_barrier
    s_and_b32 s69, s36, 15
    s_lshr_b64 s[36:37], s[36:37], 4
    s_add_u32 s69, s69, s39
    s_lshl_b32 s68, s69, 11
    s_lshl_b32 s69, s69, 17
    s_add_u32 m0, s66, 16384
    s_nop 0
    buffer_load_dwordx4 v248, s[28:31], s69 offen offset:0 lds
    buffer_load_dwordx4 v249, s[28:31], s69 offen offset:1024 lds
    buffer_load_dwordx4 v250, s[28:31], s69 offen offset:2048 lds
    buffer_load_dwordx4 v251, s[28:31], s69 offen offset:3072 lds
    s_mov_b32 m0, s66
    s_nop 0
    buffer_load_dwordx4 v246, s[24:27], s68 offen offset:0 lds
    buffer_load_dwordx4 v246, s[24:27], s68 offen offset:1024 lds
    buffer_load_dwordx4 v247, s[24:27], s68 offen offset:2048 lds
    buffer_load_dwordx4 v247, s[24:27], s68 offen offset:3072 lds
    s_add_u32 s66, s66, 32768
    s_cmp_ge_u32 s66, s71
    s_cselect_b32 s66, s70, s66
    s_sub_u32 s67, s67, 1
    s_cbranch_scc0 gd_kernel_Q_loop4
    s_waitcnt vmcnt(24)
    s_barrier
    s_waitcnt vmcnt(16)
    s_barrier
    s_waitcnt vmcnt(8)
    s_barrier
    s_waitcnt vmcnt(0)
    s_barrier
gd_kernel_fin:
gd_kernel_end:
    s_endpgm

.section .rodata,"a"
.p2align 6
.amdhsa_kernel front_kernel
  .amdhsa_next_free_vgpr 64
  .amdhsa_next_free_sgpr 64
  .amdhsa_accum_offset 64
  .amdhsa_group_segment_fixed_size 0
  .amdhsa_kernarg_size 96
  .amdhsa_user_sgpr_count 2
  .amdhsa_user_sgpr_kernarg_segment_ptr 1
  .amdhsa_system_sgpr_workgroup_id_x 1
  .amdhsa_float_denorm_mode_32 3
.end_amdhsa_kernel
.p2align 6
.amdhsa_kernel mod1_kernel
  .amdhsa_next_free_vgpr 64
  .amdhsa_next_free_sgpr 80
  .amdhsa_accum_offset 64
  .amdhsa_group_segment_fixed_size 0
  .amdhsa_kernarg_size 96
  .amdhsa_user_sgpr_count 2
  .amdhsa_user_sgpr_kernarg_segment_ptr 1
  .amdhsa_system_sgpr_workgroup_id_x 1
  .amdhsa_float_denorm_mode_32 3
.end_amdhsa_kernel
.p2align 6
.amdhsa_kernel qkv_kernel
  .amdhsa_next_free_vgpr 228
  .amdhsa_next_free_sgpr 86
  .amdhsa_accum_offset 228
  .amdhsa_group_segment_fixed_size 0
  .amdhsa_kernarg_size 96
  .amdhsa_user_sgpr_count 2
  .amdhsa_user_sgpr_kernarg_segment_ptr 1
  .amdhsa_system_sgpr_workgroup_id_x 1
  .amdhsa_float_denorm_mode_32 3
.end_amdhsa_kernel
.p2align 6
.amdhsa_kernel wo_kernel
  .amdhsa_next_free_vgpr 160
  .amdhsa_next_free_sgpr 84
  .amdhsa_accum_offset 160
  .amdhsa_group_segment_fixed_size 0
  .amdhsa_kernarg_size 96
  .amdhsa_user_sgpr_count 2
  .amdhsa_user_sgpr_kernarg_segment_ptr 1
  .amdhsa_system_sgpr_workgroup_id_x 1
  .amdhsa_float_denorm_mode_32 3
.end_amdhsa_kernel
.p2align 6
.amdhsa_kernel ln2_kernel
  .amdhsa_next_free_vgpr 80
  .amdhsa_next_free_sgpr 32
  .amdhsa_accum_offset 80
  .amdhsa_group_segment_fixed_size 0
  .amdhsa_kernarg_size 96
  .amdhsa_user_sgpr_count 2
  .amdhsa_user_sgpr_kernarg_segment_ptr 1
  .amdhsa_system_sgpr_workgroup_id_x 1
  .amdhsa_float_denorm_mode_32 3
.end_amdhsa_kernel
.p2align 6
.amdhsa_kernel gd_kernel
  .amdhsa_next_free_vgpr 252
  .amdhsa_next_free_sgpr 80
  .amdhsa_accum_offset 252
  .amdhsa_group_segment_fixed_size 0
  .amdhsa_kernarg_size 96
  .amdhsa_user_sgpr_count 2
  .amdhsa_user_sgpr_kernarg_segment_ptr 1
  .amdhsa_system_sgpr_workgroup_id_x 1
  .amdhsa_float_denorm_mode_32 3
.end_amdhsa_kernel
```

```asm
; @launch kernel=front_kernel grid=(256,1,1) block=(512,1,1) lds=4096
; @launch kernel=mod1_kernel grid=(256,1,1) block=(512,1,1) lds=1024
; @launch kernel=mega_kernel grid=(256,1,1) block=(512,1,1) lds=163840
.amdgcn_target "amdgcn-amd-amdhsa--gfx950"
.text
.globl front_kernel
.p2align 8
.type front_kernel,@function
front_kernel:
    s_cmp_ge_u32 s2, 256
    s_cbranch_scc1 front_kernel_end
    s_load_dwordx4 s[4:7], s[0:1], 56
    s_load_dwordx4 s[8:11], s[0:1], 0
    s_load_dwordx2 s[40:41], s[0:1], 88
    s_and_b32 s3, s2, 7
    s_lshr_b32 s42, s2, 4
    s_lshl_b32 s42, s42, 3
    s_or_b32 s50, s3, s42
    v_and_b32 v1, 63, v0
    s_bitcmp1_b32 s2, 3
    s_cbranch_scc1 front_kernel_stats
    s_and_b32 s3, s50, 31
    s_lshl_b32 s42, s3, 7
    s_lshr_b32 s43, s50, 5
    s_lshl_b32 s44, s43, 8
    s_lshl_b32 s45, s43, 13
    s_lshl_b32 s3, s3, 8
    s_add_u32 s45, s45, s3
    v_lshrrev_b32 v40, 3, v0
    v_add_u32 v40, s44, v40
    v_lshlrev_b32 v5, 1, v40
    s_movk_i32 s48, 12288
    v_mul_lo_u32 v40, s48, v40
    v_and_b32 v4, 7, v0
    v_lshl_add_u32 v40, v4, 4, v40
    v_add_u32 v4, s42, v40
    s_waitcnt lgkmcnt(0)
    s_mov_b32 s12, s4
    s_mov_b32 s13, s5
    s_mov_b32 s14, 0x800
    s_mov_b32 s15, 0x20000
    s_mov_b32 s16, s6
    s_mov_b32 s17, s7
    s_mov_b32 s18, 0xc00000
    s_mov_b32 s19, 0x20000
    buffer_load_ushort v8, v5, s[12:15], 0 offen offset:0
    buffer_load_ushort v9, v5, s[12:15], 0 offen offset:128
    buffer_load_ushort v10, v5, s[12:15], 0 offen offset:256
    buffer_load_ushort v11, v5, s[12:15], 0 offen offset:384
    s_mov_b32 s48, 0x0
    buffer_load_dwordx4 v[16:19], v4, s[16:19], s48 offen
    s_mov_b32 s48, 0xc0000
    buffer_load_dwordx4 v[20:23], v4, s[16:19], s48 offen
    s_mov_b32 s48, 0x180000
    buffer_load_dwordx4 v[24:27], v4, s[16:19], s48 offen
    s_mov_b32 s48, 0x240000
    buffer_load_dwordx4 v[28:31], v4, s[16:19], s48 offen
    s_add_u32 s20, s40, 0x10000
    s_addc_u32 s21, s41, 0
    s_mov_b32 s22, 0x8000
    s_mov_b32 s23, 0x20000
    s_waitcnt vmcnt(4)
    v_lshlrev_b32 v8, 16, v8
    v_lshlrev_b32 v9, 16, v9
    v_lshlrev_b32 v10, 16, v10
    v_lshlrev_b32 v11, 16, v11
    v_mul_f32 v40, 0xbfb8aa3b, v8
    v_mul_f32 v41, 0xbfb8aa3b, v9
    v_mul_f32 v42, 0xbfb8aa3b, v10
    v_mul_f32 v43, 0xbfb8aa3b, v11
    v_exp_f32 v40, v40
    v_exp_f32 v41, v41
    v_exp_f32 v42, v42
    v_exp_f32 v43, v43
    v_add_f32 v40, 1.0, v40
    v_add_f32 v41, 1.0, v41
    v_add_f32 v42, 1.0, v42
    v_add_f32 v43, 1.0, v43
    v_rcp_f32 v40, v40
    v_rcp_f32 v41, v41
    v_rcp_f32 v42, v42
    v_rcp_f32 v43, v43
    v_mul_f32 v8, v8, v40
    v_mul_f32 v9, v9, v41
    v_mul_f32 v10, v10, v42
    v_mul_f32 v11, v11, v43
    v_cvt_pk_bf16_f32 v40, v8, v8
    v_lshlrev_b32 v8, 16, v40
    v_cvt_pk_bf16_f32 v41, v9, v9
    v_lshlrev_b32 v9, 16, v41
    v_cvt_pk_bf16_f32 v42, v10, v10
    v_lshlrev_b32 v10, 16, v42
    v_cvt_pk_bf16_f32 v43, v11, v11
    v_lshlrev_b32 v11, 16, v43
    s_waitcnt vmcnt(3)
    v_lshlrev_b32 v40, 16, v16
    v_and_b32 v41, 0xffff0000, v16
    v_lshlrev_b32 v42, 16, v17
    v_and_b32 v43, 0xffff0000, v17
    v_lshlrev_b32 v44, 16, v18
    v_and_b32 v45, 0xffff0000, v18
    v_lshlrev_b32 v46, 16, v19
    v_and_b32 v47, 0xffff0000, v19
    v_mul_f32 v32, v8, v40
    v_mul_f32 v33, v8, v41
    v_mul_f32 v34, v8, v42
    v_mul_f32 v35, v8, v43
    v_mul_f32 v36, v8, v44
    v_mul_f32 v37, v8, v45
    v_mul_f32 v38, v8, v46
    v_mul_f32 v39, v8, v47
    s_waitcnt vmcnt(2)
    v_lshlrev_b32 v40, 16, v20
    v_and_b32 v41, 0xffff0000, v20
    v_lshlrev_b32 v42, 16, v21
    v_and_b32 v43, 0xffff0000, v21
    v_lshlrev_b32 v44, 16, v22
    v_and_b32 v45, 0xffff0000, v22
    v_lshlrev_b32 v46, 16, v23
    v_and_b32 v47, 0xffff0000, v23
    v_fmac_f32 v32, v9, v40
    v_fmac_f32 v33, v9, v41
    v_fmac_f32 v34, v9, v42
    v_fmac_f32 v35, v9, v43
    v_fmac_f32 v36, v9, v44
    v_fmac_f32 v37, v9, v45
    v_fmac_f32 v38, v9, v46
    v_fmac_f32 v39, v9, v47
    s_waitcnt vmcnt(1)
    v_lshlrev_b32 v40, 16, v24
    v_and_b32 v41, 0xffff0000, v24
    v_lshlrev_b32 v42, 16, v25
    v_and_b32 v43, 0xffff0000, v25
    v_lshlrev_b32 v44, 16, v26
    v_and_b32 v45, 0xffff0000, v26
    v_lshlrev_b32 v46, 16, v27
    v_and_b32 v47, 0xffff0000, v27
    v_fmac_f32 v32, v10, v40
    v_fmac_f32 v33, v10, v41
    v_fmac_f32 v34, v10, v42
    v_fmac_f32 v35, v10, v43
    v_fmac_f32 v36, v10, v44
    v_fmac_f32 v37, v10, v45
    v_fmac_f32 v38, v10, v46
    v_fmac_f32 v39, v10, v47
    s_waitcnt vmcnt(0)
    v_lshlrev_b32 v40, 16, v28
    v_and_b32 v41, 0xffff0000, v28
    v_lshlrev_b32 v42, 16, v29
    v_and_b32 v43, 0xffff0000, v29
    v_lshlrev_b32 v44, 16, v30
    v_and_b32 v45, 0xffff0000, v30
    v_lshlrev_b32 v46, 16, v31
    v_and_b32 v47, 0xffff0000, v31
    v_fmac_f32 v32, v11, v40
    v_fmac_f32 v33, v11, v41
    v_fmac_f32 v34, v11, v42
    v_fmac_f32 v35, v11, v43
    v_fmac_f32 v36, v11, v44
    v_fmac_f32 v37, v11, v45
    v_fmac_f32 v38, v11, v46
    v_fmac_f32 v39, v11, v47
    v_add_f32_dpp v32, v32, v32 row_ror:8 row_mask:0xf bank_mask:0xf
    v_add_f32_dpp v33, v33, v33 row_ror:8 row_mask:0xf bank_mask:0xf
    v_add_f32_dpp v34, v34, v34 row_ror:8 row_mask:0xf bank_mask:0xf
    v_add_f32_dpp v35, v35, v35 row_ror:8 row_mask:0xf bank_mask:0xf
    v_add_f32_dpp v36, v36, v36 row_ror:8 row_mask:0xf bank_mask:0xf
    v_add_f32_dpp v37, v37, v37 row_ror:8 row_mask:0xf bank_mask:0xf
    v_add_f32_dpp v38, v38, v38 row_ror:8 row_mask:0xf bank_mask:0xf
    v_add_f32_dpp v39, v39, v39 row_ror:8 row_mask:0xf bank_mask:0xf
    v_mov_b32 v40, v32
    v_mov_b32 v41, v33
    v_mov_b32 v42, v34
    v_mov_b32 v43, v35
    v_mov_b32 v44, v36
    v_mov_b32 v45, v37
    v_mov_b32 v46, v38
    v_mov_b32 v47, v39
    v_permlane32_swap_b32 v32, v40
    v_permlane32_swap_b32 v33, v41
    v_permlane32_swap_b32 v34, v42
    v_permlane32_swap_b32 v35, v43
    v_permlane32_swap_b32 v36, v44
    v_permlane32_swap_b32 v37, v45
    v_permlane32_swap_b32 v38, v46
    v_permlane32_swap_b32 v39, v47
    v_add_f32 v32, v32, v40
    v_add_f32 v33, v33, v41
    v_add_f32 v34, v34, v42
    v_add_f32 v35, v35, v43
    v_add_f32 v36, v36, v44
    v_add_f32 v37, v37, v45
    v_add_f32 v38, v38, v46
    v_add_f32 v39, v39, v47
    v_mov_b32 v40, v32
    v_mov_b32 v41, v33
    v_mov_b32 v42, v34
    v_mov_b32 v43, v35
    v_mov_b32 v44, v36
    v_mov_b32 v45, v37
    v_mov_b32 v46, v38
    v_mov_b32 v47, v39
    v_permlane16_swap_b32 v32, v40
    v_permlane16_swap_b32 v33, v41
    v_permlane16_swap_b32 v34, v42
    v_permlane16_swap_b32 v35, v43
    v_permlane16_swap_b32 v36, v44
    v_permlane16_swap_b32 v37, v45
    v_permlane16_swap_b32 v38, v46
    v_permlane16_swap_b32 v39, v47
    v_add_f32 v32, v32, v40
    v_add_f32 v33, v33, v41
    v_add_f32 v34, v34, v42
    v_add_f32 v35, v35, v43
    v_add_f32 v36, v36, v44
    v_add_f32 v37, v37, v45
    v_add_f32 v38, v38, v46
    v_add_f32 v39, v39, v47
    v_lshrrev_b32 v40, 6, v0
    v_lshlrev_b32 v40, 8, v40
    v_and_b32 v41, 7, v0
    v_lshl_add_u32 v40, v41, 5, v40
    ds_write_b128 v40, v[32:35] offset:0
    ds_write_b128 v40, v[36:39] offset:16
    v_and_b32 v41, 63, v0
    v_lshlrev_b32 v41, 2, v41
    v_add_u32 v42, 0, v41
    s_waitcnt lgkmcnt(0)
    s_barrier
    v_cmp_gt_u32 vcc, 64, v0
    s_nop 3
    s_and_saveexec_b64 s[46:47], vcc
    s_cbranch_execz front_kernel_gskip
    ds_read_b32 v32, v42 offset:0
    ds_read_b32 v33, v42 offset:256
    ds_read_b32 v34, v42 offset:512
    ds_read_b32 v35, v42 offset:768
    ds_read_b32 v36, v42 offset:1024
    ds_read_b32 v37, v42 offset:1280
    ds_read_b32 v38, v42 offset:1536
    ds_read_b32 v39, v42 offset:1792
    s_waitcnt lgkmcnt(0)
    v_add_f32 v32, v32, v33
    v_add_f32 v34, v34, v35
    v_add_f32 v36, v36, v37
    v_add_f32 v38, v38, v39
    v_add_f32 v32, v32, v34
    v_add_f32 v36, v36, v38
    v_add_f32 v32, v32, v36
    buffer_store_dword v32, v41, s[20:23], s45 offen
front_kernel_gskip:
    s_mov_b64 exec, -1
    s_branch front_kernel_fin
front_kernel_stats:
    v_lshrrev_b32 v2, 6, v0
    s_lshl_b32 s3, s50, 4
    v_lshl_add_u32 v2, v2, 1, s3
    v_lshlrev_b32 v3, 11, v2
    v_lshl_add_u32 v3, v1, 4, v3
    v_lshlrev_b32 v2, 3, v2
    s_waitcnt lgkmcnt(0)
    s_mov_b32 s24, s8
    s_mov_b32 s25, s9
    s_mov_b32 s26, 0x400000
    s_mov_b32 s27, 0x20000
    buffer_load_dwordx4 v[8:11], v3, s[24:27], 0 offen offset:0
    buffer_load_dwordx4 v[12:15], v3, s[24:27], 0 offen offset:1024
    buffer_load_dwordx4 v[16:19], v3, s[24:27], 0 offen offset:2048
    buffer_load_dwordx4 v[20:23], v3, s[24:27], 0 offen offset:3072
    s_add_u32 s28, s40, 0x40000
    s_addc_u32 s29, s41, 0
    s_mov_b32 s30, 0x4000
    s_mov_b32 s31, 0x20000
    s_waitcnt vmcnt(0)
    v_lshlrev_b32 v24, 16, v8
    v_and_b32 v25, 0xffff0000, v8
    v_lshlrev_b32 v26, 16, v9
    v_and_b32 v27, 0xffff0000, v9
    v_lshlrev_b32 v28, 16, v10
    v_and_b32 v29, 0xffff0000, v10
    v_lshlrev_b32 v30, 16, v11
    v_and_b32 v31, 0xffff0000, v11
    v_lshlrev_b32 v32, 16, v12
    v_and_b32 v33, 0xffff0000, v12
    v_lshlrev_b32 v34, 16, v13
    v_and_b32 v35, 0xffff0000, v13
    v_lshlrev_b32 v36, 16, v14
    v_and_b32 v37, 0xffff0000, v14
    v_lshlrev_b32 v38, 16, v15
    v_and_b32 v39, 0xffff0000, v15
    v_lshlrev_b32 v40, 16, v16
    v_and_b32 v41, 0xffff0000, v16
    v_lshlrev_b32 v42, 16, v17
    v_and_b32 v43, 0xffff0000, v17
    v_lshlrev_b32 v44, 16, v18
    v_and_b32 v45, 0xffff0000, v18
    v_lshlrev_b32 v46, 16, v19
    v_and_b32 v47, 0xffff0000, v19
    v_lshlrev_b32 v48, 16, v20
    v_and_b32 v49, 0xffff0000, v20
    v_lshlrev_b32 v50, 16, v21
    v_and_b32 v51, 0xffff0000, v21
    v_lshlrev_b32 v52, 16, v22
    v_and_b32 v53, 0xffff0000, v22
    v_lshlrev_b32 v54, 16, v23
    v_and_b32 v55, 0xffff0000, v23
    v_add_f32 v56, v24, v25
    v_add_f32 v57, v26, v27
    v_add_f32 v60, v40, v41
    v_add_f32 v61, v42, v43
    v_add_f32 v56, v56, v28
    v_add_f32 v57, v57, v29
    v_add_f32 v60, v60, v44
    v_add_f32 v61, v61, v45
    v_add_f32 v56, v56, v30
    v_add_f32 v57, v57, v31
    v_add_f32 v60, v60, v46
    v_add_f32 v61, v61, v47
    v_add_f32 v56, v56, v32
    v_add_f32 v57, v57, v33
    v_add_f32 v60, v60, v48
    v_add_f32 v61, v61, v49
    v_add_f32 v56, v56, v34
    v_add_f32 v57, v57, v35
    v_add_f32 v60, v60, v50
    v_add_f32 v61, v61, v51
    v_add_f32 v56, v56, v36
    v_add_f32 v57, v57, v37
    v_add_f32 v60, v60, v52
    v_add_f32 v61, v61, v53
    v_add_f32 v56, v56, v38
    v_add_f32 v57, v57, v39
    v_add_f32 v60, v60, v54
    v_add_f32 v61, v61, v55
    v_add_f32 v56, v56, v57
    v_add_f32 v60, v60, v61
    s_nop 0
    v_add_f32_dpp v56, v56, v56 quad_perm:[1,0,3,2] row_mask:0xf bank_mask:0xf
    v_add_f32_dpp v60, v60, v60 quad_perm:[1,0,3,2] row_mask:0xf bank_mask:0xf
    s_nop 0
    v_add_f32_dpp v56, v56, v56 quad_perm:[2,3,0,1] row_mask:0xf bank_mask:0xf
    v_add_f32_dpp v60, v60, v60 quad_perm:[2,3,0,1] row_mask:0xf bank_mask:0xf
    s_nop 0
    v_add_f32_dpp v56, v56, v56 row_half_mirror row_mask:0xf bank_mask:0xf
    v_add_f32_dpp v60, v60, v60 row_half_mirror row_mask:0xf bank_mask:0xf
    s_nop 0
    v_add_f32_dpp v56, v56, v56 row_mirror row_mask:0xf bank_mask:0xf
    v_add_f32_dpp v60, v60, v60 row_mirror row_mask:0xf bank_mask:0xf
    v_mov_b32 v58, v56
    v_mov_b32 v62, v60
    s_nop 0
    v_permlane32_swap_b32 v56, v58
    v_permlane32_swap_b32 v60, v62
    v_add_f32 v56, v56, v58
    v_add_f32 v60, v60, v62
    v_mov_b32 v58, v56
    v_mov_b32 v62, v60
    s_nop 0
    v_permlane16_swap_b32 v56, v58
    v_permlane16_swap_b32 v60, v62
    v_add_f32 v56, v56, v58
    v_add_f32 v60, v60, v62
    v_mul_f32 v56, 0x3a800000, v56
    v_mul_f32 v60, 0x3a800000, v60
    v_sub_f32 v58, v24, v56
    v_mul_f32 v57, v58, v58
    v_sub_f32 v62, v40, v60
    v_mul_f32 v61, v62, v62
    v_sub_f32 v59, v25, v56
    v_fmac_f32 v57, v59, v59
    v_sub_f32 v63, v41, v60
    v_fmac_f32 v61, v63, v63
    v_sub_f32 v58, v26, v56
    v_fmac_f32 v57, v58, v58
    v_sub_f32 v62, v42, v60
    v_fmac_f32 v61, v62, v62
    v_sub_f32 v59, v27, v56
    v_fmac_f32 v57, v59, v59
    v_sub_f32 v63, v43, v60
    v_fmac_f32 v61, v63, v63
    v_sub_f32 v58, v28, v56
    v_fmac_f32 v57, v58, v58
    v_sub_f32 v62, v44, v60
    v_fmac_f32 v61, v62, v62
    v_sub_f32 v59, v29, v56
    v_fmac_f32 v57, v59, v59
    v_sub_f32 v63, v45, v60
    v_fmac_f32 v61, v63, v63
    v_sub_f32 v58, v30, v56
    v_fmac_f32 v57, v58, v58
    v_sub_f32 v62, v46, v60
    v_fmac_f32 v61, v62, v62
    v_sub_f32 v59, v31, v56
    v_fmac_f32 v57, v59, v59
    v_sub_f32 v63, v47, v60
    v_fmac_f32 v61, v63, v63
    v_sub_f32 v58, v32, v56
    v_fmac_f32 v57, v58, v58
    v_sub_f32 v62, v48, v60
    v_fmac_f32 v61, v62, v62
    v_sub_f32 v59, v33, v56
    v_fmac_f32 v57, v59, v59
    v_sub_f32 v63, v49, v60
    v_fmac_f32 v61, v63, v63
    v_sub_f32 v58, v34, v56
    v_fmac_f32 v57, v58, v58
    v_sub_f32 v62, v50, v60
    v_fmac_f32 v61, v62, v62
    v_sub_f32 v59, v35, v56
    v_fmac_f32 v57, v59, v59
    v_sub_f32 v63, v51, v60
    v_fmac_f32 v61, v63, v63
    v_sub_f32 v58, v36, v56
    v_fmac_f32 v57, v58, v58
    v_sub_f32 v62, v52, v60
    v_fmac_f32 v61, v62, v62
    v_sub_f32 v59, v37, v56
    v_fmac_f32 v57, v59, v59
    v_sub_f32 v63, v53, v60
    v_fmac_f32 v61, v63, v63
    v_sub_f32 v58, v38, v56
    v_fmac_f32 v57, v58, v58
    v_sub_f32 v62, v54, v60
    v_fmac_f32 v61, v62, v62
    v_sub_f32 v59, v39, v56
    v_fmac_f32 v57, v59, v59
    v_sub_f32 v63, v55, v60
    v_fmac_f32 v61, v63, v63
    v_add_f32_dpp v57, v57, v57 quad_perm:[1,0,3,2] row_mask:0xf bank_mask:0xf
    s_nop 0
    v_add_f32_dpp v61, v61, v61 quad_perm:[1,0,3,2] row_mask:0xf bank_mask:0xf
    v_add_f32_dpp v57, v57, v57 quad_perm:[2,3,0,1] row_mask:0xf bank_mask:0xf
    s_nop 0
    v_add_f32_dpp v61, v61, v61 quad_perm:[2,3,0,1] row_mask:0xf bank_mask:0xf
    v_add_f32_dpp v57, v57, v57 row_half_mirror row_mask:0xf bank_mask:0xf
    s_nop 0
    v_add_f32_dpp v61, v61, v61 row_half_mirror row_mask:0xf bank_mask:0xf
    v_add_f32_dpp v57, v57, v57 row_mirror row_mask:0xf bank_mask:0xf
    s_nop 0
    v_add_f32_dpp v61, v61, v61 row_mirror row_mask:0xf bank_mask:0xf
    v_mov_b32 v58, v57
    v_mov_b32 v62, v61
    s_nop 0
    v_permlane32_swap_b32 v57, v58
    v_permlane32_swap_b32 v61, v62
    v_add_f32 v57, v57, v58
    v_add_f32 v61, v61, v62
    v_mov_b32 v58, v57
    v_mov_b32 v62, v61
    s_nop 0
    v_permlane16_swap_b32 v57, v58
    v_permlane16_swap_b32 v61, v62
    v_add_f32 v57, v57, v58
    v_add_f32 v61, v61, v62
    v_mul_f32 v57, 0x3a800000, v57
    v_mul_f32 v61, 0x3a800000, v61
    v_cvt_pk_bf16_f32 v58, v56, v57
    v_lshlrev_b32 v56, 16, v58
    v_and_b32 v57, 0xffff0000, v58
    v_cvt_pk_bf16_f32 v62, v60, v61
    v_lshlrev_b32 v60, 16, v62
    v_and_b32 v61, 0xffff0000, v62
    v_add_f32 v57, 0x3727c5ac, v57
    v_add_f32 v61, 0x3727c5ac, v61
    v_cvt_pk_bf16_f32 v58, v57, v57
    v_lshlrev_b32 v57, 16, v58
    v_cvt_pk_bf16_f32 v62, v61, v61
    v_lshlrev_b32 v61, 16, v62
    v_sqrt_f32 v57, v57
    v_sqrt_f32 v61, v61
    v_cvt_pk_bf16_f32 v58, v57, v57
    v_lshlrev_b32 v57, 16, v58
    v_cvt_pk_bf16_f32 v62, v61, v61
    v_lshlrev_b32 v61, 16, v62
    v_rcp_f32 v57, v57
    v_rcp_f32 v61, v61
    v_mov_b32 v58, v60
    v_mov_b32 v59, v61
    v_cmp_eq_u32 vcc, 0, v1
    s_nop 3
    s_and_saveexec_b64 s[46:47], vcc
    buffer_store_dwordx4 v[56:59], v2, s[28:31], 0 offen
front_kernel_fin:
front_kernel_end:
    s_endpgm
.globl mod1_kernel
.p2align 8
.type mod1_kernel,@function
mod1_kernel:
    s_cmp_ge_u32 s2, 256
    s_cbranch_scc1 mod1_kernel_end
    s_load_dwordx4 s[8:11], s[0:1], 0
    s_load_dwordx2 s[40:41], s[0:1], 88
    s_lshr_b32 s3, s2, 4
    s_lshl_b32 s3, s3, 7
    s_and_b32 s60, s2, 15
    v_lshrrev_b32 v1, 3, v0
    v_add_u32 v1, s3, v1
    v_lshlrev_b32 v2, 3, v1
    v_and_b32 v3, 7, v0
    v_lshrrev_b32 v4, 4, v1
    s_mov_b32 s3, 32768
    v_mul_lo_u32 v60, s3, v4
    v_and_b32 v4, 15, v1
    v_lshl_add_u32 v60, v4, 4, v60
    v_lshl_add_u32 v60, v3, 8, v60
    s_lshl_b32 s3, s60, 11
    v_add_u32 v60, s3, v60
    v_lshlrev_b32 v1, 11, v1
    s_lshl_b32 s3, s60, 7
    v_lshl_add_u32 v4, v3, 4, s3
    v_add_u32 v1, v4, v1
    v_and_b32 v4, 63, v0
    v_bfe_u32 v5, v0, 6, 1
    v_lshlrev_b32 v5, 12, v5
    v_lshl_add_u32 v5, v4, 2, v5
    s_lshl_b32 s3, s60, 8
    v_add_u32 v5, s3, v5
    s_lshl_b32 s3, s2, 9
    v_add_lshl_u32 v6, v0, s3, 4
    s_mov_b32 s64, 0
    s_mov_b32 s65, 8192
    s_mov_b32 s66, 16384
    s_mov_b32 s67, 24576
    s_mov_b32 s72, 0x20000
    s_mov_b32 s76, 0x20000
    s_waitcnt lgkmcnt(0)
    s_add_u32 s32, s40, 0x10000
    s_addc_u32 s33, s41, 0
    s_mov_b32 s34, 0x8000
    s_mov_b32 s35, 0x20000
    s_add_u32 s28, s40, 0x40000
    s_addc_u32 s29, s41, 0
    s_mov_b32 s30, 0x4000
    s_mov_b32 s31, 0x20000
    s_mov_b32 s24, s8
    s_mov_b32 s25, s9
    s_mov_b32 s26, 0x400000
    s_mov_b32 s27, 0x20000
    buffer_load_dword v8, v5, s[32:35], s64 offen
    buffer_load_dword v9, v5, s[32:35], s65 offen
    buffer_load_dword v10, v5, s[32:35], s66 offen
    buffer_load_dword v11, v5, s[32:35], s67 offen
    buffer_load_dwordx2 v[16:17], v2, s[28:31], 0 offen offset:0
    buffer_load_dwordx2 v[18:19], v2, s[28:31], 0 offen offset:512
    buffer_load_dwordx4 v[24:27], v1, s[24:27], 0 offen
    buffer_load_dwordx4 v[28:31], v1, s[24:27], s72 offen
    s_mov_b32 s12, s10
    s_mov_b32 s13, s11
    s_mov_b32 s14, 0x600000
    s_mov_b32 s15, 0x20000
    s_mov_b32 s3, 0x0
    buffer_load_dword v7, v6, s[12:15], s3 offen
    s_mov_b32 s3, 0x200000
    buffer_load_dword v7, v6, s[12:15], s3 offen
    s_mov_b32 s3, 0x400000
    buffer_load_dword v7, v6, s[12:15], s3 offen
    s_add_u32 s36, s40, 0x100000
    s_addc_u32 s37, s41, 0
    s_mov_b32 s38, 0x400000
    s_mov_b32 s39, 0x20000
    s_add_u32 s16, s40, 0x50000
    s_addc_u32 s17, s41, 0
    s_mov_b32 s18, 0x8000
    s_mov_b32 s19, 0x20000
    s_add_u32 s20, s40, 0x60000
    s_addc_u32 s21, s41, 0
    s_mov_b32 s22, 0x50000
    s_mov_b32 s23, 0x20000
    s_lshl_b32 s3, s2, 11
    v_lshl_add_u32 v61, v0, 2, s3
    v_mov_b32 v62, 0
    v_mov_b32 v63, -1
    buffer_store_dword v62, v61, s[16:19], 0 offen
    buffer_store_dword v63, v61, s[20:23], 0 offen
    s_waitcnt vmcnt(9)
    v_add_f32 v8, v8, v9
    v_add_f32 v10, v10, v11
    v_add_f32 v8, v8, v10
    v_cvt_pk_bf16_f32 v9, v8, v8
    v_lshlrev_b32 v8, 16, v9
    v_bfe_u32 v9, v0, 6, 1
    v_cvt_f32_u32 v9, v9
    v_add_f32 v8, v8, v9
    v_cvt_pk_bf16_f32 v9, v8, v8
    v_lshlrev_b32 v8, 16, v9
    v_and_b32 v9, 127, v0
    v_lshlrev_b32 v9, 2, v9
    ds_write_b32 v9, v8
    v_lshlrev_b32 v9, 5, v3
    s_waitcnt lgkmcnt(0)
    s_barrier
    ds_read_b128 v[32:35], v9
    ds_read_b128 v[36:39], v9 offset:16
    ds_read_b128 v[40:43], v9 offset:256
    ds_read_b128 v[44:47], v9 offset:272
    s_waitcnt vmcnt(5) lgkmcnt(0)
    v_lshlrev_b32 v48, 16, v24
    v_and_b32 v49, 0xffff0000, v24
    v_lshlrev_b32 v50, 16, v25
    v_and_b32 v51, 0xffff0000, v25
    v_lshlrev_b32 v52, 16, v26
    v_and_b32 v53, 0xffff0000, v26
    v_lshlrev_b32 v54, 16, v27
    v_and_b32 v55, 0xffff0000, v27
    v_sub_f32 v48, v48, v16
    v_sub_f32 v49, v49, v16
    v_sub_f32 v50, v50, v16
    v_sub_f32 v51, v51, v16
    v_sub_f32 v52, v52, v16
    v_sub_f32 v53, v53, v16
    v_sub_f32 v54, v54, v16
    v_sub_f32 v55, v55, v16
    v_cvt_pk_bf16_f32 v56, v48, v49
    v_lshlrev_b32 v48, 16, v56
    v_and_b32 v49, 0xffff0000, v56
    v_cvt_pk_bf16_f32 v57, v50, v51
    v_lshlrev_b32 v50, 16, v57
    v_and_b32 v51, 0xffff0000, v57
    v_cvt_pk_bf16_f32 v58, v52, v53
    v_lshlrev_b32 v52, 16, v58
    v_and_b32 v53, 0xffff0000, v58
    v_cvt_pk_bf16_f32 v59, v54, v55
    v_lshlrev_b32 v54, 16, v59
    v_and_b32 v55, 0xffff0000, v59
    v_mul_f32 v48, v48, v17
    v_mul_f32 v49, v49, v17
    v_mul_f32 v50, v50, v17
    v_mul_f32 v51, v51, v17
    v_mul_f32 v52, v52, v17
    v_mul_f32 v53, v53, v17
    v_mul_f32 v54, v54, v17
    v_mul_f32 v55, v55, v17
    v_cvt_pk_bf16_f32 v56, v48, v49
    v_lshlrev_b32 v48, 16, v56
    v_and_b32 v49, 0xffff0000, v56
    v_cvt_pk_bf16_f32 v57, v50, v51
    v_lshlrev_b32 v50, 16, v57
    v_and_b32 v51, 0xffff0000, v57
    v_cvt_pk_bf16_f32 v58, v52, v53
    v_lshlrev_b32 v52, 16, v58
    v_and_b32 v53, 0xffff0000, v58
    v_cvt_pk_bf16_f32 v59, v54, v55
    v_lshlrev_b32 v54, 16, v59
    v_and_b32 v55, 0xffff0000, v59
    v_mul_f32 v48, v48, v40
    v_mul_f32 v49, v49, v41
    v_mul_f32 v50, v50, v42
    v_mul_f32 v51, v51, v43
    v_mul_f32 v52, v52, v44
    v_mul_f32 v53, v53, v45
    v_mul_f32 v54, v54, v46
    v_mul_f32 v55, v55, v47
    v_cvt_pk_bf16_f32 v56, v48, v49
    v_lshlrev_b32 v48, 16, v56
    v_and_b32 v49, 0xffff0000, v56
    v_cvt_pk_bf16_f32 v57, v50, v51
    v_lshlrev_b32 v50, 16, v57
    v_and_b32 v51, 0xffff0000, v57
    v_cvt_pk_bf16_f32 v58, v52, v53
    v_lshlrev_b32 v52, 16, v58
    v_and_b32 v53, 0xffff0000, v58
    v_cvt_pk_bf16_f32 v59, v54, v55
    v_lshlrev_b32 v54, 16, v59
    v_and_b32 v55, 0xffff0000, v59
    v_add_f32 v48, v48, v32
    v_add_f32 v49, v49, v33
    v_add_f32 v50, v50, v34
    v_add_f32 v51, v51, v35
    v_add_f32 v52, v52, v36
    v_add_f32 v53, v53, v37
    v_add_f32 v54, v54, v38
    v_add_f32 v55, v55, v39
    v_cvt_pk_bf16_f32 v24, v48, v49
    v_cvt_pk_bf16_f32 v25, v50, v51
    v_cvt_pk_bf16_f32 v26, v52, v53
    v_cvt_pk_bf16_f32 v27, v54, v55
    buffer_store_dwordx4 v[24:27], v60, s[36:39], 0 offen
    v_lshlrev_b32 v48, 16, v28
    v_and_b32 v49, 0xffff0000, v28
    v_lshlrev_b32 v50, 16, v29
    v_and_b32 v51, 0xffff0000, v29
    v_lshlrev_b32 v52, 16, v30
    v_and_b32 v53, 0xffff0000, v30
    v_lshlrev_b32 v54, 16, v31
    v_and_b32 v55, 0xffff0000, v31
    v_sub_f32 v48, v48, v18
    v_sub_f32 v49, v49, v18
    v_sub_f32 v50, v50, v18
    v_sub_f32 v51, v51, v18
    v_sub_f32 v52, v52, v18
    v_sub_f32 v53, v53, v18
    v_sub_f32 v54, v54, v18
    v_sub_f32 v55, v55, v18
    v_cvt_pk_bf16_f32 v56, v48, v49
    v_lshlrev_b32 v48, 16, v56
    v_and_b32 v49, 0xffff0000, v56
    v_cvt_pk_bf16_f32 v57, v50, v51
    v_lshlrev_b32 v50, 16, v57
    v_and_b32 v51, 0xffff0000, v57
    v_cvt_pk_bf16_f32 v58, v52, v53
    v_lshlrev_b32 v52, 16, v58
    v_and_b32 v53, 0xffff0000, v58
    v_cvt_pk_bf16_f32 v59, v54, v55
    v_lshlrev_b32 v54, 16, v59
    v_and_b32 v55, 0xffff0000, v59
    v_mul_f32 v48, v48, v19
    v_mul_f32 v49, v49, v19
    v_mul_f32 v50, v50, v19
    v_mul_f32 v51, v51, v19
    v_mul_f32 v52, v52, v19
    v_mul_f32 v53, v53, v19
    v_mul_f32 v54, v54, v19
    v_mul_f32 v55, v55, v19
    v_cvt_pk_bf16_f32 v56, v48, v49
    v_lshlrev_b32 v48, 16, v56
    v_and_b32 v49, 0xffff0000, v56
    v_cvt_pk_bf16_f32 v57, v50, v51
    v_lshlrev_b32 v50, 16, v57
    v_and_b32 v51, 0xffff0000, v57
    v_cvt_pk_bf16_f32 v58, v52, v53
    v_lshlrev_b32 v52, 16, v58
    v_and_b32 v53, 0xffff0000, v58
    v_cvt_pk_bf16_f32 v59, v54, v55
    v_lshlrev_b32 v54, 16, v59
    v_and_b32 v55, 0xffff0000, v59
    v_mul_f32 v48, v48, v40
    v_mul_f32 v49, v49, v41
    v_mul_f32 v50, v50, v42
    v_mul_f32 v51, v51, v43
    v_mul_f32 v52, v52, v44
    v_mul_f32 v53, v53, v45
    v_mul_f32 v54, v54, v46
    v_mul_f32 v55, v55, v47
    v_cvt_pk_bf16_f32 v56, v48, v49
    v_lshlrev_b32 v48, 16, v56
    v_and_b32 v49, 0xffff0000, v56
    v_cvt_pk_bf16_f32 v57, v50, v51
    v_lshlrev_b32 v50, 16, v57
    v_and_b32 v51, 0xffff0000, v57
    v_cvt_pk_bf16_f32 v58, v52, v53
    v_lshlrev_b32 v52, 16, v58
    v_and_b32 v53, 0xffff0000, v58
    v_cvt_pk_bf16_f32 v59, v54, v55
    v_lshlrev_b32 v54, 16, v59
    v_and_b32 v55, 0xffff0000, v59
    v_add_f32 v48, v48, v32
    v_add_f32 v49, v49, v33
    v_add_f32 v50, v50, v34
    v_add_f32 v51, v51, v35
    v_add_f32 v52, v52, v36
    v_add_f32 v53, v53, v37
    v_add_f32 v54, v54, v38
    v_add_f32 v55, v55, v39
    v_cvt_pk_bf16_f32 v28, v48, v49
    v_cvt_pk_bf16_f32 v29, v50, v51
    v_cvt_pk_bf16_f32 v30, v52, v53
    v_cvt_pk_bf16_f32 v31, v54, v55
    buffer_store_dwordx4 v[28:31], v60, s[36:39], s76 offen
mod1_kernel_end:
    s_endpgm
.globl mega_kernel
.p2align 8
.type mega_kernel,@function
mega_kernel:
    s_cmp_ge_u32 s2, 256
    s_cbranch_scc1 mega_kernel_end
    s_load_dwordx16 s[4:19], s[0:1], 0
    s_load_dwordx8 s[20:27], s[0:1], 64
    v_lshrrev_b32 v2, 6, v0
    v_and_b32 v1, 63, v0
    v_readfirstlane_b32 s44, v2
    s_and_b32 s47, s2, 1
    s_lshl_b32 s47, s47, 3
    s_bfe_u32 s64, s2, 0x30003
    s_add_u32 s47, s47, s64
    s_and_b32 s48, s2, 6
    s_lshl_b32 s48, s48, 1
    s_lshr_b32 s64, s2, 6
    s_add_u32 s48, s48, s64
    s_cmp_ge_u32 s44, 4
    s_cbranch_scc1 mega_kernel_Q
    s_lshr_b32 s45, s44, 1
    s_and_b32 s46, s44, 1
    s_bfe_u32 s49, s2, 0x10003
    s_and_b32 s50, s2, 3
    s_lshl_b32 s50, s50, 2
    s_bfe_u32 s64, s2, 0x20004
    s_add_u32 s50, s50, s64
    s_and_b32 s51, s2, 4
    s_lshr_b32 s64, s2, 6
    s_add_u32 s51, s51, s64
    s_cmp_ge_u32 s2, 192
    s_cselect_b32 s69, 0x80000000, 0
    s_mov_b32 s67, 0x40053526
    v_lshlrev_b32 v234, 2, v1
    s_mov_b32 s52, 0
    s_lshl_b32 s64, s45, 13
    v_lshl_add_u32 v233, v1, 4, s64
    v_lshrrev_b32 v3, 4, v1
    v_bfe_u32 v2, v1, 2, 2
    v_lshl_add_u32 v4, v3, 3, v2
    v_mul_u32_u24 v4, 384, v4
    v_and_b32 v5, 3, v1
    v_lshl_add_u32 v4, v5, 3, v4
    v_add_u32 v4, 18432, v4
    v_bfe_u32 v2, v1, 3, 2
    s_lshl_b32 s64, s46, 1
    v_xor_b32 v2, s64, v2
    v_lshl_add_u32 v239, v2, 5, v4
    v_xor_b32 v2, 1, v2
    v_lshl_add_u32 v240, v2, 5, v4
    v_and_b32 v2, 15, v1
    v_lshlrev_b32 v3, 2, v3
    v_sub_u32 v3, v2, v3
    s_mov_b32 s64, 0x80000001
    v_sub_u32 v4, -2, v3
    v_and_b32 v4, s64, v4
    v_cmp_eq_u32 s[72:73], 0, v4
    v_subrev_u32 v4, 0, v3
    v_and_b32 v4, s64, v4
    v_cmp_eq_u32 s[80:81], 0, v4
    v_sub_u32 v4, -1, v3
    v_and_b32 v4, s64, v4
    v_cmp_eq_u32 s[74:75], 0, v4
    v_subrev_u32 v4, 1, v3
    v_and_b32 v4, s64, v4
    v_cmp_eq_u32 s[82:83], 0, v4
    v_sub_u32 v4, 0, v3
    v_and_b32 v4, s64, v4
    v_cmp_eq_u32 s[76:77], 0, v4
    v_subrev_u32 v4, 2, v3
    v_and_b32 v4, s64, v4
    v_cmp_eq_u32 s[84:85], 0, v4
    v_sub_u32 v4, 1, v3
    v_and_b32 v4, s64, v4
    v_cmp_eq_u32 s[78:79], 0, v4
    v_subrev_u32 v4, 3, v3
    v_and_b32 v4, s64, v4
    v_cmp_eq_u32 s[86:87], 0, v4
    s_lshl_b32 s64, s47, 1
    s_add_u32 s64, s64, s45
    s_cmp_eq_u32 s64, 0
    s_cselect_b64 s[88:89], 0, s[72:73]
    s_cselect_b64 s[90:91], 0, s[74:75]
    s_cselect_b64 s[92:93], 0, s[76:77]
    s_cselect_b64 s[94:95], 0, s[78:79]
    s_mul_i32 s64, s64, 131072
    s_lshl_b32 s65, s48, 11
    s_add_u32 s64, s64, s65
    s_lshl_b32 s65, s46, 10
    s_add_u32 s64, s64, s65
    s_add_u32 s64, s64, 0x600000
    v_lshl_add_u32 v237, v1, 4, s64
    s_lshl_b32 s64, s2, 8
    v_add_lshl_u32 v243, v0, s64, 5
    s_lshl_b32 s64, s47, 3
    s_lshl_b32 s65, s44, 1
    s_add_u32 s64, s64, s65
    s_mul_i32 s64, s64, 32768
    s_add_u32 s64, s64, 0x600000
    v_lshl_add_u32 v208, v1, 4, s64
    v_add_u32 v209, 30720, v208
    v_lshrrev_b32 v3, 3, v1
    s_lshl_b32 s64, s44, 4
    v_add_lshl_u32 v2, v3, s64, 11
    s_lshl_b32 s64, s48, 7
    v_add_u32 v2, s64, v2
    v_and_b32 v3, 6, v3
    v_and_b32 v4, 7, v1
    v_xor_b32 v3, v3, v4
    v_lshl_add_u32 v210, v3, 4, v2
    v_add_u32 v211, 15360, v210
    s_lshl_b32 s65, s48, 8
    v_lshrrev_b32 v3, 4, v1
    s_lshl_b32 s64, s44, 4
    v_add_u32 v2, s64, v3
    s_movk_i32 s64, 7168
    v_mul_u32_u24 v2, s64, v2
    v_add_u32 v2, s65, v2
    v_lshlrev_b32 v3, 1, v3
    v_and_b32 v4, 15, v1
    v_xor_b32 v3, v3, v4
    v_lshl_add_u32 v212, v3, 4, v2
    v_add_u32 v214, 55296, v212
    v_xor_b32 v3, 8, v3
    v_lshl_add_u32 v213, v3, 4, v2
    v_add_u32 v213, 27648, v213
    v_add_u32 v215, 55296, v213
    v_add_u32 v232, s52, v233
    v_add_u32 v235, s52, v239
    v_add_u32 v236, s52, v240
    s_waitcnt lgkmcnt(0)
    s_mov_b32 s28, s26
    s_mov_b32 s29, s27
    s_mov_b32 s30, 0x3000000
    s_mov_b32 s31, 0x20000
    s_lshl_b32 s60, s44, 12
    s_add_u32 s61, s60, 147456
    s_add_u32 s53, s60, 49152
    s_lshl_b32 s70, s44, 11
    s_sub_u32 s70, 16384, s70
    s_bfe_u32 s66, s2, 0x30003
    s_lshr_b32 s55, s2, 6
    s_add_u32 s66, s66, s55
    s_and_b32 s66, s66, 3
    s_mov_b32 s58, 0x76453210
    s_mov_b32 s59, 0xfecdba89
    s_cmp_eq_u32 s66, 1
    s_cselect_b32 s58, 0x75643120, s58
    s_cselect_b32 s59, 0xfdecb9a8, s59
    s_cmp_eq_u32 s66, 2
    s_cselect_b32 s58, 0x67542310, s58
    s_cselect_b32 s59, 0xefdcab98, s59
    s_cmp_eq_u32 s66, 3
    s_cselect_b32 s58, 0x86534210, s58
    s_cselect_b32 s59, 0xfedbca97, s59
    s_mov_b32 s32, s8
    s_mov_b32 s33, s9
    s_mov_b32 s34, 0x200000
    s_mov_b32 s35, 0x20000
    s_setprio 2
    s_barrier
    ds_read_b128 v[120:123], v232 offset:0
    ds_read_b64_tr_b16 v[148:149], v235 offset:128
    ds_read_b64_tr_b16 v[150:151], v235 offset:1664
    ds_read_b64_tr_b16 v[152:153], v236 offset:128
    ds_read_b64_tr_b16 v[154:155], v236 offset:1664
    ds_read_b64_tr_b16 v[156:157], v235 offset:256
    ds_read_b64_tr_b16 v[158:159], v235 offset:1792
    ds_read_b64_tr_b16 v[160:161], v236 offset:256
    ds_read_b64_tr_b16 v[162:163], v236 offset:1792
    ds_read_b128 v[124:127], v232 offset:2048
    ds_read_b64_tr_b16 v[140:141], v235 offset:0
    ds_read_b64_tr_b16 v[142:143], v235 offset:1536
    ds_read_b64_tr_b16 v[144:145], v236 offset:0
    ds_read_b64_tr_b16 v[146:147], v236 offset:1536
    ds_read_b128 v[128:131], v232 offset:4096
    ds_read_b128 v[132:135], v232 offset:6144
    ds_read_b128 v[136:139], v232 offset:8192
    s_add_u32 s52, s52, 49152
    s_cmp_ge_u32 s52, 147456
    s_cselect_b32 s52, 0, s52
    s_waitcnt lgkmcnt(0)
    v_mfma_f32_16x16x32_bf16 v[40:43], v[148:151], v[120:123], 0
    ds_read_b128 v[164:167], v232 offset:1024
    v_mfma_f32_16x16x32_bf16 v[44:47], v[152:155], v[120:123], 0
    ds_read_b64_tr_b16 v[192:193], v235 offset:12416
    v_mfma_f32_16x16x32_bf16 v[80:83], v[120:123], v[156:159], 0
    ds_read_b64_tr_b16 v[194:195], v235 offset:13952
    v_mfma_f32_16x16x32_bf16 v[84:87], v[120:123], v[160:163], 0
    ds_read_b64_tr_b16 v[196:197], v236 offset:12416
    v_mfma_f32_16x16x32_bf16 v[48:51], v[148:151], v[124:127], 0
    ds_read_b64_tr_b16 v[198:199], v236 offset:13952
    v_mfma_f32_16x16x32_bf16 v[52:55], v[152:155], v[124:127], 0
    v_mfma_f32_16x16x32_bf16 v[88:91], v[124:127], v[156:159], 0
    ds_read_b64_tr_b16 v[200:201], v235 offset:12544
    v_mfma_f32_16x16x32_bf16 v[92:95], v[124:127], v[160:163], 0
    ds_read_b64_tr_b16 v[202:203], v235 offset:14080
    v_mfma_f32_16x16x32_bf16 v[8:11], v[140:143], v[124:127], 0
    ds_read_b64_tr_b16 v[204:205], v236 offset:12544
    v_mfma_f32_16x16x32_bf16 v[12:15], v[144:147], v[124:127], 0
    ds_read_b64_tr_b16 v[206:207], v236 offset:14080
    v_mfma_f32_16x16x32_bf16 v[56:59], v[148:151], v[128:131], 0
    v_mfma_f32_16x16x32_bf16 v[60:63], v[152:155], v[128:131], 0
    ds_read_b128 v[168:171], v232 offset:3072
    v_mfma_f32_16x16x32_bf16 v[96:99], v[128:131], v[156:159], 0
    ds_read_b64_tr_b16 v[184:185], v235 offset:12288
    v_mfma_f32_16x16x32_bf16 v[100:103], v[128:131], v[160:163], 0
    ds_read_b64_tr_b16 v[186:187], v235 offset:13824
    v_mfma_f32_16x16x32_bf16 v[16:19], v[140:143], v[128:131], 0
    ds_read_b64_tr_b16 v[188:189], v236 offset:12288
    v_mfma_f32_16x16x32_bf16 v[20:23], v[144:147], v[128:131], 0
    v_mfma_f32_16x16x32_bf16 v[64:67], v[148:151], v[132:135], 0
    ds_read_b64_tr_b16 v[190:191], v236 offset:13824
    v_mfma_f32_16x16x32_bf16 v[68:71], v[152:155], v[132:135], 0
    ds_read_b128 v[172:175], v232 offset:5120
    v_mfma_f32_16x16x32_bf16 v[104:107], v[132:135], v[156:159], 0
    ds_read_b128 v[176:179], v232 offset:7168
    v_mfma_f32_16x16x32_bf16 v[108:111], v[132:135], v[160:163], 0
    ds_read_b128 v[180:183], v232 offset:9216
    v_mfma_f32_16x16x32_bf16 v[24:27], v[140:143], v[132:135], 0
    v_mfma_f32_16x16x32_bf16 v[28:31], v[144:147], v[132:135], 0
    v_add_u32 v232, s52, v233
    v_mfma_f32_16x16x32_bf16 v[72:75], v[148:151], v[136:139], 0
    v_mfma_f32_16x16x32_bf16 v[76:79], v[152:155], v[136:139], 0
    v_add_u32 v235, s52, v239
    v_mfma_f32_16x16x32_bf16 v[112:115], v[136:139], v[156:159], 0
    v_mfma_f32_16x16x32_bf16 v[116:119], v[136:139], v[160:163], 0
    v_add_u32 v236, s52, v240
    v_mfma_f32_16x16x32_bf16 v[32:35], v[140:143], v[136:139], 0
    v_mfma_f32_16x16x32_bf16 v[36:39], v[144:147], v[136:139], 0
    s_waitcnt lgkmcnt(0)
    v_mfma_f32_16x16x32_bf16 v[40:43], v[192:195], v[164:167], v[40:43]
    s_barrier
    v_mfma_f32_16x16x32_bf16 v[44:47], v[196:199], v[164:167], v[44:47]
    ds_read_b128 v[120:123], v232 offset:0
    v_mfma_f32_16x16x32_bf16 v[80:83], v[164:167], v[200:203], v[80:83]
    ds_read_b64_tr_b16 v[148:149], v235 offset:128
    v_mfma_f32_16x16x32_bf16 v[84:87], v[164:167], v[204:207], v[84:87]
    ds_read_b64_tr_b16 v[150:151], v235 offset:1664
    v_mfma_f32_16x16x32_bf16 v[48:51], v[192:195], v[168:171], v[48:51]
    ds_read_b64_tr_b16 v[152:153], v236 offset:128
    v_mfma_f32_16x16x32_bf16 v[52:55], v[196:199], v[168:171], v[52:55]
    ds_read_b64_tr_b16 v[154:155], v236 offset:1664
    v_mfma_f32_16x16x32_bf16 v[88:91], v[168:171], v[200:203], v[88:91]
    ds_read_b64_tr_b16 v[156:157], v235 offset:256
    v_mfma_f32_16x16x32_bf16 v[92:95], v[168:171], v[204:207], v[92:95]
    v_mfma_f32_16x16x32_bf16 v[8:11], v[184:187], v[168:171], v[8:11]
    ds_read_b64_tr_b16 v[158:159], v235 offset:1792
    v_mfma_f32_16x16x32_bf16 v[12:15], v[188:191], v[168:171], v[12:15]
    ds_read_b64_tr_b16 v[160:161], v236 offset:256
    v_mfma_f32_16x16x32_bf16 v[56:59], v[192:195], v[172:175], v[56:59]
    ds_read_b64_tr_b16 v[162:163], v236 offset:1792
    v_mfma_f32_16x16x32_bf16 v[60:63], v[196:199], v[172:175], v[60:63]
    ds_read_b128 v[124:127], v232 offset:2048
    v_mfma_f32_16x16x32_bf16 v[96:99], v[172:175], v[200:203], v[96:99]
    ds_read_b64_tr_b16 v[140:141], v235 offset:0
    v_mfma_f32_16x16x32_bf16 v[100:103], v[172:175], v[204:207], v[100:103]
    ds_read_b64_tr_b16 v[142:143], v235 offset:1536
    v_mfma_f32_16x16x32_bf16 v[16:19], v[184:187], v[172:175], v[16:19]
    v_mfma_f32_16x16x32_bf16 v[20:23], v[188:191], v[172:175], v[20:23]
    ds_read_b64_tr_b16 v[144:145], v236 offset:0
    v_mfma_f32_16x16x32_bf16 v[64:67], v[192:195], v[176:179], v[64:67]
    ds_read_b64_tr_b16 v[146:147], v236 offset:1536
    v_mfma_f32_16x16x32_bf16 v[68:71], v[196:199], v[176:179], v[68:71]
    ds_read_b128 v[128:131], v232 offset:4096
    v_mfma_f32_16x16x32_bf16 v[104:107], v[176:179], v[200:203], v[104:107]
    ds_read_b128 v[132:135], v232 offset:6144
    v_mfma_f32_16x16x32_bf16 v[108:111], v[176:179], v[204:207], v[108:111]
    ds_read_b128 v[136:139], v232 offset:8192
    v_mfma_f32_16x16x32_bf16 v[24:27], v[184:187], v[176:179], v[24:27]
    v_mfma_f32_16x16x32_bf16 v[28:31], v[188:191], v[176:179], v[28:31]
    v_mfma_f32_16x16x32_bf16 v[72:75], v[192:195], v[180:183], v[72:75]
    v_mfma_f32_16x16x32_bf16 v[76:79], v[196:199], v[180:183], v[76:79]
    v_mfma_f32_16x16x32_bf16 v[112:115], v[180:183], v[200:203], v[112:115]
    v_mfma_f32_16x16x32_bf16 v[116:119], v[180:183], v[204:207], v[116:119]
    v_mfma_f32_16x16x32_bf16 v[32:35], v[184:187], v[180:183], v[32:35]
    s_add_u32 s52, s52, 49152
    s_cmp_ge_u32 s52, 147456
    s_cselect_b32 s52, 0, s52
    v_mfma_f32_16x16x32_bf16 v[36:39], v[188:191], v[180:183], v[36:39]
    s_waitcnt lgkmcnt(0)
    v_mfma_f32_16x16x32_bf16 v[40:43], v[148:151], v[120:123], v[40:43]
    ds_read_b128 v[164:167], v232 offset:1024
    v_mfma_f32_16x16x32_bf16 v[44:47], v[152:155], v[120:123], v[44:47]
    ds_read_b64_tr_b16 v[192:193], v235 offset:12416
    v_mfma_f32_16x16x32_bf16 v[80:83], v[120:123], v[156:159], v[80:83]
    ds_read_b64_tr_b16 v[194:195], v235 offset:13952
    v_mfma_f32_16x16x32_bf16 v[84:87], v[120:123], v[160:163], v[84:87]
    ds_read_b64_tr_b16 v[196:197], v236 offset:12416
    v_mfma_f32_16x16x32_bf16 v[48:51], v[148:151], v[124:127], v[48:51]
    ds_read_b64_tr_b16 v[198:199], v236 offset:13952
    v_mfma_f32_16x16x32_bf16 v[52:55], v[152:155], v[124:127], v[52:55]
    v_mfma_f32_16x16x32_bf16 v[88:91], v[124:127], v[156:159], v[88:91]
    ds_read_b64_tr_b16 v[200:201], v235 offset:12544
    v_mfma_f32_16x16x32_bf16 v[92:95], v[124:127], v[160:163], v[92:95]
    ds_read_b64_tr_b16 v[202:203], v235 offset:14080
    v_mfma_f32_16x16x32_bf16 v[8:11], v[140:143], v[124:127], v[8:11]
    ds_read_b64_tr_b16 v[204:205], v236 offset:12544
    v_mfma_f32_16x16x32_bf16 v[12:15], v[144:147], v[124:127], v[12:15]
    ds_read_b64_tr_b16 v[206:207], v236 offset:14080
    v_mfma_f32_16x16x32_bf16 v[56:59], v[148:151], v[128:131], v[56:59]
    v_mfma_f32_16x16x32_bf16 v[60:63], v[152:155], v[128:131], v[60:63]
    ds_read_b128 v[168:171], v232 offset:3072
    v_mfma_f32_16x16x32_bf16 v[96:99], v[128:131], v[156:159], v[96:99]
    ds_read_b64_tr_b16 v[184:185], v235 offset:12288
    v_mfma_f32_16x16x32_bf16 v[100:103], v[128:131], v[160:163], v[100:103]
    ds_read_b64_tr_b16 v[186:187], v235 offset:13824
    v_mfma_f32_16x16x32_bf16 v[16:19], v[140:143], v[128:131], v[16:19]
    s_movk_i32 s54, 13
mega_kernel_P_loop0:
    ds_read_b64_tr_b16 v[188:189], v236 offset:12288
    v_mfma_f32_16x16x32_bf16 v[20:23], v[144:147], v[128:131], v[20:23]
    v_mfma_f32_16x16x32_bf16 v[64:67], v[148:151], v[132:135], v[64:67]
    ds_read_b64_tr_b16 v[190:191], v236 offset:13824
    v_mfma_f32_16x16x32_bf16 v[68:71], v[152:155], v[132:135], v[68:71]
    ds_read_b128 v[172:175], v232 offset:5120
    v_mfma_f32_16x16x32_bf16 v[104:107], v[132:135], v[156:159], v[104:107]
    ds_read_b128 v[176:179], v232 offset:7168
    v_mfma_f32_16x16x32_bf16 v[108:111], v[132:135], v[160:163], v[108:111]
    ds_read_b128 v[180:183], v232 offset:9216
    v_mfma_f32_16x16x32_bf16 v[24:27], v[140:143], v[132:135], v[24:27]
    v_mfma_f32_16x16x32_bf16 v[28:31], v[144:147], v[132:135], v[28:31]
    v_add_u32 v232, s52, v233
    v_mfma_f32_16x16x32_bf16 v[72:75], v[148:151], v[136:139], v[72:75]
    v_mfma_f32_16x16x32_bf16 v[76:79], v[152:155], v[136:139], v[76:79]
    v_add_u32 v235, s52, v239
    v_mfma_f32_16x16x32_bf16 v[112:115], v[136:139], v[156:159], v[112:115]
    v_mfma_f32_16x16x32_bf16 v[116:119], v[136:139], v[160:163], v[116:119]
    v_add_u32 v236, s52, v240
    v_mfma_f32_16x16x32_bf16 v[32:35], v[140:143], v[136:139], v[32:35]
    v_mfma_f32_16x16x32_bf16 v[36:39], v[144:147], v[136:139], v[36:39]
    s_waitcnt lgkmcnt(0)
    v_mfma_f32_16x16x32_bf16 v[40:43], v[192:195], v[164:167], v[40:43]
    s_barrier
    v_mfma_f32_16x16x32_bf16 v[44:47], v[196:199], v[164:167], v[44:47]
    ds_read_b128 v[120:123], v232 offset:0
    v_mfma_f32_16x16x32_bf16 v[80:83], v[164:167], v[200:203], v[80:83]
    ds_read_b64_tr_b16 v[148:149], v235 offset:128
    v_mfma_f32_16x16x32_bf16 v[84:87], v[164:167], v[204:207], v[84:87]
    ds_read_b64_tr_b16 v[150:151], v235 offset:1664
    v_mfma_f32_16x16x32_bf16 v[48:51], v[192:195], v[168:171], v[48:51]
    ds_read_b64_tr_b16 v[152:153], v236 offset:128
    v_mfma_f32_16x16x32_bf16 v[52:55], v[196:199], v[168:171], v[52:55]
    ds_read_b64_tr_b16 v[154:155], v236 offset:1664
    v_mfma_f32_16x16x32_bf16 v[88:91], v[168:171], v[200:203], v[88:91]
    ds_read_b64_tr_b16 v[156:157], v235 offset:256
    v_mfma_f32_16x16x32_bf16 v[92:95], v[168:171], v[204:207], v[92:95]
    v_mfma_f32_16x16x32_bf16 v[8:11], v[184:187], v[168:171], v[8:11]
    ds_read_b64_tr_b16 v[158:159], v235 offset:1792
    v_mfma_f32_16x16x32_bf16 v[12:15], v[188:191], v[168:171], v[12:15]
    ds_read_b64_tr_b16 v[160:161], v236 offset:256
    v_mfma_f32_16x16x32_bf16 v[56:59], v[192:195], v[172:175], v[56:59]
    ds_read_b64_tr_b16 v[162:163], v236 offset:1792
    v_mfma_f32_16x16x32_bf16 v[60:63], v[196:199], v[172:175], v[60:63]
    ds_read_b128 v[124:127], v232 offset:2048
    v_mfma_f32_16x16x32_bf16 v[96:99], v[172:175], v[200:203], v[96:99]
    ds_read_b64_tr_b16 v[140:141], v235 offset:0
    v_mfma_f32_16x16x32_bf16 v[100:103], v[172:175], v[204:207], v[100:103]
    ds_read_b64_tr_b16 v[142:143], v235 offset:1536
    v_mfma_f32_16x16x32_bf16 v[16:19], v[184:187], v[172:175], v[16:19]
    v_mfma_f32_16x16x32_bf16 v[20:23], v[188:191], v[172:175], v[20:23]
    ds_read_b64_tr_b16 v[144:145], v236 offset:0
    v_mfma_f32_16x16x32_bf16 v[64:67], v[192:195], v[176:179], v[64:67]
    ds_read_b64_tr_b16 v[146:147], v236 offset:1536
    v_mfma_f32_16x16x32_bf16 v[68:71], v[196:199], v[176:179], v[68:71]
    ds_read_b128 v[128:131], v232 offset:4096
    v_mfma_f32_16x16x32_bf16 v[104:107], v[176:179], v[200:203], v[104:107]
    ds_read_b128 v[132:135], v232 offset:6144
    v_mfma_f32_16x16x32_bf16 v[108:111], v[176:179], v[204:207], v[108:111]
    ds_read_b128 v[136:139], v232 offset:8192
    v_mfma_f32_16x16x32_bf16 v[24:27], v[184:187], v[176:179], v[24:27]
    v_mfma_f32_16x16x32_bf16 v[28:31], v[188:191], v[176:179], v[28:31]
    v_mfma_f32_16x16x32_bf16 v[72:75], v[192:195], v[180:183], v[72:75]
    v_mfma_f32_16x16x32_bf16 v[76:79], v[196:199], v[180:183], v[76:79]
    v_mfma_f32_16x16x32_bf16 v[112:115], v[180:183], v[200:203], v[112:115]
    v_mfma_f32_16x16x32_bf16 v[116:119], v[180:183], v[204:207], v[116:119]
    v_mfma_f32_16x16x32_bf16 v[32:35], v[184:187], v[180:183], v[32:35]
    s_add_u32 s52, s52, 49152
    s_cmp_ge_u32 s52, 147456
    s_cselect_b32 s52, 0, s52
    v_mfma_f32_16x16x32_bf16 v[36:39], v[188:191], v[180:183], v[36:39]
    s_waitcnt lgkmcnt(0)
    v_mfma_f32_16x16x32_bf16 v[40:43], v[148:151], v[120:123], v[40:43]
    ds_read_b128 v[164:167], v232 offset:1024
    v_mfma_f32_16x16x32_bf16 v[44:47], v[152:155], v[120:123], v[44:47]
    ds_read_b64_tr_b16 v[192:193], v235 offset:12416
    v_mfma_f32_16x16x32_bf16 v[80:83], v[120:123], v[156:159], v[80:83]
    ds_read_b64_tr_b16 v[194:195], v235 offset:13952
    v_mfma_f32_16x16x32_bf16 v[84:87], v[120:123], v[160:163], v[84:87]
    ds_read_b64_tr_b16 v[196:197], v236 offset:12416
    v_mfma_f32_16x16x32_bf16 v[48:51], v[148:151], v[124:127], v[48:51]
    ds_read_b64_tr_b16 v[198:199], v236 offset:13952
    v_mfma_f32_16x16x32_bf16 v[52:55], v[152:155], v[124:127], v[52:55]
    v_mfma_f32_16x16x32_bf16 v[88:91], v[124:127], v[156:159], v[88:91]
    ds_read_b64_tr_b16 v[200:201], v235 offset:12544
    v_mfma_f32_16x16x32_bf16 v[92:95], v[124:127], v[160:163], v[92:95]
    ds_read_b64_tr_b16 v[202:203], v235 offset:14080
    v_mfma_f32_16x16x32_bf16 v[8:11], v[140:143], v[124:127], v[8:11]
    ds_read_b64_tr_b16 v[204:205], v236 offset:12544
    v_mfma_f32_16x16x32_bf16 v[12:15], v[144:147], v[124:127], v[12:15]
    ds_read_b64_tr_b16 v[206:207], v236 offset:14080
    v_mfma_f32_16x16x32_bf16 v[56:59], v[148:151], v[128:131], v[56:59]
    v_mfma_f32_16x16x32_bf16 v[60:63], v[152:155], v[128:131], v[60:63]
    ds_read_b128 v[168:171], v232 offset:3072
    v_mfma_f32_16x16x32_bf16 v[96:99], v[128:131], v[156:159], v[96:99]
    ds_read_b64_tr_b16 v[184:185], v235 offset:12288
    v_mfma_f32_16x16x32_bf16 v[100:103], v[128:131], v[160:163], v[100:103]
    s_sub_u32 s54, s54, 1
    ds_read_b64_tr_b16 v[186:187], v235 offset:13824
    v_mfma_f32_16x16x32_bf16 v[16:19], v[140:143], v[128:131], v[16:19]
    s_cbranch_scc0 mega_kernel_P_loop0
    ds_read_b64_tr_b16 v[188:189], v236 offset:12288
    v_mfma_f32_16x16x32_bf16 v[20:23], v[144:147], v[128:131], v[20:23]
    v_mfma_f32_16x16x32_bf16 v[64:67], v[148:151], v[132:135], v[64:67]
    ds_read_b64_tr_b16 v[190:191], v236 offset:13824
    v_mfma_f32_16x16x32_bf16 v[68:71], v[152:155], v[132:135], v[68:71]
    ds_read_b128 v[172:175], v232 offset:5120
    v_mfma_f32_16x16x32_bf16 v[104:107], v[132:135], v[156:159], v[104:107]
    ds_read_b128 v[176:179], v232 offset:7168
    v_mfma_f32_16x16x32_bf16 v[108:111], v[132:135], v[160:163], v[108:111]
    ds_read_b128 v[180:183], v232 offset:9216
    v_mfma_f32_16x16x32_bf16 v[24:27], v[140:143], v[132:135], v[24:27]
    v_mfma_f32_16x16x32_bf16 v[28:31], v[144:147], v[132:135], v[28:31]
    v_mfma_f32_16x16x32_bf16 v[72:75], v[148:151], v[136:139], v[72:75]
    v_mfma_f32_16x16x32_bf16 v[76:79], v[152:155], v[136:139], v[76:79]
    v_mfma_f32_16x16x32_bf16 v[112:115], v[136:139], v[156:159], v[112:115]
    v_mfma_f32_16x16x32_bf16 v[116:119], v[136:139], v[160:163], v[116:119]
    v_mfma_f32_16x16x32_bf16 v[32:35], v[140:143], v[136:139], v[32:35]
    v_mfma_f32_16x16x32_bf16 v[36:39], v[144:147], v[136:139], v[36:39]
    s_waitcnt lgkmcnt(0)
    v_mfma_f32_16x16x32_bf16 v[40:43], v[192:195], v[164:167], v[40:43]
    s_barrier
    v_mfma_f32_16x16x32_bf16 v[44:47], v[196:199], v[164:167], v[44:47]
    v_mfma_f32_16x16x32_bf16 v[80:83], v[164:167], v[200:203], v[80:83]
    v_mfma_f32_16x16x32_bf16 v[84:87], v[164:167], v[204:207], v[84:87]
    v_mfma_f32_16x16x32_bf16 v[48:51], v[192:195], v[168:171], v[48:51]
    v_mfma_f32_16x16x32_bf16 v[52:55], v[196:199], v[168:171], v[52:55]
    v_mfma_f32_16x16x32_bf16 v[88:91], v[168:171], v[200:203], v[88:91]
    v_mfma_f32_16x16x32_bf16 v[92:95], v[168:171], v[204:207], v[92:95]
    v_mfma_f32_16x16x32_bf16 v[8:11], v[184:187], v[168:171], v[8:11]
    v_mfma_f32_16x16x32_bf16 v[12:15], v[188:191], v[168:171], v[12:15]
    v_mfma_f32_16x16x32_bf16 v[56:59], v[192:195], v[172:175], v[56:59]
    v_mfma_f32_16x16x32_bf16 v[60:63], v[196:199], v[172:175], v[60:63]
    v_mfma_f32_16x16x32_bf16 v[96:99], v[172:175], v[200:203], v[96:99]
    v_mfma_f32_16x16x32_bf16 v[100:103], v[172:175], v[204:207], v[100:103]
    v_mfma_f32_16x16x32_bf16 v[16:19], v[184:187], v[172:175], v[16:19]
    v_mfma_f32_16x16x32_bf16 v[20:23], v[188:191], v[172:175], v[20:23]
    v_mfma_f32_16x16x32_bf16 v[64:67], v[192:195], v[176:179], v[64:67]
    v_mfma_f32_16x16x32_bf16 v[68:71], v[196:199], v[176:179], v[68:71]
    v_mfma_f32_16x16x32_bf16 v[104:107], v[176:179], v[200:203], v[104:107]
    v_mfma_f32_16x16x32_bf16 v[108:111], v[176:179], v[204:207], v[108:111]
    v_mfma_f32_16x16x32_bf16 v[24:27], v[184:187], v[176:179], v[24:27]
    v_mfma_f32_16x16x32_bf16 v[28:31], v[188:191], v[176:179], v[28:31]
    v_mfma_f32_16x16x32_bf16 v[72:75], v[192:195], v[180:183], v[72:75]
    v_mfma_f32_16x16x32_bf16 v[76:79], v[196:199], v[180:183], v[76:79]
    v_mfma_f32_16x16x32_bf16 v[112:115], v[180:183], v[200:203], v[112:115]
    v_mfma_f32_16x16x32_bf16 v[116:119], v[180:183], v[204:207], v[116:119]
    v_mfma_f32_16x16x32_bf16 v[32:35], v[184:187], v[180:183], v[32:35]
    v_mfma_f32_16x16x32_bf16 v[36:39], v[188:191], v[180:183], v[36:39]
    v_cvt_pk_bf16_f32 v120, v40, v41
    v_cvt_pk_bf16_f32 v121, v42, v43
    v_cvt_pk_bf16_f32 v122, v44, v45
    v_cvt_pk_bf16_f32 v123, v46, v47
    v_cvt_pk_bf16_f32 v124, v48, v49
    v_cvt_pk_bf16_f32 v125, v50, v51
    v_cvt_pk_bf16_f32 v126, v52, v53
    v_cvt_pk_bf16_f32 v127, v54, v55
    v_cvt_pk_bf16_f32 v140, v8, v9
    v_cvt_pk_bf16_f32 v141, v10, v11
    v_cvt_pk_bf16_f32 v142, v12, v13
    v_cvt_pk_bf16_f32 v143, v14, v15
    v_cvt_pk_bf16_f32 v128, v56, v57
    v_cvt_pk_bf16_f32 v129, v58, v59
    v_cvt_pk_bf16_f32 v130, v60, v61
    v_cvt_pk_bf16_f32 v131, v62, v63
    v_cvt_pk_bf16_f32 v144, v16, v17
    v_cvt_pk_bf16_f32 v145, v18, v19
    v_cvt_pk_bf16_f32 v146, v20, v21
    v_cvt_pk_bf16_f32 v147, v22, v23
    v_cvt_pk_bf16_f32 v132, v64, v65
    v_cvt_pk_bf16_f32 v133, v66, v67
    v_cvt_pk_bf16_f32 v134, v68, v69
    v_cvt_pk_bf16_f32 v135, v70, v71
    v_cvt_pk_bf16_f32 v148, v24, v25
    v_cvt_pk_bf16_f32 v149, v26, v27
    v_cvt_pk_bf16_f32 v150, v28, v29
    v_cvt_pk_bf16_f32 v151, v30, v31
    v_cvt_pk_bf16_f32 v136, v72, v73
    v_cvt_pk_bf16_f32 v137, v74, v75
    v_cvt_pk_bf16_f32 v138, v76, v77
    v_cvt_pk_bf16_f32 v139, v78, v79
    v_cvt_pk_bf16_f32 v152, v32, v33
    v_cvt_pk_bf16_f32 v153, v34, v35
    v_cvt_pk_bf16_f32 v154, v36, v37
    v_cvt_pk_bf16_f32 v155, v38, v39
    v_mfma_f32_16x16x32_bf16 v[8:11], v[120:123], v[140:143], 0
    v_mfma_f32_16x16x32_bf16 v[12:15], v[124:127], v[140:143], 0
    v_mfma_f32_16x16x32_bf16 v[16:19], v[124:127], v[144:147], 0
    v_mfma_f32_16x16x32_bf16 v[20:23], v[128:131], v[144:147], 0
    v_mfma_f32_16x16x32_bf16 v[24:27], v[128:131], v[148:151], 0
    v_mfma_f32_16x16x32_bf16 v[28:31], v[132:135], v[148:151], 0
    v_mfma_f32_16x16x32_bf16 v[32:35], v[132:135], v[152:155], 0
    v_mfma_f32_16x16x32_bf16 v[36:39], v[136:139], v[152:155], 0
    v_cvt_pk_bf16_f32 v156, v80, v81
    v_cvt_pk_bf16_f32 v157, v82, v83
    v_cvt_pk_bf16_f32 v166, v84, v85
    v_cvt_pk_bf16_f32 v167, v86, v87
    v_cvt_pk_bf16_f32 v158, v88, v89
    v_cvt_pk_bf16_f32 v159, v90, v91
    v_cvt_pk_bf16_f32 v168, v92, v93
    v_cvt_pk_bf16_f32 v169, v94, v95
    v_cvt_pk_bf16_f32 v160, v96, v97
    v_cvt_pk_bf16_f32 v161, v98, v99
    v_cvt_pk_bf16_f32 v170, v100, v101
    v_cvt_pk_bf16_f32 v171, v102, v103
    v_cvt_pk_bf16_f32 v162, v104, v105
    v_cvt_pk_bf16_f32 v163, v106, v107
    v_cvt_pk_bf16_f32 v172, v108, v109
    v_cvt_pk_bf16_f32 v173, v110, v111
    v_cvt_pk_bf16_f32 v164, v112, v113
    v_cvt_pk_bf16_f32 v165, v114, v115
    v_cvt_pk_bf16_f32 v174, v116, v117
    v_cvt_pk_bf16_f32 v175, v118, v119
    s_mov_b32 s64, 0x3e8293ee
    v_mov_b32 v5, 0xf149f2ca
    v_cndmask_b32 v8, v5, v8, s[88:89]
    v_cndmask_b32 v12, v5, v12, s[80:81]
    v_cndmask_b32 v9, v5, v9, s[90:91]
    v_cndmask_b32 v13, v5, v13, s[82:83]
    v_cndmask_b32 v10, v5, v10, s[92:93]
    v_cndmask_b32 v14, v5, v14, s[84:85]
    v_cndmask_b32 v11, v5, v11, s[94:95]
    v_cndmask_b32 v15, v5, v15, s[86:87]
    v_cndmask_b32 v16, v5, v16, s[72:73]
    v_cndmask_b32 v20, v5, v20, s[80:81]
    v_cndmask_b32 v17, v5, v17, s[74:75]
    v_cndmask_b32 v21, v5, v21, s[82:83]
    v_cndmask_b32 v18, v5, v18, s[76:77]
    v_cndmask_b32 v22, v5, v22, s[84:85]
    v_cndmask_b32 v19, v5, v19, s[78:79]
    v_cndmask_b32 v23, v5, v23, s[86:87]
    v_cndmask_b32 v24, v5, v24, s[72:73]
    v_cndmask_b32 v28, v5, v28, s[80:81]
    v_cndmask_b32 v25, v5, v25, s[74:75]
    v_cndmask_b32 v29, v5, v29, s[82:83]
    v_cndmask_b32 v26, v5, v26, s[76:77]
    v_cndmask_b32 v30, v5, v30, s[84:85]
    v_cndmask_b32 v27, v5, v27, s[78:79]
    v_cndmask_b32 v31, v5, v31, s[86:87]
    v_cndmask_b32 v32, v5, v32, s[72:73]
    v_cndmask_b32 v36, v5, v36, s[80:81]
    v_cndmask_b32 v33, v5, v33, s[74:75]
    v_cndmask_b32 v37, v5, v37, s[82:83]
    v_cndmask_b32 v34, v5, v34, s[76:77]
    v_cndmask_b32 v38, v5, v38, s[84:85]
    v_cndmask_b32 v35, v5, v35, s[78:79]
    v_cndmask_b32 v39, v5, v39, s[86:87]
    v_max3_f32 v192, v8, v9, v10
    v_max3_f32 v196, v11, v12, v13
    v_max3_f32 v193, v16, v17, v18
    v_max3_f32 v197, v19, v20, v21
    v_max3_f32 v194, v24, v25, v26
    v_max3_f32 v198, v27, v28, v29
    v_max3_f32 v195, v32, v33, v34
    v_max3_f32 v199, v35, v36, v37
    v_max3_f32 v192, v192, v14, v15
    v_max3_f32 v193, v193, v22, v23
    v_max3_f32 v194, v194, v30, v31
    v_max3_f32 v195, v195, v38, v39
    v_max_f32 v192, v192, v196
    v_max_f32 v193, v193, v197
    v_max_f32 v194, v194, v198
    v_max_f32 v195, v195, v199
    v_mov_b32 v196, v192
    v_mov_b32 v197, v193
    v_mov_b32 v198, v194
    v_mov_b32 v199, v195
    v_permlane32_swap_b32 v192, v196
    v_permlane32_swap_b32 v193, v197
    v_permlane32_swap_b32 v194, v198
    v_permlane32_swap_b32 v195, v199
    v_max_f32 v192, v192, v196
    v_max_f32 v193, v193, v197
    v_max_f32 v194, v194, v198
    v_max_f32 v195, v195, v199
    v_mov_b32 v196, v192
    v_mov_b32 v197, v193
    v_mov_b32 v198, v194
    v_mov_b32 v199, v195
    v_permlane16_swap_b32 v192, v196
    v_permlane16_swap_b32 v193, v197
    v_permlane16_swap_b32 v194, v198
    v_permlane16_swap_b32 v195, v199
    v_max_f32 v192, v192, v196
    v_max_f32 v193, v193, v197
    v_max_f32 v194, v194, v198
    v_max_f32 v195, v195, v199
    v_mul_f32 v192, s64, v192
    v_mul_f32 v193, s64, v193
    v_mul_f32 v194, s64, v194
    v_mul_f32 v195, s64, v195
    v_fma_f32 v8, v8, s64, -v192
    v_fma_f32 v9, v9, s64, -v192
    v_fma_f32 v10, v10, s64, -v192
    v_fma_f32 v11, v11, s64, -v192
    v_fma_f32 v12, v12, s64, -v192
    v_fma_f32 v13, v13, s64, -v192
    v_fma_f32 v14, v14, s64, -v192
    v_fma_f32 v15, v15, s64, -v192
    v_fma_f32 v16, v16, s64, -v193
    v_fma_f32 v17, v17, s64, -v193
    v_fma_f32 v18, v18, s64, -v193
    v_fma_f32 v19, v19, s64, -v193
    v_fma_f32 v20, v20, s64, -v193
    v_fma_f32 v21, v21, s64, -v193
    v_fma_f32 v22, v22, s64, -v193
    v_fma_f32 v23, v23, s64, -v193
    v_fma_f32 v24, v24, s64, -v194
    v_fma_f32 v25, v25, s64, -v194
    v_fma_f32 v26, v26, s64, -v194
    v_fma_f32 v27, v27, s64, -v194
    v_fma_f32 v28, v28, s64, -v194
    v_fma_f32 v29, v29, s64, -v194
    v_fma_f32 v30, v30, s64, -v194
    v_fma_f32 v31, v31, s64, -v194
    v_fma_f32 v32, v32, s64, -v195
    v_fma_f32 v33, v33, s64, -v195
    v_fma_f32 v34, v34, s64, -v195
    v_fma_f32 v35, v35, s64, -v195
    v_fma_f32 v36, v36, s64, -v195
    v_fma_f32 v37, v37, s64, -v195
    v_fma_f32 v38, v38, s64, -v195
    v_fma_f32 v39, v39, s64, -v195
    v_exp_f32 v8, v8
    v_exp_f32 v9, v9
    v_exp_f32 v10, v10
    v_exp_f32 v11, v11
    v_exp_f32 v12, v12
    v_exp_f32 v13, v13
    v_exp_f32 v14, v14
    v_exp_f32 v15, v15
    v_exp_f32 v16, v16
    v_exp_f32 v17, v17
    v_exp_f32 v18, v18
    v_exp_f32 v19, v19
    v_exp_f32 v20, v20
    v_exp_f32 v21, v21
    v_exp_f32 v22, v22
    v_exp_f32 v23, v23
    v_exp_f32 v24, v24
    v_exp_f32 v25, v25
    v_exp_f32 v26, v26
    v_exp_f32 v27, v27
    v_exp_f32 v28, v28
    v_exp_f32 v29, v29
    v_exp_f32 v30, v30
    v_exp_f32 v31, v31
    v_exp_f32 v32, v32
    v_exp_f32 v33, v33
    v_exp_f32 v34, v34
    v_exp_f32 v35, v35
    v_exp_f32 v36, v36
    v_exp_f32 v37, v37
    v_exp_f32 v38, v38
    v_exp_f32 v39, v39
    v_pk_add_f32 v[200:201], v[8:9], v[10:11]
    v_pk_add_f32 v[202:203], v[16:17], v[18:19]
    v_pk_add_f32 v[204:205], v[24:25], v[26:27]
    v_pk_add_f32 v[206:207], v[32:33], v[34:35]
    v_pk_add_f32 v[200:201], v[200:201], v[12:13]
    v_pk_add_f32 v[202:203], v[202:203], v[20:21]
    v_pk_add_f32 v[204:205], v[204:205], v[28:29]
    v_pk_add_f32 v[206:207], v[206:207], v[36:37]
    v_pk_add_f32 v[200:201], v[200:201], v[14:15]
    v_pk_add_f32 v[202:203], v[202:203], v[22:23]
    v_pk_add_f32 v[204:205], v[204:205], v[30:31]
    v_pk_add_f32 v[206:207], v[206:207], v[38:39]
    v_add_f32 v200, v200, v201
    v_add_f32 v202, v202, v203
    v_add_f32 v204, v204, v205
    v_add_f32 v206, v206, v207
    v_mov_b32 v196, v200
    v_mov_b32 v197, v202
    v_mov_b32 v198, v204
    v_mov_b32 v199, v206
    v_permlane32_swap_b32 v200, v196
    v_permlane32_swap_b32 v202, v197
    v_permlane32_swap_b32 v204, v198
    v_permlane32_swap_b32 v206, v199
    v_add_f32 v200, v200, v196
    v_add_f32 v202, v202, v197
    v_add_f32 v204, v204, v198
    v_add_f32 v206, v206, v199
    v_mov_b32 v196, v200
    v_mov_b32 v197, v202
    v_mov_b32 v198, v204
    v_mov_b32 v199, v206
    v_permlane16_swap_b32 v200, v196
    v_permlane16_swap_b32 v202, v197
    v_permlane16_swap_b32 v204, v198
    v_permlane16_swap_b32 v206, v199
    v_add_f32 v200, v200, v196
    v_add_f32 v202, v202, v197
    v_add_f32 v204, v204, v198
    v_add_f32 v206, v206, v199
    v_rcp_f32 v200, v200
    v_rcp_f32 v202, v202
    v_rcp_f32 v204, v204
    v_rcp_f32 v206, v206
    v_pk_mul_f32 v[8:9], v[8:9], v[200:201] op_sel_hi:[1,0]
    v_pk_mul_f32 v[10:11], v[10:11], v[200:201] op_sel_hi:[1,0]
    v_pk_mul_f32 v[12:13], v[12:13], v[200:201] op_sel_hi:[1,0]
    v_pk_mul_f32 v[14:15], v[14:15], v[200:201] op_sel_hi:[1,0]
    v_pk_mul_f32 v[16:17], v[16:17], v[202:203] op_sel_hi:[1,0]
    v_pk_mul_f32 v[18:19], v[18:19], v[202:203] op_sel_hi:[1,0]
    v_pk_mul_f32 v[20:21], v[20:21], v[202:203] op_sel_hi:[1,0]
    v_pk_mul_f32 v[22:23], v[22:23], v[202:203] op_sel_hi:[1,0]
    v_pk_mul_f32 v[24:25], v[24:25], v[204:205] op_sel_hi:[1,0]
    v_pk_mul_f32 v[26:27], v[26:27], v[204:205] op_sel_hi:[1,0]
    v_pk_mul_f32 v[28:29], v[28:29], v[204:205] op_sel_hi:[1,0]
    v_pk_mul_f32 v[30:31], v[30:31], v[204:205] op_sel_hi:[1,0]
    v_pk_mul_f32 v[32:33], v[32:33], v[206:207] op_sel_hi:[1,0]
    v_pk_mul_f32 v[34:35], v[34:35], v[206:207] op_sel_hi:[1,0]
    v_pk_mul_f32 v[36:37], v[36:37], v[206:207] op_sel_hi:[1,0]
    v_pk_mul_f32 v[38:39], v[38:39], v[206:207] op_sel_hi:[1,0]
    v_cvt_pk_bf16_f32 v176, v8, v9
    v_cvt_pk_bf16_f32 v177, v10, v11
    v_cvt_pk_bf16_f32 v178, v12, v13
    v_cvt_pk_bf16_f32 v179, v14, v15
    v_cvt_pk_bf16_f32 v180, v16, v17
    v_cvt_pk_bf16_f32 v181, v18, v19
    v_cvt_pk_bf16_f32 v182, v20, v21
    v_cvt_pk_bf16_f32 v183, v22, v23
    v_cvt_pk_bf16_f32 v184, v24, v25
    v_cvt_pk_bf16_f32 v185, v26, v27
    v_cvt_pk_bf16_f32 v186, v28, v29
    v_cvt_pk_bf16_f32 v187, v30, v31
    v_cvt_pk_bf16_f32 v188, v32, v33
    v_cvt_pk_bf16_f32 v189, v34, v35
    v_cvt_pk_bf16_f32 v190, v36, v37
    v_cvt_pk_bf16_f32 v191, v38, v39
    v_mfma_f32_16x16x32_bf16 v[40:43], v[156:159], v[176:179], 0
    v_mfma_f32_16x16x32_bf16 v[44:47], v[166:169], v[176:179], 0
    v_mfma_f32_16x16x32_bf16 v[48:51], v[158:161], v[180:183], 0
    v_mfma_f32_16x16x32_bf16 v[52:55], v[168:171], v[180:183], 0
    v_mfma_f32_16x16x32_bf16 v[56:59], v[160:163], v[184:187], 0
    v_mfma_f32_16x16x32_bf16 v[60:63], v[170:173], v[184:187], 0
    v_mfma_f32_16x16x32_bf16 v[64:67], v[162:165], v[188:191], 0
    v_mfma_f32_16x16x32_bf16 v[68:71], v[172:175], v[188:191], 0
    s_mov_b32 s72, 0x0
    s_mov_b32 s73, 0x8000
    s_mov_b32 s74, 0x10000
    s_mov_b32 s75, 0x18000
    v_cvt_pk_bf16_f32 v120, v40, v41
    v_cvt_pk_bf16_f32 v121, v42, v43
    v_cvt_pk_bf16_f32 v122, v44, v45
    v_cvt_pk_bf16_f32 v123, v46, v47
    buffer_store_dwordx4 v[120:123], v237, s[28:31], s72 offen sc1
    v_cvt_pk_bf16_f32 v124, v48, v49
    v_cvt_pk_bf16_f32 v125, v50, v51
    v_cvt_pk_bf16_f32 v126, v52, v53
    v_cvt_pk_bf16_f32 v127, v54, v55
    buffer_store_dwordx4 v[124:127], v237, s[28:31], s73 offen sc1
    v_cvt_pk_bf16_f32 v128, v56, v57
    v_cvt_pk_bf16_f32 v129, v58, v59
    v_cvt_pk_bf16_f32 v130, v60, v61
    v_cvt_pk_bf16_f32 v131, v62, v63
    buffer_store_dwordx4 v[128:131], v237, s[28:31], s74 offen sc1
    v_cvt_pk_bf16_f32 v132, v64, v65
    v_cvt_pk_bf16_f32 v133, v66, v67
    v_cvt_pk_bf16_f32 v134, v68, v69
    v_cvt_pk_bf16_f32 v135, v70, v71
    buffer_store_dwordx4 v[132:135], v237, s[28:31], s75 offen sc1
    s_lshl_b32 s64, s44, 12
    s_lshl_b32 s65, s48, 8
    s_add_u32 s64, s64, s65
    s_add_u32 s64, s64, 0xa0000
    v_add_u32 v196, s64, v234
    s_mov_b32 s76, 0
    s_mov_b32 s77, 16384
    s_mov_b32 s78, 32768
    s_mov_b32 s79, 49152
    s_lshl_b32 s68, s47, 9
    s_add_u32 s68, s68, 0x54000
    v_lshlrev_b32 v3, 7, v1
    s_lshr_b32 s64, s48, 2
    s_lshl_b32 s64, s64, 7
    v_mov_b32 v4, s64
    v_mov_b32 v2, 1
    v_mov_b32 v5, 148484
    s_waitcnt vmcnt(0)
    s_mov_b64 exec, 1
    ds_add_rtn_u32 v245, v5, v2
    s_waitcnt lgkmcnt(0)
    v_cmp_ne_u32 vcc, 3, v245
    s_nop 4
    s_cbranch_vccnz mega_kernel_po_ok
    s_mov_b64 exec, 15
    buffer_atomic_add v2, v3, s[28:31], s68 offen
    s_mov_b64 exec, 1
    s_mov_b32 s3, 0x40000
mega_kernel_po_chk:
    v_cmp_ne_u32 vcc, 16, v245
    s_nop 4
    s_cbranch_vccz mega_kernel_po_ok
    s_sub_u32 s3, s3, 1
    s_cbranch_scc1 mega_kernel_po_ok
    buffer_load_dword v245, v4, s[28:31], s68 offen sc1
    s_waitcnt vmcnt(0)
    s_branch mega_kernel_po_chk
mega_kernel_po_ok:
    s_mov_b64 exec, -1
    s_barrier
    s_setprio 0
    s_and_b32 s57, s58, 15
    s_lshr_b64 s[58:59], s[58:59], 4
    s_lshl_b32 s56, s57, 11
    s_mul_i32 s57, s57, 0x20000
    s_mov_b32 m0, s53
    s_nop 0
    buffer_load_dwordx4 v208, s[28:31], s56 offen offset:0 lds
    buffer_load_dwordx4 v208, s[28:31], s56 offen offset:1024 lds
    buffer_load_dwordx4 v209, s[28:31], s56 offen offset:2048 lds
    buffer_load_dwordx4 v209, s[28:31], s56 offen offset:3072 lds
    s_add_u32 s53, s53, 24576
    s_cmp_ge_u32 s53, s61
    s_cselect_b32 s53, s60, s53
    s_and_b32 s57, s58, 15
    s_lshr_b64 s[58:59], s[58:59], 4
    s_lshl_b32 s56, s57, 11
    s_mul_i32 s57, s57, 0x20000
    s_mov_b32 m0, s53
    s_nop 0
    buffer_load_dwordx4 v208, s[28:31], s56 offen offset:0 lds
    buffer_load_dwordx4 v208, s[28:31], s56 offen offset:1024 lds
    buffer_load_dwordx4 v209, s[28:31], s56 offen offset:2048 lds
    buffer_load_dwordx4 v209, s[28:31], s56 offen offset:3072 lds
    s_add_u32 s53, s53, 24576
    s_cmp_ge_u32 s53, s61
    s_cselect_b32 s53, s60, s53
    s_and_b32 s57, s58, 15
    s_lshr_b64 s[58:59], s[58:59], 4
    s_lshl_b32 s56, s57, 11
    s_mul_i32 s57, s57, 0x20000
    s_mov_b32 m0, s53
    s_nop 0
    buffer_load_dwordx4 v208, s[28:31], s56 offen offset:0 lds
    buffer_load_dwordx4 v208, s[28:31], s56 offen offset:1024 lds
    buffer_load_dwordx4 v209, s[28:31], s56 offen offset:2048 lds
    buffer_load_dwordx4 v209, s[28:31], s56 offen offset:3072 lds
    s_add_u32 s53, s53, 24576
    s_cmp_ge_u32 s53, s61
    s_cselect_b32 s53, s60, s53
    buffer_load_dword v192, v196, s[28:31], s76 offen sc1
    buffer_load_dword v193, v196, s[28:31], s77 offen sc1
    buffer_load_dword v194, v196, s[28:31], s78 offen sc1
    buffer_load_dword v195, v196, s[28:31], s79 offen sc1
    s_lshl_b32 s64, s45, 13
    v_lshl_add_u32 v233, v1, 4, s64
    v_lshrrev_b32 v2, 2, v1
    v_lshlrev_b32 v4, 8, v2
    v_and_b32 v5, 3, v1
    v_lshl_add_u32 v4, v5, 3, v4
    v_add_u32 v4, 16384, v4
    v_and_b32 v2, 7, v2
    s_lshl_b32 s64, s46, 2
    v_xor_b32 v2, s64, v2
    v_xor_b32 v3, 0, v2
    v_lshl_add_u32 v239, v3, 5, v4
    v_xor_b32 v3, 1, v2
    v_lshl_add_u32 v240, v3, 5, v4
    v_xor_b32 v3, 2, v2
    v_lshl_add_u32 v241, v3, 5, v4
    v_xor_b32 v3, 3, v2
    v_lshl_add_u32 v242, v3, 5, v4
    s_lshl_b32 s64, s2, 2
    s_add_u32 s64, s64, s44
    s_mul_i32 s64, s64, 7168
    s_add_u32 s64, s64, 2304
    s_add_u32 s10, s12, s64
    s_addc_u32 s11, s13, 0
    s_add_u32 s24, s14, s64
    s_addc_u32 s25, s15, 0
    s_mov_b32 s52, 0
    v_add_u32 v232, s52, v233
    v_add_u32 v235, s52, v239
    v_add_u32 v236, s52, v240
    v_add_u32 v237, s52, v241
    v_add_u32 v238, s52, v242
    s_movk_i32 s54, 2
mega_kernel_P_loop1:
    s_waitcnt vmcnt(12)
    s_barrier
    s_and_b32 s57, s58, 15
    s_lshr_b64 s[58:59], s[58:59], 4
    s_lshl_b32 s56, s57, 11
    s_mul_i32 s57, s57, 0x20000
    s_mov_b32 m0, s53
    s_nop 0
    buffer_load_dwordx4 v208, s[28:31], s56 offen offset:0 lds
    buffer_load_dwordx4 v208, s[28:31], s56 offen offset:1024 lds
    buffer_load_dwordx4 v209, s[28:31], s56 offen offset:2048 lds
    buffer_load_dwordx4 v209, s[28:31], s56 offen offset:3072 lds
    s_add_u32 s53, s53, 24576
    s_cmp_ge_u32 s53, s61
    s_cselect_b32 s53, s60, s53
    s_sub_u32 s54, s54, 1
    s_cbranch_scc0 mega_kernel_P_loop1
    s_waitcnt vmcnt(8)
    s_barrier
    s_and_b32 s57, s58, 15
    s_lshr_b64 s[58:59], s[58:59], 4
    s_lshl_b32 s56, s57, 11
    s_mul_i32 s57, s57, 0x20000
    s_add_u32 m0, s53, s70
    s_nop 0
    buffer_load_dwordx4 v210, s[32:35], s57 offen offset:0 lds
    buffer_load_dwordx4 v211, s[32:35], s57 offen offset:1024 lds
    s_mov_b32 m0, s53
    s_nop 0
    buffer_load_dwordx4 v208, s[28:31], s56 offen offset:0 lds
    buffer_load_dwordx4 v208, s[28:31], s56 offen offset:1024 lds
    buffer_load_dwordx4 v209, s[28:31], s56 offen offset:2048 lds
    buffer_load_dwordx4 v209, s[28:31], s56 offen offset:3072 lds
    s_add_u32 s53, s53, 24576
    s_cmp_ge_u32 s53, s61
    s_cselect_b32 s53, s60, s53
    s_mov_b32 s3, 0x40000
mega_kernel_tb_chk:
    v_max3_u32 v2, v192, v193, v194
    v_max_u32 v2, v2, v195
    v_cmp_eq_u32 vcc, -1, v2
    s_nop 4
    s_cbranch_vccz mega_kernel_tb_ok
    s_sub_u32 s3, s3, 1
    s_cbranch_scc1 mega_kernel_tb_ok
    s_sleep 1
    buffer_load_dword v192, v196, s[28:31], s76 offen sc1
    buffer_load_dword v193, v196, s[28:31], s77 offen sc1
    buffer_load_dword v194, v196, s[28:31], s78 offen sc1
    buffer_load_dword v195, v196, s[28:31], s79 offen sc1
    s_waitcnt vmcnt(0)
    s_branch mega_kernel_tb_chk
mega_kernel_tb_ok:
    v_add_f32 v192, v192, v193
    v_add_f32 v194, v194, v195
    v_add_f32 v192, v192, v194
    v_cvt_pk_bf16_f32 v193, v192, v192
    v_lshlrev_b32 v192, 16, v193
    s_cmp_eq_u32 s44, 2
    s_cselect_b32 s64, 1.0, 0
    v_add_f32 v192, s64, v192
    v_cvt_pk_bf16_f32 v193, v192, v192
    v_lshlrev_b32 v192, 16, v193
    s_cmp_lg_u32 s45, s46
    s_cselect_b32 s64, 0x3fb8aa3b, 1.0
    v_mul_f32 v192, s64, v192
    s_lshl_b32 s64, s44, 8
    s_add_u32 s64, s64, 149504
    v_add_u32 v2, s64, v234
    ds_write_b32 v2, v192
    s_lshl_b32 s64, s47, 12
    s_lshl_b32 s65, s48, 8
    s_add_u32 s64, s64, s65
    s_add_u32 s64, s64, 0xc0000
    s_cmp_eq_u32 s44, 3
    s_cselect_b32 s64, s64, 0x80000000
    v_add_u32 v2, s64, v234
    buffer_store_dword v192, v2, s[28:31], 0 offen sc1
    s_waitcnt lgkmcnt(0)
    s_waitcnt vmcnt(11)
    s_barrier
    s_and_b32 s57, s58, 15
    s_lshr_b64 s[58:59], s[58:59], 4
    s_lshl_b32 s56, s57, 11
    s_mul_i32 s57, s57, 0x20000
    s_add_u32 m0, s53, s70
    s_nop 0
    buffer_load_dwordx4 v210, s[32:35], s57 offen offset:0 lds
    buffer_load_dwordx4 v211, s[32:35], s57 offen offset:1024 lds
    s_load_dword s99, s[10:11], 0
    s_mov_b32 m0, s53
    s_nop 0
    buffer_load_dwordx4 v208, s[28:31], s56 offen offset:0 lds
    buffer_load_dwordx4 v208, s[28:31], s56 offen offset:1024 lds
    buffer_load_dwordx4 v209, s[28:31], s56 offen offset:2048 lds
    s_load_dword s99, s[24:25], 0
    buffer_load_dwordx4 v209, s[28:31], s56 offen offset:3072 lds
    s_add_u32 s53, s53, 24576
    s_cmp_ge_u32 s53, s61
    s_cselect_b32 s53, s60, s53
    s_add_u32 s10, s10, 64
    s_addc_u32 s11, s11, 0
    s_add_u32 s24, s24, 64
    s_addc_u32 s25, s25, 0
    s_movk_i32 s54, 1
mega_kernel_P_loop2:
    s_waitcnt vmcnt(13)
    s_barrier
    s_and_b32 s57, s58, 15
    s_lshr_b64 s[58:59], s[58:59], 4
    s_lshl_b32 s56, s57, 11
    s_mul_i32 s57, s57, 0x20000
    s_add_u32 m0, s53, s70
    s_nop 0
    buffer_load_dwordx4 v210, s[32:35], s57 offen offset:0 lds
    buffer_load_dwordx4 v211, s[32:35], s57 offen offset:1024 lds
    s_load_dword s99, s[10:11], 0
    s_mov_b32 m0, s53
    s_nop 0
    buffer_load_dwordx4 v208, s[28:31], s56 offen offset:0 lds
    buffer_load_dwordx4 v208, s[28:31], s56 offen offset:1024 lds
    buffer_load_dwordx4 v209, s[28:31], s56 offen offset:2048 lds
    s_load_dword s99, s[24:25], 0
    buffer_load_dwordx4 v209, s[28:31], s56 offen offset:3072 lds
    s_add_u32 s53, s53, 24576
    s_cmp_ge_u32 s53, s61
    s_cselect_b32 s53, s60, s53
    s_add_u32 s10, s10, 64
    s_addc_u32 s11, s11, 0
    s_add_u32 s24, s24, 64
    s_addc_u32 s25, s25, 0
    s_sub_u32 s54, s54, 1
    s_cbranch_scc0 mega_kernel_P_loop2
    s_movk_i32 s54, 4
mega_kernel_P_loop3:
    s_waitcnt vmcnt(12)
    s_barrier
    s_and_b32 s57, s58, 15
    s_lshr_b64 s[58:59], s[58:59], 4
    s_lshl_b32 s56, s57, 11
    s_mul_i32 s57, s57, 0x20000
    s_add_u32 m0, s53, s70
    s_nop 0
    buffer_load_dwordx4 v210, s[32:35], s57 offen offset:0 lds
    buffer_load_dwordx4 v211, s[32:35], s57 offen offset:1024 lds
    s_load_dword s99, s[10:11], 0
    s_mov_b32 m0, s53
    s_nop 0
    buffer_load_dwordx4 v208, s[28:31], s56 offen offset:0 lds
    buffer_load_dwordx4 v208, s[28:31], s56 offen offset:1024 lds
    buffer_load_dwordx4 v209, s[28:31], s56 offen offset:2048 lds
    s_load_dword s99, s[24:25], 0
    buffer_load_dwordx4 v209, s[28:31], s56 offen offset:3072 lds
    s_add_u32 s53, s53, 24576
    s_cmp_ge_u32 s53, s61
    s_cselect_b32 s53, s60, s53
    s_add_u32 s10, s10, 64
    s_addc_u32 s11, s11, 0
    s_add_u32 s24, s24, 64
    s_addc_u32 s25, s25, 0
    s_sub_u32 s54, s54, 1
    s_cbranch_scc0 mega_kernel_P_loop3
    s_waitcnt vmcnt(12)
    s_barrier
    s_and_b32 s57, s58, 15
    s_lshr_b64 s[58:59], s[58:59], 4
    s_lshl_b32 s56, s57, 11
    s_mul_i32 s57, s57, 0x20000
    s_add_u32 m0, s53, s70
    s_nop 0
    buffer_load_dwordx4 v210, s[32:35], s57 offen offset:0 lds
    buffer_load_dwordx4 v211, s[32:35], s57 offen offset:1024 lds
    s_mov_b32 m0, s53
    s_nop 0
    buffer_load_dwordx4 v208, s[28:31], s56 offen offset:0 lds
    s_load_dword s99, s[10:11], 0
    buffer_load_dwordx4 v208, s[28:31], s56 offen offset:1024 lds
    buffer_load_dwordx4 v209, s[28:31], s56 offen offset:2048 lds
    buffer_load_dwordx4 v209, s[28:31], s56 offen offset:3072 lds
    s_add_u32 s53, s53, 24576
    s_cmp_ge_u32 s53, s61
    s_cselect_b32 s53, s60, s53
    s_load_dword s99, s[24:25], 0
    s_lshl_b32 s60, s44, 12
    s_add_u32 s61, s60, 147456
    s_add_u32 s53, s60, 0
    s_bfe_u32 s66, s2, 0x30003
    s_lshr_b32 s55, s2, 6
    s_add_u32 s66, s66, s55
    s_and_b32 s66, s66, 3
    s_mov_b32 s58, 0x76453210
    s_mov_b32 s59, 0xfecdba89
    s_cmp_eq_u32 s66, 1
    s_cselect_b32 s58, 0x75643120, s58
    s_cselect_b32 s59, 0xfdecb9a8, s59
    s_cmp_eq_u32 s66, 2
    s_cselect_b32 s58, 0x67542310, s58
    s_cselect_b32 s59, 0xefdcab98, s59
    s_cmp_eq_u32 s66, 3
    s_cselect_b32 s58, 0x86534210, s58
    s_cselect_b32 s59, 0xfedbca97, s59
    s_mov_b32 s32, s12
    s_mov_b32 s33, s13
    s_mov_b32 s34, 0x700000
    s_mov_b32 s35, 0x20000
    s_mov_b32 s36, s14
    s_mov_b32 s37, s15
    s_mov_b32 s38, 0x700000
    s_mov_b32 s39, 0x20000
    s_and_b32 s57, s58, 15
    s_lshr_b64 s[58:59], s[58:59], 4
    s_lshl_b32 s56, s57, 11
    s_mul_i32 s57, s57, 0x70000
    s_add_u32 m0, s53, 16384
    s_nop 0
    buffer_load_dwordx4 v212, s[32:35], s57 offen offset:0 lds
    buffer_load_dwordx4 v213, s[32:35], s57 offen offset:1024 lds
    s_add_u32 s10, s10, 64
    s_addc_u32 s11, s11, 0
    s_add_u32 s24, s24, 64
    s_addc_u32 s25, s25, 0
    s_waitcnt vmcnt(14)
    s_barrier
    buffer_load_dwordx4 v214, s[32:35], s57 offen offset:2048 lds
    s_load_dword s99, s[10:11], 0
    buffer_load_dwordx4 v215, s[32:35], s57 offen offset:3072 lds
    s_load_dword s99, s[24:25], 0
    s_add_u32 m0, s53, 32768
    s_nop 0
    buffer_load_dwordx4 v212, s[36:39], s57 offen offset:0 lds
    s_add_u32 s10, s10, 64
    s_addc_u32 s11, s11, 0
    s_add_u32 s24, s24, 64
    s_addc_u32 s25, s25, 0
    s_waitcnt vmcnt(11)
    s_barrier
    buffer_load_dwordx4 v213, s[36:39], s57 offen offset:1024 lds
    s_load_dword s99, s[10:11], 0
    buffer_load_dwordx4 v214, s[36:39], s57 offen offset:2048 lds
    s_load_dword s99, s[24:25], 0
    buffer_load_dwordx4 v215, s[36:39], s57 offen offset:3072 lds
    s_add_u32 s10, s10, 64
    s_addc_u32 s11, s11, 0
    s_add_u32 s24, s24, 64
    s_addc_u32 s25, s25, 0
    s_waitcnt vmcnt(8)
    s_barrier
    s_add_u32 s53, s53, 49152
    s_cmp_ge_u32 s53, s61
    s_cselect_b32 s53, s60, s53
    s_load_dword s99, s[10:11], 0
    s_load_dword s99, s[24:25], 0
    s_add_u32 s10, s10, 64
    s_addc_u32 s11, s11, 0
    s_add_u32 s24, s24, 64
    s_addc_u32 s25, s25, 0
    s_barrier
    s_load_dword s99, s[10:11], 0
    s_load_dword s99, s[24:25], 0
    s_load_dword s99, s[10:11], 64
    s_load_dword s99, s[24:25], 64
    s_load_dword s99, s[10:11], 128
    s_load_dword s99, s[24:25], 128
    s_load_dword s99, s[10:11], 192
    s_load_dword s99, s[24:25], 192
    s_load_dword s99, s[10:11], 256
    s_load_dword s99, s[24:25], 256
    s_load_dword s99, s[10:11], 320
    s_load_dword s99, s[24:25], 320
    s_load_dword s99, s[10:11], 384
    s_load_dword s99, s[24:25], 384
    s_load_dword s99, s[10:11], 448
    s_load_dword s99, s[24:25], 448
    s_load_dword s99, s[10:11], 512
    s_load_dword s99, s[24:25], 512
    s_load_dword s99, s[10:11], 576
    s_load_dword s99, s[24:25], 576
    s_load_dword s99, s[10:11], 640
    s_load_dword s99, s[24:25], 640
    s_load_dword s99, s[10:11], 704
    s_load_dword s99, s[24:25], 704
    s_add_u32 s10, s10, 768
    s_addc_u32 s11, s11, 0
    s_add_u32 s24, s24, 768
    s_addc_u32 s25, s25, 0
    s_setprio 2
    s_barrier
    s_waitcnt vmcnt(0)
    s_barrier
    ds_read_b128 v[136:139], v232 offset:0
    ds_read_b64_tr_b16 v[152:153], v235 offset:0
    ds_read_b64_tr_b16 v[154:155], v235 offset:4096
    ds_read_b64_tr_b16 v[156:157], v236 offset:0
    ds_read_b64_tr_b16 v[158:159], v236 offset:4096
    ds_read_b64_tr_b16 v[160:161], v237 offset:0
    ds_read_b64_tr_b16 v[162:163], v237 offset:4096
    ds_read_b64_tr_b16 v[164:165], v238 offset:0
    ds_read_b64_tr_b16 v[166:167], v238 offset:4096
    ds_read_b64_tr_b16 v[168:169], v235 offset:16384
    ds_read_b64_tr_b16 v[170:171], v235 offset:20480
    ds_read_b64_tr_b16 v[172:173], v236 offset:16384
    ds_read_b64_tr_b16 v[174:175], v236 offset:20480
    ds_read_b64_tr_b16 v[176:177], v237 offset:16384
    ds_read_b64_tr_b16 v[178:179], v237 offset:20480
    ds_read_b64_tr_b16 v[180:181], v238 offset:16384
    ds_read_b64_tr_b16 v[182:183], v238 offset:20480
    ds_read_b128 v[140:143], v232 offset:2048
    ds_read_b128 v[144:147], v232 offset:4096
    ds_read_b128 v[148:151], v232 offset:6144
    s_add_u32 s52, s52, 49152
    s_cmp_ge_u32 s52, 147456
    s_cselect_b32 s52, 0, s52
    s_waitcnt lgkmcnt(0)
    v_mfma_f32_16x16x32_bf16 v[8:11], v[152:155], v[136:139], 0
    ds_read_b128 v[184:187], v232 offset:1024
    v_mfma_f32_16x16x32_bf16 v[12:15], v[156:159], v[136:139], 0
    ds_read_b64_tr_b16 v[200:201], v235 offset:8192
    v_mfma_f32_16x16x32_bf16 v[16:19], v[160:163], v[136:139], 0
    ds_read_b64_tr_b16 v[202:203], v235 offset:12288
    v_mfma_f32_16x16x32_bf16 v[20:23], v[164:167], v[136:139], 0
    ds_read_b64_tr_b16 v[204:205], v236 offset:8192
    v_mfma_f32_16x16x32_bf16 v[24:27], v[168:171], v[136:139], 0
    v_mfma_f32_16x16x32_bf16 v[28:31], v[172:175], v[136:139], 0
    ds_read_b64_tr_b16 v[206:207], v236 offset:12288
    v_mfma_f32_16x16x32_bf16 v[32:35], v[176:179], v[136:139], 0
    ds_read_b64_tr_b16 v[208:209], v237 offset:8192
    v_mfma_f32_16x16x32_bf16 v[36:39], v[180:183], v[136:139], 0
    ds_read_b64_tr_b16 v[210:211], v237 offset:12288
    v_mfma_f32_16x16x32_bf16 v[40:43], v[152:155], v[140:143], 0
    ds_read_b64_tr_b16 v[212:213], v238 offset:8192
    v_mfma_f32_16x16x32_bf16 v[44:47], v[156:159], v[140:143], 0
    v_mfma_f32_16x16x32_bf16 v[48:51], v[160:163], v[140:143], 0
    ds_read_b64_tr_b16 v[214:215], v238 offset:12288
    v_mfma_f32_16x16x32_bf16 v[52:55], v[164:167], v[140:143], 0
    ds_read_b64_tr_b16 v[216:217], v235 offset:24576
    v_mfma_f32_16x16x32_bf16 v[56:59], v[168:171], v[140:143], 0
    ds_read_b64_tr_b16 v[218:219], v235 offset:28672
    v_mfma_f32_16x16x32_bf16 v[60:63], v[172:175], v[140:143], 0
    ds_read_b64_tr_b16 v[220:221], v236 offset:24576
    v_mfma_f32_16x16x32_bf16 v[64:67], v[176:179], v[140:143], 0
    v_mfma_f32_16x16x32_bf16 v[68:71], v[180:183], v[140:143], 0
    ds_read_b64_tr_b16 v[222:223], v236 offset:28672
    v_mfma_f32_16x16x32_bf16 v[72:75], v[152:155], v[144:147], 0
    ds_read_b64_tr_b16 v[224:225], v237 offset:24576
    v_mfma_f32_16x16x32_bf16 v[76:79], v[156:159], v[144:147], 0
    ds_read_b64_tr_b16 v[226:227], v237 offset:28672
    v_mfma_f32_16x16x32_bf16 v[80:83], v[160:163], v[144:147], 0
    ds_read_b64_tr_b16 v[228:229], v238 offset:24576
    v_mfma_f32_16x16x32_bf16 v[84:87], v[164:167], v[144:147], 0
    v_mfma_f32_16x16x32_bf16 v[88:91], v[168:171], v[144:147], 0
    ds_read_b64_tr_b16 v[230:231], v238 offset:28672
    v_mfma_f32_16x16x32_bf16 v[92:95], v[172:175], v[144:147], 0
    ds_read_b128 v[188:191], v232 offset:3072
    v_mfma_f32_16x16x32_bf16 v[96:99], v[176:179], v[144:147], 0
    ds_read_b128 v[192:195], v232 offset:5120
    v_mfma_f32_16x16x32_bf16 v[100:103], v[180:183], v[144:147], 0
    ds_read_b128 v[196:199], v232 offset:7168
    v_mfma_f32_16x16x32_bf16 v[104:107], v[152:155], v[148:151], 0
    v_mfma_f32_16x16x32_bf16 v[108:111], v[156:159], v[148:151], 0
    v_add_u32 v232, s52, v233
    v_mfma_f32_16x16x32_bf16 v[112:115], v[160:163], v[148:151], 0
    v_add_u32 v235, s52, v239
    v_mfma_f32_16x16x32_bf16 v[116:119], v[164:167], v[148:151], 0
    v_add_u32 v236, s52, v240
    v_mfma_f32_16x16x32_bf16 v[120:123], v[168:171], v[148:151], 0
    v_mfma_f32_16x16x32_bf16 v[124:127], v[172:175], v[148:151], 0
    v_add_u32 v237, s52, v241
    v_mfma_f32_16x16x32_bf16 v[128:131], v[176:179], v[148:151], 0
    v_add_u32 v238, s52, v242
    v_mfma_f32_16x16x32_bf16 v[132:135], v[180:183], v[148:151], 0
    s_waitcnt lgkmcnt(0)
    v_mfma_f32_16x16x32_bf16 v[8:11], v[200:203], v[184:187], v[8:11]
    s_barrier
    v_mfma_f32_16x16x32_bf16 v[12:15], v[204:207], v[184:187], v[12:15]
    ds_read_b128 v[136:139], v232 offset:0
    v_mfma_f32_16x16x32_bf16 v[16:19], v[208:211], v[184:187], v[16:19]
    ds_read_b64_tr_b16 v[152:153], v235 offset:0
    v_mfma_f32_16x16x32_bf16 v[20:23], v[212:215], v[184:187], v[20:23]
    ds_read_b64_tr_b16 v[154:155], v235 offset:4096
    v_mfma_f32_16x16x32_bf16 v[24:27], v[216:219], v[184:187], v[24:27]
    ds_read_b64_tr_b16 v[156:157], v236 offset:0
    v_mfma_f32_16x16x32_bf16 v[28:31], v[220:223], v[184:187], v[28:31]
    ds_read_b64_tr_b16 v[158:159], v236 offset:4096
    v_mfma_f32_16x16x32_bf16 v[32:35], v[224:227], v[184:187], v[32:35]
    v_mfma_f32_16x16x32_bf16 v[36:39], v[228:231], v[184:187], v[36:39]
    ds_read_b64_tr_b16 v[160:161], v237 offset:0
    v_mfma_f32_16x16x32_bf16 v[40:43], v[200:203], v[188:191], v[40:43]
    ds_read_b64_tr_b16 v[162:163], v237 offset:4096
    v_mfma_f32_16x16x32_bf16 v[44:47], v[204:207], v[188:191], v[44:47]
    ds_read_b64_tr_b16 v[164:165], v238 offset:0
    v_mfma_f32_16x16x32_bf16 v[48:51], v[208:211], v[188:191], v[48:51]
    ds_read_b64_tr_b16 v[166:167], v238 offset:4096
    v_mfma_f32_16x16x32_bf16 v[52:55], v[212:215], v[188:191], v[52:55]
    ds_read_b64_tr_b16 v[168:169], v235 offset:16384
    v_mfma_f32_16x16x32_bf16 v[56:59], v[216:219], v[188:191], v[56:59]
    v_mfma_f32_16x16x32_bf16 v[60:63], v[220:223], v[188:191], v[60:63]
    ds_read_b64_tr_b16 v[170:171], v235 offset:20480
    v_mfma_f32_16x16x32_bf16 v[64:67], v[224:227], v[188:191], v[64:67]
    ds_read_b64_tr_b16 v[172:173], v236 offset:16384
    v_mfma_f32_16x16x32_bf16 v[68:71], v[228:231], v[188:191], v[68:71]
    ds_read_b64_tr_b16 v[174:175], v236 offset:20480
    v_mfma_f32_16x16x32_bf16 v[72:75], v[200:203], v[192:195], v[72:75]
    ds_read_b64_tr_b16 v[176:177], v237 offset:16384
    v_mfma_f32_16x16x32_bf16 v[76:79], v[204:207], v[192:195], v[76:79]
    ds_read_b64_tr_b16 v[178:179], v237 offset:20480
    v_mfma_f32_16x16x32_bf16 v[80:83], v[208:211], v[192:195], v[80:83]
    v_mfma_f32_16x16x32_bf16 v[84:87], v[212:215], v[192:195], v[84:87]
    ds_read_b64_tr_b16 v[180:181], v238 offset:16384
    v_mfma_f32_16x16x32_bf16 v[88:91], v[216:219], v[192:195], v[88:91]
    ds_read_b64_tr_b16 v[182:183], v238 offset:20480
    v_mfma_f32_16x16x32_bf16 v[92:95], v[220:223], v[192:195], v[92:95]
    ds_read_b128 v[140:143], v232 offset:2048
    v_mfma_f32_16x16x32_bf16 v[96:99], v[224:227], v[192:195], v[96:99]
    ds_read_b128 v[144:147], v232 offset:4096
    v_mfma_f32_16x16x32_bf16 v[100:103], v[228:231], v[192:195], v[100:103]
    ds_read_b128 v[148:151], v232 offset:6144
    v_mfma_f32_16x16x32_bf16 v[104:107], v[200:203], v[196:199], v[104:107]
    v_mfma_f32_16x16x32_bf16 v[108:111], v[204:207], v[196:199], v[108:111]
    v_mfma_f32_16x16x32_bf16 v[112:115], v[208:211], v[196:199], v[112:115]
    v_mfma_f32_16x16x32_bf16 v[116:119], v[212:215], v[196:199], v[116:119]
    v_mfma_f32_16x16x32_bf16 v[120:123], v[216:219], v[196:199], v[120:123]
    v_mfma_f32_16x16x32_bf16 v[124:127], v[220:223], v[196:199], v[124:127]
    v_mfma_f32_16x16x32_bf16 v[128:131], v[224:227], v[196:199], v[128:131]
    s_add_u32 s52, s52, 49152
    s_cmp_ge_u32 s52, 147456
    s_cselect_b32 s52, 0, s52
    v_mfma_f32_16x16x32_bf16 v[132:135], v[228:231], v[196:199], v[132:135]
    s_waitcnt lgkmcnt(0)
    v_mfma_f32_16x16x32_bf16 v[8:11], v[152:155], v[136:139], v[8:11]
    ds_read_b128 v[184:187], v232 offset:1024
    v_mfma_f32_16x16x32_bf16 v[12:15], v[156:159], v[136:139], v[12:15]
    ds_read_b64_tr_b16 v[200:201], v235 offset:8192
    v_mfma_f32_16x16x32_bf16 v[16:19], v[160:163], v[136:139], v[16:19]
    ds_read_b64_tr_b16 v[202:203], v235 offset:12288
    v_mfma_f32_16x16x32_bf16 v[20:23], v[164:167], v[136:139], v[20:23]
    ds_read_b64_tr_b16 v[204:205], v236 offset:8192
    v_mfma_f32_16x16x32_bf16 v[24:27], v[168:171], v[136:139], v[24:27]
    v_mfma_f32_16x16x32_bf16 v[28:31], v[172:175], v[136:139], v[28:31]
    ds_read_b64_tr_b16 v[206:207], v236 offset:12288
    v_mfma_f32_16x16x32_bf16 v[32:35], v[176:179], v[136:139], v[32:35]
    ds_read_b64_tr_b16 v[208:209], v237 offset:8192
    v_mfma_f32_16x16x32_bf16 v[36:39], v[180:183], v[136:139], v[36:39]
    ds_read_b64_tr_b16 v[210:211], v237 offset:12288
    v_mfma_f32_16x16x32_bf16 v[40:43], v[152:155], v[140:143], v[40:43]
    ds_read_b64_tr_b16 v[212:213], v238 offset:8192
    v_mfma_f32_16x16x32_bf16 v[44:47], v[156:159], v[140:143], v[44:47]
    v_mfma_f32_16x16x32_bf16 v[48:51], v[160:163], v[140:143], v[48:51]
    ds_read_b64_tr_b16 v[214:215], v238 offset:12288
    v_mfma_f32_16x16x32_bf16 v[52:55], v[164:167], v[140:143], v[52:55]
    ds_read_b64_tr_b16 v[216:217], v235 offset:24576
    v_mfma_f32_16x16x32_bf16 v[56:59], v[168:171], v[140:143], v[56:59]
    ds_read_b64_tr_b16 v[218:219], v235 offset:28672
    v_mfma_f32_16x16x32_bf16 v[60:63], v[172:175], v[140:143], v[60:63]
    ds_read_b64_tr_b16 v[220:221], v236 offset:24576
    v_mfma_f32_16x16x32_bf16 v[64:67], v[176:179], v[140:143], v[64:67]
    v_mfma_f32_16x16x32_bf16 v[68:71], v[180:183], v[140:143], v[68:71]
    ds_read_b64_tr_b16 v[222:223], v236 offset:28672
    v_mfma_f32_16x16x32_bf16 v[72:75], v[152:155], v[144:147], v[72:75]
    s_movk_i32 s54, 13
mega_kernel_P_loop4:
    ds_read_b64_tr_b16 v[224:225], v237 offset:24576
    v_mfma_f32_16x16x32_bf16 v[76:79], v[156:159], v[144:147], v[76:79]
    ds_read_b64_tr_b16 v[226:227], v237 offset:28672
    v_mfma_f32_16x16x32_bf16 v[80:83], v[160:163], v[144:147], v[80:83]
    ds_read_b64_tr_b16 v[228:229], v238 offset:24576
    v_mfma_f32_16x16x32_bf16 v[84:87], v[164:167], v[144:147], v[84:87]
    v_mfma_f32_16x16x32_bf16 v[88:91], v[168:171], v[144:147], v[88:91]
    ds_read_b64_tr_b16 v[230:231], v238 offset:28672
    v_mfma_f32_16x16x32_bf16 v[92:95], v[172:175], v[144:147], v[92:95]
    ds_read_b128 v[188:191], v232 offset:3072
    v_mfma_f32_16x16x32_bf16 v[96:99], v[176:179], v[144:147], v[96:99]
    ds_read_b128 v[192:195], v232 offset:5120
    v_mfma_f32_16x16x32_bf16 v[100:103], v[180:183], v[144:147], v[100:103]
    ds_read_b128 v[196:199], v232 offset:7168
    v_mfma_f32_16x16x32_bf16 v[104:107], v[152:155], v[148:151], v[104:107]
    v_mfma_f32_16x16x32_bf16 v[108:111], v[156:159], v[148:151], v[108:111]
    v_add_u32 v232, s52, v233
    v_mfma_f32_16x16x32_bf16 v[112:115], v[160:163], v[148:151], v[112:115]
    v_add_u32 v235, s52, v239
    v_mfma_f32_16x16x32_bf16 v[116:119], v[164:167], v[148:151], v[116:119]
    v_add_u32 v236, s52, v240
    v_mfma_f32_16x16x32_bf16 v[120:123], v[168:171], v[148:151], v[120:123]
    v_mfma_f32_16x16x32_bf16 v[124:127], v[172:175], v[148:151], v[124:127]
    v_add_u32 v237, s52, v241
    v_mfma_f32_16x16x32_bf16 v[128:131], v[176:179], v[148:151], v[128:131]
    v_add_u32 v238, s52, v242
    v_mfma_f32_16x16x32_bf16 v[132:135], v[180:183], v[148:151], v[132:135]
    s_waitcnt lgkmcnt(0)
    v_mfma_f32_16x16x32_bf16 v[8:11], v[200:203], v[184:187], v[8:11]
    s_barrier
    v_mfma_f32_16x16x32_bf16 v[12:15], v[204:207], v[184:187], v[12:15]
    ds_read_b128 v[136:139], v232 offset:0
    v_mfma_f32_16x16x32_bf16 v[16:19], v[208:211], v[184:187], v[16:19]
    ds_read_b64_tr_b16 v[152:153], v235 offset:0
    v_mfma_f32_16x16x32_bf16 v[20:23], v[212:215], v[184:187], v[20:23]
    ds_read_b64_tr_b16 v[154:155], v235 offset:4096
    v_mfma_f32_16x16x32_bf16 v[24:27], v[216:219], v[184:187], v[24:27]
    ds_read_b64_tr_b16 v[156:157], v236 offset:0
    v_mfma_f32_16x16x32_bf16 v[28:31], v[220:223], v[184:187], v[28:31]
    ds_read_b64_tr_b16 v[158:159], v236 offset:4096
    v_mfma_f32_16x16x32_bf16 v[32:35], v[224:227], v[184:187], v[32:35]
    v_mfma_f32_16x16x32_bf16 v[36:39], v[228:231], v[184:187], v[36:39]
    ds_read_b64_tr_b16 v[160:161], v237 offset:0
    v_mfma_f32_16x16x32_bf16 v[40:43], v[200:203], v[188:191], v[40:43]
    ds_read_b64_tr_b16 v[162:163], v237 offset:4096
    v_mfma_f32_16x16x32_bf16 v[44:47], v[204:207], v[188:191], v[44:47]
    ds_read_b64_tr_b16 v[164:165], v238 offset:0
    v_mfma_f32_16x16x32_bf16 v[48:51], v[208:211], v[188:191], v[48:51]
    ds_read_b64_tr_b16 v[166:167], v238 offset:4096
    v_mfma_f32_16x16x32_bf16 v[52:55], v[212:215], v[188:191], v[52:55]
    ds_read_b64_tr_b16 v[168:169], v235 offset:16384
    v_mfma_f32_16x16x32_bf16 v[56:59], v[216:219], v[188:191], v[56:59]
    v_mfma_f32_16x16x32_bf16 v[60:63], v[220:223], v[188:191], v[60:63]
    ds_read_b64_tr_b16 v[170:171], v235 offset:20480
    v_mfma_f32_16x16x32_bf16 v[64:67], v[224:227], v[188:191], v[64:67]
    ds_read_b64_tr_b16 v[172:173], v236 offset:16384
    v_mfma_f32_16x16x32_bf16 v[68:71], v[228:231], v[188:191], v[68:71]
    ds_read_b64_tr_b16 v[174:175], v236 offset:20480
    v_mfma_f32_16x16x32_bf16 v[72:75], v[200:203], v[192:195], v[72:75]
    ds_read_b64_tr_b16 v[176:177], v237 offset:16384
    v_mfma_f32_16x16x32_bf16 v[76:79], v[204:207], v[192:195], v[76:79]
    ds_read_b64_tr_b16 v[178:179], v237 offset:20480
    v_mfma_f32_16x16x32_bf16 v[80:83], v[208:211], v[192:195], v[80:83]
    v_mfma_f32_16x16x32_bf16 v[84:87], v[212:215], v[192:195], v[84:87]
    ds_read_b64_tr_b16 v[180:181], v238 offset:16384
    v_mfma_f32_16x16x32_bf16 v[88:91], v[216:219], v[192:195], v[88:91]
    ds_read_b64_tr_b16 v[182:183], v238 offset:20480
    v_mfma_f32_16x16x32_bf16 v[92:95], v[220:223], v[192:195], v[92:95]
    ds_read_b128 v[140:143], v232 offset:2048
    v_mfma_f32_16x16x32_bf16 v[96:99], v[224:227], v[192:195], v[96:99]
    ds_read_b128 v[144:147], v232 offset:4096
    v_mfma_f32_16x16x32_bf16 v[100:103], v[228:231], v[192:195], v[100:103]
    ds_read_b128 v[148:151], v232 offset:6144
    v_mfma_f32_16x16x32_bf16 v[104:107], v[200:203], v[196:199], v[104:107]
    v_mfma_f32_16x16x32_bf16 v[108:111], v[204:207], v[196:199], v[108:111]
    v_mfma_f32_16x16x32_bf16 v[112:115], v[208:211], v[196:199], v[112:115]
    v_mfma_f32_16x16x32_bf16 v[116:119], v[212:215], v[196:199], v[116:119]
    v_mfma_f32_16x16x32_bf16 v[120:123], v[216:219], v[196:199], v[120:123]
    v_mfma_f32_16x16x32_bf16 v[124:127], v[220:223], v[196:199], v[124:127]
    v_mfma_f32_16x16x32_bf16 v[128:131], v[224:227], v[196:199], v[128:131]
    s_add_u32 s52, s52, 49152
    s_cmp_ge_u32 s52, 147456
    s_cselect_b32 s52, 0, s52
    v_mfma_f32_16x16x32_bf16 v[132:135], v[228:231], v[196:199], v[132:135]
    s_waitcnt lgkmcnt(0)
    v_mfma_f32_16x16x32_bf16 v[8:11], v[152:155], v[136:139], v[8:11]
    ds_read_b128 v[184:187], v232 offset:1024
    v_mfma_f32_16x16x32_bf16 v[12:15], v[156:159], v[136:139], v[12:15]
    ds_read_b64_tr_b16 v[200:201], v235 offset:8192
    v_mfma_f32_16x16x32_bf16 v[16:19], v[160:163], v[136:139], v[16:19]
    ds_read_b64_tr_b16 v[202:203], v235 offset:12288
    v_mfma_f32_16x16x32_bf16 v[20:23], v[164:167], v[136:139], v[20:23]
    ds_read_b64_tr_b16 v[204:205], v236 offset:8192
    v_mfma_f32_16x16x32_bf16 v[24:27], v[168:171], v[136:139], v[24:27]
    v_mfma_f32_16x16x32_bf16 v[28:31], v[172:175], v[136:139], v[28:31]
    ds_read_b64_tr_b16 v[206:207], v236 offset:12288
    v_mfma_f32_16x16x32_bf16 v[32:35], v[176:179], v[136:139], v[32:35]
    ds_read_b64_tr_b16 v[208:209], v237 offset:8192
    v_mfma_f32_16x16x32_bf16 v[36:39], v[180:183], v[136:139], v[36:39]
    ds_read_b64_tr_b16 v[210:211], v237 offset:12288
    v_mfma_f32_16x16x32_bf16 v[40:43], v[152:155], v[140:143], v[40:43]
    ds_read_b64_tr_b16 v[212:213], v238 offset:8192
    v_mfma_f32_16x16x32_bf16 v[44:47], v[156:159], v[140:143], v[44:47]
    v_mfma_f32_16x16x32_bf16 v[48:51], v[160:163], v[140:143], v[48:51]
    ds_read_b64_tr_b16 v[214:215], v238 offset:12288
    v_mfma_f32_16x16x32_bf16 v[52:55], v[164:167], v[140:143], v[52:55]
    ds_read_b64_tr_b16 v[216:217], v235 offset:24576
    v_mfma_f32_16x16x32_bf16 v[56:59], v[168:171], v[140:143], v[56:59]
    ds_read_b64_tr_b16 v[218:219], v235 offset:28672
    v_mfma_f32_16x16x32_bf16 v[60:63], v[172:175], v[140:143], v[60:63]
    ds_read_b64_tr_b16 v[220:221], v236 offset:24576
    v_mfma_f32_16x16x32_bf16 v[64:67], v[176:179], v[140:143], v[64:67]
    v_mfma_f32_16x16x32_bf16 v[68:71], v[180:183], v[140:143], v[68:71]
    s_sub_u32 s54, s54, 1
    ds_read_b64_tr_b16 v[222:223], v236 offset:28672
    v_mfma_f32_16x16x32_bf16 v[72:75], v[152:155], v[144:147], v[72:75]
    s_cbranch_scc0 mega_kernel_P_loop4
    ds_read_b64_tr_b16 v[224:225], v237 offset:24576
    v_mfma_f32_16x16x32_bf16 v[76:79], v[156:159], v[144:147], v[76:79]
    ds_read_b64_tr_b16 v[226:227], v237 offset:28672
    v_mfma_f32_16x16x32_bf16 v[80:83], v[160:163], v[144:147], v[80:83]
    ds_read_b64_tr_b16 v[228:229], v238 offset:24576
    v_mfma_f32_16x16x32_bf16 v[84:87], v[164:167], v[144:147], v[84:87]
    v_mfma_f32_16x16x32_bf16 v[88:91], v[168:171], v[144:147], v[88:91]
    ds_read_b64_tr_b16 v[230:231], v238 offset:28672
    v_mfma_f32_16x16x32_bf16 v[92:95], v[172:175], v[144:147], v[92:95]
    ds_read_b128 v[188:191], v232 offset:3072
    v_mfma_f32_16x16x32_bf16 v[96:99], v[176:179], v[144:147], v[96:99]
    ds_read_b128 v[192:195], v232 offset:5120
    v_mfma_f32_16x16x32_bf16 v[100:103], v[180:183], v[144:147], v[100:103]
    ds_read_b128 v[196:199], v232 offset:7168
    v_mfma_f32_16x16x32_bf16 v[104:107], v[152:155], v[148:151], v[104:107]
    v_mfma_f32_16x16x32_bf16 v[108:111], v[156:159], v[148:151], v[108:111]
    v_mfma_f32_16x16x32_bf16 v[112:115], v[160:163], v[148:151], v[112:115]
    v_mfma_f32_16x16x32_bf16 v[116:119], v[164:167], v[148:151], v[116:119]
    v_mfma_f32_16x16x32_bf16 v[120:123], v[168:171], v[148:151], v[120:123]
    v_mfma_f32_16x16x32_bf16 v[124:127], v[172:175], v[148:151], v[124:127]
    v_mfma_f32_16x16x32_bf16 v[128:131], v[176:179], v[148:151], v[128:131]
    v_mfma_f32_16x16x32_bf16 v[132:135], v[180:183], v[148:151], v[132:135]
    s_waitcnt lgkmcnt(0)
    v_mfma_f32_16x16x32_bf16 v[8:11], v[200:203], v[184:187], v[8:11]
    s_barrier
    v_mfma_f32_16x16x32_bf16 v[12:15], v[204:207], v[184:187], v[12:15]
    v_mfma_f32_16x16x32_bf16 v[16:19], v[208:211], v[184:187], v[16:19]
    v_mfma_f32_16x16x32_bf16 v[20:23], v[212:215], v[184:187], v[20:23]
    v_mfma_f32_16x16x32_bf16 v[24:27], v[216:219], v[184:187], v[24:27]
    v_mfma_f32_16x16x32_bf16 v[28:31], v[220:223], v[184:187], v[28:31]
    v_mfma_f32_16x16x32_bf16 v[32:35], v[224:227], v[184:187], v[32:35]
    v_mfma_f32_16x16x32_bf16 v[36:39], v[228:231], v[184:187], v[36:39]
    v_mfma_f32_16x16x32_bf16 v[40:43], v[200:203], v[188:191], v[40:43]
    v_mfma_f32_16x16x32_bf16 v[44:47], v[204:207], v[188:191], v[44:47]
    v_mfma_f32_16x16x32_bf16 v[48:51], v[208:211], v[188:191], v[48:51]
    v_mfma_f32_16x16x32_bf16 v[52:55], v[212:215], v[188:191], v[52:55]
    v_mfma_f32_16x16x32_bf16 v[56:59], v[216:219], v[188:191], v[56:59]
    v_mfma_f32_16x16x32_bf16 v[60:63], v[220:223], v[188:191], v[60:63]
    v_mfma_f32_16x16x32_bf16 v[64:67], v[224:227], v[188:191], v[64:67]
    v_mfma_f32_16x16x32_bf16 v[68:71], v[228:231], v[188:191], v[68:71]
    v_mfma_f32_16x16x32_bf16 v[72:75], v[200:203], v[192:195], v[72:75]
    v_mfma_f32_16x16x32_bf16 v[76:79], v[204:207], v[192:195], v[76:79]
    v_mfma_f32_16x16x32_bf16 v[80:83], v[208:211], v[192:195], v[80:83]
    v_mfma_f32_16x16x32_bf16 v[84:87], v[212:215], v[192:195], v[84:87]
    v_mfma_f32_16x16x32_bf16 v[88:91], v[216:219], v[192:195], v[88:91]
    v_mfma_f32_16x16x32_bf16 v[92:95], v[220:223], v[192:195], v[92:95]
    v_mfma_f32_16x16x32_bf16 v[96:99], v[224:227], v[192:195], v[96:99]
    v_mfma_f32_16x16x32_bf16 v[100:103], v[228:231], v[192:195], v[100:103]
    v_mfma_f32_16x16x32_bf16 v[104:107], v[200:203], v[196:199], v[104:107]
    v_mfma_f32_16x16x32_bf16 v[108:111], v[204:207], v[196:199], v[108:111]
    v_mfma_f32_16x16x32_bf16 v[112:115], v[208:211], v[196:199], v[112:115]
    v_mfma_f32_16x16x32_bf16 v[116:119], v[212:215], v[196:199], v[116:119]
    v_mfma_f32_16x16x32_bf16 v[120:123], v[216:219], v[196:199], v[120:123]
    v_mfma_f32_16x16x32_bf16 v[124:127], v[220:223], v[196:199], v[124:127]
    v_mfma_f32_16x16x32_bf16 v[128:131], v[224:227], v[196:199], v[128:131]
    v_mfma_f32_16x16x32_bf16 v[132:135], v[228:231], v[196:199], v[132:135]
    s_setprio 0
    s_cmp_lg_u32 s69, 0
    s_cbranch_scc1 mega_kernel_Pidle
    s_lshl_b32 s64, s47, 3
    s_lshl_b32 s65, s44, 1
    s_add_u32 s64, s64, s65
    s_mul_i32 s64, s64, 32768
    s_add_u32 s64, s64, 0x1000000
    v_lshl_add_u32 v184, v1, 4, s64
    v_add_u32 v185, 30720, v184
    s_lshr_b32 s65, s48, 2
    s_sub_u32 s65, s48, s65
    s_add_u32 s65, s65, 16
    s_lshl_b32 s65, s65, 8
    s_or_b32 s65, s65, s69
    v_lshrrev_b32 v3, 4, v1
    s_lshl_b32 s64, s44, 4
    v_add_u32 v2, s64, v3
    s_movk_i32 s64, 7168
    v_mul_u32_u24 v2, s64, v2
    v_add_u32 v2, s65, v2
    v_lshlrev_b32 v3, 1, v3
    v_and_b32 v4, 15, v1
    v_xor_b32 v3, v3, v4
    v_lshl_add_u32 v188, v3, 4, v2
    v_add_u32 v190, 55296, v188
    v_xor_b32 v3, 8, v3
    v_lshl_add_u32 v189, v3, 4, v2
    v_add_u32 v189, 27648, v189
    v_add_u32 v191, 55296, v189
    s_lshl_b32 s60, s44, 12
    s_add_u32 s61, s60, 147456
    s_add_u32 s53, s60, 49152
    s_bfe_u32 s66, s2, 0x30003
    s_lshr_b32 s55, s2, 6
    s_add_u32 s66, s66, s55
    s_mul_i32 s55, s66, 11
    s_lshr_b32 s55, s55, 5
    s_mul_i32 s55, s55, 3
    s_sub_u32 s66, s66, s55
    s_mov_b32 s58, 0x9a867534
    s_mov_b32 s59, 0xfecdb
    s_cmp_eq_u32 s66, 1
    s_cselect_b32 s58, 0xb9786453, s58
    s_cselect_b32 s59, 0xfdeca, s59
    s_cmp_eq_u32 s66, 2
    s_cselect_b32 s58, 0xa8975642, s58
    s_cselect_b32 s59, 0xefdbc, s59
    s_mov_b32 s32, s12
    s_mov_b32 s33, s13
    s_mov_b32 s34, 0x700000
    s_mov_b32 s35, 0x20000
    s_mov_b32 s36, s14
    s_mov_b32 s37, s15
    s_mov_b32 s38, 0x700000
    s_mov_b32 s39, 0x20000
    s_lshl_b32 s70, s48, 12
    s_lshl_b32 s64, s47, 3
    s_lshl_b32 s65, s45, 2
    s_add_u32 s64, s64, s65
    s_mul_i32 s64, s64, 114688
    s_add_u32 s64, s64, s70
    s_lshl_b32 s65, s46, 11
    s_add_u32 s64, s64, s65
    s_add_u32 s64, s64, 0x1500000
    v_lshl_add_u32 v198, v1, 4, s64
    v_mul_f32 v24, v8, v24
    v_exp_f32 v216, -v8
    v_mul_f32 v25, v9, v25
    v_exp_f32 v217, -v9
    v_mul_f32 v26, v10, v26
    v_exp_f32 v218, -v10
    v_mul_f32 v27, v11, v27
    v_exp_f32 v219, -v11
    v_mul_f32 v28, v12, v28
    v_exp_f32 v220, -v12
    v_mul_f32 v29, v13, v29
    v_exp_f32 v221, -v13
    v_mul_f32 v30, v14, v30
    v_exp_f32 v222, -v14
    v_mul_f32 v31, v15, v31
    v_exp_f32 v223, -v15
    s_barrier
    s_and_b32 s57, s58, 15
    s_lshr_b64 s[58:59], s[58:59], 4
    s_lshl_b32 s56, s57, 11
    s_mul_i32 s57, s57, 0x70000
    s_add_u32 m0, s53, 16384
    s_nop 0
    buffer_load_dwordx4 v188, s[32:35], s57 offen offset:0 lds
    v_fma_f32 v216, v216, s67, s67
    v_fma_f32 v217, v217, s67, s67
    v_rcp_f32 v216, v216
    v_fma_f32 v218, v218, s67, s67
    buffer_load_dwordx4 v189, s[32:35], s57 offen offset:1024 lds
    v_rcp_f32 v217, v217
    v_fma_f32 v219, v219, s67, s67
    v_rcp_f32 v218, v218
    v_fma_f32 v220, v220, s67, s67
    buffer_load_dwordx4 v190, s[32:35], s57 offen offset:2048 lds
    v_rcp_f32 v219, v219
    v_fma_f32 v221, v221, s67, s67
    v_rcp_f32 v220, v220
    v_fma_f32 v222, v222, s67, s67
    buffer_load_dwordx4 v191, s[32:35], s57 offen offset:3072 lds
    v_rcp_f32 v221, v221
    v_fma_f32 v223, v223, s67, s67
    v_rcp_f32 v222, v222
    v_rcp_f32 v223, v223
    s_add_u32 m0, s53, 32768
    s_nop 0
    buffer_load_dwordx4 v188, s[36:39], s57 offen offset:0 lds
    v_mul_f32 v24, v24, v216
    v_mul_f32 v25, v25, v217
    v_mul_f32 v26, v26, v218
    v_mul_f32 v27, v27, v219
    buffer_load_dwordx4 v189, s[36:39], s57 offen offset:1024 lds
    v_mul_f32 v28, v28, v220
    v_mul_f32 v29, v29, v221
    v_mul_f32 v30, v30, v222
    v_mul_f32 v31, v31, v223
    buffer_load_dwordx4 v190, s[36:39], s57 offen offset:2048 lds
    v_cvt_pk_bf16_f32 v200, v24, v25
    v_cvt_pk_bf16_f32 v201, v26, v27
    v_cvt_pk_bf16_f32 v202, v28, v29
    v_cvt_pk_bf16_f32 v203, v30, v31
    buffer_load_dwordx4 v191, s[36:39], s57 offen offset:3072 lds
    v_mul_f32 v32, v16, v32
    v_exp_f32 v224, -v16
    v_mul_f32 v33, v17, v33
    s_mov_b32 m0, s53
    s_nop 0
    buffer_load_dwordx4 v184, s[28:31], s56 offen offset:0 lds
    v_exp_f32 v225, -v17
    v_mul_f32 v34, v18, v34
    v_exp_f32 v226, -v18
    v_mul_f32 v35, v19, v35
    buffer_load_dwordx4 v184, s[28:31], s56 offen offset:1024 lds
    v_exp_f32 v227, -v19
    v_mul_f32 v36, v20, v36
    v_exp_f32 v228, -v20
    v_mul_f32 v37, v21, v37
    buffer_load_dwordx4 v185, s[28:31], s56 offen offset:2048 lds
    v_exp_f32 v229, -v21
    v_mul_f32 v38, v22, v38
    v_exp_f32 v230, -v22
    v_mul_f32 v39, v23, v39
    buffer_load_dwordx4 v185, s[28:31], s56 offen offset:3072 lds
    v_exp_f32 v231, -v23
    v_fma_f32 v224, v224, s67, s67
    v_fma_f32 v225, v225, s67, s67
    v_rcp_f32 v224, v224
    s_add_u32 s53, s53, 49152
    s_cmp_ge_u32 s53, s61
    s_cselect_b32 s53, s60, s53
    buffer_store_dwordx4 v[200:203], v198, s[28:31], 0 offen offset:0 sc1
    s_barrier
    s_and_b32 s57, s58, 15
    s_lshr_b64 s[58:59], s[58:59], 4
    s_lshl_b32 s56, s57, 11
    s_mul_i32 s57, s57, 0x70000
    s_add_u32 m0, s53, 16384
    s_nop 0
    buffer_load_dwordx4 v188, s[32:35], s57 offen offset:0 lds
    v_fma_f32 v226, v226, s67, s67
    v_rcp_f32 v225, v225
    v_fma_f32 v227, v227, s67, s67
    v_rcp_f32 v226, v226
    buffer_load_dwordx4 v189, s[32:35], s57 offen offset:1024 lds
    v_fma_f32 v228, v228, s67, s67
    v_rcp_f32 v227, v227
    v_fma_f32 v229, v229, s67, s67
    v_rcp_f32 v228, v228
    buffer_load_dwordx4 v190, s[32:35], s57 offen offset:2048 lds
    v_fma_f32 v230, v230, s67, s67
    v_rcp_f32 v229, v229
    v_fma_f32 v231, v231, s67, s67
    v_rcp_f32 v230, v230
    buffer_load_dwordx4 v191, s[32:35], s57 offen offset:3072 lds
    v_rcp_f32 v231, v231
    v_mul_f32 v32, v32, v224
    v_mul_f32 v33, v33, v225
    v_mul_f32 v34, v34, v226
    s_add_u32 m0, s53, 32768
    s_nop 0
    buffer_load_dwordx4 v188, s[36:39], s57 offen offset:0 lds
    v_mul_f32 v35, v35, v227
    v_mul_f32 v36, v36, v228
    v_mul_f32 v37, v37, v229
    v_mul_f32 v38, v38, v230
    buffer_load_dwordx4 v189, s[36:39], s57 offen offset:1024 lds
    v_mul_f32 v39, v39, v231
    v_cvt_pk_bf16_f32 v204, v32, v33
    v_cvt_pk_bf16_f32 v205, v34, v35
    v_cvt_pk_bf16_f32 v206, v36, v37
    buffer_load_dwordx4 v190, s[36:39], s57 offen offset:2048 lds
    v_cvt_pk_bf16_f32 v207, v38, v39
    v_mul_f32 v56, v40, v56
    buffer_load_dwordx4 v191, s[36:39], s57 offen offset:3072 lds
    v_exp_f32 v216, -v40
    v_mul_f32 v57, v41, v57
    v_exp_f32 v217, -v41
    v_mul_f32 v58, v42, v58
    s_mov_b32 m0, s53
    s_nop 0
    buffer_load_dwordx4 v184, s[28:31], s56 offen offset:0 lds
    v_exp_f32 v218, -v42
    v_mul_f32 v59, v43, v59
    v_exp_f32 v219, -v43
    v_mul_f32 v60, v44, v60
    buffer_load_dwordx4 v184, s[28:31], s56 offen offset:1024 lds
    v_exp_f32 v220, -v44
    v_mul_f32 v61, v45, v61
    v_exp_f32 v221, -v45
    v_mul_f32 v62, v46, v62
    buffer_load_dwordx4 v185, s[28:31], s56 offen offset:2048 lds
    v_exp_f32 v222, -v46
    v_mul_f32 v63, v47, v63
    v_exp_f32 v223, -v47
    v_fma_f32 v216, v216, s67, s67
    buffer_load_dwordx4 v185, s[28:31], s56 offen offset:3072 lds
    v_fma_f32 v217, v217, s67, s67
    v_rcp_f32 v216, v216
    v_fma_f32 v218, v218, s67, s67
    v_rcp_f32 v217, v217
    s_add_u32 s53, s53, 49152
    s_cmp_ge_u32 s53, s61
    s_cselect_b32 s53, s60, s53
    buffer_store_dwordx4 v[204:207], v198, s[28:31], 0 offen offset:1024 sc1
    v_add_u32 v198, 114688, v198
    s_waitcnt vmcnt(14)
    s_barrier
    s_and_b32 s57, s58, 15
    s_lshr_b64 s[58:59], s[58:59], 4
    s_lshl_b32 s56, s57, 11
    s_mul_i32 s57, s57, 0x70000
    s_add_u32 m0, s53, 16384
    s_nop 0
    buffer_load_dwordx4 v188, s[32:35], s57 offen offset:0 lds
    v_fma_f32 v219, v219, s67, s67
    v_rcp_f32 v218, v218
    v_fma_f32 v220, v220, s67, s67
    v_rcp_f32 v219, v219
    buffer_load_dwordx4 v189, s[32:35], s57 offen offset:1024 lds
    v_fma_f32 v221, v221, s67, s67
    v_rcp_f32 v220, v220
    v_fma_f32 v222, v222, s67, s67
    v_rcp_f32 v221, v221
    buffer_load_dwordx4 v190, s[32:35], s57 offen offset:2048 lds
    v_fma_f32 v223, v223, s67, s67
    v_rcp_f32 v222, v222
    v_rcp_f32 v223, v223
    v_mul_f32 v56, v56, v216
    buffer_load_dwordx4 v191, s[32:35], s57 offen offset:3072 lds
    v_mul_f32 v57, v57, v217
    v_mul_f32 v58, v58, v218
    v_mul_f32 v59, v59, v219
    v_mul_f32 v60, v60, v220
    s_add_u32 m0, s53, 32768
    s_nop 0
    buffer_load_dwordx4 v188, s[36:39], s57 offen offset:0 lds
    v_mul_f32 v61, v61, v221
    v_mul_f32 v62, v62, v222
    v_mul_f32 v63, v63, v223
    v_cvt_pk_bf16_f32 v208, v56, v57
    buffer_load_dwordx4 v189, s[36:39], s57 offen offset:1024 lds
    v_cvt_pk_bf16_f32 v209, v58, v59
    v_cvt_pk_bf16_f32 v210, v60, v61
    v_cvt_pk_bf16_f32 v211, v62, v63
    buffer_load_dwordx4 v190, s[36:39], s57 offen offset:2048 lds
    v_mul_f32 v64, v48, v64
    v_exp_f32 v224, -v48
    v_mul_f32 v65, v49, v65
    v_exp_f32 v225, -v49
    buffer_load_dwordx4 v191, s[36:39], s57 offen offset:3072 lds
    v_mul_f32 v66, v50, v66
    v_exp_f32 v226, -v50
    v_mul_f32 v67, v51, v67
    v_exp_f32 v227, -v51
    s_mov_b32 m0, s53
    s_nop 0
    buffer_load_dwordx4 v184, s[28:31], s56 offen offset:0 lds
    v_mul_f32 v68, v52, v68
    v_exp_f32 v228, -v52
    v_mul_f32 v69, v53, v69
    v_exp_f32 v229, -v53
    buffer_load_dwordx4 v184, s[28:31], s56 offen offset:1024 lds
    v_mul_f32 v70, v54, v70
    v_exp_f32 v230, -v54
    v_mul_f32 v71, v55, v71
    v_exp_f32 v231, -v55
    buffer_load_dwordx4 v185, s[28:31], s56 offen offset:2048 lds
    v_fma_f32 v224, v224, s67, s67
    v_fma_f32 v225, v225, s67, s67
    v_rcp_f32 v224, v224
    v_fma_f32 v226, v226, s67, s67
    buffer_load_dwordx4 v185, s[28:31], s56 offen offset:3072 lds
    v_rcp_f32 v225, v225
    v_fma_f32 v227, v227, s67, s67
    v_rcp_f32 v226, v226
    v_fma_f32 v228, v228, s67, s67
    s_add_u32 s53, s53, 49152
    s_cmp_ge_u32 s53, s61
    s_cselect_b32 s53, s60, s53
    buffer_store_dwordx4 v[208:211], v198, s[28:31], 0 offen offset:0 sc1
    s_waitcnt vmcnt(14)
    s_barrier
    s_and_b32 s57, s58, 15
    s_lshr_b64 s[58:59], s[58:59], 4
    s_lshl_b32 s56, s57, 11
    s_mul_i32 s57, s57, 0x70000
    s_add_u32 m0, s53, 16384
    s_nop 0
    buffer_load_dwordx4 v188, s[32:35], s57 offen offset:0 lds
    v_rcp_f32 v227, v227
    v_fma_f32 v229, v229, s67, s67
    v_rcp_f32 v228, v228
    v_fma_f32 v230, v230, s67, s67
    buffer_load_dwordx4 v189, s[32:35], s57 offen offset:1024 lds
    v_rcp_f32 v229, v229
    v_fma_f32 v231, v231, s67, s67
    v_rcp_f32 v230, v230
    v_rcp_f32 v231, v231
    buffer_load_dwordx4 v190, s[32:35], s57 offen offset:2048 lds
    v_mul_f32 v64, v64, v224
    v_mul_f32 v65, v65, v225
    v_mul_f32 v66, v66, v226
    v_mul_f32 v67, v67, v227
    buffer_load_dwordx4 v191, s[32:35], s57 offen offset:3072 lds
    v_mul_f32 v68, v68, v228
    v_mul_f32 v69, v69, v229
    v_mul_f32 v70, v70, v230
    v_mul_f32 v71, v71, v231
    s_add_u32 m0, s53, 32768
    s_nop 0
    buffer_load_dwordx4 v188, s[36:39], s57 offen offset:0 lds
    v_cvt_pk_bf16_f32 v212, v64, v65
    v_cvt_pk_bf16_f32 v213, v66, v67
    v_cvt_pk_bf16_f32 v214, v68, v69
    v_cvt_pk_bf16_f32 v215, v70, v71
    buffer_load_dwordx4 v189, s[36:39], s57 offen offset:1024 lds
    v_mul_f32 v88, v72, v88
    v_exp_f32 v216, -v72
    buffer_load_dwordx4 v190, s[36:39], s57 offen offset:2048 lds
    v_mul_f32 v89, v73, v89
    v_exp_f32 v217, -v73
    v_mul_f32 v90, v74, v90
    v_exp_f32 v218, -v74
    buffer_load_dwordx4 v191, s[36:39], s57 offen offset:3072 lds
    v_mul_f32 v91, v75, v91
    v_exp_f32 v219, -v75
    v_mul_f32 v92, v76, v92
    v_exp_f32 v220, -v76
    s_mov_b32 m0, s53
    s_nop 0
    buffer_load_dwordx4 v184, s[28:31], s56 offen offset:0 lds
    v_mul_f32 v93, v77, v93
    v_exp_f32 v221, -v77
    v_mul_f32 v94, v78, v94
    v_exp_f32 v222, -v78
    buffer_load_dwordx4 v184, s[28:31], s56 offen offset:1024 lds
    v_mul_f32 v95, v79, v95
    v_exp_f32 v223, -v79
    v_fma_f32 v216, v216, s67, s67
    v_fma_f32 v217, v217, s67, s67
    buffer_load_dwordx4 v185, s[28:31], s56 offen offset:2048 lds
    v_rcp_f32 v216, v216
    v_fma_f32 v218, v218, s67, s67
    v_rcp_f32 v217, v217
    v_fma_f32 v219, v219, s67, s67
    buffer_load_dwordx4 v185, s[28:31], s56 offen offset:3072 lds
    v_rcp_f32 v218, v218
    v_fma_f32 v220, v220, s67, s67
    v_rcp_f32 v219, v219
    v_fma_f32 v221, v221, s67, s67
    s_add_u32 s53, s53, 49152
    s_cmp_ge_u32 s53, s61
    s_cselect_b32 s53, s60, s53
    buffer_store_dwordx4 v[212:215], v198, s[28:31], 0 offen offset:1024 sc1
    v_add_u32 v198, 114688, v198
    s_waitcnt vmcnt(14)
    s_barrier
    s_and_b32 s57, s58, 15
    s_lshr_b64 s[58:59], s[58:59], 4
    s_lshl_b32 s56, s57, 11
    s_mul_i32 s57, s57, 0x70000
    s_add_u32 m0, s53, 16384
    s_nop 0
    buffer_load_dwordx4 v188, s[32:35], s57 offen offset:0 lds
    v_rcp_f32 v220, v220
    v_fma_f32 v222, v222, s67, s67
    v_rcp_f32 v221, v221
    v_fma_f32 v223, v223, s67, s67
    buffer_load_dwordx4 v189, s[32:35], s57 offen offset:1024 lds
    v_rcp_f32 v222, v222
    v_rcp_f32 v223, v223
    v_mul_f32 v88, v88, v216
    v_mul_f32 v89, v89, v217
    buffer_load_dwordx4 v190, s[32:35], s57 offen offset:2048 lds
    v_mul_f32 v90, v90, v218
    v_mul_f32 v91, v91, v219
    v_mul_f32 v92, v92, v220
    v_mul_f32 v93, v93, v221
    buffer_load_dwordx4 v191, s[32:35], s57 offen offset:3072 lds
    v_mul_f32 v94, v94, v222
    v_mul_f32 v95, v95, v223
    v_cvt_pk_bf16_f32 v200, v88, v89
    v_cvt_pk_bf16_f32 v201, v90, v91
    s_add_u32 m0, s53, 32768
    s_nop 0
    buffer_load_dwordx4 v188, s[36:39], s57 offen offset:0 lds
    v_cvt_pk_bf16_f32 v202, v92, v93
    v_cvt_pk_bf16_f32 v203, v94, v95
    v_mul_f32 v96, v80, v96
    buffer_load_dwordx4 v189, s[36:39], s57 offen offset:1024 lds
    v_exp_f32 v224, -v80
    v_mul_f32 v97, v81, v97
    v_exp_f32 v225, -v81
    v_mul_f32 v98, v82, v98
    buffer_load_dwordx4 v190, s[36:39], s57 offen offset:2048 lds
    v_exp_f32 v226, -v82
    v_mul_f32 v99, v83, v99
    v_exp_f32 v227, -v83
    v_mul_f32 v100, v84, v100
    buffer_load_dwordx4 v191, s[36:39], s57 offen offset:3072 lds
    v_exp_f32 v228, -v84
    v_mul_f32 v101, v85, v101
    v_exp_f32 v229, -v85
    v_mul_f32 v102, v86, v102
    s_mov_b32 m0, s53
    s_nop 0
    buffer_load_dwordx4 v184, s[28:31], s56 offen offset:0 lds
    v_exp_f32 v230, -v86
    v_mul_f32 v103, v87, v103
    v_exp_f32 v231, -v87
    v_fma_f32 v224, v224, s67, s67
    buffer_load_dwordx4 v184, s[28:31], s56 offen offset:1024 lds
    v_fma_f32 v225, v225, s67, s67
    v_rcp_f32 v224, v224
    v_fma_f32 v226, v226, s67, s67
    v_rcp_f32 v225, v225
    buffer_load_dwordx4 v185, s[28:31], s56 offen offset:2048 lds
    v_fma_f32 v227, v227, s67, s67
    v_rcp_f32 v226, v226
    v_fma_f32 v228, v228, s67, s67
    v_rcp_f32 v227, v227
    buffer_load_dwordx4 v185, s[28:31], s56 offen offset:3072 lds
    v_fma_f32 v229, v229, s67, s67
    v_rcp_f32 v228, v228
    v_fma_f32 v230, v230, s67, s67
    v_rcp_f32 v229, v229
    s_add_u32 s53, s53, 49152
    s_cmp_ge_u32 s53, s61
    s_cselect_b32 s53, s60, s53
    buffer_store_dwordx4 v[200:203], v198, s[28:31], 0 offen offset:0 sc1
    s_waitcnt vmcnt(14)
    s_barrier
    s_and_b32 s57, s58, 15
    s_lshr_b64 s[58:59], s[58:59], 4
    s_lshl_b32 s56, s57, 11
    s_mul_i32 s57, s57, 0x70000
    s_add_u32 m0, s53, 16384
    s_nop 0
    buffer_load_dwordx4 v188, s[32:35], s57 offen offset:0 lds
    v_fma_f32 v231, v231, s67, s67
    v_rcp_f32 v230, v230
    v_rcp_f32 v231, v231
    v_mul_f32 v96, v96, v224
    buffer_load_dwordx4 v189, s[32:35], s57 offen offset:1024 lds
    v_mul_f32 v97, v97, v225
    v_mul_f32 v98, v98, v226
    v_mul_f32 v99, v99, v227
    v_mul_f32 v100, v100, v228
    buffer_load_dwordx4 v190, s[32:35], s57 offen offset:2048 lds
    v_mul_f32 v101, v101, v229
    v_mul_f32 v102, v102, v230
    v_mul_f32 v103, v103, v231
    v_cvt_pk_bf16_f32 v204, v96, v97
    buffer_load_dwordx4 v191, s[32:35], s57 offen offset:3072 lds
    v_cvt_pk_bf16_f32 v205, v98, v99
    v_cvt_pk_bf16_f32 v206, v100, v101
    v_cvt_pk_bf16_f32 v207, v102, v103
    s_add_u32 m0, s53, 32768
    s_nop 0
    buffer_load_dwordx4 v188, s[36:39], s57 offen offset:0 lds
    v_mul_f32 v120, v104, v120
    v_exp_f32 v216, -v104
    v_mul_f32 v121, v105, v121
    buffer_load_dwordx4 v189, s[36:39], s57 offen offset:1024 lds
    v_exp_f32 v217, -v105
    v_mul_f32 v122, v106, v122
    v_exp_f32 v218, -v106
    v_mul_f32 v123, v107, v123
    buffer_load_dwordx4 v190, s[36:39], s57 offen offset:2048 lds
    v_exp_f32 v219, -v107
    v_mul_f32 v124, v108, v124
    v_exp_f32 v220, -v108
    v_mul_f32 v125, v109, v125
    buffer_load_dwordx4 v191, s[36:39], s57 offen offset:3072 lds
    v_exp_f32 v221, -v109
    v_mul_f32 v126, v110, v126
    v_exp_f32 v222, -v110
    v_mul_f32 v127, v111, v127
    s_mov_b32 m0, s53
    s_nop 0
    buffer_load_dwordx4 v184, s[28:31], s56 offen offset:0 lds
    v_exp_f32 v223, -v111
    v_fma_f32 v216, v216, s67, s67
    v_fma_f32 v217, v217, s67, s67
    v_rcp_f32 v216, v216
    buffer_load_dwordx4 v184, s[28:31], s56 offen offset:1024 lds
    v_fma_f32 v218, v218, s67, s67
    v_rcp_f32 v217, v217
    v_fma_f32 v219, v219, s67, s67
    v_rcp_f32 v218, v218
    buffer_load_dwordx4 v185, s[28:31], s56 offen offset:2048 lds
    v_fma_f32 v220, v220, s67, s67
    v_rcp_f32 v219, v219
    v_fma_f32 v221, v221, s67, s67
    v_rcp_f32 v220, v220
    buffer_load_dwordx4 v185, s[28:31], s56 offen offset:3072 lds
    v_fma_f32 v222, v222, s67, s67
    v_rcp_f32 v221, v221
    v_fma_f32 v223, v223, s67, s67
    v_rcp_f32 v222, v222
    s_add_u32 s53, s53, 49152
    s_cmp_ge_u32 s53, s61
    s_cselect_b32 s53, s60, s53
    buffer_store_dwordx4 v[204:207], v198, s[28:31], 0 offen offset:1024 sc1
    v_add_u32 v198, 114688, v198
    s_waitcnt vmcnt(14)
    s_barrier
    s_and_b32 s57, s58, 15
    s_lshr_b64 s[58:59], s[58:59], 4
    s_lshl_b32 s56, s57, 11
    s_mul_i32 s57, s57, 0x70000
    s_add_u32 m0, s53, 16384
    s_nop 0
    buffer_load_dwordx4 v188, s[32:35], s57 offen offset:0 lds
    v_rcp_f32 v223, v223
    v_mul_f32 v120, v120, v216
    v_mul_f32 v121, v121, v217
    v_mul_f32 v122, v122, v218
    buffer_load_dwordx4 v189, s[32:35], s57 offen offset:1024 lds
    v_mul_f32 v123, v123, v219
    v_mul_f32 v124, v124, v220
    v_mul_f32 v125, v125, v221
    v_mul_f32 v126, v126, v222
    buffer_load_dwordx4 v190, s[32:35], s57 offen offset:2048 lds
    v_mul_f32 v127, v127, v223
    v_cvt_pk_bf16_f32 v208, v120, v121
    v_cvt_pk_bf16_f32 v209, v122, v123
    v_cvt_pk_bf16_f32 v210, v124, v125
    buffer_load_dwordx4 v191, s[32:35], s57 offen offset:3072 lds
    v_cvt_pk_bf16_f32 v211, v126, v127
    v_mul_f32 v128, v112, v128
    v_exp_f32 v224, -v112
    s_add_u32 m0, s53, 32768
    s_nop 0
    buffer_load_dwordx4 v188, s[36:39], s57 offen offset:0 lds
    v_mul_f32 v129, v113, v129
    v_exp_f32 v225, -v113
    v_mul_f32 v130, v114, v130
    v_exp_f32 v226, -v114
    buffer_load_dwordx4 v189, s[36:39], s57 offen offset:1024 lds
    v_mul_f32 v131, v115, v131
    v_exp_f32 v227, -v115
    v_mul_f32 v132, v116, v132
    v_exp_f32 v228, -v116
    buffer_load_dwordx4 v190, s[36:39], s57 offen offset:2048 lds
    v_mul_f32 v133, v117, v133
    v_exp_f32 v229, -v117
    v_mul_f32 v134, v118, v134
    v_exp_f32 v230, -v118
    buffer_load_dwordx4 v191, s[36:39], s57 offen offset:3072 lds
    v_mul_f32 v135, v119, v135
    v_exp_f32 v231, -v119
    v_fma_f32 v224, v224, s67, s67
    v_fma_f32 v225, v225, s67, s67
    s_mov_b32 m0, s53
    s_nop 0
    buffer_load_dwordx4 v184, s[28:31], s56 offen offset:0 lds
    v_rcp_f32 v224, v224
    v_fma_f32 v226, v226, s67, s67
    v_rcp_f32 v225, v225
    v_fma_f32 v227, v227, s67, s67
    buffer_load_dwordx4 v184, s[28:31], s56 offen offset:1024 lds
    v_rcp_f32 v226, v226
    v_fma_f32 v228, v228, s67, s67
    v_rcp_f32 v227, v227
    v_fma_f32 v229, v229, s67, s67
    buffer_load_dwordx4 v185, s[28:31], s56 offen offset:2048 lds
    v_rcp_f32 v228, v228
    v_fma_f32 v230, v230, s67, s67
    v_rcp_f32 v229, v229
    v_fma_f32 v231, v231, s67, s67
    buffer_load_dwordx4 v185, s[28:31], s56 offen offset:3072 lds
    v_rcp_f32 v230, v230
    v_rcp_f32 v231, v231
    v_mul_f32 v128, v128, v224
    v_mul_f32 v129, v129, v225
    s_add_u32 s53, s53, 49152
    s_cmp_ge_u32 s53, s61
    s_cselect_b32 s53, s60, s53
    buffer_store_dwordx4 v[208:211], v198, s[28:31], 0 offen offset:0 sc1
    s_waitcnt vmcnt(14)
    s_barrier
    s_and_b32 s57, s58, 15
    s_lshr_b64 s[58:59], s[58:59], 4
    s_lshl_b32 s56, s57, 11
    s_mul_i32 s57, s57, 0x70000
    s_add_u32 m0, s53, 16384
    s_nop 0
    buffer_load_dwordx4 v188, s[32:35], s57 offen offset:0 lds
    v_mul_f32 v130, v130, v226
    v_mul_f32 v131, v131, v227
    v_mul_f32 v132, v132, v228
    v_mul_f32 v133, v133, v229
    buffer_load_dwordx4 v189, s[32:35], s57 offen offset:1024 lds
    v_mul_f32 v134, v134, v230
    v_mul_f32 v135, v135, v231
    v_cvt_pk_bf16_f32 v212, v128, v129
    v_cvt_pk_bf16_f32 v213, v130, v131
    buffer_load_dwordx4 v190, s[32:35], s57 offen offset:2048 lds
    v_cvt_pk_bf16_f32 v214, v132, v133
    v_cvt_pk_bf16_f32 v215, v134, v135
    buffer_load_dwordx4 v191, s[32:35], s57 offen offset:3072 lds
    s_add_u32 m0, s53, 32768
    s_nop 0
    buffer_load_dwordx4 v188, s[36:39], s57 offen offset:0 lds
    buffer_load_dwordx4 v189, s[36:39], s57 offen offset:1024 lds
    buffer_load_dwordx4 v190, s[36:39], s57 offen offset:2048 lds
    buffer_load_dwordx4 v191, s[36:39], s57 offen offset:3072 lds
    s_mov_b32 m0, s53
    s_nop 0
    buffer_load_dwordx4 v184, s[28:31], s56 offen offset:0 lds
    buffer_load_dwordx4 v184, s[28:31], s56 offen offset:1024 lds
    buffer_load_dwordx4 v185, s[28:31], s56 offen offset:2048 lds
    buffer_load_dwordx4 v185, s[28:31], s56 offen offset:3072 lds
    s_add_u32 s53, s53, 49152
    s_cmp_ge_u32 s53, s61
    s_cselect_b32 s53, s60, s53
    buffer_store_dwordx4 v[212:215], v198, s[28:31], 0 offen offset:1024 sc1
    s_waitcnt vmcnt(14)
    s_barrier
    s_and_b32 s57, s58, 15
    s_lshr_b64 s[58:59], s[58:59], 4
    s_lshl_b32 s56, s57, 11
    s_mul_i32 s57, s57, 0x70000
    s_add_u32 m0, s53, 16384
    s_nop 0
    buffer_load_dwordx4 v188, s[32:35], s57 offen offset:0 lds
    buffer_load_dwordx4 v189, s[32:35], s57 offen offset:1024 lds
    buffer_load_dwordx4 v190, s[32:35], s57 offen offset:2048 lds
    buffer_load_dwordx4 v191, s[32:35], s57 offen offset:3072 lds
    s_add_u32 m0, s53, 32768
    s_nop 0
    buffer_load_dwordx4 v188, s[36:39], s57 offen offset:0 lds
    buffer_load_dwordx4 v189, s[36:39], s57 offen offset:1024 lds
    buffer_load_dwordx4 v190, s[36:39], s57 offen offset:2048 lds
    buffer_load_dwordx4 v191, s[36:39], s57 offen offset:3072 lds
    s_mov_b32 m0, s53
    s_nop 0
    buffer_load_dwordx4 v184, s[28:31], s56 offen offset:0 lds
    buffer_load_dwordx4 v184, s[28:31], s56 offen offset:1024 lds
    buffer_load_dwordx4 v185, s[28:31], s56 offen offset:2048 lds
    buffer_load_dwordx4 v185, s[28:31], s56 offen offset:3072 lds
    s_add_u32 s53, s53, 49152
    s_cmp_ge_u32 s53, s61
    s_cselect_b32 s53, s60, s53
    s_lshl_b32 s64, s47, 8
    s_lshl_b32 s65, s48, 4
    s_add_u32 s64, s64, s65
    s_lshl_b32 s65, s44, 2
    s_add_u32 s64, s64, s65
    s_add_u32 s64, s64, 0x51000
    v_mov_b32 v2, 1
    s_waitcnt vmcnt(12)
    s_mov_b64 exec, 1
    buffer_store_dword v2, v234, s[28:31], s64 offen sc1
    s_mov_b64 exec, -1
    s_lshl_b32 s64, s50, 3
    s_lshl_b32 s65, s44, 1
    s_add_u32 s64, s64, s65
    s_mul_i32 s64, s64, 114688
    s_add_u32 s64, s64, 0x1500000
    v_lshl_add_u32 v192, v1, 4, s64
    v_add_u32 v193, 112640, v192
    s_lshl_b32 s65, s51, 8
    v_lshrrev_b32 v3, 4, v1
    s_lshl_b32 s64, s44, 4
    v_add_u32 v2, s64, v3
    s_movk_i32 s64, 2048
    v_mul_u32_u24 v2, s64, v2
    v_add_u32 v2, s65, v2
    v_lshlrev_b32 v3, 1, v3
    v_and_b32 v4, 15, v1
    v_xor_b32 v3, v3, v4
    v_lshl_add_u32 v194, v3, 4, v2
    v_add_u32 v196, 14336, v194
    v_xor_b32 v3, 8, v3
    v_lshl_add_u32 v195, v3, 4, v2
    v_add_u32 v195, 7168, v195
    v_add_u32 v197, 14336, v195
    s_barrier
    s_and_b32 s57, s58, 15
    s_lshr_b64 s[58:59], s[58:59], 4
    s_lshl_b32 s56, s57, 11
    s_mul_i32 s57, s57, 0x70000
    s_add_u32 m0, s53, 16384
    s_nop 0
    buffer_load_dwordx4 v188, s[32:35], s57 offen offset:0 lds
    buffer_load_dwordx4 v189, s[32:35], s57 offen offset:1024 lds
    buffer_load_dwordx4 v190, s[32:35], s57 offen offset:2048 lds
    buffer_load_dwordx4 v191, s[32:35], s57 offen offset:3072 lds
    s_add_u32 m0, s53, 32768
    s_nop 0
    buffer_load_dwordx4 v188, s[36:39], s57 offen offset:0 lds
    buffer_load_dwordx4 v189, s[36:39], s57 offen offset:1024 lds
    buffer_load_dwordx4 v190, s[36:39], s57 offen offset:2048 lds
    buffer_load_dwordx4 v191, s[36:39], s57 offen offset:3072 lds
    s_mov_b32 m0, s53
    s_nop 0
    buffer_load_dwordx4 v184, s[28:31], s56 offen offset:0 lds
    buffer_load_dwordx4 v184, s[28:31], s56 offen offset:1024 lds
    buffer_load_dwordx4 v185, s[28:31], s56 offen offset:2048 lds
    buffer_load_dwordx4 v185, s[28:31], s56 offen offset:3072 lds
    s_add_u32 s53, s53, 49152
    s_cmp_ge_u32 s53, s61
    s_cselect_b32 s53, s60, s53
    s_waitcnt vmcnt(13)
    s_barrier
    s_and_b32 s57, s58, 15
    s_lshr_b64 s[58:59], s[58:59], 4
    s_lshl_b32 s56, s57, 11
    s_mul_i32 s57, s57, 0x70000
    s_add_u32 m0, s53, 16384
    s_nop 0
    buffer_load_dwordx4 v188, s[32:35], s57 offen offset:0 lds
    buffer_load_dwordx4 v189, s[32:35], s57 offen offset:1024 lds
    buffer_load_dwordx4 v190, s[32:35], s57 offen offset:2048 lds
    buffer_load_dwordx4 v191, s[32:35], s57 offen offset:3072 lds
    s_add_u32 m0, s53, 32768
    s_nop 0
    buffer_load_dwordx4 v188, s[36:39], s57 offen offset:0 lds
    buffer_load_dwordx4 v189, s[36:39], s57 offen offset:1024 lds
    buffer_load_dwordx4 v190, s[36:39], s57 offen offset:2048 lds
    buffer_load_dwordx4 v191, s[36:39], s57 offen offset:3072 lds
    s_mov_b32 m0, s53
    s_nop 0
    buffer_load_dwordx4 v184, s[28:31], s56 offen offset:0 lds
    buffer_load_dwordx4 v184, s[28:31], s56 offen offset:1024 lds
    buffer_load_dwordx4 v185, s[28:31], s56 offen offset:2048 lds
    buffer_load_dwordx4 v185, s[28:31], s56 offen offset:3072 lds
    s_add_u32 s53, s53, 49152
    s_cmp_ge_u32 s53, s61
    s_cselect_b32 s53, s60, s53
    s_waitcnt vmcnt(12)
    s_barrier
    s_and_b32 s57, s58, 15
    s_lshr_b64 s[58:59], s[58:59], 4
    s_lshl_b32 s56, s57, 11
    s_mul_i32 s57, s57, 0x70000
    s_add_u32 m0, s53, 16384
    s_nop 0
    buffer_load_dwordx4 v188, s[32:35], s57 offen offset:0 lds
    buffer_load_dwordx4 v189, s[32:35], s57 offen offset:1024 lds
    buffer_load_dwordx4 v190, s[32:35], s57 offen offset:2048 lds
    buffer_load_dwordx4 v191, s[32:35], s57 offen offset:3072 lds
    s_add_u32 m0, s53, 32768
    s_nop 0
    buffer_load_dwordx4 v188, s[36:39], s57 offen offset:0 lds
    buffer_load_dwordx4 v189, s[36:39], s57 offen offset:1024 lds
    buffer_load_dwordx4 v190, s[36:39], s57 offen offset:2048 lds
    buffer_load_dwordx4 v191, s[36:39], s57 offen offset:3072 lds
    s_mov_b32 m0, s53
    s_nop 0
    buffer_load_dwordx4 v184, s[28:31], s56 offen offset:0 lds
    buffer_load_dwordx4 v184, s[28:31], s56 offen offset:1024 lds
    buffer_load_dwordx4 v185, s[28:31], s56 offen offset:2048 lds
    buffer_load_dwordx4 v185, s[28:31], s56 offen offset:3072 lds
    s_add_u32 s53, s53, 49152
    s_cmp_ge_u32 s53, s61
    s_cselect_b32 s53, s60, s53
    s_waitcnt vmcnt(12)
    s_barrier
    s_lshl_b32 s68, s50, 8
    s_add_u32 s68, s68, 0x51000
    buffer_load_dword v245, v234, s[28:31], s68 offen sc1
    s_and_b32 s57, s58, 15
    s_lshr_b64 s[58:59], s[58:59], 4
    s_lshl_b32 s56, s57, 11
    s_mul_i32 s57, s57, 0x70000
    s_add_u32 m0, s53, 16384
    s_nop 0
    buffer_load_dwordx4 v188, s[32:35], s57 offen offset:0 lds
    buffer_load_dwordx4 v189, s[32:35], s57 offen offset:1024 lds
    buffer_load_dwordx4 v190, s[32:35], s57 offen offset:2048 lds
    buffer_load_dwordx4 v191, s[32:35], s57 offen offset:3072 lds
    s_add_u32 m0, s53, 32768
    s_nop 0
    buffer_load_dwordx4 v188, s[36:39], s57 offen offset:0 lds
    buffer_load_dwordx4 v189, s[36:39], s57 offen offset:1024 lds
    buffer_load_dwordx4 v190, s[36:39], s57 offen offset:2048 lds
    buffer_load_dwordx4 v191, s[36:39], s57 offen offset:3072 lds
    s_mov_b32 m0, s53
    s_nop 0
    buffer_load_dwordx4 v184, s[28:31], s56 offen offset:0 lds
    buffer_load_dwordx4 v184, s[28:31], s56 offen offset:1024 lds
    buffer_load_dwordx4 v185, s[28:31], s56 offen offset:2048 lds
    buffer_load_dwordx4 v185, s[28:31], s56 offen offset:3072 lds
    s_add_u32 s53, s53, 49152
    s_cmp_ge_u32 s53, s61
    s_cselect_b32 s53, s60, s53
    s_waitcnt vmcnt(13)
    s_barrier
mega_kernel_Pjoin:
    s_waitcnt vmcnt(12)
    s_mov_b32 s3, 0x40000
mega_kernel_pa_chk:
    v_cmp_ne_u32 vcc, 1, v245
    s_nop 4
    s_cbranch_vccz mega_kernel_pa_ok
    s_sub_u32 s3, s3, 1
    s_cbranch_scc1 mega_kernel_pa_ok
    s_sleep 4
    s_cmp_eq_u32 s69, 0
    s_cbranch_scc1 mega_kernel_pa_rl
    s_sleep 48
mega_kernel_pa_rl:
    buffer_load_dword v245, v234, s[28:31], s68 offen sc1
    s_waitcnt vmcnt(0)
    s_branch mega_kernel_pa_chk
mega_kernel_pa_ok:
    s_lshl_b32 s60, s44, 12
    s_add_u32 s61, s60, 163840
    s_add_u32 s53, s60, 98304
    s_add_u32 s66, s50, s51
    s_and_b32 s66, s66, 3
    s_mov_b32 s58, 0x76453201
    s_mov_b32 s59, 0xfecdba89
    s_cmp_eq_u32 s66, 1
    s_cselect_b32 s58, 0x75643120, s58
    s_cselect_b32 s59, 0xfdecb9a8, s59
    s_cmp_eq_u32 s66, 2
    s_cselect_b32 s58, 0x67542310, s58
    s_cselect_b32 s59, 0xefdcab98, s59
    s_cmp_eq_u32 s66, 3
    s_cselect_b32 s58, 0x86534210, s58
    s_cselect_b32 s59, 0xfedbca97, s59
    s_cmp_eq_u32 s49, 0
    s_cselect_b32 s55, 16, 0
    s_mov_b32 s32, s16
    s_mov_b32 s33, s17
    s_mov_b32 s34, 0x700000
    s_mov_b32 s35, 0x20000
    s_and_b32 s57, s58, 15
    s_lshr_b64 s[58:59], s[58:59], 4
    s_add_u32 s57, s57, s55
    s_lshl_b32 s56, s57, 11
    s_mul_i32 s57, s57, 0x20000
    s_add_u32 m0, s53, 16384
    s_nop 0
    buffer_load_dwordx4 v194, s[32:35], s57 offen offset:0 lds
    buffer_load_dwordx4 v195, s[32:35], s57 offen offset:1024 lds
    buffer_load_dwordx4 v196, s[32:35], s57 offen offset:2048 lds
    buffer_load_dwordx4 v197, s[32:35], s57 offen offset:3072 lds
    s_mov_b32 m0, s53
    s_nop 0
    buffer_load_dwordx4 v192, s[28:31], s56 offen offset:0 lds
    buffer_load_dwordx4 v192, s[28:31], s56 offen offset:1024 lds
    buffer_load_dwordx4 v193, s[28:31], s56 offen offset:2048 lds
    buffer_load_dwordx4 v193, s[28:31], s56 offen offset:3072 lds
    s_add_u32 s53, s53, 32768
    s_cmp_ge_u32 s53, s61
    s_cselect_b32 s53, s60, s53
    s_and_b32 s57, s58, 15
    s_lshr_b64 s[58:59], s[58:59], 4
    s_add_u32 s57, s57, s55
    s_lshl_b32 s56, s57, 11
    s_mul_i32 s57, s57, 0x20000
    s_add_u32 m0, s53, 16384
    s_nop 0
    buffer_load_dwordx4 v194, s[32:35], s57 offen offset:0 lds
    buffer_load_dwordx4 v195, s[32:35], s57 offen offset:1024 lds
    buffer_load_dwordx4 v196, s[32:35], s57 offen offset:2048 lds
    buffer_load_dwordx4 v197, s[32:35], s57 offen offset:3072 lds
    v_and_b32 v2, 15, v1
    s_lshl_b32 s70, s50, 1
    s_add_u32 s70, s70, s45
    s_lshl_b32 s71, s51, 1
    s_add_u32 s71, s71, s46
    s_lshl_b32 s64, s70, 17
    s_lshl_b32 s65, s71, 7
    s_add_u32 s64, s64, s65
    v_lshl_add_u32 v2, v2, 11, s64
    v_bfe_u32 v3, v1, 4, 1
    v_lshl_add_u32 v2, v3, 5, v2
    v_lshrrev_b32 v3, 5, v1
    v_lshl_add_u32 v184, v3, 4, v2
    s_cmp_eq_u32 s49, 0
    s_cselect_b32 s63, 0x80000000, 0
    s_mul_i32 s64, s70, 131072
    s_lshl_b32 s65, s71, 11
    s_add_u32 s64, s64, s65
    s_add_u32 s64, s64, 0xb00000
    s_or_b32 s64, s64, s63
    v_lshl_add_u32 v188, v1, 4, s64
    s_lshl_b32 s64, s50, 12
    s_lshl_b32 s65, s71, 8
    s_add_u32 s64, s64, s65
    s_add_u32 s64, s64, 0xc0000
    s_or_b32 s64, s64, s63
    v_and_b32 v2, 48, v1
    v_add_u32 v185, s64, v2
    s_lshl_b32 s64, s50, 3
    s_add_u32 s64, s64, s51
    s_lshl_b32 s64, s64, 2
    s_add_u32 s64, s64, s44
    s_lshl_b32 s65, s64, 13
    s_add_u32 s65, s65, 0x2400000
    v_lshl_add_u32 v186, v1, 4, s65
    s_lshl_b32 s65, s64, 2
    s_add_u32 s65, s65, 0x50000
    v_mov_b32 v187, s65
    s_mul_i32 s62, s49, 8
    s_mov_b32 s52, 98304
    s_waitcnt vmcnt(12)
    s_barrier
    s_mov_b32 m0, s53
    s_nop 0
    buffer_load_dwordx4 v192, s[28:31], s56 offen offset:0 lds
    buffer_load_dwordx4 v192, s[28:31], s56 offen offset:1024 lds
    buffer_load_dwordx4 v193, s[28:31], s56 offen offset:2048 lds
    buffer_load_dwordx4 v193, s[28:31], s56 offen offset:3072 lds
    s_add_u32 s53, s53, 32768
    s_cmp_ge_u32 s53, s61
    s_cselect_b32 s53, s60, s53
    s_and_b32 s57, s58, 15
    s_lshr_b64 s[58:59], s[58:59], 4
    s_add_u32 s57, s57, s55
    s_lshl_b32 s56, s57, 11
    s_mul_i32 s57, s57, 0x20000
    s_add_u32 m0, s53, 16384
    s_nop 0
    buffer_load_dwordx4 v194, s[32:35], s57 offen offset:0 lds
    buffer_load_dwordx4 v195, s[32:35], s57 offen offset:1024 lds
    buffer_load_dwordx4 v196, s[32:35], s57 offen offset:2048 lds
    buffer_load_dwordx4 v197, s[32:35], s57 offen offset:3072 lds
    s_mov_b32 m0, s53
    s_nop 0
    buffer_load_dwordx4 v192, s[28:31], s56 offen offset:0 lds
    buffer_load_dwordx4 v192, s[28:31], s56 offen offset:1024 lds
    buffer_load_dwordx4 v193, s[28:31], s56 offen offset:2048 lds
    buffer_load_dwordx4 v193, s[28:31], s56 offen offset:3072 lds
    s_add_u32 s53, s53, 32768
    s_cmp_ge_u32 s53, s61
    s_cselect_b32 s53, s60, s53
    v_add_u32 v232, s52, v233
    v_add_u32 v235, s52, v239
    v_add_u32 v236, s52, v240
    v_add_u32 v237, s52, v241
    v_add_u32 v238, s52, v242
    s_mov_b32 s72, 0x0
    s_mov_b32 s76, 0x0
    s_mov_b32 s73, 0x8000
    s_mov_b32 s77, 0x8000
    s_mov_b32 s74, 0x10000
    s_mov_b32 s78, 0x10000
    s_mov_b32 s75, 0x18000
    s_mov_b32 s79, 0x18000
    s_mov_b32 s80, 0x0
    s_mov_b32 s81, 0x1000
    s_mov_b32 s40, s22
    s_mov_b32 s41, s23
    s_mov_b32 s42, 0x400000
    s_mov_b32 s43, 0x20000
    s_waitcnt vmcnt(16)
    s_barrier
    s_setprio 2
    ds_read_b128 v[72:75], v232 offset:0
    ds_read_b64_tr_b16 v[88:89], v235 offset:0
    ds_read_b64_tr_b16 v[90:91], v235 offset:4096
    ds_read_b64_tr_b16 v[92:93], v236 offset:0
    ds_read_b64_tr_b16 v[94:95], v236 offset:4096
    ds_read_b128 v[76:79], v232 offset:2048
    ds_read_b64_tr_b16 v[96:97], v237 offset:0
    ds_read_b64_tr_b16 v[98:99], v237 offset:4096
    ds_read_b64_tr_b16 v[100:101], v238 offset:0
    ds_read_b64_tr_b16 v[102:103], v238 offset:4096
    ds_read_b128 v[80:83], v232 offset:4096
    ds_read_b128 v[84:87], v232 offset:6144
    s_and_b32 s57, s58, 15
    s_lshr_b64 s[58:59], s[58:59], 4
    s_add_u32 s57, s57, s55
    s_lshl_b32 s56, s57, 11
    s_mul_i32 s57, s57, 0x20000
    s_add_u32 m0, s53, 16384
    s_nop 0
    buffer_load_dwordx4 v194, s[32:35], s57 offen offset:0 lds
    buffer_load_dwordx4 v195, s[32:35], s57 offen offset:1024 lds
    buffer_load_dwordx4 v196, s[32:35], s57 offen offset:2048 lds
    buffer_load_dwordx4 v197, s[32:35], s57 offen offset:3072 lds
    s_mov_b32 m0, s53
    s_nop 0
    buffer_load_dwordx4 v192, s[28:31], s56 offen offset:0 lds
    buffer_load_dwordx4 v192, s[28:31], s56 offen offset:1024 lds
    buffer_load_dwordx4 v193, s[28:31], s56 offen offset:2048 lds
    buffer_load_dwordx4 v193, s[28:31], s56 offen offset:3072 lds
    s_add_u32 s53, s53, 32768
    s_cmp_ge_u32 s53, s61
    s_cselect_b32 s53, s60, s53
    s_add_u32 s52, s52, 32768
    s_cmp_ge_u32 s52, 163840
    s_cselect_b32 s52, 0, s52
    s_waitcnt lgkmcnt(0)
    v_mfma_f32_16x16x32_bf16 v[8:11], v[88:91], v[72:75], 0
    ds_read_b128 v[104:107], v232 offset:1024
    v_mfma_f32_16x16x32_bf16 v[12:15], v[92:95], v[72:75], 0
    ds_read_b64_tr_b16 v[120:121], v235 offset:8192
    v_mfma_f32_16x16x32_bf16 v[16:19], v[96:99], v[72:75], 0
    ds_read_b64_tr_b16 v[122:123], v235 offset:12288
    v_mfma_f32_16x16x32_bf16 v[20:23], v[100:103], v[72:75], 0
    ds_read_b64_tr_b16 v[124:125], v236 offset:8192
    v_mfma_f32_16x16x32_bf16 v[24:27], v[88:91], v[76:79], 0
    ds_read_b64_tr_b16 v[126:127], v236 offset:12288
    v_mfma_f32_16x16x32_bf16 v[28:31], v[92:95], v[76:79], 0
    ds_read_b128 v[108:111], v232 offset:3072
    v_mfma_f32_16x16x32_bf16 v[32:35], v[96:99], v[76:79], 0
    ds_read_b64_tr_b16 v[128:129], v237 offset:8192
    v_mfma_f32_16x16x32_bf16 v[36:39], v[100:103], v[76:79], 0
    ds_read_b64_tr_b16 v[130:131], v237 offset:12288
    v_mfma_f32_16x16x32_bf16 v[40:43], v[88:91], v[80:83], 0
    ds_read_b64_tr_b16 v[132:133], v238 offset:8192
    v_mfma_f32_16x16x32_bf16 v[44:47], v[92:95], v[80:83], 0
    ds_read_b64_tr_b16 v[134:135], v238 offset:12288
    v_mfma_f32_16x16x32_bf16 v[48:51], v[96:99], v[80:83], 0
    ds_read_b128 v[112:115], v232 offset:5120
    v_mfma_f32_16x16x32_bf16 v[52:55], v[100:103], v[80:83], 0
    ds_read_b128 v[116:119], v232 offset:7168
    v_mfma_f32_16x16x32_bf16 v[56:59], v[88:91], v[84:87], 0
    v_add_u32 v232, s52, v233
    v_add_u32 v235, s52, v239
    v_mfma_f32_16x16x32_bf16 v[60:63], v[92:95], v[84:87], 0
    v_add_u32 v236, s52, v240
    v_mfma_f32_16x16x32_bf16 v[64:67], v[96:99], v[84:87], 0
    v_add_u32 v237, s52, v241
    v_mfma_f32_16x16x32_bf16 v[68:71], v[100:103], v[84:87], 0
    v_add_u32 v238, s52, v242
    s_waitcnt lgkmcnt(0)
    v_mfma_f32_16x16x32_bf16 v[8:11], v[120:123], v[104:107], v[8:11]
    s_waitcnt vmcnt(16)
    s_barrier
    v_mfma_f32_16x16x32_bf16 v[12:15], v[124:127], v[104:107], v[12:15]
    ds_read_b128 v[72:75], v232 offset:0
    ds_read_b64_tr_b16 v[88:89], v235 offset:0
    v_mfma_f32_16x16x32_bf16 v[16:19], v[128:131], v[104:107], v[16:19]
    ds_read_b64_tr_b16 v[90:91], v235 offset:4096
    v_mfma_f32_16x16x32_bf16 v[20:23], v[132:135], v[104:107], v[20:23]
    ds_read_b64_tr_b16 v[92:93], v236 offset:0
    v_mfma_f32_16x16x32_bf16 v[24:27], v[120:123], v[108:111], v[24:27]
    ds_read_b64_tr_b16 v[94:95], v236 offset:4096
    v_mfma_f32_16x16x32_bf16 v[28:31], v[124:127], v[108:111], v[28:31]
    ds_read_b128 v[76:79], v232 offset:2048
    v_mfma_f32_16x16x32_bf16 v[32:35], v[128:131], v[108:111], v[32:35]
    ds_read_b64_tr_b16 v[96:97], v237 offset:0
    v_mfma_f32_16x16x32_bf16 v[36:39], v[132:135], v[108:111], v[36:39]
    ds_read_b64_tr_b16 v[98:99], v237 offset:4096
    v_mfma_f32_16x16x32_bf16 v[40:43], v[120:123], v[112:115], v[40:43]
    ds_read_b64_tr_b16 v[100:101], v238 offset:0
    v_mfma_f32_16x16x32_bf16 v[44:47], v[124:127], v[112:115], v[44:47]
    ds_read_b64_tr_b16 v[102:103], v238 offset:4096
    v_mfma_f32_16x16x32_bf16 v[48:51], v[128:131], v[112:115], v[48:51]
    ds_read_b128 v[80:83], v232 offset:4096
    v_mfma_f32_16x16x32_bf16 v[52:55], v[132:135], v[112:115], v[52:55]
    ds_read_b128 v[84:87], v232 offset:6144
    v_mfma_f32_16x16x32_bf16 v[56:59], v[120:123], v[116:119], v[56:59]
    v_mfma_f32_16x16x32_bf16 v[60:63], v[124:127], v[116:119], v[60:63]
    v_mfma_f32_16x16x32_bf16 v[64:67], v[128:131], v[116:119], v[64:67]
    s_add_u32 s52, s52, 32768
    s_cmp_ge_u32 s52, 163840
    s_cselect_b32 s52, 0, s52
    v_mfma_f32_16x16x32_bf16 v[68:71], v[132:135], v[116:119], v[68:71]
    s_waitcnt lgkmcnt(0)
    v_mfma_f32_16x16x32_bf16 v[8:11], v[88:91], v[72:75], v[8:11]
    ds_read_b128 v[104:107], v232 offset:1024
    v_mfma_f32_16x16x32_bf16 v[12:15], v[92:95], v[72:75], v[12:15]
    ds_read_b64_tr_b16 v[120:121], v235 offset:8192
    v_mfma_f32_16x16x32_bf16 v[16:19], v[96:99], v[72:75], v[16:19]
    ds_read_b64_tr_b16 v[122:123], v235 offset:12288
    v_mfma_f32_16x16x32_bf16 v[20:23], v[100:103], v[72:75], v[20:23]
    ds_read_b64_tr_b16 v[124:125], v236 offset:8192
    v_mfma_f32_16x16x32_bf16 v[24:27], v[88:91], v[76:79], v[24:27]
    ds_read_b64_tr_b16 v[126:127], v236 offset:12288
    v_mfma_f32_16x16x32_bf16 v[28:31], v[92:95], v[76:79], v[28:31]
    ds_read_b128 v[108:111], v232 offset:3072
    v_mfma_f32_16x16x32_bf16 v[32:35], v[96:99], v[76:79], v[32:35]
    ds_read_b64_tr_b16 v[128:129], v237 offset:8192
    v_mfma_f32_16x16x32_bf16 v[36:39], v[100:103], v[76:79], v[36:39]
    ds_read_b64_tr_b16 v[130:131], v237 offset:12288
    v_mfma_f32_16x16x32_bf16 v[40:43], v[88:91], v[80:83], v[40:43]
    ds_read_b64_tr_b16 v[132:133], v238 offset:8192
    v_mfma_f32_16x16x32_bf16 v[44:47], v[92:95], v[80:83], v[44:47]
    ds_read_b64_tr_b16 v[134:135], v238 offset:12288
    v_mfma_f32_16x16x32_bf16 v[48:51], v[96:99], v[80:83], v[48:51]
    ds_read_b128 v[112:115], v232 offset:5120
    v_mfma_f32_16x16x32_bf16 v[52:55], v[100:103], v[80:83], v[52:55]
    ds_read_b128 v[116:119], v232 offset:7168
    v_mfma_f32_16x16x32_bf16 v[56:59], v[88:91], v[84:87], v[56:59]
    v_add_u32 v232, s52, v233
    v_add_u32 v235, s52, v239
    v_mfma_f32_16x16x32_bf16 v[60:63], v[92:95], v[84:87], v[60:63]
    v_add_u32 v236, s52, v240
    v_mfma_f32_16x16x32_bf16 v[64:67], v[96:99], v[84:87], v[64:67]
    v_add_u32 v237, s52, v241
    v_mfma_f32_16x16x32_bf16 v[68:71], v[100:103], v[84:87], v[68:71]
    v_add_u32 v238, s52, v242
    s_waitcnt lgkmcnt(0)
    v_mfma_f32_16x16x32_bf16 v[8:11], v[120:123], v[104:107], v[8:11]
    s_waitcnt vmcnt(8)
    s_barrier
    v_mfma_f32_16x16x32_bf16 v[12:15], v[124:127], v[104:107], v[12:15]
    ds_read_b128 v[72:75], v232 offset:0
    ds_read_b64_tr_b16 v[88:89], v235 offset:0
    v_mfma_f32_16x16x32_bf16 v[16:19], v[128:131], v[104:107], v[16:19]
    ds_read_b64_tr_b16 v[90:91], v235 offset:4096
    v_mfma_f32_16x16x32_bf16 v[20:23], v[132:135], v[104:107], v[20:23]
    ds_read_b64_tr_b16 v[92:93], v236 offset:0
    v_mfma_f32_16x16x32_bf16 v[24:27], v[120:123], v[108:111], v[24:27]
    ds_read_b64_tr_b16 v[94:95], v236 offset:4096
    v_mfma_f32_16x16x32_bf16 v[28:31], v[124:127], v[108:111], v[28:31]
    ds_read_b128 v[76:79], v232 offset:2048
    v_mfma_f32_16x16x32_bf16 v[32:35], v[128:131], v[108:111], v[32:35]
    ds_read_b64_tr_b16 v[96:97], v237 offset:0
    v_mfma_f32_16x16x32_bf16 v[36:39], v[132:135], v[108:111], v[36:39]
    ds_read_b64_tr_b16 v[98:99], v237 offset:4096
    v_mfma_f32_16x16x32_bf16 v[40:43], v[120:123], v[112:115], v[40:43]
    ds_read_b64_tr_b16 v[100:101], v238 offset:0
    v_mfma_f32_16x16x32_bf16 v[44:47], v[124:127], v[112:115], v[44:47]
    ds_read_b64_tr_b16 v[102:103], v238 offset:4096
    v_mfma_f32_16x16x32_bf16 v[48:51], v[128:131], v[112:115], v[48:51]
    ds_read_b128 v[80:83], v232 offset:4096
    v_mfma_f32_16x16x32_bf16 v[52:55], v[132:135], v[112:115], v[52:55]
    ds_read_b128 v[84:87], v232 offset:6144
    v_mfma_f32_16x16x32_bf16 v[56:59], v[120:123], v[116:119], v[56:59]
    v_mfma_f32_16x16x32_bf16 v[60:63], v[124:127], v[116:119], v[60:63]
    v_mfma_f32_16x16x32_bf16 v[64:67], v[128:131], v[116:119], v[64:67]
    s_add_u32 s52, s52, 32768
    s_cmp_ge_u32 s52, 163840
    s_cselect_b32 s52, 0, s52
    v_mfma_f32_16x16x32_bf16 v[68:71], v[132:135], v[116:119], v[68:71]
    s_waitcnt lgkmcnt(0)
    v_mfma_f32_16x16x32_bf16 v[8:11], v[88:91], v[72:75], v[8:11]
    ds_read_b128 v[104:107], v232 offset:1024
    v_mfma_f32_16x16x32_bf16 v[12:15], v[92:95], v[72:75], v[12:15]
    ds_read_b64_tr_b16 v[120:121], v235 offset:8192
    v_mfma_f32_16x16x32_bf16 v[16:19], v[96:99], v[72:75], v[16:19]
    ds_read_b64_tr_b16 v[122:123], v235 offset:12288
    v_mfma_f32_16x16x32_bf16 v[20:23], v[100:103], v[72:75], v[20:23]
    ds_read_b64_tr_b16 v[124:125], v236 offset:8192
    v_mfma_f32_16x16x32_bf16 v[24:27], v[88:91], v[76:79], v[24:27]
    ds_read_b64_tr_b16 v[126:127], v236 offset:12288
    v_mfma_f32_16x16x32_bf16 v[28:31], v[92:95], v[76:79], v[28:31]
    ds_read_b128 v[108:111], v232 offset:3072
    v_mfma_f32_16x16x32_bf16 v[32:35], v[96:99], v[76:79], v[32:35]
    ds_read_b64_tr_b16 v[128:129], v237 offset:8192
    v_mfma_f32_16x16x32_bf16 v[36:39], v[100:103], v[76:79], v[36:39]
    ds_read_b64_tr_b16 v[130:131], v237 offset:12288
    v_mfma_f32_16x16x32_bf16 v[40:43], v[88:91], v[80:83], v[40:43]
    ds_read_b64_tr_b16 v[132:133], v238 offset:8192
    v_mfma_f32_16x16x32_bf16 v[44:47], v[92:95], v[80:83], v[44:47]
    ds_read_b64_tr_b16 v[134:135], v238 offset:12288
    v_mfma_f32_16x16x32_bf16 v[48:51], v[96:99], v[80:83], v[48:51]
    ds_read_b128 v[112:115], v232 offset:5120
    v_mfma_f32_16x16x32_bf16 v[52:55], v[100:103], v[80:83], v[52:55]
    ds_read_b128 v[116:119], v232 offset:7168
    v_mfma_f32_16x16x32_bf16 v[56:59], v[88:91], v[84:87], v[56:59]
    v_add_u32 v232, s52, v233
    v_add_u32 v235, s52, v239
    v_mfma_f32_16x16x32_bf16 v[60:63], v[92:95], v[84:87], v[60:63]
    v_add_u32 v236, s52, v240
    v_mfma_f32_16x16x32_bf16 v[64:67], v[96:99], v[84:87], v[64:67]
    v_add_u32 v237, s52, v241
    v_mfma_f32_16x16x32_bf16 v[68:71], v[100:103], v[84:87], v[68:71]
    v_add_u32 v238, s52, v242
    s_waitcnt lgkmcnt(0)
    v_mfma_f32_16x16x32_bf16 v[8:11], v[120:123], v[104:107], v[8:11]
    s_waitcnt vmcnt(0)
    s_barrier
    v_mfma_f32_16x16x32_bf16 v[12:15], v[124:127], v[104:107], v[12:15]
    ds_read_b128 v[72:75], v232 offset:0
    ds_read_b64_tr_b16 v[88:89], v235 offset:0
    v_mfma_f32_16x16x32_bf16 v[16:19], v[128:131], v[104:107], v[16:19]
    ds_read_b64_tr_b16 v[90:91], v235 offset:4096
    v_mfma_f32_16x16x32_bf16 v[20:23], v[132:135], v[104:107], v[20:23]
    ds_read_b64_tr_b16 v[92:93], v236 offset:0
    v_mfma_f32_16x16x32_bf16 v[24:27], v[120:123], v[108:111], v[24:27]
    ds_read_b64_tr_b16 v[94:95], v236 offset:4096
    v_mfma_f32_16x16x32_bf16 v[28:31], v[124:127], v[108:111], v[28:31]
    ds_read_b128 v[76:79], v232 offset:2048
    v_mfma_f32_16x16x32_bf16 v[32:35], v[128:131], v[108:111], v[32:35]
    ds_read_b64_tr_b16 v[96:97], v237 offset:0
    v_mfma_f32_16x16x32_bf16 v[36:39], v[132:135], v[108:111], v[36:39]
    ds_read_b64_tr_b16 v[98:99], v237 offset:4096
    v_mfma_f32_16x16x32_bf16 v[40:43], v[120:123], v[112:115], v[40:43]
    ds_read_b64_tr_b16 v[100:101], v238 offset:0
    v_mfma_f32_16x16x32_bf16 v[44:47], v[124:127], v[112:115], v[44:47]
    ds_read_b64_tr_b16 v[102:103], v238 offset:4096
    v_mfma_f32_16x16x32_bf16 v[48:51], v[128:131], v[112:115], v[48:51]
    ds_read_b128 v[80:83], v232 offset:4096
    v_mfma_f32_16x16x32_bf16 v[52:55], v[132:135], v[112:115], v[52:55]
    ds_read_b128 v[84:87], v232 offset:6144
    v_mfma_f32_16x16x32_bf16 v[56:59], v[120:123], v[116:119], v[56:59]
    v_mfma_f32_16x16x32_bf16 v[60:63], v[124:127], v[116:119], v[60:63]
    v_mfma_f32_16x16x32_bf16 v[64:67], v[128:131], v[116:119], v[64:67]
    s_add_u32 s52, s52, 32768
    s_cmp_ge_u32 s52, 163840
    s_cselect_b32 s52, 0, s52
    v_mfma_f32_16x16x32_bf16 v[68:71], v[132:135], v[116:119], v[68:71]
    s_waitcnt lgkmcnt(0)
    v_mfma_f32_16x16x32_bf16 v[8:11], v[88:91], v[72:75], v[8:11]
    ds_read_b128 v[104:107], v232 offset:1024
    v_mfma_f32_16x16x32_bf16 v[12:15], v[92:95], v[72:75], v[12:15]
    ds_read_b64_tr_b16 v[120:121], v235 offset:8192
    v_mfma_f32_16x16x32_bf16 v[16:19], v[96:99], v[72:75], v[16:19]
    ds_read_b64_tr_b16 v[122:123], v235 offset:12288
    v_mfma_f32_16x16x32_bf16 v[20:23], v[100:103], v[72:75], v[20:23]
    ds_read_b64_tr_b16 v[124:125], v236 offset:8192
    v_mfma_f32_16x16x32_bf16 v[24:27], v[88:91], v[76:79], v[24:27]
    ds_read_b64_tr_b16 v[126:127], v236 offset:12288
    v_mfma_f32_16x16x32_bf16 v[28:31], v[92:95], v[76:79], v[28:31]
    ds_read_b128 v[108:111], v232 offset:3072
    v_mfma_f32_16x16x32_bf16 v[32:35], v[96:99], v[76:79], v[32:35]
    ds_read_b64_tr_b16 v[128:129], v237 offset:8192
    v_mfma_f32_16x16x32_bf16 v[36:39], v[100:103], v[76:79], v[36:39]
    ds_read_b64_tr_b16 v[130:131], v237 offset:12288
    v_mfma_f32_16x16x32_bf16 v[40:43], v[88:91], v[80:83], v[40:43]
    s_add_u32 s54, s62, 16
mega_kernel_P_loop5:
    ds_read_b64_tr_b16 v[132:133], v238 offset:8192
    v_mfma_f32_16x16x32_bf16 v[44:47], v[92:95], v[80:83], v[44:47]
    ds_read_b64_tr_b16 v[134:135], v238 offset:12288
    v_mfma_f32_16x16x32_bf16 v[48:51], v[96:99], v[80:83], v[48:51]
    ds_read_b128 v[112:115], v232 offset:5120
    v_mfma_f32_16x16x32_bf16 v[52:55], v[100:103], v[80:83], v[52:55]
    ds_read_b128 v[116:119], v232 offset:7168
    v_mfma_f32_16x16x32_bf16 v[56:59], v[88:91], v[84:87], v[56:59]
    v_add_u32 v232, s52, v233
    v_add_u32 v235, s52, v239
    v_mfma_f32_16x16x32_bf16 v[60:63], v[92:95], v[84:87], v[60:63]
    v_add_u32 v236, s52, v240
    v_mfma_f32_16x16x32_bf16 v[64:67], v[96:99], v[84:87], v[64:67]
    v_add_u32 v237, s52, v241
    v_mfma_f32_16x16x32_bf16 v[68:71], v[100:103], v[84:87], v[68:71]
    v_add_u32 v238, s52, v242
    s_waitcnt lgkmcnt(0)
    v_mfma_f32_16x16x32_bf16 v[8:11], v[120:123], v[104:107], v[8:11]
    s_barrier
    v_mfma_f32_16x16x32_bf16 v[12:15], v[124:127], v[104:107], v[12:15]
    ds_read_b128 v[72:75], v232 offset:0
    ds_read_b64_tr_b16 v[88:89], v235 offset:0
    v_mfma_f32_16x16x32_bf16 v[16:19], v[128:131], v[104:107], v[16:19]
    ds_read_b64_tr_b16 v[90:91], v235 offset:4096
    v_mfma_f32_16x16x32_bf16 v[20:23], v[132:135], v[104:107], v[20:23]
    ds_read_b64_tr_b16 v[92:93], v236 offset:0
    v_mfma_f32_16x16x32_bf16 v[24:27], v[120:123], v[108:111], v[24:27]
    ds_read_b64_tr_b16 v[94:95], v236 offset:4096
    v_mfma_f32_16x16x32_bf16 v[28:31], v[124:127], v[108:111], v[28:31]
    ds_read_b128 v[76:79], v232 offset:2048
    v_mfma_f32_16x16x32_bf16 v[32:35], v[128:131], v[108:111], v[32:35]
    ds_read_b64_tr_b16 v[96:97], v237 offset:0
    v_mfma_f32_16x16x32_bf16 v[36:39], v[132:135], v[108:111], v[36:39]
    ds_read_b64_tr_b16 v[98:99], v237 offset:4096
    v_mfma_f32_16x16x32_bf16 v[40:43], v[120:123], v[112:115], v[40:43]
    ds_read_b64_tr_b16 v[100:101], v238 offset:0
    v_mfma_f32_16x16x32_bf16 v[44:47], v[124:127], v[112:115], v[44:47]
    ds_read_b64_tr_b16 v[102:103], v238 offset:4096
    v_mfma_f32_16x16x32_bf16 v[48:51], v[128:131], v[112:115], v[48:51]
    ds_read_b128 v[80:83], v232 offset:4096
    v_mfma_f32_16x16x32_bf16 v[52:55], v[132:135], v[112:115], v[52:55]
    ds_read_b128 v[84:87], v232 offset:6144
    v_mfma_f32_16x16x32_bf16 v[56:59], v[120:123], v[116:119], v[56:59]
    v_mfma_f32_16x16x32_bf16 v[60:63], v[124:127], v[116:119], v[60:63]
    v_mfma_f32_16x16x32_bf16 v[64:67], v[128:131], v[116:119], v[64:67]
    s_add_u32 s52, s52, 32768
    s_cmp_ge_u32 s52, 163840
    s_cselect_b32 s52, 0, s52
    v_mfma_f32_16x16x32_bf16 v[68:71], v[132:135], v[116:119], v[68:71]
    s_waitcnt lgkmcnt(0)
    v_mfma_f32_16x16x32_bf16 v[8:11], v[88:91], v[72:75], v[8:11]
    ds_read_b128 v[104:107], v232 offset:1024
    v_mfma_f32_16x16x32_bf16 v[12:15], v[92:95], v[72:75], v[12:15]
    ds_read_b64_tr_b16 v[120:121], v235 offset:8192
    v_mfma_f32_16x16x32_bf16 v[16:19], v[96:99], v[72:75], v[16:19]
    ds_read_b64_tr_b16 v[122:123], v235 offset:12288
    v_mfma_f32_16x16x32_bf16 v[20:23], v[100:103], v[72:75], v[20:23]
    ds_read_b64_tr_b16 v[124:125], v236 offset:8192
    v_mfma_f32_16x16x32_bf16 v[24:27], v[88:91], v[76:79], v[24:27]
    ds_read_b64_tr_b16 v[126:127], v236 offset:12288
    v_mfma_f32_16x16x32_bf16 v[28:31], v[92:95], v[76:79], v[28:31]
    ds_read_b128 v[108:111], v232 offset:3072
    v_mfma_f32_16x16x32_bf16 v[32:35], v[96:99], v[76:79], v[32:35]
    ds_read_b64_tr_b16 v[128:129], v237 offset:8192
    v_mfma_f32_16x16x32_bf16 v[36:39], v[100:103], v[76:79], v[36:39]
    s_sub_u32 s54, s54, 1
    ds_read_b64_tr_b16 v[130:131], v237 offset:12288
    v_mfma_f32_16x16x32_bf16 v[40:43], v[88:91], v[80:83], v[40:43]
    s_cbranch_scc0 mega_kernel_P_loop5
    ds_read_b64_tr_b16 v[132:133], v238 offset:8192
    v_mfma_f32_16x16x32_bf16 v[44:47], v[92:95], v[80:83], v[44:47]
    ds_read_b64_tr_b16 v[134:135], v238 offset:12288
    v_mfma_f32_16x16x32_bf16 v[48:51], v[96:99], v[80:83], v[48:51]
    ds_read_b128 v[112:115], v232 offset:5120
    v_mfma_f32_16x16x32_bf16 v[52:55], v[100:103], v[80:83], v[52:55]
    ds_read_b128 v[116:119], v232 offset:7168
    v_mfma_f32_16x16x32_bf16 v[56:59], v[88:91], v[84:87], v[56:59]
    v_add_u32 v232, s52, v233
    v_add_u32 v235, s52, v239
    v_mfma_f32_16x16x32_bf16 v[60:63], v[92:95], v[84:87], v[60:63]
    v_add_u32 v236, s52, v240
    v_mfma_f32_16x16x32_bf16 v[64:67], v[96:99], v[84:87], v[64:67]
    v_add_u32 v237, s52, v241
    v_mfma_f32_16x16x32_bf16 v[68:71], v[100:103], v[84:87], v[68:71]
    v_add_u32 v238, s52, v242
    s_waitcnt lgkmcnt(0)
    v_mfma_f32_16x16x32_bf16 v[8:11], v[120:123], v[104:107], v[8:11]
    s_barrier
    v_mfma_f32_16x16x32_bf16 v[12:15], v[124:127], v[104:107], v[12:15]
    ds_read_b128 v[72:75], v232 offset:0
    ds_read_b64_tr_b16 v[88:89], v235 offset:0
    v_mfma_f32_16x16x32_bf16 v[16:19], v[128:131], v[104:107], v[16:19]
    ds_read_b64_tr_b16 v[90:91], v235 offset:4096
    v_mfma_f32_16x16x32_bf16 v[20:23], v[132:135], v[104:107], v[20:23]
    ds_read_b64_tr_b16 v[92:93], v236 offset:0
    v_mfma_f32_16x16x32_bf16 v[24:27], v[120:123], v[108:111], v[24:27]
    ds_read_b64_tr_b16 v[94:95], v236 offset:4096
    v_mfma_f32_16x16x32_bf16 v[28:31], v[124:127], v[108:111], v[28:31]
    ds_read_b128 v[76:79], v232 offset:2048
    v_mfma_f32_16x16x32_bf16 v[32:35], v[128:131], v[108:111], v[32:35]
    ds_read_b64_tr_b16 v[96:97], v237 offset:0
    v_mfma_f32_16x16x32_bf16 v[36:39], v[132:135], v[108:111], v[36:39]
    ds_read_b64_tr_b16 v[98:99], v237 offset:4096
    v_mfma_f32_16x16x32_bf16 v[40:43], v[120:123], v[112:115], v[40:43]
    ds_read_b64_tr_b16 v[100:101], v238 offset:0
    v_mfma_f32_16x16x32_bf16 v[44:47], v[124:127], v[112:115], v[44:47]
    ds_read_b64_tr_b16 v[102:103], v238 offset:4096
    v_mfma_f32_16x16x32_bf16 v[48:51], v[128:131], v[112:115], v[48:51]
    ds_read_b128 v[80:83], v232 offset:4096
    v_mfma_f32_16x16x32_bf16 v[52:55], v[132:135], v[112:115], v[52:55]
    ds_read_b128 v[84:87], v232 offset:6144
    v_mfma_f32_16x16x32_bf16 v[56:59], v[120:123], v[116:119], v[56:59]
    v_mfma_f32_16x16x32_bf16 v[60:63], v[124:127], v[116:119], v[60:63]
    v_mfma_f32_16x16x32_bf16 v[64:67], v[128:131], v[116:119], v[64:67]
    s_add_u32 s52, s52, 32768
    s_cmp_ge_u32 s52, 163840
    s_cselect_b32 s52, 0, s52
    v_mfma_f32_16x16x32_bf16 v[68:71], v[132:135], v[116:119], v[68:71]
    s_waitcnt lgkmcnt(0)
    v_mfma_f32_16x16x32_bf16 v[8:11], v[88:91], v[72:75], v[8:11]
    ds_read_b128 v[104:107], v232 offset:1024
    v_mfma_f32_16x16x32_bf16 v[12:15], v[92:95], v[72:75], v[12:15]
    ds_read_b64_tr_b16 v[120:121], v235 offset:8192
    buffer_load_dwordx4 v[136:139], v188, s[28:31], s76 offen offset:0
    v_mfma_f32_16x16x32_bf16 v[16:19], v[96:99], v[72:75], v[16:19]
    ds_read_b64_tr_b16 v[122:123], v235 offset:12288
    v_mfma_f32_16x16x32_bf16 v[20:23], v[100:103], v[72:75], v[20:23]
    ds_read_b64_tr_b16 v[124:125], v236 offset:8192
    v_mfma_f32_16x16x32_bf16 v[24:27], v[88:91], v[76:79], v[24:27]
    ds_read_b64_tr_b16 v[126:127], v236 offset:12288
    v_mfma_f32_16x16x32_bf16 v[28:31], v[92:95], v[76:79], v[28:31]
    ds_read_b128 v[108:111], v232 offset:3072
    v_mfma_f32_16x16x32_bf16 v[32:35], v[96:99], v[76:79], v[32:35]
    ds_read_b64_tr_b16 v[128:129], v237 offset:8192
    buffer_load_dwordx4 v[140:143], v188, s[28:31], s76 offen offset:1024
    v_mfma_f32_16x16x32_bf16 v[36:39], v[100:103], v[76:79], v[36:39]
    ds_read_b64_tr_b16 v[130:131], v237 offset:12288
    v_mfma_f32_16x16x32_bf16 v[40:43], v[88:91], v[80:83], v[40:43]
    ds_read_b64_tr_b16 v[132:133], v238 offset:8192
    v_mfma_f32_16x16x32_bf16 v[44:47], v[92:95], v[80:83], v[44:47]
    ds_read_b64_tr_b16 v[134:135], v238 offset:12288
    v_mfma_f32_16x16x32_bf16 v[48:51], v[96:99], v[80:83], v[48:51]
    ds_read_b128 v[112:115], v232 offset:5120
    v_mfma_f32_16x16x32_bf16 v[52:55], v[100:103], v[80:83], v[52:55]
    ds_read_b128 v[116:119], v232 offset:7168
    buffer_load_dwordx4 v[144:147], v188, s[28:31], s77 offen offset:0
    v_mfma_f32_16x16x32_bf16 v[56:59], v[88:91], v[84:87], v[56:59]
    v_add_u32 v232, s52, v233
    v_add_u32 v235, s52, v239
    v_mfma_f32_16x16x32_bf16 v[60:63], v[92:95], v[84:87], v[60:63]
    v_add_u32 v236, s52, v240
    v_mfma_f32_16x16x32_bf16 v[64:67], v[96:99], v[84:87], v[64:67]
    v_add_u32 v237, s52, v241
    v_mfma_f32_16x16x32_bf16 v[68:71], v[100:103], v[84:87], v[68:71]
    v_add_u32 v238, s52, v242
    s_waitcnt lgkmcnt(0)
    v_mfma_f32_16x16x32_bf16 v[8:11], v[120:123], v[104:107], v[8:11]
    s_barrier
    v_mfma_f32_16x16x32_bf16 v[12:15], v[124:127], v[104:107], v[12:15]
    ds_read_b128 v[72:75], v232 offset:0
    ds_read_b64_tr_b16 v[88:89], v235 offset:0
    buffer_load_dwordx4 v[148:151], v188, s[28:31], s77 offen offset:1024
    v_mfma_f32_16x16x32_bf16 v[16:19], v[128:131], v[104:107], v[16:19]
    ds_read_b64_tr_b16 v[90:91], v235 offset:4096
    v_mfma_f32_16x16x32_bf16 v[20:23], v[132:135], v[104:107], v[20:23]
    ds_read_b64_tr_b16 v[92:93], v236 offset:0
    v_mfma_f32_16x16x32_bf16 v[24:27], v[120:123], v[108:111], v[24:27]
    ds_read_b64_tr_b16 v[94:95], v236 offset:4096
    v_mfma_f32_16x16x32_bf16 v[28:31], v[124:127], v[108:111], v[28:31]
    ds_read_b128 v[76:79], v232 offset:2048
    v_mfma_f32_16x16x32_bf16 v[32:35], v[128:131], v[108:111], v[32:35]
    ds_read_b64_tr_b16 v[96:97], v237 offset:0
    buffer_load_dwordx4 v[152:155], v188, s[28:31], s78 offen offset:0
    v_mfma_f32_16x16x32_bf16 v[36:39], v[132:135], v[108:111], v[36:39]
    ds_read_b64_tr_b16 v[98:99], v237 offset:4096
    v_mfma_f32_16x16x32_bf16 v[40:43], v[120:123], v[112:115], v[40:43]
    ds_read_b64_tr_b16 v[100:101], v238 offset:0
    v_mfma_f32_16x16x32_bf16 v[44:47], v[124:127], v[112:115], v[44:47]
    ds_read_b64_tr_b16 v[102:103], v238 offset:4096
    v_mfma_f32_16x16x32_bf16 v[48:51], v[128:131], v[112:115], v[48:51]
    ds_read_b128 v[80:83], v232 offset:4096
    v_mfma_f32_16x16x32_bf16 v[52:55], v[132:135], v[112:115], v[52:55]
    ds_read_b128 v[84:87], v232 offset:6144
    buffer_load_dwordx4 v[156:159], v188, s[28:31], s78 offen offset:1024
    v_mfma_f32_16x16x32_bf16 v[56:59], v[120:123], v[116:119], v[56:59]
    v_mfma_f32_16x16x32_bf16 v[60:63], v[124:127], v[116:119], v[60:63]
    v_mfma_f32_16x16x32_bf16 v[64:67], v[128:131], v[116:119], v[64:67]
    s_add_u32 s52, s52, 32768
    s_cmp_ge_u32 s52, 163840
    s_cselect_b32 s52, 0, s52
    v_mfma_f32_16x16x32_bf16 v[68:71], v[132:135], v[116:119], v[68:71]
    s_waitcnt lgkmcnt(0)
    v_mfma_f32_16x16x32_bf16 v[8:11], v[88:91], v[72:75], v[8:11]
    ds_read_b128 v[104:107], v232 offset:1024
    v_mfma_f32_16x16x32_bf16 v[12:15], v[92:95], v[72:75], v[12:15]
    ds_read_b64_tr_b16 v[120:121], v235 offset:8192
    buffer_load_dwordx4 v[160:163], v188, s[28:31], s79 offen offset:0
    v_mfma_f32_16x16x32_bf16 v[16:19], v[96:99], v[72:75], v[16:19]
    ds_read_b64_tr_b16 v[122:123], v235 offset:12288
    v_mfma_f32_16x16x32_bf16 v[20:23], v[100:103], v[72:75], v[20:23]
    ds_read_b64_tr_b16 v[124:125], v236 offset:8192
    v_mfma_f32_16x16x32_bf16 v[24:27], v[88:91], v[76:79], v[24:27]
    ds_read_b64_tr_b16 v[126:127], v236 offset:12288
    v_mfma_f32_16x16x32_bf16 v[28:31], v[92:95], v[76:79], v[28:31]
    ds_read_b128 v[108:111], v232 offset:3072
    v_mfma_f32_16x16x32_bf16 v[32:35], v[96:99], v[76:79], v[32:35]
    ds_read_b64_tr_b16 v[128:129], v237 offset:8192
    buffer_load_dwordx4 v[164:167], v188, s[28:31], s79 offen offset:1024
    v_mfma_f32_16x16x32_bf16 v[36:39], v[100:103], v[76:79], v[36:39]
    ds_read_b64_tr_b16 v[130:131], v237 offset:12288
    v_mfma_f32_16x16x32_bf16 v[40:43], v[88:91], v[80:83], v[40:43]
    ds_read_b64_tr_b16 v[132:133], v238 offset:8192
    v_mfma_f32_16x16x32_bf16 v[44:47], v[92:95], v[80:83], v[44:47]
    ds_read_b64_tr_b16 v[134:135], v238 offset:12288
    v_mfma_f32_16x16x32_bf16 v[48:51], v[96:99], v[80:83], v[48:51]
    ds_read_b128 v[112:115], v232 offset:5120
    v_mfma_f32_16x16x32_bf16 v[52:55], v[100:103], v[80:83], v[52:55]
    ds_read_b128 v[116:119], v232 offset:7168
    buffer_load_dwordx4 v[168:171], v185, s[28:31], 0 offen offset:0
    v_mfma_f32_16x16x32_bf16 v[56:59], v[88:91], v[84:87], v[56:59]
    v_add_u32 v232, s52, v233
    v_add_u32 v235, s52, v239
    v_mfma_f32_16x16x32_bf16 v[60:63], v[92:95], v[84:87], v[60:63]
    v_add_u32 v236, s52, v240
    v_mfma_f32_16x16x32_bf16 v[64:67], v[96:99], v[84:87], v[64:67]
    v_add_u32 v237, s52, v241
    v_mfma_f32_16x16x32_bf16 v[68:71], v[100:103], v[84:87], v[68:71]
    v_add_u32 v238, s52, v242
    s_waitcnt lgkmcnt(0)
    v_mfma_f32_16x16x32_bf16 v[8:11], v[120:123], v[104:107], v[8:11]
    s_barrier
    v_mfma_f32_16x16x32_bf16 v[12:15], v[124:127], v[104:107], v[12:15]
    ds_read_b128 v[72:75], v232 offset:0
    ds_read_b64_tr_b16 v[88:89], v235 offset:0
    buffer_load_dwordx4 v[172:175], v185, s[28:31], 0 offen offset:64
    v_mfma_f32_16x16x32_bf16 v[16:19], v[128:131], v[104:107], v[16:19]
    ds_read_b64_tr_b16 v[90:91], v235 offset:4096
    v_mfma_f32_16x16x32_bf16 v[20:23], v[132:135], v[104:107], v[20:23]
    ds_read_b64_tr_b16 v[92:93], v236 offset:0
    v_mfma_f32_16x16x32_bf16 v[24:27], v[120:123], v[108:111], v[24:27]
    ds_read_b64_tr_b16 v[94:95], v236 offset:4096
    v_mfma_f32_16x16x32_bf16 v[28:31], v[124:127], v[108:111], v[28:31]
    ds_read_b128 v[76:79], v232 offset:2048
    v_mfma_f32_16x16x32_bf16 v[32:35], v[128:131], v[108:111], v[32:35]
    ds_read_b64_tr_b16 v[96:97], v237 offset:0
    buffer_load_dwordx4 v[176:179], v185, s[28:31], 0 offen offset:128
    v_mfma_f32_16x16x32_bf16 v[36:39], v[132:135], v[108:111], v[36:39]
    ds_read_b64_tr_b16 v[98:99], v237 offset:4096
    v_mfma_f32_16x16x32_bf16 v[40:43], v[120:123], v[112:115], v[40:43]
    ds_read_b64_tr_b16 v[100:101], v238 offset:0
    v_mfma_f32_16x16x32_bf16 v[44:47], v[124:127], v[112:115], v[44:47]
    ds_read_b64_tr_b16 v[102:103], v238 offset:4096
    v_mfma_f32_16x16x32_bf16 v[48:51], v[128:131], v[112:115], v[48:51]
    ds_read_b128 v[80:83], v232 offset:4096
    v_mfma_f32_16x16x32_bf16 v[52:55], v[132:135], v[112:115], v[52:55]
    ds_read_b128 v[84:87], v232 offset:6144
    buffer_load_dwordx4 v[180:183], v185, s[28:31], 0 offen offset:192
    v_mfma_f32_16x16x32_bf16 v[56:59], v[120:123], v[116:119], v[56:59]
    v_mfma_f32_16x16x32_bf16 v[60:63], v[124:127], v[116:119], v[60:63]
    v_mfma_f32_16x16x32_bf16 v[64:67], v[128:131], v[116:119], v[64:67]
    s_add_u32 s52, s52, 32768
    s_cmp_ge_u32 s52, 163840
    s_cselect_b32 s52, 0, s52
    v_mfma_f32_16x16x32_bf16 v[68:71], v[132:135], v[116:119], v[68:71]
    s_waitcnt lgkmcnt(0)
    v_mfma_f32_16x16x32_bf16 v[8:11], v[88:91], v[72:75], v[8:11]
    ds_read_b128 v[104:107], v232 offset:1024
    v_mfma_f32_16x16x32_bf16 v[12:15], v[92:95], v[72:75], v[12:15]
    ds_read_b64_tr_b16 v[120:121], v235 offset:8192
    buffer_load_dword v245, v187, s[28:31], 0 offen sc1
    v_mfma_f32_16x16x32_bf16 v[16:19], v[96:99], v[72:75], v[16:19]
    ds_read_b64_tr_b16 v[122:123], v235 offset:12288
    v_mfma_f32_16x16x32_bf16 v[20:23], v[100:103], v[72:75], v[20:23]
    ds_read_b64_tr_b16 v[124:125], v236 offset:8192
    v_mfma_f32_16x16x32_bf16 v[24:27], v[88:91], v[76:79], v[24:27]
    ds_read_b64_tr_b16 v[126:127], v236 offset:12288
    v_mfma_f32_16x16x32_bf16 v[28:31], v[92:95], v[76:79], v[28:31]
    ds_read_b128 v[108:111], v232 offset:3072
    v_mfma_f32_16x16x32_bf16 v[32:35], v[96:99], v[76:79], v[32:35]
    ds_read_b64_tr_b16 v[128:129], v237 offset:8192
    v_mfma_f32_16x16x32_bf16 v[36:39], v[100:103], v[76:79], v[36:39]
    ds_read_b64_tr_b16 v[130:131], v237 offset:12288
    v_mfma_f32_16x16x32_bf16 v[40:43], v[88:91], v[80:83], v[40:43]
    ds_read_b64_tr_b16 v[132:133], v238 offset:8192
    v_mfma_f32_16x16x32_bf16 v[44:47], v[92:95], v[80:83], v[44:47]
    ds_read_b64_tr_b16 v[134:135], v238 offset:12288
    v_mfma_f32_16x16x32_bf16 v[48:51], v[96:99], v[80:83], v[48:51]
    ds_read_b128 v[112:115], v232 offset:5120
    v_mfma_f32_16x16x32_bf16 v[52:55], v[100:103], v[80:83], v[52:55]
    ds_read_b128 v[116:119], v232 offset:7168
    v_mfma_f32_16x16x32_bf16 v[56:59], v[88:91], v[84:87], v[56:59]
    v_mfma_f32_16x16x32_bf16 v[60:63], v[92:95], v[84:87], v[60:63]
    v_mfma_f32_16x16x32_bf16 v[64:67], v[96:99], v[84:87], v[64:67]
    v_mfma_f32_16x16x32_bf16 v[68:71], v[100:103], v[84:87], v[68:71]
    s_waitcnt lgkmcnt(0)
    v_mfma_f32_16x16x32_bf16 v[8:11], v[120:123], v[104:107], v[8:11]
    v_mfma_f32_16x16x32_bf16 v[12:15], v[124:127], v[104:107], v[12:15]
    v_mfma_f32_16x16x32_bf16 v[16:19], v[128:131], v[104:107], v[16:19]
    v_mfma_f32_16x16x32_bf16 v[20:23], v[132:135], v[104:107], v[20:23]
    v_mfma_f32_16x16x32_bf16 v[24:27], v[120:123], v[108:111], v[24:27]
    v_mfma_f32_16x16x32_bf16 v[28:31], v[124:127], v[108:111], v[28:31]
    v_mfma_f32_16x16x32_bf16 v[32:35], v[128:131], v[108:111], v[32:35]
    v_mfma_f32_16x16x32_bf16 v[36:39], v[132:135], v[108:111], v[36:39]
    v_mfma_f32_16x16x32_bf16 v[40:43], v[120:123], v[112:115], v[40:43]
    v_mfma_f32_16x16x32_bf16 v[44:47], v[124:127], v[112:115], v[44:47]
    v_mfma_f32_16x16x32_bf16 v[48:51], v[128:131], v[112:115], v[48:51]
    v_mfma_f32_16x16x32_bf16 v[52:55], v[132:135], v[112:115], v[52:55]
    v_mfma_f32_16x16x32_bf16 v[56:59], v[120:123], v[116:119], v[56:59]
    v_mfma_f32_16x16x32_bf16 v[60:63], v[124:127], v[116:119], v[60:63]
    v_mfma_f32_16x16x32_bf16 v[64:67], v[128:131], v[116:119], v[64:67]
    v_mfma_f32_16x16x32_bf16 v[68:71], v[132:135], v[116:119], v[68:71]
    s_mov_b32 s3, 0x40000
    s_cmp_lg_u32 s49, 0
    s_cbranch_scc1 mega_kernel_A
    v_cvt_pk_bf16_f32 v72, v8, v9
    v_cvt_pk_bf16_f32 v73, v10, v11
    v_cvt_pk_bf16_f32 v74, v12, v13
    v_cvt_pk_bf16_f32 v75, v14, v15
    buffer_store_dwordx4 v[72:75], v186, s[28:31], s80 offen offset:0 sc1
    v_cvt_pk_bf16_f32 v76, v16, v17
    v_cvt_pk_bf16_f32 v77, v18, v19
    v_cvt_pk_bf16_f32 v78, v20, v21
    v_cvt_pk_bf16_f32 v79, v22, v23
    buffer_store_dwordx4 v[76:79], v186, s[28:31], s80 offen offset:1024 sc1
    v_cvt_pk_bf16_f32 v80, v24, v25
    v_cvt_pk_bf16_f32 v81, v26, v27
    v_cvt_pk_bf16_f32 v82, v28, v29
    v_cvt_pk_bf16_f32 v83, v30, v31
    buffer_store_dwordx4 v[80:83], v186, s[28:31], s80 offen offset:2048 sc1
    v_cvt_pk_bf16_f32 v84, v32, v33
    v_cvt_pk_bf16_f32 v85, v34, v35
    v_cvt_pk_bf16_f32 v86, v36, v37
    v_cvt_pk_bf16_f32 v87, v38, v39
    buffer_store_dwordx4 v[84:87], v186, s[28:31], s80 offen offset:3072 sc1
    v_cvt_pk_bf16_f32 v88, v40, v41
    v_cvt_pk_bf16_f32 v89, v42, v43
    v_cvt_pk_bf16_f32 v90, v44, v45
    v_cvt_pk_bf16_f32 v91, v46, v47
    buffer_store_dwordx4 v[88:91], v186, s[28:31], s81 offen offset:0 sc1
    v_cvt_pk_bf16_f32 v92, v48, v49
    v_cvt_pk_bf16_f32 v93, v50, v51
    v_cvt_pk_bf16_f32 v94, v52, v53
    v_cvt_pk_bf16_f32 v95, v54, v55
    buffer_store_dwordx4 v[92:95], v186, s[28:31], s81 offen offset:1024 sc1
    v_cvt_pk_bf16_f32 v96, v56, v57
    v_cvt_pk_bf16_f32 v97, v58, v59
    v_cvt_pk_bf16_f32 v98, v60, v61
    v_cvt_pk_bf16_f32 v99, v62, v63
    buffer_store_dwordx4 v[96:99], v186, s[28:31], s81 offen offset:2048 sc1
    v_cvt_pk_bf16_f32 v100, v64, v65
    v_cvt_pk_bf16_f32 v101, v66, v67
    v_cvt_pk_bf16_f32 v102, v68, v69
    v_cvt_pk_bf16_f32 v103, v70, v71
    buffer_store_dwordx4 v[100:103], v186, s[28:31], s81 offen offset:3072 sc1
    v_mov_b32 v2, 1
    s_waitcnt vmcnt(0)
    s_mov_b64 exec, 1
    buffer_store_dword v2, v187, s[28:31], 0 offen sc1
    s_branch mega_kernel_fin
mega_kernel_poll:
    s_sub_u32 s3, s3, 1
    s_cbranch_scc1 mega_kernel_got
    s_sleep 1
    buffer_load_dword v245, v187, s[28:31], 0 offen sc1
mega_kernel_A:
    s_waitcnt vmcnt(0)
    v_readfirstlane_b32 s64, v245
    s_nop 3
    s_cmp_lg_u32 s64, 1
    s_cbranch_scc1 mega_kernel_poll
mega_kernel_got:
    s_nop 7
    buffer_load_dwordx4 v[72:75], v186, s[28:31], s80 offen offset:0 sc1
    buffer_load_dwordx4 v[76:79], v186, s[28:31], s80 offen offset:1024 sc1
    buffer_load_dwordx4 v[80:83], v186, s[28:31], s80 offen offset:2048 sc1
    buffer_load_dwordx4 v[84:87], v186, s[28:31], s80 offen offset:3072 sc1
    buffer_load_dwordx4 v[88:91], v186, s[28:31], s81 offen offset:0 sc1
    buffer_load_dwordx4 v[92:95], v186, s[28:31], s81 offen offset:1024 sc1
    buffer_load_dwordx4 v[96:99], v186, s[28:31], s81 offen offset:2048 sc1
    buffer_load_dwordx4 v[100:103], v186, s[28:31], s81 offen offset:3072 sc1
    v_lshlrev_b32 v200, 16, v136
    v_and_b32 v201, 0xffff0000, v136
    v_lshlrev_b32 v202, 16, v137
    v_and_b32 v203, 0xffff0000, v137
    v_lshlrev_b32 v204, 16, v138
    v_and_b32 v205, 0xffff0000, v138
    v_lshlrev_b32 v206, 16, v139
    v_and_b32 v207, 0xffff0000, v139
    s_waitcnt vmcnt(7)
    v_lshlrev_b32 v104, 16, v72
    v_and_b32 v105, 0xffff0000, v72
    v_lshlrev_b32 v106, 16, v73
    v_and_b32 v107, 0xffff0000, v73
    v_lshlrev_b32 v108, 16, v74
    v_and_b32 v109, 0xffff0000, v74
    v_lshlrev_b32 v110, 16, v75
    v_and_b32 v111, 0xffff0000, v75
    v_pk_add_f32 v[8:9], v[8:9], v[104:105]
    v_pk_add_f32 v[10:11], v[10:11], v[106:107]
    v_pk_add_f32 v[12:13], v[12:13], v[108:109]
    v_pk_add_f32 v[14:15], v[14:15], v[110:111]
    v_pk_fma_f32 v[200:201], v[8:9], v[168:169], v[200:201]
    v_pk_fma_f32 v[202:203], v[10:11], v[170:171], v[202:203]
    v_pk_fma_f32 v[204:205], v[12:13], v[172:173], v[204:205]
    v_pk_fma_f32 v[206:207], v[14:15], v[174:175], v[206:207]
    v_cvt_pk_bf16_f32 v136, v200, v201
    v_cvt_pk_bf16_f32 v137, v202, v203
    v_cvt_pk_bf16_f32 v138, v204, v205
    v_cvt_pk_bf16_f32 v139, v206, v207
    s_nop 0
    v_permlane16_swap_b32 v136, v138
    v_permlane16_swap_b32 v137, v139
    buffer_store_dwordx4 v[136:139], v184, s[40:43], s72 offen offset:0
    v_lshlrev_b32 v208, 16, v140
    v_and_b32 v209, 0xffff0000, v140
    v_lshlrev_b32 v210, 16, v141
    v_and_b32 v211, 0xffff0000, v141
    v_lshlrev_b32 v212, 16, v142
    v_and_b32 v213, 0xffff0000, v142
    v_lshlrev_b32 v214, 16, v143
    v_and_b32 v215, 0xffff0000, v143
    s_waitcnt vmcnt(7)
    v_lshlrev_b32 v112, 16, v76
    v_and_b32 v113, 0xffff0000, v76
    v_lshlrev_b32 v114, 16, v77
    v_and_b32 v115, 0xffff0000, v77
    v_lshlrev_b32 v116, 16, v78
    v_and_b32 v117, 0xffff0000, v78
    v_lshlrev_b32 v118, 16, v79
    v_and_b32 v119, 0xffff0000, v79
    v_pk_add_f32 v[16:17], v[16:17], v[112:113]
    v_pk_add_f32 v[18:19], v[18:19], v[114:115]
    v_pk_add_f32 v[20:21], v[20:21], v[116:117]
    v_pk_add_f32 v[22:23], v[22:23], v[118:119]
    v_pk_fma_f32 v[208:209], v[16:17], v[176:177], v[208:209]
    v_pk_fma_f32 v[210:211], v[18:19], v[178:179], v[210:211]
    v_pk_fma_f32 v[212:213], v[20:21], v[180:181], v[212:213]
    v_pk_fma_f32 v[214:215], v[22:23], v[182:183], v[214:215]
    v_cvt_pk_bf16_f32 v140, v208, v209
    v_cvt_pk_bf16_f32 v141, v210, v211
    v_cvt_pk_bf16_f32 v142, v212, v213
    v_cvt_pk_bf16_f32 v143, v214, v215
    s_nop 0
    v_permlane16_swap_b32 v140, v142
    v_permlane16_swap_b32 v141, v143
    buffer_store_dwordx4 v[140:143], v184, s[40:43], s72 offen offset:64
    v_lshlrev_b32 v200, 16, v144
    v_and_b32 v201, 0xffff0000, v144
    v_lshlrev_b32 v202, 16, v145
    v_and_b32 v203, 0xffff0000, v145
    v_lshlrev_b32 v204, 16, v146
    v_and_b32 v205, 0xffff0000, v146
    v_lshlrev_b32 v206, 16, v147
    v_and_b32 v207, 0xffff0000, v147
    s_waitcnt vmcnt(7)
    v_lshlrev_b32 v120, 16, v80
    v_and_b32 v121, 0xffff0000, v80
    v_lshlrev_b32 v122, 16, v81
    v_and_b32 v123, 0xffff0000, v81
    v_lshlrev_b32 v124, 16, v82
    v_and_b32 v125, 0xffff0000, v82
    v_lshlrev_b32 v126, 16, v83
    v_and_b32 v127, 0xffff0000, v83
    v_pk_add_f32 v[24:25], v[24:25], v[120:121]
    v_pk_add_f32 v[26:27], v[26:27], v[122:123]
    v_pk_add_f32 v[28:29], v[28:29], v[124:125]
    v_pk_add_f32 v[30:31], v[30:31], v[126:127]
    v_pk_fma_f32 v[200:201], v[24:25], v[168:169], v[200:201]
    v_pk_fma_f32 v[202:203], v[26:27], v[170:171], v[202:203]
    v_pk_fma_f32 v[204:205], v[28:29], v[172:173], v[204:205]
    v_pk_fma_f32 v[206:207], v[30:31], v[174:175], v[206:207]
    v_cvt_pk_bf16_f32 v144, v200, v201
    v_cvt_pk_bf16_f32 v145, v202, v203
    v_cvt_pk_bf16_f32 v146, v204, v205
    v_cvt_pk_bf16_f32 v147, v206, v207
    s_nop 0
    v_permlane16_swap_b32 v144, v146
    v_permlane16_swap_b32 v145, v147
    buffer_store_dwordx4 v[144:147], v184, s[40:43], s73 offen offset:0
    v_lshlrev_b32 v208, 16, v148
    v_and_b32 v209, 0xffff0000, v148
    v_lshlrev_b32 v210, 16, v149
    v_and_b32 v211, 0xffff0000, v149
    v_lshlrev_b32 v212, 16, v150
    v_and_b32 v213, 0xffff0000, v150
    v_lshlrev_b32 v214, 16, v151
    v_and_b32 v215, 0xffff0000, v151
    s_waitcnt vmcnt(7)
    v_lshlrev_b32 v128, 16, v84
    v_and_b32 v129, 0xffff0000, v84
    v_lshlrev_b32 v130, 16, v85
    v_and_b32 v131, 0xffff0000, v85
    v_lshlrev_b32 v132, 16, v86
    v_and_b32 v133, 0xffff0000, v86
    v_lshlrev_b32 v134, 16, v87
    v_and_b32 v135, 0xffff0000, v87
    v_pk_add_f32 v[32:33], v[32:33], v[128:129]
    v_pk_add_f32 v[34:35], v[34:35], v[130:131]
    v_pk_add_f32 v[36:37], v[36:37], v[132:133]
    v_pk_add_f32 v[38:39], v[38:39], v[134:135]
    v_pk_fma_f32 v[208:209], v[32:33], v[176:177], v[208:209]
    v_pk_fma_f32 v[210:211], v[34:35], v[178:179], v[210:211]
    v_pk_fma_f32 v[212:213], v[36:37], v[180:181], v[212:213]
    v_pk_fma_f32 v[214:215], v[38:39], v[182:183], v[214:215]
    v_cvt_pk_bf16_f32 v148, v208, v209
    v_cvt_pk_bf16_f32 v149, v210, v211
    v_cvt_pk_bf16_f32 v150, v212, v213
    v_cvt_pk_bf16_f32 v151, v214, v215
    s_nop 0
    v_permlane16_swap_b32 v148, v150
    v_permlane16_swap_b32 v149, v151
    buffer_store_dwordx4 v[148:151], v184, s[40:43], s73 offen offset:64
    v_lshlrev_b32 v200, 16, v152
    v_and_b32 v201, 0xffff0000, v152
    v_lshlrev_b32 v202, 16, v153
    v_and_b32 v203, 0xffff0000, v153
    v_lshlrev_b32 v204, 16, v154
    v_and_b32 v205, 0xffff0000, v154
    v_lshlrev_b32 v206, 16, v155
    v_and_b32 v207, 0xffff0000, v155
    s_waitcnt vmcnt(7)
    v_lshlrev_b32 v104, 16, v88
    v_and_b32 v105, 0xffff0000, v88
    v_lshlrev_b32 v106, 16, v89
    v_and_b32 v107, 0xffff0000, v89
    v_lshlrev_b32 v108, 16, v90
    v_and_b32 v109, 0xffff0000, v90
    v_lshlrev_b32 v110, 16, v91
    v_and_b32 v111, 0xffff0000, v91
    v_pk_add_f32 v[40:41], v[40:41], v[104:105]
    v_pk_add_f32 v[42:43], v[42:43], v[106:107]
    v_pk_add_f32 v[44:45], v[44:45], v[108:109]
    v_pk_add_f32 v[46:47], v[46:47], v[110:111]
    v_pk_fma_f32 v[200:201], v[40:41], v[168:169], v[200:201]
    v_pk_fma_f32 v[202:203], v[42:43], v[170:171], v[202:203]
    v_pk_fma_f32 v[204:205], v[44:45], v[172:173], v[204:205]
    v_pk_fma_f32 v[206:207], v[46:47], v[174:175], v[206:207]
    v_cvt_pk_bf16_f32 v152, v200, v201
    v_cvt_pk_bf16_f32 v153, v202, v203
    v_cvt_pk_bf16_f32 v154, v204, v205
    v_cvt_pk_bf16_f32 v155, v206, v207
    s_nop 0
    v_permlane16_swap_b32 v152, v154
    v_permlane16_swap_b32 v153, v155
    buffer_store_dwordx4 v[152:155], v184, s[40:43], s74 offen offset:0
    v_lshlrev_b32 v208, 16, v156
    v_and_b32 v209, 0xffff0000, v156
    v_lshlrev_b32 v210, 16, v157
    v_and_b32 v211, 0xffff0000, v157
    v_lshlrev_b32 v212, 16, v158
    v_and_b32 v213, 0xffff0000, v158
    v_lshlrev_b32 v214, 16, v159
    v_and_b32 v215, 0xffff0000, v159
    s_waitcnt vmcnt(7)
    v_lshlrev_b32 v112, 16, v92
    v_and_b32 v113, 0xffff0000, v92
    v_lshlrev_b32 v114, 16, v93
    v_and_b32 v115, 0xffff0000, v93
    v_lshlrev_b32 v116, 16, v94
    v_and_b32 v117, 0xffff0000, v94
    v_lshlrev_b32 v118, 16, v95
    v_and_b32 v119, 0xffff0000, v95
    v_pk_add_f32 v[48:49], v[48:49], v[112:113]
    v_pk_add_f32 v[50:51], v[50:51], v[114:115]
    v_pk_add_f32 v[52:53], v[52:53], v[116:117]
    v_pk_add_f32 v[54:55], v[54:55], v[118:119]
    v_pk_fma_f32 v[208:209], v[48:49], v[176:177], v[208:209]
    v_pk_fma_f32 v[210:211], v[50:51], v[178:179], v[210:211]
    v_pk_fma_f32 v[212:213], v[52:53], v[180:181], v[212:213]
    v_pk_fma_f32 v[214:215], v[54:55], v[182:183], v[214:215]
    v_cvt_pk_bf16_f32 v156, v208, v209
    v_cvt_pk_bf16_f32 v157, v210, v211
    v_cvt_pk_bf16_f32 v158, v212, v213
    v_cvt_pk_bf16_f32 v159, v214, v215
    s_nop 0
    v_permlane16_swap_b32 v156, v158
    v_permlane16_swap_b32 v157, v159
    buffer_store_dwordx4 v[156:159], v184, s[40:43], s74 offen offset:64
    v_lshlrev_b32 v200, 16, v160
    v_and_b32 v201, 0xffff0000, v160
    v_lshlrev_b32 v202, 16, v161
    v_and_b32 v203, 0xffff0000, v161
    v_lshlrev_b32 v204, 16, v162
    v_and_b32 v205, 0xffff0000, v162
    v_lshlrev_b32 v206, 16, v163
    v_and_b32 v207, 0xffff0000, v163
    s_waitcnt vmcnt(7)
    v_lshlrev_b32 v120, 16, v96
    v_and_b32 v121, 0xffff0000, v96
    v_lshlrev_b32 v122, 16, v97
    v_and_b32 v123, 0xffff0000, v97
    v_lshlrev_b32 v124, 16, v98
    v_and_b32 v125, 0xffff0000, v98
    v_lshlrev_b32 v126, 16, v99
    v_and_b32 v127, 0xffff0000, v99
    v_pk_add_f32 v[56:57], v[56:57], v[120:121]
    v_pk_add_f32 v[58:59], v[58:59], v[122:123]
    v_pk_add_f32 v[60:61], v[60:61], v[124:125]
    v_pk_add_f32 v[62:63], v[62:63], v[126:127]
    v_pk_fma_f32 v[200:201], v[56:57], v[168:169], v[200:201]
    v_pk_fma_f32 v[202:203], v[58:59], v[170:171], v[202:203]
    v_pk_fma_f32 v[204:205], v[60:61], v[172:173], v[204:205]
    v_pk_fma_f32 v[206:207], v[62:63], v[174:175], v[206:207]
    v_cvt_pk_bf16_f32 v160, v200, v201
    v_cvt_pk_bf16_f32 v161, v202, v203
    v_cvt_pk_bf16_f32 v162, v204, v205
    v_cvt_pk_bf16_f32 v163, v206, v207
    s_nop 0
    v_permlane16_swap_b32 v160, v162
    v_permlane16_swap_b32 v161, v163
    buffer_store_dwordx4 v[160:163], v184, s[40:43], s75 offen offset:0
    v_lshlrev_b32 v208, 16, v164
    v_and_b32 v209, 0xffff0000, v164
    v_lshlrev_b32 v210, 16, v165
    v_and_b32 v211, 0xffff0000, v165
    v_lshlrev_b32 v212, 16, v166
    v_and_b32 v213, 0xffff0000, v166
    v_lshlrev_b32 v214, 16, v167
    v_and_b32 v215, 0xffff0000, v167
    s_waitcnt vmcnt(7)
    v_lshlrev_b32 v128, 16, v100
    v_and_b32 v129, 0xffff0000, v100
    v_lshlrev_b32 v130, 16, v101
    v_and_b32 v131, 0xffff0000, v101
    v_lshlrev_b32 v132, 16, v102
    v_and_b32 v133, 0xffff0000, v102
    v_lshlrev_b32 v134, 16, v103
    v_and_b32 v135, 0xffff0000, v103
    v_pk_add_f32 v[64:65], v[64:65], v[128:129]
    v_pk_add_f32 v[66:67], v[66:67], v[130:131]
    v_pk_add_f32 v[68:69], v[68:69], v[132:133]
    v_pk_add_f32 v[70:71], v[70:71], v[134:135]
    v_pk_fma_f32 v[208:209], v[64:65], v[176:177], v[208:209]
    v_pk_fma_f32 v[210:211], v[66:67], v[178:179], v[210:211]
    v_pk_fma_f32 v[212:213], v[68:69], v[180:181], v[212:213]
    v_pk_fma_f32 v[214:215], v[70:71], v[182:183], v[214:215]
    v_cvt_pk_bf16_f32 v164, v208, v209
    v_cvt_pk_bf16_f32 v165, v210, v211
    v_cvt_pk_bf16_f32 v166, v212, v213
    v_cvt_pk_bf16_f32 v167, v214, v215
    s_nop 0
    v_permlane16_swap_b32 v164, v166
    v_permlane16_swap_b32 v165, v167
    buffer_store_dwordx4 v[164:167], v184, s[40:43], s75 offen offset:64
    s_branch mega_kernel_fin
mega_kernel_Pidle:
    s_nop 7
    s_barrier
    s_lshl_b32 s70, s48, 12
    s_lshl_b32 s64, s47, 3
    s_lshl_b32 s65, s45, 2
    s_add_u32 s64, s64, s65
    s_mul_i32 s64, s64, 114688
    s_add_u32 s64, s64, s70
    s_lshl_b32 s65, s46, 11
    s_add_u32 s64, s64, s65
    s_add_u32 s64, s64, 0x1500000
    v_lshl_add_u32 v198, v1, 4, s64
    v_mul_f32 v24, v8, v24
    v_exp_f32 v216, -v8
    v_mul_f32 v25, v9, v25
    v_exp_f32 v217, -v9
    v_mul_f32 v26, v10, v26
    v_exp_f32 v218, -v10
    v_mul_f32 v27, v11, v27
    v_exp_f32 v219, -v11
    v_mul_f32 v28, v12, v28
    v_exp_f32 v220, -v12
    v_mul_f32 v29, v13, v29
    v_exp_f32 v221, -v13
    v_mul_f32 v30, v14, v30
    v_exp_f32 v222, -v14
    v_mul_f32 v31, v15, v31
    v_exp_f32 v223, -v15
    v_fma_f32 v216, v216, s67, s67
    v_fma_f32 v217, v217, s67, s67
    v_rcp_f32 v216, v216
    v_fma_f32 v218, v218, s67, s67
    v_rcp_f32 v217, v217
    v_fma_f32 v219, v219, s67, s67
    v_rcp_f32 v218, v218
    v_fma_f32 v220, v220, s67, s67
    v_rcp_f32 v219, v219
    v_fma_f32 v221, v221, s67, s67
    v_rcp_f32 v220, v220
    v_fma_f32 v222, v222, s67, s67
    v_rcp_f32 v221, v221
    v_fma_f32 v223, v223, s67, s67
    v_rcp_f32 v222, v222
    v_rcp_f32 v223, v223
    v_mul_f32 v24, v24, v216
    v_mul_f32 v25, v25, v217
    v_mul_f32 v26, v26, v218
    v_mul_f32 v27, v27, v219
    v_mul_f32 v28, v28, v220
    v_mul_f32 v29, v29, v221
    v_mul_f32 v30, v30, v222
    v_mul_f32 v31, v31, v223
    v_cvt_pk_bf16_f32 v200, v24, v25
    v_cvt_pk_bf16_f32 v201, v26, v27
    v_cvt_pk_bf16_f32 v202, v28, v29
    v_cvt_pk_bf16_f32 v203, v30, v31
    buffer_store_dwordx4 v[200:203], v198, s[28:31], 0 offen offset:0 sc1
    v_mul_f32 v32, v16, v32
    v_exp_f32 v224, -v16
    v_mul_f32 v33, v17, v33
    v_exp_f32 v225, -v17
    v_mul_f32 v34, v18, v34
    v_exp_f32 v226, -v18
    v_mul_f32 v35, v19, v35
    v_exp_f32 v227, -v19
    v_mul_f32 v36, v20, v36
    v_exp_f32 v228, -v20
    v_mul_f32 v37, v21, v37
    v_exp_f32 v229, -v21
    v_mul_f32 v38, v22, v38
    v_exp_f32 v230, -v22
    v_mul_f32 v39, v23, v39
    v_exp_f32 v231, -v23
    v_fma_f32 v224, v224, s67, s67
    v_fma_f32 v225, v225, s67, s67
    v_rcp_f32 v224, v224
    v_fma_f32 v226, v226, s67, s67
    v_rcp_f32 v225, v225
    v_fma_f32 v227, v227, s67, s67
    v_rcp_f32 v226, v226
    v_fma_f32 v228, v228, s67, s67
    v_rcp_f32 v227, v227
    v_fma_f32 v229, v229, s67, s67
    v_rcp_f32 v228, v228
    v_fma_f32 v230, v230, s67, s67
    v_rcp_f32 v229, v229
    v_fma_f32 v231, v231, s67, s67
    v_rcp_f32 v230, v230
    v_rcp_f32 v231, v231
    v_mul_f32 v32, v32, v224
    v_mul_f32 v33, v33, v225
    v_mul_f32 v34, v34, v226
    v_mul_f32 v35, v35, v227
    v_mul_f32 v36, v36, v228
    v_mul_f32 v37, v37, v229
    v_mul_f32 v38, v38, v230
    v_mul_f32 v39, v39, v231
    v_cvt_pk_bf16_f32 v204, v32, v33
    v_cvt_pk_bf16_f32 v205, v34, v35
    v_cvt_pk_bf16_f32 v206, v36, v37
    v_cvt_pk_bf16_f32 v207, v38, v39
    buffer_store_dwordx4 v[204:207], v198, s[28:31], 0 offen offset:1024 sc1
    v_add_u32 v198, 114688, v198
    v_mul_f32 v56, v40, v56
    v_exp_f32 v216, -v40
    v_mul_f32 v57, v41, v57
    v_exp_f32 v217, -v41
    v_mul_f32 v58, v42, v58
    v_exp_f32 v218, -v42
    v_mul_f32 v59, v43, v59
    v_exp_f32 v219, -v43
    v_mul_f32 v60, v44, v60
    v_exp_f32 v220, -v44
    v_mul_f32 v61, v45, v61
    v_exp_f32 v221, -v45
    v_mul_f32 v62, v46, v62
    v_exp_f32 v222, -v46
    v_mul_f32 v63, v47, v63
    v_exp_f32 v223, -v47
    v_fma_f32 v216, v216, s67, s67
    v_fma_f32 v217, v217, s67, s67
    v_rcp_f32 v216, v216
    v_fma_f32 v218, v218, s67, s67
    v_rcp_f32 v217, v217
    v_fma_f32 v219, v219, s67, s67
    v_rcp_f32 v218, v218
    v_fma_f32 v220, v220, s67, s67
    v_rcp_f32 v219, v219
    v_fma_f32 v221, v221, s67, s67
    v_rcp_f32 v220, v220
    v_fma_f32 v222, v222, s67, s67
    v_rcp_f32 v221, v221
    v_fma_f32 v223, v223, s67, s67
    v_rcp_f32 v222, v222
    v_rcp_f32 v223, v223
    v_mul_f32 v56, v56, v216
    v_mul_f32 v57, v57, v217
    v_mul_f32 v58, v58, v218
    v_mul_f32 v59, v59, v219
    v_mul_f32 v60, v60, v220
    v_mul_f32 v61, v61, v221
    v_mul_f32 v62, v62, v222
    v_mul_f32 v63, v63, v223
    v_cvt_pk_bf16_f32 v208, v56, v57
    v_cvt_pk_bf16_f32 v209, v58, v59
    v_cvt_pk_bf16_f32 v210, v60, v61
    v_cvt_pk_bf16_f32 v211, v62, v63
    buffer_store_dwordx4 v[208:211], v198, s[28:31], 0 offen offset:0 sc1
    v_mul_f32 v64, v48, v64
    v_exp_f32 v224, -v48
    v_mul_f32 v65, v49, v65
    v_exp_f32 v225, -v49
    v_mul_f32 v66, v50, v66
    v_exp_f32 v226, -v50
    v_mul_f32 v67, v51, v67
    v_exp_f32 v227, -v51
    v_mul_f32 v68, v52, v68
    v_exp_f32 v228, -v52
    v_mul_f32 v69, v53, v69
    v_exp_f32 v229, -v53
    v_mul_f32 v70, v54, v70
    v_exp_f32 v230, -v54
    v_mul_f32 v71, v55, v71
    v_exp_f32 v231, -v55
    v_fma_f32 v224, v224, s67, s67
    v_fma_f32 v225, v225, s67, s67
    v_rcp_f32 v224, v224
    v_fma_f32 v226, v226, s67, s67
    v_rcp_f32 v225, v225
    v_fma_f32 v227, v227, s67, s67
    v_rcp_f32 v226, v226
    v_fma_f32 v228, v228, s67, s67
    v_rcp_f32 v227, v227
    v_fma_f32 v229, v229, s67, s67
    v_rcp_f32 v228, v228
    v_fma_f32 v230, v230, s67, s67
    v_rcp_f32 v229, v229
    v_fma_f32 v231, v231, s67, s67
    v_rcp_f32 v230, v230
    v_rcp_f32 v231, v231
    v_mul_f32 v64, v64, v224
    v_mul_f32 v65, v65, v225
    v_mul_f32 v66, v66, v226
    v_mul_f32 v67, v67, v227
    v_mul_f32 v68, v68, v228
    v_mul_f32 v69, v69, v229
    v_mul_f32 v70, v70, v230
    v_mul_f32 v71, v71, v231
    v_cvt_pk_bf16_f32 v212, v64, v65
    v_cvt_pk_bf16_f32 v213, v66, v67
    v_cvt_pk_bf16_f32 v214, v68, v69
    v_cvt_pk_bf16_f32 v215, v70, v71
    buffer_store_dwordx4 v[212:215], v198, s[28:31], 0 offen offset:1024 sc1
    v_add_u32 v198, 114688, v198
    v_mul_f32 v88, v72, v88
    v_exp_f32 v216, -v72
    v_mul_f32 v89, v73, v89
    v_exp_f32 v217, -v73
    v_mul_f32 v90, v74, v90
    v_exp_f32 v218, -v74
    v_mul_f32 v91, v75, v91
    v_exp_f32 v219, -v75
    v_mul_f32 v92, v76, v92
    v_exp_f32 v220, -v76
    v_mul_f32 v93, v77, v93
    v_exp_f32 v221, -v77
    v_mul_f32 v94, v78, v94
    v_exp_f32 v222, -v78
    v_mul_f32 v95, v79, v95
    v_exp_f32 v223, -v79
    v_fma_f32 v216, v216, s67, s67
    v_fma_f32 v217, v217, s67, s67
    v_rcp_f32 v216, v216
    v_fma_f32 v218, v218, s67, s67
    v_rcp_f32 v217, v217
    v_fma_f32 v219, v219, s67, s67
    v_rcp_f32 v218, v218
    v_fma_f32 v220, v220, s67, s67
    v_rcp_f32 v219, v219
    v_fma_f32 v221, v221, s67, s67
    v_rcp_f32 v220, v220
    v_fma_f32 v222, v222, s67, s67
    v_rcp_f32 v221, v221
    v_fma_f32 v223, v223, s67, s67
    v_rcp_f32 v222, v222
    v_rcp_f32 v223, v223
    v_mul_f32 v88, v88, v216
    v_mul_f32 v89, v89, v217
    v_mul_f32 v90, v90, v218
    v_mul_f32 v91, v91, v219
    v_mul_f32 v92, v92, v220
    v_mul_f32 v93, v93, v221
    v_mul_f32 v94, v94, v222
    v_mul_f32 v95, v95, v223
    v_cvt_pk_bf16_f32 v200, v88, v89
    v_cvt_pk_bf16_f32 v201, v90, v91
    v_cvt_pk_bf16_f32 v202, v92, v93
    v_cvt_pk_bf16_f32 v203, v94, v95
    buffer_store_dwordx4 v[200:203], v198, s[28:31], 0 offen offset:0 sc1
    v_mul_f32 v96, v80, v96
    v_exp_f32 v224, -v80
    v_mul_f32 v97, v81, v97
    v_exp_f32 v225, -v81
    v_mul_f32 v98, v82, v98
    v_exp_f32 v226, -v82
    v_mul_f32 v99, v83, v99
    v_exp_f32 v227, -v83
    v_mul_f32 v100, v84, v100
    v_exp_f32 v228, -v84
    v_mul_f32 v101, v85, v101
    v_exp_f32 v229, -v85
    v_mul_f32 v102, v86, v102
    v_exp_f32 v230, -v86
    v_mul_f32 v103, v87, v103
    v_exp_f32 v231, -v87
    v_fma_f32 v224, v224, s67, s67
    v_fma_f32 v225, v225, s67, s67
    v_rcp_f32 v224, v224
    v_fma_f32 v226, v226, s67, s67
    v_rcp_f32 v225, v225
    v_fma_f32 v227, v227, s67, s67
    v_rcp_f32 v226, v226
    v_fma_f32 v228, v228, s67, s67
    v_rcp_f32 v227, v227
    v_fma_f32 v229, v229, s67, s67
    v_rcp_f32 v228, v228
    v_fma_f32 v230, v230, s67, s67
    v_rcp_f32 v229, v229
    v_fma_f32 v231, v231, s67, s67
    v_rcp_f32 v230, v230
    v_rcp_f32 v231, v231
    v_mul_f32 v96, v96, v224
    v_mul_f32 v97, v97, v225
    v_mul_f32 v98, v98, v226
    v_mul_f32 v99, v99, v227
    v_mul_f32 v100, v100, v228
    v_mul_f32 v101, v101, v229
    v_mul_f32 v102, v102, v230
    v_mul_f32 v103, v103, v231
    v_cvt_pk_bf16_f32 v204, v96, v97
    v_cvt_pk_bf16_f32 v205, v98, v99
    v_cvt_pk_bf16_f32 v206, v100, v101
    v_cvt_pk_bf16_f32 v207, v102, v103
    buffer_store_dwordx4 v[204:207], v198, s[28:31], 0 offen offset:1024 sc1
    v_add_u32 v198, 114688, v198
    v_mul_f32 v120, v104, v120
    v_exp_f32 v216, -v104
    v_mul_f32 v121, v105, v121
    v_exp_f32 v217, -v105
    v_mul_f32 v122, v106, v122
    v_exp_f32 v218, -v106
    v_mul_f32 v123, v107, v123
    v_exp_f32 v219, -v107
    v_mul_f32 v124, v108, v124
    v_exp_f32 v220, -v108
    v_mul_f32 v125, v109, v125
    v_exp_f32 v221, -v109
    v_mul_f32 v126, v110, v126
    v_exp_f32 v222, -v110
    v_mul_f32 v127, v111, v127
    v_exp_f32 v223, -v111
    v_fma_f32 v216, v216, s67, s67
    v_fma_f32 v217, v217, s67, s67
    v_rcp_f32 v216, v216
    v_fma_f32 v218, v218, s67, s67
    v_rcp_f32 v217, v217
    v_fma_f32 v219, v219, s67, s67
    v_rcp_f32 v218, v218
    v_fma_f32 v220, v220, s67, s67
    v_rcp_f32 v219, v219
    v_fma_f32 v221, v221, s67, s67
    v_rcp_f32 v220, v220
    v_fma_f32 v222, v222, s67, s67
    v_rcp_f32 v221, v221
    v_fma_f32 v223, v223, s67, s67
    v_rcp_f32 v222, v222
    v_rcp_f32 v223, v223
    v_mul_f32 v120, v120, v216
    v_mul_f32 v121, v121, v217
    v_mul_f32 v122, v122, v218
    v_mul_f32 v123, v123, v219
    v_mul_f32 v124, v124, v220
    v_mul_f32 v125, v125, v221
    v_mul_f32 v126, v126, v222
    v_mul_f32 v127, v127, v223
    v_cvt_pk_bf16_f32 v208, v120, v121
    v_cvt_pk_bf16_f32 v209, v122, v123
    v_cvt_pk_bf16_f32 v210, v124, v125
    v_cvt_pk_bf16_f32 v211, v126, v127
    buffer_store_dwordx4 v[208:211], v198, s[28:31], 0 offen offset:0 sc1
    v_mul_f32 v128, v112, v128
    v_exp_f32 v224, -v112
    v_mul_f32 v129, v113, v129
    v_exp_f32 v225, -v113
    v_mul_f32 v130, v114, v130
    v_exp_f32 v226, -v114
    v_mul_f32 v131, v115, v131
    v_exp_f32 v227, -v115
    v_mul_f32 v132, v116, v132
    v_exp_f32 v228, -v116
    v_mul_f32 v133, v117, v133
    v_exp_f32 v229, -v117
    v_mul_f32 v134, v118, v134
    v_exp_f32 v230, -v118
    v_mul_f32 v135, v119, v135
    v_exp_f32 v231, -v119
    v_fma_f32 v224, v224, s67, s67
    v_fma_f32 v225, v225, s67, s67
    v_rcp_f32 v224, v224
    v_fma_f32 v226, v226, s67, s67
    v_rcp_f32 v225, v225
    v_fma_f32 v227, v227, s67, s67
    v_rcp_f32 v226, v226
    v_fma_f32 v228, v228, s67, s67
    v_rcp_f32 v227, v227
    v_fma_f32 v229, v229, s67, s67
    v_rcp_f32 v228, v228
    v_fma_f32 v230, v230, s67, s67
    v_rcp_f32 v229, v229
    v_fma_f32 v231, v231, s67, s67
    v_rcp_f32 v230, v230
    v_rcp_f32 v231, v231
    v_mul_f32 v128, v128, v224
    v_mul_f32 v129, v129, v225
    v_mul_f32 v130, v130, v226
    v_mul_f32 v131, v131, v227
    v_mul_f32 v132, v132, v228
    v_mul_f32 v133, v133, v229
    v_mul_f32 v134, v134, v230
    v_mul_f32 v135, v135, v231
    v_cvt_pk_bf16_f32 v212, v128, v129
    v_cvt_pk_bf16_f32 v213, v130, v131
    v_cvt_pk_bf16_f32 v214, v132, v133
    v_cvt_pk_bf16_f32 v215, v134, v135
    buffer_store_dwordx4 v[212:215], v198, s[28:31], 0 offen offset:1024 sc1
    s_lshl_b32 s64, s50, 3
    s_lshl_b32 s65, s44, 1
    s_add_u32 s64, s64, s65
    s_mul_i32 s64, s64, 114688
    s_add_u32 s64, s64, 0x1500000
    v_lshl_add_u32 v192, v1, 4, s64
    v_add_u32 v193, 112640, v192
    s_lshl_b32 s65, s51, 8
    v_lshrrev_b32 v3, 4, v1
    s_lshl_b32 s64, s44, 4
    v_add_u32 v2, s64, v3
    s_movk_i32 s64, 2048
    v_mul_u32_u24 v2, s64, v2
    v_add_u32 v2, s65, v2
    v_lshlrev_b32 v3, 1, v3
    v_and_b32 v4, 15, v1
    v_xor_b32 v3, v3, v4
    v_lshl_add_u32 v194, v3, 4, v2
    v_add_u32 v196, 14336, v194
    v_xor_b32 v3, 8, v3
    v_lshl_add_u32 v195, v3, 4, v2
    v_add_u32 v195, 7168, v195
    v_add_u32 v197, 14336, v195
    s_lshl_b32 s64, s47, 8
    s_lshl_b32 s65, s48, 4
    s_add_u32 s64, s64, s65
    s_lshl_b32 s65, s44, 2
    s_add_u32 s64, s64, s65
    s_add_u32 s64, s64, 0x51000
    v_mov_b32 v2, 1
    s_waitcnt vmcnt(0)
    s_mov_b64 exec, 1
    buffer_store_dword v2, v234, s[28:31], s64 offen sc1
    s_mov_b64 exec, -1
    s_barrier
    s_lshl_b32 s68, s50, 8
    s_add_u32 s68, s68, 0x51000
    buffer_load_dword v245, v234, s[28:31], s68 offen sc1
    s_waitcnt vmcnt(0)
    s_branch mega_kernel_Pjoin
mega_kernel_Q:
    s_setprio 0
    s_sub_u32 s44, s44, 4
    s_mov_b32 s53, 0
    s_lshl_b32 s72, s44, 12
    s_add_u32 s72, s72, 2048
    s_lshl_b32 s73, s44, 9
    s_mul_i32 s74, s44, 6144
    s_add_u32 s74, s74, 18432
    s_add_u32 s75, s74, 4096
    s_bfe_u32 s66, s2, 0x30003
    s_lshr_b32 s55, s2, 6
    s_add_u32 s66, s66, s55
    s_and_b32 s66, s66, 3
    s_mov_b32 s58, 0x76453210
    s_mov_b32 s59, 0xfecdba89
    s_cmp_eq_u32 s66, 1
    s_cselect_b32 s58, 0x75643120, s58
    s_cselect_b32 s59, 0xfdecb9a8, s59
    s_cmp_eq_u32 s66, 2
    s_cselect_b32 s58, 0x67542310, s58
    s_cselect_b32 s59, 0xefdcab98, s59
    s_cmp_eq_u32 s66, 3
    s_cselect_b32 s58, 0x86534210, s58
    s_cselect_b32 s59, 0xfedbca97, s59
    s_lshl_b32 s65, s48, 7
    s_mul_i32 s64, s44, 98304
    s_add_u32 s65, s65, s64
    s_movk_i32 s64, 6144
    v_add_u32 v2, 0, v1
    v_mul_u32_u24 v3, 0xab, v2
    v_lshrrev_b32 v3, 12, v3
    v_mul_u32_u24 v4, 24, v3
    v_sub_u32 v2, v2, v4
    v_and_b32 v4, 2, v3
    v_lshrrev_b32 v5, 3, v3
    v_lshl_or_b32 v4, v5, 2, v4
    v_xor_b32 v2, v2, v4
    v_mul_u32_u24 v3, s64, v3
    v_lshrrev_b32 v4, 3, v2
    v_lshl_add_u32 v3, v4, 11, v3
    v_and_b32 v2, 7, v2
    v_lshl_add_u32 v3, v2, 4, v3
    v_add_u32 v187, s65, v3
    v_add_u32 v2, 64, v1
    v_mul_u32_u24 v3, 0xab, v2
    v_lshrrev_b32 v3, 12, v3
    v_mul_u32_u24 v4, 24, v3
    v_sub_u32 v2, v2, v4
    v_and_b32 v4, 2, v3
    v_lshrrev_b32 v5, 3, v3
    v_lshl_or_b32 v4, v5, 2, v4
    v_xor_b32 v2, v2, v4
    v_mul_u32_u24 v3, s64, v3
    v_lshrrev_b32 v4, 3, v2
    v_lshl_add_u32 v3, v4, 11, v3
    v_and_b32 v2, 7, v2
    v_lshl_add_u32 v3, v2, 4, v3
    v_subrev_u32 v3, 1024, v3
    v_add_u32 v188, s65, v3
    v_add_u32 v2, 128, v1
    v_mul_u32_u24 v3, 0xab, v2
    v_lshrrev_b32 v3, 12, v3
    v_mul_u32_u24 v4, 24, v3
    v_sub_u32 v2, v2, v4
    v_and_b32 v4, 2, v3
    v_lshrrev_b32 v5, 3, v3
    v_lshl_or_b32 v4, v5, 2, v4
    v_xor_b32 v2, v2, v4
    v_mul_u32_u24 v3, s64, v3
    v_lshrrev_b32 v4, 3, v2
    v_lshl_add_u32 v3, v4, 11, v3
    v_and_b32 v2, 7, v2
    v_lshl_add_u32 v3, v2, 4, v3
    v_subrev_u32 v3, 2048, v3
    v_add_u32 v189, s65, v3
    v_add_u32 v2, 192, v1
    v_mul_u32_u24 v3, 0xab, v2
    v_lshrrev_b32 v3, 12, v3
    v_mul_u32_u24 v4, 24, v3
    v_sub_u32 v2, v2, v4
    v_and_b32 v4, 2, v3
    v_lshrrev_b32 v5, 3, v3
    v_lshl_or_b32 v4, v5, 2, v4
    v_xor_b32 v2, v2, v4
    v_mul_u32_u24 v3, s64, v3
    v_lshrrev_b32 v4, 3, v2
    v_lshl_add_u32 v3, v4, 11, v3
    v_and_b32 v2, 7, v2
    v_lshl_add_u32 v3, v2, 4, v3
    v_subrev_u32 v3, 3072, v3
    v_add_u32 v190, s65, v3
    v_add_u32 v2, 256, v1
    v_mul_u32_u24 v3, 0xab, v2
    v_lshrrev_b32 v3, 12, v3
    v_mul_u32_u24 v4, 24, v3
    v_sub_u32 v2, v2, v4
    v_and_b32 v4, 2, v3
    v_lshrrev_b32 v5, 3, v3
    v_lshl_or_b32 v4, v5, 2, v4
    v_xor_b32 v2, v2, v4
    v_mul_u32_u24 v3, s64, v3
    v_lshrrev_b32 v4, 3, v2
    v_lshl_add_u32 v3, v4, 11, v3
    v_and_b32 v2, 7, v2
    v_lshl_add_u32 v3, v2, 4, v3
    v_add_u32 v191, s65, v3
    v_add_u32 v2, 320, v1
    v_mul_u32_u24 v3, 0xab, v2
    v_lshrrev_b32 v3, 12, v3
    v_mul_u32_u24 v4, 24, v3
    v_sub_u32 v2, v2, v4
    v_and_b32 v4, 2, v3
    v_lshrrev_b32 v5, 3, v3
    v_lshl_or_b32 v4, v5, 2, v4
    v_xor_b32 v2, v2, v4
    v_mul_u32_u24 v3, s64, v3
    v_lshrrev_b32 v4, 3, v2
    v_lshl_add_u32 v3, v4, 11, v3
    v_and_b32 v2, 7, v2
    v_lshl_add_u32 v3, v2, 4, v3
    v_subrev_u32 v3, 1024, v3
    v_add_u32 v192, s65, v3
    s_lshl_b32 s64, s47, 3
    s_lshl_b32 s65, s44, 1
    s_add_u32 s64, s64, s65
    s_mul_i32 s64, s64, 32768
    s_add_u32 s64, s64, 0x100000
    v_lshl_add_u32 v184, v1, 4, s64
    v_add_u32 v185, 30720, v184
    s_lshl_b32 s64, s47, 3
    s_max_u32 s64, s64, 1
    s_mul_i32 s64, s64, 32768
    s_add_u32 s64, s64, s73
    s_add_u32 s64, s64, 0xf8000
    v_lshl_add_u32 v186, v1, 4, s64
    s_waitcnt lgkmcnt(0)
    s_mov_b32 s32, s6
    s_mov_b32 s33, s7
    s_mov_b32 s34, 0x600000
    s_mov_b32 s35, 0x20000
    s_mov_b32 s28, s26
    s_mov_b32 s29, s27
    s_mov_b32 s30, 0x3000000
    s_mov_b32 s31, 0x20000
    s_and_b32 s57, s58, 15
    s_lshr_b64 s[58:59], s[58:59], 4
    s_lshl_b32 s56, s57, 11
    s_mul_i32 s57, s57, 0x60000
    s_add_u32 m0, s53, s74
    s_nop 0
    buffer_load_dwordx4 v187, s[32:35], s57 offen offset:0 lds
    buffer_load_dwordx4 v188, s[32:35], s57 offen offset:1024 lds
    buffer_load_dwordx4 v189, s[32:35], s57 offen offset:2048 lds
    buffer_load_dwordx4 v190, s[32:35], s57 offen offset:3072 lds
    s_add_u32 m0, s53, s75
    s_nop 0
    buffer_load_dwordx4 v191, s[32:35], s57 offen offset:0 lds
    buffer_load_dwordx4 v192, s[32:35], s57 offen offset:1024 lds
    s_add_u32 m0, s53, s72
    s_nop 0
    buffer_load_dwordx4 v184, s[28:31], s56 offen offset:0 lds
    buffer_load_dwordx4 v184, s[28:31], s56 offen offset:1024 lds
    buffer_load_dwordx4 v185, s[28:31], s56 offen offset:2048 lds
    buffer_load_dwordx4 v185, s[28:31], s56 offen offset:3072 lds
    s_add_u32 m0, s53, s73
    s_mov_b32 exec_hi, 0
    buffer_load_dwordx4 v186, s[28:31], s56 offen offset:0 lds
    s_mov_b32 exec_hi, -1
    s_add_u32 s53, s53, 49152
    s_cmp_ge_u32 s53, 147456
    s_cselect_b32 s53, 0, s53
    s_and_b32 s57, s58, 15
    s_lshr_b64 s[58:59], s[58:59], 4
    s_lshl_b32 s56, s57, 11
    s_mul_i32 s57, s57, 0x60000
    s_add_u32 m0, s53, s74
    s_nop 0
    buffer_load_dwordx4 v187, s[32:35], s57 offen offset:0 lds
    buffer_load_dwordx4 v188, s[32:35], s57 offen offset:1024 lds
    buffer_load_dwordx4 v189, s[32:35], s57 offen offset:2048 lds
    buffer_load_dwordx4 v190, s[32:35], s57 offen offset:3072 lds
    s_add_u32 m0, s53, s75
    s_nop 0
    buffer_load_dwordx4 v191, s[32:35], s57 offen offset:0 lds
    buffer_load_dwordx4 v192, s[32:35], s57 offen offset:1024 lds
    s_add_u32 m0, s53, s72
    s_nop 0
    buffer_load_dwordx4 v184, s[28:31], s56 offen offset:0 lds
    buffer_load_dwordx4 v184, s[28:31], s56 offen offset:1024 lds
    buffer_load_dwordx4 v185, s[28:31], s56 offen offset:2048 lds
    buffer_load_dwordx4 v185, s[28:31], s56 offen offset:3072 lds
    s_add_u32 m0, s53, s73
    s_mov_b32 exec_hi, 0
    buffer_load_dwordx4 v186, s[28:31], s56 offen offset:0 lds
    s_mov_b32 exec_hi, -1
    s_add_u32 s53, s53, 49152
    s_cmp_ge_u32 s53, 147456
    s_cselect_b32 s53, 0, s53
    s_and_b32 s57, s58, 15
    s_lshr_b64 s[58:59], s[58:59], 4
    s_lshl_b32 s56, s57, 11
    s_mul_i32 s57, s57, 0x60000
    s_add_u32 m0, s53, s74
    s_nop 0
    buffer_load_dwordx4 v187, s[32:35], s57 offen offset:0 lds
    buffer_load_dwordx4 v188, s[32:35], s57 offen offset:1024 lds
    buffer_load_dwordx4 v189, s[32:35], s57 offen offset:2048 lds
    buffer_load_dwordx4 v190, s[32:35], s57 offen offset:3072 lds
    s_add_u32 m0, s53, s75
    s_nop 0
    buffer_load_dwordx4 v191, s[32:35], s57 offen offset:0 lds
    buffer_load_dwordx4 v192, s[32:35], s57 offen offset:1024 lds
    s_add_u32 m0, s53, s72
    s_nop 0
    buffer_load_dwordx4 v184, s[28:31], s56 offen offset:0 lds
    buffer_load_dwordx4 v184, s[28:31], s56 offen offset:1024 lds
    buffer_load_dwordx4 v185, s[28:31], s56 offen offset:2048 lds
    buffer_load_dwordx4 v185, s[28:31], s56 offen offset:3072 lds
    s_add_u32 m0, s53, s73
    s_mov_b32 exec_hi, 0
    buffer_load_dwordx4 v186, s[28:31], s56 offen offset:0 lds
    s_mov_b32 exec_hi, -1
    s_add_u32 s53, s53, 49152
    s_cmp_ge_u32 s53, 147456
    s_cselect_b32 s53, 0, s53
    s_lshr_b32 s45, s44, 1
    s_and_b32 s46, s44, 1
    s_bfe_u32 s49, s2, 0x10003
    s_and_b32 s50, s2, 3
    s_lshl_b32 s50, s50, 2
    s_bfe_u32 s64, s2, 0x20004
    s_add_u32 s50, s50, s64
    s_and_b32 s51, s2, 4
    s_lshr_b32 s64, s2, 6
    s_add_u32 s51, s51, s64
    s_cmp_ge_u32 s2, 192
    s_cselect_b32 s69, 0x80000000, 0
    s_mov_b32 s67, 0x40053526
    v_lshlrev_b32 v234, 2, v1
    v_lshrrev_b32 v3, 3, v1
    s_lshl_b32 s64, s44, 4
    v_add_lshl_u32 v2, v3, s64, 11
    s_lshl_b32 s64, s48, 7
    v_add_u32 v2, s64, v2
    v_and_b32 v3, 6, v3
    v_and_b32 v4, 7, v1
    v_xor_b32 v3, v3, v4
    v_lshl_add_u32 v193, v3, 4, v2
    v_add_u32 v194, 15360, v193
    s_lshl_b32 s64, s47, 3
    s_lshl_b32 s65, s44, 1
    s_add_u32 s64, s64, s65
    s_mul_i32 s64, s64, 32768
    s_add_u32 s64, s64, 0x1000000
    v_lshl_add_u32 v206, v1, 4, s64
    v_add_u32 v207, 30720, v206
    s_lshl_b32 s65, s48, 8
    v_lshrrev_b32 v3, 4, v1
    s_lshl_b32 s64, s44, 4
    v_add_u32 v2, s64, v3
    s_movk_i32 s64, 7168
    v_mul_u32_u24 v2, s64, v2
    v_add_u32 v2, s65, v2
    v_lshlrev_b32 v3, 1, v3
    v_and_b32 v4, 15, v1
    v_xor_b32 v3, v3, v4
    v_lshl_add_u32 v208, v3, 4, v2
    v_add_u32 v210, 55296, v208
    v_xor_b32 v3, 8, v3
    v_lshl_add_u32 v209, v3, 4, v2
    v_add_u32 v209, 27648, v209
    v_add_u32 v211, 55296, v209
    s_lshr_b32 s65, s48, 2
    s_sub_u32 s65, s48, s65
    s_add_u32 s65, s65, 16
    s_lshl_b32 s65, s65, 8
    s_or_b32 s65, s65, s69
    v_lshrrev_b32 v3, 4, v1
    s_lshl_b32 s64, s44, 4
    v_add_u32 v2, s64, v3
    s_movk_i32 s64, 7168
    v_mul_u32_u24 v2, s64, v2
    v_add_u32 v2, s65, v2
    v_lshlrev_b32 v3, 1, v3
    v_and_b32 v4, 15, v1
    v_xor_b32 v3, v3, v4
    v_lshl_add_u32 v212, v3, 4, v2
    v_add_u32 v214, 55296, v212
    v_xor_b32 v3, 8, v3
    v_lshl_add_u32 v213, v3, 4, v2
    v_add_u32 v213, 27648, v213
    v_add_u32 v215, 55296, v213
    s_lshl_b32 s64, s50, 3
    s_lshl_b32 s65, s44, 1
    s_add_u32 s64, s64, s65
    s_mul_i32 s64, s64, 114688
    s_add_u32 s64, s64, 0x1500000
    v_lshl_add_u32 v246, v1, 4, s64
    v_add_u32 v247, 112640, v246
    s_lshl_b32 s65, s51, 8
    v_lshrrev_b32 v3, 4, v1
    s_lshl_b32 s64, s44, 4
    v_add_u32 v2, s64, v3
    s_movk_i32 s64, 2048
    v_mul_u32_u24 v2, s64, v2
    v_add_u32 v2, s65, v2
    v_lshlrev_b32 v3, 1, v3
    v_and_b32 v4, 15, v1
    v_xor_b32 v3, v3, v4
    v_lshl_add_u32 v248, v3, 4, v2
    v_add_u32 v250, 14336, v248
    v_xor_b32 v3, 8, v3
    v_lshl_add_u32 v249, v3, 4, v2
    v_add_u32 v249, 7168, v249
    v_add_u32 v251, 14336, v249
    s_lshl_b32 s64, s44, 12
    v_lshl_add_u32 v233, v1, 4, s64
    v_lshrrev_b32 v2, 2, v1
    v_lshlrev_b32 v4, 7, v2
    v_and_b32 v5, 3, v1
    v_lshl_add_u32 v4, v5, 3, v4
    v_add_u32 v4, 16384, v4
    v_bfe_u32 v2, v1, 3, 2
    v_xor_b32 v3, 0, v2
    v_lshl_add_u32 v239, v3, 5, v4
    v_xor_b32 v3, 1, v2
    v_lshl_add_u32 v240, v3, 5, v4
    v_xor_b32 v3, 2, v2
    v_lshl_add_u32 v241, v3, 5, v4
    v_xor_b32 v3, 3, v2
    v_lshl_add_u32 v242, v3, 5, v4
    s_mov_b32 s52, 49152
    v_add_u32 v232, s52, v233
    v_add_u32 v235, s52, v239
    v_add_u32 v236, s52, v240
    v_add_u32 v237, s52, v241
    v_add_u32 v238, s52, v242
    s_lshl_b32 s70, s47, 2
    s_add_u32 s70, s70, s44
    s_lshl_b32 s64, s70, 16
    s_lshl_b32 s65, s48, 7
    s_add_u32 s64, s64, s65
    v_and_b32 v2, 15, v1
    v_lshl_add_u32 v2, v2, 11, s64
    v_bfe_u32 v3, v1, 4, 1
    v_lshl_add_u32 v2, v3, 5, v2
    v_lshrrev_b32 v3, 5, v1
    v_lshl_add_u32 v196, v3, 4, v2
    s_mul_i32 s64, s70, 65536
    s_lshl_b32 s65, s48, 11
    s_add_u32 s64, s64, s65
    v_lshl_add_u32 v197, v1, 4, s64
    s_lshl_b32 s64, s70, 12
    s_add_u32 s64, s64, 0x60000
    v_lshl_add_u32 v198, v1, 3, s64
    v_and_b32 v2, 48, v1
    v_add_u32 v199, 149504, v2
    v_mov_b32 v72, 148480
    v_mov_b32 v73, 0
    ds_write_b32 v72, v73 offset:0
    ds_write_b32 v72, v73 offset:4
    ds_write_b32 v72, v73 offset:8
    v_and_b32 v16, 255, v0
    s_lshr_b32 s80, s2, 6
    s_lshl_b32 s81, s80, 8
    s_and_b32 s82, s2, 63
    s_lshl_b32 s83, s82, 7
    s_add_u32 s83, s83, 4096
    s_lshl_b32 s80, s80, 14
    s_lshl_b32 s82, s82, 8
    s_add_u32 s80, s80, s82
    s_add_u32 s80, s80, 0xa0000
    v_lshrrev_b32 v72, 3, v16
    v_add_u32 v72, s81, v72
    v_lshlrev_b32 v18, 1, v72
    s_movk_i32 s64, 12288
    v_mul_lo_u32 v72, s64, v72
    v_and_b32 v17, 7, v0
    v_lshl_add_u32 v72, v17, 4, v72
    v_add_u32 v17, s83, v72
    s_lshl_b32 s64, s2, 8
    v_add_lshl_u32 v243, v16, s64, 5
    s_mov_b32 s36, s20
    s_mov_b32 s37, s21
    s_mov_b32 s38, 0xc00000
    s_mov_b32 s39, 0x20000
    s_lshl_b32 s64, s2, 2
    s_add_u32 s64, s64, s44
    s_mul_i32 s64, s64, 7168
    s_add_u32 s10, s12, s64
    s_addc_u32 s11, s13, 0
    s_add_u32 s24, s14, s64
    s_addc_u32 s25, s15, 0
    s_waitcnt lgkmcnt(0)
    s_mov_b32 s40, s18
    s_mov_b32 s41, s19
    s_mov_b32 s42, 0x800
    s_mov_b32 s43, 0x20000
    buffer_load_ushort v24, v18, s[40:43], 0 offen offset:0
    buffer_load_ushort v25, v18, s[40:43], 0 offen offset:64
    buffer_load_ushort v26, v18, s[40:43], 0 offen offset:128
    buffer_load_ushort v27, v18, s[40:43], 0 offen offset:192
    buffer_load_ushort v28, v18, s[40:43], 0 offen offset:256
    buffer_load_ushort v29, v18, s[40:43], 0 offen offset:320
    buffer_load_ushort v30, v18, s[40:43], 0 offen offset:384
    buffer_load_ushort v31, v18, s[40:43], 0 offen offset:448
    s_waitcnt vmcnt(30)
    s_barrier
    s_movk_i32 s54, 1
mega_kernel_Q_loop0:
    s_waitcnt vmcnt(19)
    s_barrier
    s_and_b32 s57, s58, 15
    s_lshr_b64 s[58:59], s[58:59], 4
    s_lshl_b32 s56, s57, 11
    s_mul_i32 s57, s57, 0x60000
    s_add_u32 m0, s53, s74
    s_nop 0
    buffer_load_dwordx4 v187, s[32:35], s57 offen offset:0 lds
    s_load_dword s99, s[10:11], 0
    buffer_load_dwordx4 v188, s[32:35], s57 offen offset:1024 lds
    buffer_load_dwordx4 v189, s[32:35], s57 offen offset:2048 lds
    s_load_dword s99, s[24:25], 0
    buffer_load_dwordx4 v190, s[32:35], s57 offen offset:3072 lds
    s_add_u32 m0, s53, s75
    s_nop 0
    buffer_load_dwordx4 v191, s[32:35], s57 offen offset:0 lds
    s_load_dword s99, s[10:11], 64
    buffer_load_dwordx4 v192, s[32:35], s57 offen offset:1024 lds
    s_add_u32 m0, s53, s72
    s_nop 0
    buffer_load_dwordx4 v184, s[28:31], s56 offen offset:0 lds
    s_load_dword s99, s[24:25], 64
    buffer_load_dwordx4 v184, s[28:31], s56 offen offset:1024 lds
    buffer_load_dwordx4 v185, s[28:31], s56 offen offset:2048 lds
    s_load_dword s99, s[10:11], 128
    buffer_load_dwordx4 v185, s[28:31], s56 offen offset:3072 lds
    s_add_u32 m0, s53, s73
    s_mov_b32 exec_hi, 0
    buffer_load_dwordx4 v186, s[28:31], s56 offen offset:0 lds
    s_mov_b32 exec_hi, -1
    s_load_dword s99, s[24:25], 128
    s_add_u32 s53, s53, 49152
    s_cmp_ge_u32 s53, 147456
    s_cselect_b32 s53, 0, s53
    s_add_u32 s10, s10, 192
    s_addc_u32 s11, s11, 0
    s_add_u32 s24, s24, 192
    s_addc_u32 s25, s25, 0
    s_sub_u32 s54, s54, 1
    s_cbranch_scc0 mega_kernel_Q_loop0
    s_movk_i32 s54, 9
mega_kernel_Q_loop1:
    s_waitcnt vmcnt(11)
    s_barrier
    s_and_b32 s57, s58, 15
    s_lshr_b64 s[58:59], s[58:59], 4
    s_lshl_b32 s56, s57, 11
    s_mul_i32 s57, s57, 0x60000
    s_add_u32 m0, s53, s74
    s_nop 0
    buffer_load_dwordx4 v187, s[32:35], s57 offen offset:0 lds
    s_load_dword s99, s[10:11], 0
    buffer_load_dwordx4 v188, s[32:35], s57 offen offset:1024 lds
    buffer_load_dwordx4 v189, s[32:35], s57 offen offset:2048 lds
    s_load_dword s99, s[24:25], 0
    buffer_load_dwordx4 v190, s[32:35], s57 offen offset:3072 lds
    s_add_u32 m0, s53, s75
    s_nop 0
    buffer_load_dwordx4 v191, s[32:35], s57 offen offset:0 lds
    s_load_dword s99, s[10:11], 64
    buffer_load_dwordx4 v192, s[32:35], s57 offen offset:1024 lds
    s_add_u32 m0, s53, s72
    s_nop 0
    buffer_load_dwordx4 v184, s[28:31], s56 offen offset:0 lds
    s_load_dword s99, s[24:25], 64
    buffer_load_dwordx4 v184, s[28:31], s56 offen offset:1024 lds
    buffer_load_dwordx4 v185, s[28:31], s56 offen offset:2048 lds
    s_load_dword s99, s[10:11], 128
    buffer_load_dwordx4 v185, s[28:31], s56 offen offset:3072 lds
    s_add_u32 m0, s53, s73
    s_mov_b32 exec_hi, 0
    buffer_load_dwordx4 v186, s[28:31], s56 offen offset:0 lds
    s_mov_b32 exec_hi, -1
    s_load_dword s99, s[24:25], 128
    s_add_u32 s53, s53, 49152
    s_cmp_ge_u32 s53, 147456
    s_cselect_b32 s53, 0, s53
    s_add_u32 s10, s10, 192
    s_addc_u32 s11, s11, 0
    s_add_u32 s24, s24, 192
    s_addc_u32 s25, s25, 0
    s_sub_u32 s54, s54, 1
    s_cbranch_scc0 mega_kernel_Q_loop1
    s_waitcnt vmcnt(11)
    s_barrier
    s_and_b32 s57, s58, 15
    s_lshr_b64 s[58:59], s[58:59], 4
    s_lshl_b32 s56, s57, 11
    s_mul_i32 s57, s57, 0x60000
    s_add_u32 m0, s53, s74
    s_nop 0
    buffer_load_dwordx4 v187, s[32:35], s57 offen offset:0 lds
    buffer_load_dwordx4 v188, s[32:35], s57 offen offset:1024 lds
    buffer_load_dwordx4 v189, s[32:35], s57 offen offset:2048 lds
    buffer_load_dwordx4 v190, s[32:35], s57 offen offset:3072 lds
    s_add_u32 m0, s53, s75
    s_nop 0
    buffer_load_dwordx4 v191, s[32:35], s57 offen offset:0 lds
    buffer_load_dwordx4 v192, s[32:35], s57 offen offset:1024 lds
    s_add_u32 m0, s53, s72
    s_nop 0
    buffer_load_dwordx4 v184, s[28:31], s56 offen offset:0 lds
    buffer_load_dwordx4 v184, s[28:31], s56 offen offset:1024 lds
    buffer_load_dwordx4 v185, s[28:31], s56 offen offset:2048 lds
    buffer_load_dwordx4 v185, s[28:31], s56 offen offset:3072 lds
    s_add_u32 m0, s53, s73
    s_mov_b32 exec_hi, 0
    buffer_load_dwordx4 v186, s[28:31], s56 offen offset:0 lds
    s_mov_b32 exec_hi, -1
    s_add_u32 s53, s53, 49152
    s_cmp_ge_u32 s53, 147456
    s_cselect_b32 s53, 0, s53
    s_mov_b32 s64, 0x0
    buffer_load_dwordx4 v[32:35], v17, s[36:39], s64 offen
    s_mov_b32 s64, 0x60000
    buffer_load_dwordx4 v[36:39], v17, s[36:39], s64 offen
    s_mov_b32 s64, 0xc0000
    buffer_load_dwordx4 v[40:43], v17, s[36:39], s64 offen
    s_mov_b32 s64, 0x120000
    buffer_load_dwordx4 v[44:47], v17, s[36:39], s64 offen
    s_mov_b32 s64, 0x180000
    buffer_load_dwordx4 v[48:51], v17, s[36:39], s64 offen
    s_mov_b32 s64, 0x1e0000
    buffer_load_dwordx4 v[52:55], v17, s[36:39], s64 offen
    s_mov_b32 s64, 0x240000
    buffer_load_dwordx4 v[56:59], v17, s[36:39], s64 offen
    s_mov_b32 s64, 0x2a0000
    buffer_load_dwordx4 v[60:63], v17, s[36:39], s64 offen
    s_lshl_b32 s60, s44, 12
    s_add_u32 s61, s60, 147456
    s_add_u32 s53, s60, 49152
    s_lshl_b32 s70, s44, 11
    s_sub_u32 s70, 16384, s70
    s_bfe_u32 s66, s2, 0x30003
    s_lshr_b32 s55, s2, 6
    s_add_u32 s66, s66, s55
    s_and_b32 s66, s66, 3
    s_mov_b32 s58, 0x76453210
    s_mov_b32 s59, 0xfecdba89
    s_cmp_eq_u32 s66, 1
    s_cselect_b32 s58, 0x75643120, s58
    s_cselect_b32 s59, 0xfdecb9a8, s59
    s_cmp_eq_u32 s66, 2
    s_cselect_b32 s58, 0x67542310, s58
    s_cselect_b32 s59, 0xefdcab98, s59
    s_cmp_eq_u32 s66, 3
    s_cselect_b32 s58, 0x86534210, s58
    s_cselect_b32 s59, 0xfedbca97, s59
    s_mov_b32 s32, s8
    s_mov_b32 s33, s9
    s_mov_b32 s34, 0x200000
    s_mov_b32 s35, 0x20000
    s_waitcnt vmcnt(19)
    s_barrier
    s_waitcnt vmcnt(8)
    s_barrier
    s_barrier
    s_and_b32 s57, s58, 15
    s_lshr_b64 s[58:59], s[58:59], 4
    s_lshl_b32 s56, s57, 11
    s_mul_i32 s57, s57, 0x20000
    s_add_u32 m0, s53, s70
    s_nop 0
    buffer_load_dwordx4 v193, s[32:35], s57 offen offset:0 lds
    buffer_load_dwordx4 v194, s[32:35], s57 offen offset:1024 lds
    s_add_u32 s53, s53, 24576
    s_cmp_ge_u32 s53, s61
    s_cselect_b32 s53, s60, s53
    s_and_b32 s57, s58, 15
    s_lshr_b64 s[58:59], s[58:59], 4
    s_lshl_b32 s56, s57, 11
    s_mul_i32 s57, s57, 0x20000
    s_add_u32 m0, s53, s70
    s_nop 0
    buffer_load_dwordx4 v193, s[32:35], s57 offen offset:0 lds
    buffer_load_dwordx4 v194, s[32:35], s57 offen offset:1024 lds
    s_add_u32 s53, s53, 24576
    s_cmp_ge_u32 s53, s61
    s_cselect_b32 s53, s60, s53
    s_and_b32 s57, s58, 15
    s_lshr_b64 s[58:59], s[58:59], 4
    s_lshl_b32 s56, s57, 11
    s_mul_i32 s57, s57, 0x20000
    s_add_u32 m0, s53, s70
    s_nop 0
    buffer_load_dwordx4 v193, s[32:35], s57 offen offset:0 lds
    buffer_load_dwordx4 v194, s[32:35], s57 offen offset:1024 lds
    s_add_u32 s53, s53, 24576
    s_cmp_ge_u32 s53, s61
    s_cselect_b32 s53, s60, s53
    s_and_b32 s57, s58, 15
    s_lshr_b64 s[58:59], s[58:59], 4
    s_lshl_b32 s56, s57, 11
    s_mul_i32 s57, s57, 0x20000
    s_add_u32 m0, s53, s70
    s_nop 0
    buffer_load_dwordx4 v193, s[32:35], s57 offen offset:0 lds
    buffer_load_dwordx4 v194, s[32:35], s57 offen offset:1024 lds
    s_add_u32 s53, s53, 24576
    s_cmp_ge_u32 s53, s61
    s_cselect_b32 s53, s60, s53
    s_and_b32 s57, s58, 15
    s_lshr_b64 s[58:59], s[58:59], 4
    s_lshl_b32 s56, s57, 11
    s_mul_i32 s57, s57, 0x20000
    s_add_u32 m0, s53, s70
    s_nop 0
    buffer_load_dwordx4 v193, s[32:35], s57 offen offset:0 lds
    buffer_load_dwordx4 v194, s[32:35], s57 offen offset:1024 lds
    s_add_u32 s53, s53, 24576
    s_cmp_ge_u32 s53, s61
    s_cselect_b32 s53, s60, s53
    s_and_b32 s57, s58, 15
    s_lshr_b64 s[58:59], s[58:59], 4
    s_lshl_b32 s56, s57, 11
    s_mul_i32 s57, s57, 0x20000
    s_add_u32 m0, s53, s70
    s_nop 0
    buffer_load_dwordx4 v193, s[32:35], s57 offen offset:0 lds
    buffer_load_dwordx4 v194, s[32:35], s57 offen offset:1024 lds
    s_add_u32 s53, s53, 24576
    s_cmp_ge_u32 s53, s61
    s_cselect_b32 s53, s60, s53
    s_mov_b32 s40, s8
    s_mov_b32 s41, s9
    s_mov_b32 s42, 0x200000
    s_mov_b32 s43, 0x20000
    s_mov_b32 s64, 0x0
    buffer_load_dword v244, v243, s[40:43], s64 offen
    v_lshlrev_b32 v24, 16, v24
    v_lshlrev_b32 v25, 16, v25
    v_lshlrev_b32 v26, 16, v26
    v_lshlrev_b32 v27, 16, v27
    v_lshlrev_b32 v28, 16, v28
    v_lshlrev_b32 v29, 16, v29
    v_lshlrev_b32 v30, 16, v30
    v_lshlrev_b32 v31, 16, v31
    v_mul_f32 v72, 0xbfb8aa3b, v24
    v_mul_f32 v73, 0xbfb8aa3b, v25
    v_mul_f32 v74, 0xbfb8aa3b, v26
    v_mul_f32 v75, 0xbfb8aa3b, v27
    v_mul_f32 v76, 0xbfb8aa3b, v28
    v_mul_f32 v77, 0xbfb8aa3b, v29
    v_mul_f32 v78, 0xbfb8aa3b, v30
    v_mul_f32 v79, 0xbfb8aa3b, v31
    v_exp_f32 v72, v72
    v_exp_f32 v73, v73
    v_exp_f32 v74, v74
    v_exp_f32 v75, v75
    v_exp_f32 v76, v76
    v_exp_f32 v77, v77
    v_exp_f32 v78, v78
    v_exp_f32 v79, v79
    v_add_f32 v72, 1.0, v72
    v_add_f32 v73, 1.0, v73
    v_add_f32 v74, 1.0, v74
    v_add_f32 v75, 1.0, v75
    v_add_f32 v76, 1.0, v76
    v_add_f32 v77, 1.0, v77
    v_add_f32 v78, 1.0, v78
    v_add_f32 v79, 1.0, v79
    v_rcp_f32 v72, v72
    v_rcp_f32 v73, v73
    v_rcp_f32 v74, v74
    v_rcp_f32 v75, v75
    v_rcp_f32 v76, v76
    v_rcp_f32 v77, v77
    v_rcp_f32 v78, v78
    v_rcp_f32 v79, v79
    v_mul_f32 v24, v24, v72
    v_mul_f32 v25, v25, v73
    v_mul_f32 v26, v26, v74
    v_mul_f32 v27, v27, v75
    v_mul_f32 v28, v28, v76
    v_mul_f32 v29, v29, v77
    v_mul_f32 v30, v30, v78
    v_mul_f32 v31, v31, v79
    v_cvt_pk_bf16_f32 v72, v24, v24
    v_lshlrev_b32 v24, 16, v72
    v_cvt_pk_bf16_f32 v73, v25, v25
    v_lshlrev_b32 v25, 16, v73
    v_cvt_pk_bf16_f32 v74, v26, v26
    v_lshlrev_b32 v26, 16, v74
    v_cvt_pk_bf16_f32 v75, v27, v27
    v_lshlrev_b32 v27, 16, v75
    v_cvt_pk_bf16_f32 v76, v28, v28
    v_lshlrev_b32 v28, 16, v76
    v_cvt_pk_bf16_f32 v77, v29, v29
    v_lshlrev_b32 v29, 16, v77
    v_cvt_pk_bf16_f32 v78, v30, v30
    v_lshlrev_b32 v30, 16, v78
    v_cvt_pk_bf16_f32 v79, v31, v31
    v_lshlrev_b32 v31, 16, v79
    s_waitcnt vmcnt(20)
    v_lshlrev_b32 v72, 16, v32
    v_and_b32 v73, 0xffff0000, v32
    v_lshlrev_b32 v74, 16, v33
    v_and_b32 v75, 0xffff0000, v33
    v_lshlrev_b32 v76, 16, v34
    v_and_b32 v77, 0xffff0000, v34
    v_lshlrev_b32 v78, 16, v35
    v_and_b32 v79, 0xffff0000, v35
    v_mul_f32 v64, v24, v72
    v_mul_f32 v65, v24, v73
    v_mul_f32 v66, v24, v74
    v_mul_f32 v67, v24, v75
    v_mul_f32 v68, v24, v76
    v_mul_f32 v69, v24, v77
    v_mul_f32 v70, v24, v78
    v_mul_f32 v71, v24, v79
    s_waitcnt vmcnt(19)
    v_lshlrev_b32 v72, 16, v36
    v_and_b32 v73, 0xffff0000, v36
    v_lshlrev_b32 v74, 16, v37
    v_and_b32 v75, 0xffff0000, v37
    v_lshlrev_b32 v76, 16, v38
    v_and_b32 v77, 0xffff0000, v38
    v_lshlrev_b32 v78, 16, v39
    v_and_b32 v79, 0xffff0000, v39
    v_fmac_f32 v64, v25, v72
    v_fmac_f32 v65, v25, v73
    v_fmac_f32 v66, v25, v74
    v_fmac_f32 v67, v25, v75
    v_fmac_f32 v68, v25, v76
    v_fmac_f32 v69, v25, v77
    v_fmac_f32 v70, v25, v78
    v_fmac_f32 v71, v25, v79
    s_waitcnt vmcnt(18)
    v_lshlrev_b32 v72, 16, v40
    v_and_b32 v73, 0xffff0000, v40
    v_lshlrev_b32 v74, 16, v41
    v_and_b32 v75, 0xffff0000, v41
    v_lshlrev_b32 v76, 16, v42
    v_and_b32 v77, 0xffff0000, v42
    v_lshlrev_b32 v78, 16, v43
    v_and_b32 v79, 0xffff0000, v43
    v_fmac_f32 v64, v26, v72
    v_fmac_f32 v65, v26, v73
    v_fmac_f32 v66, v26, v74
    v_fmac_f32 v67, v26, v75
    v_fmac_f32 v68, v26, v76
    v_fmac_f32 v69, v26, v77
    v_fmac_f32 v70, v26, v78
    v_fmac_f32 v71, v26, v79
    s_waitcnt vmcnt(17)
    v_lshlrev_b32 v72, 16, v44
    v_and_b32 v73, 0xffff0000, v44
    v_lshlrev_b32 v74, 16, v45
    v_and_b32 v75, 0xffff0000, v45
    v_lshlrev_b32 v76, 16, v46
    v_and_b32 v77, 0xffff0000, v46
    v_lshlrev_b32 v78, 16, v47
    v_and_b32 v79, 0xffff0000, v47
    v_fmac_f32 v64, v27, v72
    v_fmac_f32 v65, v27, v73
    v_fmac_f32 v66, v27, v74
    v_fmac_f32 v67, v27, v75
    v_fmac_f32 v68, v27, v76
    v_fmac_f32 v69, v27, v77
    v_fmac_f32 v70, v27, v78
    v_fmac_f32 v71, v27, v79
    s_waitcnt vmcnt(16)
    v_lshlrev_b32 v72, 16, v48
    v_and_b32 v73, 0xffff0000, v48
    v_lshlrev_b32 v74, 16, v49
    v_and_b32 v75, 0xffff0000, v49
    v_lshlrev_b32 v76, 16, v50
    v_and_b32 v77, 0xffff0000, v50
    v_lshlrev_b32 v78, 16, v51
    v_and_b32 v79, 0xffff0000, v51
    v_fmac_f32 v64, v28, v72
    v_fmac_f32 v65, v28, v73
    v_fmac_f32 v66, v28, v74
    v_fmac_f32 v67, v28, v75
    v_fmac_f32 v68, v28, v76
    v_fmac_f32 v69, v28, v77
    v_fmac_f32 v70, v28, v78
    v_fmac_f32 v71, v28, v79
    s_waitcnt vmcnt(15)
    v_lshlrev_b32 v72, 16, v52
    v_and_b32 v73, 0xffff0000, v52
    v_lshlrev_b32 v74, 16, v53
    v_and_b32 v75, 0xffff0000, v53
    v_lshlrev_b32 v76, 16, v54
    v_and_b32 v77, 0xffff0000, v54
    v_lshlrev_b32 v78, 16, v55
    v_and_b32 v79, 0xffff0000, v55
    v_fmac_f32 v64, v29, v72
    v_fmac_f32 v65, v29, v73
    v_fmac_f32 v66, v29, v74
    v_fmac_f32 v67, v29, v75
    v_fmac_f32 v68, v29, v76
    v_fmac_f32 v69, v29, v77
    v_fmac_f32 v70, v29, v78
    v_fmac_f32 v71, v29, v79
    s_waitcnt vmcnt(14)
    v_lshlrev_b32 v72, 16, v56
    v_and_b32 v73, 0xffff0000, v56
    v_lshlrev_b32 v74, 16, v57
    v_and_b32 v75, 0xffff0000, v57
    v_lshlrev_b32 v76, 16, v58
    v_and_b32 v77, 0xffff0000, v58
    v_lshlrev_b32 v78, 16, v59
    v_and_b32 v79, 0xffff0000, v59
    v_fmac_f32 v64, v30, v72
    v_fmac_f32 v65, v30, v73
    v_fmac_f32 v66, v30, v74
    v_fmac_f32 v67, v30, v75
    v_fmac_f32 v68, v30, v76
    v_fmac_f32 v69, v30, v77
    v_fmac_f32 v70, v30, v78
    v_fmac_f32 v71, v30, v79
    s_waitcnt vmcnt(13)
    v_lshlrev_b32 v72, 16, v60
    v_and_b32 v73, 0xffff0000, v60
    v_lshlrev_b32 v74, 16, v61
    v_and_b32 v75, 0xffff0000, v61
    v_lshlrev_b32 v76, 16, v62
    v_and_b32 v77, 0xffff0000, v62
    v_lshlrev_b32 v78, 16, v63
    v_and_b32 v79, 0xffff0000, v63
    v_fmac_f32 v64, v31, v72
    v_fmac_f32 v65, v31, v73
    v_fmac_f32 v66, v31, v74
    v_fmac_f32 v67, v31, v75
    v_fmac_f32 v68, v31, v76
    v_fmac_f32 v69, v31, v77
    v_fmac_f32 v70, v31, v78
    v_fmac_f32 v71, v31, v79
    v_add_f32_dpp v64, v64, v64 row_ror:8 row_mask:0xf bank_mask:0xf
    v_add_f32_dpp v65, v65, v65 row_ror:8 row_mask:0xf bank_mask:0xf
    v_add_f32_dpp v66, v66, v66 row_ror:8 row_mask:0xf bank_mask:0xf
    v_add_f32_dpp v67, v67, v67 row_ror:8 row_mask:0xf bank_mask:0xf
    v_add_f32_dpp v68, v68, v68 row_ror:8 row_mask:0xf bank_mask:0xf
    v_add_f32_dpp v69, v69, v69 row_ror:8 row_mask:0xf bank_mask:0xf
    v_add_f32_dpp v70, v70, v70 row_ror:8 row_mask:0xf bank_mask:0xf
    v_add_f32_dpp v71, v71, v71 row_ror:8 row_mask:0xf bank_mask:0xf
    v_mov_b32 v72, v64
    v_mov_b32 v73, v65
    v_mov_b32 v74, v66
    v_mov_b32 v75, v67
    v_mov_b32 v76, v68
    v_mov_b32 v77, v69
    v_mov_b32 v78, v70
    v_mov_b32 v79, v71
    v_permlane32_swap_b32 v64, v72
    v_permlane32_swap_b32 v65, v73
    v_permlane32_swap_b32 v66, v74
    v_permlane32_swap_b32 v67, v75
    v_permlane32_swap_b32 v68, v76
    v_permlane32_swap_b32 v69, v77
    v_permlane32_swap_b32 v70, v78
    v_permlane32_swap_b32 v71, v79
    v_add_f32 v64, v64, v72
    v_add_f32 v65, v65, v73
    v_add_f32 v66, v66, v74
    v_add_f32 v67, v67, v75
    v_add_f32 v68, v68, v76
    v_add_f32 v69, v69, v77
    v_add_f32 v70, v70, v78
    v_add_f32 v71, v71, v79
    v_mov_b32 v72, v64
    v_mov_b32 v73, v65
    v_mov_b32 v74, v66
    v_mov_b32 v75, v67
    v_mov_b32 v76, v68
    v_mov_b32 v77, v69
    v_mov_b32 v78, v70
    v_mov_b32 v79, v71
    v_permlane16_swap_b32 v64, v72
    v_permlane16_swap_b32 v65, v73
    v_permlane16_swap_b32 v66, v74
    v_permlane16_swap_b32 v67, v75
    v_permlane16_swap_b32 v68, v76
    v_permlane16_swap_b32 v69, v77
    v_permlane16_swap_b32 v70, v78
    v_permlane16_swap_b32 v71, v79
    v_add_f32 v64, v64, v72
    v_add_f32 v65, v65, v73
    v_add_f32 v66, v66, v74
    v_add_f32 v67, v67, v75
    v_add_f32 v68, v68, v76
    v_add_f32 v69, v69, v77
    v_add_f32 v70, v70, v78
    v_add_f32 v71, v71, v79
    s_lshl_b32 s64, s44, 8
    s_add_u32 s64, s64, 147456
    v_and_b32 v72, 7, v0
    v_lshl_add_u32 v72, v72, 5, s64
    ds_write_b128 v72, v[64:67]
    ds_write_b128 v72, v[68:71] offset:16
    v_mov_b32 v73, 148480
    v_mov_b32 v74, 1
    s_waitcnt lgkmcnt(0)
    s_mov_b64 exec, 1
    ds_add_rtn_u32 v75, v73, v74
    s_waitcnt lgkmcnt(0)
    v_readfirstlane_b32 s64, v75
    s_mov_b64 exec, -1
    v_add_u32 v73, 147456, v234
    ds_read_b32 v64, v73 offset:0
    ds_read_b32 v65, v73 offset:256
    ds_read_b32 v66, v73 offset:512
    ds_read_b32 v67, v73 offset:768
    s_cmp_eq_u32 s64, 3
    s_cselect_b32 s80, s80, 0x80000000
    v_add_u32 v72, s80, v234
    s_waitcnt lgkmcnt(0)
    v_add_f32 v64, v64, v65
    v_add_f32 v66, v66, v67
    v_add_f32 v64, v64, v66
    buffer_store_dword v64, v72, s[28:31], 0 offen sc1
    s_mov_b32 s40, s4
    s_mov_b32 s41, s5
    s_mov_b32 s42, 0x400000
    s_mov_b32 s43, 0x20000
    s_mov_b32 s64, 0x8000
    buffer_load_dwordx4 v[88:91], v196, s[40:43], 0 offen offset:0
    buffer_load_dwordx4 v[92:95], v196, s[40:43], 0 offen offset:64
    buffer_load_dwordx4 v[96:99], v196, s[40:43], s64 offen offset:0
    buffer_load_dwordx4 v[100:103], v196, s[40:43], s64 offen offset:64
    s_lshl_b32 s60, s44, 12
    s_add_u32 s61, s60, 147456
    s_add_u32 s53, s60, 0
    s_bfe_u32 s66, s2, 0x30003
    s_lshr_b32 s55, s2, 6
    s_add_u32 s66, s66, s55
    s_and_b32 s66, s66, 3
    s_mov_b32 s58, 0x76453210
    s_mov_b32 s59, 0xfecdba89
    s_cmp_eq_u32 s66, 1
    s_cselect_b32 s58, 0x75643120, s58
    s_cselect_b32 s59, 0xfdecb9a8, s59
    s_cmp_eq_u32 s66, 2
    s_cselect_b32 s58, 0x67542310, s58
    s_cselect_b32 s59, 0xefdcab98, s59
    s_cmp_eq_u32 s66, 3
    s_cselect_b32 s58, 0x86534210, s58
    s_cselect_b32 s59, 0xfedbca97, s59
    s_mov_b32 s32, s12
    s_mov_b32 s33, s13
    s_mov_b32 s34, 0x700000
    s_mov_b32 s35, 0x20000
    s_mov_b32 s36, s14
    s_mov_b32 s37, s15
    s_mov_b32 s38, 0x700000
    s_mov_b32 s39, 0x20000
    s_mov_b32 s72, 0xb00000
    s_mov_b32 s74, 0x1000000
    s_mov_b32 s73, 0xb08000
    s_mov_b32 s75, 0x1008000
    s_lshl_b32 s76, s48, 8
    s_waitcnt vmcnt(0)
    v_permlane16_swap_b32 v88, v90
    v_permlane16_swap_b32 v89, v91
    v_permlane16_swap_b32 v92, v94
    v_permlane16_swap_b32 v93, v95
    v_permlane16_swap_b32 v96, v98
    v_permlane16_swap_b32 v97, v99
    v_permlane16_swap_b32 v100, v102
    v_permlane16_swap_b32 v101, v103
    v_lshlrev_b32 v104, 16, v88
    v_and_b32 v105, 0xffff0000, v88
    v_lshlrev_b32 v106, 16, v89
    v_and_b32 v107, 0xffff0000, v89
    v_lshlrev_b32 v108, 16, v90
    v_and_b32 v109, 0xffff0000, v90
    v_lshlrev_b32 v110, 16, v91
    v_and_b32 v111, 0xffff0000, v91
    v_lshlrev_b32 v112, 16, v92
    v_and_b32 v113, 0xffff0000, v92
    v_lshlrev_b32 v114, 16, v93
    v_and_b32 v115, 0xffff0000, v93
    v_lshlrev_b32 v116, 16, v94
    v_and_b32 v117, 0xffff0000, v94
    v_lshlrev_b32 v118, 16, v95
    v_and_b32 v119, 0xffff0000, v95
    v_lshlrev_b32 v120, 16, v96
    v_and_b32 v121, 0xffff0000, v96
    v_lshlrev_b32 v122, 16, v97
    v_and_b32 v123, 0xffff0000, v97
    v_lshlrev_b32 v124, 16, v98
    v_and_b32 v125, 0xffff0000, v98
    v_lshlrev_b32 v126, 16, v99
    v_and_b32 v127, 0xffff0000, v99
    v_lshlrev_b32 v128, 16, v100
    v_and_b32 v129, 0xffff0000, v100
    v_lshlrev_b32 v130, 16, v101
    v_and_b32 v131, 0xffff0000, v101
    v_lshlrev_b32 v132, 16, v102
    v_and_b32 v133, 0xffff0000, v102
    v_lshlrev_b32 v134, 16, v103
    v_and_b32 v135, 0xffff0000, v103
    s_setprio 2
    s_barrier
    s_barrier
    ds_read_b128 v[40:43], v232 offset:0
    ds_read_b64_tr_b16 v[48:49], v235 offset:0
    ds_read_b64_tr_b16 v[50:51], v235 offset:2048
    ds_read_b64_tr_b16 v[52:53], v236 offset:0
    ds_read_b64_tr_b16 v[54:55], v236 offset:2048
    ds_read_b64_tr_b16 v[56:57], v237 offset:0
    ds_read_b64_tr_b16 v[58:59], v237 offset:2048
    ds_read_b64_tr_b16 v[60:61], v238 offset:0
    ds_read_b64_tr_b16 v[62:63], v238 offset:2048
    ds_read_b128 v[44:47], v232 offset:2048
    s_add_u32 s52, s52, 24576
    s_cmp_ge_u32 s52, 147456
    s_cselect_b32 s52, 0, s52
    s_waitcnt lgkmcnt(0)
    v_mfma_f32_16x16x32_bf16 v[8:11], v[48:51], v[40:43], 0
    ds_read_b128 v[64:67], v232 offset:1024
    ds_read_b64_tr_b16 v[72:73], v235 offset:4096
    v_mfma_f32_16x16x32_bf16 v[12:15], v[52:55], v[40:43], 0
    ds_read_b64_tr_b16 v[74:75], v235 offset:6144
    ds_read_b64_tr_b16 v[76:77], v236 offset:4096
    v_mfma_f32_16x16x32_bf16 v[16:19], v[56:59], v[40:43], 0
    ds_read_b64_tr_b16 v[78:79], v236 offset:6144
    ds_read_b64_tr_b16 v[80:81], v237 offset:4096
    v_mfma_f32_16x16x32_bf16 v[20:23], v[60:63], v[40:43], 0
    ds_read_b64_tr_b16 v[82:83], v237 offset:6144
    ds_read_b64_tr_b16 v[84:85], v238 offset:4096
    v_mfma_f32_16x16x32_bf16 v[24:27], v[48:51], v[44:47], 0
    ds_read_b64_tr_b16 v[86:87], v238 offset:6144
    ds_read_b128 v[68:71], v232 offset:3072
    v_mfma_f32_16x16x32_bf16 v[28:31], v[52:55], v[44:47], 0
    v_add_u32 v232, s52, v233
    v_add_u32 v235, s52, v239
    v_mfma_f32_16x16x32_bf16 v[32:35], v[56:59], v[44:47], 0
    v_add_u32 v236, s52, v240
    v_add_u32 v237, s52, v241
    v_mfma_f32_16x16x32_bf16 v[36:39], v[60:63], v[44:47], 0
    v_add_u32 v238, s52, v242
    s_waitcnt lgkmcnt(0)
    v_mfma_f32_16x16x32_bf16 v[8:11], v[72:75], v[64:67], v[8:11]
    s_barrier
    v_mfma_f32_16x16x32_bf16 v[12:15], v[76:79], v[64:67], v[12:15]
    ds_read_b128 v[40:43], v232 offset:0
    ds_read_b64_tr_b16 v[48:49], v235 offset:0
    ds_read_b64_tr_b16 v[50:51], v235 offset:2048
    v_mfma_f32_16x16x32_bf16 v[16:19], v[80:83], v[64:67], v[16:19]
    ds_read_b64_tr_b16 v[52:53], v236 offset:0
    ds_read_b64_tr_b16 v[54:55], v236 offset:2048
    v_mfma_f32_16x16x32_bf16 v[20:23], v[84:87], v[64:67], v[20:23]
    ds_read_b64_tr_b16 v[56:57], v237 offset:0
    ds_read_b64_tr_b16 v[58:59], v237 offset:2048
    ds_read_b64_tr_b16 v[60:61], v238 offset:0
    v_mfma_f32_16x16x32_bf16 v[24:27], v[72:75], v[68:71], v[24:27]
    ds_read_b64_tr_b16 v[62:63], v238 offset:2048
    ds_read_b128 v[44:47], v232 offset:2048
    v_mfma_f32_16x16x32_bf16 v[28:31], v[76:79], v[68:71], v[28:31]
    v_mfma_f32_16x16x32_bf16 v[32:35], v[80:83], v[68:71], v[32:35]
    s_add_u32 s52, s52, 24576
    s_cmp_ge_u32 s52, 147456
    s_cselect_b32 s52, 0, s52
    v_mfma_f32_16x16x32_bf16 v[36:39], v[84:87], v[68:71], v[36:39]
    s_waitcnt lgkmcnt(0)
    v_mfma_f32_16x16x32_bf16 v[8:11], v[48:51], v[40:43], v[8:11]
    ds_read_b128 v[64:67], v232 offset:1024
    ds_read_b64_tr_b16 v[72:73], v235 offset:4096
    v_mfma_f32_16x16x32_bf16 v[12:15], v[52:55], v[40:43], v[12:15]
    ds_read_b64_tr_b16 v[74:75], v235 offset:6144
    ds_read_b64_tr_b16 v[76:77], v236 offset:4096
    v_mfma_f32_16x16x32_bf16 v[16:19], v[56:59], v[40:43], v[16:19]
    ds_read_b64_tr_b16 v[78:79], v236 offset:6144
    ds_read_b64_tr_b16 v[80:81], v237 offset:4096
    v_mfma_f32_16x16x32_bf16 v[20:23], v[60:63], v[40:43], v[20:23]
    ds_read_b64_tr_b16 v[82:83], v237 offset:6144
    ds_read_b64_tr_b16 v[84:85], v238 offset:4096
    v_mfma_f32_16x16x32_bf16 v[24:27], v[48:51], v[44:47], v[24:27]
    s_movk_i32 s54, 10
mega_kernel_Q_loop2:
    ds_read_b64_tr_b16 v[86:87], v238 offset:6144
    ds_read_b128 v[68:71], v232 offset:3072
    v_mfma_f32_16x16x32_bf16 v[28:31], v[52:55], v[44:47], v[28:31]
    v_add_u32 v232, s52, v233
    v_add_u32 v235, s52, v239
    v_mfma_f32_16x16x32_bf16 v[32:35], v[56:59], v[44:47], v[32:35]
    v_add_u32 v236, s52, v240
    v_add_u32 v237, s52, v241
    v_mfma_f32_16x16x32_bf16 v[36:39], v[60:63], v[44:47], v[36:39]
    v_add_u32 v238, s52, v242
    s_waitcnt lgkmcnt(0)
    v_mfma_f32_16x16x32_bf16 v[8:11], v[72:75], v[64:67], v[8:11]
    s_barrier
    v_mfma_f32_16x16x32_bf16 v[12:15], v[76:79], v[64:67], v[12:15]
    ds_read_b128 v[40:43], v232 offset:0
    ds_read_b64_tr_b16 v[48:49], v235 offset:0
    ds_read_b64_tr_b16 v[50:51], v235 offset:2048
    v_mfma_f32_16x16x32_bf16 v[16:19], v[80:83], v[64:67], v[16:19]
    ds_read_b64_tr_b16 v[52:53], v236 offset:0
    ds_read_b64_tr_b16 v[54:55], v236 offset:2048
    v_mfma_f32_16x16x32_bf16 v[20:23], v[84:87], v[64:67], v[20:23]
    ds_read_b64_tr_b16 v[56:57], v237 offset:0
    ds_read_b64_tr_b16 v[58:59], v237 offset:2048
    ds_read_b64_tr_b16 v[60:61], v238 offset:0
    v_mfma_f32_16x16x32_bf16 v[24:27], v[72:75], v[68:71], v[24:27]
    ds_read_b64_tr_b16 v[62:63], v238 offset:2048
    ds_read_b128 v[44:47], v232 offset:2048
    v_mfma_f32_16x16x32_bf16 v[28:31], v[76:79], v[68:71], v[28:31]
    v_mfma_f32_16x16x32_bf16 v[32:35], v[80:83], v[68:71], v[32:35]
    s_add_u32 s52, s52, 24576
    s_cmp_ge_u32 s52, 147456
    s_cselect_b32 s52, 0, s52
    v_mfma_f32_16x16x32_bf16 v[36:39], v[84:87], v[68:71], v[36:39]
    s_waitcnt lgkmcnt(0)
    v_mfma_f32_16x16x32_bf16 v[8:11], v[48:51], v[40:43], v[8:11]
    ds_read_b128 v[64:67], v232 offset:1024
    ds_read_b64_tr_b16 v[72:73], v235 offset:4096
    v_mfma_f32_16x16x32_bf16 v[12:15], v[52:55], v[40:43], v[12:15]
    ds_read_b64_tr_b16 v[74:75], v235 offset:6144
    ds_read_b64_tr_b16 v[76:77], v236 offset:4096
    v_mfma_f32_16x16x32_bf16 v[16:19], v[56:59], v[40:43], v[16:19]
    ds_read_b64_tr_b16 v[78:79], v236 offset:6144
    ds_read_b64_tr_b16 v[80:81], v237 offset:4096
    v_mfma_f32_16x16x32_bf16 v[20:23], v[60:63], v[40:43], v[20:23]
    s_sub_u32 s54, s54, 1
    ds_read_b64_tr_b16 v[82:83], v237 offset:6144
    ds_read_b64_tr_b16 v[84:85], v238 offset:4096
    v_mfma_f32_16x16x32_bf16 v[24:27], v[48:51], v[44:47], v[24:27]
    s_cbranch_scc0 mega_kernel_Q_loop2
    ds_read_b64_tr_b16 v[86:87], v238 offset:6144
    ds_read_b128 v[68:71], v232 offset:3072
    v_mfma_f32_16x16x32_bf16 v[28:31], v[52:55], v[44:47], v[28:31]
    v_add_u32 v232, s52, v233
    v_add_u32 v235, s52, v239
    v_mfma_f32_16x16x32_bf16 v[32:35], v[56:59], v[44:47], v[32:35]
    v_add_u32 v236, s52, v240
    v_add_u32 v237, s52, v241
    v_mfma_f32_16x16x32_bf16 v[36:39], v[60:63], v[44:47], v[36:39]
    v_add_u32 v238, s52, v242
    s_waitcnt lgkmcnt(0)
    v_mfma_f32_16x16x32_bf16 v[8:11], v[72:75], v[64:67], v[8:11]
    s_barrier
    v_mfma_f32_16x16x32_bf16 v[12:15], v[76:79], v[64:67], v[12:15]
    ds_read_b128 v[40:43], v232 offset:0
    ds_read_b64_tr_b16 v[48:49], v235 offset:0
    ds_read_b64_tr_b16 v[50:51], v235 offset:2048
    v_mfma_f32_16x16x32_bf16 v[16:19], v[80:83], v[64:67], v[16:19]
    ds_read_b64_tr_b16 v[52:53], v236 offset:0
    ds_read_b64_tr_b16 v[54:55], v236 offset:2048
    v_mfma_f32_16x16x32_bf16 v[20:23], v[84:87], v[64:67], v[20:23]
    ds_read_b64_tr_b16 v[56:57], v237 offset:0
    ds_read_b64_tr_b16 v[58:59], v237 offset:2048
    ds_read_b64_tr_b16 v[60:61], v238 offset:0
    v_mfma_f32_16x16x32_bf16 v[24:27], v[72:75], v[68:71], v[24:27]
    ds_read_b64_tr_b16 v[62:63], v238 offset:2048
    ds_read_b128 v[44:47], v232 offset:2048
    v_mfma_f32_16x16x32_bf16 v[28:31], v[76:79], v[68:71], v[28:31]
    v_mfma_f32_16x16x32_bf16 v[32:35], v[80:83], v[68:71], v[32:35]
    s_add_u32 s52, s52, 24576
    s_cmp_ge_u32 s52, 147456
    s_cselect_b32 s52, 0, s52
    v_mfma_f32_16x16x32_bf16 v[36:39], v[84:87], v[68:71], v[36:39]
    s_waitcnt lgkmcnt(0)
    v_mfma_f32_16x16x32_bf16 v[8:11], v[48:51], v[40:43], v[8:11]
    ds_read_b128 v[64:67], v232 offset:1024
    ds_read_b64_tr_b16 v[72:73], v235 offset:4096
    v_mfma_f32_16x16x32_bf16 v[12:15], v[52:55], v[40:43], v[12:15]
    ds_read_b64_tr_b16 v[74:75], v235 offset:6144
    ds_read_b64_tr_b16 v[76:77], v236 offset:4096
    ds_read_b128 v[136:139], v199 offset:0
    v_mfma_f32_16x16x32_bf16 v[16:19], v[56:59], v[40:43], v[16:19]
    ds_read_b64_tr_b16 v[78:79], v236 offset:6144
    ds_read_b64_tr_b16 v[80:81], v237 offset:4096
    ds_read_b128 v[140:143], v199 offset:64
    v_mfma_f32_16x16x32_bf16 v[20:23], v[60:63], v[40:43], v[20:23]
    ds_read_b64_tr_b16 v[82:83], v237 offset:6144
    ds_read_b64_tr_b16 v[84:85], v238 offset:4096
    v_mfma_f32_16x16x32_bf16 v[24:27], v[48:51], v[44:47], v[24:27]
    ds_read_b64_tr_b16 v[86:87], v238 offset:6144
    ds_read_b128 v[68:71], v232 offset:3072
    ds_read_b128 v[144:147], v199 offset:128
    v_mfma_f32_16x16x32_bf16 v[28:31], v[52:55], v[44:47], v[28:31]
    v_add_u32 v232, s52, v233
    v_add_u32 v235, s52, v239
    v_mfma_f32_16x16x32_bf16 v[32:35], v[56:59], v[44:47], v[32:35]
    v_add_u32 v236, s52, v240
    v_add_u32 v237, s52, v241
    ds_read_b128 v[148:151], v199 offset:192
    v_mfma_f32_16x16x32_bf16 v[36:39], v[60:63], v[44:47], v[36:39]
    v_add_u32 v238, s52, v242
    s_waitcnt lgkmcnt(0)
    v_mfma_f32_16x16x32_bf16 v[8:11], v[72:75], v[64:67], v[8:11]
    s_barrier
    v_mfma_f32_16x16x32_bf16 v[12:15], v[76:79], v[64:67], v[12:15]
    ds_read_b128 v[40:43], v232 offset:0
    ds_read_b64_tr_b16 v[48:49], v235 offset:0
    ds_read_b64_tr_b16 v[50:51], v235 offset:2048
    ds_read_b128 v[152:155], v199 offset:256
    v_mfma_f32_16x16x32_bf16 v[16:19], v[80:83], v[64:67], v[16:19]
    ds_read_b64_tr_b16 v[52:53], v236 offset:0
    ds_read_b64_tr_b16 v[54:55], v236 offset:2048
    ds_read_b128 v[156:159], v199 offset:320
    v_mfma_f32_16x16x32_bf16 v[20:23], v[84:87], v[64:67], v[20:23]
    ds_read_b64_tr_b16 v[56:57], v237 offset:0
    ds_read_b64_tr_b16 v[58:59], v237 offset:2048
    ds_read_b64_tr_b16 v[60:61], v238 offset:0
    v_mfma_f32_16x16x32_bf16 v[24:27], v[72:75], v[68:71], v[24:27]
    ds_read_b64_tr_b16 v[62:63], v238 offset:2048
    ds_read_b128 v[44:47], v232 offset:2048
    ds_read_b128 v[160:163], v199 offset:384
    v_mfma_f32_16x16x32_bf16 v[28:31], v[76:79], v[68:71], v[28:31]
    v_mfma_f32_16x16x32_bf16 v[32:35], v[80:83], v[68:71], v[32:35]
    s_add_u32 s52, s52, 24576
    s_cmp_ge_u32 s52, 147456
    s_cselect_b32 s52, 0, s52
    ds_read_b128 v[164:167], v199 offset:448
    v_mfma_f32_16x16x32_bf16 v[36:39], v[84:87], v[68:71], v[36:39]
    s_waitcnt lgkmcnt(0)
    v_mfma_f32_16x16x32_bf16 v[8:11], v[48:51], v[40:43], v[8:11]
    ds_read_b128 v[64:67], v232 offset:1024
    ds_read_b64_tr_b16 v[72:73], v235 offset:4096
    v_mfma_f32_16x16x32_bf16 v[12:15], v[52:55], v[40:43], v[12:15]
    ds_read_b64_tr_b16 v[74:75], v235 offset:6144
    ds_read_b64_tr_b16 v[76:77], v236 offset:4096
    ds_read_b128 v[168:171], v199 offset:512
    v_mfma_f32_16x16x32_bf16 v[16:19], v[56:59], v[40:43], v[16:19]
    ds_read_b64_tr_b16 v[78:79], v236 offset:6144
    ds_read_b64_tr_b16 v[80:81], v237 offset:4096
    ds_read_b128 v[172:175], v199 offset:576
    v_mfma_f32_16x16x32_bf16 v[20:23], v[60:63], v[40:43], v[20:23]
    ds_read_b64_tr_b16 v[82:83], v237 offset:6144
    ds_read_b64_tr_b16 v[84:85], v238 offset:4096
    v_mfma_f32_16x16x32_bf16 v[24:27], v[48:51], v[44:47], v[24:27]
    ds_read_b64_tr_b16 v[86:87], v238 offset:6144
    ds_read_b128 v[68:71], v232 offset:3072
    ds_read_b128 v[176:179], v199 offset:640
    v_mfma_f32_16x16x32_bf16 v[28:31], v[52:55], v[44:47], v[28:31]
    v_add_u32 v232, s52, v233
    v_add_u32 v235, s52, v239
    v_mfma_f32_16x16x32_bf16 v[32:35], v[56:59], v[44:47], v[32:35]
    v_add_u32 v236, s52, v240
    v_add_u32 v237, s52, v241
    ds_read_b128 v[180:183], v199 offset:704
    v_mfma_f32_16x16x32_bf16 v[36:39], v[60:63], v[44:47], v[36:39]
    v_add_u32 v238, s52, v242
    s_waitcnt lgkmcnt(0)
    v_mfma_f32_16x16x32_bf16 v[8:11], v[72:75], v[64:67], v[8:11]
    s_barrier
    v_mfma_f32_16x16x32_bf16 v[12:15], v[76:79], v[64:67], v[12:15]
    ds_read_b128 v[40:43], v232 offset:0
    ds_read_b64_tr_b16 v[48:49], v235 offset:0
    ds_read_b64_tr_b16 v[50:51], v235 offset:2048
    v_mfma_f32_16x16x32_bf16 v[16:19], v[80:83], v[64:67], v[16:19]
    ds_read_b64_tr_b16 v[52:53], v236 offset:0
    ds_read_b64_tr_b16 v[54:55], v236 offset:2048
    v_mfma_f32_16x16x32_bf16 v[20:23], v[84:87], v[64:67], v[20:23]
    ds_read_b64_tr_b16 v[56:57], v237 offset:0
    ds_read_b64_tr_b16 v[58:59], v237 offset:2048
    ds_read_b64_tr_b16 v[60:61], v238 offset:0
    v_mfma_f32_16x16x32_bf16 v[24:27], v[72:75], v[68:71], v[24:27]
    ds_read_b64_tr_b16 v[62:63], v238 offset:2048
    ds_read_b128 v[44:47], v232 offset:2048
    v_mfma_f32_16x16x32_bf16 v[28:31], v[76:79], v[68:71], v[28:31]
    v_mfma_f32_16x16x32_bf16 v[32:35], v[80:83], v[68:71], v[32:35]
    s_add_u32 s52, s52, 24576
    s_cmp_ge_u32 s52, 147456
    s_cselect_b32 s52, 0, s52
    v_mfma_f32_16x16x32_bf16 v[36:39], v[84:87], v[68:71], v[36:39]
    s_waitcnt lgkmcnt(0)
    v_mfma_f32_16x16x32_bf16 v[8:11], v[48:51], v[40:43], v[8:11]
    ds_read_b128 v[64:67], v232 offset:1024
    ds_read_b64_tr_b16 v[72:73], v235 offset:4096
    v_mfma_f32_16x16x32_bf16 v[12:15], v[52:55], v[40:43], v[12:15]
    ds_read_b64_tr_b16 v[74:75], v235 offset:6144
    ds_read_b64_tr_b16 v[76:77], v236 offset:4096
    v_mfma_f32_16x16x32_bf16 v[16:19], v[56:59], v[40:43], v[16:19]
    ds_read_b64_tr_b16 v[78:79], v236 offset:6144
    ds_read_b64_tr_b16 v[80:81], v237 offset:4096
    v_mfma_f32_16x16x32_bf16 v[20:23], v[60:63], v[40:43], v[20:23]
    ds_read_b64_tr_b16 v[82:83], v237 offset:6144
    ds_read_b64_tr_b16 v[84:85], v238 offset:4096
    v_mfma_f32_16x16x32_bf16 v[24:27], v[48:51], v[44:47], v[24:27]
    ds_read_b64_tr_b16 v[86:87], v238 offset:6144
    ds_read_b128 v[68:71], v232 offset:3072
    v_mfma_f32_16x16x32_bf16 v[28:31], v[52:55], v[44:47], v[28:31]
    v_mfma_f32_16x16x32_bf16 v[32:35], v[56:59], v[44:47], v[32:35]
    v_mfma_f32_16x16x32_bf16 v[36:39], v[60:63], v[44:47], v[36:39]
    s_waitcnt lgkmcnt(0)
    v_mfma_f32_16x16x32_bf16 v[8:11], v[72:75], v[64:67], v[8:11]
    s_barrier
    v_mfma_f32_16x16x32_bf16 v[12:15], v[76:79], v[64:67], v[12:15]
    v_mfma_f32_16x16x32_bf16 v[16:19], v[80:83], v[64:67], v[16:19]
    v_mfma_f32_16x16x32_bf16 v[20:23], v[84:87], v[64:67], v[20:23]
    v_mfma_f32_16x16x32_bf16 v[24:27], v[72:75], v[68:71], v[24:27]
    v_mfma_f32_16x16x32_bf16 v[28:31], v[76:79], v[68:71], v[28:31]
    v_mfma_f32_16x16x32_bf16 v[32:35], v[80:83], v[68:71], v[32:35]
    v_mfma_f32_16x16x32_bf16 v[36:39], v[84:87], v[68:71], v[36:39]
    v_pk_fma_f32 v[104:105], v[8:9], v[136:137], v[104:105]
    v_pk_fma_f32 v[106:107], v[10:11], v[138:139], v[106:107]
    v_pk_fma_f32 v[108:109], v[12:13], v[140:141], v[108:109]
    v_pk_fma_f32 v[110:111], v[14:15], v[142:143], v[110:111]
    v_pk_fma_f32 v[112:113], v[16:17], v[144:145], v[112:113]
    v_pk_fma_f32 v[114:115], v[18:19], v[146:147], v[114:115]
    v_pk_fma_f32 v[116:117], v[20:21], v[148:149], v[116:117]
    v_pk_fma_f32 v[118:119], v[22:23], v[150:151], v[118:119]
    v_pk_fma_f32 v[120:121], v[24:25], v[136:137], v[120:121]
    v_pk_fma_f32 v[122:123], v[26:27], v[138:139], v[122:123]
    v_pk_fma_f32 v[124:125], v[28:29], v[140:141], v[124:125]
    v_pk_fma_f32 v[126:127], v[30:31], v[142:143], v[126:127]
    v_pk_fma_f32 v[128:129], v[32:33], v[144:145], v[128:129]
    v_pk_fma_f32 v[130:131], v[34:35], v[146:147], v[130:131]
    v_pk_fma_f32 v[132:133], v[36:37], v[148:149], v[132:133]
    v_pk_fma_f32 v[134:135], v[38:39], v[150:151], v[134:135]
    v_cvt_pk_bf16_f32 v88, v104, v105
    v_cvt_pk_bf16_f32 v89, v106, v107
    v_cvt_pk_bf16_f32 v90, v108, v109
    v_cvt_pk_bf16_f32 v91, v110, v111
    v_cvt_pk_bf16_f32 v92, v112, v113
    v_cvt_pk_bf16_f32 v93, v114, v115
    v_cvt_pk_bf16_f32 v94, v116, v117
    v_cvt_pk_bf16_f32 v95, v118, v119
    v_cvt_pk_bf16_f32 v96, v120, v121
    v_cvt_pk_bf16_f32 v97, v122, v123
    v_cvt_pk_bf16_f32 v98, v124, v125
    v_cvt_pk_bf16_f32 v99, v126, v127
    v_cvt_pk_bf16_f32 v100, v128, v129
    v_cvt_pk_bf16_f32 v101, v130, v131
    v_cvt_pk_bf16_f32 v102, v132, v133
    v_cvt_pk_bf16_f32 v103, v134, v135
    v_lshlrev_b32 v104, 16, v88
    v_and_b32 v105, 0xffff0000, v88
    v_lshlrev_b32 v106, 16, v89
    v_and_b32 v107, 0xffff0000, v89
    v_lshlrev_b32 v108, 16, v90
    v_and_b32 v109, 0xffff0000, v90
    v_lshlrev_b32 v110, 16, v91
    v_and_b32 v111, 0xffff0000, v91
    v_lshlrev_b32 v112, 16, v92
    v_and_b32 v113, 0xffff0000, v92
    v_lshlrev_b32 v114, 16, v93
    v_and_b32 v115, 0xffff0000, v93
    v_lshlrev_b32 v116, 16, v94
    v_and_b32 v117, 0xffff0000, v94
    v_lshlrev_b32 v118, 16, v95
    v_and_b32 v119, 0xffff0000, v95
    v_lshlrev_b32 v120, 16, v96
    v_and_b32 v121, 0xffff0000, v96
    v_lshlrev_b32 v122, 16, v97
    v_and_b32 v123, 0xffff0000, v97
    v_lshlrev_b32 v124, 16, v98
    v_and_b32 v125, 0xffff0000, v98
    v_lshlrev_b32 v126, 16, v99
    v_and_b32 v127, 0xffff0000, v99
    v_lshlrev_b32 v128, 16, v100
    v_and_b32 v129, 0xffff0000, v100
    v_lshlrev_b32 v130, 16, v101
    v_and_b32 v131, 0xffff0000, v101
    v_lshlrev_b32 v132, 16, v102
    v_and_b32 v133, 0xffff0000, v102
    v_lshlrev_b32 v134, 16, v103
    v_and_b32 v135, 0xffff0000, v103
    v_pk_add_f32 v[40:41], v[104:105], v[106:107]
    v_pk_mul_f32 v[44:45], v[104:105], v[104:105]
    v_pk_add_f32 v[42:43], v[120:121], v[122:123]
    v_pk_mul_f32 v[46:47], v[120:121], v[120:121]
    v_pk_fma_f32 v[44:45], v[106:107], v[106:107], v[44:45]
    v_pk_fma_f32 v[46:47], v[122:123], v[122:123], v[46:47]
    v_pk_add_f32 v[40:41], v[40:41], v[108:109]
    v_pk_fma_f32 v[44:45], v[108:109], v[108:109], v[44:45]
    v_pk_add_f32 v[42:43], v[42:43], v[124:125]
    v_pk_fma_f32 v[46:47], v[124:125], v[124:125], v[46:47]
    v_pk_add_f32 v[40:41], v[40:41], v[110:111]
    v_pk_fma_f32 v[44:45], v[110:111], v[110:111], v[44:45]
    v_pk_add_f32 v[42:43], v[42:43], v[126:127]
    v_pk_fma_f32 v[46:47], v[126:127], v[126:127], v[46:47]
    v_pk_add_f32 v[40:41], v[40:41], v[112:113]
    v_pk_fma_f32 v[44:45], v[112:113], v[112:113], v[44:45]
    v_pk_add_f32 v[42:43], v[42:43], v[128:129]
    v_pk_fma_f32 v[46:47], v[128:129], v[128:129], v[46:47]
    v_pk_add_f32 v[40:41], v[40:41], v[114:115]
    v_pk_fma_f32 v[44:45], v[114:115], v[114:115], v[44:45]
    v_pk_add_f32 v[42:43], v[42:43], v[130:131]
    v_pk_fma_f32 v[46:47], v[130:131], v[130:131], v[46:47]
    v_pk_add_f32 v[40:41], v[40:41], v[116:117]
    v_pk_fma_f32 v[44:45], v[116:117], v[116:117], v[44:45]
    v_pk_add_f32 v[42:43], v[42:43], v[132:133]
    v_pk_fma_f32 v[46:47], v[132:133], v[132:133], v[46:47]
    v_pk_add_f32 v[40:41], v[40:41], v[118:119]
    v_pk_fma_f32 v[44:45], v[118:119], v[118:119], v[44:45]
    v_pk_add_f32 v[42:43], v[42:43], v[134:135]
    v_pk_fma_f32 v[46:47], v[134:135], v[134:135], v[46:47]
    v_add_f32 v40, v40, v41
    v_add_f32 v42, v42, v43
    v_add_f32 v44, v44, v45
    v_add_f32 v46, v46, v47
    v_permlane16_swap_b32 v40, v42
    s_nop 0
    v_permlane16_swap_b32 v44, v46
    v_add_f32 v48, v40, v42
    v_add_f32 v49, v44, v46
    v_mov_b32 v50, v48
    v_mov_b32 v51, v49
    s_nop 0
    v_permlane32_swap_b32 v48, v50
    v_permlane32_swap_b32 v49, v51
    v_add_f32 v48, v48, v50
    v_add_f32 v49, v49, v51
    s_mov_b32 exec_hi, 0
    buffer_store_dwordx2 v[48:49], v198, s[28:31], s76 offen sc1
    s_mov_b32 exec_hi, -1
    buffer_load_dwordx2 v[56:57], v198, s[28:31], 0 offen offset:0 sc1
    buffer_load_dwordx2 v[58:59], v198, s[28:31], 0 offen offset:512 sc1
    buffer_load_dwordx2 v[60:61], v198, s[28:31], 0 offen offset:1024 sc1
    buffer_load_dwordx2 v[62:63], v198, s[28:31], 0 offen offset:1536 sc1
    buffer_load_dwordx2 v[64:65], v198, s[28:31], 0 offen offset:2048 sc1
    buffer_load_dwordx2 v[66:67], v198, s[28:31], 0 offen offset:2560 sc1
    buffer_load_dwordx2 v[68:69], v198, s[28:31], 0 offen offset:3072 sc1
    buffer_load_dwordx2 v[70:71], v198, s[28:31], 0 offen offset:3584 sc1
    s_waitcnt vmcnt(0)
    s_mov_b32 s3, 0x40000
mega_kernel_sp_chk:
    v_cmp_eq_u32 s[80:81], -1, v57
    v_cmp_eq_u32 s[82:83], -1, v59
    v_cmp_eq_u32 s[84:85], -1, v61
    v_cmp_eq_u32 s[86:87], -1, v63
    v_cmp_eq_u32 s[88:89], -1, v65
    v_cmp_eq_u32 s[90:91], -1, v67
    v_cmp_eq_u32 s[92:93], -1, v69
    v_cmp_eq_u32 s[94:95], -1, v71
    v_max3_u32 v52, v57, v59, v61
    v_max3_u32 v53, v63, v65, v67
    v_max3_u32 v52, v52, v69, v71
    v_max_u32 v52, v52, v53
    v_cmp_eq_u32 vcc, -1, v52
    s_nop 4
    s_cbranch_vccz mega_kernel_sp_ok
    s_sub_u32 s3, s3, 1
    s_cbranch_scc1 mega_kernel_sp_ok
    s_mov_b64 exec, s[80:81]
    buffer_load_dwordx2 v[56:57], v198, s[28:31], 0 offen offset:0 sc1
    s_mov_b64 exec, s[82:83]
    buffer_load_dwordx2 v[58:59], v198, s[28:31], 0 offen offset:512 sc1
    s_mov_b64 exec, s[84:85]
    buffer_load_dwordx2 v[60:61], v198, s[28:31], 0 offen offset:1024 sc1
    s_mov_b64 exec, s[86:87]
    buffer_load_dwordx2 v[62:63], v198, s[28:31], 0 offen offset:1536 sc1
    s_mov_b64 exec, s[88:89]
    buffer_load_dwordx2 v[64:65], v198, s[28:31], 0 offen offset:2048 sc1
    s_mov_b64 exec, s[90:91]
    buffer_load_dwordx2 v[66:67], v198, s[28:31], 0 offen offset:2560 sc1
    s_mov_b64 exec, s[92:93]
    buffer_load_dwordx2 v[68:69], v198, s[28:31], 0 offen offset:3072 sc1
    s_mov_b64 exec, s[94:95]
    buffer_load_dwordx2 v[70:71], v198, s[28:31], 0 offen offset:3584 sc1
    s_mov_b64 exec, -1
    s_waitcnt vmcnt(0)
    s_branch mega_kernel_sp_chk
mega_kernel_sp_ok:
    buffer_store_dwordx4 v[88:91], v197, s[28:31], s72 offen offset:0 sc1
    buffer_store_dwordx4 v[92:95], v197, s[28:31], s72 offen offset:1024 sc1
    buffer_store_dwordx4 v[96:99], v197, s[28:31], s73 offen offset:0 sc1
    buffer_store_dwordx4 v[100:103], v197, s[28:31], s73 offen offset:1024 sc1
    v_pk_add_f32 v[56:57], v[56:57], v[58:59]
    v_pk_add_f32 v[60:61], v[60:61], v[62:63]
    v_pk_add_f32 v[64:65], v[64:65], v[66:67]
    v_pk_add_f32 v[68:69], v[68:69], v[70:71]
    v_pk_add_f32 v[56:57], v[56:57], v[60:61]
    v_pk_add_f32 v[64:65], v[64:65], v[68:69]
    v_pk_add_f32 v[56:57], v[56:57], v[64:65]
    v_mov_b32 v50, v56
    v_mov_b32 v51, v57
    s_nop 0
    v_permlane32_swap_b32 v56, v50
    v_permlane32_swap_b32 v57, v51
    v_add_f32 v56, v56, v50
    v_add_f32 v57, v57, v51
    v_mul_f32 v56, 0x3a800000, v56
    v_mul_f32 v57, 0x3a800000, v57
    v_fma_f32 v57, -v56, v56, v57
    v_max_f32 v57, 0, v57
    v_cvt_pk_bf16_f32 v50, v56, v57
    v_lshlrev_b32 v56, 16, v50
    v_and_b32 v57, 0xffff0000, v50
    v_add_f32 v57, 0x3727c5ac, v57
    v_cvt_pk_bf16_f32 v50, v57, v57
    v_lshlrev_b32 v57, 16, v50
    v_sqrt_f32 v57, v57
    s_nop 0
    v_cvt_pk_bf16_f32 v50, v57, v57
    v_lshlrev_b32 v57, 16, v50
    v_rcp_f32 v40, v57
    s_nop 0
    v_mul_f32 v44, -v56, v40
    v_mov_b32 v42, v40
    v_mov_b32 v46, v44
    s_nop 0
    v_permlane16_swap_b32 v40, v42
    v_permlane16_swap_b32 v44, v46
    v_pk_fma_f32 v[104:105], v[104:105], v[40:41], v[44:45] op_sel_hi:[1,0,0]
    v_pk_fma_f32 v[106:107], v[106:107], v[40:41], v[44:45] op_sel_hi:[1,0,0]
    v_pk_fma_f32 v[108:109], v[108:109], v[40:41], v[44:45] op_sel_hi:[1,0,0]
    v_pk_fma_f32 v[110:111], v[110:111], v[40:41], v[44:45] op_sel_hi:[1,0,0]
    v_pk_fma_f32 v[112:113], v[112:113], v[40:41], v[44:45] op_sel_hi:[1,0,0]
    v_pk_fma_f32 v[114:115], v[114:115], v[40:41], v[44:45] op_sel_hi:[1,0,0]
    v_pk_fma_f32 v[116:117], v[116:117], v[40:41], v[44:45] op_sel_hi:[1,0,0]
    v_pk_fma_f32 v[118:119], v[118:119], v[40:41], v[44:45] op_sel_hi:[1,0,0]
    v_pk_fma_f32 v[104:105], v[104:105], v[168:169], v[152:153]
    v_pk_fma_f32 v[106:107], v[106:107], v[170:171], v[154:155]
    v_pk_fma_f32 v[108:109], v[108:109], v[172:173], v[156:157]
    v_pk_fma_f32 v[110:111], v[110:111], v[174:175], v[158:159]
    v_pk_fma_f32 v[112:113], v[112:113], v[176:177], v[160:161]
    v_pk_fma_f32 v[114:115], v[114:115], v[178:179], v[162:163]
    v_pk_fma_f32 v[116:117], v[116:117], v[180:181], v[164:165]
    v_pk_fma_f32 v[118:119], v[118:119], v[182:183], v[166:167]
    v_cvt_pk_bf16_f32 v72, v104, v105
    v_cvt_pk_bf16_f32 v73, v106, v107
    v_cvt_pk_bf16_f32 v74, v108, v109
    v_cvt_pk_bf16_f32 v75, v110, v111
    buffer_store_dwordx4 v[72:75], v197, s[28:31], s74 offen offset:0 sc1
    v_cvt_pk_bf16_f32 v76, v112, v113
    v_cvt_pk_bf16_f32 v77, v114, v115
    v_cvt_pk_bf16_f32 v78, v116, v117
    v_cvt_pk_bf16_f32 v79, v118, v119
    buffer_store_dwordx4 v[76:79], v197, s[28:31], s74 offen offset:1024 sc1
    v_pk_fma_f32 v[120:121], v[120:121], v[42:43], v[46:47] op_sel_hi:[1,0,0]
    v_pk_fma_f32 v[122:123], v[122:123], v[42:43], v[46:47] op_sel_hi:[1,0,0]
    v_pk_fma_f32 v[124:125], v[124:125], v[42:43], v[46:47] op_sel_hi:[1,0,0]
    v_pk_fma_f32 v[126:127], v[126:127], v[42:43], v[46:47] op_sel_hi:[1,0,0]
    v_pk_fma_f32 v[128:129], v[128:129], v[42:43], v[46:47] op_sel_hi:[1,0,0]
    v_pk_fma_f32 v[130:131], v[130:131], v[42:43], v[46:47] op_sel_hi:[1,0,0]
    v_pk_fma_f32 v[132:133], v[132:133], v[42:43], v[46:47] op_sel_hi:[1,0,0]
    v_pk_fma_f32 v[134:135], v[134:135], v[42:43], v[46:47] op_sel_hi:[1,0,0]
    v_pk_fma_f32 v[120:121], v[120:121], v[168:169], v[152:153]
    v_pk_fma_f32 v[122:123], v[122:123], v[170:171], v[154:155]
    v_pk_fma_f32 v[124:125], v[124:125], v[172:173], v[156:157]
    v_pk_fma_f32 v[126:127], v[126:127], v[174:175], v[158:159]
    v_pk_fma_f32 v[128:129], v[128:129], v[176:177], v[160:161]
    v_pk_fma_f32 v[130:131], v[130:131], v[178:179], v[162:163]
    v_pk_fma_f32 v[132:133], v[132:133], v[180:181], v[164:165]
    v_pk_fma_f32 v[134:135], v[134:135], v[182:183], v[166:167]
    v_cvt_pk_bf16_f32 v80, v120, v121
    v_cvt_pk_bf16_f32 v81, v122, v123
    v_cvt_pk_bf16_f32 v82, v124, v125
    v_cvt_pk_bf16_f32 v83, v126, v127
    buffer_store_dwordx4 v[80:83], v197, s[28:31], s75 offen offset:0 sc1
    v_cvt_pk_bf16_f32 v84, v128, v129
    v_cvt_pk_bf16_f32 v85, v130, v131
    v_cvt_pk_bf16_f32 v86, v132, v133
    v_cvt_pk_bf16_f32 v87, v134, v135
    buffer_store_dwordx4 v[84:87], v197, s[28:31], s75 offen offset:1024 sc1
    s_lshl_b32 s68, s47, 9
    s_add_u32 s68, s68, 0x56000
    v_lshlrev_b32 v3, 7, v1
    s_lshr_b32 s64, s48, 2
    s_lshl_b32 s64, s64, 7
    v_mov_b32 v4, s64
    v_mov_b32 v2, 1
    v_mov_b32 v5, 148488
    s_waitcnt vmcnt(0)
    s_mov_b64 exec, 1
    ds_add_rtn_u32 v245, v5, v2
    s_waitcnt lgkmcnt(0)
    v_cmp_ne_u32 vcc, 3, v245
    s_nop 4
    s_cbranch_vccnz mega_kernel_ph_ok
    s_mov_b64 exec, 15
    buffer_atomic_add v2, v3, s[28:31], s68 offen
    s_mov_b64 exec, 1
    s_mov_b32 s3, 0x40000
mega_kernel_ph_chk:
    v_cmp_ne_u32 vcc, 16, v245
    s_nop 4
    s_cbranch_vccz mega_kernel_ph_ok
    s_sub_u32 s3, s3, 1
    s_cbranch_scc1 mega_kernel_ph_ok
    buffer_load_dword v245, v4, s[28:31], s68 offen sc1
    s_waitcnt vmcnt(0)
    s_branch mega_kernel_ph_chk
mega_kernel_ph_ok:
    s_mov_b64 exec, -1
    s_barrier
    s_setprio 0
    s_and_b32 s57, s58, 15
    s_lshr_b64 s[58:59], s[58:59], 4
    s_lshl_b32 s56, s57, 11
    s_mul_i32 s57, s57, 0x70000
    s_mov_b32 m0, s53
    s_nop 0
    buffer_load_dwordx4 v206, s[28:31], s56 offen offset:0 lds
    buffer_load_dwordx4 v206, s[28:31], s56 offen offset:1024 lds
    buffer_load_dwordx4 v207, s[28:31], s56 offen offset:2048 lds
    buffer_load_dwordx4 v207, s[28:31], s56 offen offset:3072 lds
    s_add_u32 s53, s53, 49152
    s_cmp_ge_u32 s53, s61
    s_cselect_b32 s53, s60, s53
    s_and_b32 s57, s58, 15
    s_lshr_b64 s[58:59], s[58:59], 4
    s_lshl_b32 s56, s57, 11
    s_mul_i32 s57, s57, 0x70000
    s_add_u32 m0, s53, 16384
    s_nop 0
    buffer_load_dwordx4 v208, s[32:35], s57 offen offset:0 lds
    buffer_load_dwordx4 v209, s[32:35], s57 offen offset:1024 lds
    buffer_load_dwordx4 v210, s[32:35], s57 offen offset:2048 lds
    buffer_load_dwordx4 v211, s[32:35], s57 offen offset:3072 lds
    s_add_u32 m0, s53, 32768
    s_nop 0
    buffer_load_dwordx4 v208, s[36:39], s57 offen offset:0 lds
    buffer_load_dwordx4 v209, s[36:39], s57 offen offset:1024 lds
    buffer_load_dwordx4 v210, s[36:39], s57 offen offset:2048 lds
    buffer_load_dwordx4 v211, s[36:39], s57 offen offset:3072 lds
    s_mov_b32 m0, s53
    s_nop 0
    buffer_load_dwordx4 v206, s[28:31], s56 offen offset:0 lds
    buffer_load_dwordx4 v206, s[28:31], s56 offen offset:1024 lds
    buffer_load_dwordx4 v207, s[28:31], s56 offen offset:2048 lds
    buffer_load_dwordx4 v207, s[28:31], s56 offen offset:3072 lds
    s_add_u32 s53, s53, 49152
    s_cmp_ge_u32 s53, s61
    s_cselect_b32 s53, s60, s53
    s_waitcnt vmcnt(12)
    s_barrier
    s_and_b32 s57, s58, 15
    s_lshr_b64 s[58:59], s[58:59], 4
    s_lshl_b32 s56, s57, 11
    s_mul_i32 s57, s57, 0x70000
    s_add_u32 m0, s53, 16384
    s_nop 0
    buffer_load_dwordx4 v208, s[32:35], s57 offen offset:0 lds
    buffer_load_dwordx4 v209, s[32:35], s57 offen offset:1024 lds
    buffer_load_dwordx4 v210, s[32:35], s57 offen offset:2048 lds
    buffer_load_dwordx4 v211, s[32:35], s57 offen offset:3072 lds
    s_add_u32 m0, s53, 32768
    s_nop 0
    buffer_load_dwordx4 v208, s[36:39], s57 offen offset:0 lds
    buffer_load_dwordx4 v209, s[36:39], s57 offen offset:1024 lds
    buffer_load_dwordx4 v210, s[36:39], s57 offen offset:2048 lds
    buffer_load_dwordx4 v211, s[36:39], s57 offen offset:3072 lds
    s_mov_b32 m0, s53
    s_nop 0
    buffer_load_dwordx4 v206, s[28:31], s56 offen offset:0 lds
    buffer_load_dwordx4 v206, s[28:31], s56 offen offset:1024 lds
    buffer_load_dwordx4 v207, s[28:31], s56 offen offset:2048 lds
    buffer_load_dwordx4 v207, s[28:31], s56 offen offset:3072 lds
    s_add_u32 s53, s53, 49152
    s_cmp_ge_u32 s53, s61
    s_cselect_b32 s53, s60, s53
    s_lshl_b32 s64, s45, 13
    v_lshl_add_u32 v233, v1, 4, s64
    v_lshrrev_b32 v2, 2, v1
    v_lshlrev_b32 v4, 8, v2
    v_and_b32 v5, 3, v1
    v_lshl_add_u32 v4, v5, 3, v4
    v_add_u32 v4, 16384, v4
    v_and_b32 v2, 7, v2
    s_lshl_b32 s64, s46, 2
    v_xor_b32 v2, s64, v2
    v_xor_b32 v3, 0, v2
    v_lshl_add_u32 v239, v3, 5, v4
    v_xor_b32 v3, 1, v2
    v_lshl_add_u32 v240, v3, 5, v4
    v_xor_b32 v3, 2, v2
    v_lshl_add_u32 v241, v3, 5, v4
    v_xor_b32 v3, 3, v2
    v_lshl_add_u32 v242, v3, 5, v4
    s_mov_b32 s52, 49152
    v_add_u32 v232, s52, v233
    v_add_u32 v235, s52, v239
    v_add_u32 v236, s52, v240
    v_add_u32 v237, s52, v241
    v_add_u32 v238, s52, v242
    s_lshl_b32 s64, s2, 2
    s_add_u32 s64, s64, s44
    s_mul_i32 s64, s64, 7168
    s_add_u32 s64, s64, 3840
    s_add_u32 s10, s12, s64
    s_addc_u32 s11, s13, 0
    s_add_u32 s24, s14, s64
    s_addc_u32 s25, s15, 0
    s_movk_i32 s54, 11
mega_kernel_Q_loop3:
    s_waitcnt vmcnt(12)
    s_barrier
    s_and_b32 s57, s58, 15
    s_lshr_b64 s[58:59], s[58:59], 4
    s_lshl_b32 s56, s57, 11
    s_mul_i32 s57, s57, 0x70000
    s_add_u32 m0, s53, 16384
    s_nop 0
    buffer_load_dwordx4 v208, s[32:35], s57 offen offset:0 lds
    s_load_dword s99, s[10:11], 0
    buffer_load_dwordx4 v209, s[32:35], s57 offen offset:1024 lds
    buffer_load_dwordx4 v210, s[32:35], s57 offen offset:2048 lds
    s_load_dword s99, s[24:25], 0
    buffer_load_dwordx4 v211, s[32:35], s57 offen offset:3072 lds
    s_load_dword s99, s[10:11], 64
    s_add_u32 m0, s53, 32768
    s_nop 0
    buffer_load_dwordx4 v208, s[36:39], s57 offen offset:0 lds
    buffer_load_dwordx4 v209, s[36:39], s57 offen offset:1024 lds
    s_load_dword s99, s[24:25], 64
    buffer_load_dwordx4 v210, s[36:39], s57 offen offset:2048 lds
    s_load_dword s99, s[10:11], 128
    buffer_load_dwordx4 v211, s[36:39], s57 offen offset:3072 lds
    s_mov_b32 m0, s53
    s_nop 0
    buffer_load_dwordx4 v206, s[28:31], s56 offen offset:0 lds
    s_load_dword s99, s[24:25], 128
    buffer_load_dwordx4 v206, s[28:31], s56 offen offset:1024 lds
    s_load_dword s99, s[10:11], 192
    buffer_load_dwordx4 v207, s[28:31], s56 offen offset:2048 lds
    buffer_load_dwordx4 v207, s[28:31], s56 offen offset:3072 lds
    s_load_dword s99, s[24:25], 192
    s_add_u32 s53, s53, 49152
    s_cmp_ge_u32 s53, s61
    s_cselect_b32 s53, s60, s53
    s_add_u32 s10, s10, 256
    s_addc_u32 s11, s11, 0
    s_add_u32 s24, s24, 256
    s_addc_u32 s25, s25, 0
    s_sub_u32 s54, s54, 1
    s_cbranch_scc0 mega_kernel_Q_loop3
    s_waitcnt vmcnt(12)
    s_barrier
    s_and_b32 s57, s58, 15
    s_lshr_b64 s[58:59], s[58:59], 4
    s_lshl_b32 s56, s57, 11
    s_mul_i32 s57, s57, 0x70000
    s_add_u32 m0, s53, 16384
    s_nop 0
    buffer_load_dwordx4 v208, s[32:35], s57 offen offset:0 lds
    buffer_load_dwordx4 v209, s[32:35], s57 offen offset:1024 lds
    buffer_load_dwordx4 v210, s[32:35], s57 offen offset:2048 lds
    buffer_load_dwordx4 v211, s[32:35], s57 offen offset:3072 lds
    s_add_u32 m0, s53, 32768
    s_nop 0
    buffer_load_dwordx4 v208, s[36:39], s57 offen offset:0 lds
    buffer_load_dwordx4 v209, s[36:39], s57 offen offset:1024 lds
    buffer_load_dwordx4 v210, s[36:39], s57 offen offset:2048 lds
    buffer_load_dwordx4 v211, s[36:39], s57 offen offset:3072 lds
    s_mov_b32 m0, s53
    s_nop 0
    buffer_load_dwordx4 v206, s[28:31], s56 offen offset:0 lds
    buffer_load_dwordx4 v206, s[28:31], s56 offen offset:1024 lds
    buffer_load_dwordx4 v207, s[28:31], s56 offen offset:2048 lds
    buffer_load_dwordx4 v207, s[28:31], s56 offen offset:3072 lds
    s_add_u32 s53, s53, 49152
    s_cmp_ge_u32 s53, s61
    s_cselect_b32 s53, s60, s53
    s_waitcnt vmcnt(12)
    s_barrier
    s_bfe_u32 s66, s2, 0x30003
    s_lshr_b32 s55, s2, 6
    s_add_u32 s66, s66, s55
    s_mul_i32 s55, s66, 11
    s_lshr_b32 s55, s55, 5
    s_mul_i32 s55, s55, 3
    s_sub_u32 s66, s66, s55
    s_mov_b32 s58, 0x67534201
    s_mov_b32 s59, 0xfecdb9a8
    s_cmp_eq_u32 s66, 1
    s_cselect_b32 s58, 0x86453120, s58
    s_cselect_b32 s59, 0xfdecab97, s59
    s_cmp_eq_u32 s66, 2
    s_cselect_b32 s58, 0x75642310, s58
    s_cselect_b32 s59, 0xefdbca89, s59
    v_or_b32 v206, s69, v206
    v_or_b32 v207, s69, v207
    s_and_b32 s57, s58, 15
    s_lshr_b64 s[58:59], s[58:59], 4
    s_lshl_b32 s56, s57, 11
    s_mul_i32 s57, s57, 0x70000
    s_add_u32 m0, s53, 16384
    s_nop 0
    buffer_load_dwordx4 v212, s[32:35], s57 offen offset:0 lds
    buffer_load_dwordx4 v213, s[32:35], s57 offen offset:1024 lds
    buffer_load_dwordx4 v214, s[32:35], s57 offen offset:2048 lds
    buffer_load_dwordx4 v215, s[32:35], s57 offen offset:3072 lds
    s_add_u32 m0, s53, 32768
    s_nop 0
    buffer_load_dwordx4 v212, s[36:39], s57 offen offset:0 lds
    buffer_load_dwordx4 v213, s[36:39], s57 offen offset:1024 lds
    buffer_load_dwordx4 v214, s[36:39], s57 offen offset:2048 lds
    buffer_load_dwordx4 v215, s[36:39], s57 offen offset:3072 lds
    s_mov_b32 m0, s53
    s_nop 0
    buffer_load_dwordx4 v206, s[28:31], s56 offen offset:0 lds
    buffer_load_dwordx4 v206, s[28:31], s56 offen offset:1024 lds
    buffer_load_dwordx4 v207, s[28:31], s56 offen offset:2048 lds
    buffer_load_dwordx4 v207, s[28:31], s56 offen offset:3072 lds
    s_add_u32 s53, s53, 49152
    s_cmp_ge_u32 s53, s61
    s_cselect_b32 s53, s60, s53
    s_waitcnt vmcnt(12)
    s_barrier
    s_and_b32 s57, s58, 15
    s_lshr_b64 s[58:59], s[58:59], 4
    s_lshl_b32 s56, s57, 11
    s_mul_i32 s57, s57, 0x70000
    s_add_u32 m0, s53, 16384
    s_nop 0
    buffer_load_dwordx4 v212, s[32:35], s57 offen offset:0 lds
    buffer_load_dwordx4 v213, s[32:35], s57 offen offset:1024 lds
    buffer_load_dwordx4 v214, s[32:35], s57 offen offset:2048 lds
    buffer_load_dwordx4 v215, s[32:35], s57 offen offset:3072 lds
    s_add_u32 m0, s53, 32768
    s_nop 0
    buffer_load_dwordx4 v212, s[36:39], s57 offen offset:0 lds
    buffer_load_dwordx4 v213, s[36:39], s57 offen offset:1024 lds
    buffer_load_dwordx4 v214, s[36:39], s57 offen offset:2048 lds
    buffer_load_dwordx4 v215, s[36:39], s57 offen offset:3072 lds
    s_mov_b32 m0, s53
    s_nop 0
    buffer_load_dwordx4 v206, s[28:31], s56 offen offset:0 lds
    buffer_load_dwordx4 v206, s[28:31], s56 offen offset:1024 lds
    buffer_load_dwordx4 v207, s[28:31], s56 offen offset:2048 lds
    buffer_load_dwordx4 v207, s[28:31], s56 offen offset:3072 lds
    s_add_u32 s53, s53, 49152
    s_cmp_ge_u32 s53, s61
    s_cselect_b32 s53, s60, s53
    s_waitcnt vmcnt(12)
    s_barrier
    s_cmp_lg_u32 s69, 0
    s_cbranch_scc1 mega_kernel_Qidle
    ds_read_b128 v[136:139], v232 offset:0
    ds_read_b64_tr_b16 v[152:153], v235 offset:0
    ds_read_b64_tr_b16 v[154:155], v235 offset:4096
    ds_read_b64_tr_b16 v[156:157], v236 offset:0
    ds_read_b64_tr_b16 v[158:159], v236 offset:4096
    ds_read_b64_tr_b16 v[160:161], v237 offset:0
    ds_read_b64_tr_b16 v[162:163], v237 offset:4096
    ds_read_b64_tr_b16 v[164:165], v238 offset:0
    ds_read_b64_tr_b16 v[166:167], v238 offset:4096
    ds_read_b64_tr_b16 v[168:169], v235 offset:16384
    ds_read_b64_tr_b16 v[170:171], v235 offset:20480
    ds_read_b64_tr_b16 v[172:173], v236 offset:16384
    ds_read_b64_tr_b16 v[174:175], v236 offset:20480
    ds_read_b64_tr_b16 v[176:177], v237 offset:16384
    ds_read_b64_tr_b16 v[178:179], v237 offset:20480
    ds_read_b64_tr_b16 v[180:181], v238 offset:16384
    ds_read_b64_tr_b16 v[182:183], v238 offset:20480
    ds_read_b128 v[140:143], v232 offset:2048
    ds_read_b128 v[144:147], v232 offset:4096
    ds_read_b128 v[148:151], v232 offset:6144
    s_and_b32 s57, s58, 15
    s_lshr_b64 s[58:59], s[58:59], 4
    s_lshl_b32 s56, s57, 11
    s_mul_i32 s57, s57, 0x70000
    s_add_u32 m0, s53, 16384
    s_nop 0
    buffer_load_dwordx4 v212, s[32:35], s57 offen offset:0 lds
    buffer_load_dwordx4 v213, s[32:35], s57 offen offset:1024 lds
    buffer_load_dwordx4 v214, s[32:35], s57 offen offset:2048 lds
    buffer_load_dwordx4 v215, s[32:35], s57 offen offset:3072 lds
    s_add_u32 m0, s53, 32768
    s_nop 0
    buffer_load_dwordx4 v212, s[36:39], s57 offen offset:0 lds
    buffer_load_dwordx4 v213, s[36:39], s57 offen offset:1024 lds
    buffer_load_dwordx4 v214, s[36:39], s57 offen offset:2048 lds
    buffer_load_dwordx4 v215, s[36:39], s57 offen offset:3072 lds
    s_mov_b32 m0, s53
    s_nop 0
    buffer_load_dwordx4 v206, s[28:31], s56 offen offset:0 lds
    buffer_load_dwordx4 v206, s[28:31], s56 offen offset:1024 lds
    buffer_load_dwordx4 v207, s[28:31], s56 offen offset:2048 lds
    buffer_load_dwordx4 v207, s[28:31], s56 offen offset:3072 lds
    s_add_u32 s53, s53, 49152
    s_cmp_ge_u32 s53, s61
    s_cselect_b32 s53, s60, s53
    s_setprio 2
    s_add_u32 s52, s52, 49152
    s_cmp_ge_u32 s52, 147456
    s_cselect_b32 s52, 0, s52
    s_waitcnt lgkmcnt(0)
    v_mfma_f32_16x16x32_bf16 v[8:11], v[152:155], v[136:139], 0
    ds_read_b128 v[184:187], v232 offset:1024
    v_mfma_f32_16x16x32_bf16 v[12:15], v[156:159], v[136:139], 0
    ds_read_b64_tr_b16 v[200:201], v235 offset:8192
    v_mfma_f32_16x16x32_bf16 v[16:19], v[160:163], v[136:139], 0
    ds_read_b64_tr_b16 v[202:203], v235 offset:12288
    v_mfma_f32_16x16x32_bf16 v[20:23], v[164:167], v[136:139], 0
    ds_read_b64_tr_b16 v[204:205], v236 offset:8192
    v_mfma_f32_16x16x32_bf16 v[24:27], v[168:171], v[136:139], 0
    v_mfma_f32_16x16x32_bf16 v[28:31], v[172:175], v[136:139], 0
    ds_read_b64_tr_b16 v[206:207], v236 offset:12288
    v_mfma_f32_16x16x32_bf16 v[32:35], v[176:179], v[136:139], 0
    ds_read_b64_tr_b16 v[208:209], v237 offset:8192
    v_mfma_f32_16x16x32_bf16 v[36:39], v[180:183], v[136:139], 0
    ds_read_b64_tr_b16 v[210:211], v237 offset:12288
    v_mfma_f32_16x16x32_bf16 v[40:43], v[152:155], v[140:143], 0
    ds_read_b64_tr_b16 v[212:213], v238 offset:8192
    v_mfma_f32_16x16x32_bf16 v[44:47], v[156:159], v[140:143], 0
    v_mfma_f32_16x16x32_bf16 v[48:51], v[160:163], v[140:143], 0
    ds_read_b64_tr_b16 v[214:215], v238 offset:12288
    v_mfma_f32_16x16x32_bf16 v[52:55], v[164:167], v[140:143], 0
    ds_read_b64_tr_b16 v[216:217], v235 offset:24576
    v_mfma_f32_16x16x32_bf16 v[56:59], v[168:171], v[140:143], 0
    ds_read_b64_tr_b16 v[218:219], v235 offset:28672
    v_mfma_f32_16x16x32_bf16 v[60:63], v[172:175], v[140:143], 0
    ds_read_b64_tr_b16 v[220:221], v236 offset:24576
    v_mfma_f32_16x16x32_bf16 v[64:67], v[176:179], v[140:143], 0
    v_mfma_f32_16x16x32_bf16 v[68:71], v[180:183], v[140:143], 0
    ds_read_b64_tr_b16 v[222:223], v236 offset:28672
    v_mfma_f32_16x16x32_bf16 v[72:75], v[152:155], v[144:147], 0
    ds_read_b64_tr_b16 v[224:225], v237 offset:24576
    v_mfma_f32_16x16x32_bf16 v[76:79], v[156:159], v[144:147], 0
    ds_read_b64_tr_b16 v[226:227], v237 offset:28672
    v_mfma_f32_16x16x32_bf16 v[80:83], v[160:163], v[144:147], 0
    ds_read_b64_tr_b16 v[228:229], v238 offset:24576
    v_mfma_f32_16x16x32_bf16 v[84:87], v[164:167], v[144:147], 0
    v_mfma_f32_16x16x32_bf16 v[88:91], v[168:171], v[144:147], 0
    ds_read_b64_tr_b16 v[230:231], v238 offset:28672
    v_mfma_f32_16x16x32_bf16 v[92:95], v[172:175], v[144:147], 0
    ds_read_b128 v[188:191], v232 offset:3072
    v_mfma_f32_16x16x32_bf16 v[96:99], v[176:179], v[144:147], 0
    ds_read_b128 v[192:195], v232 offset:5120
    v_mfma_f32_16x16x32_bf16 v[100:103], v[180:183], v[144:147], 0
    ds_read_b128 v[196:199], v232 offset:7168
    v_mfma_f32_16x16x32_bf16 v[104:107], v[152:155], v[148:151], 0
    v_mfma_f32_16x16x32_bf16 v[108:111], v[156:159], v[148:151], 0
    v_add_u32 v232, s52, v233
    v_mfma_f32_16x16x32_bf16 v[112:115], v[160:163], v[148:151], 0
    v_add_u32 v235, s52, v239
    v_mfma_f32_16x16x32_bf16 v[116:119], v[164:167], v[148:151], 0
    v_add_u32 v236, s52, v240
    v_mfma_f32_16x16x32_bf16 v[120:123], v[168:171], v[148:151], 0
    v_mfma_f32_16x16x32_bf16 v[124:127], v[172:175], v[148:151], 0
    v_add_u32 v237, s52, v241
    v_mfma_f32_16x16x32_bf16 v[128:131], v[176:179], v[148:151], 0
    v_add_u32 v238, s52, v242
    v_mfma_f32_16x16x32_bf16 v[132:135], v[180:183], v[148:151], 0
    s_waitcnt lgkmcnt(0)
    v_mfma_f32_16x16x32_bf16 v[8:11], v[200:203], v[184:187], v[8:11]
    s_waitcnt vmcnt(12)
    s_barrier
    v_mfma_f32_16x16x32_bf16 v[12:15], v[204:207], v[184:187], v[12:15]
    ds_read_b128 v[136:139], v232 offset:0
    v_mfma_f32_16x16x32_bf16 v[16:19], v[208:211], v[184:187], v[16:19]
    ds_read_b64_tr_b16 v[152:153], v235 offset:0
    v_mfma_f32_16x16x32_bf16 v[20:23], v[212:215], v[184:187], v[20:23]
    ds_read_b64_tr_b16 v[154:155], v235 offset:4096
    v_mfma_f32_16x16x32_bf16 v[24:27], v[216:219], v[184:187], v[24:27]
    ds_read_b64_tr_b16 v[156:157], v236 offset:0
    v_mfma_f32_16x16x32_bf16 v[28:31], v[220:223], v[184:187], v[28:31]
    ds_read_b64_tr_b16 v[158:159], v236 offset:4096
    v_mfma_f32_16x16x32_bf16 v[32:35], v[224:227], v[184:187], v[32:35]
    v_mfma_f32_16x16x32_bf16 v[36:39], v[228:231], v[184:187], v[36:39]
    ds_read_b64_tr_b16 v[160:161], v237 offset:0
    v_mfma_f32_16x16x32_bf16 v[40:43], v[200:203], v[188:191], v[40:43]
    ds_read_b64_tr_b16 v[162:163], v237 offset:4096
    v_mfma_f32_16x16x32_bf16 v[44:47], v[204:207], v[188:191], v[44:47]
    ds_read_b64_tr_b16 v[164:165], v238 offset:0
    v_mfma_f32_16x16x32_bf16 v[48:51], v[208:211], v[188:191], v[48:51]
    ds_read_b64_tr_b16 v[166:167], v238 offset:4096
    v_mfma_f32_16x16x32_bf16 v[52:55], v[212:215], v[188:191], v[52:55]
    ds_read_b64_tr_b16 v[168:169], v235 offset:16384
    v_mfma_f32_16x16x32_bf16 v[56:59], v[216:219], v[188:191], v[56:59]
    v_mfma_f32_16x16x32_bf16 v[60:63], v[220:223], v[188:191], v[60:63]
    ds_read_b64_tr_b16 v[170:171], v235 offset:20480
    v_mfma_f32_16x16x32_bf16 v[64:67], v[224:227], v[188:191], v[64:67]
    ds_read_b64_tr_b16 v[172:173], v236 offset:16384
    v_mfma_f32_16x16x32_bf16 v[68:71], v[228:231], v[188:191], v[68:71]
    ds_read_b64_tr_b16 v[174:175], v236 offset:20480
    v_mfma_f32_16x16x32_bf16 v[72:75], v[200:203], v[192:195], v[72:75]
    ds_read_b64_tr_b16 v[176:177], v237 offset:16384
    v_mfma_f32_16x16x32_bf16 v[76:79], v[204:207], v[192:195], v[76:79]
    ds_read_b64_tr_b16 v[178:179], v237 offset:20480
    v_mfma_f32_16x16x32_bf16 v[80:83], v[208:211], v[192:195], v[80:83]
    v_mfma_f32_16x16x32_bf16 v[84:87], v[212:215], v[192:195], v[84:87]
    ds_read_b64_tr_b16 v[180:181], v238 offset:16384
    v_mfma_f32_16x16x32_bf16 v[88:91], v[216:219], v[192:195], v[88:91]
    ds_read_b64_tr_b16 v[182:183], v238 offset:20480
    v_mfma_f32_16x16x32_bf16 v[92:95], v[220:223], v[192:195], v[92:95]
    ds_read_b128 v[140:143], v232 offset:2048
    v_mfma_f32_16x16x32_bf16 v[96:99], v[224:227], v[192:195], v[96:99]
    ds_read_b128 v[144:147], v232 offset:4096
    v_mfma_f32_16x16x32_bf16 v[100:103], v[228:231], v[192:195], v[100:103]
    ds_read_b128 v[148:151], v232 offset:6144
    v_mfma_f32_16x16x32_bf16 v[104:107], v[200:203], v[196:199], v[104:107]
    v_mfma_f32_16x16x32_bf16 v[108:111], v[204:207], v[196:199], v[108:111]
    v_mfma_f32_16x16x32_bf16 v[112:115], v[208:211], v[196:199], v[112:115]
    v_mfma_f32_16x16x32_bf16 v[116:119], v[212:215], v[196:199], v[116:119]
    v_mfma_f32_16x16x32_bf16 v[120:123], v[216:219], v[196:199], v[120:123]
    v_mfma_f32_16x16x32_bf16 v[124:127], v[220:223], v[196:199], v[124:127]
    v_mfma_f32_16x16x32_bf16 v[128:131], v[224:227], v[196:199], v[128:131]
    s_add_u32 s52, s52, 49152
    s_cmp_ge_u32 s52, 147456
    s_cselect_b32 s52, 0, s52
    v_mfma_f32_16x16x32_bf16 v[132:135], v[228:231], v[196:199], v[132:135]
    s_waitcnt lgkmcnt(0)
    v_mfma_f32_16x16x32_bf16 v[8:11], v[152:155], v[136:139], v[8:11]
    ds_read_b128 v[184:187], v232 offset:1024
    v_mfma_f32_16x16x32_bf16 v[12:15], v[156:159], v[136:139], v[12:15]
    ds_read_b64_tr_b16 v[200:201], v235 offset:8192
    v_mfma_f32_16x16x32_bf16 v[16:19], v[160:163], v[136:139], v[16:19]
    ds_read_b64_tr_b16 v[202:203], v235 offset:12288
    v_mfma_f32_16x16x32_bf16 v[20:23], v[164:167], v[136:139], v[20:23]
    ds_read_b64_tr_b16 v[204:205], v236 offset:8192
    v_mfma_f32_16x16x32_bf16 v[24:27], v[168:171], v[136:139], v[24:27]
    v_mfma_f32_16x16x32_bf16 v[28:31], v[172:175], v[136:139], v[28:31]
    ds_read_b64_tr_b16 v[206:207], v236 offset:12288
    v_mfma_f32_16x16x32_bf16 v[32:35], v[176:179], v[136:139], v[32:35]
    ds_read_b64_tr_b16 v[208:209], v237 offset:8192
    v_mfma_f32_16x16x32_bf16 v[36:39], v[180:183], v[136:139], v[36:39]
    ds_read_b64_tr_b16 v[210:211], v237 offset:12288
    v_mfma_f32_16x16x32_bf16 v[40:43], v[152:155], v[140:143], v[40:43]
    ds_read_b64_tr_b16 v[212:213], v238 offset:8192
    v_mfma_f32_16x16x32_bf16 v[44:47], v[156:159], v[140:143], v[44:47]
    v_mfma_f32_16x16x32_bf16 v[48:51], v[160:163], v[140:143], v[48:51]
    ds_read_b64_tr_b16 v[214:215], v238 offset:12288
    v_mfma_f32_16x16x32_bf16 v[52:55], v[164:167], v[140:143], v[52:55]
    ds_read_b64_tr_b16 v[216:217], v235 offset:24576
    v_mfma_f32_16x16x32_bf16 v[56:59], v[168:171], v[140:143], v[56:59]
    ds_read_b64_tr_b16 v[218:219], v235 offset:28672
    v_mfma_f32_16x16x32_bf16 v[60:63], v[172:175], v[140:143], v[60:63]
    ds_read_b64_tr_b16 v[220:221], v236 offset:24576
    v_mfma_f32_16x16x32_bf16 v[64:67], v[176:179], v[140:143], v[64:67]
    v_mfma_f32_16x16x32_bf16 v[68:71], v[180:183], v[140:143], v[68:71]
    ds_read_b64_tr_b16 v[222:223], v236 offset:28672
    v_mfma_f32_16x16x32_bf16 v[72:75], v[152:155], v[144:147], v[72:75]
    ds_read_b64_tr_b16 v[224:225], v237 offset:24576
    v_mfma_f32_16x16x32_bf16 v[76:79], v[156:159], v[144:147], v[76:79]
    ds_read_b64_tr_b16 v[226:227], v237 offset:28672
    v_mfma_f32_16x16x32_bf16 v[80:83], v[160:163], v[144:147], v[80:83]
    ds_read_b64_tr_b16 v[228:229], v238 offset:24576
    v_mfma_f32_16x16x32_bf16 v[84:87], v[164:167], v[144:147], v[84:87]
    v_mfma_f32_16x16x32_bf16 v[88:91], v[168:171], v[144:147], v[88:91]
    ds_read_b64_tr_b16 v[230:231], v238 offset:28672
    v_mfma_f32_16x16x32_bf16 v[92:95], v[172:175], v[144:147], v[92:95]
    ds_read_b128 v[188:191], v232 offset:3072
    v_mfma_f32_16x16x32_bf16 v[96:99], v[176:179], v[144:147], v[96:99]
    ds_read_b128 v[192:195], v232 offset:5120
    v_mfma_f32_16x16x32_bf16 v[100:103], v[180:183], v[144:147], v[100:103]
    ds_read_b128 v[196:199], v232 offset:7168
    v_mfma_f32_16x16x32_bf16 v[104:107], v[152:155], v[148:151], v[104:107]
    v_mfma_f32_16x16x32_bf16 v[108:111], v[156:159], v[148:151], v[108:111]
    v_add_u32 v232, s52, v233
    v_mfma_f32_16x16x32_bf16 v[112:115], v[160:163], v[148:151], v[112:115]
    v_add_u32 v235, s52, v239
    v_mfma_f32_16x16x32_bf16 v[116:119], v[164:167], v[148:151], v[116:119]
    v_add_u32 v236, s52, v240
    v_mfma_f32_16x16x32_bf16 v[120:123], v[168:171], v[148:151], v[120:123]
    v_mfma_f32_16x16x32_bf16 v[124:127], v[172:175], v[148:151], v[124:127]
    v_add_u32 v237, s52, v241
    v_mfma_f32_16x16x32_bf16 v[128:131], v[176:179], v[148:151], v[128:131]
    v_add_u32 v238, s52, v242
    v_mfma_f32_16x16x32_bf16 v[132:135], v[180:183], v[148:151], v[132:135]
    s_waitcnt lgkmcnt(0)
    v_mfma_f32_16x16x32_bf16 v[8:11], v[200:203], v[184:187], v[8:11]
    s_waitcnt vmcnt(0)
    s_barrier
    v_mfma_f32_16x16x32_bf16 v[12:15], v[204:207], v[184:187], v[12:15]
    ds_read_b128 v[136:139], v232 offset:0
    v_mfma_f32_16x16x32_bf16 v[16:19], v[208:211], v[184:187], v[16:19]
    ds_read_b64_tr_b16 v[152:153], v235 offset:0
    v_mfma_f32_16x16x32_bf16 v[20:23], v[212:215], v[184:187], v[20:23]
    ds_read_b64_tr_b16 v[154:155], v235 offset:4096
    v_mfma_f32_16x16x32_bf16 v[24:27], v[216:219], v[184:187], v[24:27]
    ds_read_b64_tr_b16 v[156:157], v236 offset:0
    v_mfma_f32_16x16x32_bf16 v[28:31], v[220:223], v[184:187], v[28:31]
    ds_read_b64_tr_b16 v[158:159], v236 offset:4096
    v_mfma_f32_16x16x32_bf16 v[32:35], v[224:227], v[184:187], v[32:35]
    v_mfma_f32_16x16x32_bf16 v[36:39], v[228:231], v[184:187], v[36:39]
    ds_read_b64_tr_b16 v[160:161], v237 offset:0
    v_mfma_f32_16x16x32_bf16 v[40:43], v[200:203], v[188:191], v[40:43]
    ds_read_b64_tr_b16 v[162:163], v237 offset:4096
    v_mfma_f32_16x16x32_bf16 v[44:47], v[204:207], v[188:191], v[44:47]
    ds_read_b64_tr_b16 v[164:165], v238 offset:0
    v_mfma_f32_16x16x32_bf16 v[48:51], v[208:211], v[188:191], v[48:51]
    ds_read_b64_tr_b16 v[166:167], v238 offset:4096
    v_mfma_f32_16x16x32_bf16 v[52:55], v[212:215], v[188:191], v[52:55]
    ds_read_b64_tr_b16 v[168:169], v235 offset:16384
    v_mfma_f32_16x16x32_bf16 v[56:59], v[216:219], v[188:191], v[56:59]
    v_mfma_f32_16x16x32_bf16 v[60:63], v[220:223], v[188:191], v[60:63]
    ds_read_b64_tr_b16 v[170:171], v235 offset:20480
    v_mfma_f32_16x16x32_bf16 v[64:67], v[224:227], v[188:191], v[64:67]
    ds_read_b64_tr_b16 v[172:173], v236 offset:16384
    v_mfma_f32_16x16x32_bf16 v[68:71], v[228:231], v[188:191], v[68:71]
    ds_read_b64_tr_b16 v[174:175], v236 offset:20480
    v_mfma_f32_16x16x32_bf16 v[72:75], v[200:203], v[192:195], v[72:75]
    ds_read_b64_tr_b16 v[176:177], v237 offset:16384
    v_mfma_f32_16x16x32_bf16 v[76:79], v[204:207], v[192:195], v[76:79]
    ds_read_b64_tr_b16 v[178:179], v237 offset:20480
    v_mfma_f32_16x16x32_bf16 v[80:83], v[208:211], v[192:195], v[80:83]
    v_mfma_f32_16x16x32_bf16 v[84:87], v[212:215], v[192:195], v[84:87]
    ds_read_b64_tr_b16 v[180:181], v238 offset:16384
    v_mfma_f32_16x16x32_bf16 v[88:91], v[216:219], v[192:195], v[88:91]
    ds_read_b64_tr_b16 v[182:183], v238 offset:20480
    v_mfma_f32_16x16x32_bf16 v[92:95], v[220:223], v[192:195], v[92:95]
    ds_read_b128 v[140:143], v232 offset:2048
    v_mfma_f32_16x16x32_bf16 v[96:99], v[224:227], v[192:195], v[96:99]
    ds_read_b128 v[144:147], v232 offset:4096
    v_mfma_f32_16x16x32_bf16 v[100:103], v[228:231], v[192:195], v[100:103]
    ds_read_b128 v[148:151], v232 offset:6144
    v_mfma_f32_16x16x32_bf16 v[104:107], v[200:203], v[196:199], v[104:107]
    v_mfma_f32_16x16x32_bf16 v[108:111], v[204:207], v[196:199], v[108:111]
    v_mfma_f32_16x16x32_bf16 v[112:115], v[208:211], v[196:199], v[112:115]
    v_mfma_f32_16x16x32_bf16 v[116:119], v[212:215], v[196:199], v[116:119]
    v_mfma_f32_16x16x32_bf16 v[120:123], v[216:219], v[196:199], v[120:123]
    v_mfma_f32_16x16x32_bf16 v[124:127], v[220:223], v[196:199], v[124:127]
    v_mfma_f32_16x16x32_bf16 v[128:131], v[224:227], v[196:199], v[128:131]
    s_add_u32 s52, s52, 49152
    s_cmp_ge_u32 s52, 147456
    s_cselect_b32 s52, 0, s52
    v_mfma_f32_16x16x32_bf16 v[132:135], v[228:231], v[196:199], v[132:135]
    s_waitcnt lgkmcnt(0)
    v_mfma_f32_16x16x32_bf16 v[8:11], v[152:155], v[136:139], v[8:11]
    ds_read_b128 v[184:187], v232 offset:1024
    v_mfma_f32_16x16x32_bf16 v[12:15], v[156:159], v[136:139], v[12:15]
    ds_read_b64_tr_b16 v[200:201], v235 offset:8192
    v_mfma_f32_16x16x32_bf16 v[16:19], v[160:163], v[136:139], v[16:19]
    ds_read_b64_tr_b16 v[202:203], v235 offset:12288
    v_mfma_f32_16x16x32_bf16 v[20:23], v[164:167], v[136:139], v[20:23]
    ds_read_b64_tr_b16 v[204:205], v236 offset:8192
    v_mfma_f32_16x16x32_bf16 v[24:27], v[168:171], v[136:139], v[24:27]
    v_mfma_f32_16x16x32_bf16 v[28:31], v[172:175], v[136:139], v[28:31]
    ds_read_b64_tr_b16 v[206:207], v236 offset:12288
    v_mfma_f32_16x16x32_bf16 v[32:35], v[176:179], v[136:139], v[32:35]
    ds_read_b64_tr_b16 v[208:209], v237 offset:8192
    v_mfma_f32_16x16x32_bf16 v[36:39], v[180:183], v[136:139], v[36:39]
    ds_read_b64_tr_b16 v[210:211], v237 offset:12288
    v_mfma_f32_16x16x32_bf16 v[40:43], v[152:155], v[140:143], v[40:43]
    ds_read_b64_tr_b16 v[212:213], v238 offset:8192
    v_mfma_f32_16x16x32_bf16 v[44:47], v[156:159], v[140:143], v[44:47]
    v_mfma_f32_16x16x32_bf16 v[48:51], v[160:163], v[140:143], v[48:51]
    ds_read_b64_tr_b16 v[214:215], v238 offset:12288
    v_mfma_f32_16x16x32_bf16 v[52:55], v[164:167], v[140:143], v[52:55]
    ds_read_b64_tr_b16 v[216:217], v235 offset:24576
    v_mfma_f32_16x16x32_bf16 v[56:59], v[168:171], v[140:143], v[56:59]
    ds_read_b64_tr_b16 v[218:219], v235 offset:28672
    v_mfma_f32_16x16x32_bf16 v[60:63], v[172:175], v[140:143], v[60:63]
    ds_read_b64_tr_b16 v[220:221], v236 offset:24576
    v_mfma_f32_16x16x32_bf16 v[64:67], v[176:179], v[140:143], v[64:67]
    v_mfma_f32_16x16x32_bf16 v[68:71], v[180:183], v[140:143], v[68:71]
    ds_read_b64_tr_b16 v[222:223], v236 offset:28672
    v_mfma_f32_16x16x32_bf16 v[72:75], v[152:155], v[144:147], v[72:75]
    s_movk_i32 s54, 12
mega_kernel_Q_loop4:
    ds_read_b64_tr_b16 v[224:225], v237 offset:24576
    v_mfma_f32_16x16x32_bf16 v[76:79], v[156:159], v[144:147], v[76:79]
    ds_read_b64_tr_b16 v[226:227], v237 offset:28672
    v_mfma_f32_16x16x32_bf16 v[80:83], v[160:163], v[144:147], v[80:83]
    ds_read_b64_tr_b16 v[228:229], v238 offset:24576
    v_mfma_f32_16x16x32_bf16 v[84:87], v[164:167], v[144:147], v[84:87]
    v_mfma_f32_16x16x32_bf16 v[88:91], v[168:171], v[144:147], v[88:91]
    ds_read_b64_tr_b16 v[230:231], v238 offset:28672
    v_mfma_f32_16x16x32_bf16 v[92:95], v[172:175], v[144:147], v[92:95]
    ds_read_b128 v[188:191], v232 offset:3072
    v_mfma_f32_16x16x32_bf16 v[96:99], v[176:179], v[144:147], v[96:99]
    ds_read_b128 v[192:195], v232 offset:5120
    v_mfma_f32_16x16x32_bf16 v[100:103], v[180:183], v[144:147], v[100:103]
    ds_read_b128 v[196:199], v232 offset:7168
    v_mfma_f32_16x16x32_bf16 v[104:107], v[152:155], v[148:151], v[104:107]
    v_mfma_f32_16x16x32_bf16 v[108:111], v[156:159], v[148:151], v[108:111]
    v_add_u32 v232, s52, v233
    v_mfma_f32_16x16x32_bf16 v[112:115], v[160:163], v[148:151], v[112:115]
    v_add_u32 v235, s52, v239
    v_mfma_f32_16x16x32_bf16 v[116:119], v[164:167], v[148:151], v[116:119]
    v_add_u32 v236, s52, v240
    v_mfma_f32_16x16x32_bf16 v[120:123], v[168:171], v[148:151], v[120:123]
    v_mfma_f32_16x16x32_bf16 v[124:127], v[172:175], v[148:151], v[124:127]
    v_add_u32 v237, s52, v241
    v_mfma_f32_16x16x32_bf16 v[128:131], v[176:179], v[148:151], v[128:131]
    v_add_u32 v238, s52, v242
    v_mfma_f32_16x16x32_bf16 v[132:135], v[180:183], v[148:151], v[132:135]
    s_waitcnt lgkmcnt(0)
    v_mfma_f32_16x16x32_bf16 v[8:11], v[200:203], v[184:187], v[8:11]
    s_barrier
    v_mfma_f32_16x16x32_bf16 v[12:15], v[204:207], v[184:187], v[12:15]
    ds_read_b128 v[136:139], v232 offset:0
    v_mfma_f32_16x16x32_bf16 v[16:19], v[208:211], v[184:187], v[16:19]
    ds_read_b64_tr_b16 v[152:153], v235 offset:0
    v_mfma_f32_16x16x32_bf16 v[20:23], v[212:215], v[184:187], v[20:23]
    ds_read_b64_tr_b16 v[154:155], v235 offset:4096
    v_mfma_f32_16x16x32_bf16 v[24:27], v[216:219], v[184:187], v[24:27]
    ds_read_b64_tr_b16 v[156:157], v236 offset:0
    v_mfma_f32_16x16x32_bf16 v[28:31], v[220:223], v[184:187], v[28:31]
    ds_read_b64_tr_b16 v[158:159], v236 offset:4096
    v_mfma_f32_16x16x32_bf16 v[32:35], v[224:227], v[184:187], v[32:35]
    v_mfma_f32_16x16x32_bf16 v[36:39], v[228:231], v[184:187], v[36:39]
    ds_read_b64_tr_b16 v[160:161], v237 offset:0
    v_mfma_f32_16x16x32_bf16 v[40:43], v[200:203], v[188:191], v[40:43]
    ds_read_b64_tr_b16 v[162:163], v237 offset:4096
    v_mfma_f32_16x16x32_bf16 v[44:47], v[204:207], v[188:191], v[44:47]
    ds_read_b64_tr_b16 v[164:165], v238 offset:0
    v_mfma_f32_16x16x32_bf16 v[48:51], v[208:211], v[188:191], v[48:51]
    ds_read_b64_tr_b16 v[166:167], v238 offset:4096
    v_mfma_f32_16x16x32_bf16 v[52:55], v[212:215], v[188:191], v[52:55]
    ds_read_b64_tr_b16 v[168:169], v235 offset:16384
    v_mfma_f32_16x16x32_bf16 v[56:59], v[216:219], v[188:191], v[56:59]
    v_mfma_f32_16x16x32_bf16 v[60:63], v[220:223], v[188:191], v[60:63]
    ds_read_b64_tr_b16 v[170:171], v235 offset:20480
    v_mfma_f32_16x16x32_bf16 v[64:67], v[224:227], v[188:191], v[64:67]
    ds_read_b64_tr_b16 v[172:173], v236 offset:16384
    v_mfma_f32_16x16x32_bf16 v[68:71], v[228:231], v[188:191], v[68:71]
    ds_read_b64_tr_b16 v[174:175], v236 offset:20480
    v_mfma_f32_16x16x32_bf16 v[72:75], v[200:203], v[192:195], v[72:75]
    ds_read_b64_tr_b16 v[176:177], v237 offset:16384
    v_mfma_f32_16x16x32_bf16 v[76:79], v[204:207], v[192:195], v[76:79]
    ds_read_b64_tr_b16 v[178:179], v237 offset:20480
    v_mfma_f32_16x16x32_bf16 v[80:83], v[208:211], v[192:195], v[80:83]
    v_mfma_f32_16x16x32_bf16 v[84:87], v[212:215], v[192:195], v[84:87]
    ds_read_b64_tr_b16 v[180:181], v238 offset:16384
    v_mfma_f32_16x16x32_bf16 v[88:91], v[216:219], v[192:195], v[88:91]
    ds_read_b64_tr_b16 v[182:183], v238 offset:20480
    v_mfma_f32_16x16x32_bf16 v[92:95], v[220:223], v[192:195], v[92:95]
    ds_read_b128 v[140:143], v232 offset:2048
    v_mfma_f32_16x16x32_bf16 v[96:99], v[224:227], v[192:195], v[96:99]
    ds_read_b128 v[144:147], v232 offset:4096
    v_mfma_f32_16x16x32_bf16 v[100:103], v[228:231], v[192:195], v[100:103]
    ds_read_b128 v[148:151], v232 offset:6144
    v_mfma_f32_16x16x32_bf16 v[104:107], v[200:203], v[196:199], v[104:107]
    v_mfma_f32_16x16x32_bf16 v[108:111], v[204:207], v[196:199], v[108:111]
    v_mfma_f32_16x16x32_bf16 v[112:115], v[208:211], v[196:199], v[112:115]
    v_mfma_f32_16x16x32_bf16 v[116:119], v[212:215], v[196:199], v[116:119]
    v_mfma_f32_16x16x32_bf16 v[120:123], v[216:219], v[196:199], v[120:123]
    v_mfma_f32_16x16x32_bf16 v[124:127], v[220:223], v[196:199], v[124:127]
    v_mfma_f32_16x16x32_bf16 v[128:131], v[224:227], v[196:199], v[128:131]
    s_add_u32 s52, s52, 49152
    s_cmp_ge_u32 s52, 147456
    s_cselect_b32 s52, 0, s52
    v_mfma_f32_16x16x32_bf16 v[132:135], v[228:231], v[196:199], v[132:135]
    s_waitcnt lgkmcnt(0)
    v_mfma_f32_16x16x32_bf16 v[8:11], v[152:155], v[136:139], v[8:11]
    ds_read_b128 v[184:187], v232 offset:1024
    v_mfma_f32_16x16x32_bf16 v[12:15], v[156:159], v[136:139], v[12:15]
    ds_read_b64_tr_b16 v[200:201], v235 offset:8192
    v_mfma_f32_16x16x32_bf16 v[16:19], v[160:163], v[136:139], v[16:19]
    ds_read_b64_tr_b16 v[202:203], v235 offset:12288
    v_mfma_f32_16x16x32_bf16 v[20:23], v[164:167], v[136:139], v[20:23]
    ds_read_b64_tr_b16 v[204:205], v236 offset:8192
    v_mfma_f32_16x16x32_bf16 v[24:27], v[168:171], v[136:139], v[24:27]
    v_mfma_f32_16x16x32_bf16 v[28:31], v[172:175], v[136:139], v[28:31]
    ds_read_b64_tr_b16 v[206:207], v236 offset:12288
    v_mfma_f32_16x16x32_bf16 v[32:35], v[176:179], v[136:139], v[32:35]
    ds_read_b64_tr_b16 v[208:209], v237 offset:8192
    v_mfma_f32_16x16x32_bf16 v[36:39], v[180:183], v[136:139], v[36:39]
    ds_read_b64_tr_b16 v[210:211], v237 offset:12288
    v_mfma_f32_16x16x32_bf16 v[40:43], v[152:155], v[140:143], v[40:43]
    ds_read_b64_tr_b16 v[212:213], v238 offset:8192
    v_mfma_f32_16x16x32_bf16 v[44:47], v[156:159], v[140:143], v[44:47]
    v_mfma_f32_16x16x32_bf16 v[48:51], v[160:163], v[140:143], v[48:51]
    ds_read_b64_tr_b16 v[214:215], v238 offset:12288
    v_mfma_f32_16x16x32_bf16 v[52:55], v[164:167], v[140:143], v[52:55]
    ds_read_b64_tr_b16 v[216:217], v235 offset:24576
    v_mfma_f32_16x16x32_bf16 v[56:59], v[168:171], v[140:143], v[56:59]
    ds_read_b64_tr_b16 v[218:219], v235 offset:28672
    v_mfma_f32_16x16x32_bf16 v[60:63], v[172:175], v[140:143], v[60:63]
    ds_read_b64_tr_b16 v[220:221], v236 offset:24576
    v_mfma_f32_16x16x32_bf16 v[64:67], v[176:179], v[140:143], v[64:67]
    v_mfma_f32_16x16x32_bf16 v[68:71], v[180:183], v[140:143], v[68:71]
    s_sub_u32 s54, s54, 1
    ds_read_b64_tr_b16 v[222:223], v236 offset:28672
    v_mfma_f32_16x16x32_bf16 v[72:75], v[152:155], v[144:147], v[72:75]
    s_cbranch_scc0 mega_kernel_Q_loop4
    ds_read_b64_tr_b16 v[224:225], v237 offset:24576
    v_mfma_f32_16x16x32_bf16 v[76:79], v[156:159], v[144:147], v[76:79]
    ds_read_b64_tr_b16 v[226:227], v237 offset:28672
    v_mfma_f32_16x16x32_bf16 v[80:83], v[160:163], v[144:147], v[80:83]
    ds_read_b64_tr_b16 v[228:229], v238 offset:24576
    v_mfma_f32_16x16x32_bf16 v[84:87], v[164:167], v[144:147], v[84:87]
    v_mfma_f32_16x16x32_bf16 v[88:91], v[168:171], v[144:147], v[88:91]
    ds_read_b64_tr_b16 v[230:231], v238 offset:28672
    v_mfma_f32_16x16x32_bf16 v[92:95], v[172:175], v[144:147], v[92:95]
    ds_read_b128 v[188:191], v232 offset:3072
    v_mfma_f32_16x16x32_bf16 v[96:99], v[176:179], v[144:147], v[96:99]
    ds_read_b128 v[192:195], v232 offset:5120
    v_mfma_f32_16x16x32_bf16 v[100:103], v[180:183], v[144:147], v[100:103]
    ds_read_b128 v[196:199], v232 offset:7168
    v_mfma_f32_16x16x32_bf16 v[104:107], v[152:155], v[148:151], v[104:107]
    v_mfma_f32_16x16x32_bf16 v[108:111], v[156:159], v[148:151], v[108:111]
    v_mfma_f32_16x16x32_bf16 v[112:115], v[160:163], v[148:151], v[112:115]
    v_mfma_f32_16x16x32_bf16 v[116:119], v[164:167], v[148:151], v[116:119]
    v_mfma_f32_16x16x32_bf16 v[120:123], v[168:171], v[148:151], v[120:123]
    v_mfma_f32_16x16x32_bf16 v[124:127], v[172:175], v[148:151], v[124:127]
    v_mfma_f32_16x16x32_bf16 v[128:131], v[176:179], v[148:151], v[128:131]
    v_mfma_f32_16x16x32_bf16 v[132:135], v[180:183], v[148:151], v[132:135]
    s_waitcnt lgkmcnt(0)
    v_mfma_f32_16x16x32_bf16 v[8:11], v[200:203], v[184:187], v[8:11]
    s_barrier
    v_mfma_f32_16x16x32_bf16 v[12:15], v[204:207], v[184:187], v[12:15]
    v_mfma_f32_16x16x32_bf16 v[16:19], v[208:211], v[184:187], v[16:19]
    v_mfma_f32_16x16x32_bf16 v[20:23], v[212:215], v[184:187], v[20:23]
    v_mfma_f32_16x16x32_bf16 v[24:27], v[216:219], v[184:187], v[24:27]
    v_mfma_f32_16x16x32_bf16 v[28:31], v[220:223], v[184:187], v[28:31]
    v_mfma_f32_16x16x32_bf16 v[32:35], v[224:227], v[184:187], v[32:35]
    v_mfma_f32_16x16x32_bf16 v[36:39], v[228:231], v[184:187], v[36:39]
    v_mfma_f32_16x16x32_bf16 v[40:43], v[200:203], v[188:191], v[40:43]
    v_mfma_f32_16x16x32_bf16 v[44:47], v[204:207], v[188:191], v[44:47]
    v_mfma_f32_16x16x32_bf16 v[48:51], v[208:211], v[188:191], v[48:51]
    v_mfma_f32_16x16x32_bf16 v[52:55], v[212:215], v[188:191], v[52:55]
    v_mfma_f32_16x16x32_bf16 v[56:59], v[216:219], v[188:191], v[56:59]
    v_mfma_f32_16x16x32_bf16 v[60:63], v[220:223], v[188:191], v[60:63]
    v_mfma_f32_16x16x32_bf16 v[64:67], v[224:227], v[188:191], v[64:67]
    v_mfma_f32_16x16x32_bf16 v[68:71], v[228:231], v[188:191], v[68:71]
    v_mfma_f32_16x16x32_bf16 v[72:75], v[200:203], v[192:195], v[72:75]
    v_mfma_f32_16x16x32_bf16 v[76:79], v[204:207], v[192:195], v[76:79]
    v_mfma_f32_16x16x32_bf16 v[80:83], v[208:211], v[192:195], v[80:83]
    v_mfma_f32_16x16x32_bf16 v[84:87], v[212:215], v[192:195], v[84:87]
    v_mfma_f32_16x16x32_bf16 v[88:91], v[216:219], v[192:195], v[88:91]
    v_mfma_f32_16x16x32_bf16 v[92:95], v[220:223], v[192:195], v[92:95]
    v_mfma_f32_16x16x32_bf16 v[96:99], v[224:227], v[192:195], v[96:99]
    v_mfma_f32_16x16x32_bf16 v[100:103], v[228:231], v[192:195], v[100:103]
    v_mfma_f32_16x16x32_bf16 v[104:107], v[200:203], v[196:199], v[104:107]
    v_mfma_f32_16x16x32_bf16 v[108:111], v[204:207], v[196:199], v[108:111]
    v_mfma_f32_16x16x32_bf16 v[112:115], v[208:211], v[196:199], v[112:115]
    v_mfma_f32_16x16x32_bf16 v[116:119], v[212:215], v[196:199], v[116:119]
    v_mfma_f32_16x16x32_bf16 v[120:123], v[216:219], v[196:199], v[120:123]
    v_mfma_f32_16x16x32_bf16 v[124:127], v[220:223], v[196:199], v[124:127]
    v_mfma_f32_16x16x32_bf16 v[128:131], v[224:227], v[196:199], v[128:131]
    v_mfma_f32_16x16x32_bf16 v[132:135], v[228:231], v[196:199], v[132:135]
mega_kernel_Qjoin:
    s_setprio 0
    s_lshl_b32 s60, s44, 12
    s_add_u32 s61, s60, 163840
    s_add_u32 s53, s60, 65536
    s_add_u32 s66, s50, s51
    s_and_b32 s66, s66, 3
    s_mov_b32 s58, 0xba897645
    s_mov_b32 s59, 0xfecd
    s_cmp_eq_u32 s66, 1
    s_cselect_b32 s58, 0xb9a87564, s58
    s_cselect_b32 s59, 0xfdec, s59
    s_cmp_eq_u32 s66, 2
    s_cselect_b32 s58, 0xab986754, s58
    s_cselect_b32 s59, 0xefdc, s59
    s_cmp_eq_u32 s66, 3
    s_cselect_b32 s58, 0xca978653, s58
    s_cselect_b32 s59, 0xfedb, s59
    s_cmp_eq_u32 s49, 0
    s_cselect_b32 s55, 16, 0
    s_mov_b32 s32, s16
    s_mov_b32 s33, s17
    s_mov_b32 s34, 0x700000
    s_mov_b32 s35, 0x20000
    s_lshr_b32 s62, s48, 2
    s_sub_u32 s62, s48, s62
    s_add_u32 s62, s62, 16
    s_lshl_b32 s70, s62, 12
    s_lshl_b32 s64, s47, 3
    s_lshl_b32 s65, s45, 2
    s_add_u32 s64, s64, s65
    s_mul_i32 s64, s64, 114688
    s_add_u32 s64, s64, s70
    s_lshl_b32 s65, s46, 11
    s_add_u32 s64, s64, s65
    s_add_u32 s64, s64, 0x1500000
    s_or_b32 s64, s64, s69
    v_lshl_add_u32 v198, v1, 4, s64
    v_mul_f32 v24, v8, v24
    v_exp_f32 v216, -v8
    v_mul_f32 v25, v9, v25
    v_exp_f32 v217, -v9
    v_mul_f32 v26, v10, v26
    v_exp_f32 v218, -v10
    v_mul_f32 v27, v11, v27
    v_exp_f32 v219, -v11
    v_mul_f32 v28, v12, v28
    v_exp_f32 v220, -v12
    v_mul_f32 v29, v13, v29
    v_exp_f32 v221, -v13
    v_mul_f32 v30, v14, v30
    v_exp_f32 v222, -v14
    v_mul_f32 v31, v15, v31
    v_exp_f32 v223, -v15
    v_fma_f32 v216, v216, s67, s67
    v_fma_f32 v217, v217, s67, s67
    v_rcp_f32 v216, v216
    v_fma_f32 v218, v218, s67, s67
    v_rcp_f32 v217, v217
    v_fma_f32 v219, v219, s67, s67
    v_rcp_f32 v218, v218
    v_fma_f32 v220, v220, s67, s67
    v_rcp_f32 v219, v219
    v_fma_f32 v221, v221, s67, s67
    v_rcp_f32 v220, v220
    v_fma_f32 v222, v222, s67, s67
    v_rcp_f32 v221, v221
    v_fma_f32 v223, v223, s67, s67
    s_mul_i32 s62, s49, 0
    s_mul_i32 s63, s49, 8
    s_barrier
    s_and_b32 s57, s58, 15
    s_lshr_b64 s[58:59], s[58:59], 4
    s_add_u32 s57, s57, s55
    s_lshl_b32 s56, s57, 11
    s_mul_i32 s57, s57, 0x20000
    s_add_u32 m0, s53, 16384
    s_nop 0
    buffer_load_dwordx4 v248, s[32:35], s57 offen offset:0 lds
    v_rcp_f32 v222, v222
    v_rcp_f32 v223, v223
    v_mul_f32 v24, v24, v216
    v_mul_f32 v25, v25, v217
    v_mul_f32 v26, v26, v218
    v_mul_f32 v27, v27, v219
    v_mul_f32 v28, v28, v220
    v_mul_f32 v29, v29, v221
    buffer_load_dwordx4 v249, s[32:35], s57 offen offset:1024 lds
    v_mul_f32 v30, v30, v222
    v_mul_f32 v31, v31, v223
    v_cvt_pk_bf16_f32 v200, v24, v25
    v_cvt_pk_bf16_f32 v201, v26, v27
    v_cvt_pk_bf16_f32 v202, v28, v29
    v_cvt_pk_bf16_f32 v203, v30, v31
    v_mul_f32 v32, v16, v32
    buffer_load_dwordx4 v250, s[32:35], s57 offen offset:2048 lds
    v_exp_f32 v224, -v16
    v_mul_f32 v33, v17, v33
    v_exp_f32 v225, -v17
    v_mul_f32 v34, v18, v34
    v_exp_f32 v226, -v18
    v_mul_f32 v35, v19, v35
    v_exp_f32 v227, -v19
    v_mul_f32 v36, v20, v36
    buffer_load_dwordx4 v251, s[32:35], s57 offen offset:3072 lds
    v_exp_f32 v228, -v20
    v_mul_f32 v37, v21, v37
    v_exp_f32 v229, -v21
    v_mul_f32 v38, v22, v38
    v_exp_f32 v230, -v22
    v_mul_f32 v39, v23, v39
    v_exp_f32 v231, -v23
    v_fma_f32 v224, v224, s67, s67
    s_mov_b32 m0, s53
    s_nop 0
    buffer_load_dwordx4 v246, s[28:31], s56 offen offset:0 lds
    v_fma_f32 v225, v225, s67, s67
    v_rcp_f32 v224, v224
    v_fma_f32 v226, v226, s67, s67
    v_rcp_f32 v225, v225
    v_fma_f32 v227, v227, s67, s67
    v_rcp_f32 v226, v226
    v_fma_f32 v228, v228, s67, s67
    v_rcp_f32 v227, v227
    buffer_load_dwordx4 v246, s[28:31], s56 offen offset:1024 lds
    v_fma_f32 v229, v229, s67, s67
    v_rcp_f32 v228, v228
    v_fma_f32 v230, v230, s67, s67
    v_rcp_f32 v229, v229
    v_fma_f32 v231, v231, s67, s67
    v_rcp_f32 v230, v230
    v_rcp_f32 v231, v231
    v_mul_f32 v32, v32, v224
    buffer_load_dwordx4 v247, s[28:31], s56 offen offset:2048 lds
    v_mul_f32 v33, v33, v225
    v_mul_f32 v34, v34, v226
    v_mul_f32 v35, v35, v227
    v_mul_f32 v36, v36, v228
    v_mul_f32 v37, v37, v229
    v_mul_f32 v38, v38, v230
    v_mul_f32 v39, v39, v231
    v_cvt_pk_bf16_f32 v204, v32, v33
    buffer_load_dwordx4 v247, s[28:31], s56 offen offset:3072 lds
    v_cvt_pk_bf16_f32 v205, v34, v35
    v_cvt_pk_bf16_f32 v206, v36, v37
    v_cvt_pk_bf16_f32 v207, v38, v39
    v_mul_f32 v56, v40, v56
    v_exp_f32 v216, -v40
    v_mul_f32 v57, v41, v57
    s_add_u32 s53, s53, 32768
    s_cmp_ge_u32 s53, s61
    s_cselect_b32 s53, s60, s53
    buffer_store_dwordx4 v[200:203], v198, s[28:31], 0 offen offset:0 sc1
    buffer_store_dwordx4 v[204:207], v198, s[28:31], 0 offen offset:1024 sc1
    v_add_u32 v198, 114688, v198
    s_barrier
    s_and_b32 s57, s58, 15
    s_lshr_b64 s[58:59], s[58:59], 4
    s_add_u32 s57, s57, s55
    s_lshl_b32 s56, s57, 11
    s_mul_i32 s57, s57, 0x20000
    s_add_u32 m0, s53, 16384
    s_nop 0
    buffer_load_dwordx4 v248, s[32:35], s57 offen offset:0 lds
    v_exp_f32 v217, -v41
    v_mul_f32 v58, v42, v58
    v_exp_f32 v218, -v42
    v_mul_f32 v59, v43, v59
    v_exp_f32 v219, -v43
    v_mul_f32 v60, v44, v60
    v_exp_f32 v220, -v44
    v_mul_f32 v61, v45, v61
    buffer_load_dwordx4 v249, s[32:35], s57 offen offset:1024 lds
    v_exp_f32 v221, -v45
    v_mul_f32 v62, v46, v62
    v_exp_f32 v222, -v46
    v_mul_f32 v63, v47, v63
    v_exp_f32 v223, -v47
    v_fma_f32 v216, v216, s67, s67
    v_fma_f32 v217, v217, s67, s67
    v_rcp_f32 v216, v216
    buffer_load_dwordx4 v250, s[32:35], s57 offen offset:2048 lds
    v_fma_f32 v218, v218, s67, s67
    v_rcp_f32 v217, v217
    v_fma_f32 v219, v219, s67, s67
    v_rcp_f32 v218, v218
    v_fma_f32 v220, v220, s67, s67
    v_rcp_f32 v219, v219
    v_fma_f32 v221, v221, s67, s67
    v_rcp_f32 v220, v220
    buffer_load_dwordx4 v251, s[32:35], s57 offen offset:3072 lds
    v_fma_f32 v222, v222, s67, s67
    v_rcp_f32 v221, v221
    v_fma_f32 v223, v223, s67, s67
    v_rcp_f32 v222, v222
    v_rcp_f32 v223, v223
    v_mul_f32 v56, v56, v216
    v_mul_f32 v57, v57, v217
    v_mul_f32 v58, v58, v218
    s_mov_b32 m0, s53
    s_nop 0
    buffer_load_dwordx4 v246, s[28:31], s56 offen offset:0 lds
    v_mul_f32 v59, v59, v219
    v_mul_f32 v60, v60, v220
    v_mul_f32 v61, v61, v221
    v_mul_f32 v62, v62, v222
    v_mul_f32 v63, v63, v223
    v_cvt_pk_bf16_f32 v208, v56, v57
    v_cvt_pk_bf16_f32 v209, v58, v59
    v_cvt_pk_bf16_f32 v210, v60, v61
    buffer_load_dwordx4 v246, s[28:31], s56 offen offset:1024 lds
    v_cvt_pk_bf16_f32 v211, v62, v63
    v_mul_f32 v64, v48, v64
    v_exp_f32 v224, -v48
    v_mul_f32 v65, v49, v65
    v_exp_f32 v225, -v49
    v_mul_f32 v66, v50, v66
    v_exp_f32 v226, -v50
    buffer_load_dwordx4 v247, s[28:31], s56 offen offset:2048 lds
    v_mul_f32 v67, v51, v67
    v_exp_f32 v227, -v51
    v_mul_f32 v68, v52, v68
    v_exp_f32 v228, -v52
    v_mul_f32 v69, v53, v69
    v_exp_f32 v229, -v53
    v_mul_f32 v70, v54, v70
    v_exp_f32 v230, -v54
    buffer_load_dwordx4 v247, s[28:31], s56 offen offset:3072 lds
    v_mul_f32 v71, v55, v71
    v_exp_f32 v231, -v55
    v_fma_f32 v224, v224, s67, s67
    v_fma_f32 v225, v225, s67, s67
    v_rcp_f32 v224, v224
    v_fma_f32 v226, v226, s67, s67
    v_rcp_f32 v225, v225
    v_fma_f32 v227, v227, s67, s67
    s_add_u32 s53, s53, 32768
    s_cmp_ge_u32 s53, s61
    s_cselect_b32 s53, s60, s53
    buffer_store_dwordx4 v[208:211], v198, s[28:31], 0 offen offset:0 sc1
    s_barrier
    s_and_b32 s57, s58, 15
    s_lshr_b64 s[58:59], s[58:59], 4
    s_add_u32 s57, s57, s55
    s_lshl_b32 s56, s57, 11
    s_mul_i32 s57, s57, 0x20000
    s_add_u32 m0, s53, 16384
    s_nop 0
    buffer_load_dwordx4 v248, s[32:35], s57 offen offset:0 lds
    v_rcp_f32 v226, v226
    v_fma_f32 v228, v228, s67, s67
    v_rcp_f32 v227, v227
    v_fma_f32 v229, v229, s67, s67
    v_rcp_f32 v228, v228
    v_fma_f32 v230, v230, s67, s67
    v_rcp_f32 v229, v229
    v_fma_f32 v231, v231, s67, s67
    buffer_load_dwordx4 v249, s[32:35], s57 offen offset:1024 lds
    v_rcp_f32 v230, v230
    v_rcp_f32 v231, v231
    v_mul_f32 v64, v64, v224
    v_mul_f32 v65, v65, v225
    v_mul_f32 v66, v66, v226
    v_mul_f32 v67, v67, v227
    v_mul_f32 v68, v68, v228
    v_mul_f32 v69, v69, v229
    buffer_load_dwordx4 v250, s[32:35], s57 offen offset:2048 lds
    v_mul_f32 v70, v70, v230
    v_mul_f32 v71, v71, v231
    v_cvt_pk_bf16_f32 v212, v64, v65
    v_cvt_pk_bf16_f32 v213, v66, v67
    v_cvt_pk_bf16_f32 v214, v68, v69
    v_cvt_pk_bf16_f32 v215, v70, v71
    buffer_load_dwordx4 v251, s[32:35], s57 offen offset:3072 lds
    v_mul_f32 v88, v72, v88
    v_exp_f32 v216, -v72
    v_mul_f32 v89, v73, v89
    v_exp_f32 v217, -v73
    v_mul_f32 v90, v74, v90
    v_exp_f32 v218, -v74
    v_mul_f32 v91, v75, v91
    v_exp_f32 v219, -v75
    s_mov_b32 m0, s53
    s_nop 0
    buffer_load_dwordx4 v246, s[28:31], s56 offen offset:0 lds
    v_mul_f32 v92, v76, v92
    v_exp_f32 v220, -v76
    v_mul_f32 v93, v77, v93
    v_exp_f32 v221, -v77
    v_mul_f32 v94, v78, v94
    v_exp_f32 v222, -v78
    v_mul_f32 v95, v79, v95
    v_exp_f32 v223, -v79
    buffer_load_dwordx4 v246, s[28:31], s56 offen offset:1024 lds
    v_fma_f32 v216, v216, s67, s67
    v_fma_f32 v217, v217, s67, s67
    v_rcp_f32 v216, v216
    v_fma_f32 v218, v218, s67, s67
    v_rcp_f32 v217, v217
    v_fma_f32 v219, v219, s67, s67
    v_rcp_f32 v218, v218
    v_fma_f32 v220, v220, s67, s67
    buffer_load_dwordx4 v247, s[28:31], s56 offen offset:2048 lds
    v_rcp_f32 v219, v219
    v_fma_f32 v221, v221, s67, s67
    v_rcp_f32 v220, v220
    v_fma_f32 v222, v222, s67, s67
    v_rcp_f32 v221, v221
    v_fma_f32 v223, v223, s67, s67
    v_rcp_f32 v222, v222
    v_rcp_f32 v223, v223
    buffer_load_dwordx4 v247, s[28:31], s56 offen offset:3072 lds
    v_mul_f32 v88, v88, v216
    v_mul_f32 v89, v89, v217
    v_mul_f32 v90, v90, v218
    v_mul_f32 v91, v91, v219
    v_mul_f32 v92, v92, v220
    v_mul_f32 v93, v93, v221
    v_mul_f32 v94, v94, v222
    v_mul_f32 v95, v95, v223
    s_add_u32 s53, s53, 32768
    s_cmp_ge_u32 s53, s61
    s_cselect_b32 s53, s60, s53
    buffer_store_dwordx4 v[212:215], v198, s[28:31], 0 offen offset:1024 sc1
    v_add_u32 v198, 114688, v198
    s_waitcnt vmcnt(20)
    s_barrier
    s_and_b32 s57, s58, 15
    s_lshr_b64 s[58:59], s[58:59], 4
    s_add_u32 s57, s57, s55
    s_lshl_b32 s56, s57, 11
    s_mul_i32 s57, s57, 0x20000
    s_add_u32 m0, s53, 16384
    s_nop 0
    buffer_load_dwordx4 v248, s[32:35], s57 offen offset:0 lds
    v_cvt_pk_bf16_f32 v200, v88, v89
    v_cvt_pk_bf16_f32 v201, v90, v91
    v_cvt_pk_bf16_f32 v202, v92, v93
    v_cvt_pk_bf16_f32 v203, v94, v95
    v_mul_f32 v96, v80, v96
    v_exp_f32 v224, -v80
    v_mul_f32 v97, v81, v97
    buffer_load_dwordx4 v249, s[32:35], s57 offen offset:1024 lds
    v_exp_f32 v225, -v81
    v_mul_f32 v98, v82, v98
    v_exp_f32 v226, -v82
    v_mul_f32 v99, v83, v99
    v_exp_f32 v227, -v83
    v_mul_f32 v100, v84, v100
    v_exp_f32 v228, -v84
    v_mul_f32 v101, v85, v101
    buffer_load_dwordx4 v250, s[32:35], s57 offen offset:2048 lds
    v_exp_f32 v229, -v85
    v_mul_f32 v102, v86, v102
    v_exp_f32 v230, -v86
    v_mul_f32 v103, v87, v103
    v_exp_f32 v231, -v87
    v_fma_f32 v224, v224, s67, s67
    v_fma_f32 v225, v225, s67, s67
    v_rcp_f32 v224, v224
    buffer_load_dwordx4 v251, s[32:35], s57 offen offset:3072 lds
    v_fma_f32 v226, v226, s67, s67
    v_rcp_f32 v225, v225
    v_fma_f32 v227, v227, s67, s67
    v_rcp_f32 v226, v226
    v_fma_f32 v228, v228, s67, s67
    v_rcp_f32 v227, v227
    v_fma_f32 v229, v229, s67, s67
    v_rcp_f32 v228, v228
    s_mov_b32 m0, s53
    s_nop 0
    buffer_load_dwordx4 v246, s[28:31], s56 offen offset:0 lds
    v_fma_f32 v230, v230, s67, s67
    v_rcp_f32 v229, v229
    v_fma_f32 v231, v231, s67, s67
    v_rcp_f32 v230, v230
    v_rcp_f32 v231, v231
    v_mul_f32 v96, v96, v224
    v_mul_f32 v97, v97, v225
    v_mul_f32 v98, v98, v226
    buffer_load_dwordx4 v246, s[28:31], s56 offen offset:1024 lds
    v_mul_f32 v99, v99, v227
    v_mul_f32 v100, v100, v228
    v_mul_f32 v101, v101, v229
    v_mul_f32 v102, v102, v230
    v_mul_f32 v103, v103, v231
    v_cvt_pk_bf16_f32 v204, v96, v97
    v_cvt_pk_bf16_f32 v205, v98, v99
    v_cvt_pk_bf16_f32 v206, v100, v101
    buffer_load_dwordx4 v247, s[28:31], s56 offen offset:2048 lds
    v_cvt_pk_bf16_f32 v207, v102, v103
    v_mul_f32 v120, v104, v120
    v_exp_f32 v216, -v104
    v_mul_f32 v121, v105, v121
    v_exp_f32 v217, -v105
    v_mul_f32 v122, v106, v122
    buffer_load_dwordx4 v247, s[28:31], s56 offen offset:3072 lds
    v_exp_f32 v218, -v106
    v_mul_f32 v123, v107, v123
    v_exp_f32 v219, -v107
    v_mul_f32 v124, v108, v124
    v_exp_f32 v220, -v108
    v_mul_f32 v125, v109, v125
    v_exp_f32 v221, -v109
    v_mul_f32 v126, v110, v126
    s_add_u32 s53, s53, 32768
    s_cmp_ge_u32 s53, s61
    s_cselect_b32 s53, s60, s53
    buffer_store_dwordx4 v[200:203], v198, s[28:31], 0 offen offset:0 sc1
    buffer_store_dwordx4 v[204:207], v198, s[28:31], 0 offen offset:1024 sc1
    v_add_u32 v198, 114688, v198
    s_waitcnt vmcnt(20)
    s_barrier
    s_and_b32 s57, s58, 15
    s_lshr_b64 s[58:59], s[58:59], 4
    s_add_u32 s57, s57, s55
    s_lshl_b32 s56, s57, 11
    s_mul_i32 s57, s57, 0x20000
    s_add_u32 m0, s53, 16384
    s_nop 0
    buffer_load_dwordx4 v248, s[32:35], s57 offen offset:0 lds
    v_exp_f32 v222, -v110
    v_mul_f32 v127, v111, v127
    v_exp_f32 v223, -v111
    v_fma_f32 v216, v216, s67, s67
    v_fma_f32 v217, v217, s67, s67
    v_rcp_f32 v216, v216
    v_fma_f32 v218, v218, s67, s67
    v_rcp_f32 v217, v217
    buffer_load_dwordx4 v249, s[32:35], s57 offen offset:1024 lds
    v_fma_f32 v219, v219, s67, s67
    v_rcp_f32 v218, v218
    v_fma_f32 v220, v220, s67, s67
    v_rcp_f32 v219, v219
    v_fma_f32 v221, v221, s67, s67
    v_rcp_f32 v220, v220
    v_fma_f32 v222, v222, s67, s67
    v_rcp_f32 v221, v221
    buffer_load_dwordx4 v250, s[32:35], s57 offen offset:2048 lds
    v_fma_f32 v223, v223, s67, s67
    v_rcp_f32 v222, v222
    v_rcp_f32 v223, v223
    v_mul_f32 v120, v120, v216
    v_mul_f32 v121, v121, v217
    v_mul_f32 v122, v122, v218
    v_mul_f32 v123, v123, v219
    v_mul_f32 v124, v124, v220
    buffer_load_dwordx4 v251, s[32:35], s57 offen offset:3072 lds
    v_mul_f32 v125, v125, v221
    v_mul_f32 v126, v126, v222
    v_mul_f32 v127, v127, v223
    v_cvt_pk_bf16_f32 v208, v120, v121
    v_cvt_pk_bf16_f32 v209, v122, v123
    v_cvt_pk_bf16_f32 v210, v124, v125
    v_cvt_pk_bf16_f32 v211, v126, v127
    s_mov_b32 m0, s53
    s_nop 0
    buffer_load_dwordx4 v246, s[28:31], s56 offen offset:0 lds
    v_mul_f32 v128, v112, v128
    v_exp_f32 v224, -v112
    v_mul_f32 v129, v113, v129
    v_exp_f32 v225, -v113
    v_mul_f32 v130, v114, v130
    v_exp_f32 v226, -v114
    v_mul_f32 v131, v115, v131
    v_exp_f32 v227, -v115
    buffer_load_dwordx4 v246, s[28:31], s56 offen offset:1024 lds
    v_mul_f32 v132, v116, v132
    v_exp_f32 v228, -v116
    v_mul_f32 v133, v117, v133
    v_exp_f32 v229, -v117
    v_mul_f32 v134, v118, v134
    v_exp_f32 v230, -v118
    v_mul_f32 v135, v119, v135
    v_exp_f32 v231, -v119
    buffer_load_dwordx4 v247, s[28:31], s56 offen offset:2048 lds
    v_fma_f32 v224, v224, s67, s67
    v_fma_f32 v225, v225, s67, s67
    v_rcp_f32 v224, v224
    v_fma_f32 v226, v226, s67, s67
    v_rcp_f32 v225, v225
    v_fma_f32 v227, v227, s67, s67
    v_rcp_f32 v226, v226
    v_fma_f32 v228, v228, s67, s67
    buffer_load_dwordx4 v247, s[28:31], s56 offen offset:3072 lds
    v_rcp_f32 v227, v227
    v_fma_f32 v229, v229, s67, s67
    v_rcp_f32 v228, v228
    v_fma_f32 v230, v230, s67, s67
    v_rcp_f32 v229, v229
    v_fma_f32 v231, v231, s67, s67
    v_rcp_f32 v230, v230
    v_rcp_f32 v231, v231
    s_add_u32 s53, s53, 32768
    s_cmp_ge_u32 s53, s61
    s_cselect_b32 s53, s60, s53
    buffer_store_dwordx4 v[208:211], v198, s[28:31], 0 offen offset:0 sc1
    s_waitcnt vmcnt(20)
    s_barrier
    s_and_b32 s57, s58, 15
    s_lshr_b64 s[58:59], s[58:59], 4
    s_add_u32 s57, s57, s55
    s_lshl_b32 s56, s57, 11
    s_mul_i32 s57, s57, 0x20000
    s_add_u32 m0, s53, 16384
    s_nop 0
    buffer_load_dwordx4 v248, s[32:35], s57 offen offset:0 lds
    v_mul_f32 v128, v128, v224
    v_mul_f32 v129, v129, v225
    v_mul_f32 v130, v130, v226
    v_mul_f32 v131, v131, v227
    v_mul_f32 v132, v132, v228
    v_mul_f32 v133, v133, v229
    v_mul_f32 v134, v134, v230
    v_mul_f32 v135, v135, v231
    buffer_load_dwordx4 v249, s[32:35], s57 offen offset:1024 lds
    v_cvt_pk_bf16_f32 v212, v128, v129
    v_cvt_pk_bf16_f32 v213, v130, v131
    v_cvt_pk_bf16_f32 v214, v132, v133
    v_cvt_pk_bf16_f32 v215, v134, v135
    buffer_load_dwordx4 v250, s[32:35], s57 offen offset:2048 lds
    buffer_load_dwordx4 v251, s[32:35], s57 offen offset:3072 lds
    s_mov_b32 m0, s53
    s_nop 0
    buffer_load_dwordx4 v246, s[28:31], s56 offen offset:0 lds
    buffer_load_dwordx4 v246, s[28:31], s56 offen offset:1024 lds
    buffer_load_dwordx4 v247, s[28:31], s56 offen offset:2048 lds
    buffer_load_dwordx4 v247, s[28:31], s56 offen offset:3072 lds
    s_add_u32 s53, s53, 32768
    s_cmp_ge_u32 s53, s61
    s_cselect_b32 s53, s60, s53
    buffer_store_dwordx4 v[212:215], v198, s[28:31], 0 offen offset:1024 sc1
    s_waitcnt vmcnt(20)
    s_barrier
    s_and_b32 s57, s58, 15
    s_lshr_b64 s[58:59], s[58:59], 4
    s_add_u32 s57, s57, s55
    s_lshl_b32 s56, s57, 11
    s_mul_i32 s57, s57, 0x20000
    s_add_u32 m0, s53, 16384
    s_nop 0
    buffer_load_dwordx4 v248, s[32:35], s57 offen offset:0 lds
    buffer_load_dwordx4 v249, s[32:35], s57 offen offset:1024 lds
    buffer_load_dwordx4 v250, s[32:35], s57 offen offset:2048 lds
    buffer_load_dwordx4 v251, s[32:35], s57 offen offset:3072 lds
    s_mov_b32 m0, s53
    s_nop 0
    buffer_load_dwordx4 v246, s[28:31], s56 offen offset:0 lds
    buffer_load_dwordx4 v246, s[28:31], s56 offen offset:1024 lds
    buffer_load_dwordx4 v247, s[28:31], s56 offen offset:2048 lds
    buffer_load_dwordx4 v247, s[28:31], s56 offen offset:3072 lds
    s_add_u32 s53, s53, 32768
    s_cmp_ge_u32 s53, s61
    s_cselect_b32 s53, s60, s53
    s_lshl_b32 s64, s47, 8
    s_lshl_b32 s65, s48, 4
    s_add_u32 s64, s64, s65
    s_lshl_b32 s65, s44, 2
    s_add_u32 s64, s64, s65
    s_add_u32 s64, s64, 0x52000
    v_mov_b32 v2, 1
    s_waitcnt vmcnt(8)
    s_mov_b64 exec, 1
    buffer_store_dword v2, v234, s[28:31], s64 offen sc1
    s_mov_b64 exec, -1
    s_movk_i32 s54, 1
mega_kernel_Q_loop5:
    s_barrier
    s_and_b32 s57, s58, 15
    s_lshr_b64 s[58:59], s[58:59], 4
    s_add_u32 s57, s57, s55
    s_lshl_b32 s56, s57, 11
    s_mul_i32 s57, s57, 0x20000
    s_add_u32 m0, s53, 16384
    s_nop 0
    buffer_load_dwordx4 v248, s[32:35], s57 offen offset:0 lds
    buffer_load_dwordx4 v249, s[32:35], s57 offen offset:1024 lds
    buffer_load_dwordx4 v250, s[32:35], s57 offen offset:2048 lds
    buffer_load_dwordx4 v251, s[32:35], s57 offen offset:3072 lds
    s_mov_b32 m0, s53
    s_nop 0
    buffer_load_dwordx4 v246, s[28:31], s56 offen offset:0 lds
    buffer_load_dwordx4 v246, s[28:31], s56 offen offset:1024 lds
    buffer_load_dwordx4 v247, s[28:31], s56 offen offset:2048 lds
    buffer_load_dwordx4 v247, s[28:31], s56 offen offset:3072 lds
    s_add_u32 s53, s53, 32768
    s_cmp_ge_u32 s53, s61
    s_cselect_b32 s53, s60, s53
    s_sub_u32 s54, s54, 1
    s_cbranch_scc0 mega_kernel_Q_loop5
    s_waitcnt vmcnt(17)
    s_barrier
    s_and_b32 s57, s58, 15
    s_lshr_b64 s[58:59], s[58:59], 4
    s_add_u32 s57, s57, s55
    s_lshl_b32 s56, s57, 11
    s_mul_i32 s57, s57, 0x20000
    s_add_u32 m0, s53, 16384
    s_nop 0
    buffer_load_dwordx4 v248, s[32:35], s57 offen offset:0 lds
    buffer_load_dwordx4 v249, s[32:35], s57 offen offset:1024 lds
    buffer_load_dwordx4 v250, s[32:35], s57 offen offset:2048 lds
    buffer_load_dwordx4 v251, s[32:35], s57 offen offset:3072 lds
    s_mov_b32 m0, s53
    s_nop 0
    buffer_load_dwordx4 v246, s[28:31], s56 offen offset:0 lds
    buffer_load_dwordx4 v246, s[28:31], s56 offen offset:1024 lds
    buffer_load_dwordx4 v247, s[28:31], s56 offen offset:2048 lds
    buffer_load_dwordx4 v247, s[28:31], s56 offen offset:3072 lds
    s_add_u32 s53, s53, 32768
    s_cmp_ge_u32 s53, s61
    s_cselect_b32 s53, s60, s53
    s_waitcnt vmcnt(16)
    s_barrier
    s_and_b32 s57, s58, 15
    s_lshr_b64 s[58:59], s[58:59], 4
    s_add_u32 s57, s57, s55
    s_lshl_b32 s56, s57, 11
    s_mul_i32 s57, s57, 0x20000
    s_add_u32 m0, s53, 16384
    s_nop 0
    buffer_load_dwordx4 v248, s[32:35], s57 offen offset:0 lds
    buffer_load_dwordx4 v249, s[32:35], s57 offen offset:1024 lds
    buffer_load_dwordx4 v250, s[32:35], s57 offen offset:2048 lds
    buffer_load_dwordx4 v251, s[32:35], s57 offen offset:3072 lds
    s_mov_b32 m0, s53
    s_nop 0
    buffer_load_dwordx4 v246, s[28:31], s56 offen offset:0 lds
    buffer_load_dwordx4 v246, s[28:31], s56 offen offset:1024 lds
    buffer_load_dwordx4 v247, s[28:31], s56 offen offset:2048 lds
    buffer_load_dwordx4 v247, s[28:31], s56 offen offset:3072 lds
    s_add_u32 s53, s53, 32768
    s_cmp_ge_u32 s53, s61
    s_cselect_b32 s53, s60, s53
    s_waitcnt vmcnt(16)
    s_barrier
    s_lshl_b32 s68, s50, 8
    s_add_u32 s68, s68, 0x52000
    buffer_load_dword v245, v234, s[28:31], s68 offen sc1
    s_and_b32 s57, s58, 15
    s_lshr_b64 s[58:59], s[58:59], 4
    s_add_u32 s57, s57, s55
    s_lshl_b32 s56, s57, 11
    s_mul_i32 s57, s57, 0x20000
    s_add_u32 m0, s53, 16384
    s_nop 0
    buffer_load_dwordx4 v248, s[32:35], s57 offen offset:0 lds
    buffer_load_dwordx4 v249, s[32:35], s57 offen offset:1024 lds
    buffer_load_dwordx4 v250, s[32:35], s57 offen offset:2048 lds
    buffer_load_dwordx4 v251, s[32:35], s57 offen offset:3072 lds
    s_mov_b32 m0, s53
    s_nop 0
    buffer_load_dwordx4 v246, s[28:31], s56 offen offset:0 lds
    buffer_load_dwordx4 v246, s[28:31], s56 offen offset:1024 lds
    buffer_load_dwordx4 v247, s[28:31], s56 offen offset:2048 lds
    buffer_load_dwordx4 v247, s[28:31], s56 offen offset:3072 lds
    s_add_u32 s53, s53, 32768
    s_cmp_ge_u32 s53, s61
    s_cselect_b32 s53, s60, s53
    s_waitcnt vmcnt(17)
    s_barrier
    s_waitcnt vmcnt(8)
    s_mov_b32 s3, 0x40000
mega_kernel_pb_chk:
    v_cmp_ne_u32 vcc, 1, v245
    s_nop 4
    s_cbranch_vccz mega_kernel_pb_ok
    s_sub_u32 s3, s3, 1
    s_cbranch_scc1 mega_kernel_pb_ok
    s_sleep 4
    s_cmp_eq_u32 s69, 0
    s_cbranch_scc1 mega_kernel_pb_rl
    s_sleep 48
mega_kernel_pb_rl:
    buffer_load_dword v245, v234, s[28:31], s68 offen sc1
    s_waitcnt vmcnt(0)
    s_branch mega_kernel_pb_chk
mega_kernel_pb_ok:
    s_add_u32 s66, s50, s51
    s_and_b32 s66, s66, 3
    s_mov_b32 s58, 0x76453201
    s_mov_b32 s59, 0xfecdba89
    s_cmp_eq_u32 s66, 1
    s_cselect_b32 s58, 0x75643120, s58
    s_cselect_b32 s59, 0xfdecb9a8, s59
    s_cmp_eq_u32 s66, 2
    s_cselect_b32 s58, 0x67542310, s58
    s_cselect_b32 s59, 0xefdcab98, s59
    s_cmp_eq_u32 s66, 3
    s_cselect_b32 s58, 0x86534210, s58
    s_cselect_b32 s59, 0xfedbca97, s59
    s_mov_b32 s56, 0x76453201
    s_mov_b32 s57, 0x0
    s_cmp_eq_u32 s66, 1
    s_cselect_b32 s56, 0x75643120, s56
    s_cselect_b32 s57, 0x0, s57
    s_cmp_eq_u32 s66, 2
    s_cselect_b32 s56, 0x67542310, s56
    s_cselect_b32 s57, 0x0, s57
    s_cmp_eq_u32 s66, 3
    s_cselect_b32 s56, 0x76534210, s56
    s_cselect_b32 s57, 0x0, s57
    s_cmp_eq_u32 s49, 0
    s_cselect_b64 s[58:59], s[56:57], s[58:59]
    s_cselect_b32 s55, 48, 32
    s_and_b32 s57, s58, 15
    s_lshr_b64 s[58:59], s[58:59], 4
    s_add_u32 s57, s57, s55
    s_lshl_b32 s56, s57, 11
    s_mul_i32 s57, s57, 0x20000
    s_add_u32 m0, s53, 16384
    s_nop 0
    buffer_load_dwordx4 v248, s[32:35], s57 offen offset:0 lds
    buffer_load_dwordx4 v249, s[32:35], s57 offen offset:1024 lds
    buffer_load_dwordx4 v250, s[32:35], s57 offen offset:2048 lds
    buffer_load_dwordx4 v251, s[32:35], s57 offen offset:3072 lds
    s_mov_b32 m0, s53
    s_nop 0
    buffer_load_dwordx4 v246, s[28:31], s56 offen offset:0 lds
    buffer_load_dwordx4 v246, s[28:31], s56 offen offset:1024 lds
    buffer_load_dwordx4 v247, s[28:31], s56 offen offset:2048 lds
    buffer_load_dwordx4 v247, s[28:31], s56 offen offset:3072 lds
    s_add_u32 s53, s53, 32768
    s_cmp_ge_u32 s53, s61
    s_cselect_b32 s53, s60, s53
    s_barrier
    s_and_b32 s57, s58, 15
    s_lshr_b64 s[58:59], s[58:59], 4
    s_add_u32 s57, s57, s55
    s_lshl_b32 s56, s57, 11
    s_mul_i32 s57, s57, 0x20000
    s_add_u32 m0, s53, 16384
    s_nop 0
    buffer_load_dwordx4 v248, s[32:35], s57 offen offset:0 lds
    buffer_load_dwordx4 v249, s[32:35], s57 offen offset:1024 lds
    buffer_load_dwordx4 v250, s[32:35], s57 offen offset:2048 lds
    buffer_load_dwordx4 v251, s[32:35], s57 offen offset:3072 lds
    s_mov_b32 m0, s53
    s_nop 0
    buffer_load_dwordx4 v246, s[28:31], s56 offen offset:0 lds
    buffer_load_dwordx4 v246, s[28:31], s56 offen offset:1024 lds
    buffer_load_dwordx4 v247, s[28:31], s56 offen offset:2048 lds
    buffer_load_dwordx4 v247, s[28:31], s56 offen offset:3072 lds
    s_add_u32 s53, s53, 32768
    s_cmp_ge_u32 s53, s61
    s_cselect_b32 s53, s60, s53
    s_add_u32 s54, s63, 5
mega_kernel_Q_loop6:
    s_waitcnt vmcnt(16)
    s_barrier
    s_and_b32 s57, s58, 15
    s_lshr_b64 s[58:59], s[58:59], 4
    s_add_u32 s57, s57, s55
    s_lshl_b32 s56, s57, 11
    s_mul_i32 s57, s57, 0x20000
    s_add_u32 m0, s53, 16384
    s_nop 0
    buffer_load_dwordx4 v248, s[32:35], s57 offen offset:0 lds
    buffer_load_dwordx4 v249, s[32:35], s57 offen offset:1024 lds
    buffer_load_dwordx4 v250, s[32:35], s57 offen offset:2048 lds
    buffer_load_dwordx4 v251, s[32:35], s57 offen offset:3072 lds
    s_mov_b32 m0, s53
    s_nop 0
    buffer_load_dwordx4 v246, s[28:31], s56 offen offset:0 lds
    buffer_load_dwordx4 v246, s[28:31], s56 offen offset:1024 lds
    buffer_load_dwordx4 v247, s[28:31], s56 offen offset:2048 lds
    buffer_load_dwordx4 v247, s[28:31], s56 offen offset:3072 lds
    s_add_u32 s53, s53, 32768
    s_cmp_ge_u32 s53, s61
    s_cselect_b32 s53, s60, s53
    s_sub_u32 s54, s54, 1
    s_cbranch_scc0 mega_kernel_Q_loop6
    s_waitcnt vmcnt(16)
    s_barrier
    s_waitcnt vmcnt(8)
    s_barrier
    s_waitcnt vmcnt(0)
    s_barrier
    s_branch mega_kernel_fin
mega_kernel_Qidle:
    s_waitcnt vmcnt(0)
    s_barrier
    v_and_b32 v2, 255, v0
    s_and_b32 s64, s2, 63
    s_lshl_b32 s64, s64, 8
    v_add_lshl_u32 v243, v2, s64, 6
    s_mov_b32 s40, s16
    s_mov_b32 s41, s17
    s_mov_b32 s42, 0x100000
    s_mov_b32 s43, 0x20000
    s_mov_b32 s64, 0x0
    buffer_load_dword v244, v243, s[40:43], s64 offen
    s_waitcnt vmcnt(0)
    s_mov_b32 s40, s16
    s_mov_b32 s41, s17
    s_mov_b32 s42, 0x200000
    s_mov_b32 s43, 0x20000
    s_mov_b32 s64, 0x100000
    buffer_load_dword v244, v243, s[40:43], s64 offen
    s_waitcnt vmcnt(0)
    s_mov_b32 s40, s16
    s_mov_b32 s41, s17
    s_mov_b32 s42, 0x300000
    s_mov_b32 s43, 0x20000
    s_mov_b32 s64, 0x200000
    buffer_load_dword v244, v243, s[40:43], s64 offen
    s_waitcnt vmcnt(0)
    s_mov_b32 s40, s16
    s_mov_b32 s41, s17
    s_mov_b32 s42, 0x400000
    s_mov_b32 s43, 0x20000
    s_mov_b32 s64, 0x300000
    buffer_load_dword v244, v243, s[40:43], s64 offen
    s_waitcnt vmcnt(0)
    s_mov_b32 s40, s16
    s_mov_b32 s41, s17
    s_mov_b32 s42, 0x500000
    s_mov_b32 s43, 0x20000
    s_mov_b32 s64, 0x400000
    buffer_load_dword v244, v243, s[40:43], s64 offen
    s_waitcnt vmcnt(0)
    s_mov_b32 s40, s16
    s_mov_b32 s41, s17
    s_mov_b32 s42, 0x600000
    s_mov_b32 s43, 0x20000
    s_mov_b32 s64, 0x500000
    buffer_load_dword v244, v243, s[40:43], s64 offen
    s_waitcnt vmcnt(0)
    s_mov_b32 s40, s16
    s_mov_b32 s41, s17
    s_mov_b32 s42, 0x700000
    s_mov_b32 s43, 0x20000
    s_mov_b32 s64, 0x600000
    buffer_load_dword v244, v243, s[40:43], s64 offen
    s_waitcnt vmcnt(0)
    s_waitcnt vmcnt(0)
    s_barrier
    s_barrier
    s_barrier
    s_branch mega_kernel_Qjoin
mega_kernel_fin:
mega_kernel_end:
    s_endpgm

.section .rodata,"a"
.p2align 6
.amdhsa_kernel front_kernel
  .amdhsa_next_free_vgpr 64
  .amdhsa_next_free_sgpr 64
  .amdhsa_accum_offset 64
  .amdhsa_group_segment_fixed_size 0
  .amdhsa_kernarg_size 96
  .amdhsa_user_sgpr_count 2
  .amdhsa_user_sgpr_kernarg_segment_ptr 1
  .amdhsa_system_sgpr_workgroup_id_x 1
  .amdhsa_float_denorm_mode_32 3
.end_amdhsa_kernel
.p2align 6
.amdhsa_kernel mod1_kernel
  .amdhsa_next_free_vgpr 64
  .amdhsa_next_free_sgpr 80
  .amdhsa_accum_offset 64
  .amdhsa_group_segment_fixed_size 0
  .amdhsa_kernarg_size 96
  .amdhsa_user_sgpr_count 2
  .amdhsa_user_sgpr_kernarg_segment_ptr 1
  .amdhsa_system_sgpr_workgroup_id_x 1
  .amdhsa_float_denorm_mode_32 3
.end_amdhsa_kernel
.p2align 6
.amdhsa_kernel mega_kernel
  .amdhsa_next_free_vgpr 252
  .amdhsa_next_free_sgpr 102
  .amdhsa_accum_offset 252
  .amdhsa_group_segment_fixed_size 0
  .amdhsa_kernarg_size 96
  .amdhsa_user_sgpr_count 2
  .amdhsa_user_sgpr_kernarg_segment_ptr 1
  .amdhsa_system_sgpr_workgroup_id_x 1
  .amdhsa_float_denorm_mode_32 3
.end_amdhsa_kernel
```

```asm
; @launch grid=(256,1,1) block=(512,1,1) lds=163840
.amdgcn_target "amdgcn-amd-amdhsa--gfx950"
.text
.globl adaLN_cond__sliding_local_dilated__glu_gated_swiglu__prompt_kernel
.p2align 8
.type adaLN_cond__sliding_local_dilated__glu_gated_swiglu__prompt_kernel,@function
adaLN_cond__sliding_local_dilated__glu_gated_swiglu__prompt_kernel:
    s_cmp_ge_u32 s2, 256
    s_cbranch_scc1 M_end
    s_load_dwordx16 s[4:19], s[0:1], 0
    s_load_dwordx8 s[20:27], s[0:1], 64
    v_lshrrev_b32 v2, 6, v0
    v_and_b32 v1, 63, v0
    v_readfirstlane_b32 s44, v2
    s_and_b32 s47, s2, 1
    s_lshl_b32 s47, s47, 3
    s_bfe_u32 s64, s2, 0x30003
    s_add_u32 s47, s47, s64
    s_and_b32 s48, s2, 6
    s_lshl_b32 s48, s48, 1
    s_lshr_b32 s64, s2, 6
    s_add_u32 s48, s48, s64
    s_getpc_b64 s[28:29]
M_pc:
    s_lshr_b32 s64, s2, 3
    s_lshl_b32 s64, s64, 3
    s_add_u32 s64, s64, s44
    s_lshl_b32 s64, s64, 8
    v_lshl_add_u32 v2, v1, 7, s64
    v_min_u32 v2, M_end-M_pc, v2
    s_mov_b64 exec, 3
    global_load_dword v244, v2, s[28:29]
    s_mov_b64 exec, -1
    s_cmp_ge_u32 s44, 4
    s_cbranch_scc1 M_Q
    s_lshr_b32 s70, s47, 1
    s_lshl_b32 s70, s70, 7
    s_and_b32 s71, s47, 1
    s_lshl_b32 s71, s71, 4
    s_add_u32 s71, s71, s48
    s_lshl_b32 s71, s71, 7
    v_lshrrev_b32 v48, 3, v0
    v_add_u32 v48, s70, v48
    v_lshlrev_b32 v9, 1, v48
    s_movk_i32 s64, 12288
    v_mul_lo_u32 v48, s64, v48
    v_and_b32 v8, 7, v0
    v_lshl_add_u32 v48, v8, 4, v48
    v_add_u32 v8, s71, v48
    s_waitcnt lgkmcnt(0)
    s_load_dword s0, s[26:27], 0
    s_mov_b32 s40, s18
    s_mov_b32 s41, s19
    s_mov_b32 s42, 0x800
    s_mov_b32 s43, 0x20000
    s_mov_b32 s36, s20
    s_mov_b32 s37, s21
    s_mov_b32 s38, 0xc00000
    s_mov_b32 s39, 0x20000
    s_barrier
    buffer_load_ushort v20, v9, s[40:43], 0 offen offset:0
    buffer_load_ushort v21, v9, s[40:43], 0 offen offset:64
    buffer_load_ushort v22, v9, s[40:43], 0 offen offset:128
    buffer_load_ushort v23, v9, s[40:43], 0 offen offset:192
    s_mov_b32 s64, 0x0
    buffer_load_dwordx4 v[24:27], v8, s[36:39], s64 offen
    s_mov_b32 s64, 0x60000
    buffer_load_dwordx4 v[28:31], v8, s[36:39], s64 offen
    s_mov_b32 s64, 0xc0000
    buffer_load_dwordx4 v[32:35], v8, s[36:39], s64 offen
    s_mov_b32 s64, 0x120000
    buffer_load_dwordx4 v[36:39], v8, s[36:39], s64 offen
    s_mov_b32 s28, s26
    s_mov_b32 s29, s27
    s_mov_b32 s30, 0x3000000
    s_mov_b32 s31, 0x20000
    s_lshl_b32 s64, s48, 13
    s_add_u32 s64, s64, 0x20000
    s_lshl_b32 s65, s47, 9
    s_add_u32 s62, s64, s65
    s_lshl_b32 s65, s44, 9
    s_add_u32 s64, s64, s65
    v_lshl_add_u32 v16, v1, 3, s64
    s_lshr_b32 s45, s44, 1
    s_and_b32 s46, s44, 1
    s_bfe_u32 s49, s2, 0x10003
    s_and_b32 s50, s2, 3
    s_lshl_b32 s50, s50, 2
    s_bfe_u32 s64, s2, 0x20004
    s_add_u32 s50, s50, s64
    s_and_b32 s51, s2, 4
    s_lshr_b32 s64, s2, 6
    s_add_u32 s51, s51, s64
    s_cmp_ge_u32 s2, 192
    s_cselect_b32 s69, 0x80000000, 0
    s_mov_b32 s67, 0x40053526
    v_lshlrev_b32 v234, 2, v1
    s_mov_b32 s52, 0
    s_lshl_b32 s64, s45, 13
    v_lshl_add_u32 v233, v1, 4, s64
    v_lshrrev_b32 v3, 4, v1
    v_bfe_u32 v2, v1, 2, 2
    v_lshl_add_u32 v4, v3, 3, v2
    v_mul_u32_u24 v4, 384, v4
    v_and_b32 v5, 3, v1
    v_lshl_add_u32 v4, v5, 3, v4
    v_add_u32 v4, 18432, v4
    v_bfe_u32 v2, v1, 3, 2
    s_lshl_b32 s64, s46, 1
    v_xor_b32 v2, s64, v2
    v_lshl_add_u32 v239, v2, 5, v4
    v_xor_b32 v2, 1, v2
    v_lshl_add_u32 v240, v2, 5, v4
    v_and_b32 v2, 15, v1
    v_lshlrev_b32 v3, 2, v3
    v_sub_u32 v3, v2, v3
    s_mov_b32 s64, 0x80000001
    v_sub_u32 v4, -2, v3
    v_and_b32 v4, s64, v4
    v_cmp_eq_u32 s[72:73], 0, v4
    v_subrev_u32 v4, 0, v3
    v_and_b32 v4, s64, v4
    v_cmp_eq_u32 s[80:81], 0, v4
    v_sub_u32 v4, -1, v3
    v_and_b32 v4, s64, v4
    v_cmp_eq_u32 s[74:75], 0, v4
    v_subrev_u32 v4, 1, v3
    v_and_b32 v4, s64, v4
    v_cmp_eq_u32 s[82:83], 0, v4
    v_sub_u32 v4, 0, v3
    v_and_b32 v4, s64, v4
    v_cmp_eq_u32 s[76:77], 0, v4
    v_subrev_u32 v4, 2, v3
    v_and_b32 v4, s64, v4
    v_cmp_eq_u32 s[84:85], 0, v4
    v_sub_u32 v4, 1, v3
    v_and_b32 v4, s64, v4
    v_cmp_eq_u32 s[78:79], 0, v4
    v_subrev_u32 v4, 3, v3
    v_and_b32 v4, s64, v4
    v_cmp_eq_u32 s[86:87], 0, v4
    s_lshl_b32 s64, s47, 1
    s_add_u32 s64, s64, s45
    s_cmp_eq_u32 s64, 0
    s_cselect_b64 s[88:89], 0, s[72:73]
    s_cselect_b64 s[90:91], 0, s[74:75]
    s_cselect_b64 s[92:93], 0, s[76:77]
    s_cselect_b64 s[94:95], 0, s[78:79]
    s_mul_i32 s64, s64, 131072
    s_lshl_b32 s65, s48, 11
    s_add_u32 s64, s64, s65
    s_lshl_b32 s65, s46, 10
    s_add_u32 s64, s64, s65
    s_add_u32 s64, s64, 0x600000
    v_lshl_add_u32 v237, v1, 4, s64
    s_lshl_b32 s64, s2, 8
    v_add_lshl_u32 v243, v0, s64, 5
    s_lshl_b32 s64, s47, 3
    s_lshl_b32 s65, s44, 1
    s_add_u32 s64, s64, s65
    s_mul_i32 s64, s64, 32768
    s_add_u32 s64, s64, 0x600000
    v_lshl_add_u32 v208, v1, 4, s64
    v_add_u32 v209, 30720, v208
    v_lshrrev_b32 v3, 3, v1
    s_lshl_b32 s64, s44, 4
    v_add_lshl_u32 v2, v3, s64, 11
    s_lshl_b32 s64, s48, 7
    v_add_u32 v2, s64, v2
    v_and_b32 v3, 6, v3
    v_and_b32 v4, 7, v1
    v_xor_b32 v3, v3, v4
    v_lshl_add_u32 v210, v3, 4, v2
    v_add_u32 v211, 15360, v210
    s_lshl_b32 s65, s48, 8
    v_lshrrev_b32 v3, 4, v1
    s_lshl_b32 s64, s44, 4
    v_add_u32 v2, s64, v3
    s_movk_i32 s64, 7168
    v_mul_u32_u24 v2, s64, v2
    v_add_u32 v2, s65, v2
    v_lshlrev_b32 v3, 1, v3
    v_and_b32 v4, 15, v1
    v_xor_b32 v3, v3, v4
    v_lshl_add_u32 v212, v3, 4, v2
    v_add_u32 v214, 55296, v212
    v_xor_b32 v3, 8, v3
    v_lshl_add_u32 v213, v3, 4, v2
    v_add_u32 v213, 27648, v213
    v_add_u32 v215, 55296, v213
    v_add_u32 v232, s52, v233
    v_add_u32 v235, s52, v239
    v_add_u32 v236, s52, v240
    s_lshl_b32 s60, s44, 12
    s_add_u32 s61, s60, 147456
    s_add_u32 s53, s60, 49152
    s_lshl_b32 s70, s44, 11
    s_sub_u32 s70, 16384, s70
    s_bfe_u32 s66, s2, 0x30003
    s_lshr_b32 s55, s2, 6
    s_add_u32 s66, s66, s55
    s_and_b32 s66, s66, 3
    s_mov_b32 s58, 0x76453210
    s_mov_b32 s59, 0xfecdba89
    s_cmp_eq_u32 s66, 1
    s_cselect_b32 s58, 0x75643120, s58
    s_cselect_b32 s59, 0xfdecb9a8, s59
    s_cmp_eq_u32 s66, 2
    s_cselect_b32 s58, 0x67542310, s58
    s_cselect_b32 s59, 0xefdcab98, s59
    s_cmp_eq_u32 s66, 3
    s_cselect_b32 s58, 0x86534210, s58
    s_cselect_b32 s59, 0xfedbca97, s59
    s_mov_b32 s32, s8
    s_mov_b32 s33, s9
    s_mov_b32 s34, 0x200000
    s_mov_b32 s35, 0x20000
    s_waitcnt lgkmcnt(0)
    s_add_u32 s0, s0, 1
    s_setprio 2
    s_barrier
    s_waitcnt vmcnt(4)
    v_lshlrev_b32 v20, 16, v20
    v_lshlrev_b32 v21, 16, v21
    v_lshlrev_b32 v22, 16, v22
    v_lshlrev_b32 v23, 16, v23
    v_mul_f32 v48, 0xbfb8aa3b, v20
    v_mul_f32 v49, 0xbfb8aa3b, v21
    v_mul_f32 v50, 0xbfb8aa3b, v22
    v_mul_f32 v51, 0xbfb8aa3b, v23
    v_exp_f32 v48, v48
    v_exp_f32 v49, v49
    v_exp_f32 v50, v50
    v_exp_f32 v51, v51
    v_add_f32 v48, 1.0, v48
    v_add_f32 v49, 1.0, v49
    v_add_f32 v50, 1.0, v50
    v_add_f32 v51, 1.0, v51
    v_rcp_f32 v48, v48
    v_rcp_f32 v49, v49
    v_rcp_f32 v50, v50
    v_rcp_f32 v51, v51
    v_mul_f32 v20, v20, v48
    v_mul_f32 v21, v21, v49
    v_mul_f32 v22, v22, v50
    v_mul_f32 v23, v23, v51
    v_cvt_pk_bf16_f32 v48, v20, v20
    v_lshlrev_b32 v20, 16, v48
    v_cvt_pk_bf16_f32 v49, v21, v21
    v_lshlrev_b32 v21, 16, v49
    v_cvt_pk_bf16_f32 v50, v22, v22
    v_lshlrev_b32 v22, 16, v50
    v_cvt_pk_bf16_f32 v51, v23, v23
    v_lshlrev_b32 v23, 16, v51
    s_waitcnt vmcnt(3)
    v_lshlrev_b32 v48, 16, v24
    v_and_b32 v49, 0xffff0000, v24
    v_lshlrev_b32 v50, 16, v25
    v_and_b32 v51, 0xffff0000, v25
    v_lshlrev_b32 v52, 16, v26
    v_and_b32 v53, 0xffff0000, v26
    v_lshlrev_b32 v54, 16, v27
    v_and_b32 v55, 0xffff0000, v27
    v_mul_f32 v40, v20, v48
    v_mul_f32 v41, v20, v49
    v_mul_f32 v42, v20, v50
    v_mul_f32 v43, v20, v51
    v_mul_f32 v44, v20, v52
    v_mul_f32 v45, v20, v53
    v_mul_f32 v46, v20, v54
    v_mul_f32 v47, v20, v55
    s_waitcnt vmcnt(2)
    v_lshlrev_b32 v48, 16, v28
    v_and_b32 v49, 0xffff0000, v28
    v_lshlrev_b32 v50, 16, v29
    v_and_b32 v51, 0xffff0000, v29
    v_lshlrev_b32 v52, 16, v30
    v_and_b32 v53, 0xffff0000, v30
    v_lshlrev_b32 v54, 16, v31
    v_and_b32 v55, 0xffff0000, v31
    v_fmac_f32 v40, v21, v48
    v_fmac_f32 v41, v21, v49
    v_fmac_f32 v42, v21, v50
    v_fmac_f32 v43, v21, v51
    v_fmac_f32 v44, v21, v52
    v_fmac_f32 v45, v21, v53
    v_fmac_f32 v46, v21, v54
    v_fmac_f32 v47, v21, v55
    s_waitcnt vmcnt(1)
    v_lshlrev_b32 v48, 16, v32
    v_and_b32 v49, 0xffff0000, v32
    v_lshlrev_b32 v50, 16, v33
    v_and_b32 v51, 0xffff0000, v33
    v_lshlrev_b32 v52, 16, v34
    v_and_b32 v53, 0xffff0000, v34
    v_lshlrev_b32 v54, 16, v35
    v_and_b32 v55, 0xffff0000, v35
    v_fmac_f32 v40, v22, v48
    v_fmac_f32 v41, v22, v49
    v_fmac_f32 v42, v22, v50
    v_fmac_f32 v43, v22, v51
    v_fmac_f32 v44, v22, v52
    v_fmac_f32 v45, v22, v53
    v_fmac_f32 v46, v22, v54
    v_fmac_f32 v47, v22, v55
    s_waitcnt vmcnt(0)
    v_lshlrev_b32 v48, 16, v36
    v_and_b32 v49, 0xffff0000, v36
    v_lshlrev_b32 v50, 16, v37
    v_and_b32 v51, 0xffff0000, v37
    v_lshlrev_b32 v52, 16, v38
    v_and_b32 v53, 0xffff0000, v38
    v_lshlrev_b32 v54, 16, v39
    v_and_b32 v55, 0xffff0000, v39
    v_fmac_f32 v40, v23, v48
    v_fmac_f32 v41, v23, v49
    v_fmac_f32 v42, v23, v50
    v_fmac_f32 v43, v23, v51
    v_fmac_f32 v44, v23, v52
    v_fmac_f32 v45, v23, v53
    v_fmac_f32 v46, v23, v54
    v_fmac_f32 v47, v23, v55
    v_add_f32_dpp v40, v40, v40 row_ror:8 row_mask:0xf bank_mask:0xf
    v_add_f32_dpp v41, v41, v41 row_ror:8 row_mask:0xf bank_mask:0xf
    v_add_f32_dpp v42, v42, v42 row_ror:8 row_mask:0xf bank_mask:0xf
    v_add_f32_dpp v43, v43, v43 row_ror:8 row_mask:0xf bank_mask:0xf
    v_add_f32_dpp v44, v44, v44 row_ror:8 row_mask:0xf bank_mask:0xf
    v_add_f32_dpp v45, v45, v45 row_ror:8 row_mask:0xf bank_mask:0xf
    v_add_f32_dpp v46, v46, v46 row_ror:8 row_mask:0xf bank_mask:0xf
    v_add_f32_dpp v47, v47, v47 row_ror:8 row_mask:0xf bank_mask:0xf
    v_mov_b32 v48, v40
    v_mov_b32 v49, v41
    v_mov_b32 v50, v42
    v_mov_b32 v51, v43
    v_mov_b32 v52, v44
    v_mov_b32 v53, v45
    v_mov_b32 v54, v46
    v_mov_b32 v55, v47
    v_permlane32_swap_b32 v40, v48
    v_permlane32_swap_b32 v41, v49
    v_permlane32_swap_b32 v42, v50
    v_permlane32_swap_b32 v43, v51
    v_permlane32_swap_b32 v44, v52
    v_permlane32_swap_b32 v45, v53
    v_permlane32_swap_b32 v46, v54
    v_permlane32_swap_b32 v47, v55
    v_add_f32 v40, v40, v48
    v_add_f32 v41, v41, v49
    v_add_f32 v42, v42, v50
    v_add_f32 v43, v43, v51
    v_add_f32 v44, v44, v52
    v_add_f32 v45, v45, v53
    v_add_f32 v46, v46, v54
    v_add_f32 v47, v47, v55
    v_mov_b32 v48, v40
    v_mov_b32 v49, v41
    v_mov_b32 v50, v42
    v_mov_b32 v51, v43
    v_mov_b32 v52, v44
    v_mov_b32 v53, v45
    v_mov_b32 v54, v46
    v_mov_b32 v55, v47
    v_permlane16_swap_b32 v40, v48
    v_permlane16_swap_b32 v41, v49
    v_permlane16_swap_b32 v42, v50
    v_permlane16_swap_b32 v43, v51
    v_permlane16_swap_b32 v44, v52
    v_permlane16_swap_b32 v45, v53
    v_permlane16_swap_b32 v46, v54
    v_permlane16_swap_b32 v47, v55
    v_add_f32 v40, v40, v48
    v_add_f32 v41, v41, v49
    v_add_f32 v42, v42, v50
    v_add_f32 v43, v43, v51
    v_add_f32 v44, v44, v52
    v_add_f32 v45, v45, v53
    v_add_f32 v46, v46, v54
    v_add_f32 v47, v47, v55
    s_lshl_b32 s64, s44, 8
    s_add_u32 s64, s64, 147456
    v_and_b32 v48, 7, v0
    v_lshl_add_u32 v48, v48, 5, s64
    ds_write_b128 v48, v[40:43]
    ds_write_b128 v48, v[44:47] offset:16
    v_mov_b32 v49, 148492
    v_mov_b32 v50, 1
    s_waitcnt lgkmcnt(0)
    s_mov_b64 exec, 1
    ds_add_rtn_u32 v51, v49, v50
    s_mov_b64 exec, -1
    v_add_u32 v49, 147456, v234
    s_waitcnt lgkmcnt(0)
    ds_read_b32 v40, v49 offset:0
    ds_read_b32 v41, v49 offset:256
    ds_read_b32 v42, v49 offset:512
    ds_read_b32 v43, v49 offset:768
    v_readfirstlane_b32 s64, v51
    s_nop 3
    s_cmp_eq_u32 s64, 3
    s_cselect_b32 s62, s62, 0x80000000
    v_lshl_add_u32 v48, v1, 3, s62
    s_waitcnt lgkmcnt(0)
    v_add_f32 v40, v40, v41
    v_add_f32 v42, v42, v43
    v_add_f32 v40, v40, v42
    v_mov_b32 v41, s0
    buffer_store_dwordx2 v[40:41], v48, s[28:31], 0 offen sc1
    s_cmp_ge_u32 s44, 2
    s_cbranch_scc1 M_spf
    s_movk_i32 s63, 4096
    buffer_load_dwordx2 v[88:89], v16, s[28:31], 0 offen offset:0 sc1
    buffer_load_dwordx2 v[90:91], v16, s[28:31], 0 offen offset:1024 sc1
    buffer_load_dwordx2 v[92:93], v16, s[28:31], 0 offen offset:2048 sc1
    buffer_load_dwordx2 v[94:95], v16, s[28:31], 0 offen offset:3072 sc1
    buffer_load_dwordx2 v[96:97], v16, s[28:31], s63 offen offset:0 sc1
    buffer_load_dwordx2 v[98:99], v16, s[28:31], s63 offen offset:1024 sc1
    buffer_load_dwordx2 v[100:101], v16, s[28:31], s63 offen offset:2048 sc1
    buffer_load_dwordx2 v[102:103], v16, s[28:31], s63 offen offset:3072 sc1
    s_waitcnt vmcnt(0)
    s_mov_b32 s3, 0x40000
M_pt_chk:
    v_xor_b32 v48, s0, v89
    v_xor_b32 v49, s0, v91
    v_xor_b32 v50, s0, v93
    v_xor_b32 v51, s0, v95
    v_xor_b32 v52, s0, v97
    v_xor_b32 v53, s0, v99
    v_xor_b32 v54, s0, v101
    v_xor_b32 v55, s0, v103
    v_or3_b32 v48, v48, v49, v50
    v_or3_b32 v48, v48, v51, v52
    v_or3_b32 v48, v48, v53, v54
    v_or_b32 v48, v48, v55
    v_cmp_ne_u32 vcc, 0, v48
    s_nop 4
    s_cbranch_vccz M_pt_ok
    s_sub_u32 s3, s3, 1
    s_cbranch_scc1 M_pt_ok
    v_cmp_ne_u32 vcc, s0, v89
    s_nop 4
    s_mov_b64 exec, vcc
    buffer_load_dwordx2 v[88:89], v16, s[28:31], 0 offen offset:0 sc1
    s_mov_b64 exec, -1
    v_cmp_ne_u32 vcc, s0, v91
    s_nop 4
    s_mov_b64 exec, vcc
    buffer_load_dwordx2 v[90:91], v16, s[28:31], 0 offen offset:1024 sc1
    s_mov_b64 exec, -1
    v_cmp_ne_u32 vcc, s0, v93
    s_nop 4
    s_mov_b64 exec, vcc
    buffer_load_dwordx2 v[92:93], v16, s[28:31], 0 offen offset:2048 sc1
    s_mov_b64 exec, -1
    v_cmp_ne_u32 vcc, s0, v95
    s_nop 4
    s_mov_b64 exec, vcc
    buffer_load_dwordx2 v[94:95], v16, s[28:31], 0 offen offset:3072 sc1
    s_mov_b64 exec, -1
    v_cmp_ne_u32 vcc, s0, v97
    s_nop 4
    s_mov_b64 exec, vcc
    buffer_load_dwordx2 v[96:97], v16, s[28:31], s63 offen offset:0 sc1
    s_mov_b64 exec, -1
    v_cmp_ne_u32 vcc, s0, v99
    s_nop 4
    s_mov_b64 exec, vcc
    buffer_load_dwordx2 v[98:99], v16, s[28:31], s63 offen offset:1024 sc1
    s_mov_b64 exec, -1
    v_cmp_ne_u32 vcc, s0, v101
    s_nop 4
    s_mov_b64 exec, vcc
    buffer_load_dwordx2 v[100:101], v16, s[28:31], s63 offen offset:2048 sc1
    s_mov_b64 exec, -1
    v_cmp_ne_u32 vcc, s0, v103
    s_nop 4
    s_mov_b64 exec, vcc
    buffer_load_dwordx2 v[102:103], v16, s[28:31], s63 offen offset:3072 sc1
    s_mov_b64 exec, -1
    s_waitcnt vmcnt(0)
    s_branch M_pt_chk
M_pt_ok:
    v_add_f32 v88, v88, v90
    v_add_f32 v92, v92, v94
    v_add_f32 v96, v96, v98
    v_add_f32 v100, v100, v102
    v_add_f32 v88, v88, v92
    v_add_f32 v96, v96, v100
    v_add_f32 v88, v88, v96
    v_cvt_pk_bf16_f32 v89, v88, v88
    v_lshlrev_b32 v88, 16, v89
    s_cmp_eq_u32 s44, 1
    s_cselect_b32 s64, 1.0, 0
    v_add_f32 v88, s64, v88
    v_cvt_pk_bf16_f32 v89, v88, v88
    v_lshlrev_b32 v88, 16, v89
    s_lshl_b32 s64, s44, 8
    s_add_u32 s64, s64, 149504
    v_add_u32 v2, s64, v234
    ds_write_b32 v2, v88
    s_waitcnt lgkmcnt(0)
    s_branch M_tbl
M_spf:
    s_lshl_b32 s64, s2, 1
    s_add_u32 s64, s64, s46
    s_mul_i32 s65, s64, 12288
    s_add_u32 s56, s6, s65
    s_addc_u32 s57, s7, 0
    s_load_dword s99, s[56:57], 384
    s_load_dword s99, s[56:57], 448
    s_load_dword s99, s[56:57], 1408
    s_load_dword s99, s[56:57], 1472
    s_load_dword s99, s[56:57], 2432
    s_load_dword s99, s[56:57], 2496
    s_load_dword s99, s[56:57], 3456
    s_load_dword s99, s[56:57], 3520
    s_load_dword s99, s[56:57], 4480
    s_load_dword s99, s[56:57], 4544
    s_load_dword s99, s[56:57], 5504
    s_load_dword s99, s[56:57], 5568
    s_load_dword s99, s[56:57], 6528
    s_load_dword s99, s[56:57], 6592
    s_load_dword s99, s[56:57], 7552
    s_load_dword s99, s[56:57], 7616
    s_load_dword s99, s[56:57], 8576
    s_load_dword s99, s[56:57], 8640
    s_load_dword s99, s[56:57], 9600
    s_load_dword s99, s[56:57], 9664
    s_load_dword s99, s[56:57], 10624
    s_load_dword s99, s[56:57], 10688
    s_load_dword s99, s[56:57], 11648
    s_load_dword s99, s[56:57], 11712
M_tbl:
    s_barrier
    s_barrier
    s_or_b32 s64, s2, s44
    s_cmp_eq_u32 s64, 0
    s_cselect_b32 s64, 0, 0x80000000
    v_mov_b32 v2, s64
    v_mov_b32 v3, s0
    s_mov_b64 exec, 1
    buffer_store_dword v3, v2, s[28:31], 0 offen sc1
    s_mov_b64 exec, -1
    s_barrier
    ds_read_b128 v[120:123], v232 offset:0
    ds_read_b64_tr_b16 v[148:149], v235 offset:128
    ds_read_b64_tr_b16 v[150:151], v235 offset:1664
    ds_read_b64_tr_b16 v[152:153], v236 offset:128
    ds_read_b64_tr_b16 v[154:155], v236 offset:1664
    ds_read_b64_tr_b16 v[156:157], v235 offset:256
    ds_read_b64_tr_b16 v[158:159], v235 offset:1792
    ds_read_b64_tr_b16 v[160:161], v236 offset:256
    ds_read_b64_tr_b16 v[162:163], v236 offset:1792
    ds_read_b128 v[124:127], v232 offset:2048
    ds_read_b64_tr_b16 v[140:141], v235 offset:0
    ds_read_b64_tr_b16 v[142:143], v235 offset:1536
    ds_read_b64_tr_b16 v[144:145], v236 offset:0
    ds_read_b64_tr_b16 v[146:147], v236 offset:1536
    ds_read_b128 v[128:131], v232 offset:4096
    ds_read_b128 v[132:135], v232 offset:6144
    ds_read_b128 v[136:139], v232 offset:8192
    s_add_u32 s52, s52, 49152
    s_cmp_ge_u32 s52, 147456
    s_cselect_b32 s52, 0, s52
    s_waitcnt lgkmcnt(0)
    v_mfma_f32_16x16x32_bf16 v[40:43], v[148:151], v[120:123], 0
    ds_read_b128 v[164:167], v232 offset:1024
    v_mfma_f32_16x16x32_bf16 v[44:47], v[152:155], v[120:123], 0
    ds_read_b64_tr_b16 v[192:193], v235 offset:12416
    v_mfma_f32_16x16x32_bf16 v[80:83], v[120:123], v[156:159], 0
    ds_read_b64_tr_b16 v[194:195], v235 offset:13952
    v_mfma_f32_16x16x32_bf16 v[84:87], v[120:123], v[160:163], 0
    ds_read_b64_tr_b16 v[196:197], v236 offset:12416
    v_mfma_f32_16x16x32_bf16 v[48:51], v[148:151], v[124:127], 0
    ds_read_b64_tr_b16 v[198:199], v236 offset:13952
    v_mfma_f32_16x16x32_bf16 v[52:55], v[152:155], v[124:127], 0
    v_mfma_f32_16x16x32_bf16 v[88:91], v[124:127], v[156:159], 0
    ds_read_b64_tr_b16 v[200:201], v235 offset:12544
    v_mfma_f32_16x16x32_bf16 v[92:95], v[124:127], v[160:163], 0
    ds_read_b64_tr_b16 v[202:203], v235 offset:14080
    v_mfma_f32_16x16x32_bf16 v[8:11], v[140:143], v[124:127], 0
    ds_read_b64_tr_b16 v[204:205], v236 offset:12544
    v_mfma_f32_16x16x32_bf16 v[12:15], v[144:147], v[124:127], 0
    ds_read_b64_tr_b16 v[206:207], v236 offset:14080
    v_mfma_f32_16x16x32_bf16 v[56:59], v[148:151], v[128:131], 0
    v_mfma_f32_16x16x32_bf16 v[60:63], v[152:155], v[128:131], 0
    ds_read_b128 v[168:171], v232 offset:3072
    v_mfma_f32_16x16x32_bf16 v[96:99], v[128:131], v[156:159], 0
    ds_read_b64_tr_b16 v[184:185], v235 offset:12288
    v_mfma_f32_16x16x32_bf16 v[100:103], v[128:131], v[160:163], 0
    ds_read_b64_tr_b16 v[186:187], v235 offset:13824
    v_mfma_f32_16x16x32_bf16 v[16:19], v[140:143], v[128:131], 0
    ds_read_b64_tr_b16 v[188:189], v236 offset:12288
    v_mfma_f32_16x16x32_bf16 v[20:23], v[144:147], v[128:131], 0
    v_mfma_f32_16x16x32_bf16 v[64:67], v[148:151], v[132:135], 0
    ds_read_b64_tr_b16 v[190:191], v236 offset:13824
    v_mfma_f32_16x16x32_bf16 v[68:71], v[152:155], v[132:135], 0
    ds_read_b128 v[172:175], v232 offset:5120
    v_mfma_f32_16x16x32_bf16 v[104:107], v[132:135], v[156:159], 0
    ds_read_b128 v[176:179], v232 offset:7168
    v_mfma_f32_16x16x32_bf16 v[108:111], v[132:135], v[160:163], 0
    ds_read_b128 v[180:183], v232 offset:9216
    v_mfma_f32_16x16x32_bf16 v[24:27], v[140:143], v[132:135], 0
    v_mfma_f32_16x16x32_bf16 v[28:31], v[144:147], v[132:135], 0
    v_add_u32 v232, s52, v233
    v_mfma_f32_16x16x32_bf16 v[72:75], v[148:151], v[136:139], 0
    v_mfma_f32_16x16x32_bf16 v[76:79], v[152:155], v[136:139], 0
    v_add_u32 v235, s52, v239
    v_mfma_f32_16x16x32_bf16 v[112:115], v[136:139], v[156:159], 0
    v_mfma_f32_16x16x32_bf16 v[116:119], v[136:139], v[160:163], 0
    v_add_u32 v236, s52, v240
    v_mfma_f32_16x16x32_bf16 v[32:35], v[140:143], v[136:139], 0
    v_mfma_f32_16x16x32_bf16 v[36:39], v[144:147], v[136:139], 0
    s_waitcnt lgkmcnt(0)
    v_mfma_f32_16x16x32_bf16 v[40:43], v[192:195], v[164:167], v[40:43]
    s_barrier
    v_mfma_f32_16x16x32_bf16 v[44:47], v[196:199], v[164:167], v[44:47]
    ds_read_b128 v[120:123], v232 offset:0
    v_mfma_f32_16x16x32_bf16 v[80:83], v[164:167], v[200:203], v[80:83]
    ds_read_b64_tr_b16 v[148:149], v235 offset:128
    v_mfma_f32_16x16x32_bf16 v[84:87], v[164:167], v[204:207], v[84:87]
    ds_read_b64_tr_b16 v[150:151], v235 offset:1664
    v_mfma_f32_16x16x32_bf16 v[48:51], v[192:195], v[168:171], v[48:51]
    ds_read_b64_tr_b16 v[152:153], v236 offset:128
    v_mfma_f32_16x16x32_bf16 v[52:55], v[196:199], v[168:171], v[52:55]
    ds_read_b64_tr_b16 v[154:155], v236 offset:1664
    v_mfma_f32_16x16x32_bf16 v[88:91], v[168:171], v[200:203], v[88:91]
    ds_read_b64_tr_b16 v[156:157], v235 offset:256
    v_mfma_f32_16x16x32_bf16 v[92:95], v[168:171], v[204:207], v[92:95]
    v_mfma_f32_16x16x32_bf16 v[8:11], v[184:187], v[168:171], v[8:11]
    ds_read_b64_tr_b16 v[158:159], v235 offset:1792
    v_mfma_f32_16x16x32_bf16 v[12:15], v[188:191], v[168:171], v[12:15]
    ds_read_b64_tr_b16 v[160:161], v236 offset:256
    v_mfma_f32_16x16x32_bf16 v[56:59], v[192:195], v[172:175], v[56:59]
    ds_read_b64_tr_b16 v[162:163], v236 offset:1792
    v_mfma_f32_16x16x32_bf16 v[60:63], v[196:199], v[172:175], v[60:63]
    ds_read_b128 v[124:127], v232 offset:2048
    v_mfma_f32_16x16x32_bf16 v[96:99], v[172:175], v[200:203], v[96:99]
    ds_read_b64_tr_b16 v[140:141], v235 offset:0
    v_mfma_f32_16x16x32_bf16 v[100:103], v[172:175], v[204:207], v[100:103]
    ds_read_b64_tr_b16 v[142:143], v235 offset:1536
    v_mfma_f32_16x16x32_bf16 v[16:19], v[184:187], v[172:175], v[16:19]
    v_mfma_f32_16x16x32_bf16 v[20:23], v[188:191], v[172:175], v[20:23]
    ds_read_b64_tr_b16 v[144:145], v236 offset:0
    v_mfma_f32_16x16x32_bf16 v[64:67], v[192:195], v[176:179], v[64:67]
    ds_read_b64_tr_b16 v[146:147], v236 offset:1536
    v_mfma_f32_16x16x32_bf16 v[68:71], v[196:199], v[176:179], v[68:71]
    ds_read_b128 v[128:131], v232 offset:4096
    v_mfma_f32_16x16x32_bf16 v[104:107], v[176:179], v[200:203], v[104:107]
    ds_read_b128 v[132:135], v232 offset:6144
    v_mfma_f32_16x16x32_bf16 v[108:111], v[176:179], v[204:207], v[108:111]
    ds_read_b128 v[136:139], v232 offset:8192
    v_mfma_f32_16x16x32_bf16 v[24:27], v[184:187], v[176:179], v[24:27]
    v_mfma_f32_16x16x32_bf16 v[28:31], v[188:191], v[176:179], v[28:31]
    v_mfma_f32_16x16x32_bf16 v[72:75], v[192:195], v[180:183], v[72:75]
    v_mfma_f32_16x16x32_bf16 v[76:79], v[196:199], v[180:183], v[76:79]
    v_mfma_f32_16x16x32_bf16 v[112:115], v[180:183], v[200:203], v[112:115]
    v_mfma_f32_16x16x32_bf16 v[116:119], v[180:183], v[204:207], v[116:119]
    v_mfma_f32_16x16x32_bf16 v[32:35], v[184:187], v[180:183], v[32:35]
    s_add_u32 s52, s52, 49152
    s_cmp_ge_u32 s52, 147456
    s_cselect_b32 s52, 0, s52
    v_mfma_f32_16x16x32_bf16 v[36:39], v[188:191], v[180:183], v[36:39]
    s_waitcnt lgkmcnt(0)
    v_mfma_f32_16x16x32_bf16 v[40:43], v[148:151], v[120:123], v[40:43]
    ds_read_b128 v[164:167], v232 offset:1024
    v_mfma_f32_16x16x32_bf16 v[44:47], v[152:155], v[120:123], v[44:47]
    ds_read_b64_tr_b16 v[192:193], v235 offset:12416
    v_mfma_f32_16x16x32_bf16 v[80:83], v[120:123], v[156:159], v[80:83]
    ds_read_b64_tr_b16 v[194:195], v235 offset:13952
    v_mfma_f32_16x16x32_bf16 v[84:87], v[120:123], v[160:163], v[84:87]
    ds_read_b64_tr_b16 v[196:197], v236 offset:12416
    v_mfma_f32_16x16x32_bf16 v[48:51], v[148:151], v[124:127], v[48:51]
    ds_read_b64_tr_b16 v[198:199], v236 offset:13952
    v_mfma_f32_16x16x32_bf16 v[52:55], v[152:155], v[124:127], v[52:55]
    v_mfma_f32_16x16x32_bf16 v[88:91], v[124:127], v[156:159], v[88:91]
    ds_read_b64_tr_b16 v[200:201], v235 offset:12544
    v_mfma_f32_16x16x32_bf16 v[92:95], v[124:127], v[160:163], v[92:95]
    ds_read_b64_tr_b16 v[202:203], v235 offset:14080
    v_mfma_f32_16x16x32_bf16 v[8:11], v[140:143], v[124:127], v[8:11]
    ds_read_b64_tr_b16 v[204:205], v236 offset:12544
    v_mfma_f32_16x16x32_bf16 v[12:15], v[144:147], v[124:127], v[12:15]
    ds_read_b64_tr_b16 v[206:207], v236 offset:14080
    v_mfma_f32_16x16x32_bf16 v[56:59], v[148:151], v[128:131], v[56:59]
    v_mfma_f32_16x16x32_bf16 v[60:63], v[152:155], v[128:131], v[60:63]
    ds_read_b128 v[168:171], v232 offset:3072
    v_mfma_f32_16x16x32_bf16 v[96:99], v[128:131], v[156:159], v[96:99]
    ds_read_b64_tr_b16 v[184:185], v235 offset:12288
    v_mfma_f32_16x16x32_bf16 v[100:103], v[128:131], v[160:163], v[100:103]
    ds_read_b64_tr_b16 v[186:187], v235 offset:13824
    v_mfma_f32_16x16x32_bf16 v[16:19], v[140:143], v[128:131], v[16:19]
    s_movk_i32 s54, 13
M_P_loop0:
    ds_read_b64_tr_b16 v[188:189], v236 offset:12288
    v_mfma_f32_16x16x32_bf16 v[20:23], v[144:147], v[128:131], v[20:23]
    v_mfma_f32_16x16x32_bf16 v[64:67], v[148:151], v[132:135], v[64:67]
    ds_read_b64_tr_b16 v[190:191], v236 offset:13824
    v_mfma_f32_16x16x32_bf16 v[68:71], v[152:155], v[132:135], v[68:71]
    ds_read_b128 v[172:175], v232 offset:5120
    v_mfma_f32_16x16x32_bf16 v[104:107], v[132:135], v[156:159], v[104:107]
    ds_read_b128 v[176:179], v232 offset:7168
    v_mfma_f32_16x16x32_bf16 v[108:111], v[132:135], v[160:163], v[108:111]
    ds_read_b128 v[180:183], v232 offset:9216
    v_mfma_f32_16x16x32_bf16 v[24:27], v[140:143], v[132:135], v[24:27]
    v_mfma_f32_16x16x32_bf16 v[28:31], v[144:147], v[132:135], v[28:31]
    v_add_u32 v232, s52, v233
    v_mfma_f32_16x16x32_bf16 v[72:75], v[148:151], v[136:139], v[72:75]
    v_mfma_f32_16x16x32_bf16 v[76:79], v[152:155], v[136:139], v[76:79]
    v_add_u32 v235, s52, v239
    v_mfma_f32_16x16x32_bf16 v[112:115], v[136:139], v[156:159], v[112:115]
    v_mfma_f32_16x16x32_bf16 v[116:119], v[136:139], v[160:163], v[116:119]
    v_add_u32 v236, s52, v240
    v_mfma_f32_16x16x32_bf16 v[32:35], v[140:143], v[136:139], v[32:35]
    v_mfma_f32_16x16x32_bf16 v[36:39], v[144:147], v[136:139], v[36:39]
    s_waitcnt lgkmcnt(0)
    v_mfma_f32_16x16x32_bf16 v[40:43], v[192:195], v[164:167], v[40:43]
    s_barrier
    v_mfma_f32_16x16x32_bf16 v[44:47], v[196:199], v[164:167], v[44:47]
    ds_read_b128 v[120:123], v232 offset:0
    v_mfma_f32_16x16x32_bf16 v[80:83], v[164:167], v[200:203], v[80:83]
    ds_read_b64_tr_b16 v[148:149], v235 offset:128
    v_mfma_f32_16x16x32_bf16 v[84:87], v[164:167], v[204:207], v[84:87]
    ds_read_b64_tr_b16 v[150:151], v235 offset:1664
    v_mfma_f32_16x16x32_bf16 v[48:51], v[192:195], v[168:171], v[48:51]
    ds_read_b64_tr_b16 v[152:153], v236 offset:128
    v_mfma_f32_16x16x32_bf16 v[52:55], v[196:199], v[168:171], v[52:55]
    ds_read_b64_tr_b16 v[154:155], v236 offset:1664
    v_mfma_f32_16x16x32_bf16 v[88:91], v[168:171], v[200:203], v[88:91]
    ds_read_b64_tr_b16 v[156:157], v235 offset:256
    v_mfma_f32_16x16x32_bf16 v[92:95], v[168:171], v[204:207], v[92:95]
    v_mfma_f32_16x16x32_bf16 v[8:11], v[184:187], v[168:171], v[8:11]
    ds_read_b64_tr_b16 v[158:159], v235 offset:1792
    v_mfma_f32_16x16x32_bf16 v[12:15], v[188:191], v[168:171], v[12:15]
    ds_read_b64_tr_b16 v[160:161], v236 offset:256
    v_mfma_f32_16x16x32_bf16 v[56:59], v[192:195], v[172:175], v[56:59]
    ds_read_b64_tr_b16 v[162:163], v236 offset:1792
    v_mfma_f32_16x16x32_bf16 v[60:63], v[196:199], v[172:175], v[60:63]
    ds_read_b128 v[124:127], v232 offset:2048
    v_mfma_f32_16x16x32_bf16 v[96:99], v[172:175], v[200:203], v[96:99]
    ds_read_b64_tr_b16 v[140:141], v235 offset:0
    v_mfma_f32_16x16x32_bf16 v[100:103], v[172:175], v[204:207], v[100:103]
    ds_read_b64_tr_b16 v[142:143], v235 offset:1536
    v_mfma_f32_16x16x32_bf16 v[16:19], v[184:187], v[172:175], v[16:19]
    v_mfma_f32_16x16x32_bf16 v[20:23], v[188:191], v[172:175], v[20:23]
    ds_read_b64_tr_b16 v[144:145], v236 offset:0
    v_mfma_f32_16x16x32_bf16 v[64:67], v[192:195], v[176:179], v[64:67]
    ds_read_b64_tr_b16 v[146:147], v236 offset:1536
    v_mfma_f32_16x16x32_bf16 v[68:71], v[196:199], v[176:179], v[68:71]
    ds_read_b128 v[128:131], v232 offset:4096
    v_mfma_f32_16x16x32_bf16 v[104:107], v[176:179], v[200:203], v[104:107]
    ds_read_b128 v[132:135], v232 offset:6144
    v_mfma_f32_16x16x32_bf16 v[108:111], v[176:179], v[204:207], v[108:111]
    ds_read_b128 v[136:139], v232 offset:8192
    v_mfma_f32_16x16x32_bf16 v[24:27], v[184:187], v[176:179], v[24:27]
    v_mfma_f32_16x16x32_bf16 v[28:31], v[188:191], v[176:179], v[28:31]
    v_mfma_f32_16x16x32_bf16 v[72:75], v[192:195], v[180:183], v[72:75]
    v_mfma_f32_16x16x32_bf16 v[76:79], v[196:199], v[180:183], v[76:79]
    v_mfma_f32_16x16x32_bf16 v[112:115], v[180:183], v[200:203], v[112:115]
    v_mfma_f32_16x16x32_bf16 v[116:119], v[180:183], v[204:207], v[116:119]
    v_mfma_f32_16x16x32_bf16 v[32:35], v[184:187], v[180:183], v[32:35]
    s_add_u32 s52, s52, 49152
    s_cmp_ge_u32 s52, 147456
    s_cselect_b32 s52, 0, s52
    v_mfma_f32_16x16x32_bf16 v[36:39], v[188:191], v[180:183], v[36:39]
    s_waitcnt lgkmcnt(0)
    v_mfma_f32_16x16x32_bf16 v[40:43], v[148:151], v[120:123], v[40:43]
    ds_read_b128 v[164:167], v232 offset:1024
    v_mfma_f32_16x16x32_bf16 v[44:47], v[152:155], v[120:123], v[44:47]
    ds_read_b64_tr_b16 v[192:193], v235 offset:12416
    v_mfma_f32_16x16x32_bf16 v[80:83], v[120:123], v[156:159], v[80:83]
    ds_read_b64_tr_b16 v[194:195], v235 offset:13952
    v_mfma_f32_16x16x32_bf16 v[84:87], v[120:123], v[160:163], v[84:87]
    ds_read_b64_tr_b16 v[196:197], v236 offset:12416
    v_mfma_f32_16x16x32_bf16 v[48:51], v[148:151], v[124:127], v[48:51]
    ds_read_b64_tr_b16 v[198:199], v236 offset:13952
    v_mfma_f32_16x16x32_bf16 v[52:55], v[152:155], v[124:127], v[52:55]
    v_mfma_f32_16x16x32_bf16 v[88:91], v[124:127], v[156:159], v[88:91]
    ds_read_b64_tr_b16 v[200:201], v235 offset:12544
    v_mfma_f32_16x16x32_bf16 v[92:95], v[124:127], v[160:163], v[92:95]
    ds_read_b64_tr_b16 v[202:203], v235 offset:14080
    v_mfma_f32_16x16x32_bf16 v[8:11], v[140:143], v[124:127], v[8:11]
    ds_read_b64_tr_b16 v[204:205], v236 offset:12544
    v_mfma_f32_16x16x32_bf16 v[12:15], v[144:147], v[124:127], v[12:15]
    ds_read_b64_tr_b16 v[206:207], v236 offset:14080
    v_mfma_f32_16x16x32_bf16 v[56:59], v[148:151], v[128:131], v[56:59]
    v_mfma_f32_16x16x32_bf16 v[60:63], v[152:155], v[128:131], v[60:63]
    ds_read_b128 v[168:171], v232 offset:3072
    v_mfma_f32_16x16x32_bf16 v[96:99], v[128:131], v[156:159], v[96:99]
    ds_read_b64_tr_b16 v[184:185], v235 offset:12288
    v_mfma_f32_16x16x32_bf16 v[100:103], v[128:131], v[160:163], v[100:103]
    s_sub_u32 s54, s54, 1
    ds_read_b64_tr_b16 v[186:187], v235 offset:13824
    v_mfma_f32_16x16x32_bf16 v[16:19], v[140:143], v[128:131], v[16:19]
    s_cbranch_scc0 M_P_loop0
    ds_read_b64_tr_b16 v[188:189], v236 offset:12288
    v_mfma_f32_16x16x32_bf16 v[20:23], v[144:147], v[128:131], v[20:23]
    v_mfma_f32_16x16x32_bf16 v[64:67], v[148:151], v[132:135], v[64:67]
    ds_read_b64_tr_b16 v[190:191], v236 offset:13824
    v_mfma_f32_16x16x32_bf16 v[68:71], v[152:155], v[132:135], v[68:71]
    ds_read_b128 v[172:175], v232 offset:5120
    v_mfma_f32_16x16x32_bf16 v[104:107], v[132:135], v[156:159], v[104:107]
    ds_read_b128 v[176:179], v232 offset:7168
    v_mfma_f32_16x16x32_bf16 v[108:111], v[132:135], v[160:163], v[108:111]
    ds_read_b128 v[180:183], v232 offset:9216
    v_mfma_f32_16x16x32_bf16 v[24:27], v[140:143], v[132:135], v[24:27]
    v_mfma_f32_16x16x32_bf16 v[28:31], v[144:147], v[132:135], v[28:31]
    v_mfma_f32_16x16x32_bf16 v[72:75], v[148:151], v[136:139], v[72:75]
    v_mfma_f32_16x16x32_bf16 v[76:79], v[152:155], v[136:139], v[76:79]
    v_mfma_f32_16x16x32_bf16 v[112:115], v[136:139], v[156:159], v[112:115]
    v_mfma_f32_16x16x32_bf16 v[116:119], v[136:139], v[160:163], v[116:119]
    v_mfma_f32_16x16x32_bf16 v[32:35], v[140:143], v[136:139], v[32:35]
    v_mfma_f32_16x16x32_bf16 v[36:39], v[144:147], v[136:139], v[36:39]
    s_waitcnt lgkmcnt(0)
    v_mfma_f32_16x16x32_bf16 v[40:43], v[192:195], v[164:167], v[40:43]
    s_barrier
    v_mfma_f32_16x16x32_bf16 v[44:47], v[196:199], v[164:167], v[44:47]
    v_mfma_f32_16x16x32_bf16 v[80:83], v[164:167], v[200:203], v[80:83]
    v_mfma_f32_16x16x32_bf16 v[84:87], v[164:167], v[204:207], v[84:87]
    v_mfma_f32_16x16x32_bf16 v[48:51], v[192:195], v[168:171], v[48:51]
    v_mfma_f32_16x16x32_bf16 v[52:55], v[196:199], v[168:171], v[52:55]
    v_mfma_f32_16x16x32_bf16 v[88:91], v[168:171], v[200:203], v[88:91]
    v_mfma_f32_16x16x32_bf16 v[92:95], v[168:171], v[204:207], v[92:95]
    v_mfma_f32_16x16x32_bf16 v[8:11], v[184:187], v[168:171], v[8:11]
    v_mfma_f32_16x16x32_bf16 v[12:15], v[188:191], v[168:171], v[12:15]
    v_mfma_f32_16x16x32_bf16 v[56:59], v[192:195], v[172:175], v[56:59]
    v_mfma_f32_16x16x32_bf16 v[60:63], v[196:199], v[172:175], v[60:63]
    v_mfma_f32_16x16x32_bf16 v[96:99], v[172:175], v[200:203], v[96:99]
    v_mfma_f32_16x16x32_bf16 v[100:103], v[172:175], v[204:207], v[100:103]
    v_mfma_f32_16x16x32_bf16 v[16:19], v[184:187], v[172:175], v[16:19]
    v_mfma_f32_16x16x32_bf16 v[20:23], v[188:191], v[172:175], v[20:23]
    v_mfma_f32_16x16x32_bf16 v[64:67], v[192:195], v[176:179], v[64:67]
    v_mfma_f32_16x16x32_bf16 v[68:71], v[196:199], v[176:179], v[68:71]
    v_mfma_f32_16x16x32_bf16 v[104:107], v[176:179], v[200:203], v[104:107]
    v_mfma_f32_16x16x32_bf16 v[108:111], v[176:179], v[204:207], v[108:111]
    v_mfma_f32_16x16x32_bf16 v[24:27], v[184:187], v[176:179], v[24:27]
    v_mfma_f32_16x16x32_bf16 v[28:31], v[188:191], v[176:179], v[28:31]
    v_mfma_f32_16x16x32_bf16 v[72:75], v[192:195], v[180:183], v[72:75]
    v_mfma_f32_16x16x32_bf16 v[76:79], v[196:199], v[180:183], v[76:79]
    v_mfma_f32_16x16x32_bf16 v[112:115], v[180:183], v[200:203], v[112:115]
    v_mfma_f32_16x16x32_bf16 v[116:119], v[180:183], v[204:207], v[116:119]
    v_mfma_f32_16x16x32_bf16 v[32:35], v[184:187], v[180:183], v[32:35]
    v_mfma_f32_16x16x32_bf16 v[36:39], v[188:191], v[180:183], v[36:39]
    v_cvt_pk_bf16_f32 v120, v40, v41
    v_cvt_pk_bf16_f32 v121, v42, v43
    v_cvt_pk_bf16_f32 v122, v44, v45
    v_cvt_pk_bf16_f32 v123, v46, v47
    v_cvt_pk_bf16_f32 v124, v48, v49
    v_cvt_pk_bf16_f32 v125, v50, v51
    v_cvt_pk_bf16_f32 v126, v52, v53
    v_cvt_pk_bf16_f32 v127, v54, v55
    v_cvt_pk_bf16_f32 v140, v8, v9
    v_cvt_pk_bf16_f32 v141, v10, v11
    v_cvt_pk_bf16_f32 v142, v12, v13
    v_cvt_pk_bf16_f32 v143, v14, v15
    v_cvt_pk_bf16_f32 v128, v56, v57
    v_cvt_pk_bf16_f32 v129, v58, v59
    v_cvt_pk_bf16_f32 v130, v60, v61
    v_cvt_pk_bf16_f32 v131, v62, v63
    v_cvt_pk_bf16_f32 v144, v16, v17
    v_cvt_pk_bf16_f32 v145, v18, v19
    v_cvt_pk_bf16_f32 v146, v20, v21
    v_cvt_pk_bf16_f32 v147, v22, v23
    v_cvt_pk_bf16_f32 v132, v64, v65
    v_cvt_pk_bf16_f32 v133, v66, v67
    v_cvt_pk_bf16_f32 v134, v68, v69
    v_cvt_pk_bf16_f32 v135, v70, v71
    v_cvt_pk_bf16_f32 v148, v24, v25
    v_cvt_pk_bf16_f32 v149, v26, v27
    v_cvt_pk_bf16_f32 v150, v28, v29
    v_cvt_pk_bf16_f32 v151, v30, v31
    v_cvt_pk_bf16_f32 v136, v72, v73
    v_cvt_pk_bf16_f32 v137, v74, v75
    v_cvt_pk_bf16_f32 v138, v76, v77
    v_cvt_pk_bf16_f32 v139, v78, v79
    v_cvt_pk_bf16_f32 v152, v32, v33
    v_cvt_pk_bf16_f32 v153, v34, v35
    v_cvt_pk_bf16_f32 v154, v36, v37
    v_cvt_pk_bf16_f32 v155, v38, v39
    v_mfma_f32_16x16x32_bf16 v[8:11], v[120:123], v[140:143], 0
    v_mfma_f32_16x16x32_bf16 v[12:15], v[124:127], v[140:143], 0
    v_mfma_f32_16x16x32_bf16 v[16:19], v[124:127], v[144:147], 0
    v_mfma_f32_16x16x32_bf16 v[20:23], v[128:131], v[144:147], 0
    v_mfma_f32_16x16x32_bf16 v[24:27], v[128:131], v[148:151], 0
    v_mfma_f32_16x16x32_bf16 v[28:31], v[132:135], v[148:151], 0
    v_mfma_f32_16x16x32_bf16 v[32:35], v[132:135], v[152:155], 0
    v_mfma_f32_16x16x32_bf16 v[36:39], v[136:139], v[152:155], 0
    v_cvt_pk_bf16_f32 v156, v80, v81
    v_cvt_pk_bf16_f32 v157, v82, v83
    v_cvt_pk_bf16_f32 v166, v84, v85
    v_cvt_pk_bf16_f32 v167, v86, v87
    v_cvt_pk_bf16_f32 v158, v88, v89
    v_cvt_pk_bf16_f32 v159, v90, v91
    v_cvt_pk_bf16_f32 v168, v92, v93
    v_cvt_pk_bf16_f32 v169, v94, v95
    v_cvt_pk_bf16_f32 v160, v96, v97
    v_cvt_pk_bf16_f32 v161, v98, v99
    v_cvt_pk_bf16_f32 v170, v100, v101
    v_cvt_pk_bf16_f32 v171, v102, v103
    v_cvt_pk_bf16_f32 v162, v104, v105
    v_cvt_pk_bf16_f32 v163, v106, v107
    v_cvt_pk_bf16_f32 v172, v108, v109
    v_cvt_pk_bf16_f32 v173, v110, v111
    v_cvt_pk_bf16_f32 v164, v112, v113
    v_cvt_pk_bf16_f32 v165, v114, v115
    v_cvt_pk_bf16_f32 v174, v116, v117
    v_cvt_pk_bf16_f32 v175, v118, v119
    s_mov_b32 s64, 0x3e8293ee
    v_mov_b32 v5, 0xf149f2ca
    v_cndmask_b32 v8, v5, v8, s[88:89]
    v_cndmask_b32 v12, v5, v12, s[80:81]
    v_cndmask_b32 v9, v5, v9, s[90:91]
    v_cndmask_b32 v13, v5, v13, s[82:83]
    v_cndmask_b32 v10, v5, v10, s[92:93]
    v_cndmask_b32 v14, v5, v14, s[84:85]
    v_cndmask_b32 v11, v5, v11, s[94:95]
    v_cndmask_b32 v15, v5, v15, s[86:87]
    v_cndmask_b32 v16, v5, v16, s[72:73]
    v_cndmask_b32 v20, v5, v20, s[80:81]
    v_cndmask_b32 v17, v5, v17, s[74:75]
    v_cndmask_b32 v21, v5, v21, s[82:83]
    v_cndmask_b32 v18, v5, v18, s[76:77]
    v_cndmask_b32 v22, v5, v22, s[84:85]
    v_cndmask_b32 v19, v5, v19, s[78:79]
    v_cndmask_b32 v23, v5, v23, s[86:87]
    v_cndmask_b32 v24, v5, v24, s[72:73]
    v_cndmask_b32 v28, v5, v28, s[80:81]
    v_cndmask_b32 v25, v5, v25, s[74:75]
    v_cndmask_b32 v29, v5, v29, s[82:83]
    v_cndmask_b32 v26, v5, v26, s[76:77]
    v_cndmask_b32 v30, v5, v30, s[84:85]
    v_cndmask_b32 v27, v5, v27, s[78:79]
    v_cndmask_b32 v31, v5, v31, s[86:87]
    v_cndmask_b32 v32, v5, v32, s[72:73]
    v_cndmask_b32 v36, v5, v36, s[80:81]
    v_cndmask_b32 v33, v5, v33, s[74:75]
    v_cndmask_b32 v37, v5, v37, s[82:83]
    v_cndmask_b32 v34, v5, v34, s[76:77]
    v_cndmask_b32 v38, v5, v38, s[84:85]
    v_cndmask_b32 v35, v5, v35, s[78:79]
    v_cndmask_b32 v39, v5, v39, s[86:87]
    v_max3_f32 v192, v8, v9, v10
    v_max3_f32 v196, v11, v12, v13
    v_max3_f32 v193, v16, v17, v18
    v_max3_f32 v197, v19, v20, v21
    v_max3_f32 v194, v24, v25, v26
    v_max3_f32 v198, v27, v28, v29
    v_max3_f32 v195, v32, v33, v34
    v_max3_f32 v199, v35, v36, v37
    v_max3_f32 v192, v192, v14, v15
    v_max3_f32 v193, v193, v22, v23
    v_max3_f32 v194, v194, v30, v31
    v_max3_f32 v195, v195, v38, v39
    v_max_f32 v192, v192, v196
    v_max_f32 v193, v193, v197
    v_max_f32 v194, v194, v198
    v_max_f32 v195, v195, v199
    v_mov_b32 v196, v192
    v_mov_b32 v197, v193
    v_mov_b32 v198, v194
    v_mov_b32 v199, v195
    v_permlane32_swap_b32 v192, v196
    v_permlane32_swap_b32 v193, v197
    v_permlane32_swap_b32 v194, v198
    v_permlane32_swap_b32 v195, v199
    v_max_f32 v192, v192, v196
    v_max_f32 v193, v193, v197
    v_max_f32 v194, v194, v198
    v_max_f32 v195, v195, v199
    v_mov_b32 v196, v192
    v_mov_b32 v197, v193
    v_mov_b32 v198, v194
    v_mov_b32 v199, v195
    v_permlane16_swap_b32 v192, v196
    v_permlane16_swap_b32 v193, v197
    v_permlane16_swap_b32 v194, v198
    v_permlane16_swap_b32 v195, v199
    v_max_f32 v192, v192, v196
    v_max_f32 v193, v193, v197
    v_max_f32 v194, v194, v198
    v_max_f32 v195, v195, v199
    v_mul_f32 v192, s64, v192
    v_mul_f32 v193, s64, v193
    v_mul_f32 v194, s64, v194
    v_mul_f32 v195, s64, v195
    v_fma_f32 v8, v8, s64, -v192
    v_fma_f32 v9, v9, s64, -v192
    v_fma_f32 v10, v10, s64, -v192
    v_fma_f32 v11, v11, s64, -v192
    v_fma_f32 v12, v12, s64, -v192
    v_fma_f32 v13, v13, s64, -v192
    v_fma_f32 v14, v14, s64, -v192
    v_fma_f32 v15, v15, s64, -v192
    v_fma_f32 v16, v16, s64, -v193
    v_fma_f32 v17, v17, s64, -v193
    v_fma_f32 v18, v18, s64, -v193
    v_fma_f32 v19, v19, s64, -v193
    v_fma_f32 v20, v20, s64, -v193
    v_fma_f32 v21, v21, s64, -v193
    v_fma_f32 v22, v22, s64, -v193
    v_fma_f32 v23, v23, s64, -v193
    v_fma_f32 v24, v24, s64, -v194
    v_fma_f32 v25, v25, s64, -v194
    v_fma_f32 v26, v26, s64, -v194
    v_fma_f32 v27, v27, s64, -v194
    v_fma_f32 v28, v28, s64, -v194
    v_fma_f32 v29, v29, s64, -v194
    v_fma_f32 v30, v30, s64, -v194
    v_fma_f32 v31, v31, s64, -v194
    v_fma_f32 v32, v32, s64, -v195
    v_fma_f32 v33, v33, s64, -v195
    v_fma_f32 v34, v34, s64, -v195
    v_fma_f32 v35, v35, s64, -v195
    v_fma_f32 v36, v36, s64, -v195
    v_fma_f32 v37, v37, s64, -v195
    v_fma_f32 v38, v38, s64, -v195
    v_fma_f32 v39, v39, s64, -v195
    v_exp_f32 v8, v8
    v_exp_f32 v9, v9
    v_exp_f32 v10, v10
    v_exp_f32 v11, v11
    v_exp_f32 v12, v12
    v_exp_f32 v13, v13
    v_exp_f32 v14, v14
    v_exp_f32 v15, v15
    v_exp_f32 v16, v16
    v_exp_f32 v17, v17
    v_exp_f32 v18, v18
    v_exp_f32 v19, v19
    v_exp_f32 v20, v20
    v_exp_f32 v21, v21
    v_exp_f32 v22, v22
    v_exp_f32 v23, v23
    v_exp_f32 v24, v24
    v_exp_f32 v25, v25
    v_exp_f32 v26, v26
    v_exp_f32 v27, v27
    v_exp_f32 v28, v28
    v_exp_f32 v29, v29
    v_exp_f32 v30, v30
    v_exp_f32 v31, v31
    v_exp_f32 v32, v32
    v_exp_f32 v33, v33
    v_exp_f32 v34, v34
    v_exp_f32 v35, v35
    v_exp_f32 v36, v36
    v_exp_f32 v37, v37
    v_exp_f32 v38, v38
    v_exp_f32 v39, v39
    v_pk_add_f32 v[200:201], v[8:9], v[10:11]
    v_pk_add_f32 v[202:203], v[16:17], v[18:19]
    v_pk_add_f32 v[204:205], v[24:25], v[26:27]
    v_pk_add_f32 v[206:207], v[32:33], v[34:35]
    v_pk_add_f32 v[200:201], v[200:201], v[12:13]
    v_pk_add_f32 v[202:203], v[202:203], v[20:21]
    v_pk_add_f32 v[204:205], v[204:205], v[28:29]
    v_pk_add_f32 v[206:207], v[206:207], v[36:37]
    v_pk_add_f32 v[200:201], v[200:201], v[14:15]
    v_pk_add_f32 v[202:203], v[202:203], v[22:23]
    v_pk_add_f32 v[204:205], v[204:205], v[30:31]
    v_pk_add_f32 v[206:207], v[206:207], v[38:39]
    v_add_f32 v200, v200, v201
    v_add_f32 v202, v202, v203
    v_add_f32 v204, v204, v205
    v_add_f32 v206, v206, v207
    v_mov_b32 v196, v200
    v_mov_b32 v197, v202
    v_mov_b32 v198, v204
    v_mov_b32 v199, v206
    v_permlane32_swap_b32 v200, v196
    v_permlane32_swap_b32 v202, v197
    v_permlane32_swap_b32 v204, v198
    v_permlane32_swap_b32 v206, v199
    v_add_f32 v200, v200, v196
    v_add_f32 v202, v202, v197
    v_add_f32 v204, v204, v198
    v_add_f32 v206, v206, v199
    v_mov_b32 v196, v200
    v_mov_b32 v197, v202
    v_mov_b32 v198, v204
    v_mov_b32 v199, v206
    v_permlane16_swap_b32 v200, v196
    v_permlane16_swap_b32 v202, v197
    v_permlane16_swap_b32 v204, v198
    v_permlane16_swap_b32 v206, v199
    v_add_f32 v200, v200, v196
    v_add_f32 v202, v202, v197
    v_add_f32 v204, v204, v198
    v_add_f32 v206, v206, v199
    v_rcp_f32 v200, v200
    v_rcp_f32 v202, v202
    v_rcp_f32 v204, v204
    v_rcp_f32 v206, v206
    v_pk_mul_f32 v[8:9], v[8:9], v[200:201] op_sel_hi:[1,0]
    v_pk_mul_f32 v[10:11], v[10:11], v[200:201] op_sel_hi:[1,0]
    v_pk_mul_f32 v[12:13], v[12:13], v[200:201] op_sel_hi:[1,0]
    v_pk_mul_f32 v[14:15], v[14:15], v[200:201] op_sel_hi:[1,0]
    v_pk_mul_f32 v[16:17], v[16:17], v[202:203] op_sel_hi:[1,0]
    v_pk_mul_f32 v[18:19], v[18:19], v[202:203] op_sel_hi:[1,0]
    v_pk_mul_f32 v[20:21], v[20:21], v[202:203] op_sel_hi:[1,0]
    v_pk_mul_f32 v[22:23], v[22:23], v[202:203] op_sel_hi:[1,0]
    v_pk_mul_f32 v[24:25], v[24:25], v[204:205] op_sel_hi:[1,0]
    v_pk_mul_f32 v[26:27], v[26:27], v[204:205] op_sel_hi:[1,0]
    v_pk_mul_f32 v[28:29], v[28:29], v[204:205] op_sel_hi:[1,0]
    v_pk_mul_f32 v[30:31], v[30:31], v[204:205] op_sel_hi:[1,0]
    v_pk_mul_f32 v[32:33], v[32:33], v[206:207] op_sel_hi:[1,0]
    v_pk_mul_f32 v[34:35], v[34:35], v[206:207] op_sel_hi:[1,0]
    v_pk_mul_f32 v[36:37], v[36:37], v[206:207] op_sel_hi:[1,0]
    v_pk_mul_f32 v[38:39], v[38:39], v[206:207] op_sel_hi:[1,0]
    v_cvt_pk_bf16_f32 v176, v8, v9
    v_cvt_pk_bf16_f32 v177, v10, v11
    v_cvt_pk_bf16_f32 v178, v12, v13
    v_cvt_pk_bf16_f32 v179, v14, v15
    v_cvt_pk_bf16_f32 v180, v16, v17
    v_cvt_pk_bf16_f32 v181, v18, v19
    v_cvt_pk_bf16_f32 v182, v20, v21
    v_cvt_pk_bf16_f32 v183, v22, v23
    v_cvt_pk_bf16_f32 v184, v24, v25
    v_cvt_pk_bf16_f32 v185, v26, v27
    v_cvt_pk_bf16_f32 v186, v28, v29
    v_cvt_pk_bf16_f32 v187, v30, v31
    v_cvt_pk_bf16_f32 v188, v32, v33
    v_cvt_pk_bf16_f32 v189, v34, v35
    v_cvt_pk_bf16_f32 v190, v36, v37
    v_cvt_pk_bf16_f32 v191, v38, v39
    v_mfma_f32_16x16x32_bf16 v[40:43], v[156:159], v[176:179], 0
    v_mfma_f32_16x16x32_bf16 v[44:47], v[166:169], v[176:179], 0
    v_mfma_f32_16x16x32_bf16 v[48:51], v[158:161], v[180:183], 0
    v_mfma_f32_16x16x32_bf16 v[52:55], v[168:171], v[180:183], 0
    v_mfma_f32_16x16x32_bf16 v[56:59], v[160:163], v[184:187], 0
    v_mfma_f32_16x16x32_bf16 v[60:63], v[170:173], v[184:187], 0
    v_mfma_f32_16x16x32_bf16 v[64:67], v[162:165], v[188:191], 0
    v_mfma_f32_16x16x32_bf16 v[68:71], v[172:175], v[188:191], 0
    s_mov_b32 s72, 0x0
    s_mov_b32 s73, 0x8000
    s_mov_b32 s74, 0x10000
    s_mov_b32 s75, 0x18000
    v_cvt_pk_bf16_f32 v120, v40, v41
    v_cvt_pk_bf16_f32 v121, v42, v43
    v_cvt_pk_bf16_f32 v122, v44, v45
    v_cvt_pk_bf16_f32 v123, v46, v47
    buffer_store_dwordx4 v[120:123], v237, s[28:31], s72 offen sc1
    v_cvt_pk_bf16_f32 v124, v48, v49
    v_cvt_pk_bf16_f32 v125, v50, v51
    v_cvt_pk_bf16_f32 v126, v52, v53
    v_cvt_pk_bf16_f32 v127, v54, v55
    buffer_store_dwordx4 v[124:127], v237, s[28:31], s73 offen sc1
    v_cvt_pk_bf16_f32 v128, v56, v57
    v_cvt_pk_bf16_f32 v129, v58, v59
    v_cvt_pk_bf16_f32 v130, v60, v61
    v_cvt_pk_bf16_f32 v131, v62, v63
    buffer_store_dwordx4 v[128:131], v237, s[28:31], s74 offen sc1
    v_cvt_pk_bf16_f32 v132, v64, v65
    v_cvt_pk_bf16_f32 v133, v66, v67
    v_cvt_pk_bf16_f32 v134, v68, v69
    v_cvt_pk_bf16_f32 v135, v70, v71
    buffer_store_dwordx4 v[132:135], v237, s[28:31], s75 offen sc1
    s_lshl_b32 s64, s44, 13
    s_lshl_b32 s65, s48, 9
    s_add_u32 s64, s64, s65
    s_add_u32 s64, s64, 0xa0000
    v_lshl_add_u32 v200, v1, 3, s64
    s_mov_b32 s76, 0
    s_mov_b32 s77, 32768
    s_mov_b32 s78, 65536
    s_mov_b32 s79, 98304
    s_lshl_b32 s68, s47, 9
    s_add_u32 s68, s68, 0x54000
    s_add_u32 s62, s26, s68
    s_addc_u32 s63, s27, 0
    s_lshr_b32 s68, s48, 2
    s_lshl_b32 s68, s68, 7
    v_mov_b32 v2, 1
    v_mov_b32 v5, 148484
    s_waitcnt vmcnt(0)
    s_mov_b64 exec, 1
    ds_add_rtn_u32 v245, v5, v2
    s_mov_b64 exec, -1
    s_mov_b32 s1, 1
    s_mov_b32 s3, 0x40000
    s_waitcnt lgkmcnt(0)
    v_readfirstlane_b32 s64, v245
    s_nop 3
    s_cmp_lg_u32 s64, 3
    s_cbranch_scc1 M_po_ok
    s_atomic_add s1, s[62:63], 0
    s_atomic_add s1, s[62:63], 128
    s_atomic_add s1, s[62:63], 256
    s_atomic_add s1, s[62:63], 384
M_po_chk:
    s_load_dword s64, s[62:63], s68 glc
    s_sub_u32 s3, s3, 1
    s_cselect_b32 s65, 0, 16
    s_waitcnt lgkmcnt(0)
    s_cmp_lt_u32 s64, s65
    s_cbranch_scc1 M_po_chk
M_po_ok:
    s_barrier
    s_setprio 0
    s_and_b32 s57, s58, 15
    s_lshr_b64 s[58:59], s[58:59], 4
    s_lshl_b32 s56, s57, 11
    s_mul_i32 s57, s57, 0x20000
    s_mov_b32 m0, s53
    s_nop 0
    buffer_load_dwordx4 v208, s[28:31], s56 offen offset:0 lds
    buffer_load_dwordx4 v208, s[28:31], s56 offen offset:1024 lds
    buffer_load_dwordx4 v209, s[28:31], s56 offen offset:2048 lds
    buffer_load_dwordx4 v209, s[28:31], s56 offen offset:3072 lds
    s_add_u32 s53, s53, 24576
    s_cmp_ge_u32 s53, s61
    s_cselect_b32 s53, s60, s53
    s_and_b32 s57, s58, 15
    s_lshr_b64 s[58:59], s[58:59], 4
    s_lshl_b32 s56, s57, 11
    s_mul_i32 s57, s57, 0x20000
    s_mov_b32 m0, s53
    s_nop 0
    buffer_load_dwordx4 v208, s[28:31], s56 offen offset:0 lds
    buffer_load_dwordx4 v208, s[28:31], s56 offen offset:1024 lds
    buffer_load_dwordx4 v209, s[28:31], s56 offen offset:2048 lds
    buffer_load_dwordx4 v209, s[28:31], s56 offen offset:3072 lds
    s_add_u32 s53, s53, 24576
    s_cmp_ge_u32 s53, s61
    s_cselect_b32 s53, s60, s53
    s_and_b32 s57, s58, 15
    s_lshr_b64 s[58:59], s[58:59], 4
    s_lshl_b32 s56, s57, 11
    s_mul_i32 s57, s57, 0x20000
    s_mov_b32 m0, s53
    s_nop 0
    buffer_load_dwordx4 v208, s[28:31], s56 offen offset:0 lds
    buffer_load_dwordx4 v208, s[28:31], s56 offen offset:1024 lds
    buffer_load_dwordx4 v209, s[28:31], s56 offen offset:2048 lds
    buffer_load_dwordx4 v209, s[28:31], s56 offen offset:3072 lds
    s_add_u32 s53, s53, 24576
    s_cmp_ge_u32 s53, s61
    s_cselect_b32 s53, s60, s53
    buffer_load_dwordx2 v[192:193], v200, s[28:31], s76 offen sc1
    buffer_load_dwordx2 v[194:195], v200, s[28:31], s77 offen sc1
    buffer_load_dwordx2 v[196:197], v200, s[28:31], s78 offen sc1
    buffer_load_dwordx2 v[198:199], v200, s[28:31], s79 offen sc1
    s_lshl_b32 s64, s45, 13
    v_lshl_add_u32 v233, v1, 4, s64
    v_lshrrev_b32 v2, 2, v1
    v_lshlrev_b32 v4, 8, v2
    v_and_b32 v5, 3, v1
    v_lshl_add_u32 v4, v5, 3, v4
    v_add_u32 v4, 16384, v4
    v_and_b32 v2, 7, v2
    s_lshl_b32 s64, s46, 2
    v_xor_b32 v2, s64, v2
    v_xor_b32 v3, 0, v2
    v_lshl_add_u32 v239, v3, 5, v4
    v_xor_b32 v3, 1, v2
    v_lshl_add_u32 v240, v3, 5, v4
    v_xor_b32 v3, 2, v2
    v_lshl_add_u32 v241, v3, 5, v4
    v_xor_b32 v3, 3, v2
    v_lshl_add_u32 v242, v3, 5, v4
    s_lshl_b32 s64, s2, 2
    s_add_u32 s64, s64, s44
    s_mul_i32 s64, s64, 7168
    s_add_u32 s64, s64, 2304
    s_add_u32 s10, s12, s64
    s_addc_u32 s11, s13, 0
    s_add_u32 s24, s14, s64
    s_addc_u32 s25, s15, 0
    s_mov_b32 s52, 0
    v_add_u32 v232, s52, v233
    v_add_u32 v235, s52, v239
    v_add_u32 v236, s52, v240
    v_add_u32 v237, s52, v241
    v_add_u32 v238, s52, v242
    s_movk_i32 s54, 2
M_P_loop1:
    s_waitcnt vmcnt(12)
    s_barrier
    s_and_b32 s57, s58, 15
    s_lshr_b64 s[58:59], s[58:59], 4
    s_lshl_b32 s56, s57, 11
    s_mul_i32 s57, s57, 0x20000
    s_mov_b32 m0, s53
    s_nop 0
    buffer_load_dwordx4 v208, s[28:31], s56 offen offset:0 lds
    buffer_load_dwordx4 v208, s[28:31], s56 offen offset:1024 lds
    buffer_load_dwordx4 v209, s[28:31], s56 offen offset:2048 lds
    buffer_load_dwordx4 v209, s[28:31], s56 offen offset:3072 lds
    s_add_u32 s53, s53, 24576
    s_cmp_ge_u32 s53, s61
    s_cselect_b32 s53, s60, s53
    s_sub_u32 s54, s54, 1
    s_cbranch_scc0 M_P_loop1
    s_waitcnt vmcnt(8)
    s_barrier
    s_and_b32 s57, s58, 15
    s_lshr_b64 s[58:59], s[58:59], 4
    s_lshl_b32 s56, s57, 11
    s_mul_i32 s57, s57, 0x20000
    s_add_u32 m0, s53, s70
    s_nop 0
    buffer_load_dwordx4 v210, s[32:35], s57 offen offset:0 lds
    buffer_load_dwordx4 v211, s[32:35], s57 offen offset:1024 lds
    s_mov_b32 m0, s53
    s_nop 0
    buffer_load_dwordx4 v208, s[28:31], s56 offen offset:0 lds
    buffer_load_dwordx4 v208, s[28:31], s56 offen offset:1024 lds
    buffer_load_dwordx4 v209, s[28:31], s56 offen offset:2048 lds
    buffer_load_dwordx4 v209, s[28:31], s56 offen offset:3072 lds
    s_add_u32 s53, s53, 24576
    s_cmp_ge_u32 s53, s61
    s_cselect_b32 s53, s60, s53
    s_mov_b32 s3, 0x40000
M_tb_chk:
    v_xor_b32 v2, s0, v193
    v_xor_b32 v3, s0, v195
    v_xor_b32 v4, s0, v197
    v_xor_b32 v5, s0, v199
    v_or3_b32 v2, v2, v3, v4
    v_or_b32 v2, v2, v5
    v_cmp_ne_u32 vcc, 0, v2
    s_nop 4
    s_cbranch_vccz M_tb_ok
    s_sub_u32 s3, s3, 1
    s_cbranch_scc1 M_tb_ok
    s_sleep 1
    buffer_load_dwordx2 v[192:193], v200, s[28:31], s76 offen sc1
    buffer_load_dwordx2 v[194:195], v200, s[28:31], s77 offen sc1
    buffer_load_dwordx2 v[196:197], v200, s[28:31], s78 offen sc1
    buffer_load_dwordx2 v[198:199], v200, s[28:31], s79 offen sc1
    s_waitcnt vmcnt(0)
    s_branch M_tb_chk
M_tb_ok:
    v_add_f32 v192, v192, v194
    v_add_f32 v196, v196, v198
    v_add_f32 v192, v192, v196
    v_cvt_pk_bf16_f32 v193, v192, v192
    v_lshlrev_b32 v192, 16, v193
    s_cmp_eq_u32 s44, 2
    s_cselect_b32 s64, 1.0, 0
    v_add_f32 v192, s64, v192
    v_cvt_pk_bf16_f32 v193, v192, v192
    v_lshlrev_b32 v192, 16, v193
    s_cmp_lg_u32 s45, s46
    s_cselect_b32 s64, 0x3fb8aa3b, 1.0
    v_mul_f32 v192, s64, v192
    s_lshl_b32 s64, s44, 8
    s_add_u32 s64, s64, 149504
    v_add_u32 v2, s64, v234
    ds_write_b32 v2, v192
    s_lshl_b32 s64, s47, 12
    s_lshl_b32 s65, s48, 8
    s_add_u32 s64, s64, s65
    s_add_u32 s64, s64, 0xc0000
    s_cmp_eq_u32 s44, 3
    s_cselect_b32 s64, s64, 0x80000000
    v_add_u32 v2, s64, v234
    buffer_store_dword v192, v2, s[28:31], 0 offen sc1
    s_waitcnt lgkmcnt(0)
    s_waitcnt vmcnt(11)
    s_barrier
    s_and_b32 s57, s58, 15
    s_lshr_b64 s[58:59], s[58:59], 4
    s_lshl_b32 s56, s57, 11
    s_mul_i32 s57, s57, 0x20000
    s_add_u32 m0, s53, s70
    s_nop 0
    buffer_load_dwordx4 v210, s[32:35], s57 offen offset:0 lds
    buffer_load_dwordx4 v211, s[32:35], s57 offen offset:1024 lds
    s_mov_b32 m0, s53
    s_nop 0
    buffer_load_dwordx4 v208, s[28:31], s56 offen offset:0 lds
    buffer_load_dwordx4 v208, s[28:31], s56 offen offset:1024 lds
    buffer_load_dwordx4 v209, s[28:31], s56 offen offset:2048 lds
    buffer_load_dwordx4 v209, s[28:31], s56 offen offset:3072 lds
    s_add_u32 s53, s53, 24576
    s_cmp_ge_u32 s53, s61
    s_cselect_b32 s53, s60, s53
    s_movk_i32 s54, 1
M_P_loop2:
    s_waitcnt vmcnt(13)
    s_barrier
    s_and_b32 s57, s58, 15
    s_lshr_b64 s[58:59], s[58:59], 4
    s_lshl_b32 s56, s57, 11
    s_mul_i32 s57, s57, 0x20000
    s_add_u32 m0, s53, s70
    s_nop 0
    buffer_load_dwordx4 v210, s[32:35], s57 offen offset:0 lds
    buffer_load_dwordx4 v211, s[32:35], s57 offen offset:1024 lds
    s_mov_b32 m0, s53
    s_nop 0
    buffer_load_dwordx4 v208, s[28:31], s56 offen offset:0 lds
    buffer_load_dwordx4 v208, s[28:31], s56 offen offset:1024 lds
    buffer_load_dwordx4 v209, s[28:31], s56 offen offset:2048 lds
    buffer_load_dwordx4 v209, s[28:31], s56 offen offset:3072 lds
    s_add_u32 s53, s53, 24576
    s_cmp_ge_u32 s53, s61
    s_cselect_b32 s53, s60, s53
    s_sub_u32 s54, s54, 1
    s_cbranch_scc0 M_P_loop2
    s_movk_i32 s54, 4
M_P_loop3:
    s_waitcnt vmcnt(12)
    s_barrier
    s_and_b32 s57, s58, 15
    s_lshr_b64 s[58:59], s[58:59], 4
    s_lshl_b32 s56, s57, 11
    s_mul_i32 s57, s57, 0x20000
    s_add_u32 m0, s53, s70
    s_nop 0
    buffer_load_dwordx4 v210, s[32:35], s57 offen offset:0 lds
    buffer_load_dwordx4 v211, s[32:35], s57 offen offset:1024 lds
    s_mov_b32 m0, s53
    s_nop 0
    buffer_load_dwordx4 v208, s[28:31], s56 offen offset:0 lds
    buffer_load_dwordx4 v208, s[28:31], s56 offen offset:1024 lds
    buffer_load_dwordx4 v209, s[28:31], s56 offen offset:2048 lds
    buffer_load_dwordx4 v209, s[28:31], s56 offen offset:3072 lds
    s_add_u32 s53, s53, 24576
    s_cmp_ge_u32 s53, s61
    s_cselect_b32 s53, s60, s53
    s_sub_u32 s54, s54, 1
    s_cbranch_scc0 M_P_loop3
    s_waitcnt vmcnt(12)
    s_barrier
    s_and_b32 s57, s58, 15
    s_lshr_b64 s[58:59], s[58:59], 4
    s_lshl_b32 s56, s57, 11
    s_mul_i32 s57, s57, 0x20000
    s_add_u32 m0, s53, s70
    s_nop 0
    buffer_load_dwordx4 v210, s[32:35], s57 offen offset:0 lds
    buffer_load_dwordx4 v211, s[32:35], s57 offen offset:1024 lds
    s_mov_b32 m0, s53
    s_nop 0
    buffer_load_dwordx4 v208, s[28:31], s56 offen offset:0 lds
    buffer_load_dwordx4 v208, s[28:31], s56 offen offset:1024 lds
    buffer_load_dwordx4 v209, s[28:31], s56 offen offset:2048 lds
    buffer_load_dwordx4 v209, s[28:31], s56 offen offset:3072 lds
    s_add_u32 s53, s53, 24576
    s_cmp_ge_u32 s53, s61
    s_cselect_b32 s53, s60, s53
    s_lshl_b32 s60, s44, 12
    s_add_u32 s61, s60, 147456
    s_add_u32 s53, s60, 0
    s_bfe_u32 s66, s2, 0x30003
    s_lshr_b32 s55, s2, 6
    s_add_u32 s66, s66, s55
    s_and_b32 s66, s66, 3
    s_mov_b32 s58, 0x76453210
    s_mov_b32 s59, 0xfecdba89
    s_cmp_eq_u32 s66, 1
    s_cselect_b32 s58, 0x75643120, s58
    s_cselect_b32 s59, 0xfdecb9a8, s59
    s_cmp_eq_u32 s66, 2
    s_cselect_b32 s58, 0x67542310, s58
    s_cselect_b32 s59, 0xefdcab98, s59
    s_cmp_eq_u32 s66, 3
    s_cselect_b32 s58, 0x86534210, s58
    s_cselect_b32 s59, 0xfedbca97, s59
    s_mov_b32 s32, s12
    s_mov_b32 s33, s13
    s_mov_b32 s34, 0x700000
    s_mov_b32 s35, 0x20000
    s_mov_b32 s36, s14
    s_mov_b32 s37, s15
    s_mov_b32 s38, 0x700000
    s_mov_b32 s39, 0x20000
    s_and_b32 s57, s58, 15
    s_lshr_b64 s[58:59], s[58:59], 4
    s_lshl_b32 s56, s57, 11
    s_mul_i32 s57, s57, 0x70000
    s_add_u32 m0, s53, 16384
    s_nop 0
    buffer_load_dwordx4 v212, s[32:35], s57 offen offset:0 lds
    buffer_load_dwordx4 v213, s[32:35], s57 offen offset:1024 lds
    s_waitcnt vmcnt(14)
    s_barrier
    buffer_load_dwordx4 v214, s[32:35], s57 offen offset:2048 lds
    buffer_load_dwordx4 v215, s[32:35], s57 offen offset:3072 lds
    s_add_u32 m0, s53, 32768
    s_nop 0
    buffer_load_dwordx4 v212, s[36:39], s57 offen offset:0 lds
    s_waitcnt vmcnt(11)
    s_barrier
    buffer_load_dwordx4 v213, s[36:39], s57 offen offset:1024 lds
    buffer_load_dwordx4 v214, s[36:39], s57 offen offset:2048 lds
    buffer_load_dwordx4 v215, s[36:39], s57 offen offset:3072 lds
    s_waitcnt vmcnt(8)
    s_barrier
    s_add_u32 s53, s53, 49152
    s_cmp_ge_u32 s53, s61
    s_cselect_b32 s53, s60, s53
    s_barrier
    s_setprio 2
    s_barrier
    s_waitcnt vmcnt(0)
    s_barrier
    ds_read_b128 v[136:139], v232 offset:0
    ds_read_b64_tr_b16 v[152:153], v235 offset:0
    ds_read_b64_tr_b16 v[154:155], v235 offset:4096
    ds_read_b64_tr_b16 v[156:157], v236 offset:0
    ds_read_b64_tr_b16 v[158:159], v236 offset:4096
    ds_read_b64_tr_b16 v[160:161], v237 offset:0
    ds_read_b64_tr_b16 v[162:163], v237 offset:4096
    ds_read_b64_tr_b16 v[164:165], v238 offset:0
    ds_read_b64_tr_b16 v[166:167], v238 offset:4096
    ds_read_b64_tr_b16 v[168:169], v235 offset:16384
    ds_read_b64_tr_b16 v[170:171], v235 offset:20480
    ds_read_b64_tr_b16 v[172:173], v236 offset:16384
    ds_read_b64_tr_b16 v[174:175], v236 offset:20480
    ds_read_b64_tr_b16 v[176:177], v237 offset:16384
    ds_read_b64_tr_b16 v[178:179], v237 offset:20480
    ds_read_b64_tr_b16 v[180:181], v238 offset:16384
    ds_read_b64_tr_b16 v[182:183], v238 offset:20480
    ds_read_b128 v[140:143], v232 offset:2048
    ds_read_b128 v[144:147], v232 offset:4096
    ds_read_b128 v[148:151], v232 offset:6144
    s_add_u32 s52, s52, 49152
    s_cmp_ge_u32 s52, 147456
    s_cselect_b32 s52, 0, s52
    s_waitcnt lgkmcnt(0)
    v_mfma_f32_16x16x32_bf16 v[8:11], v[152:155], v[136:139], 0
    ds_read_b128 v[184:187], v232 offset:1024
    v_mfma_f32_16x16x32_bf16 v[12:15], v[156:159], v[136:139], 0
    ds_read_b64_tr_b16 v[200:201], v235 offset:8192
    v_mfma_f32_16x16x32_bf16 v[16:19], v[160:163], v[136:139], 0
    ds_read_b64_tr_b16 v[202:203], v235 offset:12288
    v_mfma_f32_16x16x32_bf16 v[20:23], v[164:167], v[136:139], 0
    ds_read_b64_tr_b16 v[204:205], v236 offset:8192
    v_mfma_f32_16x16x32_bf16 v[24:27], v[168:171], v[136:139], 0
    v_mfma_f32_16x16x32_bf16 v[28:31], v[172:175], v[136:139], 0
    ds_read_b64_tr_b16 v[206:207], v236 offset:12288
    v_mfma_f32_16x16x32_bf16 v[32:35], v[176:179], v[136:139], 0
    ds_read_b64_tr_b16 v[208:209], v237 offset:8192
    v_mfma_f32_16x16x32_bf16 v[36:39], v[180:183], v[136:139], 0
    ds_read_b64_tr_b16 v[210:211], v237 offset:12288
    v_mfma_f32_16x16x32_bf16 v[40:43], v[152:155], v[140:143], 0
    ds_read_b64_tr_b16 v[212:213], v238 offset:8192
    v_mfma_f32_16x16x32_bf16 v[44:47], v[156:159], v[140:143], 0
    v_mfma_f32_16x16x32_bf16 v[48:51], v[160:163], v[140:143], 0
    ds_read_b64_tr_b16 v[214:215], v238 offset:12288
    v_mfma_f32_16x16x32_bf16 v[52:55], v[164:167], v[140:143], 0
    ds_read_b64_tr_b16 v[216:217], v235 offset:24576
    v_mfma_f32_16x16x32_bf16 v[56:59], v[168:171], v[140:143], 0
    ds_read_b64_tr_b16 v[218:219], v235 offset:28672
    v_mfma_f32_16x16x32_bf16 v[60:63], v[172:175], v[140:143], 0
    ds_read_b64_tr_b16 v[220:221], v236 offset:24576
    v_mfma_f32_16x16x32_bf16 v[64:67], v[176:179], v[140:143], 0
    v_mfma_f32_16x16x32_bf16 v[68:71], v[180:183], v[140:143], 0
    ds_read_b64_tr_b16 v[222:223], v236 offset:28672
    v_mfma_f32_16x16x32_bf16 v[72:75], v[152:155], v[144:147], 0
    ds_read_b64_tr_b16 v[224:225], v237 offset:24576
    v_mfma_f32_16x16x32_bf16 v[76:79], v[156:159], v[144:147], 0
    ds_read_b64_tr_b16 v[226:227], v237 offset:28672
    v_mfma_f32_16x16x32_bf16 v[80:83], v[160:163], v[144:147], 0
    ds_read_b64_tr_b16 v[228:229], v238 offset:24576
    v_mfma_f32_16x16x32_bf16 v[84:87], v[164:167], v[144:147], 0
    v_mfma_f32_16x16x32_bf16 v[88:91], v[168:171], v[144:147], 0
    ds_read_b64_tr_b16 v[230:231], v238 offset:28672
    v_mfma_f32_16x16x32_bf16 v[92:95], v[172:175], v[144:147], 0
    ds_read_b128 v[188:191], v232 offset:3072
    v_mfma_f32_16x16x32_bf16 v[96:99], v[176:179], v[144:147], 0
    ds_read_b128 v[192:195], v232 offset:5120
    v_mfma_f32_16x16x32_bf16 v[100:103], v[180:183], v[144:147], 0
    ds_read_b128 v[196:199], v232 offset:7168
    v_mfma_f32_16x16x32_bf16 v[104:107], v[152:155], v[148:151], 0
    v_mfma_f32_16x16x32_bf16 v[108:111], v[156:159], v[148:151], 0
    v_add_u32 v232, s52, v233
    v_mfma_f32_16x16x32_bf16 v[112:115], v[160:163], v[148:151], 0
    v_add_u32 v235, s52, v239
    v_mfma_f32_16x16x32_bf16 v[116:119], v[164:167], v[148:151], 0
    v_add_u32 v236, s52, v240
    v_mfma_f32_16x16x32_bf16 v[120:123], v[168:171], v[148:151], 0
    v_mfma_f32_16x16x32_bf16 v[124:127], v[172:175], v[148:151], 0
    v_add_u32 v237, s52, v241
    v_mfma_f32_16x16x32_bf16 v[128:131], v[176:179], v[148:151], 0
    v_add_u32 v238, s52, v242
    v_mfma_f32_16x16x32_bf16 v[132:135], v[180:183], v[148:151], 0
    s_waitcnt lgkmcnt(0)
    v_mfma_f32_16x16x32_bf16 v[8:11], v[200:203], v[184:187], v[8:11]
    s_barrier
    v_mfma_f32_16x16x32_bf16 v[12:15], v[204:207], v[184:187], v[12:15]
    ds_read_b128 v[136:139], v232 offset:0
    v_mfma_f32_16x16x32_bf16 v[16:19], v[208:211], v[184:187], v[16:19]
    ds_read_b64_tr_b16 v[152:153], v235 offset:0
    v_mfma_f32_16x16x32_bf16 v[20:23], v[212:215], v[184:187], v[20:23]
    ds_read_b64_tr_b16 v[154:155], v235 offset:4096
    v_mfma_f32_16x16x32_bf16 v[24:27], v[216:219], v[184:187], v[24:27]
    ds_read_b64_tr_b16 v[156:157], v236 offset:0
    v_mfma_f32_16x16x32_bf16 v[28:31], v[220:223], v[184:187], v[28:31]
    ds_read_b64_tr_b16 v[158:159], v236 offset:4096
    v_mfma_f32_16x16x32_bf16 v[32:35], v[224:227], v[184:187], v[32:35]
    v_mfma_f32_16x16x32_bf16 v[36:39], v[228:231], v[184:187], v[36:39]
    ds_read_b64_tr_b16 v[160:161], v237 offset:0
    v_mfma_f32_16x16x32_bf16 v[40:43], v[200:203], v[188:191], v[40:43]
    ds_read_b64_tr_b16 v[162:163], v237 offset:4096
    v_mfma_f32_16x16x32_bf16 v[44:47], v[204:207], v[188:191], v[44:47]
    ds_read_b64_tr_b16 v[164:165], v238 offset:0
    v_mfma_f32_16x16x32_bf16 v[48:51], v[208:211], v[188:191], v[48:51]
    ds_read_b64_tr_b16 v[166:167], v238 offset:4096
    v_mfma_f32_16x16x32_bf16 v[52:55], v[212:215], v[188:191], v[52:55]
    ds_read_b64_tr_b16 v[168:169], v235 offset:16384
    v_mfma_f32_16x16x32_bf16 v[56:59], v[216:219], v[188:191], v[56:59]
    v_mfma_f32_16x16x32_bf16 v[60:63], v[220:223], v[188:191], v[60:63]
    ds_read_b64_tr_b16 v[170:171], v235 offset:20480
    v_mfma_f32_16x16x32_bf16 v[64:67], v[224:227], v[188:191], v[64:67]
    ds_read_b64_tr_b16 v[172:173], v236 offset:16384
    v_mfma_f32_16x16x32_bf16 v[68:71], v[228:231], v[188:191], v[68:71]
    ds_read_b64_tr_b16 v[174:175], v236 offset:20480
    v_mfma_f32_16x16x32_bf16 v[72:75], v[200:203], v[192:195], v[72:75]
    ds_read_b64_tr_b16 v[176:177], v237 offset:16384
    v_mfma_f32_16x16x32_bf16 v[76:79], v[204:207], v[192:195], v[76:79]
    ds_read_b64_tr_b16 v[178:179], v237 offset:20480
    v_mfma_f32_16x16x32_bf16 v[80:83], v[208:211], v[192:195], v[80:83]
    v_mfma_f32_16x16x32_bf16 v[84:87], v[212:215], v[192:195], v[84:87]
    ds_read_b64_tr_b16 v[180:181], v238 offset:16384
    v_mfma_f32_16x16x32_bf16 v[88:91], v[216:219], v[192:195], v[88:91]
    ds_read_b64_tr_b16 v[182:183], v238 offset:20480
    v_mfma_f32_16x16x32_bf16 v[92:95], v[220:223], v[192:195], v[92:95]
    ds_read_b128 v[140:143], v232 offset:2048
    v_mfma_f32_16x16x32_bf16 v[96:99], v[224:227], v[192:195], v[96:99]
    ds_read_b128 v[144:147], v232 offset:4096
    v_mfma_f32_16x16x32_bf16 v[100:103], v[228:231], v[192:195], v[100:103]
    ds_read_b128 v[148:151], v232 offset:6144
    v_mfma_f32_16x16x32_bf16 v[104:107], v[200:203], v[196:199], v[104:107]
    v_mfma_f32_16x16x32_bf16 v[108:111], v[204:207], v[196:199], v[108:111]
    v_mfma_f32_16x16x32_bf16 v[112:115], v[208:211], v[196:199], v[112:115]
    v_mfma_f32_16x16x32_bf16 v[116:119], v[212:215], v[196:199], v[116:119]
    v_mfma_f32_16x16x32_bf16 v[120:123], v[216:219], v[196:199], v[120:123]
    v_mfma_f32_16x16x32_bf16 v[124:127], v[220:223], v[196:199], v[124:127]
    v_mfma_f32_16x16x32_bf16 v[128:131], v[224:227], v[196:199], v[128:131]
    s_add_u32 s52, s52, 49152
    s_cmp_ge_u32 s52, 147456
    s_cselect_b32 s52, 0, s52
    v_mfma_f32_16x16x32_bf16 v[132:135], v[228:231], v[196:199], v[132:135]
    s_waitcnt lgkmcnt(0)
    v_mfma_f32_16x16x32_bf16 v[8:11], v[152:155], v[136:139], v[8:11]
    ds_read_b128 v[184:187], v232 offset:1024
    v_mfma_f32_16x16x32_bf16 v[12:15], v[156:159], v[136:139], v[12:15]
    ds_read_b64_tr_b16 v[200:201], v235 offset:8192
    v_mfma_f32_16x16x32_bf16 v[16:19], v[160:163], v[136:139], v[16:19]
    ds_read_b64_tr_b16 v[202:203], v235 offset:12288
    v_mfma_f32_16x16x32_bf16 v[20:23], v[164:167], v[136:139], v[20:23]
    ds_read_b64_tr_b16 v[204:205], v236 offset:8192
    v_mfma_f32_16x16x32_bf16 v[24:27], v[168:171], v[136:139], v[24:27]
    v_mfma_f32_16x16x32_bf16 v[28:31], v[172:175], v[136:139], v[28:31]
    ds_read_b64_tr_b16 v[206:207], v236 offset:12288
    v_mfma_f32_16x16x32_bf16 v[32:35], v[176:179], v[136:139], v[32:35]
    ds_read_b64_tr_b16 v[208:209], v237 offset:8192
    v_mfma_f32_16x16x32_bf16 v[36:39], v[180:183], v[136:139], v[36:39]
    ds_read_b64_tr_b16 v[210:211], v237 offset:12288
    v_mfma_f32_16x16x32_bf16 v[40:43], v[152:155], v[140:143], v[40:43]
    ds_read_b64_tr_b16 v[212:213], v238 offset:8192
    v_mfma_f32_16x16x32_bf16 v[44:47], v[156:159], v[140:143], v[44:47]
    v_mfma_f32_16x16x32_bf16 v[48:51], v[160:163], v[140:143], v[48:51]
    ds_read_b64_tr_b16 v[214:215], v238 offset:12288
    v_mfma_f32_16x16x32_bf16 v[52:55], v[164:167], v[140:143], v[52:55]
    ds_read_b64_tr_b16 v[216:217], v235 offset:24576
    v_mfma_f32_16x16x32_bf16 v[56:59], v[168:171], v[140:143], v[56:59]
    ds_read_b64_tr_b16 v[218:219], v235 offset:28672
    v_mfma_f32_16x16x32_bf16 v[60:63], v[172:175], v[140:143], v[60:63]
    ds_read_b64_tr_b16 v[220:221], v236 offset:24576
    v_mfma_f32_16x16x32_bf16 v[64:67], v[176:179], v[140:143], v[64:67]
    v_mfma_f32_16x16x32_bf16 v[68:71], v[180:183], v[140:143], v[68:71]
    ds_read_b64_tr_b16 v[222:223], v236 offset:28672
    v_mfma_f32_16x16x32_bf16 v[72:75], v[152:155], v[144:147], v[72:75]
    s_movk_i32 s54, 13
M_P_loop4:
    ds_read_b64_tr_b16 v[224:225], v237 offset:24576
    v_mfma_f32_16x16x32_bf16 v[76:79], v[156:159], v[144:147], v[76:79]
    ds_read_b64_tr_b16 v[226:227], v237 offset:28672
    v_mfma_f32_16x16x32_bf16 v[80:83], v[160:163], v[144:147], v[80:83]
    ds_read_b64_tr_b16 v[228:229], v238 offset:24576
    v_mfma_f32_16x16x32_bf16 v[84:87], v[164:167], v[144:147], v[84:87]
    v_mfma_f32_16x16x32_bf16 v[88:91], v[168:171], v[144:147], v[88:91]
    ds_read_b64_tr_b16 v[230:231], v238 offset:28672
    v_mfma_f32_16x16x32_bf16 v[92:95], v[172:175], v[144:147], v[92:95]
    ds_read_b128 v[188:191], v232 offset:3072
    v_mfma_f32_16x16x32_bf16 v[96:99], v[176:179], v[144:147], v[96:99]
    ds_read_b128 v[192:195], v232 offset:5120
    v_mfma_f32_16x16x32_bf16 v[100:103], v[180:183], v[144:147], v[100:103]
    ds_read_b128 v[196:199], v232 offset:7168
    v_mfma_f32_16x16x32_bf16 v[104:107], v[152:155], v[148:151], v[104:107]
    v_mfma_f32_16x16x32_bf16 v[108:111], v[156:159], v[148:151], v[108:111]
    v_add_u32 v232, s52, v233
    v_mfma_f32_16x16x32_bf16 v[112:115], v[160:163], v[148:151], v[112:115]
    v_add_u32 v235, s52, v239
    v_mfma_f32_16x16x32_bf16 v[116:119], v[164:167], v[148:151], v[116:119]
    v_add_u32 v236, s52, v240
    v_mfma_f32_16x16x32_bf16 v[120:123], v[168:171], v[148:151], v[120:123]
    v_mfma_f32_16x16x32_bf16 v[124:127], v[172:175], v[148:151], v[124:127]
    v_add_u32 v237, s52, v241
    v_mfma_f32_16x16x32_bf16 v[128:131], v[176:179], v[148:151], v[128:131]
    v_add_u32 v238, s52, v242
    v_mfma_f32_16x16x32_bf16 v[132:135], v[180:183], v[148:151], v[132:135]
    s_waitcnt lgkmcnt(0)
    v_mfma_f32_16x16x32_bf16 v[8:11], v[200:203], v[184:187], v[8:11]
    s_barrier
    v_mfma_f32_16x16x32_bf16 v[12:15], v[204:207], v[184:187], v[12:15]
    ds_read_b128 v[136:139], v232 offset:0
    v_mfma_f32_16x16x32_bf16 v[16:19], v[208:211], v[184:187], v[16:19]
    ds_read_b64_tr_b16 v[152:153], v235 offset:0
    v_mfma_f32_16x16x32_bf16 v[20:23], v[212:215], v[184:187], v[20:23]
    ds_read_b64_tr_b16 v[154:155], v235 offset:4096
    v_mfma_f32_16x16x32_bf16 v[24:27], v[216:219], v[184:187], v[24:27]
    ds_read_b64_tr_b16 v[156:157], v236 offset:0
    v_mfma_f32_16x16x32_bf16 v[28:31], v[220:223], v[184:187], v[28:31]
    ds_read_b64_tr_b16 v[158:159], v236 offset:4096
    v_mfma_f32_16x16x32_bf16 v[32:35], v[224:227], v[184:187], v[32:35]
    v_mfma_f32_16x16x32_bf16 v[36:39], v[228:231], v[184:187], v[36:39]
    ds_read_b64_tr_b16 v[160:161], v237 offset:0
    v_mfma_f32_16x16x32_bf16 v[40:43], v[200:203], v[188:191], v[40:43]
    ds_read_b64_tr_b16 v[162:163], v237 offset:4096
    v_mfma_f32_16x16x32_bf16 v[44:47], v[204:207], v[188:191], v[44:47]
    ds_read_b64_tr_b16 v[164:165], v238 offset:0
    v_mfma_f32_16x16x32_bf16 v[48:51], v[208:211], v[188:191], v[48:51]
    ds_read_b64_tr_b16 v[166:167], v238 offset:4096
    v_mfma_f32_16x16x32_bf16 v[52:55], v[212:215], v[188:191], v[52:55]
    ds_read_b64_tr_b16 v[168:169], v235 offset:16384
    v_mfma_f32_16x16x32_bf16 v[56:59], v[216:219], v[188:191], v[56:59]
    v_mfma_f32_16x16x32_bf16 v[60:63], v[220:223], v[188:191], v[60:63]
    ds_read_b64_tr_b16 v[170:171], v235 offset:20480
    v_mfma_f32_16x16x32_bf16 v[64:67], v[224:227], v[188:191], v[64:67]
    ds_read_b64_tr_b16 v[172:173], v236 offset:16384
    v_mfma_f32_16x16x32_bf16 v[68:71], v[228:231], v[188:191], v[68:71]
    ds_read_b64_tr_b16 v[174:175], v236 offset:20480
    v_mfma_f32_16x16x32_bf16 v[72:75], v[200:203], v[192:195], v[72:75]
    ds_read_b64_tr_b16 v[176:177], v237 offset:16384
    v_mfma_f32_16x16x32_bf16 v[76:79], v[204:207], v[192:195], v[76:79]
    ds_read_b64_tr_b16 v[178:179], v237 offset:20480
    v_mfma_f32_16x16x32_bf16 v[80:83], v[208:211], v[192:195], v[80:83]
    v_mfma_f32_16x16x32_bf16 v[84:87], v[212:215], v[192:195], v[84:87]
    ds_read_b64_tr_b16 v[180:181], v238 offset:16384
    v_mfma_f32_16x16x32_bf16 v[88:91], v[216:219], v[192:195], v[88:91]
    ds_read_b64_tr_b16 v[182:183], v238 offset:20480
    v_mfma_f32_16x16x32_bf16 v[92:95], v[220:223], v[192:195], v[92:95]
    ds_read_b128 v[140:143], v232 offset:2048
    v_mfma_f32_16x16x32_bf16 v[96:99], v[224:227], v[192:195], v[96:99]
    ds_read_b128 v[144:147], v232 offset:4096
    v_mfma_f32_16x16x32_bf16 v[100:103], v[228:231], v[192:195], v[100:103]
    ds_read_b128 v[148:151], v232 offset:6144
    v_mfma_f32_16x16x32_bf16 v[104:107], v[200:203], v[196:199], v[104:107]
    v_mfma_f32_16x16x32_bf16 v[108:111], v[204:207], v[196:199], v[108:111]
    v_mfma_f32_16x16x32_bf16 v[112:115], v[208:211], v[196:199], v[112:115]
    v_mfma_f32_16x16x32_bf16 v[116:119], v[212:215], v[196:199], v[116:119]
    v_mfma_f32_16x16x32_bf16 v[120:123], v[216:219], v[196:199], v[120:123]
    v_mfma_f32_16x16x32_bf16 v[124:127], v[220:223], v[196:199], v[124:127]
    v_mfma_f32_16x16x32_bf16 v[128:131], v[224:227], v[196:199], v[128:131]
    s_add_u32 s52, s52, 49152
    s_cmp_ge_u32 s52, 147456
    s_cselect_b32 s52, 0, s52
    v_mfma_f32_16x16x32_bf16 v[132:135], v[228:231], v[196:199], v[132:135]
    s_waitcnt lgkmcnt(0)
    v_mfma_f32_16x16x32_bf16 v[8:11], v[152:155], v[136:139], v[8:11]
    ds_read_b128 v[184:187], v232 offset:1024
    v_mfma_f32_16x16x32_bf16 v[12:15], v[156:159], v[136:139], v[12:15]
    ds_read_b64_tr_b16 v[200:201], v235 offset:8192
    v_mfma_f32_16x16x32_bf16 v[16:19], v[160:163], v[136:139], v[16:19]
    ds_read_b64_tr_b16 v[202:203], v235 offset:12288
    v_mfma_f32_16x16x32_bf16 v[20:23], v[164:167], v[136:139], v[20:23]
    ds_read_b64_tr_b16 v[204:205], v236 offset:8192
    v_mfma_f32_16x16x32_bf16 v[24:27], v[168:171], v[136:139], v[24:27]
    v_mfma_f32_16x16x32_bf16 v[28:31], v[172:175], v[136:139], v[28:31]
    ds_read_b64_tr_b16 v[206:207], v236 offset:12288
    v_mfma_f32_16x16x32_bf16 v[32:35], v[176:179], v[136:139], v[32:35]
    ds_read_b64_tr_b16 v[208:209], v237 offset:8192
    v_mfma_f32_16x16x32_bf16 v[36:39], v[180:183], v[136:139], v[36:39]
    ds_read_b64_tr_b16 v[210:211], v237 offset:12288
    v_mfma_f32_16x16x32_bf16 v[40:43], v[152:155], v[140:143], v[40:43]
    ds_read_b64_tr_b16 v[212:213], v238 offset:8192
    v_mfma_f32_16x16x32_bf16 v[44:47], v[156:159], v[140:143], v[44:47]
    v_mfma_f32_16x16x32_bf16 v[48:51], v[160:163], v[140:143], v[48:51]
    ds_read_b64_tr_b16 v[214:215], v238 offset:12288
    v_mfma_f32_16x16x32_bf16 v[52:55], v[164:167], v[140:143], v[52:55]
    ds_read_b64_tr_b16 v[216:217], v235 offset:24576
    v_mfma_f32_16x16x32_bf16 v[56:59], v[168:171], v[140:143], v[56:59]
    ds_read_b64_tr_b16 v[218:219], v235 offset:28672
    v_mfma_f32_16x16x32_bf16 v[60:63], v[172:175], v[140:143], v[60:63]
    ds_read_b64_tr_b16 v[220:221], v236 offset:24576
    v_mfma_f32_16x16x32_bf16 v[64:67], v[176:179], v[140:143], v[64:67]
    v_mfma_f32_16x16x32_bf16 v[68:71], v[180:183], v[140:143], v[68:71]
    s_sub_u32 s54, s54, 1
    ds_read_b64_tr_b16 v[222:223], v236 offset:28672
    v_mfma_f32_16x16x32_bf16 v[72:75], v[152:155], v[144:147], v[72:75]
    s_cbranch_scc0 M_P_loop4
    ds_read_b64_tr_b16 v[224:225], v237 offset:24576
    v_mfma_f32_16x16x32_bf16 v[76:79], v[156:159], v[144:147], v[76:79]
    ds_read_b64_tr_b16 v[226:227], v237 offset:28672
    v_mfma_f32_16x16x32_bf16 v[80:83], v[160:163], v[144:147], v[80:83]
    ds_read_b64_tr_b16 v[228:229], v238 offset:24576
    v_mfma_f32_16x16x32_bf16 v[84:87], v[164:167], v[144:147], v[84:87]
    v_mfma_f32_16x16x32_bf16 v[88:91], v[168:171], v[144:147], v[88:91]
    ds_read_b64_tr_b16 v[230:231], v238 offset:28672
    v_mfma_f32_16x16x32_bf16 v[92:95], v[172:175], v[144:147], v[92:95]
    ds_read_b128 v[188:191], v232 offset:3072
    v_mfma_f32_16x16x32_bf16 v[96:99], v[176:179], v[144:147], v[96:99]
    ds_read_b128 v[192:195], v232 offset:5120
    v_mfma_f32_16x16x32_bf16 v[100:103], v[180:183], v[144:147], v[100:103]
    ds_read_b128 v[196:199], v232 offset:7168
    v_mfma_f32_16x16x32_bf16 v[104:107], v[152:155], v[148:151], v[104:107]
    v_mfma_f32_16x16x32_bf16 v[108:111], v[156:159], v[148:151], v[108:111]
    v_mfma_f32_16x16x32_bf16 v[112:115], v[160:163], v[148:151], v[112:115]
    v_mfma_f32_16x16x32_bf16 v[116:119], v[164:167], v[148:151], v[116:119]
    v_mfma_f32_16x16x32_bf16 v[120:123], v[168:171], v[148:151], v[120:123]
    v_mfma_f32_16x16x32_bf16 v[124:127], v[172:175], v[148:151], v[124:127]
    v_mfma_f32_16x16x32_bf16 v[128:131], v[176:179], v[148:151], v[128:131]
    v_mfma_f32_16x16x32_bf16 v[132:135], v[180:183], v[148:151], v[132:135]
    s_waitcnt lgkmcnt(0)
    v_mfma_f32_16x16x32_bf16 v[8:11], v[200:203], v[184:187], v[8:11]
    s_barrier
    v_mfma_f32_16x16x32_bf16 v[12:15], v[204:207], v[184:187], v[12:15]
    v_mfma_f32_16x16x32_bf16 v[16:19], v[208:211], v[184:187], v[16:19]
    v_mfma_f32_16x16x32_bf16 v[20:23], v[212:215], v[184:187], v[20:23]
    v_mfma_f32_16x16x32_bf16 v[24:27], v[216:219], v[184:187], v[24:27]
    v_mfma_f32_16x16x32_bf16 v[28:31], v[220:223], v[184:187], v[28:31]
    v_mfma_f32_16x16x32_bf16 v[32:35], v[224:227], v[184:187], v[32:35]
    v_mfma_f32_16x16x32_bf16 v[36:39], v[228:231], v[184:187], v[36:39]
    v_mfma_f32_16x16x32_bf16 v[40:43], v[200:203], v[188:191], v[40:43]
    v_mfma_f32_16x16x32_bf16 v[44:47], v[204:207], v[188:191], v[44:47]
    v_mfma_f32_16x16x32_bf16 v[48:51], v[208:211], v[188:191], v[48:51]
    v_mfma_f32_16x16x32_bf16 v[52:55], v[212:215], v[188:191], v[52:55]
    v_mfma_f32_16x16x32_bf16 v[56:59], v[216:219], v[188:191], v[56:59]
    v_mfma_f32_16x16x32_bf16 v[60:63], v[220:223], v[188:191], v[60:63]
    v_mfma_f32_16x16x32_bf16 v[64:67], v[224:227], v[188:191], v[64:67]
    v_mfma_f32_16x16x32_bf16 v[68:71], v[228:231], v[188:191], v[68:71]
    v_mfma_f32_16x16x32_bf16 v[72:75], v[200:203], v[192:195], v[72:75]
    v_mfma_f32_16x16x32_bf16 v[76:79], v[204:207], v[192:195], v[76:79]
    v_mfma_f32_16x16x32_bf16 v[80:83], v[208:211], v[192:195], v[80:83]
    v_mfma_f32_16x16x32_bf16 v[84:87], v[212:215], v[192:195], v[84:87]
    v_mfma_f32_16x16x32_bf16 v[88:91], v[216:219], v[192:195], v[88:91]
    v_mfma_f32_16x16x32_bf16 v[92:95], v[220:223], v[192:195], v[92:95]
    v_mfma_f32_16x16x32_bf16 v[96:99], v[224:227], v[192:195], v[96:99]
    v_mfma_f32_16x16x32_bf16 v[100:103], v[228:231], v[192:195], v[100:103]
    v_mfma_f32_16x16x32_bf16 v[104:107], v[200:203], v[196:199], v[104:107]
    v_mfma_f32_16x16x32_bf16 v[108:111], v[204:207], v[196:199], v[108:111]
    v_mfma_f32_16x16x32_bf16 v[112:115], v[208:211], v[196:199], v[112:115]
    v_mfma_f32_16x16x32_bf16 v[116:119], v[212:215], v[196:199], v[116:119]
    v_mfma_f32_16x16x32_bf16 v[120:123], v[216:219], v[196:199], v[120:123]
    v_mfma_f32_16x16x32_bf16 v[124:127], v[220:223], v[196:199], v[124:127]
    v_mfma_f32_16x16x32_bf16 v[128:131], v[224:227], v[196:199], v[128:131]
    v_mfma_f32_16x16x32_bf16 v[132:135], v[228:231], v[196:199], v[132:135]
    s_setprio 0
    s_cmp_lg_u32 s69, 0
    s_cbranch_scc1 M_Pidle
    s_lshl_b32 s64, s47, 3
    s_lshl_b32 s65, s44, 1
    s_add_u32 s64, s64, s65
    s_mul_i32 s64, s64, 32768
    s_add_u32 s64, s64, 0x1000000
    v_lshl_add_u32 v184, v1, 4, s64
    v_add_u32 v185, 30720, v184
    s_lshr_b32 s65, s48, 2
    s_sub_u32 s65, s48, s65
    s_add_u32 s65, s65, 16
    s_lshl_b32 s65, s65, 8
    s_or_b32 s65, s65, s69
    v_lshrrev_b32 v3, 4, v1
    s_lshl_b32 s64, s44, 4
    v_add_u32 v2, s64, v3
    s_movk_i32 s64, 7168
    v_mul_u32_u24 v2, s64, v2
    v_add_u32 v2, s65, v2
    v_lshlrev_b32 v3, 1, v3
    v_and_b32 v4, 15, v1
    v_xor_b32 v3, v3, v4
    v_lshl_add_u32 v188, v3, 4, v2
    v_add_u32 v190, 55296, v188
    v_xor_b32 v3, 8, v3
    v_lshl_add_u32 v189, v3, 4, v2
    v_add_u32 v189, 27648, v189
    v_add_u32 v191, 55296, v189
    s_lshl_b32 s60, s44, 12
    s_add_u32 s61, s60, 147456
    s_add_u32 s53, s60, 49152
    s_bfe_u32 s66, s2, 0x30003
    s_lshr_b32 s55, s2, 6
    s_add_u32 s66, s66, s55
    s_mul_i32 s55, s66, 11
    s_lshr_b32 s55, s55, 5
    s_mul_i32 s55, s55, 3
    s_sub_u32 s66, s66, s55
    s_mov_b32 s58, 0x9a867534
    s_mov_b32 s59, 0xfecdb
    s_cmp_eq_u32 s66, 1
    s_cselect_b32 s58, 0xb9786453, s58
    s_cselect_b32 s59, 0xfdeca, s59
    s_cmp_eq_u32 s66, 2
    s_cselect_b32 s58, 0xa8975642, s58
    s_cselect_b32 s59, 0xefdbc, s59
    s_mov_b32 s32, s12
    s_mov_b32 s33, s13
    s_mov_b32 s34, 0x700000
    s_mov_b32 s35, 0x20000
    s_mov_b32 s36, s14
    s_mov_b32 s37, s15
    s_mov_b32 s38, 0x700000
    s_mov_b32 s39, 0x20000
    s_lshl_b32 s70, s48, 12
    s_lshl_b32 s64, s47, 3
    s_lshl_b32 s65, s45, 2
    s_add_u32 s64, s64, s65
    s_mul_i32 s64, s64, 114688
    s_add_u32 s64, s64, s70
    s_lshl_b32 s65, s46, 11
    s_add_u32 s64, s64, s65
    s_add_u32 s64, s64, 0x1500000
    v_lshl_add_u32 v198, v1, 4, s64
    v_mul_f32 v24, v8, v24
    v_exp_f32 v216, -v8
    v_mul_f32 v25, v9, v25
    v_exp_f32 v217, -v9
    v_mul_f32 v26, v10, v26
    v_exp_f32 v218, -v10
    v_mul_f32 v27, v11, v27
    v_exp_f32 v219, -v11
    v_mul_f32 v28, v12, v28
    v_exp_f32 v220, -v12
    v_mul_f32 v29, v13, v29
    v_exp_f32 v221, -v13
    v_mul_f32 v30, v14, v30
    v_exp_f32 v222, -v14
    v_mul_f32 v31, v15, v31
    v_exp_f32 v223, -v15
    s_barrier
    s_and_b32 s57, s58, 15
    s_lshr_b64 s[58:59], s[58:59], 4
    s_lshl_b32 s56, s57, 11
    s_mul_i32 s57, s57, 0x70000
    s_add_u32 m0, s53, 16384
    s_nop 0
    buffer_load_dwordx4 v188, s[32:35], s57 offen offset:0 lds
    v_fma_f32 v216, v216, s67, s67
    v_fma_f32 v217, v217, s67, s67
    v_rcp_f32 v216, v216
    v_fma_f32 v218, v218, s67, s67
    buffer_load_dwordx4 v189, s[32:35], s57 offen offset:1024 lds
    v_rcp_f32 v217, v217
    v_fma_f32 v219, v219, s67, s67
    v_rcp_f32 v218, v218
    v_fma_f32 v220, v220, s67, s67
    buffer_load_dwordx4 v190, s[32:35], s57 offen offset:2048 lds
    v_rcp_f32 v219, v219
    v_fma_f32 v221, v221, s67, s67
    v_rcp_f32 v220, v220
    v_fma_f32 v222, v222, s67, s67
    buffer_load_dwordx4 v191, s[32:35], s57 offen offset:3072 lds
    v_rcp_f32 v221, v221
    v_fma_f32 v223, v223, s67, s67
    v_rcp_f32 v222, v222
    v_rcp_f32 v223, v223
    s_add_u32 m0, s53, 32768
    s_nop 0
    buffer_load_dwordx4 v188, s[36:39], s57 offen offset:0 lds
    v_mul_f32 v24, v24, v216
    v_mul_f32 v25, v25, v217
    v_mul_f32 v26, v26, v218
    v_mul_f32 v27, v27, v219
    buffer_load_dwordx4 v189, s[36:39], s57 offen offset:1024 lds
    v_mul_f32 v28, v28, v220
    v_mul_f32 v29, v29, v221
    v_mul_f32 v30, v30, v222
    v_mul_f32 v31, v31, v223
    buffer_load_dwordx4 v190, s[36:39], s57 offen offset:2048 lds
    v_cvt_pk_bf16_f32 v200, v24, v25
    v_cvt_pk_bf16_f32 v201, v26, v27
    v_cvt_pk_bf16_f32 v202, v28, v29
    v_cvt_pk_bf16_f32 v203, v30, v31
    buffer_load_dwordx4 v191, s[36:39], s57 offen offset:3072 lds
    v_mul_f32 v32, v16, v32
    v_exp_f32 v224, -v16
    v_mul_f32 v33, v17, v33
    s_mov_b32 m0, s53
    s_nop 0
    buffer_load_dwordx4 v184, s[28:31], s56 offen offset:0 lds
    v_exp_f32 v225, -v17
    v_mul_f32 v34, v18, v34
    v_exp_f32 v226, -v18
    v_mul_f32 v35, v19, v35
    buffer_load_dwordx4 v184, s[28:31], s56 offen offset:1024 lds
    v_exp_f32 v227, -v19
    v_mul_f32 v36, v20, v36
    v_exp_f32 v228, -v20
    v_mul_f32 v37, v21, v37
    buffer_load_dwordx4 v185, s[28:31], s56 offen offset:2048 lds
    v_exp_f32 v229, -v21
    v_mul_f32 v38, v22, v38
    v_exp_f32 v230, -v22
    v_mul_f32 v39, v23, v39
    buffer_load_dwordx4 v185, s[28:31], s56 offen offset:3072 lds
    v_exp_f32 v231, -v23
    v_fma_f32 v224, v224, s67, s67
    v_fma_f32 v225, v225, s67, s67
    v_rcp_f32 v224, v224
    s_add_u32 s53, s53, 49152
    s_cmp_ge_u32 s53, s61
    s_cselect_b32 s53, s60, s53
    buffer_store_dwordx4 v[200:203], v198, s[28:31], 0 offen offset:0 sc1
    s_barrier
    s_and_b32 s57, s58, 15
    s_lshr_b64 s[58:59], s[58:59], 4
    s_lshl_b32 s56, s57, 11
    s_mul_i32 s57, s57, 0x70000
    s_add_u32 m0, s53, 16384
    s_nop 0
    buffer_load_dwordx4 v188, s[32:35], s57 offen offset:0 lds
    v_fma_f32 v226, v226, s67, s67
    v_rcp_f32 v225, v225
    v_fma_f32 v227, v227, s67, s67
    v_rcp_f32 v226, v226
    buffer_load_dwordx4 v189, s[32:35], s57 offen offset:1024 lds
    v_fma_f32 v228, v228, s67, s67
    v_rcp_f32 v227, v227
    v_fma_f32 v229, v229, s67, s67
    v_rcp_f32 v228, v228
    buffer_load_dwordx4 v190, s[32:35], s57 offen offset:2048 lds
    v_fma_f32 v230, v230, s67, s67
    v_rcp_f32 v229, v229
    v_fma_f32 v231, v231, s67, s67
    v_rcp_f32 v230, v230
    buffer_load_dwordx4 v191, s[32:35], s57 offen offset:3072 lds
    v_rcp_f32 v231, v231
    v_mul_f32 v32, v32, v224
    v_mul_f32 v33, v33, v225
    v_mul_f32 v34, v34, v226
    s_add_u32 m0, s53, 32768
    s_nop 0
    buffer_load_dwordx4 v188, s[36:39], s57 offen offset:0 lds
    v_mul_f32 v35, v35, v227
    v_mul_f32 v36, v36, v228
    v_mul_f32 v37, v37, v229
    v_mul_f32 v38, v38, v230
    buffer_load_dwordx4 v189, s[36:39], s57 offen offset:1024 lds
    v_mul_f32 v39, v39, v231
    v_cvt_pk_bf16_f32 v204, v32, v33
    v_cvt_pk_bf16_f32 v205, v34, v35
    v_cvt_pk_bf16_f32 v206, v36, v37
    buffer_load_dwordx4 v190, s[36:39], s57 offen offset:2048 lds
    v_cvt_pk_bf16_f32 v207, v38, v39
    v_mul_f32 v56, v40, v56
    buffer_load_dwordx4 v191, s[36:39], s57 offen offset:3072 lds
    v_exp_f32 v216, -v40
    v_mul_f32 v57, v41, v57
    v_exp_f32 v217, -v41
    v_mul_f32 v58, v42, v58
    s_mov_b32 m0, s53
    s_nop 0
    buffer_load_dwordx4 v184, s[28:31], s56 offen offset:0 lds
    v_exp_f32 v218, -v42
    v_mul_f32 v59, v43, v59
    v_exp_f32 v219, -v43
    v_mul_f32 v60, v44, v60
    buffer_load_dwordx4 v184, s[28:31], s56 offen offset:1024 lds
    v_exp_f32 v220, -v44
    v_mul_f32 v61, v45, v61
    v_exp_f32 v221, -v45
    v_mul_f32 v62, v46, v62
    buffer_load_dwordx4 v185, s[28:31], s56 offen offset:2048 lds
    v_exp_f32 v222, -v46
    v_mul_f32 v63, v47, v63
    v_exp_f32 v223, -v47
    v_fma_f32 v216, v216, s67, s67
    buffer_load_dwordx4 v185, s[28:31], s56 offen offset:3072 lds
    v_fma_f32 v217, v217, s67, s67
    v_rcp_f32 v216, v216
    v_fma_f32 v218, v218, s67, s67
    v_rcp_f32 v217, v217
    s_add_u32 s53, s53, 49152
    s_cmp_ge_u32 s53, s61
    s_cselect_b32 s53, s60, s53
    buffer_store_dwordx4 v[204:207], v198, s[28:31], 0 offen offset:1024 sc1
    v_add_u32 v198, 114688, v198
    s_waitcnt vmcnt(14)
    s_barrier
    s_and_b32 s57, s58, 15
    s_lshr_b64 s[58:59], s[58:59], 4
    s_lshl_b32 s56, s57, 11
    s_mul_i32 s57, s57, 0x70000
    s_add_u32 m0, s53, 16384
    s_nop 0
    buffer_load_dwordx4 v188, s[32:35], s57 offen offset:0 lds
    v_fma_f32 v219, v219, s67, s67
    v_rcp_f32 v218, v218
    v_fma_f32 v220, v220, s67, s67
    v_rcp_f32 v219, v219
    buffer_load_dwordx4 v189, s[32:35], s57 offen offset:1024 lds
    v_fma_f32 v221, v221, s67, s67
    v_rcp_f32 v220, v220
    v_fma_f32 v222, v222, s67, s67
    v_rcp_f32 v221, v221
    buffer_load_dwordx4 v190, s[32:35], s57 offen offset:2048 lds
    v_fma_f32 v223, v223, s67, s67
    v_rcp_f32 v222, v222
    v_rcp_f32 v223, v223
    v_mul_f32 v56, v56, v216
    buffer_load_dwordx4 v191, s[32:35], s57 offen offset:3072 lds
    v_mul_f32 v57, v57, v217
    v_mul_f32 v58, v58, v218
    v_mul_f32 v59, v59, v219
    v_mul_f32 v60, v60, v220
    s_add_u32 m0, s53, 32768
    s_nop 0
    buffer_load_dwordx4 v188, s[36:39], s57 offen offset:0 lds
    v_mul_f32 v61, v61, v221
    v_mul_f32 v62, v62, v222
    v_mul_f32 v63, v63, v223
    v_cvt_pk_bf16_f32 v208, v56, v57
    buffer_load_dwordx4 v189, s[36:39], s57 offen offset:1024 lds
    v_cvt_pk_bf16_f32 v209, v58, v59
    v_cvt_pk_bf16_f32 v210, v60, v61
    v_cvt_pk_bf16_f32 v211, v62, v63
    buffer_load_dwordx4 v190, s[36:39], s57 offen offset:2048 lds
    v_mul_f32 v64, v48, v64
    v_exp_f32 v224, -v48
    v_mul_f32 v65, v49, v65
    v_exp_f32 v225, -v49
    buffer_load_dwordx4 v191, s[36:39], s57 offen offset:3072 lds
    v_mul_f32 v66, v50, v66
    v_exp_f32 v226, -v50
    v_mul_f32 v67, v51, v67
    v_exp_f32 v227, -v51
    s_mov_b32 m0, s53
    s_nop 0
    buffer_load_dwordx4 v184, s[28:31], s56 offen offset:0 lds
    v_mul_f32 v68, v52, v68
    v_exp_f32 v228, -v52
    v_mul_f32 v69, v53, v69
    v_exp_f32 v229, -v53
    buffer_load_dwordx4 v184, s[28:31], s56 offen offset:1024 lds
    v_mul_f32 v70, v54, v70
    v_exp_f32 v230, -v54
    v_mul_f32 v71, v55, v71
    v_exp_f32 v231, -v55
    buffer_load_dwordx4 v185, s[28:31], s56 offen offset:2048 lds
    v_fma_f32 v224, v224, s67, s67
    v_fma_f32 v225, v225, s67, s67
    v_rcp_f32 v224, v224
    v_fma_f32 v226, v226, s67, s67
    buffer_load_dwordx4 v185, s[28:31], s56 offen offset:3072 lds
    v_rcp_f32 v225, v225
    v_fma_f32 v227, v227, s67, s67
    v_rcp_f32 v226, v226
    v_fma_f32 v228, v228, s67, s67
    s_add_u32 s53, s53, 49152
    s_cmp_ge_u32 s53, s61
    s_cselect_b32 s53, s60, s53
    buffer_store_dwordx4 v[208:211], v198, s[28:31], 0 offen offset:0 sc1
    s_waitcnt vmcnt(14)
    s_barrier
    s_and_b32 s57, s58, 15
    s_lshr_b64 s[58:59], s[58:59], 4
    s_lshl_b32 s56, s57, 11
    s_mul_i32 s57, s57, 0x70000
    s_add_u32 m0, s53, 16384
    s_nop 0
    buffer_load_dwordx4 v188, s[32:35], s57 offen offset:0 lds
    v_rcp_f32 v227, v227
    v_fma_f32 v229, v229, s67, s67
    v_rcp_f32 v228, v228
    v_fma_f32 v230, v230, s67, s67
    buffer_load_dwordx4 v189, s[32:35], s57 offen offset:1024 lds
    v_rcp_f32 v229, v229
    v_fma_f32 v231, v231, s67, s67
    v_rcp_f32 v230, v230
    v_rcp_f32 v231, v231
    buffer_load_dwordx4 v190, s[32:35], s57 offen offset:2048 lds
    v_mul_f32 v64, v64, v224
    v_mul_f32 v65, v65, v225
    v_mul_f32 v66, v66, v226
    v_mul_f32 v67, v67, v227
    buffer_load_dwordx4 v191, s[32:35], s57 offen offset:3072 lds
    v_mul_f32 v68, v68, v228
    v_mul_f32 v69, v69, v229
    v_mul_f32 v70, v70, v230
    v_mul_f32 v71, v71, v231
    s_add_u32 m0, s53, 32768
    s_nop 0
    buffer_load_dwordx4 v188, s[36:39], s57 offen offset:0 lds
    v_cvt_pk_bf16_f32 v212, v64, v65
    v_cvt_pk_bf16_f32 v213, v66, v67
    v_cvt_pk_bf16_f32 v214, v68, v69
    v_cvt_pk_bf16_f32 v215, v70, v71
    buffer_load_dwordx4 v189, s[36:39], s57 offen offset:1024 lds
    v_mul_f32 v88, v72, v88
    v_exp_f32 v216, -v72
    buffer_load_dwordx4 v190, s[36:39], s57 offen offset:2048 lds
    v_mul_f32 v89, v73, v89
    v_exp_f32 v217, -v73
    v_mul_f32 v90, v74, v90
    v_exp_f32 v218, -v74
    buffer_load_dwordx4 v191, s[36:39], s57 offen offset:3072 lds
    v_mul_f32 v91, v75, v91
    v_exp_f32 v219, -v75
    v_mul_f32 v92, v76, v92
    v_exp_f32 v220, -v76
    s_mov_b32 m0, s53
    s_nop 0
    buffer_load_dwordx4 v184, s[28:31], s56 offen offset:0 lds
    v_mul_f32 v93, v77, v93
    v_exp_f32 v221, -v77
    v_mul_f32 v94, v78, v94
    v_exp_f32 v222, -v78
    buffer_load_dwordx4 v184, s[28:31], s56 offen offset:1024 lds
    v_mul_f32 v95, v79, v95
    v_exp_f32 v223, -v79
    v_fma_f32 v216, v216, s67, s67
    v_fma_f32 v217, v217, s67, s67
    buffer_load_dwordx4 v185, s[28:31], s56 offen offset:2048 lds
    v_rcp_f32 v216, v216
    v_fma_f32 v218, v218, s67, s67
    v_rcp_f32 v217, v217
    v_fma_f32 v219, v219, s67, s67
    buffer_load_dwordx4 v185, s[28:31], s56 offen offset:3072 lds
    v_rcp_f32 v218, v218
    v_fma_f32 v220, v220, s67, s67
    v_rcp_f32 v219, v219
    v_fma_f32 v221, v221, s67, s67
    s_add_u32 s53, s53, 49152
    s_cmp_ge_u32 s53, s61
    s_cselect_b32 s53, s60, s53
    buffer_store_dwordx4 v[212:215], v198, s[28:31], 0 offen offset:1024 sc1
    v_add_u32 v198, 114688, v198
    s_waitcnt vmcnt(14)
    s_barrier
    s_and_b32 s57, s58, 15
    s_lshr_b64 s[58:59], s[58:59], 4
    s_lshl_b32 s56, s57, 11
    s_mul_i32 s57, s57, 0x70000
    s_add_u32 m0, s53, 16384
    s_nop 0
    buffer_load_dwordx4 v188, s[32:35], s57 offen offset:0 lds
    v_rcp_f32 v220, v220
    v_fma_f32 v222, v222, s67, s67
    v_rcp_f32 v221, v221
    v_fma_f32 v223, v223, s67, s67
    buffer_load_dwordx4 v189, s[32:35], s57 offen offset:1024 lds
    v_rcp_f32 v222, v222
    v_rcp_f32 v223, v223
    v_mul_f32 v88, v88, v216
    v_mul_f32 v89, v89, v217
    buffer_load_dwordx4 v190, s[32:35], s57 offen offset:2048 lds
    v_mul_f32 v90, v90, v218
    v_mul_f32 v91, v91, v219
    v_mul_f32 v92, v92, v220
    v_mul_f32 v93, v93, v221
    buffer_load_dwordx4 v191, s[32:35], s57 offen offset:3072 lds
    v_mul_f32 v94, v94, v222
    v_mul_f32 v95, v95, v223
    v_cvt_pk_bf16_f32 v200, v88, v89
    v_cvt_pk_bf16_f32 v201, v90, v91
    s_add_u32 m0, s53, 32768
    s_nop 0
    buffer_load_dwordx4 v188, s[36:39], s57 offen offset:0 lds
    v_cvt_pk_bf16_f32 v202, v92, v93
    v_cvt_pk_bf16_f32 v203, v94, v95
    v_mul_f32 v96, v80, v96
    buffer_load_dwordx4 v189, s[36:39], s57 offen offset:1024 lds
    v_exp_f32 v224, -v80
    v_mul_f32 v97, v81, v97
    v_exp_f32 v225, -v81
    v_mul_f32 v98, v82, v98
    buffer_load_dwordx4 v190, s[36:39], s57 offen offset:2048 lds
    v_exp_f32 v226, -v82
    v_mul_f32 v99, v83, v99
    v_exp_f32 v227, -v83
    v_mul_f32 v100, v84, v100
    buffer_load_dwordx4 v191, s[36:39], s57 offen offset:3072 lds
    v_exp_f32 v228, -v84
    v_mul_f32 v101, v85, v101
    v_exp_f32 v229, -v85
    v_mul_f32 v102, v86, v102
    s_mov_b32 m0, s53
    s_nop 0
    buffer_load_dwordx4 v184, s[28:31], s56 offen offset:0 lds
    v_exp_f32 v230, -v86
    v_mul_f32 v103, v87, v103
    v_exp_f32 v231, -v87
    v_fma_f32 v224, v224, s67, s67
    buffer_load_dwordx4 v184, s[28:31], s56 offen offset:1024 lds
    v_fma_f32 v225, v225, s67, s67
    v_rcp_f32 v224, v224
    v_fma_f32 v226, v226, s67, s67
    v_rcp_f32 v225, v225
    buffer_load_dwordx4 v185, s[28:31], s56 offen offset:2048 lds
    v_fma_f32 v227, v227, s67, s67
    v_rcp_f32 v226, v226
    v_fma_f32 v228, v228, s67, s67
    v_rcp_f32 v227, v227
    buffer_load_dwordx4 v185, s[28:31], s56 offen offset:3072 lds
    v_fma_f32 v229, v229, s67, s67
    v_rcp_f32 v228, v228
    v_fma_f32 v230, v230, s67, s67
    v_rcp_f32 v229, v229
    s_add_u32 s53, s53, 49152
    s_cmp_ge_u32 s53, s61
    s_cselect_b32 s53, s60, s53
    buffer_store_dwordx4 v[200:203], v198, s[28:31], 0 offen offset:0 sc1
    s_waitcnt vmcnt(14)
    s_barrier
    s_and_b32 s57, s58, 15
    s_lshr_b64 s[58:59], s[58:59], 4
    s_lshl_b32 s56, s57, 11
    s_mul_i32 s57, s57, 0x70000
    s_add_u32 m0, s53, 16384
    s_nop 0
    buffer_load_dwordx4 v188, s[32:35], s57 offen offset:0 lds
    v_fma_f32 v231, v231, s67, s67
    v_rcp_f32 v230, v230
    v_rcp_f32 v231, v231
    v_mul_f32 v96, v96, v224
    buffer_load_dwordx4 v189, s[32:35], s57 offen offset:1024 lds
    v_mul_f32 v97, v97, v225
    v_mul_f32 v98, v98, v226
    v_mul_f32 v99, v99, v227
    v_mul_f32 v100, v100, v228
    buffer_load_dwordx4 v190, s[32:35], s57 offen offset:2048 lds
    v_mul_f32 v101, v101, v229
    v_mul_f32 v102, v102, v230
    v_mul_f32 v103, v103, v231
    v_cvt_pk_bf16_f32 v204, v96, v97
    buffer_load_dwordx4 v191, s[32:35], s57 offen offset:3072 lds
    v_cvt_pk_bf16_f32 v205, v98, v99
    v_cvt_pk_bf16_f32 v206, v100, v101
    v_cvt_pk_bf16_f32 v207, v102, v103
    s_add_u32 m0, s53, 32768
    s_nop 0
    buffer_load_dwordx4 v188, s[36:39], s57 offen offset:0 lds
    v_mul_f32 v120, v104, v120
    v_exp_f32 v216, -v104
    v_mul_f32 v121, v105, v121
    buffer_load_dwordx4 v189, s[36:39], s57 offen offset:1024 lds
    v_exp_f32 v217, -v105
    v_mul_f32 v122, v106, v122
    v_exp_f32 v218, -v106
    v_mul_f32 v123, v107, v123
    buffer_load_dwordx4 v190, s[36:39], s57 offen offset:2048 lds
    v_exp_f32 v219, -v107
    v_mul_f32 v124, v108, v124
    v_exp_f32 v220, -v108
    v_mul_f32 v125, v109, v125
    buffer_load_dwordx4 v191, s[36:39], s57 offen offset:3072 lds
    v_exp_f32 v221, -v109
    v_mul_f32 v126, v110, v126
    v_exp_f32 v222, -v110
    v_mul_f32 v127, v111, v127
    s_mov_b32 m0, s53
    s_nop 0
    buffer_load_dwordx4 v184, s[28:31], s56 offen offset:0 lds
    v_exp_f32 v223, -v111
    v_fma_f32 v216, v216, s67, s67
    v_fma_f32 v217, v217, s67, s67
    v_rcp_f32 v216, v216
    buffer_load_dwordx4 v184, s[28:31], s56 offen offset:1024 lds
    v_fma_f32 v218, v218, s67, s67
    v_rcp_f32 v217, v217
    v_fma_f32 v219, v219, s67, s67
    v_rcp_f32 v218, v218
    buffer_load_dwordx4 v185, s[28:31], s56 offen offset:2048 lds
    v_fma_f32 v220, v220, s67, s67
    v_rcp_f32 v219, v219
    v_fma_f32 v221, v221, s67, s67
    v_rcp_f32 v220, v220
    buffer_load_dwordx4 v185, s[28:31], s56 offen offset:3072 lds
    v_fma_f32 v222, v222, s67, s67
    v_rcp_f32 v221, v221
    v_fma_f32 v223, v223, s67, s67
    v_rcp_f32 v222, v222
    s_add_u32 s53, s53, 49152
    s_cmp_ge_u32 s53, s61
    s_cselect_b32 s53, s60, s53
    buffer_store_dwordx4 v[204:207], v198, s[28:31], 0 offen offset:1024 sc1
    v_add_u32 v198, 114688, v198
    s_waitcnt vmcnt(14)
    s_barrier
    s_and_b32 s57, s58, 15
    s_lshr_b64 s[58:59], s[58:59], 4
    s_lshl_b32 s56, s57, 11
    s_mul_i32 s57, s57, 0x70000
    s_add_u32 m0, s53, 16384
    s_nop 0
    buffer_load_dwordx4 v188, s[32:35], s57 offen offset:0 lds
    v_rcp_f32 v223, v223
    v_mul_f32 v120, v120, v216
    v_mul_f32 v121, v121, v217
    v_mul_f32 v122, v122, v218
    buffer_load_dwordx4 v189, s[32:35], s57 offen offset:1024 lds
    v_mul_f32 v123, v123, v219
    v_mul_f32 v124, v124, v220
    v_mul_f32 v125, v125, v221
    v_mul_f32 v126, v126, v222
    buffer_load_dwordx4 v190, s[32:35], s57 offen offset:2048 lds
    v_mul_f32 v127, v127, v223
    v_cvt_pk_bf16_f32 v208, v120, v121
    v_cvt_pk_bf16_f32 v209, v122, v123
    v_cvt_pk_bf16_f32 v210, v124, v125
    buffer_load_dwordx4 v191, s[32:35], s57 offen offset:3072 lds
    v_cvt_pk_bf16_f32 v211, v126, v127
    v_mul_f32 v128, v112, v128
    v_exp_f32 v224, -v112
    s_add_u32 m0, s53, 32768
    s_nop 0
    buffer_load_dwordx4 v188, s[36:39], s57 offen offset:0 lds
    v_mul_f32 v129, v113, v129
    v_exp_f32 v225, -v113
    v_mul_f32 v130, v114, v130
    v_exp_f32 v226, -v114
    buffer_load_dwordx4 v189, s[36:39], s57 offen offset:1024 lds
    v_mul_f32 v131, v115, v131
    v_exp_f32 v227, -v115
    v_mul_f32 v132, v116, v132
    v_exp_f32 v228, -v116
    buffer_load_dwordx4 v190, s[36:39], s57 offen offset:2048 lds
    v_mul_f32 v133, v117, v133
    v_exp_f32 v229, -v117
    v_mul_f32 v134, v118, v134
    v_exp_f32 v230, -v118
    buffer_load_dwordx4 v191, s[36:39], s57 offen offset:3072 lds
    v_mul_f32 v135, v119, v135
    v_exp_f32 v231, -v119
    v_fma_f32 v224, v224, s67, s67
    v_fma_f32 v225, v225, s67, s67
    s_mov_b32 m0, s53
    s_nop 0
    buffer_load_dwordx4 v184, s[28:31], s56 offen offset:0 lds
    v_rcp_f32 v224, v224
    v_fma_f32 v226, v226, s67, s67
    v_rcp_f32 v225, v225
    v_fma_f32 v227, v227, s67, s67
    buffer_load_dwordx4 v184, s[28:31], s56 offen offset:1024 lds
    v_rcp_f32 v226, v226
    v_fma_f32 v228, v228, s67, s67
    v_rcp_f32 v227, v227
    v_fma_f32 v229, v229, s67, s67
    buffer_load_dwordx4 v185, s[28:31], s56 offen offset:2048 lds
    v_rcp_f32 v228, v228
    v_fma_f32 v230, v230, s67, s67
    v_rcp_f32 v229, v229
    v_fma_f32 v231, v231, s67, s67
    buffer_load_dwordx4 v185, s[28:31], s56 offen offset:3072 lds
    v_rcp_f32 v230, v230
    v_rcp_f32 v231, v231
    v_mul_f32 v128, v128, v224
    v_mul_f32 v129, v129, v225
    s_add_u32 s53, s53, 49152
    s_cmp_ge_u32 s53, s61
    s_cselect_b32 s53, s60, s53
    buffer_store_dwordx4 v[208:211], v198, s[28:31], 0 offen offset:0 sc1
    s_waitcnt vmcnt(14)
    s_barrier
    s_and_b32 s57, s58, 15
    s_lshr_b64 s[58:59], s[58:59], 4
    s_lshl_b32 s56, s57, 11
    s_mul_i32 s57, s57, 0x70000
    s_add_u32 m0, s53, 16384
    s_nop 0
    buffer_load_dwordx4 v188, s[32:35], s57 offen offset:0 lds
    v_mul_f32 v130, v130, v226
    v_mul_f32 v131, v131, v227
    v_mul_f32 v132, v132, v228
    v_mul_f32 v133, v133, v229
    buffer_load_dwordx4 v189, s[32:35], s57 offen offset:1024 lds
    v_mul_f32 v134, v134, v230
    v_mul_f32 v135, v135, v231
    v_cvt_pk_bf16_f32 v212, v128, v129
    v_cvt_pk_bf16_f32 v213, v130, v131
    buffer_load_dwordx4 v190, s[32:35], s57 offen offset:2048 lds
    v_cvt_pk_bf16_f32 v214, v132, v133
    v_cvt_pk_bf16_f32 v215, v134, v135
    buffer_load_dwordx4 v191, s[32:35], s57 offen offset:3072 lds
    s_add_u32 m0, s53, 32768
    s_nop 0
    buffer_load_dwordx4 v188, s[36:39], s57 offen offset:0 lds
    buffer_load_dwordx4 v189, s[36:39], s57 offen offset:1024 lds
    buffer_load_dwordx4 v190, s[36:39], s57 offen offset:2048 lds
    buffer_load_dwordx4 v191, s[36:39], s57 offen offset:3072 lds
    s_mov_b32 m0, s53
    s_nop 0
    buffer_load_dwordx4 v184, s[28:31], s56 offen offset:0 lds
    buffer_load_dwordx4 v184, s[28:31], s56 offen offset:1024 lds
    buffer_load_dwordx4 v185, s[28:31], s56 offen offset:2048 lds
    buffer_load_dwordx4 v185, s[28:31], s56 offen offset:3072 lds
    s_add_u32 s53, s53, 49152
    s_cmp_ge_u32 s53, s61
    s_cselect_b32 s53, s60, s53
    buffer_store_dwordx4 v[212:215], v198, s[28:31], 0 offen offset:1024 sc1
    s_waitcnt vmcnt(14)
    s_barrier
    s_and_b32 s57, s58, 15
    s_lshr_b64 s[58:59], s[58:59], 4
    s_lshl_b32 s56, s57, 11
    s_mul_i32 s57, s57, 0x70000
    s_add_u32 m0, s53, 16384
    s_nop 0
    buffer_load_dwordx4 v188, s[32:35], s57 offen offset:0 lds
    buffer_load_dwordx4 v189, s[32:35], s57 offen offset:1024 lds
    buffer_load_dwordx4 v190, s[32:35], s57 offen offset:2048 lds
    buffer_load_dwordx4 v191, s[32:35], s57 offen offset:3072 lds
    s_add_u32 m0, s53, 32768
    s_nop 0
    buffer_load_dwordx4 v188, s[36:39], s57 offen offset:0 lds
    buffer_load_dwordx4 v189, s[36:39], s57 offen offset:1024 lds
    buffer_load_dwordx4 v190, s[36:39], s57 offen offset:2048 lds
    buffer_load_dwordx4 v191, s[36:39], s57 offen offset:3072 lds
    s_mov_b32 m0, s53
    s_nop 0
    buffer_load_dwordx4 v184, s[28:31], s56 offen offset:0 lds
    buffer_load_dwordx4 v184, s[28:31], s56 offen offset:1024 lds
    buffer_load_dwordx4 v185, s[28:31], s56 offen offset:2048 lds
    buffer_load_dwordx4 v185, s[28:31], s56 offen offset:3072 lds
    s_add_u32 s53, s53, 49152
    s_cmp_ge_u32 s53, s61
    s_cselect_b32 s53, s60, s53
    s_lshl_b32 s64, s47, 8
    s_lshl_b32 s65, s48, 4
    s_add_u32 s64, s64, s65
    s_lshl_b32 s65, s44, 2
    s_add_u32 s64, s64, s65
    s_add_u32 s64, s64, 0x51000
    v_mov_b32 v2, s0
    s_waitcnt vmcnt(12)
    s_mov_b64 exec, 1
    buffer_store_dword v2, v234, s[28:31], s64 offen sc1
    s_mov_b64 exec, -1
    s_lshl_b32 s64, s50, 3
    s_lshl_b32 s65, s44, 1
    s_add_u32 s64, s64, s65
    s_mul_i32 s64, s64, 114688
    s_add_u32 s64, s64, 0x1500000
    v_lshl_add_u32 v192, v1, 4, s64
    v_add_u32 v193, 112640, v192
    s_lshl_b32 s65, s51, 8
    v_lshrrev_b32 v3, 4, v1
    s_lshl_b32 s64, s44, 4
    v_add_u32 v2, s64, v3
    s_movk_i32 s64, 2048
    v_mul_u32_u24 v2, s64, v2
    v_add_u32 v2, s65, v2
    v_lshlrev_b32 v3, 1, v3
    v_and_b32 v4, 15, v1
    v_xor_b32 v3, v3, v4
    v_lshl_add_u32 v194, v3, 4, v2
    v_add_u32 v196, 14336, v194
    v_xor_b32 v3, 8, v3
    v_lshl_add_u32 v195, v3, 4, v2
    v_add_u32 v195, 7168, v195
    v_add_u32 v197, 14336, v195
    s_barrier
    s_and_b32 s57, s58, 15
    s_lshr_b64 s[58:59], s[58:59], 4
    s_lshl_b32 s56, s57, 11
    s_mul_i32 s57, s57, 0x70000
    s_add_u32 m0, s53, 16384
    s_nop 0
    buffer_load_dwordx4 v188, s[32:35], s57 offen offset:0 lds
    buffer_load_dwordx4 v189, s[32:35], s57 offen offset:1024 lds
    buffer_load_dwordx4 v190, s[32:35], s57 offen offset:2048 lds
    buffer_load_dwordx4 v191, s[32:35], s57 offen offset:3072 lds
    s_add_u32 m0, s53, 32768
    s_nop 0
    buffer_load_dwordx4 v188, s[36:39], s57 offen offset:0 lds
    buffer_load_dwordx4 v189, s[36:39], s57 offen offset:1024 lds
    buffer_load_dwordx4 v190, s[36:39], s57 offen offset:2048 lds
    buffer_load_dwordx4 v191, s[36:39], s57 offen offset:3072 lds
    s_mov_b32 m0, s53
    s_nop 0
    buffer_load_dwordx4 v184, s[28:31], s56 offen offset:0 lds
    buffer_load_dwordx4 v184, s[28:31], s56 offen offset:1024 lds
    buffer_load_dwordx4 v185, s[28:31], s56 offen offset:2048 lds
    buffer_load_dwordx4 v185, s[28:31], s56 offen offset:3072 lds
    s_add_u32 s53, s53, 49152
    s_cmp_ge_u32 s53, s61
    s_cselect_b32 s53, s60, s53
    s_waitcnt vmcnt(13)
    s_barrier
    s_and_b32 s57, s58, 15
    s_lshr_b64 s[58:59], s[58:59], 4
    s_lshl_b32 s56, s57, 11
    s_mul_i32 s57, s57, 0x70000
    s_add_u32 m0, s53, 16384
    s_nop 0
    buffer_load_dwordx4 v188, s[32:35], s57 offen offset:0 lds
    buffer_load_dwordx4 v189, s[32:35], s57 offen offset:1024 lds
    buffer_load_dwordx4 v190, s[32:35], s57 offen offset:2048 lds
    buffer_load_dwordx4 v191, s[32:35], s57 offen offset:3072 lds
    s_add_u32 m0, s53, 32768
    s_nop 0
    buffer_load_dwordx4 v188, s[36:39], s57 offen offset:0 lds
    buffer_load_dwordx4 v189, s[36:39], s57 offen offset:1024 lds
    buffer_load_dwordx4 v190, s[36:39], s57 offen offset:2048 lds
    buffer_load_dwordx4 v191, s[36:39], s57 offen offset:3072 lds
    s_mov_b32 m0, s53
    s_nop 0
    buffer_load_dwordx4 v184, s[28:31], s56 offen offset:0 lds
    buffer_load_dwordx4 v184, s[28:31], s56 offen offset:1024 lds
    buffer_load_dwordx4 v185, s[28:31], s56 offen offset:2048 lds
    buffer_load_dwordx4 v185, s[28:31], s56 offen offset:3072 lds
    s_add_u32 s53, s53, 49152
    s_cmp_ge_u32 s53, s61
    s_cselect_b32 s53, s60, s53
    s_waitcnt vmcnt(12)
    s_barrier
    s_and_b32 s57, s58, 15
    s_lshr_b64 s[58:59], s[58:59], 4
    s_lshl_b32 s56, s57, 11
    s_mul_i32 s57, s57, 0x70000
    s_add_u32 m0, s53, 16384
    s_nop 0
    buffer_load_dwordx4 v188, s[32:35], s57 offen offset:0 lds
    buffer_load_dwordx4 v189, s[32:35], s57 offen offset:1024 lds
    buffer_load_dwordx4 v190, s[32:35], s57 offen offset:2048 lds
    buffer_load_dwordx4 v191, s[32:35], s57 offen offset:3072 lds
    s_add_u32 m0, s53, 32768
    s_nop 0
    buffer_load_dwordx4 v188, s[36:39], s57 offen offset:0 lds
    buffer_load_dwordx4 v189, s[36:39], s57 offen offset:1024 lds
    buffer_load_dwordx4 v190, s[36:39], s57 offen offset:2048 lds
    buffer_load_dwordx4 v191, s[36:39], s57 offen offset:3072 lds
    s_mov_b32 m0, s53
    s_nop 0
    buffer_load_dwordx4 v184, s[28:31], s56 offen offset:0 lds
    buffer_load_dwordx4 v184, s[28:31], s56 offen offset:1024 lds
    buffer_load_dwordx4 v185, s[28:31], s56 offen offset:2048 lds
    buffer_load_dwordx4 v185, s[28:31], s56 offen offset:3072 lds
    s_add_u32 s53, s53, 49152
    s_cmp_ge_u32 s53, s61
    s_cselect_b32 s53, s60, s53
    s_waitcnt vmcnt(12)
    s_barrier
    s_lshl_b32 s68, s50, 8
    s_add_u32 s68, s68, 0x51000
    buffer_load_dword v245, v234, s[28:31], s68 offen sc1
    s_and_b32 s57, s58, 15
    s_lshr_b64 s[58:59], s[58:59], 4
    s_lshl_b32 s56, s57, 11
    s_mul_i32 s57, s57, 0x70000
    s_add_u32 m0, s53, 16384
    s_nop 0
    buffer_load_dwordx4 v188, s[32:35], s57 offen offset:0 lds
    buffer_load_dwordx4 v189, s[32:35], s57 offen offset:1024 lds
    buffer_load_dwordx4 v190, s[32:35], s57 offen offset:2048 lds
    buffer_load_dwordx4 v191, s[32:35], s57 offen offset:3072 lds
    s_add_u32 m0, s53, 32768
    s_nop 0
    buffer_load_dwordx4 v188, s[36:39], s57 offen offset:0 lds
    buffer_load_dwordx4 v189, s[36:39], s57 offen offset:1024 lds
    buffer_load_dwordx4 v190, s[36:39], s57 offen offset:2048 lds
    buffer_load_dwordx4 v191, s[36:39], s57 offen offset:3072 lds
    s_mov_b32 m0, s53
    s_nop 0
    buffer_load_dwordx4 v184, s[28:31], s56 offen offset:0 lds
    buffer_load_dwordx4 v184, s[28:31], s56 offen offset:1024 lds
    buffer_load_dwordx4 v185, s[28:31], s56 offen offset:2048 lds
    buffer_load_dwordx4 v185, s[28:31], s56 offen offset:3072 lds
    s_add_u32 s53, s53, 49152
    s_cmp_ge_u32 s53, s61
    s_cselect_b32 s53, s60, s53
    s_waitcnt vmcnt(13)
    s_barrier
M_Pjoin:
    s_waitcnt vmcnt(12)
    s_mov_b32 s3, 0x40000
M_pa_chk:
    v_cmp_ne_u32 vcc, s0, v245
    s_nop 4
    s_cbranch_vccz M_pa_ok
    s_sub_u32 s3, s3, 1
    s_cbranch_scc1 M_pa_ok
    s_sleep 4
    s_cmp_eq_u32 s69, 0
    s_cbranch_scc1 M_pa_rl
    s_sleep 48
M_pa_rl:
    buffer_load_dword v245, v234, s[28:31], s68 offen sc1
    s_waitcnt vmcnt(0)
    s_branch M_pa_chk
M_pa_ok:
    s_lshl_b32 s60, s44, 12
    s_add_u32 s61, s60, 163840
    s_add_u32 s53, s60, 98304
    s_add_u32 s66, s50, s51
    s_and_b32 s66, s66, 3
    s_mov_b32 s58, 0x76453201
    s_mov_b32 s59, 0xfecdba89
    s_cmp_eq_u32 s66, 1
    s_cselect_b32 s58, 0x75643120, s58
    s_cselect_b32 s59, 0xfdecb9a8, s59
    s_cmp_eq_u32 s66, 2
    s_cselect_b32 s58, 0x67542310, s58
    s_cselect_b32 s59, 0xefdcab98, s59
    s_cmp_eq_u32 s66, 3
    s_cselect_b32 s58, 0x86534210, s58
    s_cselect_b32 s59, 0xfedbca97, s59
    s_cmp_eq_u32 s49, 0
    s_cselect_b32 s55, 16, 0
    s_mov_b32 s32, s16
    s_mov_b32 s33, s17
    s_mov_b32 s34, 0x700000
    s_mov_b32 s35, 0x20000
    s_and_b32 s57, s58, 15
    s_lshr_b64 s[58:59], s[58:59], 4
    s_add_u32 s57, s57, s55
    s_lshl_b32 s56, s57, 11
    s_mul_i32 s57, s57, 0x20000
    s_add_u32 m0, s53, 16384
    s_nop 0
    buffer_load_dwordx4 v194, s[32:35], s57 offen offset:0 lds
    buffer_load_dwordx4 v195, s[32:35], s57 offen offset:1024 lds
    buffer_load_dwordx4 v196, s[32:35], s57 offen offset:2048 lds
    buffer_load_dwordx4 v197, s[32:35], s57 offen offset:3072 lds
    s_mov_b32 m0, s53
    s_nop 0
    buffer_load_dwordx4 v192, s[28:31], s56 offen offset:0 lds
    buffer_load_dwordx4 v192, s[28:31], s56 offen offset:1024 lds
    buffer_load_dwordx4 v193, s[28:31], s56 offen offset:2048 lds
    buffer_load_dwordx4 v193, s[28:31], s56 offen offset:3072 lds
    s_add_u32 s53, s53, 32768
    s_cmp_ge_u32 s53, s61
    s_cselect_b32 s53, s60, s53
    s_and_b32 s57, s58, 15
    s_lshr_b64 s[58:59], s[58:59], 4
    s_add_u32 s57, s57, s55
    s_lshl_b32 s56, s57, 11
    s_mul_i32 s57, s57, 0x20000
    s_add_u32 m0, s53, 16384
    s_nop 0
    buffer_load_dwordx4 v194, s[32:35], s57 offen offset:0 lds
    buffer_load_dwordx4 v195, s[32:35], s57 offen offset:1024 lds
    buffer_load_dwordx4 v196, s[32:35], s57 offen offset:2048 lds
    buffer_load_dwordx4 v197, s[32:35], s57 offen offset:3072 lds
    v_and_b32 v2, 15, v1
    s_lshl_b32 s70, s50, 1
    s_add_u32 s70, s70, s45
    s_lshl_b32 s71, s51, 1
    s_add_u32 s71, s71, s46
    s_lshl_b32 s64, s70, 17
    s_lshl_b32 s65, s71, 7
    s_add_u32 s64, s64, s65
    v_lshl_add_u32 v2, v2, 11, s64
    v_bfe_u32 v3, v1, 4, 1
    v_lshl_add_u32 v2, v3, 5, v2
    v_lshrrev_b32 v3, 5, v1
    v_lshl_add_u32 v184, v3, 4, v2
    s_cmp_eq_u32 s49, 0
    s_cselect_b32 s63, 0x80000000, 0
    s_mul_i32 s64, s70, 131072
    s_lshl_b32 s65, s71, 11
    s_add_u32 s64, s64, s65
    s_add_u32 s64, s64, 0xb00000
    s_or_b32 s64, s64, s63
    v_lshl_add_u32 v188, v1, 4, s64
    s_lshl_b32 s64, s50, 12
    s_lshl_b32 s65, s71, 8
    s_add_u32 s64, s64, s65
    s_add_u32 s64, s64, 0xc0000
    s_or_b32 s64, s64, s63
    v_and_b32 v2, 48, v1
    v_add_u32 v185, s64, v2
    s_lshl_b32 s64, s50, 3
    s_add_u32 s64, s64, s51
    s_lshl_b32 s64, s64, 2
    s_add_u32 s64, s64, s44
    s_lshl_b32 s65, s64, 13
    s_add_u32 s65, s65, 0x2400000
    v_lshl_add_u32 v186, v1, 4, s65
    s_lshl_b32 s65, s64, 2
    s_add_u32 s65, s65, 0x50000
    v_mov_b32 v187, s65
    s_mul_i32 s62, s49, 4
    s_mov_b32 s52, 98304
    s_waitcnt vmcnt(12)
    s_barrier
    s_mov_b32 m0, s53
    s_nop 0
    buffer_load_dwordx4 v192, s[28:31], s56 offen offset:0 lds
    buffer_load_dwordx4 v192, s[28:31], s56 offen offset:1024 lds
    buffer_load_dwordx4 v193, s[28:31], s56 offen offset:2048 lds
    buffer_load_dwordx4 v193, s[28:31], s56 offen offset:3072 lds
    s_add_u32 s53, s53, 32768
    s_cmp_ge_u32 s53, s61
    s_cselect_b32 s53, s60, s53
    s_and_b32 s57, s58, 15
    s_lshr_b64 s[58:59], s[58:59], 4
    s_add_u32 s57, s57, s55
    s_lshl_b32 s56, s57, 11
    s_mul_i32 s57, s57, 0x20000
    s_add_u32 m0, s53, 16384
    s_nop 0
    buffer_load_dwordx4 v194, s[32:35], s57 offen offset:0 lds
    buffer_load_dwordx4 v195, s[32:35], s57 offen offset:1024 lds
    buffer_load_dwordx4 v196, s[32:35], s57 offen offset:2048 lds
    buffer_load_dwordx4 v197, s[32:35], s57 offen offset:3072 lds
    s_mov_b32 m0, s53
    s_nop 0
    buffer_load_dwordx4 v192, s[28:31], s56 offen offset:0 lds
    buffer_load_dwordx4 v192, s[28:31], s56 offen offset:1024 lds
    buffer_load_dwordx4 v193, s[28:31], s56 offen offset:2048 lds
    buffer_load_dwordx4 v193, s[28:31], s56 offen offset:3072 lds
    s_add_u32 s53, s53, 32768
    s_cmp_ge_u32 s53, s61
    s_cselect_b32 s53, s60, s53
    v_add_u32 v232, s52, v233
    v_add_u32 v235, s52, v239
    v_add_u32 v236, s52, v240
    v_add_u32 v237, s52, v241
    v_add_u32 v238, s52, v242
    s_mov_b32 s72, 0x0
    s_mov_b32 s76, 0x0
    s_mov_b32 s73, 0x8000
    s_mov_b32 s77, 0x8000
    s_mov_b32 s74, 0x10000
    s_mov_b32 s78, 0x10000
    s_mov_b32 s75, 0x18000
    s_mov_b32 s79, 0x18000
    s_mov_b32 s80, 0x0
    s_mov_b32 s81, 0x1000
    s_mov_b32 s40, s22
    s_mov_b32 s41, s23
    s_mov_b32 s42, 0x400000
    s_mov_b32 s43, 0x20000
    s_waitcnt vmcnt(16)
    s_barrier
    s_setprio 2
    ds_read_b128 v[72:75], v232 offset:0
    ds_read_b64_tr_b16 v[88:89], v235 offset:0
    ds_read_b64_tr_b16 v[90:91], v235 offset:4096
    ds_read_b64_tr_b16 v[92:93], v236 offset:0
    ds_read_b64_tr_b16 v[94:95], v236 offset:4096
    ds_read_b128 v[76:79], v232 offset:2048
    ds_read_b64_tr_b16 v[96:97], v237 offset:0
    ds_read_b64_tr_b16 v[98:99], v237 offset:4096
    ds_read_b64_tr_b16 v[100:101], v238 offset:0
    ds_read_b64_tr_b16 v[102:103], v238 offset:4096
    ds_read_b128 v[80:83], v232 offset:4096
    ds_read_b128 v[84:87], v232 offset:6144
    s_and_b32 s57, s58, 15
    s_lshr_b64 s[58:59], s[58:59], 4
    s_add_u32 s57, s57, s55
    s_lshl_b32 s56, s57, 11
    s_mul_i32 s57, s57, 0x20000
    s_add_u32 m0, s53, 16384
    s_nop 0
    buffer_load_dwordx4 v194, s[32:35], s57 offen offset:0 lds
    buffer_load_dwordx4 v195, s[32:35], s57 offen offset:1024 lds
    buffer_load_dwordx4 v196, s[32:35], s57 offen offset:2048 lds
    buffer_load_dwordx4 v197, s[32:35], s57 offen offset:3072 lds
    s_mov_b32 m0, s53
    s_nop 0
    buffer_load_dwordx4 v192, s[28:31], s56 offen offset:0 lds
    buffer_load_dwordx4 v192, s[28:31], s56 offen offset:1024 lds
    buffer_load_dwordx4 v193, s[28:31], s56 offen offset:2048 lds
    buffer_load_dwordx4 v193, s[28:31], s56 offen offset:3072 lds
    s_add_u32 s53, s53, 32768
    s_cmp_ge_u32 s53, s61
    s_cselect_b32 s53, s60, s53
    s_add_u32 s52, s52, 32768
    s_cmp_ge_u32 s52, 163840
    s_cselect_b32 s52, 0, s52
    s_waitcnt lgkmcnt(0)
    v_mfma_f32_16x16x32_bf16 v[8:11], v[88:91], v[72:75], 0
    ds_read_b128 v[104:107], v232 offset:1024
    v_mfma_f32_16x16x32_bf16 v[12:15], v[92:95], v[72:75], 0
    ds_read_b64_tr_b16 v[120:121], v235 offset:8192
    v_mfma_f32_16x16x32_bf16 v[16:19], v[96:99], v[72:75], 0
    ds_read_b64_tr_b16 v[122:123], v235 offset:12288
    v_mfma_f32_16x16x32_bf16 v[20:23], v[100:103], v[72:75], 0
    ds_read_b64_tr_b16 v[124:125], v236 offset:8192
    v_mfma_f32_16x16x32_bf16 v[24:27], v[88:91], v[76:79], 0
    ds_read_b64_tr_b16 v[126:127], v236 offset:12288
    v_mfma_f32_16x16x32_bf16 v[28:31], v[92:95], v[76:79], 0
    ds_read_b128 v[108:111], v232 offset:3072
    v_mfma_f32_16x16x32_bf16 v[32:35], v[96:99], v[76:79], 0
    ds_read_b64_tr_b16 v[128:129], v237 offset:8192
    v_mfma_f32_16x16x32_bf16 v[36:39], v[100:103], v[76:79], 0
    ds_read_b64_tr_b16 v[130:131], v237 offset:12288
    v_mfma_f32_16x16x32_bf16 v[40:43], v[88:91], v[80:83], 0
    ds_read_b64_tr_b16 v[132:133], v238 offset:8192
    v_mfma_f32_16x16x32_bf16 v[44:47], v[92:95], v[80:83], 0
    ds_read_b64_tr_b16 v[134:135], v238 offset:12288
    v_mfma_f32_16x16x32_bf16 v[48:51], v[96:99], v[80:83], 0
    ds_read_b128 v[112:115], v232 offset:5120
    v_mfma_f32_16x16x32_bf16 v[52:55], v[100:103], v[80:83], 0
    ds_read_b128 v[116:119], v232 offset:7168
    v_mfma_f32_16x16x32_bf16 v[56:59], v[88:91], v[84:87], 0
    v_add_u32 v232, s52, v233
    v_add_u32 v235, s52, v239
    v_mfma_f32_16x16x32_bf16 v[60:63], v[92:95], v[84:87], 0
    v_add_u32 v236, s52, v240
    v_mfma_f32_16x16x32_bf16 v[64:67], v[96:99], v[84:87], 0
    v_add_u32 v237, s52, v241
    v_mfma_f32_16x16x32_bf16 v[68:71], v[100:103], v[84:87], 0
    v_add_u32 v238, s52, v242
    s_waitcnt lgkmcnt(0)
    v_mfma_f32_16x16x32_bf16 v[8:11], v[120:123], v[104:107], v[8:11]
    s_waitcnt vmcnt(16)
    s_barrier
    v_mfma_f32_16x16x32_bf16 v[12:15], v[124:127], v[104:107], v[12:15]
    ds_read_b128 v[72:75], v232 offset:0
    ds_read_b64_tr_b16 v[88:89], v235 offset:0
    v_mfma_f32_16x16x32_bf16 v[16:19], v[128:131], v[104:107], v[16:19]
    ds_read_b64_tr_b16 v[90:91], v235 offset:4096
    v_mfma_f32_16x16x32_bf16 v[20:23], v[132:135], v[104:107], v[20:23]
    ds_read_b64_tr_b16 v[92:93], v236 offset:0
    v_mfma_f32_16x16x32_bf16 v[24:27], v[120:123], v[108:111], v[24:27]
    ds_read_b64_tr_b16 v[94:95], v236 offset:4096
    v_mfma_f32_16x16x32_bf16 v[28:31], v[124:127], v[108:111], v[28:31]
    ds_read_b128 v[76:79], v232 offset:2048
    v_mfma_f32_16x16x32_bf16 v[32:35], v[128:131], v[108:111], v[32:35]
    ds_read_b64_tr_b16 v[96:97], v237 offset:0
    v_mfma_f32_16x16x32_bf16 v[36:39], v[132:135], v[108:111], v[36:39]
    ds_read_b64_tr_b16 v[98:99], v237 offset:4096
    v_mfma_f32_16x16x32_bf16 v[40:43], v[120:123], v[112:115], v[40:43]
    ds_read_b64_tr_b16 v[100:101], v238 offset:0
    v_mfma_f32_16x16x32_bf16 v[44:47], v[124:127], v[112:115], v[44:47]
    ds_read_b64_tr_b16 v[102:103], v238 offset:4096
    v_mfma_f32_16x16x32_bf16 v[48:51], v[128:131], v[112:115], v[48:51]
    ds_read_b128 v[80:83], v232 offset:4096
    v_mfma_f32_16x16x32_bf16 v[52:55], v[132:135], v[112:115], v[52:55]
    ds_read_b128 v[84:87], v232 offset:6144
    v_mfma_f32_16x16x32_bf16 v[56:59], v[120:123], v[116:119], v[56:59]
    v_mfma_f32_16x16x32_bf16 v[60:63], v[124:127], v[116:119], v[60:63]
    v_mfma_f32_16x16x32_bf16 v[64:67], v[128:131], v[116:119], v[64:67]
    s_add_u32 s52, s52, 32768
    s_cmp_ge_u32 s52, 163840
    s_cselect_b32 s52, 0, s52
    v_mfma_f32_16x16x32_bf16 v[68:71], v[132:135], v[116:119], v[68:71]
    s_waitcnt lgkmcnt(0)
    v_mfma_f32_16x16x32_bf16 v[8:11], v[88:91], v[72:75], v[8:11]
    ds_read_b128 v[104:107], v232 offset:1024
    v_mfma_f32_16x16x32_bf16 v[12:15], v[92:95], v[72:75], v[12:15]
    ds_read_b64_tr_b16 v[120:121], v235 offset:8192
    v_mfma_f32_16x16x32_bf16 v[16:19], v[96:99], v[72:75], v[16:19]
    ds_read_b64_tr_b16 v[122:123], v235 offset:12288
    v_mfma_f32_16x16x32_bf16 v[20:23], v[100:103], v[72:75], v[20:23]
    ds_read_b64_tr_b16 v[124:125], v236 offset:8192
    v_mfma_f32_16x16x32_bf16 v[24:27], v[88:91], v[76:79], v[24:27]
    ds_read_b64_tr_b16 v[126:127], v236 offset:12288
    v_mfma_f32_16x16x32_bf16 v[28:31], v[92:95], v[76:79], v[28:31]
    ds_read_b128 v[108:111], v232 offset:3072
    v_mfma_f32_16x16x32_bf16 v[32:35], v[96:99], v[76:79], v[32:35]
    ds_read_b64_tr_b16 v[128:129], v237 offset:8192
    v_mfma_f32_16x16x32_bf16 v[36:39], v[100:103], v[76:79], v[36:39]
    ds_read_b64_tr_b16 v[130:131], v237 offset:12288
    v_mfma_f32_16x16x32_bf16 v[40:43], v[88:91], v[80:83], v[40:43]
    ds_read_b64_tr_b16 v[132:133], v238 offset:8192
    v_mfma_f32_16x16x32_bf16 v[44:47], v[92:95], v[80:83], v[44:47]
    ds_read_b64_tr_b16 v[134:135], v238 offset:12288
    v_mfma_f32_16x16x32_bf16 v[48:51], v[96:99], v[80:83], v[48:51]
    ds_read_b128 v[112:115], v232 offset:5120
    v_mfma_f32_16x16x32_bf16 v[52:55], v[100:103], v[80:83], v[52:55]
    ds_read_b128 v[116:119], v232 offset:7168
    v_mfma_f32_16x16x32_bf16 v[56:59], v[88:91], v[84:87], v[56:59]
    v_add_u32 v232, s52, v233
    v_add_u32 v235, s52, v239
    v_mfma_f32_16x16x32_bf16 v[60:63], v[92:95], v[84:87], v[60:63]
    v_add_u32 v236, s52, v240
    v_mfma_f32_16x16x32_bf16 v[64:67], v[96:99], v[84:87], v[64:67]
    v_add_u32 v237, s52, v241
    v_mfma_f32_16x16x32_bf16 v[68:71], v[100:103], v[84:87], v[68:71]
    v_add_u32 v238, s52, v242
    s_waitcnt lgkmcnt(0)
    v_mfma_f32_16x16x32_bf16 v[8:11], v[120:123], v[104:107], v[8:11]
    s_waitcnt vmcnt(8)
    s_barrier
    v_mfma_f32_16x16x32_bf16 v[12:15], v[124:127], v[104:107], v[12:15]
    ds_read_b128 v[72:75], v232 offset:0
    ds_read_b64_tr_b16 v[88:89], v235 offset:0
    v_mfma_f32_16x16x32_bf16 v[16:19], v[128:131], v[104:107], v[16:19]
    ds_read_b64_tr_b16 v[90:91], v235 offset:4096
    v_mfma_f32_16x16x32_bf16 v[20:23], v[132:135], v[104:107], v[20:23]
    ds_read_b64_tr_b16 v[92:93], v236 offset:0
    v_mfma_f32_16x16x32_bf16 v[24:27], v[120:123], v[108:111], v[24:27]
    ds_read_b64_tr_b16 v[94:95], v236 offset:4096
    v_mfma_f32_16x16x32_bf16 v[28:31], v[124:127], v[108:111], v[28:31]
    ds_read_b128 v[76:79], v232 offset:2048
    v_mfma_f32_16x16x32_bf16 v[32:35], v[128:131], v[108:111], v[32:35]
    ds_read_b64_tr_b16 v[96:97], v237 offset:0
    v_mfma_f32_16x16x32_bf16 v[36:39], v[132:135], v[108:111], v[36:39]
    ds_read_b64_tr_b16 v[98:99], v237 offset:4096
    v_mfma_f32_16x16x32_bf16 v[40:43], v[120:123], v[112:115], v[40:43]
    ds_read_b64_tr_b16 v[100:101], v238 offset:0
    v_mfma_f32_16x16x32_bf16 v[44:47], v[124:127], v[112:115], v[44:47]
    ds_read_b64_tr_b16 v[102:103], v238 offset:4096
    v_mfma_f32_16x16x32_bf16 v[48:51], v[128:131], v[112:115], v[48:51]
    ds_read_b128 v[80:83], v232 offset:4096
    v_mfma_f32_16x16x32_bf16 v[52:55], v[132:135], v[112:115], v[52:55]
    ds_read_b128 v[84:87], v232 offset:6144
    v_mfma_f32_16x16x32_bf16 v[56:59], v[120:123], v[116:119], v[56:59]
    v_mfma_f32_16x16x32_bf16 v[60:63], v[124:127], v[116:119], v[60:63]
    v_mfma_f32_16x16x32_bf16 v[64:67], v[128:131], v[116:119], v[64:67]
    s_add_u32 s52, s52, 32768
    s_cmp_ge_u32 s52, 163840
    s_cselect_b32 s52, 0, s52
    v_mfma_f32_16x16x32_bf16 v[68:71], v[132:135], v[116:119], v[68:71]
    s_waitcnt lgkmcnt(0)
    v_mfma_f32_16x16x32_bf16 v[8:11], v[88:91], v[72:75], v[8:11]
    ds_read_b128 v[104:107], v232 offset:1024
    v_mfma_f32_16x16x32_bf16 v[12:15], v[92:95], v[72:75], v[12:15]
    ds_read_b64_tr_b16 v[120:121], v235 offset:8192
    v_mfma_f32_16x16x32_bf16 v[16:19], v[96:99], v[72:75], v[16:19]
    ds_read_b64_tr_b16 v[122:123], v235 offset:12288
    v_mfma_f32_16x16x32_bf16 v[20:23], v[100:103], v[72:75], v[20:23]
    ds_read_b64_tr_b16 v[124:125], v236 offset:8192
    v_mfma_f32_16x16x32_bf16 v[24:27], v[88:91], v[76:79], v[24:27]
    ds_read_b64_tr_b16 v[126:127], v236 offset:12288
    v_mfma_f32_16x16x32_bf16 v[28:31], v[92:95], v[76:79], v[28:31]
    ds_read_b128 v[108:111], v232 offset:3072
    v_mfma_f32_16x16x32_bf16 v[32:35], v[96:99], v[76:79], v[32:35]
    ds_read_b64_tr_b16 v[128:129], v237 offset:8192
    v_mfma_f32_16x16x32_bf16 v[36:39], v[100:103], v[76:79], v[36:39]
    ds_read_b64_tr_b16 v[130:131], v237 offset:12288
    v_mfma_f32_16x16x32_bf16 v[40:43], v[88:91], v[80:83], v[40:43]
    ds_read_b64_tr_b16 v[132:133], v238 offset:8192
    v_mfma_f32_16x16x32_bf16 v[44:47], v[92:95], v[80:83], v[44:47]
    ds_read_b64_tr_b16 v[134:135], v238 offset:12288
    v_mfma_f32_16x16x32_bf16 v[48:51], v[96:99], v[80:83], v[48:51]
    ds_read_b128 v[112:115], v232 offset:5120
    v_mfma_f32_16x16x32_bf16 v[52:55], v[100:103], v[80:83], v[52:55]
    ds_read_b128 v[116:119], v232 offset:7168
    v_mfma_f32_16x16x32_bf16 v[56:59], v[88:91], v[84:87], v[56:59]
    v_add_u32 v232, s52, v233
    v_add_u32 v235, s52, v239
    v_mfma_f32_16x16x32_bf16 v[60:63], v[92:95], v[84:87], v[60:63]
    v_add_u32 v236, s52, v240
    v_mfma_f32_16x16x32_bf16 v[64:67], v[96:99], v[84:87], v[64:67]
    v_add_u32 v237, s52, v241
    v_mfma_f32_16x16x32_bf16 v[68:71], v[100:103], v[84:87], v[68:71]
    v_add_u32 v238, s52, v242
    s_waitcnt lgkmcnt(0)
    v_mfma_f32_16x16x32_bf16 v[8:11], v[120:123], v[104:107], v[8:11]
    s_waitcnt vmcnt(0)
    s_barrier
    v_mfma_f32_16x16x32_bf16 v[12:15], v[124:127], v[104:107], v[12:15]
    ds_read_b128 v[72:75], v232 offset:0
    ds_read_b64_tr_b16 v[88:89], v235 offset:0
    v_mfma_f32_16x16x32_bf16 v[16:19], v[128:131], v[104:107], v[16:19]
    ds_read_b64_tr_b16 v[90:91], v235 offset:4096
    v_mfma_f32_16x16x32_bf16 v[20:23], v[132:135], v[104:107], v[20:23]
    ds_read_b64_tr_b16 v[92:93], v236 offset:0
    v_mfma_f32_16x16x32_bf16 v[24:27], v[120:123], v[108:111], v[24:27]
    ds_read_b64_tr_b16 v[94:95], v236 offset:4096
    v_mfma_f32_16x16x32_bf16 v[28:31], v[124:127], v[108:111], v[28:31]
    ds_read_b128 v[76:79], v232 offset:2048
    v_mfma_f32_16x16x32_bf16 v[32:35], v[128:131], v[108:111], v[32:35]
    ds_read_b64_tr_b16 v[96:97], v237 offset:0
    v_mfma_f32_16x16x32_bf16 v[36:39], v[132:135], v[108:111], v[36:39]
    ds_read_b64_tr_b16 v[98:99], v237 offset:4096
    v_mfma_f32_16x16x32_bf16 v[40:43], v[120:123], v[112:115], v[40:43]
    ds_read_b64_tr_b16 v[100:101], v238 offset:0
    v_mfma_f32_16x16x32_bf16 v[44:47], v[124:127], v[112:115], v[44:47]
    ds_read_b64_tr_b16 v[102:103], v238 offset:4096
    v_mfma_f32_16x16x32_bf16 v[48:51], v[128:131], v[112:115], v[48:51]
    ds_read_b128 v[80:83], v232 offset:4096
    v_mfma_f32_16x16x32_bf16 v[52:55], v[132:135], v[112:115], v[52:55]
    ds_read_b128 v[84:87], v232 offset:6144
    v_mfma_f32_16x16x32_bf16 v[56:59], v[120:123], v[116:119], v[56:59]
    v_mfma_f32_16x16x32_bf16 v[60:63], v[124:127], v[116:119], v[60:63]
    v_mfma_f32_16x16x32_bf16 v[64:67], v[128:131], v[116:119], v[64:67]
    s_add_u32 s52, s52, 32768
    s_cmp_ge_u32 s52, 163840
    s_cselect_b32 s52, 0, s52
    v_mfma_f32_16x16x32_bf16 v[68:71], v[132:135], v[116:119], v[68:71]
    s_waitcnt lgkmcnt(0)
    v_mfma_f32_16x16x32_bf16 v[8:11], v[88:91], v[72:75], v[8:11]
    ds_read_b128 v[104:107], v232 offset:1024
    v_mfma_f32_16x16x32_bf16 v[12:15], v[92:95], v[72:75], v[12:15]
    ds_read_b64_tr_b16 v[120:121], v235 offset:8192
    v_mfma_f32_16x16x32_bf16 v[16:19], v[96:99], v[72:75], v[16:19]
    ds_read_b64_tr_b16 v[122:123], v235 offset:12288
    v_mfma_f32_16x16x32_bf16 v[20:23], v[100:103], v[72:75], v[20:23]
    ds_read_b64_tr_b16 v[124:125], v236 offset:8192
    v_mfma_f32_16x16x32_bf16 v[24:27], v[88:91], v[76:79], v[24:27]
    ds_read_b64_tr_b16 v[126:127], v236 offset:12288
    v_mfma_f32_16x16x32_bf16 v[28:31], v[92:95], v[76:79], v[28:31]
    ds_read_b128 v[108:111], v232 offset:3072
    v_mfma_f32_16x16x32_bf16 v[32:35], v[96:99], v[76:79], v[32:35]
    ds_read_b64_tr_b16 v[128:129], v237 offset:8192
    v_mfma_f32_16x16x32_bf16 v[36:39], v[100:103], v[76:79], v[36:39]
    ds_read_b64_tr_b16 v[130:131], v237 offset:12288
    v_mfma_f32_16x16x32_bf16 v[40:43], v[88:91], v[80:83], v[40:43]
    s_add_u32 s54, s62, 18
M_P_loop5:
    ds_read_b64_tr_b16 v[132:133], v238 offset:8192
    v_mfma_f32_16x16x32_bf16 v[44:47], v[92:95], v[80:83], v[44:47]
    ds_read_b64_tr_b16 v[134:135], v238 offset:12288
    v_mfma_f32_16x16x32_bf16 v[48:51], v[96:99], v[80:83], v[48:51]
    ds_read_b128 v[112:115], v232 offset:5120
    v_mfma_f32_16x16x32_bf16 v[52:55], v[100:103], v[80:83], v[52:55]
    ds_read_b128 v[116:119], v232 offset:7168
    v_mfma_f32_16x16x32_bf16 v[56:59], v[88:91], v[84:87], v[56:59]
    v_add_u32 v232, s52, v233
    v_add_u32 v235, s52, v239
    v_mfma_f32_16x16x32_bf16 v[60:63], v[92:95], v[84:87], v[60:63]
    v_add_u32 v236, s52, v240
    v_mfma_f32_16x16x32_bf16 v[64:67], v[96:99], v[84:87], v[64:67]
    v_add_u32 v237, s52, v241
    v_mfma_f32_16x16x32_bf16 v[68:71], v[100:103], v[84:87], v[68:71]
    v_add_u32 v238, s52, v242
    s_waitcnt lgkmcnt(0)
    v_mfma_f32_16x16x32_bf16 v[8:11], v[120:123], v[104:107], v[8:11]
    s_barrier
    v_mfma_f32_16x16x32_bf16 v[12:15], v[124:127], v[104:107], v[12:15]
    ds_read_b128 v[72:75], v232 offset:0
    ds_read_b64_tr_b16 v[88:89], v235 offset:0
    v_mfma_f32_16x16x32_bf16 v[16:19], v[128:131], v[104:107], v[16:19]
    ds_read_b64_tr_b16 v[90:91], v235 offset:4096
    v_mfma_f32_16x16x32_bf16 v[20:23], v[132:135], v[104:107], v[20:23]
    ds_read_b64_tr_b16 v[92:93], v236 offset:0
    v_mfma_f32_16x16x32_bf16 v[24:27], v[120:123], v[108:111], v[24:27]
    ds_read_b64_tr_b16 v[94:95], v236 offset:4096
    v_mfma_f32_16x16x32_bf16 v[28:31], v[124:127], v[108:111], v[28:31]
    ds_read_b128 v[76:79], v232 offset:2048
    v_mfma_f32_16x16x32_bf16 v[32:35], v[128:131], v[108:111], v[32:35]
    ds_read_b64_tr_b16 v[96:97], v237 offset:0
    v_mfma_f32_16x16x32_bf16 v[36:39], v[132:135], v[108:111], v[36:39]
    ds_read_b64_tr_b16 v[98:99], v237 offset:4096
    v_mfma_f32_16x16x32_bf16 v[40:43], v[120:123], v[112:115], v[40:43]
    ds_read_b64_tr_b16 v[100:101], v238 offset:0
    v_mfma_f32_16x16x32_bf16 v[44:47], v[124:127], v[112:115], v[44:47]
    ds_read_b64_tr_b16 v[102:103], v238 offset:4096
    v_mfma_f32_16x16x32_bf16 v[48:51], v[128:131], v[112:115], v[48:51]
    ds_read_b128 v[80:83], v232 offset:4096
    v_mfma_f32_16x16x32_bf16 v[52:55], v[132:135], v[112:115], v[52:55]
    ds_read_b128 v[84:87], v232 offset:6144
    v_mfma_f32_16x16x32_bf16 v[56:59], v[120:123], v[116:119], v[56:59]
    v_mfma_f32_16x16x32_bf16 v[60:63], v[124:127], v[116:119], v[60:63]
    v_mfma_f32_16x16x32_bf16 v[64:67], v[128:131], v[116:119], v[64:67]
    s_add_u32 s52, s52, 32768
    s_cmp_ge_u32 s52, 163840
    s_cselect_b32 s52, 0, s52
    v_mfma_f32_16x16x32_bf16 v[68:71], v[132:135], v[116:119], v[68:71]
    s_waitcnt lgkmcnt(0)
    v_mfma_f32_16x16x32_bf16 v[8:11], v[88:91], v[72:75], v[8:11]
    ds_read_b128 v[104:107], v232 offset:1024
    v_mfma_f32_16x16x32_bf16 v[12:15], v[92:95], v[72:75], v[12:15]
    ds_read_b64_tr_b16 v[120:121], v235 offset:8192
    v_mfma_f32_16x16x32_bf16 v[16:19], v[96:99], v[72:75], v[16:19]
    ds_read_b64_tr_b16 v[122:123], v235 offset:12288
    v_mfma_f32_16x16x32_bf16 v[20:23], v[100:103], v[72:75], v[20:23]
    ds_read_b64_tr_b16 v[124:125], v236 offset:8192
    v_mfma_f32_16x16x32_bf16 v[24:27], v[88:91], v[76:79], v[24:27]
    ds_read_b64_tr_b16 v[126:127], v236 offset:12288
    v_mfma_f32_16x16x32_bf16 v[28:31], v[92:95], v[76:79], v[28:31]
    ds_read_b128 v[108:111], v232 offset:3072
    v_mfma_f32_16x16x32_bf16 v[32:35], v[96:99], v[76:79], v[32:35]
    ds_read_b64_tr_b16 v[128:129], v237 offset:8192
    v_mfma_f32_16x16x32_bf16 v[36:39], v[100:103], v[76:79], v[36:39]
    s_sub_u32 s54, s54, 1
    ds_read_b64_tr_b16 v[130:131], v237 offset:12288
    v_mfma_f32_16x16x32_bf16 v[40:43], v[88:91], v[80:83], v[40:43]
    s_cbranch_scc0 M_P_loop5
    ds_read_b64_tr_b16 v[132:133], v238 offset:8192
    v_mfma_f32_16x16x32_bf16 v[44:47], v[92:95], v[80:83], v[44:47]
    ds_read_b64_tr_b16 v[134:135], v238 offset:12288
    v_mfma_f32_16x16x32_bf16 v[48:51], v[96:99], v[80:83], v[48:51]
    ds_read_b128 v[112:115], v232 offset:5120
    v_mfma_f32_16x16x32_bf16 v[52:55], v[100:103], v[80:83], v[52:55]
    ds_read_b128 v[116:119], v232 offset:7168
    v_mfma_f32_16x16x32_bf16 v[56:59], v[88:91], v[84:87], v[56:59]
    v_add_u32 v232, s52, v233
    v_add_u32 v235, s52, v239
    v_mfma_f32_16x16x32_bf16 v[60:63], v[92:95], v[84:87], v[60:63]
    v_add_u32 v236, s52, v240
    v_mfma_f32_16x16x32_bf16 v[64:67], v[96:99], v[84:87], v[64:67]
    v_add_u32 v237, s52, v241
    v_mfma_f32_16x16x32_bf16 v[68:71], v[100:103], v[84:87], v[68:71]
    v_add_u32 v238, s52, v242
    s_waitcnt lgkmcnt(0)
    v_mfma_f32_16x16x32_bf16 v[8:11], v[120:123], v[104:107], v[8:11]
    s_barrier
    v_mfma_f32_16x16x32_bf16 v[12:15], v[124:127], v[104:107], v[12:15]
    ds_read_b128 v[72:75], v232 offset:0
    ds_read_b64_tr_b16 v[88:89], v235 offset:0
    v_mfma_f32_16x16x32_bf16 v[16:19], v[128:131], v[104:107], v[16:19]
    ds_read_b64_tr_b16 v[90:91], v235 offset:4096
    v_mfma_f32_16x16x32_bf16 v[20:23], v[132:135], v[104:107], v[20:23]
    ds_read_b64_tr_b16 v[92:93], v236 offset:0
    v_mfma_f32_16x16x32_bf16 v[24:27], v[120:123], v[108:111], v[24:27]
    ds_read_b64_tr_b16 v[94:95], v236 offset:4096
    v_mfma_f32_16x16x32_bf16 v[28:31], v[124:127], v[108:111], v[28:31]
    ds_read_b128 v[76:79], v232 offset:2048
    v_mfma_f32_16x16x32_bf16 v[32:35], v[128:131], v[108:111], v[32:35]
    ds_read_b64_tr_b16 v[96:97], v237 offset:0
    v_mfma_f32_16x16x32_bf16 v[36:39], v[132:135], v[108:111], v[36:39]
    ds_read_b64_tr_b16 v[98:99], v237 offset:4096
    v_mfma_f32_16x16x32_bf16 v[40:43], v[120:123], v[112:115], v[40:43]
    ds_read_b64_tr_b16 v[100:101], v238 offset:0
    v_mfma_f32_16x16x32_bf16 v[44:47], v[124:127], v[112:115], v[44:47]
    ds_read_b64_tr_b16 v[102:103], v238 offset:4096
    v_mfma_f32_16x16x32_bf16 v[48:51], v[128:131], v[112:115], v[48:51]
    ds_read_b128 v[80:83], v232 offset:4096
    v_mfma_f32_16x16x32_bf16 v[52:55], v[132:135], v[112:115], v[52:55]
    ds_read_b128 v[84:87], v232 offset:6144
    v_mfma_f32_16x16x32_bf16 v[56:59], v[120:123], v[116:119], v[56:59]
    v_mfma_f32_16x16x32_bf16 v[60:63], v[124:127], v[116:119], v[60:63]
    v_mfma_f32_16x16x32_bf16 v[64:67], v[128:131], v[116:119], v[64:67]
    s_add_u32 s52, s52, 32768
    s_cmp_ge_u32 s52, 163840
    s_cselect_b32 s52, 0, s52
    v_mfma_f32_16x16x32_bf16 v[68:71], v[132:135], v[116:119], v[68:71]
    s_waitcnt lgkmcnt(0)
    v_mfma_f32_16x16x32_bf16 v[8:11], v[88:91], v[72:75], v[8:11]
    ds_read_b128 v[104:107], v232 offset:1024
    v_mfma_f32_16x16x32_bf16 v[12:15], v[92:95], v[72:75], v[12:15]
    ds_read_b64_tr_b16 v[120:121], v235 offset:8192
    buffer_load_dwordx4 v[136:139], v188, s[28:31], s76 offen offset:0
    v_mfma_f32_16x16x32_bf16 v[16:19], v[96:99], v[72:75], v[16:19]
    ds_read_b64_tr_b16 v[122:123], v235 offset:12288
    v_mfma_f32_16x16x32_bf16 v[20:23], v[100:103], v[72:75], v[20:23]
    ds_read_b64_tr_b16 v[124:125], v236 offset:8192
    v_mfma_f32_16x16x32_bf16 v[24:27], v[88:91], v[76:79], v[24:27]
    ds_read_b64_tr_b16 v[126:127], v236 offset:12288
    v_mfma_f32_16x16x32_bf16 v[28:31], v[92:95], v[76:79], v[28:31]
    ds_read_b128 v[108:111], v232 offset:3072
    v_mfma_f32_16x16x32_bf16 v[32:35], v[96:99], v[76:79], v[32:35]
    ds_read_b64_tr_b16 v[128:129], v237 offset:8192
    buffer_load_dwordx4 v[140:143], v188, s[28:31], s76 offen offset:1024
    v_mfma_f32_16x16x32_bf16 v[36:39], v[100:103], v[76:79], v[36:39]
    ds_read_b64_tr_b16 v[130:131], v237 offset:12288
    v_mfma_f32_16x16x32_bf16 v[40:43], v[88:91], v[80:83], v[40:43]
    ds_read_b64_tr_b16 v[132:133], v238 offset:8192
    v_mfma_f32_16x16x32_bf16 v[44:47], v[92:95], v[80:83], v[44:47]
    ds_read_b64_tr_b16 v[134:135], v238 offset:12288
    v_mfma_f32_16x16x32_bf16 v[48:51], v[96:99], v[80:83], v[48:51]
    ds_read_b128 v[112:115], v232 offset:5120
    v_mfma_f32_16x16x32_bf16 v[52:55], v[100:103], v[80:83], v[52:55]
    ds_read_b128 v[116:119], v232 offset:7168
    buffer_load_dwordx4 v[144:147], v188, s[28:31], s77 offen offset:0
    v_mfma_f32_16x16x32_bf16 v[56:59], v[88:91], v[84:87], v[56:59]
    v_add_u32 v232, s52, v233
    v_add_u32 v235, s52, v239
    v_mfma_f32_16x16x32_bf16 v[60:63], v[92:95], v[84:87], v[60:63]
    v_add_u32 v236, s52, v240
    v_mfma_f32_16x16x32_bf16 v[64:67], v[96:99], v[84:87], v[64:67]
    v_add_u32 v237, s52, v241
    v_mfma_f32_16x16x32_bf16 v[68:71], v[100:103], v[84:87], v[68:71]
    v_add_u32 v238, s52, v242
    s_waitcnt lgkmcnt(0)
    v_mfma_f32_16x16x32_bf16 v[8:11], v[120:123], v[104:107], v[8:11]
    s_barrier
    v_mfma_f32_16x16x32_bf16 v[12:15], v[124:127], v[104:107], v[12:15]
    ds_read_b128 v[72:75], v232 offset:0
    ds_read_b64_tr_b16 v[88:89], v235 offset:0
    buffer_load_dwordx4 v[148:151], v188, s[28:31], s77 offen offset:1024
    v_mfma_f32_16x16x32_bf16 v[16:19], v[128:131], v[104:107], v[16:19]
    ds_read_b64_tr_b16 v[90:91], v235 offset:4096
    v_mfma_f32_16x16x32_bf16 v[20:23], v[132:135], v[104:107], v[20:23]
    ds_read_b64_tr_b16 v[92:93], v236 offset:0
    v_mfma_f32_16x16x32_bf16 v[24:27], v[120:123], v[108:111], v[24:27]
    ds_read_b64_tr_b16 v[94:95], v236 offset:4096
    v_mfma_f32_16x16x32_bf16 v[28:31], v[124:127], v[108:111], v[28:31]
    ds_read_b128 v[76:79], v232 offset:2048
    v_mfma_f32_16x16x32_bf16 v[32:35], v[128:131], v[108:111], v[32:35]
    ds_read_b64_tr_b16 v[96:97], v237 offset:0
    buffer_load_dwordx4 v[152:155], v188, s[28:31], s78 offen offset:0
    v_mfma_f32_16x16x32_bf16 v[36:39], v[132:135], v[108:111], v[36:39]
    ds_read_b64_tr_b16 v[98:99], v237 offset:4096
    v_mfma_f32_16x16x32_bf16 v[40:43], v[120:123], v[112:115], v[40:43]
    ds_read_b64_tr_b16 v[100:101], v238 offset:0
    v_mfma_f32_16x16x32_bf16 v[44:47], v[124:127], v[112:115], v[44:47]
    ds_read_b64_tr_b16 v[102:103], v238 offset:4096
    v_mfma_f32_16x16x32_bf16 v[48:51], v[128:131], v[112:115], v[48:51]
    ds_read_b128 v[80:83], v232 offset:4096
    v_mfma_f32_16x16x32_bf16 v[52:55], v[132:135], v[112:115], v[52:55]
    ds_read_b128 v[84:87], v232 offset:6144
    buffer_load_dwordx4 v[156:159], v188, s[28:31], s78 offen offset:1024
    v_mfma_f32_16x16x32_bf16 v[56:59], v[120:123], v[116:119], v[56:59]
    v_mfma_f32_16x16x32_bf16 v[60:63], v[124:127], v[116:119], v[60:63]
    v_mfma_f32_16x16x32_bf16 v[64:67], v[128:131], v[116:119], v[64:67]
    s_add_u32 s52, s52, 32768
    s_cmp_ge_u32 s52, 163840
    s_cselect_b32 s52, 0, s52
    v_mfma_f32_16x16x32_bf16 v[68:71], v[132:135], v[116:119], v[68:71]
    s_waitcnt lgkmcnt(0)
    v_mfma_f32_16x16x32_bf16 v[8:11], v[88:91], v[72:75], v[8:11]
    ds_read_b128 v[104:107], v232 offset:1024
    v_mfma_f32_16x16x32_bf16 v[12:15], v[92:95], v[72:75], v[12:15]
    ds_read_b64_tr_b16 v[120:121], v235 offset:8192
    buffer_load_dwordx4 v[160:163], v188, s[28:31], s79 offen offset:0
    v_mfma_f32_16x16x32_bf16 v[16:19], v[96:99], v[72:75], v[16:19]
    ds_read_b64_tr_b16 v[122:123], v235 offset:12288
    v_mfma_f32_16x16x32_bf16 v[20:23], v[100:103], v[72:75], v[20:23]
    ds_read_b64_tr_b16 v[124:125], v236 offset:8192
    v_mfma_f32_16x16x32_bf16 v[24:27], v[88:91], v[76:79], v[24:27]
    ds_read_b64_tr_b16 v[126:127], v236 offset:12288
    v_mfma_f32_16x16x32_bf16 v[28:31], v[92:95], v[76:79], v[28:31]
    ds_read_b128 v[108:111], v232 offset:3072
    v_mfma_f32_16x16x32_bf16 v[32:35], v[96:99], v[76:79], v[32:35]
    ds_read_b64_tr_b16 v[128:129], v237 offset:8192
    buffer_load_dwordx4 v[164:167], v188, s[28:31], s79 offen offset:1024
    v_mfma_f32_16x16x32_bf16 v[36:39], v[100:103], v[76:79], v[36:39]
    ds_read_b64_tr_b16 v[130:131], v237 offset:12288
    v_mfma_f32_16x16x32_bf16 v[40:43], v[88:91], v[80:83], v[40:43]
    ds_read_b64_tr_b16 v[132:133], v238 offset:8192
    v_mfma_f32_16x16x32_bf16 v[44:47], v[92:95], v[80:83], v[44:47]
    ds_read_b64_tr_b16 v[134:135], v238 offset:12288
    v_mfma_f32_16x16x32_bf16 v[48:51], v[96:99], v[80:83], v[48:51]
    ds_read_b128 v[112:115], v232 offset:5120
    v_mfma_f32_16x16x32_bf16 v[52:55], v[100:103], v[80:83], v[52:55]
    ds_read_b128 v[116:119], v232 offset:7168
    buffer_load_dwordx4 v[168:171], v185, s[28:31], 0 offen offset:0
    v_mfma_f32_16x16x32_bf16 v[56:59], v[88:91], v[84:87], v[56:59]
    v_add_u32 v232, s52, v233
    v_add_u32 v235, s52, v239
    v_mfma_f32_16x16x32_bf16 v[60:63], v[92:95], v[84:87], v[60:63]
    v_add_u32 v236, s52, v240
    v_mfma_f32_16x16x32_bf16 v[64:67], v[96:99], v[84:87], v[64:67]
    v_add_u32 v237, s52, v241
    v_mfma_f32_16x16x32_bf16 v[68:71], v[100:103], v[84:87], v[68:71]
    v_add_u32 v238, s52, v242
    s_waitcnt lgkmcnt(0)
    v_mfma_f32_16x16x32_bf16 v[8:11], v[120:123], v[104:107], v[8:11]
    s_barrier
    v_mfma_f32_16x16x32_bf16 v[12:15], v[124:127], v[104:107], v[12:15]
    ds_read_b128 v[72:75], v232 offset:0
    ds_read_b64_tr_b16 v[88:89], v235 offset:0
    buffer_load_dwordx4 v[172:175], v185, s[28:31], 0 offen offset:64
    v_mfma_f32_16x16x32_bf16 v[16:19], v[128:131], v[104:107], v[16:19]
    ds_read_b64_tr_b16 v[90:91], v235 offset:4096
    v_mfma_f32_16x16x32_bf16 v[20:23], v[132:135], v[104:107], v[20:23]
    ds_read_b64_tr_b16 v[92:93], v236 offset:0
    v_mfma_f32_16x16x32_bf16 v[24:27], v[120:123], v[108:111], v[24:27]
    ds_read_b64_tr_b16 v[94:95], v236 offset:4096
    v_mfma_f32_16x16x32_bf16 v[28:31], v[124:127], v[108:111], v[28:31]
    ds_read_b128 v[76:79], v232 offset:2048
    v_mfma_f32_16x16x32_bf16 v[32:35], v[128:131], v[108:111], v[32:35]
    ds_read_b64_tr_b16 v[96:97], v237 offset:0
    buffer_load_dwordx4 v[176:179], v185, s[28:31], 0 offen offset:128
    v_mfma_f32_16x16x32_bf16 v[36:39], v[132:135], v[108:111], v[36:39]
    ds_read_b64_tr_b16 v[98:99], v237 offset:4096
    v_mfma_f32_16x16x32_bf16 v[40:43], v[120:123], v[112:115], v[40:43]
    ds_read_b64_tr_b16 v[100:101], v238 offset:0
    v_mfma_f32_16x16x32_bf16 v[44:47], v[124:127], v[112:115], v[44:47]
    ds_read_b64_tr_b16 v[102:103], v238 offset:4096
    v_mfma_f32_16x16x32_bf16 v[48:51], v[128:131], v[112:115], v[48:51]
    ds_read_b128 v[80:83], v232 offset:4096
    v_mfma_f32_16x16x32_bf16 v[52:55], v[132:135], v[112:115], v[52:55]
    ds_read_b128 v[84:87], v232 offset:6144
    buffer_load_dwordx4 v[180:183], v185, s[28:31], 0 offen offset:192
    v_mfma_f32_16x16x32_bf16 v[56:59], v[120:123], v[116:119], v[56:59]
    v_mfma_f32_16x16x32_bf16 v[60:63], v[124:127], v[116:119], v[60:63]
    v_mfma_f32_16x16x32_bf16 v[64:67], v[128:131], v[116:119], v[64:67]
    s_add_u32 s52, s52, 32768
    s_cmp_ge_u32 s52, 163840
    s_cselect_b32 s52, 0, s52
    v_mfma_f32_16x16x32_bf16 v[68:71], v[132:135], v[116:119], v[68:71]
    s_waitcnt lgkmcnt(0)
    v_mfma_f32_16x16x32_bf16 v[8:11], v[88:91], v[72:75], v[8:11]
    ds_read_b128 v[104:107], v232 offset:1024
    v_mfma_f32_16x16x32_bf16 v[12:15], v[92:95], v[72:75], v[12:15]
    ds_read_b64_tr_b16 v[120:121], v235 offset:8192
    buffer_load_dword v245, v187, s[28:31], 0 offen sc1
    v_mfma_f32_16x16x32_bf16 v[16:19], v[96:99], v[72:75], v[16:19]
    ds_read_b64_tr_b16 v[122:123], v235 offset:12288
    v_mfma_f32_16x16x32_bf16 v[20:23], v[100:103], v[72:75], v[20:23]
    ds_read_b64_tr_b16 v[124:125], v236 offset:8192
    v_mfma_f32_16x16x32_bf16 v[24:27], v[88:91], v[76:79], v[24:27]
    ds_read_b64_tr_b16 v[126:127], v236 offset:12288
    v_mfma_f32_16x16x32_bf16 v[28:31], v[92:95], v[76:79], v[28:31]
    ds_read_b128 v[108:111], v232 offset:3072
    v_mfma_f32_16x16x32_bf16 v[32:35], v[96:99], v[76:79], v[32:35]
    ds_read_b64_tr_b16 v[128:129], v237 offset:8192
    v_mfma_f32_16x16x32_bf16 v[36:39], v[100:103], v[76:79], v[36:39]
    ds_read_b64_tr_b16 v[130:131], v237 offset:12288
    v_mfma_f32_16x16x32_bf16 v[40:43], v[88:91], v[80:83], v[40:43]
    ds_read_b64_tr_b16 v[132:133], v238 offset:8192
    v_mfma_f32_16x16x32_bf16 v[44:47], v[92:95], v[80:83], v[44:47]
    ds_read_b64_tr_b16 v[134:135], v238 offset:12288
    v_mfma_f32_16x16x32_bf16 v[48:51], v[96:99], v[80:83], v[48:51]
    ds_read_b128 v[112:115], v232 offset:5120
    v_mfma_f32_16x16x32_bf16 v[52:55], v[100:103], v[80:83], v[52:55]
    ds_read_b128 v[116:119], v232 offset:7168
    v_mfma_f32_16x16x32_bf16 v[56:59], v[88:91], v[84:87], v[56:59]
    v_mfma_f32_16x16x32_bf16 v[60:63], v[92:95], v[84:87], v[60:63]
    v_mfma_f32_16x16x32_bf16 v[64:67], v[96:99], v[84:87], v[64:67]
    v_mfma_f32_16x16x32_bf16 v[68:71], v[100:103], v[84:87], v[68:71]
    s_waitcnt lgkmcnt(0)
    v_mfma_f32_16x16x32_bf16 v[8:11], v[120:123], v[104:107], v[8:11]
    v_mfma_f32_16x16x32_bf16 v[12:15], v[124:127], v[104:107], v[12:15]
    v_mfma_f32_16x16x32_bf16 v[16:19], v[128:131], v[104:107], v[16:19]
    v_mfma_f32_16x16x32_bf16 v[20:23], v[132:135], v[104:107], v[20:23]
    v_mfma_f32_16x16x32_bf16 v[24:27], v[120:123], v[108:111], v[24:27]
    v_mfma_f32_16x16x32_bf16 v[28:31], v[124:127], v[108:111], v[28:31]
    v_mfma_f32_16x16x32_bf16 v[32:35], v[128:131], v[108:111], v[32:35]
    v_mfma_f32_16x16x32_bf16 v[36:39], v[132:135], v[108:111], v[36:39]
    v_mfma_f32_16x16x32_bf16 v[40:43], v[120:123], v[112:115], v[40:43]
    v_mfma_f32_16x16x32_bf16 v[44:47], v[124:127], v[112:115], v[44:47]
    v_mfma_f32_16x16x32_bf16 v[48:51], v[128:131], v[112:115], v[48:51]
    v_mfma_f32_16x16x32_bf16 v[52:55], v[132:135], v[112:115], v[52:55]
    v_mfma_f32_16x16x32_bf16 v[56:59], v[120:123], v[116:119], v[56:59]
    v_mfma_f32_16x16x32_bf16 v[60:63], v[124:127], v[116:119], v[60:63]
    v_mfma_f32_16x16x32_bf16 v[64:67], v[128:131], v[116:119], v[64:67]
    v_mfma_f32_16x16x32_bf16 v[68:71], v[132:135], v[116:119], v[68:71]
    s_mov_b32 s3, 0x40000
    s_cmp_lg_u32 s49, 0
    s_cbranch_scc1 M_A
    v_cvt_pk_bf16_f32 v72, v8, v9
    v_cvt_pk_bf16_f32 v73, v10, v11
    v_cvt_pk_bf16_f32 v74, v12, v13
    v_cvt_pk_bf16_f32 v75, v14, v15
    buffer_store_dwordx4 v[72:75], v186, s[28:31], s80 offen offset:0 sc1
    v_cvt_pk_bf16_f32 v76, v16, v17
    v_cvt_pk_bf16_f32 v77, v18, v19
    v_cvt_pk_bf16_f32 v78, v20, v21
    v_cvt_pk_bf16_f32 v79, v22, v23
    buffer_store_dwordx4 v[76:79], v186, s[28:31], s80 offen offset:1024 sc1
    v_cvt_pk_bf16_f32 v80, v24, v25
    v_cvt_pk_bf16_f32 v81, v26, v27
    v_cvt_pk_bf16_f32 v82, v28, v29
    v_cvt_pk_bf16_f32 v83, v30, v31
    buffer_store_dwordx4 v[80:83], v186, s[28:31], s80 offen offset:2048 sc1
    v_cvt_pk_bf16_f32 v84, v32, v33
    v_cvt_pk_bf16_f32 v85, v34, v35
    v_cvt_pk_bf16_f32 v86, v36, v37
    v_cvt_pk_bf16_f32 v87, v38, v39
    buffer_store_dwordx4 v[84:87], v186, s[28:31], s80 offen offset:3072 sc1
    v_cvt_pk_bf16_f32 v88, v40, v41
    v_cvt_pk_bf16_f32 v89, v42, v43
    v_cvt_pk_bf16_f32 v90, v44, v45
    v_cvt_pk_bf16_f32 v91, v46, v47
    buffer_store_dwordx4 v[88:91], v186, s[28:31], s81 offen offset:0 sc1
    v_cvt_pk_bf16_f32 v92, v48, v49
    v_cvt_pk_bf16_f32 v93, v50, v51
    v_cvt_pk_bf16_f32 v94, v52, v53
    v_cvt_pk_bf16_f32 v95, v54, v55
    buffer_store_dwordx4 v[92:95], v186, s[28:31], s81 offen offset:1024 sc1
    v_cvt_pk_bf16_f32 v96, v56, v57
    v_cvt_pk_bf16_f32 v97, v58, v59
    v_cvt_pk_bf16_f32 v98, v60, v61
    v_cvt_pk_bf16_f32 v99, v62, v63
    buffer_store_dwordx4 v[96:99], v186, s[28:31], s81 offen offset:2048 sc1
    v_cvt_pk_bf16_f32 v100, v64, v65
    v_cvt_pk_bf16_f32 v101, v66, v67
    v_cvt_pk_bf16_f32 v102, v68, v69
    v_cvt_pk_bf16_f32 v103, v70, v71
    buffer_store_dwordx4 v[100:103], v186, s[28:31], s81 offen offset:3072 sc1
    v_mov_b32 v2, s0
    s_waitcnt vmcnt(0)
    s_mov_b64 exec, 1
    buffer_store_dword v2, v187, s[28:31], 0 offen sc1
    s_branch M_fin
M_poll:
    s_sub_u32 s3, s3, 1
    s_cbranch_scc1 M_got
    s_sleep 1
    buffer_load_dword v245, v187, s[28:31], 0 offen sc1
M_A:
    s_waitcnt vmcnt(0)
    v_readfirstlane_b32 s64, v245
    s_nop 3
    s_cmp_lg_u32 s64, s0
    s_cbranch_scc1 M_poll
M_got:
    s_nop 7
    buffer_load_dwordx4 v[72:75], v186, s[28:31], s80 offen offset:0 sc1
    buffer_load_dwordx4 v[76:79], v186, s[28:31], s80 offen offset:1024 sc1
    buffer_load_dwordx4 v[80:83], v186, s[28:31], s80 offen offset:2048 sc1
    buffer_load_dwordx4 v[84:87], v186, s[28:31], s80 offen offset:3072 sc1
    buffer_load_dwordx4 v[88:91], v186, s[28:31], s81 offen offset:0 sc1
    buffer_load_dwordx4 v[92:95], v186, s[28:31], s81 offen offset:1024 sc1
    buffer_load_dwordx4 v[96:99], v186, s[28:31], s81 offen offset:2048 sc1
    buffer_load_dwordx4 v[100:103], v186, s[28:31], s81 offen offset:3072 sc1
    v_lshlrev_b32 v200, 16, v136
    v_and_b32 v201, 0xffff0000, v136
    v_lshlrev_b32 v202, 16, v137
    v_and_b32 v203, 0xffff0000, v137
    v_lshlrev_b32 v204, 16, v138
    v_and_b32 v205, 0xffff0000, v138
    v_lshlrev_b32 v206, 16, v139
    v_and_b32 v207, 0xffff0000, v139
    s_waitcnt vmcnt(7)
    v_lshlrev_b32 v104, 16, v72
    v_and_b32 v105, 0xffff0000, v72
    v_lshlrev_b32 v106, 16, v73
    v_and_b32 v107, 0xffff0000, v73
    v_lshlrev_b32 v108, 16, v74
    v_and_b32 v109, 0xffff0000, v74
    v_lshlrev_b32 v110, 16, v75
    v_and_b32 v111, 0xffff0000, v75
    v_pk_add_f32 v[8:9], v[8:9], v[104:105]
    v_pk_add_f32 v[10:11], v[10:11], v[106:107]
    v_pk_add_f32 v[12:13], v[12:13], v[108:109]
    v_pk_add_f32 v[14:15], v[14:15], v[110:111]
    v_pk_fma_f32 v[200:201], v[8:9], v[168:169], v[200:201]
    v_pk_fma_f32 v[202:203], v[10:11], v[170:171], v[202:203]
    v_pk_fma_f32 v[204:205], v[12:13], v[172:173], v[204:205]
    v_pk_fma_f32 v[206:207], v[14:15], v[174:175], v[206:207]
    v_cvt_pk_bf16_f32 v136, v200, v201
    v_cvt_pk_bf16_f32 v137, v202, v203
    v_cvt_pk_bf16_f32 v138, v204, v205
    v_cvt_pk_bf16_f32 v139, v206, v207
    s_nop 0
    v_permlane16_swap_b32 v136, v138
    v_permlane16_swap_b32 v137, v139
    buffer_store_dwordx4 v[136:139], v184, s[40:43], s72 offen offset:0
    v_lshlrev_b32 v208, 16, v140
    v_and_b32 v209, 0xffff0000, v140
    v_lshlrev_b32 v210, 16, v141
    v_and_b32 v211, 0xffff0000, v141
    v_lshlrev_b32 v212, 16, v142
    v_and_b32 v213, 0xffff0000, v142
    v_lshlrev_b32 v214, 16, v143
    v_and_b32 v215, 0xffff0000, v143
    s_waitcnt vmcnt(7)
    v_lshlrev_b32 v112, 16, v76
    v_and_b32 v113, 0xffff0000, v76
    v_lshlrev_b32 v114, 16, v77
    v_and_b32 v115, 0xffff0000, v77
    v_lshlrev_b32 v116, 16, v78
    v_and_b32 v117, 0xffff0000, v78
    v_lshlrev_b32 v118, 16, v79
    v_and_b32 v119, 0xffff0000, v79
    v_pk_add_f32 v[16:17], v[16:17], v[112:113]
    v_pk_add_f32 v[18:19], v[18:19], v[114:115]
    v_pk_add_f32 v[20:21], v[20:21], v[116:117]
    v_pk_add_f32 v[22:23], v[22:23], v[118:119]
    v_pk_fma_f32 v[208:209], v[16:17], v[176:177], v[208:209]
    v_pk_fma_f32 v[210:211], v[18:19], v[178:179], v[210:211]
    v_pk_fma_f32 v[212:213], v[20:21], v[180:181], v[212:213]
    v_pk_fma_f32 v[214:215], v[22:23], v[182:183], v[214:215]
    v_cvt_pk_bf16_f32 v140, v208, v209
    v_cvt_pk_bf16_f32 v141, v210, v211
    v_cvt_pk_bf16_f32 v142, v212, v213
    v_cvt_pk_bf16_f32 v143, v214, v215
    s_nop 0
    v_permlane16_swap_b32 v140, v142
    v_permlane16_swap_b32 v141, v143
    buffer_store_dwordx4 v[140:143], v184, s[40:43], s72 offen offset:64
    v_lshlrev_b32 v200, 16, v144
    v_and_b32 v201, 0xffff0000, v144
    v_lshlrev_b32 v202, 16, v145
    v_and_b32 v203, 0xffff0000, v145
    v_lshlrev_b32 v204, 16, v146
    v_and_b32 v205, 0xffff0000, v146
    v_lshlrev_b32 v206, 16, v147
    v_and_b32 v207, 0xffff0000, v147
    s_waitcnt vmcnt(7)
    v_lshlrev_b32 v120, 16, v80
    v_and_b32 v121, 0xffff0000, v80
    v_lshlrev_b32 v122, 16, v81
    v_and_b32 v123, 0xffff0000, v81
    v_lshlrev_b32 v124, 16, v82
    v_and_b32 v125, 0xffff0000, v82
    v_lshlrev_b32 v126, 16, v83
    v_and_b32 v127, 0xffff0000, v83
    v_pk_add_f32 v[24:25], v[24:25], v[120:121]
    v_pk_add_f32 v[26:27], v[26:27], v[122:123]
    v_pk_add_f32 v[28:29], v[28:29], v[124:125]
    v_pk_add_f32 v[30:31], v[30:31], v[126:127]
    v_pk_fma_f32 v[200:201], v[24:25], v[168:169], v[200:201]
    v_pk_fma_f32 v[202:203], v[26:27], v[170:171], v[202:203]
    v_pk_fma_f32 v[204:205], v[28:29], v[172:173], v[204:205]
    v_pk_fma_f32 v[206:207], v[30:31], v[174:175], v[206:207]
    v_cvt_pk_bf16_f32 v144, v200, v201
    v_cvt_pk_bf16_f32 v145, v202, v203
    v_cvt_pk_bf16_f32 v146, v204, v205
    v_cvt_pk_bf16_f32 v147, v206, v207
    s_nop 0
    v_permlane16_swap_b32 v144, v146
    v_permlane16_swap_b32 v145, v147
    buffer_store_dwordx4 v[144:147], v184, s[40:43], s73 offen offset:0
    v_lshlrev_b32 v208, 16, v148
    v_and_b32 v209, 0xffff0000, v148
    v_lshlrev_b32 v210, 16, v149
    v_and_b32 v211, 0xffff0000, v149
    v_lshlrev_b32 v212, 16, v150
    v_and_b32 v213, 0xffff0000, v150
    v_lshlrev_b32 v214, 16, v151
    v_and_b32 v215, 0xffff0000, v151
    s_waitcnt vmcnt(7)
    v_lshlrev_b32 v128, 16, v84
    v_and_b32 v129, 0xffff0000, v84
    v_lshlrev_b32 v130, 16, v85
    v_and_b32 v131, 0xffff0000, v85
    v_lshlrev_b32 v132, 16, v86
    v_and_b32 v133, 0xffff0000, v86
    v_lshlrev_b32 v134, 16, v87
    v_and_b32 v135, 0xffff0000, v87
    v_pk_add_f32 v[32:33], v[32:33], v[128:129]
    v_pk_add_f32 v[34:35], v[34:35], v[130:131]
    v_pk_add_f32 v[36:37], v[36:37], v[132:133]
    v_pk_add_f32 v[38:39], v[38:39], v[134:135]
    v_pk_fma_f32 v[208:209], v[32:33], v[176:177], v[208:209]
    v_pk_fma_f32 v[210:211], v[34:35], v[178:179], v[210:211]
    v_pk_fma_f32 v[212:213], v[36:37], v[180:181], v[212:213]
    v_pk_fma_f32 v[214:215], v[38:39], v[182:183], v[214:215]
    v_cvt_pk_bf16_f32 v148, v208, v209
    v_cvt_pk_bf16_f32 v149, v210, v211
    v_cvt_pk_bf16_f32 v150, v212, v213
    v_cvt_pk_bf16_f32 v151, v214, v215
    s_nop 0
    v_permlane16_swap_b32 v148, v150
    v_permlane16_swap_b32 v149, v151
    buffer_store_dwordx4 v[148:151], v184, s[40:43], s73 offen offset:64
    v_lshlrev_b32 v200, 16, v152
    v_and_b32 v201, 0xffff0000, v152
    v_lshlrev_b32 v202, 16, v153
    v_and_b32 v203, 0xffff0000, v153
    v_lshlrev_b32 v204, 16, v154
    v_and_b32 v205, 0xffff0000, v154
    v_lshlrev_b32 v206, 16, v155
    v_and_b32 v207, 0xffff0000, v155
    s_waitcnt vmcnt(7)
    v_lshlrev_b32 v104, 16, v88
    v_and_b32 v105, 0xffff0000, v88
    v_lshlrev_b32 v106, 16, v89
    v_and_b32 v107, 0xffff0000, v89
    v_lshlrev_b32 v108, 16, v90
    v_and_b32 v109, 0xffff0000, v90
    v_lshlrev_b32 v110, 16, v91
    v_and_b32 v111, 0xffff0000, v91
    v_pk_add_f32 v[40:41], v[40:41], v[104:105]
    v_pk_add_f32 v[42:43], v[42:43], v[106:107]
    v_pk_add_f32 v[44:45], v[44:45], v[108:109]
    v_pk_add_f32 v[46:47], v[46:47], v[110:111]
    v_pk_fma_f32 v[200:201], v[40:41], v[168:169], v[200:201]
    v_pk_fma_f32 v[202:203], v[42:43], v[170:171], v[202:203]
    v_pk_fma_f32 v[204:205], v[44:45], v[172:173], v[204:205]
    v_pk_fma_f32 v[206:207], v[46:47], v[174:175], v[206:207]
    v_cvt_pk_bf16_f32 v152, v200, v201
    v_cvt_pk_bf16_f32 v153, v202, v203
    v_cvt_pk_bf16_f32 v154, v204, v205
    v_cvt_pk_bf16_f32 v155, v206, v207
    s_nop 0
    v_permlane16_swap_b32 v152, v154
    v_permlane16_swap_b32 v153, v155
    buffer_store_dwordx4 v[152:155], v184, s[40:43], s74 offen offset:0
    v_lshlrev_b32 v208, 16, v156
    v_and_b32 v209, 0xffff0000, v156
    v_lshlrev_b32 v210, 16, v157
    v_and_b32 v211, 0xffff0000, v157
    v_lshlrev_b32 v212, 16, v158
    v_and_b32 v213, 0xffff0000, v158
    v_lshlrev_b32 v214, 16, v159
    v_and_b32 v215, 0xffff0000, v159
    s_waitcnt vmcnt(7)
    v_lshlrev_b32 v112, 16, v92
    v_and_b32 v113, 0xffff0000, v92
    v_lshlrev_b32 v114, 16, v93
    v_and_b32 v115, 0xffff0000, v93
    v_lshlrev_b32 v116, 16, v94
    v_and_b32 v117, 0xffff0000, v94
    v_lshlrev_b32 v118, 16, v95
    v_and_b32 v119, 0xffff0000, v95
    v_pk_add_f32 v[48:49], v[48:49], v[112:113]
    v_pk_add_f32 v[50:51], v[50:51], v[114:115]
    v_pk_add_f32 v[52:53], v[52:53], v[116:117]
    v_pk_add_f32 v[54:55], v[54:55], v[118:119]
    v_pk_fma_f32 v[208:209], v[48:49], v[176:177], v[208:209]
    v_pk_fma_f32 v[210:211], v[50:51], v[178:179], v[210:211]
    v_pk_fma_f32 v[212:213], v[52:53], v[180:181], v[212:213]
    v_pk_fma_f32 v[214:215], v[54:55], v[182:183], v[214:215]
    v_cvt_pk_bf16_f32 v156, v208, v209
    v_cvt_pk_bf16_f32 v157, v210, v211
    v_cvt_pk_bf16_f32 v158, v212, v213
    v_cvt_pk_bf16_f32 v159, v214, v215
    s_nop 0
    v_permlane16_swap_b32 v156, v158
    v_permlane16_swap_b32 v157, v159
    buffer_store_dwordx4 v[156:159], v184, s[40:43], s74 offen offset:64
    v_lshlrev_b32 v200, 16, v160
    v_and_b32 v201, 0xffff0000, v160
    v_lshlrev_b32 v202, 16, v161
    v_and_b32 v203, 0xffff0000, v161
    v_lshlrev_b32 v204, 16, v162
    v_and_b32 v205, 0xffff0000, v162
    v_lshlrev_b32 v206, 16, v163
    v_and_b32 v207, 0xffff0000, v163
    s_waitcnt vmcnt(7)
    v_lshlrev_b32 v120, 16, v96
    v_and_b32 v121, 0xffff0000, v96
    v_lshlrev_b32 v122, 16, v97
    v_and_b32 v123, 0xffff0000, v97
    v_lshlrev_b32 v124, 16, v98
    v_and_b32 v125, 0xffff0000, v98
    v_lshlrev_b32 v126, 16, v99
    v_and_b32 v127, 0xffff0000, v99
    v_pk_add_f32 v[56:57], v[56:57], v[120:121]
    v_pk_add_f32 v[58:59], v[58:59], v[122:123]
    v_pk_add_f32 v[60:61], v[60:61], v[124:125]
    v_pk_add_f32 v[62:63], v[62:63], v[126:127]
    v_pk_fma_f32 v[200:201], v[56:57], v[168:169], v[200:201]
    v_pk_fma_f32 v[202:203], v[58:59], v[170:171], v[202:203]
    v_pk_fma_f32 v[204:205], v[60:61], v[172:173], v[204:205]
    v_pk_fma_f32 v[206:207], v[62:63], v[174:175], v[206:207]
    v_cvt_pk_bf16_f32 v160, v200, v201
    v_cvt_pk_bf16_f32 v161, v202, v203
    v_cvt_pk_bf16_f32 v162, v204, v205
    v_cvt_pk_bf16_f32 v163, v206, v207
    s_nop 0
    v_permlane16_swap_b32 v160, v162
    v_permlane16_swap_b32 v161, v163
    buffer_store_dwordx4 v[160:163], v184, s[40:43], s75 offen offset:0
    v_lshlrev_b32 v208, 16, v164
    v_and_b32 v209, 0xffff0000, v164
    v_lshlrev_b32 v210, 16, v165
    v_and_b32 v211, 0xffff0000, v165
    v_lshlrev_b32 v212, 16, v166
    v_and_b32 v213, 0xffff0000, v166
    v_lshlrev_b32 v214, 16, v167
    v_and_b32 v215, 0xffff0000, v167
    s_waitcnt vmcnt(7)
    v_lshlrev_b32 v128, 16, v100
    v_and_b32 v129, 0xffff0000, v100
    v_lshlrev_b32 v130, 16, v101
    v_and_b32 v131, 0xffff0000, v101
    v_lshlrev_b32 v132, 16, v102
    v_and_b32 v133, 0xffff0000, v102
    v_lshlrev_b32 v134, 16, v103
    v_and_b32 v135, 0xffff0000, v103
    v_pk_add_f32 v[64:65], v[64:65], v[128:129]
    v_pk_add_f32 v[66:67], v[66:67], v[130:131]
    v_pk_add_f32 v[68:69], v[68:69], v[132:133]
    v_pk_add_f32 v[70:71], v[70:71], v[134:135]
    v_pk_fma_f32 v[208:209], v[64:65], v[176:177], v[208:209]
    v_pk_fma_f32 v[210:211], v[66:67], v[178:179], v[210:211]
    v_pk_fma_f32 v[212:213], v[68:69], v[180:181], v[212:213]
    v_pk_fma_f32 v[214:215], v[70:71], v[182:183], v[214:215]
    v_cvt_pk_bf16_f32 v164, v208, v209
    v_cvt_pk_bf16_f32 v165, v210, v211
    v_cvt_pk_bf16_f32 v166, v212, v213
    v_cvt_pk_bf16_f32 v167, v214, v215
    s_nop 0
    v_permlane16_swap_b32 v164, v166
    v_permlane16_swap_b32 v165, v167
    buffer_store_dwordx4 v[164:167], v184, s[40:43], s75 offen offset:64
    s_branch M_fin
M_Pidle:
    s_nop 7
    s_barrier
    s_lshl_b32 s70, s48, 12
    s_lshl_b32 s64, s47, 3
    s_lshl_b32 s65, s45, 2
    s_add_u32 s64, s64, s65
    s_mul_i32 s64, s64, 114688
    s_add_u32 s64, s64, s70
    s_lshl_b32 s65, s46, 11
    s_add_u32 s64, s64, s65
    s_add_u32 s64, s64, 0x1500000
    v_lshl_add_u32 v198, v1, 4, s64
    v_mul_f32 v24, v8, v24
    v_exp_f32 v216, -v8
    v_mul_f32 v25, v9, v25
    v_exp_f32 v217, -v9
    v_mul_f32 v26, v10, v26
    v_exp_f32 v218, -v10
    v_mul_f32 v27, v11, v27
    v_exp_f32 v219, -v11
    v_mul_f32 v28, v12, v28
    v_exp_f32 v220, -v12
    v_mul_f32 v29, v13, v29
    v_exp_f32 v221, -v13
    v_mul_f32 v30, v14, v30
    v_exp_f32 v222, -v14
    v_mul_f32 v31, v15, v31
    v_exp_f32 v223, -v15
    v_fma_f32 v216, v216, s67, s67
    v_fma_f32 v217, v217, s67, s67
    v_rcp_f32 v216, v216
    v_fma_f32 v218, v218, s67, s67
    v_rcp_f32 v217, v217
    v_fma_f32 v219, v219, s67, s67
    v_rcp_f32 v218, v218
    v_fma_f32 v220, v220, s67, s67
    v_rcp_f32 v219, v219
    v_fma_f32 v221, v221, s67, s67
    v_rcp_f32 v220, v220
    v_fma_f32 v222, v222, s67, s67
    v_rcp_f32 v221, v221
    v_fma_f32 v223, v223, s67, s67
    v_rcp_f32 v222, v222
    v_rcp_f32 v223, v223
    v_mul_f32 v24, v24, v216
    v_mul_f32 v25, v25, v217
    v_mul_f32 v26, v26, v218
    v_mul_f32 v27, v27, v219
    v_mul_f32 v28, v28, v220
    v_mul_f32 v29, v29, v221
    v_mul_f32 v30, v30, v222
    v_mul_f32 v31, v31, v223
    v_cvt_pk_bf16_f32 v200, v24, v25
    v_cvt_pk_bf16_f32 v201, v26, v27
    v_cvt_pk_bf16_f32 v202, v28, v29
    v_cvt_pk_bf16_f32 v203, v30, v31
    buffer_store_dwordx4 v[200:203], v198, s[28:31], 0 offen offset:0 sc1
    v_mul_f32 v32, v16, v32
    v_exp_f32 v224, -v16
    v_mul_f32 v33, v17, v33
    v_exp_f32 v225, -v17
    v_mul_f32 v34, v18, v34
    v_exp_f32 v226, -v18
    v_mul_f32 v35, v19, v35
    v_exp_f32 v227, -v19
    v_mul_f32 v36, v20, v36
    v_exp_f32 v228, -v20
    v_mul_f32 v37, v21, v37
    v_exp_f32 v229, -v21
    v_mul_f32 v38, v22, v38
    v_exp_f32 v230, -v22
    v_mul_f32 v39, v23, v39
    v_exp_f32 v231, -v23
    v_fma_f32 v224, v224, s67, s67
    v_fma_f32 v225, v225, s67, s67
    v_rcp_f32 v224, v224
    v_fma_f32 v226, v226, s67, s67
    v_rcp_f32 v225, v225
    v_fma_f32 v227, v227, s67, s67
    v_rcp_f32 v226, v226
    v_fma_f32 v228, v228, s67, s67
    v_rcp_f32 v227, v227
    v_fma_f32 v229, v229, s67, s67
    v_rcp_f32 v228, v228
    v_fma_f32 v230, v230, s67, s67
    v_rcp_f32 v229, v229
    v_fma_f32 v231, v231, s67, s67
    v_rcp_f32 v230, v230
    v_rcp_f32 v231, v231
    v_mul_f32 v32, v32, v224
    v_mul_f32 v33, v33, v225
    v_mul_f32 v34, v34, v226
    v_mul_f32 v35, v35, v227
    v_mul_f32 v36, v36, v228
    v_mul_f32 v37, v37, v229
    v_mul_f32 v38, v38, v230
    v_mul_f32 v39, v39, v231
    v_cvt_pk_bf16_f32 v204, v32, v33
    v_cvt_pk_bf16_f32 v205, v34, v35
    v_cvt_pk_bf16_f32 v206, v36, v37
    v_cvt_pk_bf16_f32 v207, v38, v39
    buffer_store_dwordx4 v[204:207], v198, s[28:31], 0 offen offset:1024 sc1
    v_add_u32 v198, 114688, v198
    v_mul_f32 v56, v40, v56
    v_exp_f32 v216, -v40
    v_mul_f32 v57, v41, v57
    v_exp_f32 v217, -v41
    v_mul_f32 v58, v42, v58
    v_exp_f32 v218, -v42
    v_mul_f32 v59, v43, v59
    v_exp_f32 v219, -v43
    v_mul_f32 v60, v44, v60
    v_exp_f32 v220, -v44
    v_mul_f32 v61, v45, v61
    v_exp_f32 v221, -v45
    v_mul_f32 v62, v46, v62
    v_exp_f32 v222, -v46
    v_mul_f32 v63, v47, v63
    v_exp_f32 v223, -v47
    v_fma_f32 v216, v216, s67, s67
    v_fma_f32 v217, v217, s67, s67
    v_rcp_f32 v216, v216
    v_fma_f32 v218, v218, s67, s67
    v_rcp_f32 v217, v217
    v_fma_f32 v219, v219, s67, s67
    v_rcp_f32 v218, v218
    v_fma_f32 v220, v220, s67, s67
    v_rcp_f32 v219, v219
    v_fma_f32 v221, v221, s67, s67
    v_rcp_f32 v220, v220
    v_fma_f32 v222, v222, s67, s67
    v_rcp_f32 v221, v221
    v_fma_f32 v223, v223, s67, s67
    v_rcp_f32 v222, v222
    v_rcp_f32 v223, v223
    v_mul_f32 v56, v56, v216
    v_mul_f32 v57, v57, v217
    v_mul_f32 v58, v58, v218
    v_mul_f32 v59, v59, v219
    v_mul_f32 v60, v60, v220
    v_mul_f32 v61, v61, v221
    v_mul_f32 v62, v62, v222
    v_mul_f32 v63, v63, v223
    v_cvt_pk_bf16_f32 v208, v56, v57
    v_cvt_pk_bf16_f32 v209, v58, v59
    v_cvt_pk_bf16_f32 v210, v60, v61
    v_cvt_pk_bf16_f32 v211, v62, v63
    buffer_store_dwordx4 v[208:211], v198, s[28:31], 0 offen offset:0 sc1
    v_mul_f32 v64, v48, v64
    v_exp_f32 v224, -v48
    v_mul_f32 v65, v49, v65
    v_exp_f32 v225, -v49
    v_mul_f32 v66, v50, v66
    v_exp_f32 v226, -v50
    v_mul_f32 v67, v51, v67
    v_exp_f32 v227, -v51
    v_mul_f32 v68, v52, v68
    v_exp_f32 v228, -v52
    v_mul_f32 v69, v53, v69
    v_exp_f32 v229, -v53
    v_mul_f32 v70, v54, v70
    v_exp_f32 v230, -v54
    v_mul_f32 v71, v55, v71
    v_exp_f32 v231, -v55
    v_fma_f32 v224, v224, s67, s67
    v_fma_f32 v225, v225, s67, s67
    v_rcp_f32 v224, v224
    v_fma_f32 v226, v226, s67, s67
    v_rcp_f32 v225, v225
    v_fma_f32 v227, v227, s67, s67
    v_rcp_f32 v226, v226
    v_fma_f32 v228, v228, s67, s67
    v_rcp_f32 v227, v227
    v_fma_f32 v229, v229, s67, s67
    v_rcp_f32 v228, v228
    v_fma_f32 v230, v230, s67, s67
    v_rcp_f32 v229, v229
    v_fma_f32 v231, v231, s67, s67
    v_rcp_f32 v230, v230
    v_rcp_f32 v231, v231
    v_mul_f32 v64, v64, v224
    v_mul_f32 v65, v65, v225
    v_mul_f32 v66, v66, v226
    v_mul_f32 v67, v67, v227
    v_mul_f32 v68, v68, v228
    v_mul_f32 v69, v69, v229
    v_mul_f32 v70, v70, v230
    v_mul_f32 v71, v71, v231
    v_cvt_pk_bf16_f32 v212, v64, v65
    v_cvt_pk_bf16_f32 v213, v66, v67
    v_cvt_pk_bf16_f32 v214, v68, v69
    v_cvt_pk_bf16_f32 v215, v70, v71
    buffer_store_dwordx4 v[212:215], v198, s[28:31], 0 offen offset:1024 sc1
    v_add_u32 v198, 114688, v198
    v_mul_f32 v88, v72, v88
    v_exp_f32 v216, -v72
    v_mul_f32 v89, v73, v89
    v_exp_f32 v217, -v73
    v_mul_f32 v90, v74, v90
    v_exp_f32 v218, -v74
    v_mul_f32 v91, v75, v91
    v_exp_f32 v219, -v75
    v_mul_f32 v92, v76, v92
    v_exp_f32 v220, -v76
    v_mul_f32 v93, v77, v93
    v_exp_f32 v221, -v77
    v_mul_f32 v94, v78, v94
    v_exp_f32 v222, -v78
    v_mul_f32 v95, v79, v95
    v_exp_f32 v223, -v79
    v_fma_f32 v216, v216, s67, s67
    v_fma_f32 v217, v217, s67, s67
    v_rcp_f32 v216, v216
    v_fma_f32 v218, v218, s67, s67
    v_rcp_f32 v217, v217
    v_fma_f32 v219, v219, s67, s67
    v_rcp_f32 v218, v218
    v_fma_f32 v220, v220, s67, s67
    v_rcp_f32 v219, v219
    v_fma_f32 v221, v221, s67, s67
    v_rcp_f32 v220, v220
    v_fma_f32 v222, v222, s67, s67
    v_rcp_f32 v221, v221
    v_fma_f32 v223, v223, s67, s67
    v_rcp_f32 v222, v222
    v_rcp_f32 v223, v223
    v_mul_f32 v88, v88, v216
    v_mul_f32 v89, v89, v217
    v_mul_f32 v90, v90, v218
    v_mul_f32 v91, v91, v219
    v_mul_f32 v92, v92, v220
    v_mul_f32 v93, v93, v221
    v_mul_f32 v94, v94, v222
    v_mul_f32 v95, v95, v223
    v_cvt_pk_bf16_f32 v200, v88, v89
    v_cvt_pk_bf16_f32 v201, v90, v91
    v_cvt_pk_bf16_f32 v202, v92, v93
    v_cvt_pk_bf16_f32 v203, v94, v95
    buffer_store_dwordx4 v[200:203], v198, s[28:31], 0 offen offset:0 sc1
    v_mul_f32 v96, v80, v96
    v_exp_f32 v224, -v80
    v_mul_f32 v97, v81, v97
    v_exp_f32 v225, -v81
    v_mul_f32 v98, v82, v98
    v_exp_f32 v226, -v82
    v_mul_f32 v99, v83, v99
    v_exp_f32 v227, -v83
    v_mul_f32 v100, v84, v100
    v_exp_f32 v228, -v84
    v_mul_f32 v101, v85, v101
    v_exp_f32 v229, -v85
    v_mul_f32 v102, v86, v102
    v_exp_f32 v230, -v86
    v_mul_f32 v103, v87, v103
    v_exp_f32 v231, -v87
    v_fma_f32 v224, v224, s67, s67
    v_fma_f32 v225, v225, s67, s67
    v_rcp_f32 v224, v224
    v_fma_f32 v226, v226, s67, s67
    v_rcp_f32 v225, v225
    v_fma_f32 v227, v227, s67, s67
    v_rcp_f32 v226, v226
    v_fma_f32 v228, v228, s67, s67
    v_rcp_f32 v227, v227
    v_fma_f32 v229, v229, s67, s67
    v_rcp_f32 v228, v228
    v_fma_f32 v230, v230, s67, s67
    v_rcp_f32 v229, v229
    v_fma_f32 v231, v231, s67, s67
    v_rcp_f32 v230, v230
    v_rcp_f32 v231, v231
    v_mul_f32 v96, v96, v224
    v_mul_f32 v97, v97, v225
    v_mul_f32 v98, v98, v226
    v_mul_f32 v99, v99, v227
    v_mul_f32 v100, v100, v228
    v_mul_f32 v101, v101, v229
    v_mul_f32 v102, v102, v230
    v_mul_f32 v103, v103, v231
    v_cvt_pk_bf16_f32 v204, v96, v97
    v_cvt_pk_bf16_f32 v205, v98, v99
    v_cvt_pk_bf16_f32 v206, v100, v101
    v_cvt_pk_bf16_f32 v207, v102, v103
    buffer_store_dwordx4 v[204:207], v198, s[28:31], 0 offen offset:1024 sc1
    v_add_u32 v198, 114688, v198
    v_mul_f32 v120, v104, v120
    v_exp_f32 v216, -v104
    v_mul_f32 v121, v105, v121
    v_exp_f32 v217, -v105
    v_mul_f32 v122, v106, v122
    v_exp_f32 v218, -v106
    v_mul_f32 v123, v107, v123
    v_exp_f32 v219, -v107
    v_mul_f32 v124, v108, v124
    v_exp_f32 v220, -v108
    v_mul_f32 v125, v109, v125
    v_exp_f32 v221, -v109
    v_mul_f32 v126, v110, v126
    v_exp_f32 v222, -v110
    v_mul_f32 v127, v111, v127
    v_exp_f32 v223, -v111
    v_fma_f32 v216, v216, s67, s67
    v_fma_f32 v217, v217, s67, s67
    v_rcp_f32 v216, v216
    v_fma_f32 v218, v218, s67, s67
    v_rcp_f32 v217, v217
    v_fma_f32 v219, v219, s67, s67
    v_rcp_f32 v218, v218
    v_fma_f32 v220, v220, s67, s67
    v_rcp_f32 v219, v219
    v_fma_f32 v221, v221, s67, s67
    v_rcp_f32 v220, v220
    v_fma_f32 v222, v222, s67, s67
    v_rcp_f32 v221, v221
    v_fma_f32 v223, v223, s67, s67
    v_rcp_f32 v222, v222
    v_rcp_f32 v223, v223
    v_mul_f32 v120, v120, v216
    v_mul_f32 v121, v121, v217
    v_mul_f32 v122, v122, v218
    v_mul_f32 v123, v123, v219
    v_mul_f32 v124, v124, v220
    v_mul_f32 v125, v125, v221
    v_mul_f32 v126, v126, v222
    v_mul_f32 v127, v127, v223
    v_cvt_pk_bf16_f32 v208, v120, v121
    v_cvt_pk_bf16_f32 v209, v122, v123
    v_cvt_pk_bf16_f32 v210, v124, v125
    v_cvt_pk_bf16_f32 v211, v126, v127
    buffer_store_dwordx4 v[208:211], v198, s[28:31], 0 offen offset:0 sc1
    v_mul_f32 v128, v112, v128
    v_exp_f32 v224, -v112
    v_mul_f32 v129, v113, v129
    v_exp_f32 v225, -v113
    v_mul_f32 v130, v114, v130
    v_exp_f32 v226, -v114
    v_mul_f32 v131, v115, v131
    v_exp_f32 v227, -v115
    v_mul_f32 v132, v116, v132
    v_exp_f32 v228, -v116
    v_mul_f32 v133, v117, v133
    v_exp_f32 v229, -v117
    v_mul_f32 v134, v118, v134
    v_exp_f32 v230, -v118
    v_mul_f32 v135, v119, v135
    v_exp_f32 v231, -v119
    v_fma_f32 v224, v224, s67, s67
    v_fma_f32 v225, v225, s67, s67
    v_rcp_f32 v224, v224
    v_fma_f32 v226, v226, s67, s67
    v_rcp_f32 v225, v225
    v_fma_f32 v227, v227, s67, s67
    v_rcp_f32 v226, v226
    v_fma_f32 v228, v228, s67, s67
    v_rcp_f32 v227, v227
    v_fma_f32 v229, v229, s67, s67
    v_rcp_f32 v228, v228
    v_fma_f32 v230, v230, s67, s67
    v_rcp_f32 v229, v229
    v_fma_f32 v231, v231, s67, s67
    v_rcp_f32 v230, v230
    v_rcp_f32 v231, v231
    v_mul_f32 v128, v128, v224
    v_mul_f32 v129, v129, v225
    v_mul_f32 v130, v130, v226
    v_mul_f32 v131, v131, v227
    v_mul_f32 v132, v132, v228
    v_mul_f32 v133, v133, v229
    v_mul_f32 v134, v134, v230
    v_mul_f32 v135, v135, v231
    v_cvt_pk_bf16_f32 v212, v128, v129
    v_cvt_pk_bf16_f32 v213, v130, v131
    v_cvt_pk_bf16_f32 v214, v132, v133
    v_cvt_pk_bf16_f32 v215, v134, v135
    buffer_store_dwordx4 v[212:215], v198, s[28:31], 0 offen offset:1024 sc1
    s_lshl_b32 s64, s50, 3
    s_lshl_b32 s65, s44, 1
    s_add_u32 s64, s64, s65
    s_mul_i32 s64, s64, 114688
    s_add_u32 s64, s64, 0x1500000
    v_lshl_add_u32 v192, v1, 4, s64
    v_add_u32 v193, 112640, v192
    s_lshl_b32 s65, s51, 8
    v_lshrrev_b32 v3, 4, v1
    s_lshl_b32 s64, s44, 4
    v_add_u32 v2, s64, v3
    s_movk_i32 s64, 2048
    v_mul_u32_u24 v2, s64, v2
    v_add_u32 v2, s65, v2
    v_lshlrev_b32 v3, 1, v3
    v_and_b32 v4, 15, v1
    v_xor_b32 v3, v3, v4
    v_lshl_add_u32 v194, v3, 4, v2
    v_add_u32 v196, 14336, v194
    v_xor_b32 v3, 8, v3
    v_lshl_add_u32 v195, v3, 4, v2
    v_add_u32 v195, 7168, v195
    v_add_u32 v197, 14336, v195
    s_lshl_b32 s64, s47, 8
    s_lshl_b32 s65, s48, 4
    s_add_u32 s64, s64, s65
    s_lshl_b32 s65, s44, 2
    s_add_u32 s64, s64, s65
    s_add_u32 s64, s64, 0x51000
    v_mov_b32 v2, s0
    s_waitcnt vmcnt(0)
    s_mov_b64 exec, 1
    buffer_store_dword v2, v234, s[28:31], s64 offen sc1
    s_mov_b64 exec, -1
    s_barrier
    s_lshl_b32 s68, s50, 8
    s_add_u32 s68, s68, 0x51000
    buffer_load_dword v245, v234, s[28:31], s68 offen sc1
    s_waitcnt vmcnt(0)
    s_branch M_Pjoin
M_Q:
    s_setprio 0
    s_sub_u32 s44, s44, 4
    s_lshl_b32 s62, s47, 4
    s_add_u32 s62, s62, s48
    s_lshl_b32 s62, s62, 2
    s_add_u32 s62, s62, s44
    s_lshl_b32 s64, s62, 12
    v_lshl_add_u32 v2, v1, 4, s64
    s_waitcnt lgkmcnt(0)
    s_load_dword s0, s[26:27], 0
    s_mov_b32 s40, s4
    s_mov_b32 s41, s5
    s_mov_b32 s42, 0x400000
    s_mov_b32 s43, 0x20000
    buffer_load_dwordx4 v[104:107], v2, s[40:43], 0 offen offset:0
    buffer_load_dwordx4 v[108:111], v2, s[40:43], 0 offen offset:1024
    buffer_load_dwordx4 v[112:115], v2, s[40:43], 0 offen offset:2048
    buffer_load_dwordx4 v[116:119], v2, s[40:43], 0 offen offset:3072
    s_barrier
    s_or_b32 s65, s48, s44
    s_cmp_lg_u32 s65, 0
    s_cbranch_scc1 M_noclr
    s_lshl_b32 s64, s47, 9
    s_add_u32 s64, s64, 0x54000
    s_add_u32 s56, s26, s64
    s_addc_u32 s57, s27, 0
    s_mov_b32 s84, 0
    s_mov_b32 s85, 0
    s_mov_b32 s86, 0
    s_mov_b32 s87, 0
    s_mov_b32 s88, 0
    s_mov_b32 s89, 0
    s_mov_b32 s90, 0
    s_mov_b32 s91, 0
    s_mov_b32 s92, 0
    s_mov_b32 s93, 0
    s_mov_b32 s94, 0
    s_mov_b32 s95, 0
    s_atomic_swap s84, s[56:57], 0 glc
    s_atomic_swap s85, s[56:57], 128 glc
    s_atomic_swap s86, s[56:57], 256 glc
    s_atomic_swap s87, s[56:57], 384 glc
    s_atomic_swap s88, s[56:57], 8192 glc
    s_atomic_swap s89, s[56:57], 8320 glc
    s_atomic_swap s90, s[56:57], 8448 glc
    s_atomic_swap s91, s[56:57], 8576 glc
    s_atomic_swap s92, s[56:57], 16384 glc
    s_atomic_swap s93, s[56:57], 16512 glc
    s_atomic_swap s94, s[56:57], 16640 glc
    s_atomic_swap s95, s[56:57], 16768 glc
M_noclr:
    v_bfe_u32 v2, v0, 3, 5
    v_and_b32 v3, 7, v0
    v_lshlrev_b32 v14, 5, v3
    v_add_u32 v14, 149504, v14
    s_lshl_b32 s64, s48, 7
    v_lshl_add_u32 v4, v3, 4, s64
    s_lshl_b32 s70, s47, 7
    v_add_u32 v12, s70, v2
    v_lshl_add_u32 v8, v12, 11, v4
    s_max_u32 s70, s70, 16
    s_sub_u32 s70, s70, 16
    v_and_b32 v5, 15, v2
    v_add_u32 v13, s70, v5
    v_lshl_add_u32 v9, v13, 11, v4
    v_and_b32 v4, 7, v2
    v_lshlrev_b32 v4, 3, v4
    v_add_u32 v4, 0x10000, v4
    v_lshrrev_b32 v12, 3, v12
    v_lshl_add_u32 v12, v12, 7, v4
    v_lshrrev_b32 v13, 3, v13
    v_lshl_add_u32 v13, v13, 7, v4
    v_lshlrev_b32 v3, 8, v3
    v_lshl_add_u32 v3, v5, 4, v3
    s_mul_i32 s64, s47, 294912
    s_lshl_b32 s65, s48, 11
    s_add_u32 s64, s64, s65
    s_add_u32 s64, s64, 0x100000
    s_cmp_ge_u32 s44, 2
    s_cselect_b32 s65, 0x80000000, s64
    v_add_u32 v11, s65, v3
    s_cselect_b32 s65, 32768, 0
    s_add_u32 s64, s64, s65
    s_add_u32 s64, s64, 32768
    v_add_u32 v10, s64, v3
    s_mov_b32 s53, 0
    s_lshl_b32 s72, s44, 12
    s_add_u32 s72, s72, 2048
    s_lshl_b32 s73, s44, 9
    s_mul_i32 s74, s44, 6144
    s_add_u32 s74, s74, 18432
    s_add_u32 s75, s74, 4096
    s_bfe_u32 s66, s2, 0x30003
    s_lshr_b32 s55, s2, 6
    s_add_u32 s66, s66, s55
    s_and_b32 s66, s66, 3
    s_mov_b32 s58, 0x76453210
    s_mov_b32 s59, 0xfecdba89
    s_cmp_eq_u32 s66, 1
    s_cselect_b32 s58, 0x75643120, s58
    s_cselect_b32 s59, 0xfdecb9a8, s59
    s_cmp_eq_u32 s66, 2
    s_cselect_b32 s58, 0x67542310, s58
    s_cselect_b32 s59, 0xefdcab98, s59
    s_cmp_eq_u32 s66, 3
    s_cselect_b32 s58, 0x86534210, s58
    s_cselect_b32 s59, 0xfedbca97, s59
    s_lshl_b32 s65, s48, 7
    s_mul_i32 s64, s44, 98304
    s_add_u32 s65, s65, s64
    s_movk_i32 s64, 6144
    v_add_u32 v2, 0, v1
    v_mul_u32_u24 v3, 0xab, v2
    v_lshrrev_b32 v3, 12, v3
    v_mul_u32_u24 v4, 24, v3
    v_sub_u32 v2, v2, v4
    v_and_b32 v4, 2, v3
    v_lshrrev_b32 v5, 3, v3
    v_lshl_or_b32 v4, v5, 2, v4
    v_xor_b32 v2, v2, v4
    v_mul_u32_u24 v3, s64, v3
    v_lshrrev_b32 v4, 3, v2
    v_lshl_add_u32 v3, v4, 11, v3
    v_and_b32 v2, 7, v2
    v_lshl_add_u32 v3, v2, 4, v3
    v_add_u32 v187, s65, v3
    v_add_u32 v2, 64, v1
    v_mul_u32_u24 v3, 0xab, v2
    v_lshrrev_b32 v3, 12, v3
    v_mul_u32_u24 v4, 24, v3
    v_sub_u32 v2, v2, v4
    v_and_b32 v4, 2, v3
    v_lshrrev_b32 v5, 3, v3
    v_lshl_or_b32 v4, v5, 2, v4
    v_xor_b32 v2, v2, v4
    v_mul_u32_u24 v3, s64, v3
    v_lshrrev_b32 v4, 3, v2
    v_lshl_add_u32 v3, v4, 11, v3
    v_and_b32 v2, 7, v2
    v_lshl_add_u32 v3, v2, 4, v3
    v_subrev_u32 v3, 1024, v3
    v_add_u32 v188, s65, v3
    v_add_u32 v2, 128, v1
    v_mul_u32_u24 v3, 0xab, v2
    v_lshrrev_b32 v3, 12, v3
    v_mul_u32_u24 v4, 24, v3
    v_sub_u32 v2, v2, v4
    v_and_b32 v4, 2, v3
    v_lshrrev_b32 v5, 3, v3
    v_lshl_or_b32 v4, v5, 2, v4
    v_xor_b32 v2, v2, v4
    v_mul_u32_u24 v3, s64, v3
    v_lshrrev_b32 v4, 3, v2
    v_lshl_add_u32 v3, v4, 11, v3
    v_and_b32 v2, 7, v2
    v_lshl_add_u32 v3, v2, 4, v3
    v_subrev_u32 v3, 2048, v3
    v_add_u32 v189, s65, v3
    v_add_u32 v2, 192, v1
    v_mul_u32_u24 v3, 0xab, v2
    v_lshrrev_b32 v3, 12, v3
    v_mul_u32_u24 v4, 24, v3
    v_sub_u32 v2, v2, v4
    v_and_b32 v4, 2, v3
    v_lshrrev_b32 v5, 3, v3
    v_lshl_or_b32 v4, v5, 2, v4
    v_xor_b32 v2, v2, v4
    v_mul_u32_u24 v3, s64, v3
    v_lshrrev_b32 v4, 3, v2
    v_lshl_add_u32 v3, v4, 11, v3
    v_and_b32 v2, 7, v2
    v_lshl_add_u32 v3, v2, 4, v3
    v_subrev_u32 v3, 3072, v3
    v_add_u32 v190, s65, v3
    v_add_u32 v2, 256, v1
    v_mul_u32_u24 v3, 0xab, v2
    v_lshrrev_b32 v3, 12, v3
    v_mul_u32_u24 v4, 24, v3
    v_sub_u32 v2, v2, v4
    v_and_b32 v4, 2, v3
    v_lshrrev_b32 v5, 3, v3
    v_lshl_or_b32 v4, v5, 2, v4
    v_xor_b32 v2, v2, v4
    v_mul_u32_u24 v3, s64, v3
    v_lshrrev_b32 v4, 3, v2
    v_lshl_add_u32 v3, v4, 11, v3
    v_and_b32 v2, 7, v2
    v_lshl_add_u32 v3, v2, 4, v3
    v_add_u32 v191, s65, v3
    v_add_u32 v2, 320, v1
    v_mul_u32_u24 v3, 0xab, v2
    v_lshrrev_b32 v3, 12, v3
    v_mul_u32_u24 v4, 24, v3
    v_sub_u32 v2, v2, v4
    v_and_b32 v4, 2, v3
    v_lshrrev_b32 v5, 3, v3
    v_lshl_or_b32 v4, v5, 2, v4
    v_xor_b32 v2, v2, v4
    v_mul_u32_u24 v3, s64, v3
    v_lshrrev_b32 v4, 3, v2
    v_lshl_add_u32 v3, v4, 11, v3
    v_and_b32 v2, 7, v2
    v_lshl_add_u32 v3, v2, 4, v3
    v_subrev_u32 v3, 1024, v3
    v_add_u32 v192, s65, v3
    s_mul_i32 s64, s47, 294912
    s_add_u32 s64, s64, 0x100000
    s_add_u32 s65, s64, s73
    v_lshl_add_u32 v186, v1, 4, s65
    s_mul_i32 s65, s44, 65536
    s_add_u32 s64, s64, s65
    s_add_u32 s64, s64, 32768
    v_lshl_add_u32 v184, v1, 4, s64
    v_add_u32 v185, 30720, v184
    s_mov_b32 s32, s6
    s_mov_b32 s33, s7
    s_mov_b32 s34, 0x600000
    s_mov_b32 s35, 0x20000
    s_mov_b32 s28, s26
    s_mov_b32 s29, s27
    s_mov_b32 s30, 0x3000000
    s_mov_b32 s31, 0x20000
    s_lshr_b32 s45, s44, 1
    s_and_b32 s46, s44, 1
    s_bfe_u32 s49, s2, 0x10003
    s_and_b32 s50, s2, 3
    s_lshl_b32 s50, s50, 2
    s_bfe_u32 s64, s2, 0x20004
    s_add_u32 s50, s50, s64
    s_and_b32 s51, s2, 4
    s_lshr_b32 s64, s2, 6
    s_add_u32 s51, s51, s64
    s_cmp_ge_u32 s2, 192
    s_cselect_b32 s69, 0x80000000, 0
    s_mov_b32 s67, 0x40053526
    v_lshlrev_b32 v234, 2, v1
    v_lshrrev_b32 v3, 3, v1
    s_lshl_b32 s64, s44, 4
    v_add_lshl_u32 v2, v3, s64, 11
    s_lshl_b32 s64, s48, 7
    v_add_u32 v2, s64, v2
    v_and_b32 v3, 6, v3
    v_and_b32 v4, 7, v1
    v_xor_b32 v3, v3, v4
    v_lshl_add_u32 v193, v3, 4, v2
    v_add_u32 v194, 15360, v193
    s_lshl_b32 s64, s47, 3
    s_lshl_b32 s65, s44, 1
    s_add_u32 s64, s64, s65
    s_mul_i32 s64, s64, 32768
    s_add_u32 s64, s64, 0x1000000
    v_lshl_add_u32 v206, v1, 4, s64
    v_add_u32 v207, 30720, v206
    s_lshl_b32 s65, s48, 8
    v_lshrrev_b32 v3, 4, v1
    s_lshl_b32 s64, s44, 4
    v_add_u32 v2, s64, v3
    s_movk_i32 s64, 7168
    v_mul_u32_u24 v2, s64, v2
    v_add_u32 v2, s65, v2
    v_lshlrev_b32 v3, 1, v3
    v_and_b32 v4, 15, v1
    v_xor_b32 v3, v3, v4
    v_lshl_add_u32 v208, v3, 4, v2
    v_add_u32 v210, 55296, v208
    v_xor_b32 v3, 8, v3
    v_lshl_add_u32 v209, v3, 4, v2
    v_add_u32 v209, 27648, v209
    v_add_u32 v211, 55296, v209
    s_lshr_b32 s65, s48, 2
    s_sub_u32 s65, s48, s65
    s_add_u32 s65, s65, 16
    s_lshl_b32 s65, s65, 8
    s_or_b32 s65, s65, s69
    v_lshrrev_b32 v3, 4, v1
    s_lshl_b32 s64, s44, 4
    v_add_u32 v2, s64, v3
    s_movk_i32 s64, 7168
    v_mul_u32_u24 v2, s64, v2
    v_add_u32 v2, s65, v2
    v_lshlrev_b32 v3, 1, v3
    v_and_b32 v4, 15, v1
    v_xor_b32 v3, v3, v4
    v_lshl_add_u32 v212, v3, 4, v2
    v_add_u32 v214, 55296, v212
    v_xor_b32 v3, 8, v3
    v_lshl_add_u32 v213, v3, 4, v2
    v_add_u32 v213, 27648, v213
    v_add_u32 v215, 55296, v213
    s_lshl_b32 s64, s50, 3
    s_lshl_b32 s65, s44, 1
    s_add_u32 s64, s64, s65
    s_mul_i32 s64, s64, 114688
    s_add_u32 s64, s64, 0x1500000
    v_lshl_add_u32 v246, v1, 4, s64
    v_add_u32 v247, 112640, v246
    s_lshl_b32 s65, s51, 8
    v_lshrrev_b32 v3, 4, v1
    s_lshl_b32 s64, s44, 4
    v_add_u32 v2, s64, v3
    s_movk_i32 s64, 2048
    v_mul_u32_u24 v2, s64, v2
    v_add_u32 v2, s65, v2
    v_lshlrev_b32 v3, 1, v3
    v_and_b32 v4, 15, v1
    v_xor_b32 v3, v3, v4
    v_lshl_add_u32 v248, v3, 4, v2
    v_add_u32 v250, 14336, v248
    v_xor_b32 v3, 8, v3
    v_lshl_add_u32 v249, v3, 4, v2
    v_add_u32 v249, 7168, v249
    v_add_u32 v251, 14336, v249
    s_lshl_b32 s64, s44, 12
    v_lshl_add_u32 v233, v1, 4, s64
    v_lshrrev_b32 v2, 2, v1
    v_lshlrev_b32 v4, 7, v2
    v_and_b32 v5, 3, v1
    v_lshl_add_u32 v4, v5, 3, v4
    v_add_u32 v4, 16384, v4
    v_bfe_u32 v2, v1, 3, 2
    v_xor_b32 v3, 0, v2
    v_lshl_add_u32 v239, v3, 5, v4
    v_xor_b32 v3, 1, v2
    v_lshl_add_u32 v240, v3, 5, v4
    v_xor_b32 v3, 2, v2
    v_lshl_add_u32 v241, v3, 5, v4
    v_xor_b32 v3, 3, v2
    v_lshl_add_u32 v242, v3, 5, v4
    s_mov_b32 s52, 49152
    v_add_u32 v232, s52, v233
    v_add_u32 v235, s52, v239
    v_add_u32 v236, s52, v240
    v_add_u32 v237, s52, v241
    v_add_u32 v238, s52, v242
    s_lshl_b32 s70, s47, 2
    s_add_u32 s70, s70, s44
    s_lshl_b32 s64, s70, 16
    s_lshl_b32 s65, s48, 7
    s_add_u32 s64, s64, s65
    v_and_b32 v2, 15, v1
    v_lshl_add_u32 v2, v2, 11, s64
    v_bfe_u32 v3, v1, 4, 1
    v_lshl_add_u32 v2, v3, 5, v2
    v_lshrrev_b32 v3, 5, v1
    v_lshl_add_u32 v196, v3, 4, v2
    s_mul_i32 s64, s70, 65536
    s_lshl_b32 s65, s48, 11
    s_add_u32 s64, s64, s65
    v_lshl_add_u32 v197, v1, 4, s64
    s_lshl_b32 s64, s70, 12
    s_add_u32 s64, s64, 0x60000
    v_lshl_add_u32 v198, v1, 3, s64
    v_and_b32 v2, 48, v1
    v_add_u32 v199, 149504, v2
    v_mov_b32 v72, 148480
    v_mov_b32 v73, 0
    ds_write_b32 v72, v73 offset:0
    ds_write_b32 v72, v73 offset:4
    ds_write_b32 v72, v73 offset:8
    ds_write_b32 v72, v73 offset:12
    ds_write_b32 v72, v73 offset:16
    ds_write_b32 v72, v73 offset:20
    v_and_b32 v16, 255, v0
    s_lshr_b32 s80, s2, 6
    s_lshl_b32 s81, s80, 8
    s_and_b32 s82, s2, 63
    s_lshl_b32 s83, s82, 7
    s_add_u32 s83, s83, 4096
    s_lshl_b32 s80, s80, 15
    s_lshl_b32 s82, s82, 9
    s_add_u32 s80, s80, s82
    s_add_u32 s80, s80, 0xa0000
    v_lshrrev_b32 v72, 3, v16
    v_add_u32 v72, s81, v72
    v_lshlrev_b32 v18, 1, v72
    s_movk_i32 s64, 12288
    v_mul_lo_u32 v72, s64, v72
    v_and_b32 v17, 7, v0
    v_lshl_add_u32 v72, v17, 4, v72
    v_add_u32 v17, s83, v72
    s_lshl_b32 s64, s2, 8
    v_add_lshl_u32 v243, v16, s64, 5
    s_mov_b32 s36, s20
    s_mov_b32 s37, s21
    s_mov_b32 s38, 0xc00000
    s_mov_b32 s39, 0x20000
    s_lshl_b32 s64, s2, 2
    s_add_u32 s64, s64, s44
    s_mul_i32 s64, s64, 7168
    s_add_u32 s10, s12, s64
    s_addc_u32 s11, s13, 0
    s_add_u32 s24, s14, s64
    s_addc_u32 s25, s15, 0
    s_waitcnt lgkmcnt(0)
    s_add_u32 s0, s0, 1
    s_barrier
    s_waitcnt vmcnt(0)
    v_lshlrev_b32 v120, 16, v104
    v_and_b32 v121, 0xffff0000, v104
    v_lshlrev_b32 v122, 16, v105
    v_and_b32 v123, 0xffff0000, v105
    v_lshlrev_b32 v124, 16, v106
    v_and_b32 v125, 0xffff0000, v106
    v_lshlrev_b32 v126, 16, v107
    v_and_b32 v127, 0xffff0000, v107
    v_lshlrev_b32 v128, 16, v108
    v_and_b32 v129, 0xffff0000, v108
    v_lshlrev_b32 v130, 16, v109
    v_and_b32 v131, 0xffff0000, v109
    v_lshlrev_b32 v132, 16, v110
    v_and_b32 v133, 0xffff0000, v110
    v_lshlrev_b32 v134, 16, v111
    v_and_b32 v135, 0xffff0000, v111
    v_lshlrev_b32 v136, 16, v112
    v_and_b32 v137, 0xffff0000, v112
    v_lshlrev_b32 v138, 16, v113
    v_and_b32 v139, 0xffff0000, v113
    v_lshlrev_b32 v140, 16, v114
    v_and_b32 v141, 0xffff0000, v114
    v_lshlrev_b32 v142, 16, v115
    v_and_b32 v143, 0xffff0000, v115
    v_lshlrev_b32 v144, 16, v116
    v_and_b32 v145, 0xffff0000, v116
    v_lshlrev_b32 v146, 16, v117
    v_and_b32 v147, 0xffff0000, v117
    v_lshlrev_b32 v148, 16, v118
    v_and_b32 v149, 0xffff0000, v118
    v_lshlrev_b32 v150, 16, v119
    v_and_b32 v151, 0xffff0000, v119
    v_pk_add_f32 v[104:105], v[120:121], v[122:123]
    v_pk_mul_f32 v[108:109], v[120:121], v[120:121]
    v_pk_add_f32 v[106:107], v[136:137], v[138:139]
    v_pk_mul_f32 v[110:111], v[136:137], v[136:137]
    v_pk_fma_f32 v[108:109], v[122:123], v[122:123], v[108:109]
    v_pk_fma_f32 v[110:111], v[138:139], v[138:139], v[110:111]
    v_pk_add_f32 v[104:105], v[104:105], v[124:125]
    v_pk_fma_f32 v[108:109], v[124:125], v[124:125], v[108:109]
    v_pk_add_f32 v[106:107], v[106:107], v[140:141]
    v_pk_fma_f32 v[110:111], v[140:141], v[140:141], v[110:111]
    v_pk_add_f32 v[104:105], v[104:105], v[126:127]
    v_pk_fma_f32 v[108:109], v[126:127], v[126:127], v[108:109]
    v_pk_add_f32 v[106:107], v[106:107], v[142:143]
    v_pk_fma_f32 v[110:111], v[142:143], v[142:143], v[110:111]
    v_pk_add_f32 v[104:105], v[104:105], v[128:129]
    v_pk_fma_f32 v[108:109], v[128:129], v[128:129], v[108:109]
    v_pk_add_f32 v[106:107], v[106:107], v[144:145]
    v_pk_fma_f32 v[110:111], v[144:145], v[144:145], v[110:111]
    v_pk_add_f32 v[104:105], v[104:105], v[130:131]
    v_pk_fma_f32 v[108:109], v[130:131], v[130:131], v[108:109]
    v_pk_add_f32 v[106:107], v[106:107], v[146:147]
    v_pk_fma_f32 v[110:111], v[146:147], v[146:147], v[110:111]
    v_pk_add_f32 v[104:105], v[104:105], v[132:133]
    v_pk_fma_f32 v[108:109], v[132:133], v[132:133], v[108:109]
    v_pk_add_f32 v[106:107], v[106:107], v[148:149]
    v_pk_fma_f32 v[110:111], v[148:149], v[148:149], v[110:111]
    v_pk_add_f32 v[104:105], v[104:105], v[134:135]
    v_pk_fma_f32 v[108:109], v[134:135], v[134:135], v[108:109]
    v_pk_add_f32 v[106:107], v[106:107], v[150:151]
    v_pk_fma_f32 v[110:111], v[150:151], v[150:151], v[110:111]
    v_add_f32 v152, v104, v105
    v_add_f32 v153, v108, v109
    v_add_f32 v156, v106, v107
    v_add_f32 v157, v110, v111
    v_add_f32_dpp v152, v152, v152 quad_perm:[1,0,3,2] row_mask:0xf bank_mask:0xf
    v_add_f32_dpp v153, v153, v153 quad_perm:[1,0,3,2] row_mask:0xf bank_mask:0xf
    v_add_f32_dpp v156, v156, v156 quad_perm:[1,0,3,2] row_mask:0xf bank_mask:0xf
    v_add_f32_dpp v157, v157, v157 quad_perm:[1,0,3,2] row_mask:0xf bank_mask:0xf
    v_add_f32_dpp v152, v152, v152 quad_perm:[2,3,0,1] row_mask:0xf bank_mask:0xf
    v_add_f32_dpp v153, v153, v153 quad_perm:[2,3,0,1] row_mask:0xf bank_mask:0xf
    v_add_f32_dpp v156, v156, v156 quad_perm:[2,3,0,1] row_mask:0xf bank_mask:0xf
    v_add_f32_dpp v157, v157, v157 quad_perm:[2,3,0,1] row_mask:0xf bank_mask:0xf
    v_add_f32_dpp v152, v152, v152 row_half_mirror row_mask:0xf bank_mask:0xf
    v_add_f32_dpp v153, v153, v153 row_half_mirror row_mask:0xf bank_mask:0xf
    v_add_f32_dpp v156, v156, v156 row_half_mirror row_mask:0xf bank_mask:0xf
    v_add_f32_dpp v157, v157, v157 row_half_mirror row_mask:0xf bank_mask:0xf
    v_add_f32_dpp v152, v152, v152 row_mirror row_mask:0xf bank_mask:0xf
    v_add_f32_dpp v153, v153, v153 row_mirror row_mask:0xf bank_mask:0xf
    v_add_f32_dpp v156, v156, v156 row_mirror row_mask:0xf bank_mask:0xf
    v_add_f32_dpp v157, v157, v157 row_mirror row_mask:0xf bank_mask:0xf
    v_mov_b32 v154, v152
    v_mov_b32 v155, v153
    v_mov_b32 v158, v156
    v_mov_b32 v159, v157
    v_permlane32_swap_b32 v152, v154
    v_permlane32_swap_b32 v153, v155
    v_permlane32_swap_b32 v156, v158
    v_permlane32_swap_b32 v157, v159
    v_add_f32 v152, v152, v154
    v_add_f32 v153, v153, v155
    v_add_f32 v156, v156, v158
    v_add_f32 v157, v157, v159
    v_mov_b32 v154, v152
    v_mov_b32 v155, v153
    v_mov_b32 v158, v156
    v_mov_b32 v159, v157
    v_permlane16_swap_b32 v152, v154
    v_permlane16_swap_b32 v153, v155
    v_permlane16_swap_b32 v156, v158
    v_permlane16_swap_b32 v157, v159
    v_add_f32 v152, v152, v154
    v_add_f32 v153, v153, v155
    v_add_f32 v156, v156, v158
    v_add_f32 v157, v157, v159
    v_mul_f32 v152, 0x3a800000, v152
    v_mul_f32 v153, 0x3a800000, v153
    v_mul_f32 v156, 0x3a800000, v156
    v_mul_f32 v157, 0x3a800000, v157
    v_fma_f32 v153, -v152, v152, v153
    v_fma_f32 v157, -v156, v156, v157
    v_max_f32 v153, 0, v153
    v_max_f32 v157, 0, v157
    v_cvt_pk_bf16_f32 v154, v152, v153
    v_lshlrev_b32 v152, 16, v154
    v_and_b32 v153, 0xffff0000, v154
    v_cvt_pk_bf16_f32 v158, v156, v157
    v_lshlrev_b32 v156, 16, v158
    v_and_b32 v157, 0xffff0000, v158
    v_add_f32 v153, 0x3727c5ac, v153
    v_add_f32 v157, 0x3727c5ac, v157
    v_cvt_pk_bf16_f32 v154, v153, v153
    v_lshlrev_b32 v153, 16, v154
    v_cvt_pk_bf16_f32 v158, v157, v157
    v_lshlrev_b32 v157, 16, v158
    v_sqrt_f32 v153, v153
    v_sqrt_f32 v157, v157
    v_cvt_pk_bf16_f32 v154, v153, v153
    v_lshlrev_b32 v153, 16, v154
    v_cvt_pk_bf16_f32 v158, v157, v157
    v_lshlrev_b32 v157, 16, v158
    v_lshrrev_b32 v153, 16, v153
    v_or_b32 v160, v152, v153
    v_mov_b32 v161, s0
    v_lshrrev_b32 v157, 16, v157
    v_or_b32 v162, v156, v157
    v_mov_b32 v163, s0
    s_lshl_b32 s64, s44, 4
    s_add_u32 s64, s64, 150528
    v_mov_b32 v2, s64
    v_mov_b32 v3, 148500
    v_mov_b32 v4, 1
    s_mov_b64 exec, 1
    ds_write_b128 v2, v[160:163]
    ds_add_rtn_u32 v5, v3, v4
    s_mov_b64 exec, 15
    v_lshlrev_b32 v2, 4, v1
    v_add_u32 v3, 150528, v2
    ds_read_b128 v[164:167], v3
    s_lshr_b32 s64, s62, 2
    s_lshl_b32 s64, s64, 7
    s_add_u32 s64, s64, 0x10000
    s_waitcnt lgkmcnt(0)
    v_readfirstlane_b32 s65, v5
    s_nop 3
    s_cmp_eq_u32 s65, 3
    s_cselect_b32 s64, s64, 0x80000000
    v_add_u32 v2, s64, v2
    buffer_store_dwordx4 v[164:167], v2, s[28:31], 0 offen sc1
    s_mov_b64 exec, -1
    s_mov_b32 s64, 0x0
    buffer_load_dwordx4 v[80:83], v8, s[40:43], s64 offen
    s_mov_b32 s64, 0x10000
    buffer_load_dwordx4 v[84:87], v8, s[40:43], s64 offen
    s_mov_b32 s64, 0x20000
    buffer_load_dwordx4 v[88:91], v8, s[40:43], s64 offen
    s_mov_b32 s64, 0x30000
    buffer_load_dwordx4 v[92:95], v8, s[40:43], s64 offen
    buffer_load_dwordx4 v[96:99], v9, s[40:43], 0 offen
    v_mov_b32 v74, -1
    v_mov_b32 v75, -1
    s_lshl_b32 s64, s48, 8
    s_mov_b32 exec_hi, 0
    buffer_store_dwordx2 v[74:75], v198, s[28:31], s64 offen sc1
    s_mov_b32 exec_hi, -1
    s_mov_b32 s40, s18
    s_mov_b32 s41, s19
    s_mov_b32 s42, 0x800
    s_mov_b32 s43, 0x20000
    buffer_load_ushort v24, v18, s[40:43], 0 offen offset:0
    buffer_load_ushort v25, v18, s[40:43], 0 offen offset:64
    buffer_load_ushort v26, v18, s[40:43], 0 offen offset:128
    buffer_load_ushort v27, v18, s[40:43], 0 offen offset:192
    buffer_load_ushort v28, v18, s[40:43], 0 offen offset:256
    buffer_load_ushort v29, v18, s[40:43], 0 offen offset:320
    buffer_load_ushort v30, v18, s[40:43], 0 offen offset:384
    buffer_load_ushort v31, v18, s[40:43], 0 offen offset:448
    buffer_load_dwordx2 v[168:169], v12, s[28:31], 0 offen offset:0 sc1
    buffer_load_dwordx2 v[170:171], v12, s[28:31], 0 offen offset:512 sc1
    buffer_load_dwordx2 v[172:173], v12, s[28:31], 0 offen offset:1024 sc1
    buffer_load_dwordx2 v[174:175], v12, s[28:31], 0 offen offset:1536 sc1
    buffer_load_dwordx2 v[176:177], v13, s[28:31], 0 offen sc1
    s_waitcnt vmcnt(14)
    v_lshlrev_b32 v120, 16, v80
    v_and_b32 v121, 0xffff0000, v80
    v_lshlrev_b32 v122, 16, v81
    v_and_b32 v123, 0xffff0000, v81
    v_lshlrev_b32 v124, 16, v82
    v_and_b32 v125, 0xffff0000, v82
    v_lshlrev_b32 v126, 16, v83
    v_and_b32 v127, 0xffff0000, v83
    v_lshlrev_b32 v128, 16, v84
    v_and_b32 v129, 0xffff0000, v84
    v_lshlrev_b32 v130, 16, v85
    v_and_b32 v131, 0xffff0000, v85
    v_lshlrev_b32 v132, 16, v86
    v_and_b32 v133, 0xffff0000, v86
    v_lshlrev_b32 v134, 16, v87
    v_and_b32 v135, 0xffff0000, v87
    v_lshlrev_b32 v136, 16, v88
    v_and_b32 v137, 0xffff0000, v88
    v_lshlrev_b32 v138, 16, v89
    v_and_b32 v139, 0xffff0000, v89
    v_lshlrev_b32 v140, 16, v90
    v_and_b32 v141, 0xffff0000, v90
    v_lshlrev_b32 v142, 16, v91
    v_and_b32 v143, 0xffff0000, v91
    v_lshlrev_b32 v144, 16, v92
    v_and_b32 v145, 0xffff0000, v92
    v_lshlrev_b32 v146, 16, v93
    v_and_b32 v147, 0xffff0000, v93
    v_lshlrev_b32 v148, 16, v94
    v_and_b32 v149, 0xffff0000, v94
    v_lshlrev_b32 v150, 16, v95
    v_and_b32 v151, 0xffff0000, v95
    v_lshlrev_b32 v152, 16, v96
    v_and_b32 v153, 0xffff0000, v96
    v_lshlrev_b32 v154, 16, v97
    v_and_b32 v155, 0xffff0000, v97
    v_lshlrev_b32 v156, 16, v98
    v_and_b32 v157, 0xffff0000, v98
    v_lshlrev_b32 v158, 16, v99
    v_and_b32 v159, 0xffff0000, v99
    s_waitcnt vmcnt(0)
    s_mov_b32 s3, 0x40000
M_s1_chk:
    v_xor_b32 v72, s0, v169
    v_xor_b32 v73, s0, v171
    v_xor_b32 v74, s0, v173
    v_xor_b32 v75, s0, v175
    v_xor_b32 v76, s0, v177
    v_or3_b32 v72, v72, v73, v74
    v_or3_b32 v72, v72, v75, v76
    v_cmp_ne_u32 vcc, 0, v72
    s_nop 4
    s_cbranch_vccz M_s1_ok
    s_sub_u32 s3, s3, 1
    s_cbranch_scc1 M_s1_ok
    s_sleep 2
    v_cmp_ne_u32 vcc, s0, v169
    s_nop 4
    s_mov_b64 exec, vcc
    buffer_load_dwordx2 v[168:169], v12, s[28:31], 0 offen offset:0 sc1
    s_mov_b64 exec, -1
    v_cmp_ne_u32 vcc, s0, v171
    s_nop 4
    s_mov_b64 exec, vcc
    buffer_load_dwordx2 v[170:171], v12, s[28:31], 0 offen offset:512 sc1
    s_mov_b64 exec, -1
    v_cmp_ne_u32 vcc, s0, v173
    s_nop 4
    s_mov_b64 exec, vcc
    buffer_load_dwordx2 v[172:173], v12, s[28:31], 0 offen offset:1024 sc1
    s_mov_b64 exec, -1
    v_cmp_ne_u32 vcc, s0, v175
    s_nop 4
    s_mov_b64 exec, vcc
    buffer_load_dwordx2 v[174:175], v12, s[28:31], 0 offen offset:1536 sc1
    s_mov_b64 exec, -1
    v_cmp_ne_u32 vcc, s0, v177
    s_nop 4
    s_mov_b64 exec, vcc
    buffer_load_dwordx2 v[176:177], v13, s[28:31], 0 offen sc1
    s_mov_b64 exec, -1
    s_waitcnt vmcnt(0)
    s_branch M_s1_chk
M_s1_ok:
    v_lshlrev_b32 v169, 16, v168
    v_and_b32 v168, 0xffff0000, v168
    v_lshlrev_b32 v171, 16, v170
    v_and_b32 v170, 0xffff0000, v170
    v_lshlrev_b32 v173, 16, v172
    v_and_b32 v172, 0xffff0000, v172
    v_lshlrev_b32 v175, 16, v174
    v_and_b32 v174, 0xffff0000, v174
    v_lshlrev_b32 v177, 16, v176
    v_and_b32 v176, 0xffff0000, v176
    v_rcp_f32 v169, v169
    v_rcp_f32 v171, v171
    v_rcp_f32 v173, v173
    v_rcp_f32 v175, v175
    v_rcp_f32 v177, v177
    v_pk_add_f32 v[120:121], v[120:121], v[168:169] op_sel_hi:[1,0] neg_lo:[0,1] neg_hi:[0,1]
    v_pk_add_f32 v[122:123], v[122:123], v[168:169] op_sel_hi:[1,0] neg_lo:[0,1] neg_hi:[0,1]
    v_pk_add_f32 v[124:125], v[124:125], v[168:169] op_sel_hi:[1,0] neg_lo:[0,1] neg_hi:[0,1]
    v_pk_add_f32 v[126:127], v[126:127], v[168:169] op_sel_hi:[1,0] neg_lo:[0,1] neg_hi:[0,1]
    v_cvt_pk_bf16_f32 v72, v120, v121
    v_lshlrev_b32 v120, 16, v72
    v_and_b32 v121, 0xffff0000, v72
    v_cvt_pk_bf16_f32 v73, v122, v123
    v_lshlrev_b32 v122, 16, v73
    v_and_b32 v123, 0xffff0000, v73
    v_cvt_pk_bf16_f32 v74, v124, v125
    v_lshlrev_b32 v124, 16, v74
    v_and_b32 v125, 0xffff0000, v74
    v_cvt_pk_bf16_f32 v75, v126, v127
    v_lshlrev_b32 v126, 16, v75
    v_and_b32 v127, 0xffff0000, v75
    v_pk_mul_f32 v[120:121], v[120:121], v[168:169] op_sel:[0,1] op_sel_hi:[1,1]
    v_pk_mul_f32 v[122:123], v[122:123], v[168:169] op_sel:[0,1] op_sel_hi:[1,1]
    v_pk_mul_f32 v[124:125], v[124:125], v[168:169] op_sel:[0,1] op_sel_hi:[1,1]
    v_pk_mul_f32 v[126:127], v[126:127], v[168:169] op_sel:[0,1] op_sel_hi:[1,1]
    v_cvt_pk_bf16_f32 v72, v120, v121
    v_lshlrev_b32 v120, 16, v72
    v_and_b32 v121, 0xffff0000, v72
    v_cvt_pk_bf16_f32 v73, v122, v123
    v_lshlrev_b32 v122, 16, v73
    v_and_b32 v123, 0xffff0000, v73
    v_cvt_pk_bf16_f32 v74, v124, v125
    v_lshlrev_b32 v124, 16, v74
    v_and_b32 v125, 0xffff0000, v74
    v_cvt_pk_bf16_f32 v75, v126, v127
    v_lshlrev_b32 v126, 16, v75
    v_and_b32 v127, 0xffff0000, v75
    v_pk_add_f32 v[128:129], v[128:129], v[170:171] op_sel_hi:[1,0] neg_lo:[0,1] neg_hi:[0,1]
    v_pk_add_f32 v[130:131], v[130:131], v[170:171] op_sel_hi:[1,0] neg_lo:[0,1] neg_hi:[0,1]
    v_pk_add_f32 v[132:133], v[132:133], v[170:171] op_sel_hi:[1,0] neg_lo:[0,1] neg_hi:[0,1]
    v_pk_add_f32 v[134:135], v[134:135], v[170:171] op_sel_hi:[1,0] neg_lo:[0,1] neg_hi:[0,1]
    v_cvt_pk_bf16_f32 v72, v128, v129
    v_lshlrev_b32 v128, 16, v72
    v_and_b32 v129, 0xffff0000, v72
    v_cvt_pk_bf16_f32 v73, v130, v131
    v_lshlrev_b32 v130, 16, v73
    v_and_b32 v131, 0xffff0000, v73
    v_cvt_pk_bf16_f32 v74, v132, v133
    v_lshlrev_b32 v132, 16, v74
    v_and_b32 v133, 0xffff0000, v74
    v_cvt_pk_bf16_f32 v75, v134, v135
    v_lshlrev_b32 v134, 16, v75
    v_and_b32 v135, 0xffff0000, v75
    v_pk_mul_f32 v[128:129], v[128:129], v[170:171] op_sel:[0,1] op_sel_hi:[1,1]
    v_pk_mul_f32 v[130:131], v[130:131], v[170:171] op_sel:[0,1] op_sel_hi:[1,1]
    v_pk_mul_f32 v[132:133], v[132:133], v[170:171] op_sel:[0,1] op_sel_hi:[1,1]
    v_pk_mul_f32 v[134:135], v[134:135], v[170:171] op_sel:[0,1] op_sel_hi:[1,1]
    v_cvt_pk_bf16_f32 v72, v128, v129
    v_lshlrev_b32 v128, 16, v72
    v_and_b32 v129, 0xffff0000, v72
    v_cvt_pk_bf16_f32 v73, v130, v131
    v_lshlrev_b32 v130, 16, v73
    v_and_b32 v131, 0xffff0000, v73
    v_cvt_pk_bf16_f32 v74, v132, v133
    v_lshlrev_b32 v132, 16, v74
    v_and_b32 v133, 0xffff0000, v74
    v_cvt_pk_bf16_f32 v75, v134, v135
    v_lshlrev_b32 v134, 16, v75
    v_and_b32 v135, 0xffff0000, v75
    v_pk_add_f32 v[136:137], v[136:137], v[172:173] op_sel_hi:[1,0] neg_lo:[0,1] neg_hi:[0,1]
    v_pk_add_f32 v[138:139], v[138:139], v[172:173] op_sel_hi:[1,0] neg_lo:[0,1] neg_hi:[0,1]
    v_pk_add_f32 v[140:141], v[140:141], v[172:173] op_sel_hi:[1,0] neg_lo:[0,1] neg_hi:[0,1]
    v_pk_add_f32 v[142:143], v[142:143], v[172:173] op_sel_hi:[1,0] neg_lo:[0,1] neg_hi:[0,1]
    v_cvt_pk_bf16_f32 v72, v136, v137
    v_lshlrev_b32 v136, 16, v72
    v_and_b32 v137, 0xffff0000, v72
    v_cvt_pk_bf16_f32 v73, v138, v139
    v_lshlrev_b32 v138, 16, v73
    v_and_b32 v139, 0xffff0000, v73
    v_cvt_pk_bf16_f32 v74, v140, v141
    v_lshlrev_b32 v140, 16, v74
    v_and_b32 v141, 0xffff0000, v74
    v_cvt_pk_bf16_f32 v75, v142, v143
    v_lshlrev_b32 v142, 16, v75
    v_and_b32 v143, 0xffff0000, v75
    v_pk_mul_f32 v[136:137], v[136:137], v[172:173] op_sel:[0,1] op_sel_hi:[1,1]
    v_pk_mul_f32 v[138:139], v[138:139], v[172:173] op_sel:[0,1] op_sel_hi:[1,1]
    v_pk_mul_f32 v[140:141], v[140:141], v[172:173] op_sel:[0,1] op_sel_hi:[1,1]
    v_pk_mul_f32 v[142:143], v[142:143], v[172:173] op_sel:[0,1] op_sel_hi:[1,1]
    v_cvt_pk_bf16_f32 v72, v136, v137
    v_lshlrev_b32 v136, 16, v72
    v_and_b32 v137, 0xffff0000, v72
    v_cvt_pk_bf16_f32 v73, v138, v139
    v_lshlrev_b32 v138, 16, v73
    v_and_b32 v139, 0xffff0000, v73
    v_cvt_pk_bf16_f32 v74, v140, v141
    v_lshlrev_b32 v140, 16, v74
    v_and_b32 v141, 0xffff0000, v74
    v_cvt_pk_bf16_f32 v75, v142, v143
    v_lshlrev_b32 v142, 16, v75
    v_and_b32 v143, 0xffff0000, v75
    v_pk_add_f32 v[144:145], v[144:145], v[174:175] op_sel_hi:[1,0] neg_lo:[0,1] neg_hi:[0,1]
    v_pk_add_f32 v[146:147], v[146:147], v[174:175] op_sel_hi:[1,0] neg_lo:[0,1] neg_hi:[0,1]
    v_pk_add_f32 v[148:149], v[148:149], v[174:175] op_sel_hi:[1,0] neg_lo:[0,1] neg_hi:[0,1]
    v_pk_add_f32 v[150:151], v[150:151], v[174:175] op_sel_hi:[1,0] neg_lo:[0,1] neg_hi:[0,1]
    v_cvt_pk_bf16_f32 v72, v144, v145
    v_lshlrev_b32 v144, 16, v72
    v_and_b32 v145, 0xffff0000, v72
    v_cvt_pk_bf16_f32 v73, v146, v147
    v_lshlrev_b32 v146, 16, v73
    v_and_b32 v147, 0xffff0000, v73
    v_cvt_pk_bf16_f32 v74, v148, v149
    v_lshlrev_b32 v148, 16, v74
    v_and_b32 v149, 0xffff0000, v74
    v_cvt_pk_bf16_f32 v75, v150, v151
    v_lshlrev_b32 v150, 16, v75
    v_and_b32 v151, 0xffff0000, v75
    v_pk_mul_f32 v[144:145], v[144:145], v[174:175] op_sel:[0,1] op_sel_hi:[1,1]
    v_pk_mul_f32 v[146:147], v[146:147], v[174:175] op_sel:[0,1] op_sel_hi:[1,1]
    v_pk_mul_f32 v[148:149], v[148:149], v[174:175] op_sel:[0,1] op_sel_hi:[1,1]
    v_pk_mul_f32 v[150:151], v[150:151], v[174:175] op_sel:[0,1] op_sel_hi:[1,1]
    v_cvt_pk_bf16_f32 v72, v144, v145
    v_lshlrev_b32 v144, 16, v72
    v_and_b32 v145, 0xffff0000, v72
    v_cvt_pk_bf16_f32 v73, v146, v147
    v_lshlrev_b32 v146, 16, v73
    v_and_b32 v147, 0xffff0000, v73
    v_cvt_pk_bf16_f32 v74, v148, v149
    v_lshlrev_b32 v148, 16, v74
    v_and_b32 v149, 0xffff0000, v74
    v_cvt_pk_bf16_f32 v75, v150, v151
    v_lshlrev_b32 v150, 16, v75
    v_and_b32 v151, 0xffff0000, v75
    v_pk_add_f32 v[152:153], v[152:153], v[176:177] op_sel_hi:[1,0] neg_lo:[0,1] neg_hi:[0,1]
    v_pk_add_f32 v[154:155], v[154:155], v[176:177] op_sel_hi:[1,0] neg_lo:[0,1] neg_hi:[0,1]
    v_pk_add_f32 v[156:157], v[156:157], v[176:177] op_sel_hi:[1,0] neg_lo:[0,1] neg_hi:[0,1]
    v_pk_add_f32 v[158:159], v[158:159], v[176:177] op_sel_hi:[1,0] neg_lo:[0,1] neg_hi:[0,1]
    v_cvt_pk_bf16_f32 v72, v152, v153
    v_lshlrev_b32 v152, 16, v72
    v_and_b32 v153, 0xffff0000, v72
    v_cvt_pk_bf16_f32 v73, v154, v155
    v_lshlrev_b32 v154, 16, v73
    v_and_b32 v155, 0xffff0000, v73
    v_cvt_pk_bf16_f32 v74, v156, v157
    v_lshlrev_b32 v156, 16, v74
    v_and_b32 v157, 0xffff0000, v74
    v_cvt_pk_bf16_f32 v75, v158, v159
    v_lshlrev_b32 v158, 16, v75
    v_and_b32 v159, 0xffff0000, v75
    v_pk_mul_f32 v[152:153], v[152:153], v[176:177] op_sel:[0,1] op_sel_hi:[1,1]
    v_pk_mul_f32 v[154:155], v[154:155], v[176:177] op_sel:[0,1] op_sel_hi:[1,1]
    v_pk_mul_f32 v[156:157], v[156:157], v[176:177] op_sel:[0,1] op_sel_hi:[1,1]
    v_pk_mul_f32 v[158:159], v[158:159], v[176:177] op_sel:[0,1] op_sel_hi:[1,1]
    v_cvt_pk_bf16_f32 v72, v152, v153
    v_lshlrev_b32 v152, 16, v72
    v_and_b32 v153, 0xffff0000, v72
    v_cvt_pk_bf16_f32 v73, v154, v155
    v_lshlrev_b32 v154, 16, v73
    v_and_b32 v155, 0xffff0000, v73
    v_cvt_pk_bf16_f32 v74, v156, v157
    v_lshlrev_b32 v156, 16, v74
    v_and_b32 v157, 0xffff0000, v74
    v_cvt_pk_bf16_f32 v75, v158, v159
    v_lshlrev_b32 v158, 16, v75
    v_and_b32 v159, 0xffff0000, v75
    s_lshl_b32 s68, s47, 9
    s_add_u32 s68, s68, 0x58000
    s_add_u32 s62, s26, s68
    s_addc_u32 s63, s27, 0
    s_lshr_b32 s68, s48, 2
    s_lshl_b32 s68, s68, 7
    v_mov_b32 v2, 1
    v_mov_b32 v5, 148496
    s_barrier
    ds_read_b128 v[32:35], v14 offset:0
    ds_read_b128 v[36:39], v14 offset:16
    ds_read_b128 v[40:43], v14 offset:256
    ds_read_b128 v[44:47], v14 offset:272
    s_waitcnt lgkmcnt(0)
    v_pk_mul_f32 v[120:121], v[120:121], v[40:41]
    v_pk_mul_f32 v[122:123], v[122:123], v[42:43]
    v_pk_mul_f32 v[124:125], v[124:125], v[44:45]
    v_pk_mul_f32 v[126:127], v[126:127], v[46:47]
    v_cvt_pk_bf16_f32 v72, v120, v121
    v_lshlrev_b32 v120, 16, v72
    v_and_b32 v121, 0xffff0000, v72
    v_cvt_pk_bf16_f32 v73, v122, v123
    v_lshlrev_b32 v122, 16, v73
    v_and_b32 v123, 0xffff0000, v73
    v_cvt_pk_bf16_f32 v74, v124, v125
    v_lshlrev_b32 v124, 16, v74
    v_and_b32 v125, 0xffff0000, v74
    v_cvt_pk_bf16_f32 v75, v126, v127
    v_lshlrev_b32 v126, 16, v75
    v_and_b32 v127, 0xffff0000, v75
    v_pk_add_f32 v[120:121], v[120:121], v[32:33]
    v_pk_add_f32 v[122:123], v[122:123], v[34:35]
    v_pk_add_f32 v[124:125], v[124:125], v[36:37]
    v_pk_add_f32 v[126:127], v[126:127], v[38:39]
    v_cvt_pk_bf16_f32 v80, v120, v121
    v_cvt_pk_bf16_f32 v81, v122, v123
    v_cvt_pk_bf16_f32 v82, v124, v125
    v_cvt_pk_bf16_f32 v83, v126, v127
    s_mov_b32 s64, 0x0
    buffer_store_dwordx4 v[80:83], v10, s[28:31], s64 offen sc1
    v_pk_mul_f32 v[128:129], v[128:129], v[40:41]
    v_pk_mul_f32 v[130:131], v[130:131], v[42:43]
    v_pk_mul_f32 v[132:133], v[132:133], v[44:45]
    v_pk_mul_f32 v[134:135], v[134:135], v[46:47]
    v_cvt_pk_bf16_f32 v72, v128, v129
    v_lshlrev_b32 v128, 16, v72
    v_and_b32 v129, 0xffff0000, v72
    v_cvt_pk_bf16_f32 v73, v130, v131
    v_lshlrev_b32 v130, 16, v73
    v_and_b32 v131, 0xffff0000, v73
    v_cvt_pk_bf16_f32 v74, v132, v133
    v_lshlrev_b32 v132, 16, v74
    v_and_b32 v133, 0xffff0000, v74
    v_cvt_pk_bf16_f32 v75, v134, v135
    v_lshlrev_b32 v134, 16, v75
    v_and_b32 v135, 0xffff0000, v75
    v_pk_add_f32 v[128:129], v[128:129], v[32:33]
    v_pk_add_f32 v[130:131], v[130:131], v[34:35]
    v_pk_add_f32 v[132:133], v[132:133], v[36:37]
    v_pk_add_f32 v[134:135], v[134:135], v[38:39]
    v_cvt_pk_bf16_f32 v84, v128, v129
    v_cvt_pk_bf16_f32 v85, v130, v131
    v_cvt_pk_bf16_f32 v86, v132, v133
    v_cvt_pk_bf16_f32 v87, v134, v135
    s_mov_b32 s64, 0x10000
    buffer_store_dwordx4 v[84:87], v10, s[28:31], s64 offen sc1
    v_pk_mul_f32 v[136:137], v[136:137], v[40:41]
    v_pk_mul_f32 v[138:139], v[138:139], v[42:43]
    v_pk_mul_f32 v[140:141], v[140:141], v[44:45]
    v_pk_mul_f32 v[142:143], v[142:143], v[46:47]
    v_cvt_pk_bf16_f32 v72, v136, v137
    v_lshlrev_b32 v136, 16, v72
    v_and_b32 v137, 0xffff0000, v72
    v_cvt_pk_bf16_f32 v73, v138, v139
    v_lshlrev_b32 v138, 16, v73
    v_and_b32 v139, 0xffff0000, v73
    v_cvt_pk_bf16_f32 v74, v140, v141
    v_lshlrev_b32 v140, 16, v74
    v_and_b32 v141, 0xffff0000, v74
    v_cvt_pk_bf16_f32 v75, v142, v143
    v_lshlrev_b32 v142, 16, v75
    v_and_b32 v143, 0xffff0000, v75
    v_pk_add_f32 v[136:137], v[136:137], v[32:33]
    v_pk_add_f32 v[138:139], v[138:139], v[34:35]
    v_pk_add_f32 v[140:141], v[140:141], v[36:37]
    v_pk_add_f32 v[142:143], v[142:143], v[38:39]
    v_cvt_pk_bf16_f32 v88, v136, v137
    v_cvt_pk_bf16_f32 v89, v138, v139
    v_cvt_pk_bf16_f32 v90, v140, v141
    v_cvt_pk_bf16_f32 v91, v142, v143
    s_mov_b32 s64, 0x20000
    buffer_store_dwordx4 v[88:91], v10, s[28:31], s64 offen sc1
    v_pk_mul_f32 v[144:145], v[144:145], v[40:41]
    v_pk_mul_f32 v[146:147], v[146:147], v[42:43]
    v_pk_mul_f32 v[148:149], v[148:149], v[44:45]
    v_pk_mul_f32 v[150:151], v[150:151], v[46:47]
    v_cvt_pk_bf16_f32 v72, v144, v145
    v_lshlrev_b32 v144, 16, v72
    v_and_b32 v145, 0xffff0000, v72
    v_cvt_pk_bf16_f32 v73, v146, v147
    v_lshlrev_b32 v146, 16, v73
    v_and_b32 v147, 0xffff0000, v73
    v_cvt_pk_bf16_f32 v74, v148, v149
    v_lshlrev_b32 v148, 16, v74
    v_and_b32 v149, 0xffff0000, v74
    v_cvt_pk_bf16_f32 v75, v150, v151
    v_lshlrev_b32 v150, 16, v75
    v_and_b32 v151, 0xffff0000, v75
    v_pk_add_f32 v[144:145], v[144:145], v[32:33]
    v_pk_add_f32 v[146:147], v[146:147], v[34:35]
    v_pk_add_f32 v[148:149], v[148:149], v[36:37]
    v_pk_add_f32 v[150:151], v[150:151], v[38:39]
    v_cvt_pk_bf16_f32 v92, v144, v145
    v_cvt_pk_bf16_f32 v93, v146, v147
    v_cvt_pk_bf16_f32 v94, v148, v149
    v_cvt_pk_bf16_f32 v95, v150, v151
    s_mov_b32 s64, 0x30000
    buffer_store_dwordx4 v[92:95], v10, s[28:31], s64 offen sc1
    v_pk_mul_f32 v[152:153], v[152:153], v[40:41]
    v_pk_mul_f32 v[154:155], v[154:155], v[42:43]
    v_pk_mul_f32 v[156:157], v[156:157], v[44:45]
    v_pk_mul_f32 v[158:159], v[158:159], v[46:47]
    v_cvt_pk_bf16_f32 v72, v152, v153
    v_lshlrev_b32 v152, 16, v72
    v_and_b32 v153, 0xffff0000, v72
    v_cvt_pk_bf16_f32 v73, v154, v155
    v_lshlrev_b32 v154, 16, v73
    v_and_b32 v155, 0xffff0000, v73
    v_cvt_pk_bf16_f32 v74, v156, v157
    v_lshlrev_b32 v156, 16, v74
    v_and_b32 v157, 0xffff0000, v74
    v_cvt_pk_bf16_f32 v75, v158, v159
    v_lshlrev_b32 v158, 16, v75
    v_and_b32 v159, 0xffff0000, v75
    v_pk_add_f32 v[152:153], v[152:153], v[32:33]
    v_pk_add_f32 v[154:155], v[154:155], v[34:35]
    v_pk_add_f32 v[156:157], v[156:157], v[36:37]
    v_pk_add_f32 v[158:159], v[158:159], v[38:39]
    v_cvt_pk_bf16_f32 v96, v152, v153
    v_cvt_pk_bf16_f32 v97, v154, v155
    v_cvt_pk_bf16_f32 v98, v156, v157
    v_cvt_pk_bf16_f32 v99, v158, v159
    buffer_store_dwordx4 v[96:99], v11, s[28:31], 0 offen sc1
    s_and_b32 s57, s58, 15
    s_lshr_b64 s[58:59], s[58:59], 4
    s_lshl_b32 s56, s57, 11
    s_mul_i32 s57, s57, 0x60000
    s_add_u32 m0, s53, s74
    s_nop 0
    buffer_load_dwordx4 v187, s[32:35], s57 offen offset:0 lds
    buffer_load_dwordx4 v188, s[32:35], s57 offen offset:1024 lds
    buffer_load_dwordx4 v189, s[32:35], s57 offen offset:2048 lds
    buffer_load_dwordx4 v190, s[32:35], s57 offen offset:3072 lds
    s_add_u32 m0, s53, s75
    s_nop 0
    buffer_load_dwordx4 v191, s[32:35], s57 offen offset:0 lds
    buffer_load_dwordx4 v192, s[32:35], s57 offen offset:1024 lds
    s_add_u32 s53, s53, 49152
    s_cmp_ge_u32 s53, 147456
    s_cselect_b32 s53, 0, s53
    s_mov_b32 s53, 0
    s_bfe_u32 s66, s2, 0x30003
    s_lshr_b32 s55, s2, 6
    s_add_u32 s66, s66, s55
    s_and_b32 s66, s66, 3
    s_mov_b32 s58, 0x76453210
    s_mov_b32 s59, 0xfecdba89
    s_cmp_eq_u32 s66, 1
    s_cselect_b32 s58, 0x75643120, s58
    s_cselect_b32 s59, 0xfdecb9a8, s59
    s_cmp_eq_u32 s66, 2
    s_cselect_b32 s58, 0x67542310, s58
    s_cselect_b32 s59, 0xefdcab98, s59
    s_cmp_eq_u32 s66, 3
    s_cselect_b32 s58, 0x86534210, s58
    s_cselect_b32 s59, 0xfedbca97, s59
    s_waitcnt vmcnt(6)
    s_mov_b64 exec, 1
    ds_add_rtn_u32 v245, v5, v2
    s_mov_b64 exec, -1
    s_mov_b32 s1, 1
    s_mov_b32 s3, 0x40000
    s_waitcnt lgkmcnt(0)
    v_readfirstlane_b32 s64, v245
    s_nop 3
    s_cmp_lg_u32 s64, 3
    s_cbranch_scc1 M_p1_ok
    s_atomic_add s1, s[62:63], 0
    s_atomic_add s1, s[62:63], 128
    s_atomic_add s1, s[62:63], 256
    s_atomic_add s1, s[62:63], 384
M_p1_chk:
    s_load_dword s64, s[62:63], s68 glc
    s_sub_u32 s3, s3, 1
    s_cselect_b32 s65, 0, 16
    s_waitcnt lgkmcnt(0)
    s_cmp_lt_u32 s64, s65
    s_cbranch_scc1 M_p1_chk
M_p1_ok:
    s_barrier
    s_and_b32 s57, s58, 15
    s_lshr_b64 s[58:59], s[58:59], 4
    s_lshl_b32 s56, s57, 11
    s_mul_i32 s57, s57, 0x60000
    s_add_u32 m0, s53, s72
    s_nop 0
    buffer_load_dwordx4 v184, s[28:31], s56 offen offset:0 lds
    buffer_load_dwordx4 v184, s[28:31], s56 offen offset:1024 lds
    buffer_load_dwordx4 v185, s[28:31], s56 offen offset:2048 lds
    buffer_load_dwordx4 v185, s[28:31], s56 offen offset:3072 lds
    s_add_u32 m0, s53, s73
    s_mov_b32 exec_hi, 0
    buffer_load_dwordx4 v186, s[28:31], s56 offen offset:0 lds
    s_mov_b32 exec_hi, -1
    s_add_u32 s53, s53, 49152
    s_cmp_ge_u32 s53, 147456
    s_cselect_b32 s53, 0, s53
    s_and_b32 s57, s58, 15
    s_lshr_b64 s[58:59], s[58:59], 4
    s_lshl_b32 s56, s57, 11
    s_mul_i32 s57, s57, 0x60000
    s_add_u32 m0, s53, s74
    s_nop 0
    buffer_load_dwordx4 v187, s[32:35], s57 offen offset:0 lds
    buffer_load_dwordx4 v188, s[32:35], s57 offen offset:1024 lds
    buffer_load_dwordx4 v189, s[32:35], s57 offen offset:2048 lds
    buffer_load_dwordx4 v190, s[32:35], s57 offen offset:3072 lds
    s_add_u32 m0, s53, s75
    s_nop 0
    buffer_load_dwordx4 v191, s[32:35], s57 offen offset:0 lds
    buffer_load_dwordx4 v192, s[32:35], s57 offen offset:1024 lds
    s_add_u32 m0, s53, s72
    s_nop 0
    buffer_load_dwordx4 v184, s[28:31], s56 offen offset:0 lds
    buffer_load_dwordx4 v184, s[28:31], s56 offen offset:1024 lds
    buffer_load_dwordx4 v185, s[28:31], s56 offen offset:2048 lds
    buffer_load_dwordx4 v185, s[28:31], s56 offen offset:3072 lds
    s_add_u32 m0, s53, s73
    s_mov_b32 exec_hi, 0
    buffer_load_dwordx4 v186, s[28:31], s56 offen offset:0 lds
    s_mov_b32 exec_hi, -1
    s_add_u32 s53, s53, 49152
    s_cmp_ge_u32 s53, 147456
    s_cselect_b32 s53, 0, s53
    s_movk_i32 s54, 12
M_Q_loop0:
    s_waitcnt vmcnt(11)
    s_barrier
    s_and_b32 s57, s58, 15
    s_lshr_b64 s[58:59], s[58:59], 4
    s_lshl_b32 s56, s57, 11
    s_mul_i32 s57, s57, 0x60000
    s_add_u32 m0, s53, s74
    s_nop 0
    buffer_load_dwordx4 v187, s[32:35], s57 offen offset:0 lds
    buffer_load_dwordx4 v188, s[32:35], s57 offen offset:1024 lds
    buffer_load_dwordx4 v189, s[32:35], s57 offen offset:2048 lds
    buffer_load_dwordx4 v190, s[32:35], s57 offen offset:3072 lds
    s_add_u32 m0, s53, s75
    s_nop 0
    buffer_load_dwordx4 v191, s[32:35], s57 offen offset:0 lds
    buffer_load_dwordx4 v192, s[32:35], s57 offen offset:1024 lds
    s_add_u32 m0, s53, s72
    s_nop 0
    buffer_load_dwordx4 v184, s[28:31], s56 offen offset:0 lds
    buffer_load_dwordx4 v184, s[28:31], s56 offen offset:1024 lds
    buffer_load_dwordx4 v185, s[28:31], s56 offen offset:2048 lds
    buffer_load_dwordx4 v185, s[28:31], s56 offen offset:3072 lds
    s_add_u32 m0, s53, s73
    s_mov_b32 exec_hi, 0
    buffer_load_dwordx4 v186, s[28:31], s56 offen offset:0 lds
    s_mov_b32 exec_hi, -1
    s_add_u32 s53, s53, 49152
    s_cmp_ge_u32 s53, 147456
    s_cselect_b32 s53, 0, s53
    s_sub_u32 s54, s54, 1
    s_cbranch_scc0 M_Q_loop0
    s_waitcnt vmcnt(11)
    s_barrier
    s_and_b32 s57, s58, 15
    s_lshr_b64 s[58:59], s[58:59], 4
    s_lshl_b32 s56, s57, 11
    s_mul_i32 s57, s57, 0x60000
    s_add_u32 m0, s53, s74
    s_nop 0
    buffer_load_dwordx4 v187, s[32:35], s57 offen offset:0 lds
    buffer_load_dwordx4 v188, s[32:35], s57 offen offset:1024 lds
    buffer_load_dwordx4 v189, s[32:35], s57 offen offset:2048 lds
    buffer_load_dwordx4 v190, s[32:35], s57 offen offset:3072 lds
    s_add_u32 m0, s53, s75
    s_nop 0
    buffer_load_dwordx4 v191, s[32:35], s57 offen offset:0 lds
    buffer_load_dwordx4 v192, s[32:35], s57 offen offset:1024 lds
    s_add_u32 m0, s53, s72
    s_nop 0
    buffer_load_dwordx4 v184, s[28:31], s56 offen offset:0 lds
    buffer_load_dwordx4 v184, s[28:31], s56 offen offset:1024 lds
    buffer_load_dwordx4 v185, s[28:31], s56 offen offset:2048 lds
    buffer_load_dwordx4 v185, s[28:31], s56 offen offset:3072 lds
    s_add_u32 m0, s53, s73
    s_mov_b32 exec_hi, 0
    buffer_load_dwordx4 v186, s[28:31], s56 offen offset:0 lds
    s_mov_b32 exec_hi, -1
    s_add_u32 s53, s53, 49152
    s_cmp_ge_u32 s53, 147456
    s_cselect_b32 s53, 0, s53
    s_mov_b32 s64, 0x0
    buffer_load_dwordx4 v[32:35], v17, s[36:39], s64 offen
    s_mov_b32 s64, 0x60000
    buffer_load_dwordx4 v[36:39], v17, s[36:39], s64 offen
    s_mov_b32 s64, 0xc0000
    buffer_load_dwordx4 v[40:43], v17, s[36:39], s64 offen
    s_mov_b32 s64, 0x120000
    buffer_load_dwordx4 v[44:47], v17, s[36:39], s64 offen
    s_mov_b32 s64, 0x180000
    buffer_load_dwordx4 v[48:51], v17, s[36:39], s64 offen
    s_mov_b32 s64, 0x1e0000
    buffer_load_dwordx4 v[52:55], v17, s[36:39], s64 offen
    s_mov_b32 s64, 0x240000
    buffer_load_dwordx4 v[56:59], v17, s[36:39], s64 offen
    s_mov_b32 s64, 0x2a0000
    buffer_load_dwordx4 v[60:63], v17, s[36:39], s64 offen
    s_lshl_b32 s60, s44, 12
    s_add_u32 s61, s60, 147456
    s_add_u32 s53, s60, 49152
    s_lshl_b32 s70, s44, 11
    s_sub_u32 s70, 16384, s70
    s_bfe_u32 s66, s2, 0x30003
    s_lshr_b32 s55, s2, 6
    s_add_u32 s66, s66, s55
    s_and_b32 s66, s66, 3
    s_mov_b32 s58, 0x76453210
    s_mov_b32 s59, 0xfecdba89
    s_cmp_eq_u32 s66, 1
    s_cselect_b32 s58, 0x75643120, s58
    s_cselect_b32 s59, 0xfdecb9a8, s59
    s_cmp_eq_u32 s66, 2
    s_cselect_b32 s58, 0x67542310, s58
    s_cselect_b32 s59, 0xefdcab98, s59
    s_cmp_eq_u32 s66, 3
    s_cselect_b32 s58, 0x86534210, s58
    s_cselect_b32 s59, 0xfedbca97, s59
    s_mov_b32 s32, s8
    s_mov_b32 s33, s9
    s_mov_b32 s34, 0x200000
    s_mov_b32 s35, 0x20000
    s_waitcnt vmcnt(19)
    s_barrier
    s_waitcnt vmcnt(8)
    s_barrier
    s_barrier
    s_and_b32 s57, s58, 15
    s_lshr_b64 s[58:59], s[58:59], 4
    s_lshl_b32 s56, s57, 11
    s_mul_i32 s57, s57, 0x20000
    s_add_u32 m0, s53, s70
    s_nop 0
    buffer_load_dwordx4 v193, s[32:35], s57 offen offset:0 lds
    buffer_load_dwordx4 v194, s[32:35], s57 offen offset:1024 lds
    s_add_u32 s53, s53, 24576
    s_cmp_ge_u32 s53, s61
    s_cselect_b32 s53, s60, s53
    s_and_b32 s57, s58, 15
    s_lshr_b64 s[58:59], s[58:59], 4
    s_lshl_b32 s56, s57, 11
    s_mul_i32 s57, s57, 0x20000
    s_add_u32 m0, s53, s70
    s_nop 0
    buffer_load_dwordx4 v193, s[32:35], s57 offen offset:0 lds
    buffer_load_dwordx4 v194, s[32:35], s57 offen offset:1024 lds
    s_add_u32 s53, s53, 24576
    s_cmp_ge_u32 s53, s61
    s_cselect_b32 s53, s60, s53
    s_and_b32 s57, s58, 15
    s_lshr_b64 s[58:59], s[58:59], 4
    s_lshl_b32 s56, s57, 11
    s_mul_i32 s57, s57, 0x20000
    s_add_u32 m0, s53, s70
    s_nop 0
    buffer_load_dwordx4 v193, s[32:35], s57 offen offset:0 lds
    buffer_load_dwordx4 v194, s[32:35], s57 offen offset:1024 lds
    s_add_u32 s53, s53, 24576
    s_cmp_ge_u32 s53, s61
    s_cselect_b32 s53, s60, s53
    s_and_b32 s57, s58, 15
    s_lshr_b64 s[58:59], s[58:59], 4
    s_lshl_b32 s56, s57, 11
    s_mul_i32 s57, s57, 0x20000
    s_add_u32 m0, s53, s70
    s_nop 0
    buffer_load_dwordx4 v193, s[32:35], s57 offen offset:0 lds
    buffer_load_dwordx4 v194, s[32:35], s57 offen offset:1024 lds
    s_add_u32 s53, s53, 24576
    s_cmp_ge_u32 s53, s61
    s_cselect_b32 s53, s60, s53
    s_and_b32 s57, s58, 15
    s_lshr_b64 s[58:59], s[58:59], 4
    s_lshl_b32 s56, s57, 11
    s_mul_i32 s57, s57, 0x20000
    s_add_u32 m0, s53, s70
    s_nop 0
    buffer_load_dwordx4 v193, s[32:35], s57 offen offset:0 lds
    buffer_load_dwordx4 v194, s[32:35], s57 offen offset:1024 lds
    s_add_u32 s53, s53, 24576
    s_cmp_ge_u32 s53, s61
    s_cselect_b32 s53, s60, s53
    s_and_b32 s57, s58, 15
    s_lshr_b64 s[58:59], s[58:59], 4
    s_lshl_b32 s56, s57, 11
    s_mul_i32 s57, s57, 0x20000
    s_add_u32 m0, s53, s70
    s_nop 0
    buffer_load_dwordx4 v193, s[32:35], s57 offen offset:0 lds
    buffer_load_dwordx4 v194, s[32:35], s57 offen offset:1024 lds
    s_add_u32 s53, s53, 24576
    s_cmp_ge_u32 s53, s61
    s_cselect_b32 s53, s60, s53
    s_mov_b32 s40, s8
    s_mov_b32 s41, s9
    s_mov_b32 s42, 0x200000
    s_mov_b32 s43, 0x20000
    s_mov_b32 s64, 0x0
    buffer_load_dword v244, v243, s[40:43], s64 offen
    v_lshlrev_b32 v24, 16, v24
    v_lshlrev_b32 v25, 16, v25
    v_lshlrev_b32 v26, 16, v26
    v_lshlrev_b32 v27, 16, v27
    v_lshlrev_b32 v28, 16, v28
    v_lshlrev_b32 v29, 16, v29
    v_lshlrev_b32 v30, 16, v30
    v_lshlrev_b32 v31, 16, v31
    v_mul_f32 v72, 0xbfb8aa3b, v24
    v_mul_f32 v73, 0xbfb8aa3b, v25
    v_mul_f32 v74, 0xbfb8aa3b, v26
    v_mul_f32 v75, 0xbfb8aa3b, v27
    v_mul_f32 v76, 0xbfb8aa3b, v28
    v_mul_f32 v77, 0xbfb8aa3b, v29
    v_mul_f32 v78, 0xbfb8aa3b, v30
    v_mul_f32 v79, 0xbfb8aa3b, v31
    v_exp_f32 v72, v72
    v_exp_f32 v73, v73
    v_exp_f32 v74, v74
    v_exp_f32 v75, v75
    v_exp_f32 v76, v76
    v_exp_f32 v77, v77
    v_exp_f32 v78, v78
    v_exp_f32 v79, v79
    v_add_f32 v72, 1.0, v72
    v_add_f32 v73, 1.0, v73
    v_add_f32 v74, 1.0, v74
    v_add_f32 v75, 1.0, v75
    v_add_f32 v76, 1.0, v76
    v_add_f32 v77, 1.0, v77
    v_add_f32 v78, 1.0, v78
    v_add_f32 v79, 1.0, v79
    v_rcp_f32 v72, v72
    v_rcp_f32 v73, v73
    v_rcp_f32 v74, v74
    v_rcp_f32 v75, v75
    v_rcp_f32 v76, v76
    v_rcp_f32 v77, v77
    v_rcp_f32 v78, v78
    v_rcp_f32 v79, v79
    v_mul_f32 v24, v24, v72
    v_mul_f32 v25, v25, v73
    v_mul_f32 v26, v26, v74
    v_mul_f32 v27, v27, v75
    v_mul_f32 v28, v28, v76
    v_mul_f32 v29, v29, v77
    v_mul_f32 v30, v30, v78
    v_mul_f32 v31, v31, v79
    v_cvt_pk_bf16_f32 v72, v24, v24
    v_lshlrev_b32 v24, 16, v72
    v_cvt_pk_bf16_f32 v73, v25, v25
    v_lshlrev_b32 v25, 16, v73
    v_cvt_pk_bf16_f32 v74, v26, v26
    v_lshlrev_b32 v26, 16, v74
    v_cvt_pk_bf16_f32 v75, v27, v27
    v_lshlrev_b32 v27, 16, v75
    v_cvt_pk_bf16_f32 v76, v28, v28
    v_lshlrev_b32 v28, 16, v76
    v_cvt_pk_bf16_f32 v77, v29, v29
    v_lshlrev_b32 v29, 16, v77
    v_cvt_pk_bf16_f32 v78, v30, v30
    v_lshlrev_b32 v30, 16, v78
    v_cvt_pk_bf16_f32 v79, v31, v31
    v_lshlrev_b32 v31, 16, v79
    s_waitcnt vmcnt(20)
    v_lshlrev_b32 v72, 16, v32
    v_and_b32 v73, 0xffff0000, v32
    v_lshlrev_b32 v74, 16, v33
    v_and_b32 v75, 0xffff0000, v33
    v_lshlrev_b32 v76, 16, v34
    v_and_b32 v77, 0xffff0000, v34
    v_lshlrev_b32 v78, 16, v35
    v_and_b32 v79, 0xffff0000, v35
    v_mul_f32 v64, v24, v72
    v_mul_f32 v65, v24, v73
    v_mul_f32 v66, v24, v74
    v_mul_f32 v67, v24, v75
    v_mul_f32 v68, v24, v76
    v_mul_f32 v69, v24, v77
    v_mul_f32 v70, v24, v78
    v_mul_f32 v71, v24, v79
    s_waitcnt vmcnt(19)
    v_lshlrev_b32 v72, 16, v36
    v_and_b32 v73, 0xffff0000, v36
    v_lshlrev_b32 v74, 16, v37
    v_and_b32 v75, 0xffff0000, v37
    v_lshlrev_b32 v76, 16, v38
    v_and_b32 v77, 0xffff0000, v38
    v_lshlrev_b32 v78, 16, v39
    v_and_b32 v79, 0xffff0000, v39
    v_fmac_f32 v64, v25, v72
    v_fmac_f32 v65, v25, v73
    v_fmac_f32 v66, v25, v74
    v_fmac_f32 v67, v25, v75
    v_fmac_f32 v68, v25, v76
    v_fmac_f32 v69, v25, v77
    v_fmac_f32 v70, v25, v78
    v_fmac_f32 v71, v25, v79
    s_waitcnt vmcnt(18)
    v_lshlrev_b32 v72, 16, v40
    v_and_b32 v73, 0xffff0000, v40
    v_lshlrev_b32 v74, 16, v41
    v_and_b32 v75, 0xffff0000, v41
    v_lshlrev_b32 v76, 16, v42
    v_and_b32 v77, 0xffff0000, v42
    v_lshlrev_b32 v78, 16, v43
    v_and_b32 v79, 0xffff0000, v43
    v_fmac_f32 v64, v26, v72
    v_fmac_f32 v65, v26, v73
    v_fmac_f32 v66, v26, v74
    v_fmac_f32 v67, v26, v75
    v_fmac_f32 v68, v26, v76
    v_fmac_f32 v69, v26, v77
    v_fmac_f32 v70, v26, v78
    v_fmac_f32 v71, v26, v79
    s_waitcnt vmcnt(17)
    v_lshlrev_b32 v72, 16, v44
    v_and_b32 v73, 0xffff0000, v44
    v_lshlrev_b32 v74, 16, v45
    v_and_b32 v75, 0xffff0000, v45
    v_lshlrev_b32 v76, 16, v46
    v_and_b32 v77, 0xffff0000, v46
    v_lshlrev_b32 v78, 16, v47
    v_and_b32 v79, 0xffff0000, v47
    v_fmac_f32 v64, v27, v72
    v_fmac_f32 v65, v27, v73
    v_fmac_f32 v66, v27, v74
    v_fmac_f32 v67, v27, v75
    v_fmac_f32 v68, v27, v76
    v_fmac_f32 v69, v27, v77
    v_fmac_f32 v70, v27, v78
    v_fmac_f32 v71, v27, v79
    s_waitcnt vmcnt(16)
    v_lshlrev_b32 v72, 16, v48
    v_and_b32 v73, 0xffff0000, v48
    v_lshlrev_b32 v74, 16, v49
    v_and_b32 v75, 0xffff0000, v49
    v_lshlrev_b32 v76, 16, v50
    v_and_b32 v77, 0xffff0000, v50
    v_lshlrev_b32 v78, 16, v51
    v_and_b32 v79, 0xffff0000, v51
    v_fmac_f32 v64, v28, v72
    v_fmac_f32 v65, v28, v73
    v_fmac_f32 v66, v28, v74
    v_fmac_f32 v67, v28, v75
    v_fmac_f32 v68, v28, v76
    v_fmac_f32 v69, v28, v77
    v_fmac_f32 v70, v28, v78
    v_fmac_f32 v71, v28, v79
    s_waitcnt vmcnt(15)
    v_lshlrev_b32 v72, 16, v52
    v_and_b32 v73, 0xffff0000, v52
    v_lshlrev_b32 v74, 16, v53
    v_and_b32 v75, 0xffff0000, v53
    v_lshlrev_b32 v76, 16, v54
    v_and_b32 v77, 0xffff0000, v54
    v_lshlrev_b32 v78, 16, v55
    v_and_b32 v79, 0xffff0000, v55
    v_fmac_f32 v64, v29, v72
    v_fmac_f32 v65, v29, v73
    v_fmac_f32 v66, v29, v74
    v_fmac_f32 v67, v29, v75
    v_fmac_f32 v68, v29, v76
    v_fmac_f32 v69, v29, v77
    v_fmac_f32 v70, v29, v78
    v_fmac_f32 v71, v29, v79
    s_waitcnt vmcnt(14)
    v_lshlrev_b32 v72, 16, v56
    v_and_b32 v73, 0xffff0000, v56
    v_lshlrev_b32 v74, 16, v57
    v_and_b32 v75, 0xffff0000, v57
    v_lshlrev_b32 v76, 16, v58
    v_and_b32 v77, 0xffff0000, v58
    v_lshlrev_b32 v78, 16, v59
    v_and_b32 v79, 0xffff0000, v59
    v_fmac_f32 v64, v30, v72
    v_fmac_f32 v65, v30, v73
    v_fmac_f32 v66, v30, v74
    v_fmac_f32 v67, v30, v75
    v_fmac_f32 v68, v30, v76
    v_fmac_f32 v69, v30, v77
    v_fmac_f32 v70, v30, v78
    v_fmac_f32 v71, v30, v79
    s_waitcnt vmcnt(13)
    v_lshlrev_b32 v72, 16, v60
    v_and_b32 v73, 0xffff0000, v60
    v_lshlrev_b32 v74, 16, v61
    v_and_b32 v75, 0xffff0000, v61
    v_lshlrev_b32 v76, 16, v62
    v_and_b32 v77, 0xffff0000, v62
    v_lshlrev_b32 v78, 16, v63
    v_and_b32 v79, 0xffff0000, v63
    v_fmac_f32 v64, v31, v72
    v_fmac_f32 v65, v31, v73
    v_fmac_f32 v66, v31, v74
    v_fmac_f32 v67, v31, v75
    v_fmac_f32 v68, v31, v76
    v_fmac_f32 v69, v31, v77
    v_fmac_f32 v70, v31, v78
    v_fmac_f32 v71, v31, v79
    v_add_f32_dpp v64, v64, v64 row_ror:8 row_mask:0xf bank_mask:0xf
    v_add_f32_dpp v65, v65, v65 row_ror:8 row_mask:0xf bank_mask:0xf
    v_add_f32_dpp v66, v66, v66 row_ror:8 row_mask:0xf bank_mask:0xf
    v_add_f32_dpp v67, v67, v67 row_ror:8 row_mask:0xf bank_mask:0xf
    v_add_f32_dpp v68, v68, v68 row_ror:8 row_mask:0xf bank_mask:0xf
    v_add_f32_dpp v69, v69, v69 row_ror:8 row_mask:0xf bank_mask:0xf
    v_add_f32_dpp v70, v70, v70 row_ror:8 row_mask:0xf bank_mask:0xf
    v_add_f32_dpp v71, v71, v71 row_ror:8 row_mask:0xf bank_mask:0xf
    v_mov_b32 v72, v64
    v_mov_b32 v73, v65
    v_mov_b32 v74, v66
    v_mov_b32 v75, v67
    v_mov_b32 v76, v68
    v_mov_b32 v77, v69
    v_mov_b32 v78, v70
    v_mov_b32 v79, v71
    v_permlane32_swap_b32 v64, v72
    v_permlane32_swap_b32 v65, v73
    v_permlane32_swap_b32 v66, v74
    v_permlane32_swap_b32 v67, v75
    v_permlane32_swap_b32 v68, v76
    v_permlane32_swap_b32 v69, v77
    v_permlane32_swap_b32 v70, v78
    v_permlane32_swap_b32 v71, v79
    v_add_f32 v64, v64, v72
    v_add_f32 v65, v65, v73
    v_add_f32 v66, v66, v74
    v_add_f32 v67, v67, v75
    v_add_f32 v68, v68, v76
    v_add_f32 v69, v69, v77
    v_add_f32 v70, v70, v78
    v_add_f32 v71, v71, v79
    v_mov_b32 v72, v64
    v_mov_b32 v73, v65
    v_mov_b32 v74, v66
    v_mov_b32 v75, v67
    v_mov_b32 v76, v68
    v_mov_b32 v77, v69
    v_mov_b32 v78, v70
    v_mov_b32 v79, v71
    v_permlane16_swap_b32 v64, v72
    v_permlane16_swap_b32 v65, v73
    v_permlane16_swap_b32 v66, v74
    v_permlane16_swap_b32 v67, v75
    v_permlane16_swap_b32 v68, v76
    v_permlane16_swap_b32 v69, v77
    v_permlane16_swap_b32 v70, v78
    v_permlane16_swap_b32 v71, v79
    v_add_f32 v64, v64, v72
    v_add_f32 v65, v65, v73
    v_add_f32 v66, v66, v74
    v_add_f32 v67, v67, v75
    v_add_f32 v68, v68, v76
    v_add_f32 v69, v69, v77
    v_add_f32 v70, v70, v78
    v_add_f32 v71, v71, v79
    s_lshl_b32 s64, s44, 8
    s_add_u32 s64, s64, 147456
    v_and_b32 v72, 7, v0
    v_lshl_add_u32 v72, v72, 5, s64
    ds_write_b128 v72, v[64:67]
    ds_write_b128 v72, v[68:71] offset:16
    v_mov_b32 v73, 148480
    v_mov_b32 v74, 1
    s_waitcnt lgkmcnt(0)
    s_mov_b64 exec, 1
    ds_add_rtn_u32 v75, v73, v74
    s_mov_b64 exec, -1
    v_add_u32 v73, 147456, v234
    s_waitcnt lgkmcnt(0)
    ds_read_b32 v64, v73 offset:0
    ds_read_b32 v65, v73 offset:256
    ds_read_b32 v66, v73 offset:512
    ds_read_b32 v67, v73 offset:768
    v_readfirstlane_b32 s64, v75
    s_nop 3
    s_cmp_eq_u32 s64, 3
    s_cselect_b32 s80, s80, 0x80000000
    v_lshl_add_u32 v72, v1, 3, s80
    s_waitcnt lgkmcnt(0)
    v_add_f32 v64, v64, v65
    v_add_f32 v66, v66, v67
    v_add_f32 v64, v64, v66
    v_mov_b32 v65, s0
    buffer_store_dwordx2 v[64:65], v72, s[28:31], 0 offen sc1
    s_mov_b32 s40, s4
    s_mov_b32 s41, s5
    s_mov_b32 s42, 0x400000
    s_mov_b32 s43, 0x20000
    s_mov_b32 s64, 0x8000
    buffer_load_dwordx4 v[88:91], v196, s[40:43], 0 offen offset:0
    buffer_load_dwordx4 v[92:95], v196, s[40:43], 0 offen offset:64
    buffer_load_dwordx4 v[96:99], v196, s[40:43], s64 offen offset:0
    buffer_load_dwordx4 v[100:103], v196, s[40:43], s64 offen offset:64
    s_lshl_b32 s60, s44, 12
    s_add_u32 s61, s60, 147456
    s_add_u32 s53, s60, 0
    s_bfe_u32 s66, s2, 0x30003
    s_lshr_b32 s55, s2, 6
    s_add_u32 s66, s66, s55
    s_and_b32 s66, s66, 3
    s_mov_b32 s58, 0x76453210
    s_mov_b32 s59, 0xfecdba89
    s_cmp_eq_u32 s66, 1
    s_cselect_b32 s58, 0x75643120, s58
    s_cselect_b32 s59, 0xfdecb9a8, s59
    s_cmp_eq_u32 s66, 2
    s_cselect_b32 s58, 0x67542310, s58
    s_cselect_b32 s59, 0xefdcab98, s59
    s_cmp_eq_u32 s66, 3
    s_cselect_b32 s58, 0x86534210, s58
    s_cselect_b32 s59, 0xfedbca97, s59
    s_mov_b32 s32, s12
    s_mov_b32 s33, s13
    s_mov_b32 s34, 0x700000
    s_mov_b32 s35, 0x20000
    s_mov_b32 s36, s14
    s_mov_b32 s37, s15
    s_mov_b32 s38, 0x700000
    s_mov_b32 s39, 0x20000
    s_mov_b32 s72, 0xb00000
    s_mov_b32 s74, 0x1000000
    s_mov_b32 s73, 0xb08000
    s_mov_b32 s75, 0x1008000
    s_lshl_b32 s76, s48, 8
    s_waitcnt vmcnt(0)
    v_permlane16_swap_b32 v88, v90
    v_permlane16_swap_b32 v89, v91
    v_permlane16_swap_b32 v92, v94
    v_permlane16_swap_b32 v93, v95
    v_permlane16_swap_b32 v96, v98
    v_permlane16_swap_b32 v97, v99
    v_permlane16_swap_b32 v100, v102
    v_permlane16_swap_b32 v101, v103
    v_lshlrev_b32 v104, 16, v88
    v_and_b32 v105, 0xffff0000, v88
    v_lshlrev_b32 v106, 16, v89
    v_and_b32 v107, 0xffff0000, v89
    v_lshlrev_b32 v108, 16, v90
    v_and_b32 v109, 0xffff0000, v90
    v_lshlrev_b32 v110, 16, v91
    v_and_b32 v111, 0xffff0000, v91
    v_lshlrev_b32 v112, 16, v92
    v_and_b32 v113, 0xffff0000, v92
    v_lshlrev_b32 v114, 16, v93
    v_and_b32 v115, 0xffff0000, v93
    v_lshlrev_b32 v116, 16, v94
    v_and_b32 v117, 0xffff0000, v94
    v_lshlrev_b32 v118, 16, v95
    v_and_b32 v119, 0xffff0000, v95
    v_lshlrev_b32 v120, 16, v96
    v_and_b32 v121, 0xffff0000, v96
    v_lshlrev_b32 v122, 16, v97
    v_and_b32 v123, 0xffff0000, v97
    v_lshlrev_b32 v124, 16, v98
    v_and_b32 v125, 0xffff0000, v98
    v_lshlrev_b32 v126, 16, v99
    v_and_b32 v127, 0xffff0000, v99
    v_lshlrev_b32 v128, 16, v100
    v_and_b32 v129, 0xffff0000, v100
    v_lshlrev_b32 v130, 16, v101
    v_and_b32 v131, 0xffff0000, v101
    v_lshlrev_b32 v132, 16, v102
    v_and_b32 v133, 0xffff0000, v102
    v_lshlrev_b32 v134, 16, v103
    v_and_b32 v135, 0xffff0000, v103
    s_setprio 2
    s_barrier
    s_barrier
    ds_read_b128 v[40:43], v232 offset:0
    ds_read_b64_tr_b16 v[48:49], v235 offset:0
    ds_read_b64_tr_b16 v[50:51], v235 offset:2048
    ds_read_b64_tr_b16 v[52:53], v236 offset:0
    ds_read_b64_tr_b16 v[54:55], v236 offset:2048
    ds_read_b64_tr_b16 v[56:57], v237 offset:0
    ds_read_b64_tr_b16 v[58:59], v237 offset:2048
    ds_read_b64_tr_b16 v[60:61], v238 offset:0
    ds_read_b64_tr_b16 v[62:63], v238 offset:2048
    ds_read_b128 v[44:47], v232 offset:2048
    s_add_u32 s52, s52, 24576
    s_cmp_ge_u32 s52, 147456
    s_cselect_b32 s52, 0, s52
    s_waitcnt lgkmcnt(0)
    v_mfma_f32_16x16x32_bf16 v[8:11], v[48:51], v[40:43], 0
    ds_read_b128 v[64:67], v232 offset:1024
    ds_read_b64_tr_b16 v[72:73], v235 offset:4096
    v_mfma_f32_16x16x32_bf16 v[12:15], v[52:55], v[40:43], 0
    ds_read_b64_tr_b16 v[74:75], v235 offset:6144
    ds_read_b64_tr_b16 v[76:77], v236 offset:4096
    v_mfma_f32_16x16x32_bf16 v[16:19], v[56:59], v[40:43], 0
    ds_read_b64_tr_b16 v[78:79], v236 offset:6144
    ds_read_b64_tr_b16 v[80:81], v237 offset:4096
    v_mfma_f32_16x16x32_bf16 v[20:23], v[60:63], v[40:43], 0
    ds_read_b64_tr_b16 v[82:83], v237 offset:6144
    ds_read_b64_tr_b16 v[84:85], v238 offset:4096
    v_mfma_f32_16x16x32_bf16 v[24:27], v[48:51], v[44:47], 0
    ds_read_b64_tr_b16 v[86:87], v238 offset:6144
    ds_read_b128 v[68:71], v232 offset:3072
    v_mfma_f32_16x16x32_bf16 v[28:31], v[52:55], v[44:47], 0
    v_add_u32 v232, s52, v233
    v_add_u32 v235, s52, v239
    v_mfma_f32_16x16x32_bf16 v[32:35], v[56:59], v[44:47], 0
    v_add_u32 v236, s52, v240
    v_add_u32 v237, s52, v241
    v_mfma_f32_16x16x32_bf16 v[36:39], v[60:63], v[44:47], 0
    v_add_u32 v238, s52, v242
    s_waitcnt lgkmcnt(0)
    v_mfma_f32_16x16x32_bf16 v[8:11], v[72:75], v[64:67], v[8:11]
    s_barrier
    v_mfma_f32_16x16x32_bf16 v[12:15], v[76:79], v[64:67], v[12:15]
    ds_read_b128 v[40:43], v232 offset:0
    ds_read_b64_tr_b16 v[48:49], v235 offset:0
    ds_read_b64_tr_b16 v[50:51], v235 offset:2048
    v_mfma_f32_16x16x32_bf16 v[16:19], v[80:83], v[64:67], v[16:19]
    ds_read_b64_tr_b16 v[52:53], v236 offset:0
    ds_read_b64_tr_b16 v[54:55], v236 offset:2048
    v_mfma_f32_16x16x32_bf16 v[20:23], v[84:87], v[64:67], v[20:23]
    ds_read_b64_tr_b16 v[56:57], v237 offset:0
    ds_read_b64_tr_b16 v[58:59], v237 offset:2048
    ds_read_b64_tr_b16 v[60:61], v238 offset:0
    v_mfma_f32_16x16x32_bf16 v[24:27], v[72:75], v[68:71], v[24:27]
    ds_read_b64_tr_b16 v[62:63], v238 offset:2048
    ds_read_b128 v[44:47], v232 offset:2048
    v_mfma_f32_16x16x32_bf16 v[28:31], v[76:79], v[68:71], v[28:31]
    v_mfma_f32_16x16x32_bf16 v[32:35], v[80:83], v[68:71], v[32:35]
    s_add_u32 s52, s52, 24576
    s_cmp_ge_u32 s52, 147456
    s_cselect_b32 s52, 0, s52
    v_mfma_f32_16x16x32_bf16 v[36:39], v[84:87], v[68:71], v[36:39]
    s_waitcnt lgkmcnt(0)
    v_mfma_f32_16x16x32_bf16 v[8:11], v[48:51], v[40:43], v[8:11]
    ds_read_b128 v[64:67], v232 offset:1024
    ds_read_b64_tr_b16 v[72:73], v235 offset:4096
    v_mfma_f32_16x16x32_bf16 v[12:15], v[52:55], v[40:43], v[12:15]
    ds_read_b64_tr_b16 v[74:75], v235 offset:6144
    ds_read_b64_tr_b16 v[76:77], v236 offset:4096
    v_mfma_f32_16x16x32_bf16 v[16:19], v[56:59], v[40:43], v[16:19]
    ds_read_b64_tr_b16 v[78:79], v236 offset:6144
    ds_read_b64_tr_b16 v[80:81], v237 offset:4096
    v_mfma_f32_16x16x32_bf16 v[20:23], v[60:63], v[40:43], v[20:23]
    ds_read_b64_tr_b16 v[82:83], v237 offset:6144
    ds_read_b64_tr_b16 v[84:85], v238 offset:4096
    v_mfma_f32_16x16x32_bf16 v[24:27], v[48:51], v[44:47], v[24:27]
    s_movk_i32 s54, 10
M_Q_loop1:
    ds_read_b64_tr_b16 v[86:87], v238 offset:6144
    ds_read_b128 v[68:71], v232 offset:3072
    v_mfma_f32_16x16x32_bf16 v[28:31], v[52:55], v[44:47], v[28:31]
    v_add_u32 v232, s52, v233
    v_add_u32 v235, s52, v239
    v_mfma_f32_16x16x32_bf16 v[32:35], v[56:59], v[44:47], v[32:35]
    v_add_u32 v236, s52, v240
    v_add_u32 v237, s52, v241
    v_mfma_f32_16x16x32_bf16 v[36:39], v[60:63], v[44:47], v[36:39]
    v_add_u32 v238, s52, v242
    s_waitcnt lgkmcnt(0)
    v_mfma_f32_16x16x32_bf16 v[8:11], v[72:75], v[64:67], v[8:11]
    s_barrier
    v_mfma_f32_16x16x32_bf16 v[12:15], v[76:79], v[64:67], v[12:15]
    ds_read_b128 v[40:43], v232 offset:0
    ds_read_b64_tr_b16 v[48:49], v235 offset:0
    ds_read_b64_tr_b16 v[50:51], v235 offset:2048
    v_mfma_f32_16x16x32_bf16 v[16:19], v[80:83], v[64:67], v[16:19]
    ds_read_b64_tr_b16 v[52:53], v236 offset:0
    ds_read_b64_tr_b16 v[54:55], v236 offset:2048
    v_mfma_f32_16x16x32_bf16 v[20:23], v[84:87], v[64:67], v[20:23]
    ds_read_b64_tr_b16 v[56:57], v237 offset:0
    ds_read_b64_tr_b16 v[58:59], v237 offset:2048
    ds_read_b64_tr_b16 v[60:61], v238 offset:0
    v_mfma_f32_16x16x32_bf16 v[24:27], v[72:75], v[68:71], v[24:27]
    ds_read_b64_tr_b16 v[62:63], v238 offset:2048
    ds_read_b128 v[44:47], v232 offset:2048
    v_mfma_f32_16x16x32_bf16 v[28:31], v[76:79], v[68:71], v[28:31]
    v_mfma_f32_16x16x32_bf16 v[32:35], v[80:83], v[68:71], v[32:35]
    s_add_u32 s52, s52, 24576
    s_cmp_ge_u32 s52, 147456
    s_cselect_b32 s52, 0, s52
    v_mfma_f32_16x16x32_bf16 v[36:39], v[84:87], v[68:71], v[36:39]
    s_waitcnt lgkmcnt(0)
    v_mfma_f32_16x16x32_bf16 v[8:11], v[48:51], v[40:43], v[8:11]
    ds_read_b128 v[64:67], v232 offset:1024
    ds_read_b64_tr_b16 v[72:73], v235 offset:4096
    v_mfma_f32_16x16x32_bf16 v[12:15], v[52:55], v[40:43], v[12:15]
    ds_read_b64_tr_b16 v[74:75], v235 offset:6144
    ds_read_b64_tr_b16 v[76:77], v236 offset:4096
    v_mfma_f32_16x16x32_bf16 v[16:19], v[56:59], v[40:43], v[16:19]
    ds_read_b64_tr_b16 v[78:79], v236 offset:6144
    ds_read_b64_tr_b16 v[80:81], v237 offset:4096
    v_mfma_f32_16x16x32_bf16 v[20:23], v[60:63], v[40:43], v[20:23]
    s_sub_u32 s54, s54, 1
    ds_read_b64_tr_b16 v[82:83], v237 offset:6144
    ds_read_b64_tr_b16 v[84:85], v238 offset:4096
    v_mfma_f32_16x16x32_bf16 v[24:27], v[48:51], v[44:47], v[24:27]
    s_cbranch_scc0 M_Q_loop1
    ds_read_b64_tr_b16 v[86:87], v238 offset:6144
    ds_read_b128 v[68:71], v232 offset:3072
    v_mfma_f32_16x16x32_bf16 v[28:31], v[52:55], v[44:47], v[28:31]
    v_add_u32 v232, s52, v233
    v_add_u32 v235, s52, v239
    v_mfma_f32_16x16x32_bf16 v[32:35], v[56:59], v[44:47], v[32:35]
    v_add_u32 v236, s52, v240
    v_add_u32 v237, s52, v241
    v_mfma_f32_16x16x32_bf16 v[36:39], v[60:63], v[44:47], v[36:39]
    v_add_u32 v238, s52, v242
    s_waitcnt lgkmcnt(0)
    v_mfma_f32_16x16x32_bf16 v[8:11], v[72:75], v[64:67], v[8:11]
    s_barrier
    v_mfma_f32_16x16x32_bf16 v[12:15], v[76:79], v[64:67], v[12:15]
    ds_read_b128 v[40:43], v232 offset:0
    ds_read_b64_tr_b16 v[48:49], v235 offset:0
    ds_read_b64_tr_b16 v[50:51], v235 offset:2048
    v_mfma_f32_16x16x32_bf16 v[16:19], v[80:83], v[64:67], v[16:19]
    ds_read_b64_tr_b16 v[52:53], v236 offset:0
    ds_read_b64_tr_b16 v[54:55], v236 offset:2048
    v_mfma_f32_16x16x32_bf16 v[20:23], v[84:87], v[64:67], v[20:23]
    ds_read_b64_tr_b16 v[56:57], v237 offset:0
    ds_read_b64_tr_b16 v[58:59], v237 offset:2048
    ds_read_b64_tr_b16 v[60:61], v238 offset:0
    v_mfma_f32_16x16x32_bf16 v[24:27], v[72:75], v[68:71], v[24:27]
    ds_read_b64_tr_b16 v[62:63], v238 offset:2048
    ds_read_b128 v[44:47], v232 offset:2048
    v_mfma_f32_16x16x32_bf16 v[28:31], v[76:79], v[68:71], v[28:31]
    v_mfma_f32_16x16x32_bf16 v[32:35], v[80:83], v[68:71], v[32:35]
    s_add_u32 s52, s52, 24576
    s_cmp_ge_u32 s52, 147456
    s_cselect_b32 s52, 0, s52
    v_mfma_f32_16x16x32_bf16 v[36:39], v[84:87], v[68:71], v[36:39]
    s_waitcnt lgkmcnt(0)
    v_mfma_f32_16x16x32_bf16 v[8:11], v[48:51], v[40:43], v[8:11]
    ds_read_b128 v[64:67], v232 offset:1024
    ds_read_b64_tr_b16 v[72:73], v235 offset:4096
    v_mfma_f32_16x16x32_bf16 v[12:15], v[52:55], v[40:43], v[12:15]
    ds_read_b64_tr_b16 v[74:75], v235 offset:6144
    ds_read_b64_tr_b16 v[76:77], v236 offset:4096
    ds_read_b128 v[136:139], v199 offset:0
    v_mfma_f32_16x16x32_bf16 v[16:19], v[56:59], v[40:43], v[16:19]
    ds_read_b64_tr_b16 v[78:79], v236 offset:6144
    ds_read_b64_tr_b16 v[80:81], v237 offset:4096
    ds_read_b128 v[140:143], v199 offset:64
    v_mfma_f32_16x16x32_bf16 v[20:23], v[60:63], v[40:43], v[20:23]
    ds_read_b64_tr_b16 v[82:83], v237 offset:6144
    ds_read_b64_tr_b16 v[84:85], v238 offset:4096
    v_mfma_f32_16x16x32_bf16 v[24:27], v[48:51], v[44:47], v[24:27]
    ds_read_b64_tr_b16 v[86:87], v238 offset:6144
    ds_read_b128 v[68:71], v232 offset:3072
    ds_read_b128 v[144:147], v199 offset:128
    v_mfma_f32_16x16x32_bf16 v[28:31], v[52:55], v[44:47], v[28:31]
    v_add_u32 v232, s52, v233
    v_add_u32 v235, s52, v239
    v_mfma_f32_16x16x32_bf16 v[32:35], v[56:59], v[44:47], v[32:35]
    v_add_u32 v236, s52, v240
    v_add_u32 v237, s52, v241
    ds_read_b128 v[148:151], v199 offset:192
    v_mfma_f32_16x16x32_bf16 v[36:39], v[60:63], v[44:47], v[36:39]
    v_add_u32 v238, s52, v242
    s_waitcnt lgkmcnt(0)
    v_mfma_f32_16x16x32_bf16 v[8:11], v[72:75], v[64:67], v[8:11]
    s_barrier
    v_mfma_f32_16x16x32_bf16 v[12:15], v[76:79], v[64:67], v[12:15]
    ds_read_b128 v[40:43], v232 offset:0
    ds_read_b64_tr_b16 v[48:49], v235 offset:0
    ds_read_b64_tr_b16 v[50:51], v235 offset:2048
    ds_read_b128 v[152:155], v199 offset:256
    v_mfma_f32_16x16x32_bf16 v[16:19], v[80:83], v[64:67], v[16:19]
    ds_read_b64_tr_b16 v[52:53], v236 offset:0
    ds_read_b64_tr_b16 v[54:55], v236 offset:2048
    ds_read_b128 v[156:159], v199 offset:320
    v_mfma_f32_16x16x32_bf16 v[20:23], v[84:87], v[64:67], v[20:23]
    ds_read_b64_tr_b16 v[56:57], v237 offset:0
    ds_read_b64_tr_b16 v[58:59], v237 offset:2048
    ds_read_b64_tr_b16 v[60:61], v238 offset:0
    v_mfma_f32_16x16x32_bf16 v[24:27], v[72:75], v[68:71], v[24:27]
    ds_read_b64_tr_b16 v[62:63], v238 offset:2048
    ds_read_b128 v[44:47], v232 offset:2048
    ds_read_b128 v[160:163], v199 offset:384
    v_mfma_f32_16x16x32_bf16 v[28:31], v[76:79], v[68:71], v[28:31]
    v_mfma_f32_16x16x32_bf16 v[32:35], v[80:83], v[68:71], v[32:35]
    s_add_u32 s52, s52, 24576
    s_cmp_ge_u32 s52, 147456
    s_cselect_b32 s52, 0, s52
    ds_read_b128 v[164:167], v199 offset:448
    v_mfma_f32_16x16x32_bf16 v[36:39], v[84:87], v[68:71], v[36:39]
    s_waitcnt lgkmcnt(0)
    v_mfma_f32_16x16x32_bf16 v[8:11], v[48:51], v[40:43], v[8:11]
    ds_read_b128 v[64:67], v232 offset:1024
    ds_read_b64_tr_b16 v[72:73], v235 offset:4096
    v_mfma_f32_16x16x32_bf16 v[12:15], v[52:55], v[40:43], v[12:15]
    ds_read_b64_tr_b16 v[74:75], v235 offset:6144
    ds_read_b64_tr_b16 v[76:77], v236 offset:4096
    ds_read_b128 v[168:171], v199 offset:512
    v_mfma_f32_16x16x32_bf16 v[16:19], v[56:59], v[40:43], v[16:19]
    ds_read_b64_tr_b16 v[78:79], v236 offset:6144
    ds_read_b64_tr_b16 v[80:81], v237 offset:4096
    ds_read_b128 v[172:175], v199 offset:576
    v_mfma_f32_16x16x32_bf16 v[20:23], v[60:63], v[40:43], v[20:23]
    ds_read_b64_tr_b16 v[82:83], v237 offset:6144
    ds_read_b64_tr_b16 v[84:85], v238 offset:4096
    v_mfma_f32_16x16x32_bf16 v[24:27], v[48:51], v[44:47], v[24:27]
    ds_read_b64_tr_b16 v[86:87], v238 offset:6144
    ds_read_b128 v[68:71], v232 offset:3072
    ds_read_b128 v[176:179], v199 offset:640
    v_mfma_f32_16x16x32_bf16 v[28:31], v[52:55], v[44:47], v[28:31]
    v_add_u32 v232, s52, v233
    v_add_u32 v235, s52, v239
    v_mfma_f32_16x16x32_bf16 v[32:35], v[56:59], v[44:47], v[32:35]
    v_add_u32 v236, s52, v240
    v_add_u32 v237, s52, v241
    ds_read_b128 v[180:183], v199 offset:704
    v_mfma_f32_16x16x32_bf16 v[36:39], v[60:63], v[44:47], v[36:39]
    v_add_u32 v238, s52, v242
    s_waitcnt lgkmcnt(0)
    v_mfma_f32_16x16x32_bf16 v[8:11], v[72:75], v[64:67], v[8:11]
    s_barrier
    v_mfma_f32_16x16x32_bf16 v[12:15], v[76:79], v[64:67], v[12:15]
    ds_read_b128 v[40:43], v232 offset:0
    ds_read_b64_tr_b16 v[48:49], v235 offset:0
    ds_read_b64_tr_b16 v[50:51], v235 offset:2048
    v_mfma_f32_16x16x32_bf16 v[16:19], v[80:83], v[64:67], v[16:19]
    ds_read_b64_tr_b16 v[52:53], v236 offset:0
    ds_read_b64_tr_b16 v[54:55], v236 offset:2048
    v_mfma_f32_16x16x32_bf16 v[20:23], v[84:87], v[64:67], v[20:23]
    ds_read_b64_tr_b16 v[56:57], v237 offset:0
    ds_read_b64_tr_b16 v[58:59], v237 offset:2048
    ds_read_b64_tr_b16 v[60:61], v238 offset:0
    v_mfma_f32_16x16x32_bf16 v[24:27], v[72:75], v[68:71], v[24:27]
    ds_read_b64_tr_b16 v[62:63], v238 offset:2048
    ds_read_b128 v[44:47], v232 offset:2048
    v_mfma_f32_16x16x32_bf16 v[28:31], v[76:79], v[68:71], v[28:31]
    v_mfma_f32_16x16x32_bf16 v[32:35], v[80:83], v[68:71], v[32:35]
    s_add_u32 s52, s52, 24576
    s_cmp_ge_u32 s52, 147456
    s_cselect_b32 s52, 0, s52
    v_mfma_f32_16x16x32_bf16 v[36:39], v[84:87], v[68:71], v[36:39]
    s_waitcnt lgkmcnt(0)
    v_mfma_f32_16x16x32_bf16 v[8:11], v[48:51], v[40:43], v[8:11]
    ds_read_b128 v[64:67], v232 offset:1024
    ds_read_b64_tr_b16 v[72:73], v235 offset:4096
    v_mfma_f32_16x16x32_bf16 v[12:15], v[52:55], v[40:43], v[12:15]
    ds_read_b64_tr_b16 v[74:75], v235 offset:6144
    ds_read_b64_tr_b16 v[76:77], v236 offset:4096
    v_mfma_f32_16x16x32_bf16 v[16:19], v[56:59], v[40:43], v[16:19]
    ds_read_b64_tr_b16 v[78:79], v236 offset:6144
    ds_read_b64_tr_b16 v[80:81], v237 offset:4096
    v_mfma_f32_16x16x32_bf16 v[20:23], v[60:63], v[40:43], v[20:23]
    ds_read_b64_tr_b16 v[82:83], v237 offset:6144
    ds_read_b64_tr_b16 v[84:85], v238 offset:4096
    v_mfma_f32_16x16x32_bf16 v[24:27], v[48:51], v[44:47], v[24:27]
    ds_read_b64_tr_b16 v[86:87], v238 offset:6144
    ds_read_b128 v[68:71], v232 offset:3072
    v_mfma_f32_16x16x32_bf16 v[28:31], v[52:55], v[44:47], v[28:31]
    v_mfma_f32_16x16x32_bf16 v[32:35], v[56:59], v[44:47], v[32:35]
    v_mfma_f32_16x16x32_bf16 v[36:39], v[60:63], v[44:47], v[36:39]
    s_waitcnt lgkmcnt(0)
    v_mfma_f32_16x16x32_bf16 v[8:11], v[72:75], v[64:67], v[8:11]
    s_barrier
    v_mfma_f32_16x16x32_bf16 v[12:15], v[76:79], v[64:67], v[12:15]
    v_mfma_f32_16x16x32_bf16 v[16:19], v[80:83], v[64:67], v[16:19]
    v_mfma_f32_16x16x32_bf16 v[20:23], v[84:87], v[64:67], v[20:23]
    v_mfma_f32_16x16x32_bf16 v[24:27], v[72:75], v[68:71], v[24:27]
    v_mfma_f32_16x16x32_bf16 v[28:31], v[76:79], v[68:71], v[28:31]
    v_mfma_f32_16x16x32_bf16 v[32:35], v[80:83], v[68:71], v[32:35]
    v_mfma_f32_16x16x32_bf16 v[36:39], v[84:87], v[68:71], v[36:39]
    v_pk_fma_f32 v[104:105], v[8:9], v[136:137], v[104:105]
    v_pk_fma_f32 v[106:107], v[10:11], v[138:139], v[106:107]
    v_pk_fma_f32 v[108:109], v[12:13], v[140:141], v[108:109]
    v_pk_fma_f32 v[110:111], v[14:15], v[142:143], v[110:111]
    v_pk_fma_f32 v[112:113], v[16:17], v[144:145], v[112:113]
    v_pk_fma_f32 v[114:115], v[18:19], v[146:147], v[114:115]
    v_pk_fma_f32 v[116:117], v[20:21], v[148:149], v[116:117]
    v_pk_fma_f32 v[118:119], v[22:23], v[150:151], v[118:119]
    v_pk_fma_f32 v[120:121], v[24:25], v[136:137], v[120:121]
    v_pk_fma_f32 v[122:123], v[26:27], v[138:139], v[122:123]
    v_pk_fma_f32 v[124:125], v[28:29], v[140:141], v[124:125]
    v_pk_fma_f32 v[126:127], v[30:31], v[142:143], v[126:127]
    v_pk_fma_f32 v[128:129], v[32:33], v[144:145], v[128:129]
    v_pk_fma_f32 v[130:131], v[34:35], v[146:147], v[130:131]
    v_pk_fma_f32 v[132:133], v[36:37], v[148:149], v[132:133]
    v_pk_fma_f32 v[134:135], v[38:39], v[150:151], v[134:135]
    v_cvt_pk_bf16_f32 v88, v104, v105
    v_cvt_pk_bf16_f32 v89, v106, v107
    v_cvt_pk_bf16_f32 v90, v108, v109
    v_cvt_pk_bf16_f32 v91, v110, v111
    v_cvt_pk_bf16_f32 v92, v112, v113
    v_cvt_pk_bf16_f32 v93, v114, v115
    v_cvt_pk_bf16_f32 v94, v116, v117
    v_cvt_pk_bf16_f32 v95, v118, v119
    v_cvt_pk_bf16_f32 v96, v120, v121
    v_cvt_pk_bf16_f32 v97, v122, v123
    v_cvt_pk_bf16_f32 v98, v124, v125
    v_cvt_pk_bf16_f32 v99, v126, v127
    v_cvt_pk_bf16_f32 v100, v128, v129
    v_cvt_pk_bf16_f32 v101, v130, v131
    v_cvt_pk_bf16_f32 v102, v132, v133
    v_cvt_pk_bf16_f32 v103, v134, v135
    v_lshlrev_b32 v104, 16, v88
    v_and_b32 v105, 0xffff0000, v88
    v_lshlrev_b32 v106, 16, v89
    v_and_b32 v107, 0xffff0000, v89
    v_lshlrev_b32 v108, 16, v90
    v_and_b32 v109, 0xffff0000, v90
    v_lshlrev_b32 v110, 16, v91
    v_and_b32 v111, 0xffff0000, v91
    v_lshlrev_b32 v112, 16, v92
    v_and_b32 v113, 0xffff0000, v92
    v_lshlrev_b32 v114, 16, v93
    v_and_b32 v115, 0xffff0000, v93
    v_lshlrev_b32 v116, 16, v94
    v_and_b32 v117, 0xffff0000, v94
    v_lshlrev_b32 v118, 16, v95
    v_and_b32 v119, 0xffff0000, v95
    v_lshlrev_b32 v120, 16, v96
    v_and_b32 v121, 0xffff0000, v96
    v_lshlrev_b32 v122, 16, v97
    v_and_b32 v123, 0xffff0000, v97
    v_lshlrev_b32 v124, 16, v98
    v_and_b32 v125, 0xffff0000, v98
    v_lshlrev_b32 v126, 16, v99
    v_and_b32 v127, 0xffff0000, v99
    v_lshlrev_b32 v128, 16, v100
    v_and_b32 v129, 0xffff0000, v100
    v_lshlrev_b32 v130, 16, v101
    v_and_b32 v131, 0xffff0000, v101
    v_lshlrev_b32 v132, 16, v102
    v_and_b32 v133, 0xffff0000, v102
    v_lshlrev_b32 v134, 16, v103
    v_and_b32 v135, 0xffff0000, v103
    v_pk_add_f32 v[40:41], v[104:105], v[106:107]
    v_pk_mul_f32 v[44:45], v[104:105], v[104:105]
    v_pk_add_f32 v[42:43], v[120:121], v[122:123]
    v_pk_mul_f32 v[46:47], v[120:121], v[120:121]
    v_pk_fma_f32 v[44:45], v[106:107], v[106:107], v[44:45]
    v_pk_fma_f32 v[46:47], v[122:123], v[122:123], v[46:47]
    v_pk_add_f32 v[40:41], v[40:41], v[108:109]
    v_pk_fma_f32 v[44:45], v[108:109], v[108:109], v[44:45]
    v_pk_add_f32 v[42:43], v[42:43], v[124:125]
    v_pk_fma_f32 v[46:47], v[124:125], v[124:125], v[46:47]
    v_pk_add_f32 v[40:41], v[40:41], v[110:111]
    v_pk_fma_f32 v[44:45], v[110:111], v[110:111], v[44:45]
    v_pk_add_f32 v[42:43], v[42:43], v[126:127]
    v_pk_fma_f32 v[46:47], v[126:127], v[126:127], v[46:47]
    v_pk_add_f32 v[40:41], v[40:41], v[112:113]
    v_pk_fma_f32 v[44:45], v[112:113], v[112:113], v[44:45]
    v_pk_add_f32 v[42:43], v[42:43], v[128:129]
    v_pk_fma_f32 v[46:47], v[128:129], v[128:129], v[46:47]
    v_pk_add_f32 v[40:41], v[40:41], v[114:115]
    v_pk_fma_f32 v[44:45], v[114:115], v[114:115], v[44:45]
    v_pk_add_f32 v[42:43], v[42:43], v[130:131]
    v_pk_fma_f32 v[46:47], v[130:131], v[130:131], v[46:47]
    v_pk_add_f32 v[40:41], v[40:41], v[116:117]
    v_pk_fma_f32 v[44:45], v[116:117], v[116:117], v[44:45]
    v_pk_add_f32 v[42:43], v[42:43], v[132:133]
    v_pk_fma_f32 v[46:47], v[132:133], v[132:133], v[46:47]
    v_pk_add_f32 v[40:41], v[40:41], v[118:119]
    v_pk_fma_f32 v[44:45], v[118:119], v[118:119], v[44:45]
    v_pk_add_f32 v[42:43], v[42:43], v[134:135]
    v_pk_fma_f32 v[46:47], v[134:135], v[134:135], v[46:47]
    v_add_f32 v40, v40, v41
    v_add_f32 v42, v42, v43
    v_add_f32 v44, v44, v45
    v_add_f32 v46, v46, v47
    v_permlane16_swap_b32 v40, v42
    s_nop 0
    v_permlane16_swap_b32 v44, v46
    v_add_f32 v48, v40, v42
    v_add_f32 v49, v44, v46
    v_mov_b32 v50, v48
    v_mov_b32 v51, v49
    s_nop 0
    v_permlane32_swap_b32 v48, v50
    v_permlane32_swap_b32 v49, v51
    v_add_f32 v48, v48, v50
    v_add_f32 v49, v49, v51
    s_mov_b32 exec_hi, 0
    buffer_store_dwordx2 v[48:49], v198, s[28:31], s76 offen sc1
    s_mov_b32 exec_hi, -1
    buffer_load_dwordx2 v[56:57], v198, s[28:31], 0 offen offset:0 sc1
    buffer_load_dwordx2 v[58:59], v198, s[28:31], 0 offen offset:512 sc1
    buffer_load_dwordx2 v[60:61], v198, s[28:31], 0 offen offset:1024 sc1
    buffer_load_dwordx2 v[62:63], v198, s[28:31], 0 offen offset:1536 sc1
    buffer_load_dwordx2 v[64:65], v198, s[28:31], 0 offen offset:2048 sc1
    buffer_load_dwordx2 v[66:67], v198, s[28:31], 0 offen offset:2560 sc1
    buffer_load_dwordx2 v[68:69], v198, s[28:31], 0 offen offset:3072 sc1
    buffer_load_dwordx2 v[70:71], v198, s[28:31], 0 offen offset:3584 sc1
    s_waitcnt vmcnt(0)
    s_mov_b32 s3, 0x40000
M_sp_chk:
    v_cmp_eq_u32 s[80:81], -1, v57
    v_cmp_eq_u32 s[82:83], -1, v59
    v_cmp_eq_u32 s[84:85], -1, v61
    v_cmp_eq_u32 s[86:87], -1, v63
    v_cmp_eq_u32 s[88:89], -1, v65
    v_cmp_eq_u32 s[90:91], -1, v67
    v_cmp_eq_u32 s[92:93], -1, v69
    v_cmp_eq_u32 s[94:95], -1, v71
    v_max3_u32 v52, v57, v59, v61
    v_max3_u32 v53, v63, v65, v67
    v_max3_u32 v52, v52, v69, v71
    v_max_u32 v52, v52, v53
    v_cmp_eq_u32 vcc, -1, v52
    s_nop 4
    s_cbranch_vccz M_sp_ok
    s_sub_u32 s3, s3, 1
    s_cbranch_scc1 M_sp_ok
    s_mov_b64 exec, s[80:81]
    buffer_load_dwordx2 v[56:57], v198, s[28:31], 0 offen offset:0 sc1
    s_mov_b64 exec, s[82:83]
    buffer_load_dwordx2 v[58:59], v198, s[28:31], 0 offen offset:512 sc1
    s_mov_b64 exec, s[84:85]
    buffer_load_dwordx2 v[60:61], v198, s[28:31], 0 offen offset:1024 sc1
    s_mov_b64 exec, s[86:87]
    buffer_load_dwordx2 v[62:63], v198, s[28:31], 0 offen offset:1536 sc1
    s_mov_b64 exec, s[88:89]
    buffer_load_dwordx2 v[64:65], v198, s[28:31], 0 offen offset:2048 sc1
    s_mov_b64 exec, s[90:91]
    buffer_load_dwordx2 v[66:67], v198, s[28:31], 0 offen offset:2560 sc1
    s_mov_b64 exec, s[92:93]
    buffer_load_dwordx2 v[68:69], v198, s[28:31], 0 offen offset:3072 sc1
    s_mov_b64 exec, s[94:95]
    buffer_load_dwordx2 v[70:71], v198, s[28:31], 0 offen offset:3584 sc1
    s_mov_b64 exec, -1
    s_waitcnt vmcnt(0)
    s_branch M_sp_chk
M_sp_ok:
    buffer_store_dwordx4 v[88:91], v197, s[28:31], s72 offen offset:0 sc1
    buffer_store_dwordx4 v[92:95], v197, s[28:31], s72 offen offset:1024 sc1
    buffer_store_dwordx4 v[96:99], v197, s[28:31], s73 offen offset:0 sc1
    buffer_store_dwordx4 v[100:103], v197, s[28:31], s73 offen offset:1024 sc1
    v_pk_add_f32 v[56:57], v[56:57], v[58:59]
    v_pk_add_f32 v[60:61], v[60:61], v[62:63]
    v_pk_add_f32 v[64:65], v[64:65], v[66:67]
    v_pk_add_f32 v[68:69], v[68:69], v[70:71]
    v_pk_add_f32 v[56:57], v[56:57], v[60:61]
    v_pk_add_f32 v[64:65], v[64:65], v[68:69]
    v_pk_add_f32 v[56:57], v[56:57], v[64:65]
    v_mov_b32 v50, v56
    v_mov_b32 v51, v57
    s_nop 0
    v_permlane32_swap_b32 v56, v50
    v_permlane32_swap_b32 v57, v51
    v_add_f32 v56, v56, v50
    v_add_f32 v57, v57, v51
    v_mul_f32 v56, 0x3a800000, v56
    v_mul_f32 v57, 0x3a800000, v57
    v_fma_f32 v57, -v56, v56, v57
    v_max_f32 v57, 0, v57
    v_cvt_pk_bf16_f32 v50, v56, v57
    v_lshlrev_b32 v56, 16, v50
    v_and_b32 v57, 0xffff0000, v50
    v_add_f32 v57, 0x3727c5ac, v57
    v_cvt_pk_bf16_f32 v50, v57, v57
    v_lshlrev_b32 v57, 16, v50
    v_sqrt_f32 v57, v57
    s_nop 0
    v_cvt_pk_bf16_f32 v50, v57, v57
    v_lshlrev_b32 v57, 16, v50
    v_rcp_f32 v40, v57
    s_nop 0
    v_mul_f32 v44, -v56, v40
    v_mov_b32 v42, v40
    v_mov_b32 v46, v44
    s_nop 0
    v_permlane16_swap_b32 v40, v42
    v_permlane16_swap_b32 v44, v46
    v_pk_fma_f32 v[104:105], v[104:105], v[40:41], v[44:45] op_sel_hi:[1,0,0]
    v_pk_fma_f32 v[106:107], v[106:107], v[40:41], v[44:45] op_sel_hi:[1,0,0]
    v_pk_fma_f32 v[108:109], v[108:109], v[40:41], v[44:45] op_sel_hi:[1,0,0]
    v_pk_fma_f32 v[110:111], v[110:111], v[40:41], v[44:45] op_sel_hi:[1,0,0]
    v_pk_fma_f32 v[112:113], v[112:113], v[40:41], v[44:45] op_sel_hi:[1,0,0]
    v_pk_fma_f32 v[114:115], v[114:115], v[40:41], v[44:45] op_sel_hi:[1,0,0]
    v_pk_fma_f32 v[116:117], v[116:117], v[40:41], v[44:45] op_sel_hi:[1,0,0]
    v_pk_fma_f32 v[118:119], v[118:119], v[40:41], v[44:45] op_sel_hi:[1,0,0]
    v_pk_fma_f32 v[104:105], v[104:105], v[168:169], v[152:153]
    v_pk_fma_f32 v[106:107], v[106:107], v[170:171], v[154:155]
    v_pk_fma_f32 v[108:109], v[108:109], v[172:173], v[156:157]
    v_pk_fma_f32 v[110:111], v[110:111], v[174:175], v[158:159]
    v_pk_fma_f32 v[112:113], v[112:113], v[176:177], v[160:161]
    v_pk_fma_f32 v[114:115], v[114:115], v[178:179], v[162:163]
    v_pk_fma_f32 v[116:117], v[116:117], v[180:181], v[164:165]
    v_pk_fma_f32 v[118:119], v[118:119], v[182:183], v[166:167]
    v_cvt_pk_bf16_f32 v72, v104, v105
    v_cvt_pk_bf16_f32 v73, v106, v107
    v_cvt_pk_bf16_f32 v74, v108, v109
    v_cvt_pk_bf16_f32 v75, v110, v111
    buffer_store_dwordx4 v[72:75], v197, s[28:31], s74 offen offset:0 sc1
    v_cvt_pk_bf16_f32 v76, v112, v113
    v_cvt_pk_bf16_f32 v77, v114, v115
    v_cvt_pk_bf16_f32 v78, v116, v117
    v_cvt_pk_bf16_f32 v79, v118, v119
    buffer_store_dwordx4 v[76:79], v197, s[28:31], s74 offen offset:1024 sc1
    v_pk_fma_f32 v[120:121], v[120:121], v[42:43], v[46:47] op_sel_hi:[1,0,0]
    v_pk_fma_f32 v[122:123], v[122:123], v[42:43], v[46:47] op_sel_hi:[1,0,0]
    v_pk_fma_f32 v[124:125], v[124:125], v[42:43], v[46:47] op_sel_hi:[1,0,0]
    v_pk_fma_f32 v[126:127], v[126:127], v[42:43], v[46:47] op_sel_hi:[1,0,0]
    v_pk_fma_f32 v[128:129], v[128:129], v[42:43], v[46:47] op_sel_hi:[1,0,0]
    v_pk_fma_f32 v[130:131], v[130:131], v[42:43], v[46:47] op_sel_hi:[1,0,0]
    v_pk_fma_f32 v[132:133], v[132:133], v[42:43], v[46:47] op_sel_hi:[1,0,0]
    v_pk_fma_f32 v[134:135], v[134:135], v[42:43], v[46:47] op_sel_hi:[1,0,0]
    v_pk_fma_f32 v[120:121], v[120:121], v[168:169], v[152:153]
    v_pk_fma_f32 v[122:123], v[122:123], v[170:171], v[154:155]
    v_pk_fma_f32 v[124:125], v[124:125], v[172:173], v[156:157]
    v_pk_fma_f32 v[126:127], v[126:127], v[174:175], v[158:159]
    v_pk_fma_f32 v[128:129], v[128:129], v[176:177], v[160:161]
    v_pk_fma_f32 v[130:131], v[130:131], v[178:179], v[162:163]
    v_pk_fma_f32 v[132:133], v[132:133], v[180:181], v[164:165]
    v_pk_fma_f32 v[134:135], v[134:135], v[182:183], v[166:167]
    v_cvt_pk_bf16_f32 v80, v120, v121
    v_cvt_pk_bf16_f32 v81, v122, v123
    v_cvt_pk_bf16_f32 v82, v124, v125
    v_cvt_pk_bf16_f32 v83, v126, v127
    buffer_store_dwordx4 v[80:83], v197, s[28:31], s75 offen offset:0 sc1
    v_cvt_pk_bf16_f32 v84, v128, v129
    v_cvt_pk_bf16_f32 v85, v130, v131
    v_cvt_pk_bf16_f32 v86, v132, v133
    v_cvt_pk_bf16_f32 v87, v134, v135
    buffer_store_dwordx4 v[84:87], v197, s[28:31], s75 offen offset:1024 sc1
    s_lshl_b32 s68, s47, 9
    s_add_u32 s68, s68, 0x56000
    s_add_u32 s62, s26, s68
    s_addc_u32 s63, s27, 0
    s_lshr_b32 s68, s48, 2
    s_lshl_b32 s68, s68, 7
    v_mov_b32 v2, 1
    v_mov_b32 v5, 148488
    s_waitcnt vmcnt(0)
    s_mov_b64 exec, 1
    ds_add_rtn_u32 v245, v5, v2
    s_mov_b64 exec, -1
    s_mov_b32 s1, 1
    s_mov_b32 s3, 0x40000
    s_waitcnt lgkmcnt(0)
    v_readfirstlane_b32 s64, v245
    s_nop 3
    s_cmp_lg_u32 s64, 3
    s_cbranch_scc1 M_ph_ok
    s_atomic_add s1, s[62:63], 0
    s_atomic_add s1, s[62:63], 128
    s_atomic_add s1, s[62:63], 256
    s_atomic_add s1, s[62:63], 384
M_ph_chk:
    s_load_dword s64, s[62:63], s68 glc
    s_sub_u32 s3, s3, 1
    s_cselect_b32 s65, 0, 16
    s_waitcnt lgkmcnt(0)
    s_cmp_lt_u32 s64, s65
    s_cbranch_scc1 M_ph_chk
M_ph_ok:
    s_barrier
    s_setprio 0
    s_and_b32 s57, s58, 15
    s_lshr_b64 s[58:59], s[58:59], 4
    s_lshl_b32 s56, s57, 11
    s_mul_i32 s57, s57, 0x70000
    s_mov_b32 m0, s53
    s_nop 0
    buffer_load_dwordx4 v206, s[28:31], s56 offen offset:0 lds
    buffer_load_dwordx4 v206, s[28:31], s56 offen offset:1024 lds
    buffer_load_dwordx4 v207, s[28:31], s56 offen offset:2048 lds
    buffer_load_dwordx4 v207, s[28:31], s56 offen offset:3072 lds
    s_add_u32 s53, s53, 49152
    s_cmp_ge_u32 s53, s61
    s_cselect_b32 s53, s60, s53
    s_and_b32 s57, s58, 15
    s_lshr_b64 s[58:59], s[58:59], 4
    s_lshl_b32 s56, s57, 11
    s_mul_i32 s57, s57, 0x70000
    s_add_u32 m0, s53, 16384
    s_nop 0
    buffer_load_dwordx4 v208, s[32:35], s57 offen offset:0 lds
    buffer_load_dwordx4 v209, s[32:35], s57 offen offset:1024 lds
    buffer_load_dwordx4 v210, s[32:35], s57 offen offset:2048 lds
    buffer_load_dwordx4 v211, s[32:35], s57 offen offset:3072 lds
    s_add_u32 m0, s53, 32768
    s_nop 0
    buffer_load_dwordx4 v208, s[36:39], s57 offen offset:0 lds
    buffer_load_dwordx4 v209, s[36:39], s57 offen offset:1024 lds
    buffer_load_dwordx4 v210, s[36:39], s57 offen offset:2048 lds
    buffer_load_dwordx4 v211, s[36:39], s57 offen offset:3072 lds
    s_mov_b32 m0, s53
    s_nop 0
    buffer_load_dwordx4 v206, s[28:31], s56 offen offset:0 lds
    buffer_load_dwordx4 v206, s[28:31], s56 offen offset:1024 lds
    buffer_load_dwordx4 v207, s[28:31], s56 offen offset:2048 lds
    buffer_load_dwordx4 v207, s[28:31], s56 offen offset:3072 lds
    s_add_u32 s53, s53, 49152
    s_cmp_ge_u32 s53, s61
    s_cselect_b32 s53, s60, s53
    s_waitcnt vmcnt(12)
    s_barrier
    s_and_b32 s57, s58, 15
    s_lshr_b64 s[58:59], s[58:59], 4
    s_lshl_b32 s56, s57, 11
    s_mul_i32 s57, s57, 0x70000
    s_add_u32 m0, s53, 16384
    s_nop 0
    buffer_load_dwordx4 v208, s[32:35], s57 offen offset:0 lds
    buffer_load_dwordx4 v209, s[32:35], s57 offen offset:1024 lds
    buffer_load_dwordx4 v210, s[32:35], s57 offen offset:2048 lds
    buffer_load_dwordx4 v211, s[32:35], s57 offen offset:3072 lds
    s_add_u32 m0, s53, 32768
    s_nop 0
    buffer_load_dwordx4 v208, s[36:39], s57 offen offset:0 lds
    buffer_load_dwordx4 v209, s[36:39], s57 offen offset:1024 lds
    buffer_load_dwordx4 v210, s[36:39], s57 offen offset:2048 lds
    buffer_load_dwordx4 v211, s[36:39], s57 offen offset:3072 lds
    s_mov_b32 m0, s53
    s_nop 0
    buffer_load_dwordx4 v206, s[28:31], s56 offen offset:0 lds
    buffer_load_dwordx4 v206, s[28:31], s56 offen offset:1024 lds
    buffer_load_dwordx4 v207, s[28:31], s56 offen offset:2048 lds
    buffer_load_dwordx4 v207, s[28:31], s56 offen offset:3072 lds
    s_add_u32 s53, s53, 49152
    s_cmp_ge_u32 s53, s61
    s_cselect_b32 s53, s60, s53
    s_lshl_b32 s64, s45, 13
    v_lshl_add_u32 v233, v1, 4, s64
    v_lshrrev_b32 v2, 2, v1
    v_lshlrev_b32 v4, 8, v2
    v_and_b32 v5, 3, v1
    v_lshl_add_u32 v4, v5, 3, v4
    v_add_u32 v4, 16384, v4
    v_and_b32 v2, 7, v2
    s_lshl_b32 s64, s46, 2
    v_xor_b32 v2, s64, v2
    v_xor_b32 v3, 0, v2
    v_lshl_add_u32 v239, v3, 5, v4
    v_xor_b32 v3, 1, v2
    v_lshl_add_u32 v240, v3, 5, v4
    v_xor_b32 v3, 2, v2
    v_lshl_add_u32 v241, v3, 5, v4
    v_xor_b32 v3, 3, v2
    v_lshl_add_u32 v242, v3, 5, v4
    s_mov_b32 s52, 49152
    v_add_u32 v232, s52, v233
    v_add_u32 v235, s52, v239
    v_add_u32 v236, s52, v240
    v_add_u32 v237, s52, v241
    v_add_u32 v238, s52, v242
    s_lshl_b32 s64, s2, 2
    s_add_u32 s64, s64, s44
    s_mul_i32 s64, s64, 7168
    s_add_u32 s64, s64, 2304
    s_add_u32 s10, s12, s64
    s_addc_u32 s11, s13, 0
    s_add_u32 s24, s14, s64
    s_addc_u32 s25, s15, 0
    s_movk_i32 s54, 12
M_Q_loop2:
    s_waitcnt vmcnt(12)
    s_barrier
    s_and_b32 s57, s58, 15
    s_lshr_b64 s[58:59], s[58:59], 4
    s_lshl_b32 s56, s57, 11
    s_mul_i32 s57, s57, 0x70000
    s_add_u32 m0, s53, 16384
    s_nop 0
    buffer_load_dwordx4 v208, s[32:35], s57 offen offset:0 lds
    buffer_load_dwordx4 v209, s[32:35], s57 offen offset:1024 lds
    buffer_load_dwordx4 v210, s[32:35], s57 offen offset:2048 lds
    buffer_load_dwordx4 v211, s[32:35], s57 offen offset:3072 lds
    s_add_u32 m0, s53, 32768
    s_nop 0
    buffer_load_dwordx4 v208, s[36:39], s57 offen offset:0 lds
    buffer_load_dwordx4 v209, s[36:39], s57 offen offset:1024 lds
    buffer_load_dwordx4 v210, s[36:39], s57 offen offset:2048 lds
    buffer_load_dwordx4 v211, s[36:39], s57 offen offset:3072 lds
    s_mov_b32 m0, s53
    s_nop 0
    buffer_load_dwordx4 v206, s[28:31], s56 offen offset:0 lds
    buffer_load_dwordx4 v206, s[28:31], s56 offen offset:1024 lds
    buffer_load_dwordx4 v207, s[28:31], s56 offen offset:2048 lds
    buffer_load_dwordx4 v207, s[28:31], s56 offen offset:3072 lds
    s_add_u32 s53, s53, 49152
    s_cmp_ge_u32 s53, s61
    s_cselect_b32 s53, s60, s53
    s_sub_u32 s54, s54, 1
    s_cbranch_scc0 M_Q_loop2
    s_waitcnt vmcnt(12)
    s_barrier
    s_bfe_u32 s66, s2, 0x30003
    s_lshr_b32 s55, s2, 6
    s_add_u32 s66, s66, s55
    s_mul_i32 s55, s66, 11
    s_lshr_b32 s55, s55, 5
    s_mul_i32 s55, s55, 3
    s_sub_u32 s66, s66, s55
    s_mov_b32 s58, 0x67534201
    s_mov_b32 s59, 0xfecdb9a8
    s_cmp_eq_u32 s66, 1
    s_cselect_b32 s58, 0x86453120, s58
    s_cselect_b32 s59, 0xfdecab97, s59
    s_cmp_eq_u32 s66, 2
    s_cselect_b32 s58, 0x75642310, s58
    s_cselect_b32 s59, 0xefdbca89, s59
    v_or_b32 v206, s69, v206
    v_or_b32 v207, s69, v207
    s_and_b32 s57, s58, 15
    s_lshr_b64 s[58:59], s[58:59], 4
    s_lshl_b32 s56, s57, 11
    s_mul_i32 s57, s57, 0x70000
    s_add_u32 m0, s53, 16384
    s_nop 0
    buffer_load_dwordx4 v212, s[32:35], s57 offen offset:0 lds
    buffer_load_dwordx4 v213, s[32:35], s57 offen offset:1024 lds
    buffer_load_dwordx4 v214, s[32:35], s57 offen offset:2048 lds
    buffer_load_dwordx4 v215, s[32:35], s57 offen offset:3072 lds
    s_add_u32 m0, s53, 32768
    s_nop 0
    buffer_load_dwordx4 v212, s[36:39], s57 offen offset:0 lds
    buffer_load_dwordx4 v213, s[36:39], s57 offen offset:1024 lds
    buffer_load_dwordx4 v214, s[36:39], s57 offen offset:2048 lds
    buffer_load_dwordx4 v215, s[36:39], s57 offen offset:3072 lds
    s_mov_b32 m0, s53
    s_nop 0
    buffer_load_dwordx4 v206, s[28:31], s56 offen offset:0 lds
    buffer_load_dwordx4 v206, s[28:31], s56 offen offset:1024 lds
    buffer_load_dwordx4 v207, s[28:31], s56 offen offset:2048 lds
    buffer_load_dwordx4 v207, s[28:31], s56 offen offset:3072 lds
    s_add_u32 s53, s53, 49152
    s_cmp_ge_u32 s53, s61
    s_cselect_b32 s53, s60, s53
    s_waitcnt vmcnt(12)
    s_barrier
    s_and_b32 s57, s58, 15
    s_lshr_b64 s[58:59], s[58:59], 4
    s_lshl_b32 s56, s57, 11
    s_mul_i32 s57, s57, 0x70000
    s_add_u32 m0, s53, 16384
    s_nop 0
    buffer_load_dwordx4 v212, s[32:35], s57 offen offset:0 lds
    buffer_load_dwordx4 v213, s[32:35], s57 offen offset:1024 lds
    buffer_load_dwordx4 v214, s[32:35], s57 offen offset:2048 lds
    buffer_load_dwordx4 v215, s[32:35], s57 offen offset:3072 lds
    s_add_u32 m0, s53, 32768
    s_nop 0
    buffer_load_dwordx4 v212, s[36:39], s57 offen offset:0 lds
    buffer_load_dwordx4 v213, s[36:39], s57 offen offset:1024 lds
    buffer_load_dwordx4 v214, s[36:39], s57 offen offset:2048 lds
    buffer_load_dwordx4 v215, s[36:39], s57 offen offset:3072 lds
    s_mov_b32 m0, s53
    s_nop 0
    buffer_load_dwordx4 v206, s[28:31], s56 offen offset:0 lds
    buffer_load_dwordx4 v206, s[28:31], s56 offen offset:1024 lds
    buffer_load_dwordx4 v207, s[28:31], s56 offen offset:2048 lds
    buffer_load_dwordx4 v207, s[28:31], s56 offen offset:3072 lds
    s_add_u32 s53, s53, 49152
    s_cmp_ge_u32 s53, s61
    s_cselect_b32 s53, s60, s53
    s_waitcnt vmcnt(12)
    s_barrier
    s_cmp_lg_u32 s69, 0
    s_cbranch_scc1 M_Qidle
    ds_read_b128 v[136:139], v232 offset:0
    ds_read_b64_tr_b16 v[152:153], v235 offset:0
    ds_read_b64_tr_b16 v[154:155], v235 offset:4096
    ds_read_b64_tr_b16 v[156:157], v236 offset:0
    ds_read_b64_tr_b16 v[158:159], v236 offset:4096
    ds_read_b64_tr_b16 v[160:161], v237 offset:0
    ds_read_b64_tr_b16 v[162:163], v237 offset:4096
    ds_read_b64_tr_b16 v[164:165], v238 offset:0
    ds_read_b64_tr_b16 v[166:167], v238 offset:4096
    ds_read_b64_tr_b16 v[168:169], v235 offset:16384
    ds_read_b64_tr_b16 v[170:171], v235 offset:20480
    ds_read_b64_tr_b16 v[172:173], v236 offset:16384
    ds_read_b64_tr_b16 v[174:175], v236 offset:20480
    ds_read_b64_tr_b16 v[176:177], v237 offset:16384
    ds_read_b64_tr_b16 v[178:179], v237 offset:20480
    ds_read_b64_tr_b16 v[180:181], v238 offset:16384
    ds_read_b64_tr_b16 v[182:183], v238 offset:20480
    ds_read_b128 v[140:143], v232 offset:2048
    ds_read_b128 v[144:147], v232 offset:4096
    ds_read_b128 v[148:151], v232 offset:6144
    s_and_b32 s57, s58, 15
    s_lshr_b64 s[58:59], s[58:59], 4
    s_lshl_b32 s56, s57, 11
    s_mul_i32 s57, s57, 0x70000
    s_add_u32 m0, s53, 16384
    s_nop 0
    buffer_load_dwordx4 v212, s[32:35], s57 offen offset:0 lds
    buffer_load_dwordx4 v213, s[32:35], s57 offen offset:1024 lds
    buffer_load_dwordx4 v214, s[32:35], s57 offen offset:2048 lds
    buffer_load_dwordx4 v215, s[32:35], s57 offen offset:3072 lds
    s_add_u32 m0, s53, 32768
    s_nop 0
    buffer_load_dwordx4 v212, s[36:39], s57 offen offset:0 lds
    buffer_load_dwordx4 v213, s[36:39], s57 offen offset:1024 lds
    buffer_load_dwordx4 v214, s[36:39], s57 offen offset:2048 lds
    buffer_load_dwordx4 v215, s[36:39], s57 offen offset:3072 lds
    s_mov_b32 m0, s53
    s_nop 0
    buffer_load_dwordx4 v206, s[28:31], s56 offen offset:0 lds
    buffer_load_dwordx4 v206, s[28:31], s56 offen offset:1024 lds
    buffer_load_dwordx4 v207, s[28:31], s56 offen offset:2048 lds
    buffer_load_dwordx4 v207, s[28:31], s56 offen offset:3072 lds
    s_add_u32 s53, s53, 49152
    s_cmp_ge_u32 s53, s61
    s_cselect_b32 s53, s60, s53
    s_setprio 2
    s_add_u32 s52, s52, 49152
    s_cmp_ge_u32 s52, 147456
    s_cselect_b32 s52, 0, s52
    s_waitcnt lgkmcnt(0)
    v_mfma_f32_16x16x32_bf16 v[8:11], v[152:155], v[136:139], 0
    ds_read_b128 v[184:187], v232 offset:1024
    v_mfma_f32_16x16x32_bf16 v[12:15], v[156:159], v[136:139], 0
    ds_read_b64_tr_b16 v[200:201], v235 offset:8192
    v_mfma_f32_16x16x32_bf16 v[16:19], v[160:163], v[136:139], 0
    ds_read_b64_tr_b16 v[202:203], v235 offset:12288
    v_mfma_f32_16x16x32_bf16 v[20:23], v[164:167], v[136:139], 0
    ds_read_b64_tr_b16 v[204:205], v236 offset:8192
    v_mfma_f32_16x16x32_bf16 v[24:27], v[168:171], v[136:139], 0
    v_mfma_f32_16x16x32_bf16 v[28:31], v[172:175], v[136:139], 0
    ds_read_b64_tr_b16 v[206:207], v236 offset:12288
    v_mfma_f32_16x16x32_bf16 v[32:35], v[176:179], v[136:139], 0
    ds_read_b64_tr_b16 v[208:209], v237 offset:8192
    v_mfma_f32_16x16x32_bf16 v[36:39], v[180:183], v[136:139], 0
    ds_read_b64_tr_b16 v[210:211], v237 offset:12288
    v_mfma_f32_16x16x32_bf16 v[40:43], v[152:155], v[140:143], 0
    ds_read_b64_tr_b16 v[212:213], v238 offset:8192
    v_mfma_f32_16x16x32_bf16 v[44:47], v[156:159], v[140:143], 0
    v_mfma_f32_16x16x32_bf16 v[48:51], v[160:163], v[140:143], 0
    ds_read_b64_tr_b16 v[214:215], v238 offset:12288
    v_mfma_f32_16x16x32_bf16 v[52:55], v[164:167], v[140:143], 0
    ds_read_b64_tr_b16 v[216:217], v235 offset:24576
    v_mfma_f32_16x16x32_bf16 v[56:59], v[168:171], v[140:143], 0
    ds_read_b64_tr_b16 v[218:219], v235 offset:28672
    v_mfma_f32_16x16x32_bf16 v[60:63], v[172:175], v[140:143], 0
    ds_read_b64_tr_b16 v[220:221], v236 offset:24576
    v_mfma_f32_16x16x32_bf16 v[64:67], v[176:179], v[140:143], 0
    v_mfma_f32_16x16x32_bf16 v[68:71], v[180:183], v[140:143], 0
    ds_read_b64_tr_b16 v[222:223], v236 offset:28672
    v_mfma_f32_16x16x32_bf16 v[72:75], v[152:155], v[144:147], 0
    ds_read_b64_tr_b16 v[224:225], v237 offset:24576
    v_mfma_f32_16x16x32_bf16 v[76:79], v[156:159], v[144:147], 0
    ds_read_b64_tr_b16 v[226:227], v237 offset:28672
    v_mfma_f32_16x16x32_bf16 v[80:83], v[160:163], v[144:147], 0
    ds_read_b64_tr_b16 v[228:229], v238 offset:24576
    v_mfma_f32_16x16x32_bf16 v[84:87], v[164:167], v[144:147], 0
    v_mfma_f32_16x16x32_bf16 v[88:91], v[168:171], v[144:147], 0
    ds_read_b64_tr_b16 v[230:231], v238 offset:28672
    v_mfma_f32_16x16x32_bf16 v[92:95], v[172:175], v[144:147], 0
    ds_read_b128 v[188:191], v232 offset:3072
    v_mfma_f32_16x16x32_bf16 v[96:99], v[176:179], v[144:147], 0
    ds_read_b128 v[192:195], v232 offset:5120
    v_mfma_f32_16x16x32_bf16 v[100:103], v[180:183], v[144:147], 0
    ds_read_b128 v[196:199], v232 offset:7168
    v_mfma_f32_16x16x32_bf16 v[104:107], v[152:155], v[148:151], 0
    v_mfma_f32_16x16x32_bf16 v[108:111], v[156:159], v[148:151], 0
    v_add_u32 v232, s52, v233
    v_mfma_f32_16x16x32_bf16 v[112:115], v[160:163], v[148:151], 0
    v_add_u32 v235, s52, v239
    v_mfma_f32_16x16x32_bf16 v[116:119], v[164:167], v[148:151], 0
    v_add_u32 v236, s52, v240
    v_mfma_f32_16x16x32_bf16 v[120:123], v[168:171], v[148:151], 0
    v_mfma_f32_16x16x32_bf16 v[124:127], v[172:175], v[148:151], 0
    v_add_u32 v237, s52, v241
    v_mfma_f32_16x16x32_bf16 v[128:131], v[176:179], v[148:151], 0
    v_add_u32 v238, s52, v242
    v_mfma_f32_16x16x32_bf16 v[132:135], v[180:183], v[148:151], 0
    s_waitcnt lgkmcnt(0)
    v_mfma_f32_16x16x32_bf16 v[8:11], v[200:203], v[184:187], v[8:11]
    s_waitcnt vmcnt(12)
    s_barrier
    v_mfma_f32_16x16x32_bf16 v[12:15], v[204:207], v[184:187], v[12:15]
    ds_read_b128 v[136:139], v232 offset:0
    v_mfma_f32_16x16x32_bf16 v[16:19], v[208:211], v[184:187], v[16:19]
    ds_read_b64_tr_b16 v[152:153], v235 offset:0
    v_mfma_f32_16x16x32_bf16 v[20:23], v[212:215], v[184:187], v[20:23]
    ds_read_b64_tr_b16 v[154:155], v235 offset:4096
    v_mfma_f32_16x16x32_bf16 v[24:27], v[216:219], v[184:187], v[24:27]
    ds_read_b64_tr_b16 v[156:157], v236 offset:0
    v_mfma_f32_16x16x32_bf16 v[28:31], v[220:223], v[184:187], v[28:31]
    ds_read_b64_tr_b16 v[158:159], v236 offset:4096
    v_mfma_f32_16x16x32_bf16 v[32:35], v[224:227], v[184:187], v[32:35]
    v_mfma_f32_16x16x32_bf16 v[36:39], v[228:231], v[184:187], v[36:39]
    ds_read_b64_tr_b16 v[160:161], v237 offset:0
    v_mfma_f32_16x16x32_bf16 v[40:43], v[200:203], v[188:191], v[40:43]
    ds_read_b64_tr_b16 v[162:163], v237 offset:4096
    v_mfma_f32_16x16x32_bf16 v[44:47], v[204:207], v[188:191], v[44:47]
    ds_read_b64_tr_b16 v[164:165], v238 offset:0
    v_mfma_f32_16x16x32_bf16 v[48:51], v[208:211], v[188:191], v[48:51]
    ds_read_b64_tr_b16 v[166:167], v238 offset:4096
    v_mfma_f32_16x16x32_bf16 v[52:55], v[212:215], v[188:191], v[52:55]
    ds_read_b64_tr_b16 v[168:169], v235 offset:16384
    v_mfma_f32_16x16x32_bf16 v[56:59], v[216:219], v[188:191], v[56:59]
    v_mfma_f32_16x16x32_bf16 v[60:63], v[220:223], v[188:191], v[60:63]
    ds_read_b64_tr_b16 v[170:171], v235 offset:20480
    v_mfma_f32_16x16x32_bf16 v[64:67], v[224:227], v[188:191], v[64:67]
    ds_read_b64_tr_b16 v[172:173], v236 offset:16384
    v_mfma_f32_16x16x32_bf16 v[68:71], v[228:231], v[188:191], v[68:71]
    ds_read_b64_tr_b16 v[174:175], v236 offset:20480
    v_mfma_f32_16x16x32_bf16 v[72:75], v[200:203], v[192:195], v[72:75]
    ds_read_b64_tr_b16 v[176:177], v237 offset:16384
    v_mfma_f32_16x16x32_bf16 v[76:79], v[204:207], v[192:195], v[76:79]
    ds_read_b64_tr_b16 v[178:179], v237 offset:20480
    v_mfma_f32_16x16x32_bf16 v[80:83], v[208:211], v[192:195], v[80:83]
    v_mfma_f32_16x16x32_bf16 v[84:87], v[212:215], v[192:195], v[84:87]
    ds_read_b64_tr_b16 v[180:181], v238 offset:16384
    v_mfma_f32_16x16x32_bf16 v[88:91], v[216:219], v[192:195], v[88:91]
    ds_read_b64_tr_b16 v[182:183], v238 offset:20480
    v_mfma_f32_16x16x32_bf16 v[92:95], v[220:223], v[192:195], v[92:95]
    ds_read_b128 v[140:143], v232 offset:2048
    v_mfma_f32_16x16x32_bf16 v[96:99], v[224:227], v[192:195], v[96:99]
    ds_read_b128 v[144:147], v232 offset:4096
    v_mfma_f32_16x16x32_bf16 v[100:103], v[228:231], v[192:195], v[100:103]
    ds_read_b128 v[148:151], v232 offset:6144
    v_mfma_f32_16x16x32_bf16 v[104:107], v[200:203], v[196:199], v[104:107]
    v_mfma_f32_16x16x32_bf16 v[108:111], v[204:207], v[196:199], v[108:111]
    v_mfma_f32_16x16x32_bf16 v[112:115], v[208:211], v[196:199], v[112:115]
    v_mfma_f32_16x16x32_bf16 v[116:119], v[212:215], v[196:199], v[116:119]
    v_mfma_f32_16x16x32_bf16 v[120:123], v[216:219], v[196:199], v[120:123]
    v_mfma_f32_16x16x32_bf16 v[124:127], v[220:223], v[196:199], v[124:127]
    v_mfma_f32_16x16x32_bf16 v[128:131], v[224:227], v[196:199], v[128:131]
    s_add_u32 s52, s52, 49152
    s_cmp_ge_u32 s52, 147456
    s_cselect_b32 s52, 0, s52
    v_mfma_f32_16x16x32_bf16 v[132:135], v[228:231], v[196:199], v[132:135]
    s_waitcnt lgkmcnt(0)
    v_mfma_f32_16x16x32_bf16 v[8:11], v[152:155], v[136:139], v[8:11]
    ds_read_b128 v[184:187], v232 offset:1024
    v_mfma_f32_16x16x32_bf16 v[12:15], v[156:159], v[136:139], v[12:15]
    ds_read_b64_tr_b16 v[200:201], v235 offset:8192
    v_mfma_f32_16x16x32_bf16 v[16:19], v[160:163], v[136:139], v[16:19]
    ds_read_b64_tr_b16 v[202:203], v235 offset:12288
    v_mfma_f32_16x16x32_bf16 v[20:23], v[164:167], v[136:139], v[20:23]
    ds_read_b64_tr_b16 v[204:205], v236 offset:8192
    v_mfma_f32_16x16x32_bf16 v[24:27], v[168:171], v[136:139], v[24:27]
    v_mfma_f32_16x16x32_bf16 v[28:31], v[172:175], v[136:139], v[28:31]
    ds_read_b64_tr_b16 v[206:207], v236 offset:12288
    v_mfma_f32_16x16x32_bf16 v[32:35], v[176:179], v[136:139], v[32:35]
    ds_read_b64_tr_b16 v[208:209], v237 offset:8192
    v_mfma_f32_16x16x32_bf16 v[36:39], v[180:183], v[136:139], v[36:39]
    ds_read_b64_tr_b16 v[210:211], v237 offset:12288
    v_mfma_f32_16x16x32_bf16 v[40:43], v[152:155], v[140:143], v[40:43]
    ds_read_b64_tr_b16 v[212:213], v238 offset:8192
    v_mfma_f32_16x16x32_bf16 v[44:47], v[156:159], v[140:143], v[44:47]
    v_mfma_f32_16x16x32_bf16 v[48:51], v[160:163], v[140:143], v[48:51]
    ds_read_b64_tr_b16 v[214:215], v238 offset:12288
    v_mfma_f32_16x16x32_bf16 v[52:55], v[164:167], v[140:143], v[52:55]
    ds_read_b64_tr_b16 v[216:217], v235 offset:24576
    v_mfma_f32_16x16x32_bf16 v[56:59], v[168:171], v[140:143], v[56:59]
    ds_read_b64_tr_b16 v[218:219], v235 offset:28672
    v_mfma_f32_16x16x32_bf16 v[60:63], v[172:175], v[140:143], v[60:63]
    ds_read_b64_tr_b16 v[220:221], v236 offset:24576
    v_mfma_f32_16x16x32_bf16 v[64:67], v[176:179], v[140:143], v[64:67]
    v_mfma_f32_16x16x32_bf16 v[68:71], v[180:183], v[140:143], v[68:71]
    ds_read_b64_tr_b16 v[222:223], v236 offset:28672
    v_mfma_f32_16x16x32_bf16 v[72:75], v[152:155], v[144:147], v[72:75]
    ds_read_b64_tr_b16 v[224:225], v237 offset:24576
    v_mfma_f32_16x16x32_bf16 v[76:79], v[156:159], v[144:147], v[76:79]
    ds_read_b64_tr_b16 v[226:227], v237 offset:28672
    v_mfma_f32_16x16x32_bf16 v[80:83], v[160:163], v[144:147], v[80:83]
    ds_read_b64_tr_b16 v[228:229], v238 offset:24576
    v_mfma_f32_16x16x32_bf16 v[84:87], v[164:167], v[144:147], v[84:87]
    v_mfma_f32_16x16x32_bf16 v[88:91], v[168:171], v[144:147], v[88:91]
    ds_read_b64_tr_b16 v[230:231], v238 offset:28672
    v_mfma_f32_16x16x32_bf16 v[92:95], v[172:175], v[144:147], v[92:95]
    ds_read_b128 v[188:191], v232 offset:3072
    v_mfma_f32_16x16x32_bf16 v[96:99], v[176:179], v[144:147], v[96:99]
    ds_read_b128 v[192:195], v232 offset:5120
    v_mfma_f32_16x16x32_bf16 v[100:103], v[180:183], v[144:147], v[100:103]
    ds_read_b128 v[196:199], v232 offset:7168
    v_mfma_f32_16x16x32_bf16 v[104:107], v[152:155], v[148:151], v[104:107]
    v_mfma_f32_16x16x32_bf16 v[108:111], v[156:159], v[148:151], v[108:111]
    v_add_u32 v232, s52, v233
    v_mfma_f32_16x16x32_bf16 v[112:115], v[160:163], v[148:151], v[112:115]
    v_add_u32 v235, s52, v239
    v_mfma_f32_16x16x32_bf16 v[116:119], v[164:167], v[148:151], v[116:119]
    v_add_u32 v236, s52, v240
    v_mfma_f32_16x16x32_bf16 v[120:123], v[168:171], v[148:151], v[120:123]
    v_mfma_f32_16x16x32_bf16 v[124:127], v[172:175], v[148:151], v[124:127]
    v_add_u32 v237, s52, v241
    v_mfma_f32_16x16x32_bf16 v[128:131], v[176:179], v[148:151], v[128:131]
    v_add_u32 v238, s52, v242
    v_mfma_f32_16x16x32_bf16 v[132:135], v[180:183], v[148:151], v[132:135]
    s_waitcnt lgkmcnt(0)
    v_mfma_f32_16x16x32_bf16 v[8:11], v[200:203], v[184:187], v[8:11]
    s_waitcnt vmcnt(0)
    s_barrier
    v_mfma_f32_16x16x32_bf16 v[12:15], v[204:207], v[184:187], v[12:15]
    ds_read_b128 v[136:139], v232 offset:0
    v_mfma_f32_16x16x32_bf16 v[16:19], v[208:211], v[184:187], v[16:19]
    ds_read_b64_tr_b16 v[152:153], v235 offset:0
    v_mfma_f32_16x16x32_bf16 v[20:23], v[212:215], v[184:187], v[20:23]
    ds_read_b64_tr_b16 v[154:155], v235 offset:4096
    v_mfma_f32_16x16x32_bf16 v[24:27], v[216:219], v[184:187], v[24:27]
    ds_read_b64_tr_b16 v[156:157], v236 offset:0
    v_mfma_f32_16x16x32_bf16 v[28:31], v[220:223], v[184:187], v[28:31]
    ds_read_b64_tr_b16 v[158:159], v236 offset:4096
    v_mfma_f32_16x16x32_bf16 v[32:35], v[224:227], v[184:187], v[32:35]
    v_mfma_f32_16x16x32_bf16 v[36:39], v[228:231], v[184:187], v[36:39]
    ds_read_b64_tr_b16 v[160:161], v237 offset:0
    v_mfma_f32_16x16x32_bf16 v[40:43], v[200:203], v[188:191], v[40:43]
    ds_read_b64_tr_b16 v[162:163], v237 offset:4096
    v_mfma_f32_16x16x32_bf16 v[44:47], v[204:207], v[188:191], v[44:47]
    ds_read_b64_tr_b16 v[164:165], v238 offset:0
    v_mfma_f32_16x16x32_bf16 v[48:51], v[208:211], v[188:191], v[48:51]
    ds_read_b64_tr_b16 v[166:167], v238 offset:4096
    v_mfma_f32_16x16x32_bf16 v[52:55], v[212:215], v[188:191], v[52:55]
    ds_read_b64_tr_b16 v[168:169], v235 offset:16384
    v_mfma_f32_16x16x32_bf16 v[56:59], v[216:219], v[188:191], v[56:59]
    v_mfma_f32_16x16x32_bf16 v[60:63], v[220:223], v[188:191], v[60:63]
    ds_read_b64_tr_b16 v[170:171], v235 offset:20480
    v_mfma_f32_16x16x32_bf16 v[64:67], v[224:227], v[188:191], v[64:67]
    ds_read_b64_tr_b16 v[172:173], v236 offset:16384
    v_mfma_f32_16x16x32_bf16 v[68:71], v[228:231], v[188:191], v[68:71]
    ds_read_b64_tr_b16 v[174:175], v236 offset:20480
    v_mfma_f32_16x16x32_bf16 v[72:75], v[200:203], v[192:195], v[72:75]
    ds_read_b64_tr_b16 v[176:177], v237 offset:16384
    v_mfma_f32_16x16x32_bf16 v[76:79], v[204:207], v[192:195], v[76:79]
    ds_read_b64_tr_b16 v[178:179], v237 offset:20480
    v_mfma_f32_16x16x32_bf16 v[80:83], v[208:211], v[192:195], v[80:83]
    v_mfma_f32_16x16x32_bf16 v[84:87], v[212:215], v[192:195], v[84:87]
    ds_read_b64_tr_b16 v[180:181], v238 offset:16384
    v_mfma_f32_16x16x32_bf16 v[88:91], v[216:219], v[192:195], v[88:91]
    ds_read_b64_tr_b16 v[182:183], v238 offset:20480
    v_mfma_f32_16x16x32_bf16 v[92:95], v[220:223], v[192:195], v[92:95]
    ds_read_b128 v[140:143], v232 offset:2048
    v_mfma_f32_16x16x32_bf16 v[96:99], v[224:227], v[192:195], v[96:99]
    ds_read_b128 v[144:147], v232 offset:4096
    v_mfma_f32_16x16x32_bf16 v[100:103], v[228:231], v[192:195], v[100:103]
    ds_read_b128 v[148:151], v232 offset:6144
    v_mfma_f32_16x16x32_bf16 v[104:107], v[200:203], v[196:199], v[104:107]
    v_mfma_f32_16x16x32_bf16 v[108:111], v[204:207], v[196:199], v[108:111]
    v_mfma_f32_16x16x32_bf16 v[112:115], v[208:211], v[196:199], v[112:115]
    v_mfma_f32_16x16x32_bf16 v[116:119], v[212:215], v[196:199], v[116:119]
    v_mfma_f32_16x16x32_bf16 v[120:123], v[216:219], v[196:199], v[120:123]
    v_mfma_f32_16x16x32_bf16 v[124:127], v[220:223], v[196:199], v[124:127]
    v_mfma_f32_16x16x32_bf16 v[128:131], v[224:227], v[196:199], v[128:131]
    s_add_u32 s52, s52, 49152
    s_cmp_ge_u32 s52, 147456
    s_cselect_b32 s52, 0, s52
    v_mfma_f32_16x16x32_bf16 v[132:135], v[228:231], v[196:199], v[132:135]
    s_waitcnt lgkmcnt(0)
    v_mfma_f32_16x16x32_bf16 v[8:11], v[152:155], v[136:139], v[8:11]
    ds_read_b128 v[184:187], v232 offset:1024
    v_mfma_f32_16x16x32_bf16 v[12:15], v[156:159], v[136:139], v[12:15]
    ds_read_b64_tr_b16 v[200:201], v235 offset:8192
    v_mfma_f32_16x16x32_bf16 v[16:19], v[160:163], v[136:139], v[16:19]
    ds_read_b64_tr_b16 v[202:203], v235 offset:12288
    v_mfma_f32_16x16x32_bf16 v[20:23], v[164:167], v[136:139], v[20:23]
    ds_read_b64_tr_b16 v[204:205], v236 offset:8192
    v_mfma_f32_16x16x32_bf16 v[24:27], v[168:171], v[136:139], v[24:27]
    v_mfma_f32_16x16x32_bf16 v[28:31], v[172:175], v[136:139], v[28:31]
    ds_read_b64_tr_b16 v[206:207], v236 offset:12288
    v_mfma_f32_16x16x32_bf16 v[32:35], v[176:179], v[136:139], v[32:35]
    ds_read_b64_tr_b16 v[208:209], v237 offset:8192
    v_mfma_f32_16x16x32_bf16 v[36:39], v[180:183], v[136:139], v[36:39]
    ds_read_b64_tr_b16 v[210:211], v237 offset:12288
    v_mfma_f32_16x16x32_bf16 v[40:43], v[152:155], v[140:143], v[40:43]
    ds_read_b64_tr_b16 v[212:213], v238 offset:8192
    v_mfma_f32_16x16x32_bf16 v[44:47], v[156:159], v[140:143], v[44:47]
    v_mfma_f32_16x16x32_bf16 v[48:51], v[160:163], v[140:143], v[48:51]
    ds_read_b64_tr_b16 v[214:215], v238 offset:12288
    v_mfma_f32_16x16x32_bf16 v[52:55], v[164:167], v[140:143], v[52:55]
    ds_read_b64_tr_b16 v[216:217], v235 offset:24576
    v_mfma_f32_16x16x32_bf16 v[56:59], v[168:171], v[140:143], v[56:59]
    ds_read_b64_tr_b16 v[218:219], v235 offset:28672
    v_mfma_f32_16x16x32_bf16 v[60:63], v[172:175], v[140:143], v[60:63]
    ds_read_b64_tr_b16 v[220:221], v236 offset:24576
    v_mfma_f32_16x16x32_bf16 v[64:67], v[176:179], v[140:143], v[64:67]
    v_mfma_f32_16x16x32_bf16 v[68:71], v[180:183], v[140:143], v[68:71]
    ds_read_b64_tr_b16 v[222:223], v236 offset:28672
    v_mfma_f32_16x16x32_bf16 v[72:75], v[152:155], v[144:147], v[72:75]
    s_movk_i32 s54, 12
M_Q_loop3:
    ds_read_b64_tr_b16 v[224:225], v237 offset:24576
    v_mfma_f32_16x16x32_bf16 v[76:79], v[156:159], v[144:147], v[76:79]
    ds_read_b64_tr_b16 v[226:227], v237 offset:28672
    v_mfma_f32_16x16x32_bf16 v[80:83], v[160:163], v[144:147], v[80:83]
    ds_read_b64_tr_b16 v[228:229], v238 offset:24576
    v_mfma_f32_16x16x32_bf16 v[84:87], v[164:167], v[144:147], v[84:87]
    v_mfma_f32_16x16x32_bf16 v[88:91], v[168:171], v[144:147], v[88:91]
    ds_read_b64_tr_b16 v[230:231], v238 offset:28672
    v_mfma_f32_16x16x32_bf16 v[92:95], v[172:175], v[144:147], v[92:95]
    ds_read_b128 v[188:191], v232 offset:3072
    v_mfma_f32_16x16x32_bf16 v[96:99], v[176:179], v[144:147], v[96:99]
    ds_read_b128 v[192:195], v232 offset:5120
    v_mfma_f32_16x16x32_bf16 v[100:103], v[180:183], v[144:147], v[100:103]
    ds_read_b128 v[196:199], v232 offset:7168
    v_mfma_f32_16x16x32_bf16 v[104:107], v[152:155], v[148:151], v[104:107]
    v_mfma_f32_16x16x32_bf16 v[108:111], v[156:159], v[148:151], v[108:111]
    v_add_u32 v232, s52, v233
    v_mfma_f32_16x16x32_bf16 v[112:115], v[160:163], v[148:151], v[112:115]
    v_add_u32 v235, s52, v239
    v_mfma_f32_16x16x32_bf16 v[116:119], v[164:167], v[148:151], v[116:119]
    v_add_u32 v236, s52, v240
    v_mfma_f32_16x16x32_bf16 v[120:123], v[168:171], v[148:151], v[120:123]
    v_mfma_f32_16x16x32_bf16 v[124:127], v[172:175], v[148:151], v[124:127]
    v_add_u32 v237, s52, v241
    v_mfma_f32_16x16x32_bf16 v[128:131], v[176:179], v[148:151], v[128:131]
    v_add_u32 v238, s52, v242
    v_mfma_f32_16x16x32_bf16 v[132:135], v[180:183], v[148:151], v[132:135]
    s_waitcnt lgkmcnt(0)
    v_mfma_f32_16x16x32_bf16 v[8:11], v[200:203], v[184:187], v[8:11]
    s_barrier
    v_mfma_f32_16x16x32_bf16 v[12:15], v[204:207], v[184:187], v[12:15]
    ds_read_b128 v[136:139], v232 offset:0
    v_mfma_f32_16x16x32_bf16 v[16:19], v[208:211], v[184:187], v[16:19]
    ds_read_b64_tr_b16 v[152:153], v235 offset:0
    v_mfma_f32_16x16x32_bf16 v[20:23], v[212:215], v[184:187], v[20:23]
    ds_read_b64_tr_b16 v[154:155], v235 offset:4096
    v_mfma_f32_16x16x32_bf16 v[24:27], v[216:219], v[184:187], v[24:27]
    ds_read_b64_tr_b16 v[156:157], v236 offset:0
    v_mfma_f32_16x16x32_bf16 v[28:31], v[220:223], v[184:187], v[28:31]
    ds_read_b64_tr_b16 v[158:159], v236 offset:4096
    v_mfma_f32_16x16x32_bf16 v[32:35], v[224:227], v[184:187], v[32:35]
    v_mfma_f32_16x16x32_bf16 v[36:39], v[228:231], v[184:187], v[36:39]
    ds_read_b64_tr_b16 v[160:161], v237 offset:0
    v_mfma_f32_16x16x32_bf16 v[40:43], v[200:203], v[188:191], v[40:43]
    ds_read_b64_tr_b16 v[162:163], v237 offset:4096
    v_mfma_f32_16x16x32_bf16 v[44:47], v[204:207], v[188:191], v[44:47]
    ds_read_b64_tr_b16 v[164:165], v238 offset:0
    v_mfma_f32_16x16x32_bf16 v[48:51], v[208:211], v[188:191], v[48:51]
    ds_read_b64_tr_b16 v[166:167], v238 offset:4096
    v_mfma_f32_16x16x32_bf16 v[52:55], v[212:215], v[188:191], v[52:55]
    ds_read_b64_tr_b16 v[168:169], v235 offset:16384
    v_mfma_f32_16x16x32_bf16 v[56:59], v[216:219], v[188:191], v[56:59]
    v_mfma_f32_16x16x32_bf16 v[60:63], v[220:223], v[188:191], v[60:63]
    ds_read_b64_tr_b16 v[170:171], v235 offset:20480
    v_mfma_f32_16x16x32_bf16 v[64:67], v[224:227], v[188:191], v[64:67]
    ds_read_b64_tr_b16 v[172:173], v236 offset:16384
    v_mfma_f32_16x16x32_bf16 v[68:71], v[228:231], v[188:191], v[68:71]
    ds_read_b64_tr_b16 v[174:175], v236 offset:20480
    v_mfma_f32_16x16x32_bf16 v[72:75], v[200:203], v[192:195], v[72:75]
    ds_read_b64_tr_b16 v[176:177], v237 offset:16384
    v_mfma_f32_16x16x32_bf16 v[76:79], v[204:207], v[192:195], v[76:79]
    ds_read_b64_tr_b16 v[178:179], v237 offset:20480
    v_mfma_f32_16x16x32_bf16 v[80:83], v[208:211], v[192:195], v[80:83]
    v_mfma_f32_16x16x32_bf16 v[84:87], v[212:215], v[192:195], v[84:87]
    ds_read_b64_tr_b16 v[180:181], v238 offset:16384
    v_mfma_f32_16x16x32_bf16 v[88:91], v[216:219], v[192:195], v[88:91]
    ds_read_b64_tr_b16 v[182:183], v238 offset:20480
    v_mfma_f32_16x16x32_bf16 v[92:95], v[220:223], v[192:195], v[92:95]
    ds_read_b128 v[140:143], v232 offset:2048
    v_mfma_f32_16x16x32_bf16 v[96:99], v[224:227], v[192:195], v[96:99]
    ds_read_b128 v[144:147], v232 offset:4096
    v_mfma_f32_16x16x32_bf16 v[100:103], v[228:231], v[192:195], v[100:103]
    ds_read_b128 v[148:151], v232 offset:6144
    v_mfma_f32_16x16x32_bf16 v[104:107], v[200:203], v[196:199], v[104:107]
    v_mfma_f32_16x16x32_bf16 v[108:111], v[204:207], v[196:199], v[108:111]
    v_mfma_f32_16x16x32_bf16 v[112:115], v[208:211], v[196:199], v[112:115]
    v_mfma_f32_16x16x32_bf16 v[116:119], v[212:215], v[196:199], v[116:119]
    v_mfma_f32_16x16x32_bf16 v[120:123], v[216:219], v[196:199], v[120:123]
    v_mfma_f32_16x16x32_bf16 v[124:127], v[220:223], v[196:199], v[124:127]
    v_mfma_f32_16x16x32_bf16 v[128:131], v[224:227], v[196:199], v[128:131]
    s_add_u32 s52, s52, 49152
    s_cmp_ge_u32 s52, 147456
    s_cselect_b32 s52, 0, s52
    v_mfma_f32_16x16x32_bf16 v[132:135], v[228:231], v[196:199], v[132:135]
    s_waitcnt lgkmcnt(0)
    v_mfma_f32_16x16x32_bf16 v[8:11], v[152:155], v[136:139], v[8:11]
    ds_read_b128 v[184:187], v232 offset:1024
    v_mfma_f32_16x16x32_bf16 v[12:15], v[156:159], v[136:139], v[12:15]
    ds_read_b64_tr_b16 v[200:201], v235 offset:8192
    v_mfma_f32_16x16x32_bf16 v[16:19], v[160:163], v[136:139], v[16:19]
    ds_read_b64_tr_b16 v[202:203], v235 offset:12288
    v_mfma_f32_16x16x32_bf16 v[20:23], v[164:167], v[136:139], v[20:23]
    ds_read_b64_tr_b16 v[204:205], v236 offset:8192
    v_mfma_f32_16x16x32_bf16 v[24:27], v[168:171], v[136:139], v[24:27]
    v_mfma_f32_16x16x32_bf16 v[28:31], v[172:175], v[136:139], v[28:31]
    ds_read_b64_tr_b16 v[206:207], v236 offset:12288
    v_mfma_f32_16x16x32_bf16 v[32:35], v[176:179], v[136:139], v[32:35]
    ds_read_b64_tr_b16 v[208:209], v237 offset:8192
    v_mfma_f32_16x16x32_bf16 v[36:39], v[180:183], v[136:139], v[36:39]
    ds_read_b64_tr_b16 v[210:211], v237 offset:12288
    v_mfma_f32_16x16x32_bf16 v[40:43], v[152:155], v[140:143], v[40:43]
    ds_read_b64_tr_b16 v[212:213], v238 offset:8192
    v_mfma_f32_16x16x32_bf16 v[44:47], v[156:159], v[140:143], v[44:47]
    v_mfma_f32_16x16x32_bf16 v[48:51], v[160:163], v[140:143], v[48:51]
    ds_read_b64_tr_b16 v[214:215], v238 offset:12288
    v_mfma_f32_16x16x32_bf16 v[52:55], v[164:167], v[140:143], v[52:55]
    ds_read_b64_tr_b16 v[216:217], v235 offset:24576
    v_mfma_f32_16x16x32_bf16 v[56:59], v[168:171], v[140:143], v[56:59]
    ds_read_b64_tr_b16 v[218:219], v235 offset:28672
    v_mfma_f32_16x16x32_bf16 v[60:63], v[172:175], v[140:143], v[60:63]
    ds_read_b64_tr_b16 v[220:221], v236 offset:24576
    v_mfma_f32_16x16x32_bf16 v[64:67], v[176:179], v[140:143], v[64:67]
    v_mfma_f32_16x16x32_bf16 v[68:71], v[180:183], v[140:143], v[68:71]
    s_sub_u32 s54, s54, 1
    ds_read_b64_tr_b16 v[222:223], v236 offset:28672
    v_mfma_f32_16x16x32_bf16 v[72:75], v[152:155], v[144:147], v[72:75]
    s_cbranch_scc0 M_Q_loop3
    ds_read_b64_tr_b16 v[224:225], v237 offset:24576
    v_mfma_f32_16x16x32_bf16 v[76:79], v[156:159], v[144:147], v[76:79]
    ds_read_b64_tr_b16 v[226:227], v237 offset:28672
    v_mfma_f32_16x16x32_bf16 v[80:83], v[160:163], v[144:147], v[80:83]
    ds_read_b64_tr_b16 v[228:229], v238 offset:24576
    v_mfma_f32_16x16x32_bf16 v[84:87], v[164:167], v[144:147], v[84:87]
    v_mfma_f32_16x16x32_bf16 v[88:91], v[168:171], v[144:147], v[88:91]
    ds_read_b64_tr_b16 v[230:231], v238 offset:28672
    v_mfma_f32_16x16x32_bf16 v[92:95], v[172:175], v[144:147], v[92:95]
    ds_read_b128 v[188:191], v232 offset:3072
    v_mfma_f32_16x16x32_bf16 v[96:99], v[176:179], v[144:147], v[96:99]
    ds_read_b128 v[192:195], v232 offset:5120
    v_mfma_f32_16x16x32_bf16 v[100:103], v[180:183], v[144:147], v[100:103]
    ds_read_b128 v[196:199], v232 offset:7168
    v_mfma_f32_16x16x32_bf16 v[104:107], v[152:155], v[148:151], v[104:107]
    v_mfma_f32_16x16x32_bf16 v[108:111], v[156:159], v[148:151], v[108:111]
    v_mfma_f32_16x16x32_bf16 v[112:115], v[160:163], v[148:151], v[112:115]
    v_mfma_f32_16x16x32_bf16 v[116:119], v[164:167], v[148:151], v[116:119]
    v_mfma_f32_16x16x32_bf16 v[120:123], v[168:171], v[148:151], v[120:123]
    v_mfma_f32_16x16x32_bf16 v[124:127], v[172:175], v[148:151], v[124:127]
    v_mfma_f32_16x16x32_bf16 v[128:131], v[176:179], v[148:151], v[128:131]
    v_mfma_f32_16x16x32_bf16 v[132:135], v[180:183], v[148:151], v[132:135]
    s_waitcnt lgkmcnt(0)
    v_mfma_f32_16x16x32_bf16 v[8:11], v[200:203], v[184:187], v[8:11]
    s_barrier
    v_mfma_f32_16x16x32_bf16 v[12:15], v[204:207], v[184:187], v[12:15]
    v_mfma_f32_16x16x32_bf16 v[16:19], v[208:211], v[184:187], v[16:19]
    v_mfma_f32_16x16x32_bf16 v[20:23], v[212:215], v[184:187], v[20:23]
    v_mfma_f32_16x16x32_bf16 v[24:27], v[216:219], v[184:187], v[24:27]
    v_mfma_f32_16x16x32_bf16 v[28:31], v[220:223], v[184:187], v[28:31]
    v_mfma_f32_16x16x32_bf16 v[32:35], v[224:227], v[184:187], v[32:35]
    v_mfma_f32_16x16x32_bf16 v[36:39], v[228:231], v[184:187], v[36:39]
    v_mfma_f32_16x16x32_bf16 v[40:43], v[200:203], v[188:191], v[40:43]
    v_mfma_f32_16x16x32_bf16 v[44:47], v[204:207], v[188:191], v[44:47]
    v_mfma_f32_16x16x32_bf16 v[48:51], v[208:211], v[188:191], v[48:51]
    v_mfma_f32_16x16x32_bf16 v[52:55], v[212:215], v[188:191], v[52:55]
    v_mfma_f32_16x16x32_bf16 v[56:59], v[216:219], v[188:191], v[56:59]
    v_mfma_f32_16x16x32_bf16 v[60:63], v[220:223], v[188:191], v[60:63]
    v_mfma_f32_16x16x32_bf16 v[64:67], v[224:227], v[188:191], v[64:67]
    v_mfma_f32_16x16x32_bf16 v[68:71], v[228:231], v[188:191], v[68:71]
    v_mfma_f32_16x16x32_bf16 v[72:75], v[200:203], v[192:195], v[72:75]
    v_mfma_f32_16x16x32_bf16 v[76:79], v[204:207], v[192:195], v[76:79]
    v_mfma_f32_16x16x32_bf16 v[80:83], v[208:211], v[192:195], v[80:83]
    v_mfma_f32_16x16x32_bf16 v[84:87], v[212:215], v[192:195], v[84:87]
    v_mfma_f32_16x16x32_bf16 v[88:91], v[216:219], v[192:195], v[88:91]
    v_mfma_f32_16x16x32_bf16 v[92:95], v[220:223], v[192:195], v[92:95]
    v_mfma_f32_16x16x32_bf16 v[96:99], v[224:227], v[192:195], v[96:99]
    v_mfma_f32_16x16x32_bf16 v[100:103], v[228:231], v[192:195], v[100:103]
    v_mfma_f32_16x16x32_bf16 v[104:107], v[200:203], v[196:199], v[104:107]
    v_mfma_f32_16x16x32_bf16 v[108:111], v[204:207], v[196:199], v[108:111]
    v_mfma_f32_16x16x32_bf16 v[112:115], v[208:211], v[196:199], v[112:115]
    v_mfma_f32_16x16x32_bf16 v[116:119], v[212:215], v[196:199], v[116:119]
    v_mfma_f32_16x16x32_bf16 v[120:123], v[216:219], v[196:199], v[120:123]
    v_mfma_f32_16x16x32_bf16 v[124:127], v[220:223], v[196:199], v[124:127]
    v_mfma_f32_16x16x32_bf16 v[128:131], v[224:227], v[196:199], v[128:131]
    v_mfma_f32_16x16x32_bf16 v[132:135], v[228:231], v[196:199], v[132:135]
M_Qjoin:
    s_setprio 0
    s_lshl_b32 s60, s44, 12
    s_add_u32 s61, s60, 163840
    s_add_u32 s53, s60, 65536
    s_add_u32 s66, s50, s51
    s_and_b32 s66, s66, 3
    s_mov_b32 s58, 0xba897645
    s_mov_b32 s59, 0xfecd
    s_cmp_eq_u32 s66, 1
    s_cselect_b32 s58, 0xb9a87564, s58
    s_cselect_b32 s59, 0xfdec, s59
    s_cmp_eq_u32 s66, 2
    s_cselect_b32 s58, 0xab986754, s58
    s_cselect_b32 s59, 0xefdc, s59
    s_cmp_eq_u32 s66, 3
    s_cselect_b32 s58, 0xca978653, s58
    s_cselect_b32 s59, 0xfedb, s59
    s_cmp_eq_u32 s49, 0
    s_cselect_b32 s55, 16, 0
    s_mov_b32 s32, s16
    s_mov_b32 s33, s17
    s_mov_b32 s34, 0x700000
    s_mov_b32 s35, 0x20000
    s_lshr_b32 s62, s48, 2
    s_sub_u32 s62, s48, s62
    s_add_u32 s62, s62, 16
    s_lshl_b32 s70, s62, 12
    s_lshl_b32 s64, s47, 3
    s_lshl_b32 s65, s45, 2
    s_add_u32 s64, s64, s65
    s_mul_i32 s64, s64, 114688
    s_add_u32 s64, s64, s70
    s_lshl_b32 s65, s46, 11
    s_add_u32 s64, s64, s65
    s_add_u32 s64, s64, 0x1500000
    s_or_b32 s64, s64, s69
    v_lshl_add_u32 v198, v1, 4, s64
    v_mul_f32 v24, v8, v24
    v_exp_f32 v216, -v8
    v_mul_f32 v25, v9, v25
    v_exp_f32 v217, -v9
    v_mul_f32 v26, v10, v26
    v_exp_f32 v218, -v10
    v_mul_f32 v27, v11, v27
    v_exp_f32 v219, -v11
    v_mul_f32 v28, v12, v28
    v_exp_f32 v220, -v12
    v_mul_f32 v29, v13, v29
    v_exp_f32 v221, -v13
    v_mul_f32 v30, v14, v30
    v_exp_f32 v222, -v14
    v_mul_f32 v31, v15, v31
    v_exp_f32 v223, -v15
    v_fma_f32 v216, v216, s67, s67
    v_fma_f32 v217, v217, s67, s67
    v_rcp_f32 v216, v216
    v_fma_f32 v218, v218, s67, s67
    v_rcp_f32 v217, v217
    v_fma_f32 v219, v219, s67, s67
    v_rcp_f32 v218, v218
    v_fma_f32 v220, v220, s67, s67
    v_rcp_f32 v219, v219
    v_fma_f32 v221, v221, s67, s67
    v_rcp_f32 v220, v220
    v_fma_f32 v222, v222, s67, s67
    v_rcp_f32 v221, v221
    v_fma_f32 v223, v223, s67, s67
    s_mul_i32 s62, s49, 0
    s_mul_i32 s63, s49, 4
    s_barrier
    s_and_b32 s57, s58, 15
    s_lshr_b64 s[58:59], s[58:59], 4
    s_add_u32 s57, s57, s55
    s_lshl_b32 s56, s57, 11
    s_mul_i32 s57, s57, 0x20000
    s_add_u32 m0, s53, 16384
    s_nop 0
    buffer_load_dwordx4 v248, s[32:35], s57 offen offset:0 lds
    v_rcp_f32 v222, v222
    v_rcp_f32 v223, v223
    v_mul_f32 v24, v24, v216
    v_mul_f32 v25, v25, v217
    v_mul_f32 v26, v26, v218
    v_mul_f32 v27, v27, v219
    v_mul_f32 v28, v28, v220
    v_mul_f32 v29, v29, v221
    buffer_load_dwordx4 v249, s[32:35], s57 offen offset:1024 lds
    v_mul_f32 v30, v30, v222
    v_mul_f32 v31, v31, v223
    v_cvt_pk_bf16_f32 v200, v24, v25
    v_cvt_pk_bf16_f32 v201, v26, v27
    v_cvt_pk_bf16_f32 v202, v28, v29
    v_cvt_pk_bf16_f32 v203, v30, v31
    v_mul_f32 v32, v16, v32
    buffer_load_dwordx4 v250, s[32:35], s57 offen offset:2048 lds
    v_exp_f32 v224, -v16
    v_mul_f32 v33, v17, v33
    v_exp_f32 v225, -v17
    v_mul_f32 v34, v18, v34
    v_exp_f32 v226, -v18
    v_mul_f32 v35, v19, v35
    v_exp_f32 v227, -v19
    v_mul_f32 v36, v20, v36
    buffer_load_dwordx4 v251, s[32:35], s57 offen offset:3072 lds
    v_exp_f32 v228, -v20
    v_mul_f32 v37, v21, v37
    v_exp_f32 v229, -v21
    v_mul_f32 v38, v22, v38
    v_exp_f32 v230, -v22
    v_mul_f32 v39, v23, v39
    v_exp_f32 v231, -v23
    v_fma_f32 v224, v224, s67, s67
    s_mov_b32 m0, s53
    s_nop 0
    buffer_load_dwordx4 v246, s[28:31], s56 offen offset:0 lds
    v_fma_f32 v225, v225, s67, s67
    v_rcp_f32 v224, v224
    v_fma_f32 v226, v226, s67, s67
    v_rcp_f32 v225, v225
    v_fma_f32 v227, v227, s67, s67
    v_rcp_f32 v226, v226
    v_fma_f32 v228, v228, s67, s67
    v_rcp_f32 v227, v227
    buffer_load_dwordx4 v246, s[28:31], s56 offen offset:1024 lds
    v_fma_f32 v229, v229, s67, s67
    v_rcp_f32 v228, v228
    v_fma_f32 v230, v230, s67, s67
    v_rcp_f32 v229, v229
    v_fma_f32 v231, v231, s67, s67
    v_rcp_f32 v230, v230
    v_rcp_f32 v231, v231
    v_mul_f32 v32, v32, v224
    buffer_load_dwordx4 v247, s[28:31], s56 offen offset:2048 lds
    v_mul_f32 v33, v33, v225
    v_mul_f32 v34, v34, v226
    v_mul_f32 v35, v35, v227
    v_mul_f32 v36, v36, v228
    v_mul_f32 v37, v37, v229
    v_mul_f32 v38, v38, v230
    v_mul_f32 v39, v39, v231
    v_cvt_pk_bf16_f32 v204, v32, v33
    buffer_load_dwordx4 v247, s[28:31], s56 offen offset:3072 lds
    v_cvt_pk_bf16_f32 v205, v34, v35
    v_cvt_pk_bf16_f32 v206, v36, v37
    v_cvt_pk_bf16_f32 v207, v38, v39
    v_mul_f32 v56, v40, v56
    v_exp_f32 v216, -v40
    v_mul_f32 v57, v41, v57
    s_add_u32 s53, s53, 32768
    s_cmp_ge_u32 s53, s61
    s_cselect_b32 s53, s60, s53
    buffer_store_dwordx4 v[200:203], v198, s[28:31], 0 offen offset:0 sc1
    buffer_store_dwordx4 v[204:207], v198, s[28:31], 0 offen offset:1024 sc1
    v_add_u32 v198, 114688, v198
    s_barrier
    s_and_b32 s57, s58, 15
    s_lshr_b64 s[58:59], s[58:59], 4
    s_add_u32 s57, s57, s55
    s_lshl_b32 s56, s57, 11
    s_mul_i32 s57, s57, 0x20000
    s_add_u32 m0, s53, 16384
    s_nop 0
    buffer_load_dwordx4 v248, s[32:35], s57 offen offset:0 lds
    v_exp_f32 v217, -v41
    v_mul_f32 v58, v42, v58
    v_exp_f32 v218, -v42
    v_mul_f32 v59, v43, v59
    v_exp_f32 v219, -v43
    v_mul_f32 v60, v44, v60
    v_exp_f32 v220, -v44
    v_mul_f32 v61, v45, v61
    buffer_load_dwordx4 v249, s[32:35], s57 offen offset:1024 lds
    v_exp_f32 v221, -v45
    v_mul_f32 v62, v46, v62
    v_exp_f32 v222, -v46
    v_mul_f32 v63, v47, v63
    v_exp_f32 v223, -v47
    v_fma_f32 v216, v216, s67, s67
    v_fma_f32 v217, v217, s67, s67
    v_rcp_f32 v216, v216
    buffer_load_dwordx4 v250, s[32:35], s57 offen offset:2048 lds
    v_fma_f32 v218, v218, s67, s67
    v_rcp_f32 v217, v217
    v_fma_f32 v219, v219, s67, s67
    v_rcp_f32 v218, v218
    v_fma_f32 v220, v220, s67, s67
    v_rcp_f32 v219, v219
    v_fma_f32 v221, v221, s67, s67
    v_rcp_f32 v220, v220
    buffer_load_dwordx4 v251, s[32:35], s57 offen offset:3072 lds
    v_fma_f32 v222, v222, s67, s67
    v_rcp_f32 v221, v221
    v_fma_f32 v223, v223, s67, s67
    v_rcp_f32 v222, v222
    v_rcp_f32 v223, v223
    v_mul_f32 v56, v56, v216
    v_mul_f32 v57, v57, v217
    v_mul_f32 v58, v58, v218
    s_mov_b32 m0, s53
    s_nop 0
    buffer_load_dwordx4 v246, s[28:31], s56 offen offset:0 lds
    v_mul_f32 v59, v59, v219
    v_mul_f32 v60, v60, v220
    v_mul_f32 v61, v61, v221
    v_mul_f32 v62, v62, v222
    v_mul_f32 v63, v63, v223
    v_cvt_pk_bf16_f32 v208, v56, v57
    v_cvt_pk_bf16_f32 v209, v58, v59
    v_cvt_pk_bf16_f32 v210, v60, v61
    buffer_load_dwordx4 v246, s[28:31], s56 offen offset:1024 lds
    v_cvt_pk_bf16_f32 v211, v62, v63
    v_mul_f32 v64, v48, v64
    v_exp_f32 v224, -v48
    v_mul_f32 v65, v49, v65
    v_exp_f32 v225, -v49
    v_mul_f32 v66, v50, v66
    v_exp_f32 v226, -v50
    buffer_load_dwordx4 v247, s[28:31], s56 offen offset:2048 lds
    v_mul_f32 v67, v51, v67
    v_exp_f32 v227, -v51
    v_mul_f32 v68, v52, v68
    v_exp_f32 v228, -v52
    v_mul_f32 v69, v53, v69
    v_exp_f32 v229, -v53
    v_mul_f32 v70, v54, v70
    v_exp_f32 v230, -v54
    buffer_load_dwordx4 v247, s[28:31], s56 offen offset:3072 lds
    v_mul_f32 v71, v55, v71
    v_exp_f32 v231, -v55
    v_fma_f32 v224, v224, s67, s67
    v_fma_f32 v225, v225, s67, s67
    v_rcp_f32 v224, v224
    v_fma_f32 v226, v226, s67, s67
    v_rcp_f32 v225, v225
    v_fma_f32 v227, v227, s67, s67
    s_add_u32 s53, s53, 32768
    s_cmp_ge_u32 s53, s61
    s_cselect_b32 s53, s60, s53
    buffer_store_dwordx4 v[208:211], v198, s[28:31], 0 offen offset:0 sc1
    s_barrier
    s_and_b32 s57, s58, 15
    s_lshr_b64 s[58:59], s[58:59], 4
    s_add_u32 s57, s57, s55
    s_lshl_b32 s56, s57, 11
    s_mul_i32 s57, s57, 0x20000
    s_add_u32 m0, s53, 16384
    s_nop 0
    buffer_load_dwordx4 v248, s[32:35], s57 offen offset:0 lds
    v_rcp_f32 v226, v226
    v_fma_f32 v228, v228, s67, s67
    v_rcp_f32 v227, v227
    v_fma_f32 v229, v229, s67, s67
    v_rcp_f32 v228, v228
    v_fma_f32 v230, v230, s67, s67
    v_rcp_f32 v229, v229
    v_fma_f32 v231, v231, s67, s67
    buffer_load_dwordx4 v249, s[32:35], s57 offen offset:1024 lds
    v_rcp_f32 v230, v230
    v_rcp_f32 v231, v231
    v_mul_f32 v64, v64, v224
    v_mul_f32 v65, v65, v225
    v_mul_f32 v66, v66, v226
    v_mul_f32 v67, v67, v227
    v_mul_f32 v68, v68, v228
    v_mul_f32 v69, v69, v229
    buffer_load_dwordx4 v250, s[32:35], s57 offen offset:2048 lds
    v_mul_f32 v70, v70, v230
    v_mul_f32 v71, v71, v231
    v_cvt_pk_bf16_f32 v212, v64, v65
    v_cvt_pk_bf16_f32 v213, v66, v67
    v_cvt_pk_bf16_f32 v214, v68, v69
    v_cvt_pk_bf16_f32 v215, v70, v71
    buffer_load_dwordx4 v251, s[32:35], s57 offen offset:3072 lds
    v_mul_f32 v88, v72, v88
    v_exp_f32 v216, -v72
    v_mul_f32 v89, v73, v89
    v_exp_f32 v217, -v73
    v_mul_f32 v90, v74, v90
    v_exp_f32 v218, -v74
    v_mul_f32 v91, v75, v91
    v_exp_f32 v219, -v75
    s_mov_b32 m0, s53
    s_nop 0
    buffer_load_dwordx4 v246, s[28:31], s56 offen offset:0 lds
    v_mul_f32 v92, v76, v92
    v_exp_f32 v220, -v76
    v_mul_f32 v93, v77, v93
    v_exp_f32 v221, -v77
    v_mul_f32 v94, v78, v94
    v_exp_f32 v222, -v78
    v_mul_f32 v95, v79, v95
    v_exp_f32 v223, -v79
    buffer_load_dwordx4 v246, s[28:31], s56 offen offset:1024 lds
    v_fma_f32 v216, v216, s67, s67
    v_fma_f32 v217, v217, s67, s67
    v_rcp_f32 v216, v216
    v_fma_f32 v218, v218, s67, s67
    v_rcp_f32 v217, v217
    v_fma_f32 v219, v219, s67, s67
    v_rcp_f32 v218, v218
    v_fma_f32 v220, v220, s67, s67
    buffer_load_dwordx4 v247, s[28:31], s56 offen offset:2048 lds
    v_rcp_f32 v219, v219
    v_fma_f32 v221, v221, s67, s67
    v_rcp_f32 v220, v220
    v_fma_f32 v222, v222, s67, s67
    v_rcp_f32 v221, v221
    v_fma_f32 v223, v223, s67, s67
    v_rcp_f32 v222, v222
    v_rcp_f32 v223, v223
    buffer_load_dwordx4 v247, s[28:31], s56 offen offset:3072 lds
    v_mul_f32 v88, v88, v216
    v_mul_f32 v89, v89, v217
    v_mul_f32 v90, v90, v218
    v_mul_f32 v91, v91, v219
    v_mul_f32 v92, v92, v220
    v_mul_f32 v93, v93, v221
    v_mul_f32 v94, v94, v222
    v_mul_f32 v95, v95, v223
    s_add_u32 s53, s53, 32768
    s_cmp_ge_u32 s53, s61
    s_cselect_b32 s53, s60, s53
    buffer_store_dwordx4 v[212:215], v198, s[28:31], 0 offen offset:1024 sc1
    v_add_u32 v198, 114688, v198
    s_waitcnt vmcnt(20)
    s_barrier
    s_and_b32 s57, s58, 15
    s_lshr_b64 s[58:59], s[58:59], 4
    s_add_u32 s57, s57, s55
    s_lshl_b32 s56, s57, 11
    s_mul_i32 s57, s57, 0x20000
    s_add_u32 m0, s53, 16384
    s_nop 0
    buffer_load_dwordx4 v248, s[32:35], s57 offen offset:0 lds
    v_cvt_pk_bf16_f32 v200, v88, v89
    v_cvt_pk_bf16_f32 v201, v90, v91
    v_cvt_pk_bf16_f32 v202, v92, v93
    v_cvt_pk_bf16_f32 v203, v94, v95
    v_mul_f32 v96, v80, v96
    v_exp_f32 v224, -v80
    v_mul_f32 v97, v81, v97
    buffer_load_dwordx4 v249, s[32:35], s57 offen offset:1024 lds
    v_exp_f32 v225, -v81
    v_mul_f32 v98, v82, v98
    v_exp_f32 v226, -v82
    v_mul_f32 v99, v83, v99
    v_exp_f32 v227, -v83
    v_mul_f32 v100, v84, v100
    v_exp_f32 v228, -v84
    v_mul_f32 v101, v85, v101
    buffer_load_dwordx4 v250, s[32:35], s57 offen offset:2048 lds
    v_exp_f32 v229, -v85
    v_mul_f32 v102, v86, v102
    v_exp_f32 v230, -v86
    v_mul_f32 v103, v87, v103
    v_exp_f32 v231, -v87
    v_fma_f32 v224, v224, s67, s67
    v_fma_f32 v225, v225, s67, s67
    v_rcp_f32 v224, v224
    buffer_load_dwordx4 v251, s[32:35], s57 offen offset:3072 lds
    v_fma_f32 v226, v226, s67, s67
    v_rcp_f32 v225, v225
    v_fma_f32 v227, v227, s67, s67
    v_rcp_f32 v226, v226
    v_fma_f32 v228, v228, s67, s67
    v_rcp_f32 v227, v227
    v_fma_f32 v229, v229, s67, s67
    v_rcp_f32 v228, v228
    s_mov_b32 m0, s53
    s_nop 0
    buffer_load_dwordx4 v246, s[28:31], s56 offen offset:0 lds
    v_fma_f32 v230, v230, s67, s67
    v_rcp_f32 v229, v229
    v_fma_f32 v231, v231, s67, s67
    v_rcp_f32 v230, v230
    v_rcp_f32 v231, v231
    v_mul_f32 v96, v96, v224
    v_mul_f32 v97, v97, v225
    v_mul_f32 v98, v98, v226
    buffer_load_dwordx4 v246, s[28:31], s56 offen offset:1024 lds
    v_mul_f32 v99, v99, v227
    v_mul_f32 v100, v100, v228
    v_mul_f32 v101, v101, v229
    v_mul_f32 v102, v102, v230
    v_mul_f32 v103, v103, v231
    v_cvt_pk_bf16_f32 v204, v96, v97
    v_cvt_pk_bf16_f32 v205, v98, v99
    v_cvt_pk_bf16_f32 v206, v100, v101
    buffer_load_dwordx4 v247, s[28:31], s56 offen offset:2048 lds
    v_cvt_pk_bf16_f32 v207, v102, v103
    v_mul_f32 v120, v104, v120
    v_exp_f32 v216, -v104
    v_mul_f32 v121, v105, v121
    v_exp_f32 v217, -v105
    v_mul_f32 v122, v106, v122
    buffer_load_dwordx4 v247, s[28:31], s56 offen offset:3072 lds
    v_exp_f32 v218, -v106
    v_mul_f32 v123, v107, v123
    v_exp_f32 v219, -v107
    v_mul_f32 v124, v108, v124
    v_exp_f32 v220, -v108
    v_mul_f32 v125, v109, v125
    v_exp_f32 v221, -v109
    v_mul_f32 v126, v110, v126
    s_add_u32 s53, s53, 32768
    s_cmp_ge_u32 s53, s61
    s_cselect_b32 s53, s60, s53
    buffer_store_dwordx4 v[200:203], v198, s[28:31], 0 offen offset:0 sc1
    buffer_store_dwordx4 v[204:207], v198, s[28:31], 0 offen offset:1024 sc1
    v_add_u32 v198, 114688, v198
    s_waitcnt vmcnt(20)
    s_barrier
    s_and_b32 s57, s58, 15
    s_lshr_b64 s[58:59], s[58:59], 4
    s_add_u32 s57, s57, s55
    s_lshl_b32 s56, s57, 11
    s_mul_i32 s57, s57, 0x20000
    s_add_u32 m0, s53, 16384
    s_nop 0
    buffer_load_dwordx4 v248, s[32:35], s57 offen offset:0 lds
    v_exp_f32 v222, -v110
    v_mul_f32 v127, v111, v127
    v_exp_f32 v223, -v111
    v_fma_f32 v216, v216, s67, s67
    v_fma_f32 v217, v217, s67, s67
    v_rcp_f32 v216, v216
    v_fma_f32 v218, v218, s67, s67
    v_rcp_f32 v217, v217
    buffer_load_dwordx4 v249, s[32:35], s57 offen offset:1024 lds
    v_fma_f32 v219, v219, s67, s67
    v_rcp_f32 v218, v218
    v_fma_f32 v220, v220, s67, s67
    v_rcp_f32 v219, v219
    v_fma_f32 v221, v221, s67, s67
    v_rcp_f32 v220, v220
    v_fma_f32 v222, v222, s67, s67
    v_rcp_f32 v221, v221
    buffer_load_dwordx4 v250, s[32:35], s57 offen offset:2048 lds
    v_fma_f32 v223, v223, s67, s67
    v_rcp_f32 v222, v222
    v_rcp_f32 v223, v223
    v_mul_f32 v120, v120, v216
    v_mul_f32 v121, v121, v217
    v_mul_f32 v122, v122, v218
    v_mul_f32 v123, v123, v219
    v_mul_f32 v124, v124, v220
    buffer_load_dwordx4 v251, s[32:35], s57 offen offset:3072 lds
    v_mul_f32 v125, v125, v221
    v_mul_f32 v126, v126, v222
    v_mul_f32 v127, v127, v223
    v_cvt_pk_bf16_f32 v208, v120, v121
    v_cvt_pk_bf16_f32 v209, v122, v123
    v_cvt_pk_bf16_f32 v210, v124, v125
    v_cvt_pk_bf16_f32 v211, v126, v127
    s_mov_b32 m0, s53
    s_nop 0
    buffer_load_dwordx4 v246, s[28:31], s56 offen offset:0 lds
    v_mul_f32 v128, v112, v128
    v_exp_f32 v224, -v112
    v_mul_f32 v129, v113, v129
    v_exp_f32 v225, -v113
    v_mul_f32 v130, v114, v130
    v_exp_f32 v226, -v114
    v_mul_f32 v131, v115, v131
    v_exp_f32 v227, -v115
    buffer_load_dwordx4 v246, s[28:31], s56 offen offset:1024 lds
    v_mul_f32 v132, v116, v132
    v_exp_f32 v228, -v116
    v_mul_f32 v133, v117, v133
    v_exp_f32 v229, -v117
    v_mul_f32 v134, v118, v134
    v_exp_f32 v230, -v118
    v_mul_f32 v135, v119, v135
    v_exp_f32 v231, -v119
    buffer_load_dwordx4 v247, s[28:31], s56 offen offset:2048 lds
    v_fma_f32 v224, v224, s67, s67
    v_fma_f32 v225, v225, s67, s67
    v_rcp_f32 v224, v224
    v_fma_f32 v226, v226, s67, s67
    v_rcp_f32 v225, v225
    v_fma_f32 v227, v227, s67, s67
    v_rcp_f32 v226, v226
    v_fma_f32 v228, v228, s67, s67
    buffer_load_dwordx4 v247, s[28:31], s56 offen offset:3072 lds
    v_rcp_f32 v227, v227
    v_fma_f32 v229, v229, s67, s67
    v_rcp_f32 v228, v228
    v_fma_f32 v230, v230, s67, s67
    v_rcp_f32 v229, v229
    v_fma_f32 v231, v231, s67, s67
    v_rcp_f32 v230, v230
    v_rcp_f32 v231, v231
    s_add_u32 s53, s53, 32768
    s_cmp_ge_u32 s53, s61
    s_cselect_b32 s53, s60, s53
    buffer_store_dwordx4 v[208:211], v198, s[28:31], 0 offen offset:0 sc1
    s_waitcnt vmcnt(20)
    s_barrier
    s_and_b32 s57, s58, 15
    s_lshr_b64 s[58:59], s[58:59], 4
    s_add_u32 s57, s57, s55
    s_lshl_b32 s56, s57, 11
    s_mul_i32 s57, s57, 0x20000
    s_add_u32 m0, s53, 16384
    s_nop 0
    buffer_load_dwordx4 v248, s[32:35], s57 offen offset:0 lds
    v_mul_f32 v128, v128, v224
    v_mul_f32 v129, v129, v225
    v_mul_f32 v130, v130, v226
    v_mul_f32 v131, v131, v227
    v_mul_f32 v132, v132, v228
    v_mul_f32 v133, v133, v229
    v_mul_f32 v134, v134, v230
    v_mul_f32 v135, v135, v231
    buffer_load_dwordx4 v249, s[32:35], s57 offen offset:1024 lds
    v_cvt_pk_bf16_f32 v212, v128, v129
    v_cvt_pk_bf16_f32 v213, v130, v131
    v_cvt_pk_bf16_f32 v214, v132, v133
    v_cvt_pk_bf16_f32 v215, v134, v135
    buffer_load_dwordx4 v250, s[32:35], s57 offen offset:2048 lds
    buffer_load_dwordx4 v251, s[32:35], s57 offen offset:3072 lds
    s_mov_b32 m0, s53
    s_nop 0
    buffer_load_dwordx4 v246, s[28:31], s56 offen offset:0 lds
    buffer_load_dwordx4 v246, s[28:31], s56 offen offset:1024 lds
    buffer_load_dwordx4 v247, s[28:31], s56 offen offset:2048 lds
    buffer_load_dwordx4 v247, s[28:31], s56 offen offset:3072 lds
    s_add_u32 s53, s53, 32768
    s_cmp_ge_u32 s53, s61
    s_cselect_b32 s53, s60, s53
    buffer_store_dwordx4 v[212:215], v198, s[28:31], 0 offen offset:1024 sc1
    s_waitcnt vmcnt(20)
    s_barrier
    s_and_b32 s57, s58, 15
    s_lshr_b64 s[58:59], s[58:59], 4
    s_add_u32 s57, s57, s55
    s_lshl_b32 s56, s57, 11
    s_mul_i32 s57, s57, 0x20000
    s_add_u32 m0, s53, 16384
    s_nop 0
    buffer_load_dwordx4 v248, s[32:35], s57 offen offset:0 lds
    buffer_load_dwordx4 v249, s[32:35], s57 offen offset:1024 lds
    buffer_load_dwordx4 v250, s[32:35], s57 offen offset:2048 lds
    buffer_load_dwordx4 v251, s[32:35], s57 offen offset:3072 lds
    s_mov_b32 m0, s53
    s_nop 0
    buffer_load_dwordx4 v246, s[28:31], s56 offen offset:0 lds
    buffer_load_dwordx4 v246, s[28:31], s56 offen offset:1024 lds
    buffer_load_dwordx4 v247, s[28:31], s56 offen offset:2048 lds
    buffer_load_dwordx4 v247, s[28:31], s56 offen offset:3072 lds
    s_add_u32 s53, s53, 32768
    s_cmp_ge_u32 s53, s61
    s_cselect_b32 s53, s60, s53
    s_lshl_b32 s64, s47, 8
    s_lshl_b32 s65, s48, 4
    s_add_u32 s64, s64, s65
    s_lshl_b32 s65, s44, 2
    s_add_u32 s64, s64, s65
    s_add_u32 s64, s64, 0x52000
    v_mov_b32 v2, s0
    s_waitcnt vmcnt(8)
    s_mov_b64 exec, 1
    buffer_store_dword v2, v234, s[28:31], s64 offen sc1
    s_mov_b64 exec, -1
    s_movk_i32 s54, 1
M_Q_loop4:
    s_barrier
    s_and_b32 s57, s58, 15
    s_lshr_b64 s[58:59], s[58:59], 4
    s_add_u32 s57, s57, s55
    s_lshl_b32 s56, s57, 11
    s_mul_i32 s57, s57, 0x20000
    s_add_u32 m0, s53, 16384
    s_nop 0
    buffer_load_dwordx4 v248, s[32:35], s57 offen offset:0 lds
    buffer_load_dwordx4 v249, s[32:35], s57 offen offset:1024 lds
    buffer_load_dwordx4 v250, s[32:35], s57 offen offset:2048 lds
    buffer_load_dwordx4 v251, s[32:35], s57 offen offset:3072 lds
    s_mov_b32 m0, s53
    s_nop 0
    buffer_load_dwordx4 v246, s[28:31], s56 offen offset:0 lds
    buffer_load_dwordx4 v246, s[28:31], s56 offen offset:1024 lds
    buffer_load_dwordx4 v247, s[28:31], s56 offen offset:2048 lds
    buffer_load_dwordx4 v247, s[28:31], s56 offen offset:3072 lds
    s_add_u32 s53, s53, 32768
    s_cmp_ge_u32 s53, s61
    s_cselect_b32 s53, s60, s53
    s_sub_u32 s54, s54, 1
    s_cbranch_scc0 M_Q_loop4
    s_waitcnt vmcnt(17)
    s_barrier
    s_and_b32 s57, s58, 15
    s_lshr_b64 s[58:59], s[58:59], 4
    s_add_u32 s57, s57, s55
    s_lshl_b32 s56, s57, 11
    s_mul_i32 s57, s57, 0x20000
    s_add_u32 m0, s53, 16384
    s_nop 0
    buffer_load_dwordx4 v248, s[32:35], s57 offen offset:0 lds
    buffer_load_dwordx4 v249, s[32:35], s57 offen offset:1024 lds
    buffer_load_dwordx4 v250, s[32:35], s57 offen offset:2048 lds
    buffer_load_dwordx4 v251, s[32:35], s57 offen offset:3072 lds
    s_mov_b32 m0, s53
    s_nop 0
    buffer_load_dwordx4 v246, s[28:31], s56 offen offset:0 lds
    buffer_load_dwordx4 v246, s[28:31], s56 offen offset:1024 lds
    buffer_load_dwordx4 v247, s[28:31], s56 offen offset:2048 lds
    buffer_load_dwordx4 v247, s[28:31], s56 offen offset:3072 lds
    s_add_u32 s53, s53, 32768
    s_cmp_ge_u32 s53, s61
    s_cselect_b32 s53, s60, s53
    s_waitcnt vmcnt(16)
    s_barrier
    s_and_b32 s57, s58, 15
    s_lshr_b64 s[58:59], s[58:59], 4
    s_add_u32 s57, s57, s55
    s_lshl_b32 s56, s57, 11
    s_mul_i32 s57, s57, 0x20000
    s_add_u32 m0, s53, 16384
    s_nop 0
    buffer_load_dwordx4 v248, s[32:35], s57 offen offset:0 lds
    buffer_load_dwordx4 v249, s[32:35], s57 offen offset:1024 lds
    buffer_load_dwordx4 v250, s[32:35], s57 offen offset:2048 lds
    buffer_load_dwordx4 v251, s[32:35], s57 offen offset:3072 lds
    s_mov_b32 m0, s53
    s_nop 0
    buffer_load_dwordx4 v246, s[28:31], s56 offen offset:0 lds
    buffer_load_dwordx4 v246, s[28:31], s56 offen offset:1024 lds
    buffer_load_dwordx4 v247, s[28:31], s56 offen offset:2048 lds
    buffer_load_dwordx4 v247, s[28:31], s56 offen offset:3072 lds
    s_add_u32 s53, s53, 32768
    s_cmp_ge_u32 s53, s61
    s_cselect_b32 s53, s60, s53
    s_waitcnt vmcnt(16)
    s_barrier
    s_lshl_b32 s68, s50, 8
    s_add_u32 s68, s68, 0x52000
    buffer_load_dword v245, v234, s[28:31], s68 offen sc1
    s_and_b32 s57, s58, 15
    s_lshr_b64 s[58:59], s[58:59], 4
    s_add_u32 s57, s57, s55
    s_lshl_b32 s56, s57, 11
    s_mul_i32 s57, s57, 0x20000
    s_add_u32 m0, s53, 16384
    s_nop 0
    buffer_load_dwordx4 v248, s[32:35], s57 offen offset:0 lds
    buffer_load_dwordx4 v249, s[32:35], s57 offen offset:1024 lds
    buffer_load_dwordx4 v250, s[32:35], s57 offen offset:2048 lds
    buffer_load_dwordx4 v251, s[32:35], s57 offen offset:3072 lds
    s_mov_b32 m0, s53
    s_nop 0
    buffer_load_dwordx4 v246, s[28:31], s56 offen offset:0 lds
    buffer_load_dwordx4 v246, s[28:31], s56 offen offset:1024 lds
    buffer_load_dwordx4 v247, s[28:31], s56 offen offset:2048 lds
    buffer_load_dwordx4 v247, s[28:31], s56 offen offset:3072 lds
    s_add_u32 s53, s53, 32768
    s_cmp_ge_u32 s53, s61
    s_cselect_b32 s53, s60, s53
    s_waitcnt vmcnt(17)
    s_barrier
    s_waitcnt vmcnt(8)
    s_mov_b32 s3, 0x40000
M_pb_chk:
    v_cmp_ne_u32 vcc, s0, v245
    s_nop 4
    s_cbranch_vccz M_pb_ok
    s_sub_u32 s3, s3, 1
    s_cbranch_scc1 M_pb_ok
    s_sleep 4
    s_cmp_eq_u32 s69, 0
    s_cbranch_scc1 M_pb_rl
    s_sleep 48
M_pb_rl:
    buffer_load_dword v245, v234, s[28:31], s68 offen sc1
    s_waitcnt vmcnt(0)
    s_branch M_pb_chk
M_pb_ok:
    s_add_u32 s66, s50, s51
    s_and_b32 s66, s66, 3
    s_mov_b32 s58, 0x76453201
    s_mov_b32 s59, 0xcdba89
    s_cmp_eq_u32 s66, 1
    s_cselect_b32 s58, 0x75643120, s58
    s_cselect_b32 s59, 0xdcb9a8, s59
    s_cmp_eq_u32 s66, 2
    s_cselect_b32 s58, 0x67542310, s58
    s_cselect_b32 s59, 0xdcab98, s59
    s_cmp_eq_u32 s66, 3
    s_cselect_b32 s58, 0x86534210, s58
    s_cselect_b32 s59, 0xdbca97, s59
    s_mov_b32 s56, 0x76453201
    s_mov_b32 s57, 0x89
    s_cmp_eq_u32 s66, 1
    s_cselect_b32 s56, 0x75643120, s56
    s_cselect_b32 s57, 0x98, s57
    s_cmp_eq_u32 s66, 2
    s_cselect_b32 s56, 0x67542310, s56
    s_cselect_b32 s57, 0x98, s57
    s_cmp_eq_u32 s66, 3
    s_cselect_b32 s56, 0x86534210, s56
    s_cselect_b32 s57, 0x97, s57
    s_cmp_eq_u32 s49, 0
    s_cselect_b64 s[58:59], s[56:57], s[58:59]
    s_cselect_b32 s55, 46, 32
    s_and_b32 s57, s58, 15
    s_lshr_b64 s[58:59], s[58:59], 4
    s_add_u32 s57, s57, s55
    s_lshl_b32 s56, s57, 11
    s_mul_i32 s57, s57, 0x20000
    s_add_u32 m0, s53, 16384
    s_nop 0
    buffer_load_dwordx4 v248, s[32:35], s57 offen offset:0 lds
    buffer_load_dwordx4 v249, s[32:35], s57 offen offset:1024 lds
    buffer_load_dwordx4 v250, s[32:35], s57 offen offset:2048 lds
    buffer_load_dwordx4 v251, s[32:35], s57 offen offset:3072 lds
    s_mov_b32 m0, s53
    s_nop 0
    buffer_load_dwordx4 v246, s[28:31], s56 offen offset:0 lds
    buffer_load_dwordx4 v246, s[28:31], s56 offen offset:1024 lds
    buffer_load_dwordx4 v247, s[28:31], s56 offen offset:2048 lds
    buffer_load_dwordx4 v247, s[28:31], s56 offen offset:3072 lds
    s_add_u32 s53, s53, 32768
    s_cmp_ge_u32 s53, s61
    s_cselect_b32 s53, s60, s53
    s_barrier
    s_and_b32 s57, s58, 15
    s_lshr_b64 s[58:59], s[58:59], 4
    s_add_u32 s57, s57, s55
    s_lshl_b32 s56, s57, 11
    s_mul_i32 s57, s57, 0x20000
    s_add_u32 m0, s53, 16384
    s_nop 0
    buffer_load_dwordx4 v248, s[32:35], s57 offen offset:0 lds
    buffer_load_dwordx4 v249, s[32:35], s57 offen offset:1024 lds
    buffer_load_dwordx4 v250, s[32:35], s57 offen offset:2048 lds
    buffer_load_dwordx4 v251, s[32:35], s57 offen offset:3072 lds
    s_mov_b32 m0, s53
    s_nop 0
    buffer_load_dwordx4 v246, s[28:31], s56 offen offset:0 lds
    buffer_load_dwordx4 v246, s[28:31], s56 offen offset:1024 lds
    buffer_load_dwordx4 v247, s[28:31], s56 offen offset:2048 lds
    buffer_load_dwordx4 v247, s[28:31], s56 offen offset:3072 lds
    s_add_u32 s53, s53, 32768
    s_cmp_ge_u32 s53, s61
    s_cselect_b32 s53, s60, s53
    s_add_u32 s54, s63, 7
M_Q_loop5:
    s_waitcnt vmcnt(16)
    s_barrier
    s_and_b32 s57, s58, 15
    s_lshr_b64 s[58:59], s[58:59], 4
    s_add_u32 s57, s57, s55
    s_lshl_b32 s56, s57, 11
    s_mul_i32 s57, s57, 0x20000
    s_add_u32 m0, s53, 16384
    s_nop 0
    buffer_load_dwordx4 v248, s[32:35], s57 offen offset:0 lds
    buffer_load_dwordx4 v249, s[32:35], s57 offen offset:1024 lds
    buffer_load_dwordx4 v250, s[32:35], s57 offen offset:2048 lds
    buffer_load_dwordx4 v251, s[32:35], s57 offen offset:3072 lds
    s_mov_b32 m0, s53
    s_nop 0
    buffer_load_dwordx4 v246, s[28:31], s56 offen offset:0 lds
    buffer_load_dwordx4 v246, s[28:31], s56 offen offset:1024 lds
    buffer_load_dwordx4 v247, s[28:31], s56 offen offset:2048 lds
    buffer_load_dwordx4 v247, s[28:31], s56 offen offset:3072 lds
    s_add_u32 s53, s53, 32768
    s_cmp_ge_u32 s53, s61
    s_cselect_b32 s53, s60, s53
    s_sub_u32 s54, s54, 1
    s_cbranch_scc0 M_Q_loop5
    s_waitcnt vmcnt(16)
    s_barrier
    s_waitcnt vmcnt(8)
    s_barrier
    s_waitcnt vmcnt(0)
    s_barrier
    s_branch M_fin
M_Qidle:
    s_waitcnt vmcnt(0)
    s_barrier
    v_and_b32 v2, 255, v0
    s_and_b32 s64, s2, 63
    s_lshl_b32 s64, s64, 8
    v_add_lshl_u32 v243, v2, s64, 6
    s_mov_b32 s40, s16
    s_mov_b32 s41, s17
    s_mov_b32 s42, 0x100000
    s_mov_b32 s43, 0x20000
    s_mov_b32 s64, 0x0
    buffer_load_dword v244, v243, s[40:43], s64 offen
    s_waitcnt vmcnt(0)
    s_mov_b32 s40, s16
    s_mov_b32 s41, s17
    s_mov_b32 s42, 0x200000
    s_mov_b32 s43, 0x20000
    s_mov_b32 s64, 0x100000
    buffer_load_dword v244, v243, s[40:43], s64 offen
    s_waitcnt vmcnt(0)
    s_mov_b32 s40, s16
    s_mov_b32 s41, s17
    s_mov_b32 s42, 0x300000
    s_mov_b32 s43, 0x20000
    s_mov_b32 s64, 0x200000
    buffer_load_dword v244, v243, s[40:43], s64 offen
    s_waitcnt vmcnt(0)
    s_mov_b32 s40, s16
    s_mov_b32 s41, s17
    s_mov_b32 s42, 0x400000
    s_mov_b32 s43, 0x20000
    s_mov_b32 s64, 0x300000
    buffer_load_dword v244, v243, s[40:43], s64 offen
    s_waitcnt vmcnt(0)
    s_mov_b32 s40, s16
    s_mov_b32 s41, s17
    s_mov_b32 s42, 0x500000
    s_mov_b32 s43, 0x20000
    s_mov_b32 s64, 0x400000
    buffer_load_dword v244, v243, s[40:43], s64 offen
    s_waitcnt vmcnt(0)
    s_mov_b32 s40, s16
    s_mov_b32 s41, s17
    s_mov_b32 s42, 0x600000
    s_mov_b32 s43, 0x20000
    s_mov_b32 s64, 0x500000
    buffer_load_dword v244, v243, s[40:43], s64 offen
    s_waitcnt vmcnt(0)
    s_mov_b32 s40, s16
    s_mov_b32 s41, s17
    s_mov_b32 s42, 0x700000
    s_mov_b32 s43, 0x20000
    s_mov_b32 s64, 0x600000
    buffer_load_dword v244, v243, s[40:43], s64 offen
    s_waitcnt vmcnt(0)
    s_waitcnt vmcnt(0)
    s_barrier
    s_barrier
    s_barrier
    s_branch M_Qjoin
M_fin:
M_end:
    s_endpgm

.section .rodata,"a"
.p2align 6
.amdhsa_kernel adaLN_cond__sliding_local_dilated__glu_gated_swiglu__prompt_kernel
  .amdhsa_next_free_vgpr 252
  .amdhsa_next_free_sgpr 102
  .amdhsa_accum_offset 252
  .amdhsa_group_segment_fixed_size 0
  .amdhsa_kernarg_size 96
  .amdhsa_user_sgpr_count 2
  .amdhsa_user_sgpr_kernarg_segment_ptr 1
  .amdhsa_system_sgpr_workgroup_id_x 1
  .amdhsa_float_denorm_mode_32 3
.end_amdhsa_kernel
```

```asm
; @launch grid=(256,1,1) block=(512,1,1) lds=163840
.amdgcn_target "amdgcn-amd-amdhsa--gfx950"
.text
.globl adaLN_cond__sliding_local_dilated__glu_gated_swiglu__prompt_kernel
.p2align 8
.type adaLN_cond__sliding_local_dilated__glu_gated_swiglu__prompt_kernel,@function
adaLN_cond__sliding_local_dilated__glu_gated_swiglu__prompt_kernel:
    s_cmp_ge_u32 s2, 256
    s_cbranch_scc1 M_end
    s_load_dwordx16 s[4:19], s[0:1], 0
    s_load_dwordx8 s[20:27], s[0:1], 64
    v_lshrrev_b32 v2, 6, v0
    v_and_b32 v1, 63, v0
    v_readfirstlane_b32 s44, v2
    s_and_b32 s47, s2, 1
    s_lshl_b32 s47, s47, 3
    s_bfe_u32 s64, s2, 0x30003
    s_add_u32 s47, s47, s64
    s_and_b32 s48, s2, 6
    s_lshl_b32 s48, s48, 1
    s_lshr_b32 s64, s2, 6
    s_add_u32 s48, s48, s64
    s_getpc_b64 s[28:29]
M_pc:
    s_lshr_b32 s64, s2, 3
    s_lshl_b32 s64, s64, 3
    s_add_u32 s64, s64, s44
    s_lshl_b32 s64, s64, 8
    v_lshl_add_u32 v2, v1, 7, s64
    v_min_u32 v2, M_end-M_pc, v2
    s_mov_b64 exec, 3
    global_load_dword v244, v2, s[28:29]
    s_mov_b64 exec, -1
    s_cmp_ge_u32 s44, 4
    s_cbranch_scc1 M_Q
    s_lshr_b32 s70, s47, 1
    s_lshl_b32 s70, s70, 7
    s_and_b32 s71, s47, 1
    s_lshl_b32 s71, s71, 4
    s_add_u32 s71, s71, s48
    s_lshl_b32 s71, s71, 7
    v_lshrrev_b32 v48, 3, v0
    v_add_u32 v48, s70, v48
    v_lshlrev_b32 v9, 1, v48
    s_movk_i32 s64, 12288
    v_mul_lo_u32 v48, s64, v48
    v_and_b32 v8, 7, v0
    v_lshl_add_u32 v48, v8, 4, v48
    v_add_u32 v8, s71, v48
    s_waitcnt lgkmcnt(0)
    s_load_dword s0, s[26:27], 0
    s_mov_b32 s40, s18
    s_mov_b32 s41, s19
    s_mov_b32 s42, 0x800
    s_mov_b32 s43, 0x20000
    s_mov_b32 s36, s20
    s_mov_b32 s37, s21
    s_mov_b32 s38, 0xc00000
    s_mov_b32 s39, 0x20000
    s_barrier
    buffer_load_ushort v20, v9, s[40:43], 0 offen offset:0
    buffer_load_ushort v21, v9, s[40:43], 0 offen offset:64
    buffer_load_ushort v22, v9, s[40:43], 0 offen offset:128
    buffer_load_ushort v23, v9, s[40:43], 0 offen offset:192
    s_mov_b32 s64, 0x0
    buffer_load_dwordx4 v[24:27], v8, s[36:39], s64 offen
    s_mov_b32 s64, 0x60000
    buffer_load_dwordx4 v[28:31], v8, s[36:39], s64 offen
    s_mov_b32 s64, 0xc0000
    buffer_load_dwordx4 v[32:35], v8, s[36:39], s64 offen
    s_mov_b32 s64, 0x120000
    buffer_load_dwordx4 v[36:39], v8, s[36:39], s64 offen
    s_mov_b32 s28, s26
    s_mov_b32 s29, s27
    s_mov_b32 s30, 0x3000000
    s_mov_b32 s31, 0x20000
    s_lshl_b32 s64, s48, 13
    s_add_u32 s64, s64, 0x20000
    s_lshl_b32 s65, s47, 9
    s_add_u32 s62, s64, s65
    s_lshl_b32 s65, s44, 9
    s_add_u32 s64, s64, s65
    v_lshl_add_u32 v16, v1, 3, s64
    s_lshr_b32 s45, s44, 1
    s_and_b32 s46, s44, 1
    s_bfe_u32 s49, s2, 0x10003
    s_and_b32 s50, s2, 3
    s_lshl_b32 s50, s50, 2
    s_bfe_u32 s64, s2, 0x20004
    s_add_u32 s50, s50, s64
    s_and_b32 s51, s2, 4
    s_lshr_b32 s64, s2, 6
    s_add_u32 s51, s51, s64
    s_cmp_ge_u32 s2, 192
    s_cselect_b32 s69, 0x80000000, 0
    s_mov_b32 s67, 0x40053526
    v_lshlrev_b32 v234, 2, v1
    s_mov_b32 s52, 0
    s_lshl_b32 s64, s45, 13
    v_lshl_add_u32 v233, v1, 4, s64
    v_lshrrev_b32 v3, 4, v1
    v_bfe_u32 v2, v1, 2, 2
    v_lshl_add_u32 v4, v3, 3, v2
    v_mul_u32_u24 v4, 384, v4
    v_and_b32 v5, 3, v1
    v_lshl_add_u32 v4, v5, 3, v4
    v_add_u32 v4, 18432, v4
    v_bfe_u32 v2, v1, 3, 2
    s_lshl_b32 s64, s46, 1
    v_xor_b32 v2, s64, v2
    v_lshl_add_u32 v239, v2, 5, v4
    v_xor_b32 v2, 1, v2
    v_lshl_add_u32 v240, v2, 5, v4
    v_and_b32 v2, 15, v1
    v_lshlrev_b32 v3, 2, v3
    v_sub_u32 v3, v2, v3
    s_mov_b32 s64, 0x80000001
    v_sub_u32 v4, -2, v3
    v_and_b32 v4, s64, v4
    v_cmp_eq_u32 s[72:73], 0, v4
    v_subrev_u32 v4, 0, v3
    v_and_b32 v4, s64, v4
    v_cmp_eq_u32 s[80:81], 0, v4
    v_sub_u32 v4, -1, v3
    v_and_b32 v4, s64, v4
    v_cmp_eq_u32 s[74:75], 0, v4
    v_subrev_u32 v4, 1, v3
    v_and_b32 v4, s64, v4
    v_cmp_eq_u32 s[82:83], 0, v4
    v_sub_u32 v4, 0, v3
    v_and_b32 v4, s64, v4
    v_cmp_eq_u32 s[76:77], 0, v4
    v_subrev_u32 v4, 2, v3
    v_and_b32 v4, s64, v4
    v_cmp_eq_u32 s[84:85], 0, v4
    v_sub_u32 v4, 1, v3
    v_and_b32 v4, s64, v4
    v_cmp_eq_u32 s[78:79], 0, v4
    v_subrev_u32 v4, 3, v3
    v_and_b32 v4, s64, v4
    v_cmp_eq_u32 s[86:87], 0, v4
    s_lshl_b32 s64, s47, 1
    s_add_u32 s64, s64, s45
    s_cmp_eq_u32 s64, 0
    s_cselect_b64 s[88:89], 0, s[72:73]
    s_cselect_b64 s[90:91], 0, s[74:75]
    s_cselect_b64 s[92:93], 0, s[76:77]
    s_cselect_b64 s[94:95], 0, s[78:79]
    s_mul_i32 s64, s64, 131072
    s_lshl_b32 s65, s48, 11
    s_add_u32 s64, s64, s65
    s_lshl_b32 s65, s46, 10
    s_add_u32 s64, s64, s65
    s_add_u32 s64, s64, 0x600000
    v_lshl_add_u32 v237, v1, 4, s64
    s_lshl_b32 s64, s2, 8
    v_add_lshl_u32 v243, v0, s64, 5
    s_lshl_b32 s64, s47, 3
    s_lshl_b32 s65, s44, 1
    s_add_u32 s64, s64, s65
    s_mul_i32 s64, s64, 32768
    s_add_u32 s64, s64, 0x600000
    v_lshl_add_u32 v208, v1, 4, s64
    v_add_u32 v209, 30720, v208
    v_lshrrev_b32 v3, 3, v1
    s_lshl_b32 s64, s44, 4
    v_add_lshl_u32 v2, v3, s64, 11
    s_lshl_b32 s64, s48, 7
    v_add_u32 v2, s64, v2
    v_and_b32 v3, 6, v3
    v_and_b32 v4, 7, v1
    v_xor_b32 v3, v3, v4
    v_lshl_add_u32 v210, v3, 4, v2
    v_add_u32 v211, 15360, v210
    s_lshl_b32 s65, s48, 8
    v_lshrrev_b32 v3, 4, v1
    s_lshl_b32 s64, s44, 4
    v_add_u32 v2, s64, v3
    s_movk_i32 s64, 7168
    v_mul_u32_u24 v2, s64, v2
    v_add_u32 v2, s65, v2
    v_lshlrev_b32 v3, 1, v3
    v_and_b32 v4, 15, v1
    v_xor_b32 v3, v3, v4
    v_lshl_add_u32 v212, v3, 4, v2
    v_add_u32 v214, 55296, v212
    v_xor_b32 v3, 8, v3
    v_lshl_add_u32 v213, v3, 4, v2
    v_add_u32 v213, 27648, v213
    v_add_u32 v215, 55296, v213
    v_add_u32 v232, s52, v233
    v_add_u32 v235, s52, v239
    v_add_u32 v236, s52, v240
    s_lshl_b32 s60, s44, 12
    s_add_u32 s61, s60, 147456
    s_add_u32 s53, s60, 49152
    s_lshl_b32 s70, s44, 11
    s_sub_u32 s70, 16384, s70
    s_bfe_u32 s66, s2, 0x30003
    s_lshr_b32 s55, s2, 6
    s_add_u32 s66, s66, s55
    s_and_b32 s66, s66, 3
    s_mov_b32 s58, 0x76453210
    s_mov_b32 s59, 0xfecdba89
    s_cmp_eq_u32 s66, 1
    s_cselect_b32 s58, 0x75643120, s58
    s_cselect_b32 s59, 0xfdecb9a8, s59
    s_cmp_eq_u32 s66, 2
    s_cselect_b32 s58, 0x67542310, s58
    s_cselect_b32 s59, 0xefdcab98, s59
    s_cmp_eq_u32 s66, 3
    s_cselect_b32 s58, 0x86534210, s58
    s_cselect_b32 s59, 0xfedbca97, s59
    s_mov_b32 s32, s8
    s_mov_b32 s33, s9
    s_mov_b32 s34, 0x200000
    s_mov_b32 s35, 0x20000
    s_waitcnt lgkmcnt(0)
    s_add_u32 s0, s0, 1
    s_setprio 2
    s_barrier
    s_waitcnt vmcnt(4)
    v_lshlrev_b32 v20, 16, v20
    v_lshlrev_b32 v21, 16, v21
    v_lshlrev_b32 v22, 16, v22
    v_lshlrev_b32 v23, 16, v23
    v_mul_f32 v48, 0xbfb8aa3b, v20
    v_mul_f32 v49, 0xbfb8aa3b, v21
    v_mul_f32 v50, 0xbfb8aa3b, v22
    v_mul_f32 v51, 0xbfb8aa3b, v23
    v_exp_f32 v48, v48
    v_exp_f32 v49, v49
    v_exp_f32 v50, v50
    v_exp_f32 v51, v51
    v_add_f32 v48, 1.0, v48
    v_add_f32 v49, 1.0, v49
    v_add_f32 v50, 1.0, v50
    v_add_f32 v51, 1.0, v51
    v_rcp_f32 v48, v48
    v_rcp_f32 v49, v49
    v_rcp_f32 v50, v50
    v_rcp_f32 v51, v51
    v_mul_f32 v20, v20, v48
    v_mul_f32 v21, v21, v49
    v_mul_f32 v22, v22, v50
    v_mul_f32 v23, v23, v51
    v_cvt_pk_bf16_f32 v48, v20, v20
    v_lshlrev_b32 v20, 16, v48
    v_cvt_pk_bf16_f32 v49, v21, v21
    v_lshlrev_b32 v21, 16, v49
    v_cvt_pk_bf16_f32 v50, v22, v22
    v_lshlrev_b32 v22, 16, v50
    v_cvt_pk_bf16_f32 v51, v23, v23
    v_lshlrev_b32 v23, 16, v51
    s_waitcnt vmcnt(3)
    v_lshlrev_b32 v48, 16, v24
    v_and_b32 v49, 0xffff0000, v24
    v_lshlrev_b32 v50, 16, v25
    v_and_b32 v51, 0xffff0000, v25
    v_lshlrev_b32 v52, 16, v26
    v_and_b32 v53, 0xffff0000, v26
    v_lshlrev_b32 v54, 16, v27
    v_and_b32 v55, 0xffff0000, v27
    v_mul_f32 v40, v20, v48
    v_mul_f32 v41, v20, v49
    v_mul_f32 v42, v20, v50
    v_mul_f32 v43, v20, v51
    v_mul_f32 v44, v20, v52
    v_mul_f32 v45, v20, v53
    v_mul_f32 v46, v20, v54
    v_mul_f32 v47, v20, v55
    s_waitcnt vmcnt(2)
    v_lshlrev_b32 v48, 16, v28
    v_and_b32 v49, 0xffff0000, v28
    v_lshlrev_b32 v50, 16, v29
    v_and_b32 v51, 0xffff0000, v29
    v_lshlrev_b32 v52, 16, v30
    v_and_b32 v53, 0xffff0000, v30
    v_lshlrev_b32 v54, 16, v31
    v_and_b32 v55, 0xffff0000, v31
    v_fmac_f32 v40, v21, v48
    v_fmac_f32 v41, v21, v49
    v_fmac_f32 v42, v21, v50
    v_fmac_f32 v43, v21, v51
    v_fmac_f32 v44, v21, v52
    v_fmac_f32 v45, v21, v53
    v_fmac_f32 v46, v21, v54
    v_fmac_f32 v47, v21, v55
    s_waitcnt vmcnt(1)
    v_lshlrev_b32 v48, 16, v32
    v_and_b32 v49, 0xffff0000, v32
    v_lshlrev_b32 v50, 16, v33
    v_and_b32 v51, 0xffff0000, v33
    v_lshlrev_b32 v52, 16, v34
    v_and_b32 v53, 0xffff0000, v34
    v_lshlrev_b32 v54, 16, v35
    v_and_b32 v55, 0xffff0000, v35
    v_fmac_f32 v40, v22, v48
    v_fmac_f32 v41, v22, v49
    v_fmac_f32 v42, v22, v50
    v_fmac_f32 v43, v22, v51
    v_fmac_f32 v44, v22, v52
    v_fmac_f32 v45, v22, v53
    v_fmac_f32 v46, v22, v54
    v_fmac_f32 v47, v22, v55
    s_waitcnt vmcnt(0)
    v_lshlrev_b32 v48, 16, v36
    v_and_b32 v49, 0xffff0000, v36
    v_lshlrev_b32 v50, 16, v37
    v_and_b32 v51, 0xffff0000, v37
    v_lshlrev_b32 v52, 16, v38
    v_and_b32 v53, 0xffff0000, v38
    v_lshlrev_b32 v54, 16, v39
    v_and_b32 v55, 0xffff0000, v39
    v_fmac_f32 v40, v23, v48
    v_fmac_f32 v41, v23, v49
    v_fmac_f32 v42, v23, v50
    v_fmac_f32 v43, v23, v51
    v_fmac_f32 v44, v23, v52
    v_fmac_f32 v45, v23, v53
    v_fmac_f32 v46, v23, v54
    v_fmac_f32 v47, v23, v55
    v_add_f32_dpp v40, v40, v40 row_ror:8 row_mask:0xf bank_mask:0xf
    v_add_f32_dpp v41, v41, v41 row_ror:8 row_mask:0xf bank_mask:0xf
    v_add_f32_dpp v42, v42, v42 row_ror:8 row_mask:0xf bank_mask:0xf
    v_add_f32_dpp v43, v43, v43 row_ror:8 row_mask:0xf bank_mask:0xf
    v_add_f32_dpp v44, v44, v44 row_ror:8 row_mask:0xf bank_mask:0xf
    v_add_f32_dpp v45, v45, v45 row_ror:8 row_mask:0xf bank_mask:0xf
    v_add_f32_dpp v46, v46, v46 row_ror:8 row_mask:0xf bank_mask:0xf
    v_add_f32_dpp v47, v47, v47 row_ror:8 row_mask:0xf bank_mask:0xf
    v_mov_b32 v48, v40
    v_mov_b32 v49, v41
    v_mov_b32 v50, v42
    v_mov_b32 v51, v43
    v_mov_b32 v52, v44
    v_mov_b32 v53, v45
    v_mov_b32 v54, v46
    v_mov_b32 v55, v47
    v_permlane32_swap_b32 v40, v48
    v_permlane32_swap_b32 v41, v49
    v_permlane32_swap_b32 v42, v50
    v_permlane32_swap_b32 v43, v51
    v_permlane32_swap_b32 v44, v52
    v_permlane32_swap_b32 v45, v53
    v_permlane32_swap_b32 v46, v54
    v_permlane32_swap_b32 v47, v55
    v_add_f32 v40, v40, v48
    v_add_f32 v41, v41, v49
    v_add_f32 v42, v42, v50
    v_add_f32 v43, v43, v51
    v_add_f32 v44, v44, v52
    v_add_f32 v45, v45, v53
    v_add_f32 v46, v46, v54
    v_add_f32 v47, v47, v55
    v_mov_b32 v48, v40
    v_mov_b32 v49, v41
    v_mov_b32 v50, v42
    v_mov_b32 v51, v43
    v_mov_b32 v52, v44
    v_mov_b32 v53, v45
    v_mov_b32 v54, v46
    v_mov_b32 v55, v47
    v_permlane16_swap_b32 v40, v48
    v_permlane16_swap_b32 v41, v49
    v_permlane16_swap_b32 v42, v50
    v_permlane16_swap_b32 v43, v51
    v_permlane16_swap_b32 v44, v52
    v_permlane16_swap_b32 v45, v53
    v_permlane16_swap_b32 v46, v54
    v_permlane16_swap_b32 v47, v55
    v_add_f32 v40, v40, v48
    v_add_f32 v41, v41, v49
    v_add_f32 v42, v42, v50
    v_add_f32 v43, v43, v51
    v_add_f32 v44, v44, v52
    v_add_f32 v45, v45, v53
    v_add_f32 v46, v46, v54
    v_add_f32 v47, v47, v55
    s_lshl_b32 s64, s44, 8
    s_add_u32 s64, s64, 147456
    v_and_b32 v48, 7, v0
    v_lshl_add_u32 v48, v48, 5, s64
    ds_write_b128 v48, v[40:43]
    ds_write_b128 v48, v[44:47] offset:16
    v_mov_b32 v49, 148492
    v_mov_b32 v50, 1
    s_waitcnt lgkmcnt(0)
    s_mov_b64 exec, 1
    ds_add_rtn_u32 v51, v49, v50
    s_mov_b64 exec, -1
    v_add_u32 v49, 147456, v234
    s_waitcnt lgkmcnt(0)
    ds_read_b32 v40, v49 offset:0
    ds_read_b32 v41, v49 offset:256
    ds_read_b32 v42, v49 offset:512
    ds_read_b32 v43, v49 offset:768
    v_readfirstlane_b32 s64, v51
    s_nop 3
    s_cmp_eq_u32 s64, 3
    s_cselect_b32 s62, s62, 0x80000000
    v_lshl_add_u32 v48, v1, 3, s62
    s_waitcnt lgkmcnt(0)
    v_add_f32 v40, v40, v41
    v_add_f32 v42, v42, v43
    v_add_f32 v40, v40, v42
    v_mov_b32 v41, s0
    buffer_store_dwordx2 v[40:41], v48, s[28:31], 0 offen sc1
    s_cmp_ge_u32 s44, 2
    s_cbranch_scc1 M_spf
    s_movk_i32 s63, 4096
    buffer_load_dwordx2 v[88:89], v16, s[28:31], 0 offen offset:0 sc1
    buffer_load_dwordx2 v[90:91], v16, s[28:31], 0 offen offset:1024 sc1
    buffer_load_dwordx2 v[92:93], v16, s[28:31], 0 offen offset:2048 sc1
    buffer_load_dwordx2 v[94:95], v16, s[28:31], 0 offen offset:3072 sc1
    buffer_load_dwordx2 v[96:97], v16, s[28:31], s63 offen offset:0 sc1
    buffer_load_dwordx2 v[98:99], v16, s[28:31], s63 offen offset:1024 sc1
    buffer_load_dwordx2 v[100:101], v16, s[28:31], s63 offen offset:2048 sc1
    buffer_load_dwordx2 v[102:103], v16, s[28:31], s63 offen offset:3072 sc1
    s_waitcnt vmcnt(0)
    s_mov_b32 s3, 0x4000
M_pt_chk:
    v_xor_b32 v48, s0, v89
    v_xor_b32 v49, s0, v91
    v_xor_b32 v50, s0, v93
    v_xor_b32 v51, s0, v95
    v_xor_b32 v52, s0, v97
    v_xor_b32 v53, s0, v99
    v_xor_b32 v54, s0, v101
    v_xor_b32 v55, s0, v103
    v_or3_b32 v48, v48, v49, v50
    v_or3_b32 v48, v48, v51, v52
    v_or3_b32 v48, v48, v53, v54
    v_or_b32 v48, v48, v55
    v_cmp_ne_u32 vcc, 0, v48
    s_nop 4
    s_cbranch_vccz M_pt_ok
    s_sub_u32 s3, s3, 1
    s_cbranch_scc1 M_pt_ok
    v_cmp_ne_u32 vcc, s0, v89
    s_nop 4
    s_mov_b64 exec, vcc
    buffer_load_dwordx2 v[88:89], v16, s[28:31], 0 offen offset:0 sc1
    s_mov_b64 exec, -1
    v_cmp_ne_u32 vcc, s0, v91
    s_nop 4
    s_mov_b64 exec, vcc
    buffer_load_dwordx2 v[90:91], v16, s[28:31], 0 offen offset:1024 sc1
    s_mov_b64 exec, -1
    v_cmp_ne_u32 vcc, s0, v93
    s_nop 4
    s_mov_b64 exec, vcc
    buffer_load_dwordx2 v[92:93], v16, s[28:31], 0 offen offset:2048 sc1
    s_mov_b64 exec, -1
    v_cmp_ne_u32 vcc, s0, v95
    s_nop 4
    s_mov_b64 exec, vcc
    buffer_load_dwordx2 v[94:95], v16, s[28:31], 0 offen offset:3072 sc1
    s_mov_b64 exec, -1
    v_cmp_ne_u32 vcc, s0, v97
    s_nop 4
    s_mov_b64 exec, vcc
    buffer_load_dwordx2 v[96:97], v16, s[28:31], s63 offen offset:0 sc1
    s_mov_b64 exec, -1
    v_cmp_ne_u32 vcc, s0, v99
    s_nop 4
    s_mov_b64 exec, vcc
    buffer_load_dwordx2 v[98:99], v16, s[28:31], s63 offen offset:1024 sc1
    s_mov_b64 exec, -1
    v_cmp_ne_u32 vcc, s0, v101
    s_nop 4
    s_mov_b64 exec, vcc
    buffer_load_dwordx2 v[100:101], v16, s[28:31], s63 offen offset:2048 sc1
    s_mov_b64 exec, -1
    v_cmp_ne_u32 vcc, s0, v103
    s_nop 4
    s_mov_b64 exec, vcc
    buffer_load_dwordx2 v[102:103], v16, s[28:31], s63 offen offset:3072 sc1
    s_mov_b64 exec, -1
    s_waitcnt vmcnt(0)
    s_branch M_pt_chk
M_pt_ok:
    v_add_f32 v88, v88, v90
    v_add_f32 v92, v92, v94
    v_add_f32 v96, v96, v98
    v_add_f32 v100, v100, v102
    v_add_f32 v88, v88, v92
    v_add_f32 v96, v96, v100
    v_add_f32 v88, v88, v96
    v_cvt_pk_bf16_f32 v89, v88, v88
    v_lshlrev_b32 v88, 16, v89
    s_cmp_eq_u32 s44, 1
    s_cselect_b32 s64, 1.0, 0
    v_add_f32 v88, s64, v88
    v_cvt_pk_bf16_f32 v89, v88, v88
    v_lshlrev_b32 v88, 16, v89
    s_lshl_b32 s64, s44, 8
    s_add_u32 s64, s64, 149504
    v_add_u32 v2, s64, v234
    ds_write_b32 v2, v88
    s_waitcnt lgkmcnt(0)
    s_branch M_tbl
M_spf:
    s_lshl_b32 s64, s2, 1
    s_add_u32 s64, s64, s46
    s_mul_i32 s65, s64, 12288
    s_add_u32 s56, s6, s65
    s_addc_u32 s57, s7, 0
    s_load_dword s99, s[56:57], 384
    s_load_dword s99, s[56:57], 448
    s_load_dword s99, s[56:57], 1408
    s_load_dword s99, s[56:57], 1472
    s_load_dword s99, s[56:57], 2432
    s_load_dword s99, s[56:57], 2496
    s_load_dword s99, s[56:57], 3456
    s_load_dword s99, s[56:57], 3520
    s_load_dword s99, s[56:57], 4480
    s_load_dword s99, s[56:57], 4544
    s_load_dword s99, s[56:57], 5504
    s_load_dword s99, s[56:57], 5568
    s_load_dword s99, s[56:57], 6528
    s_load_dword s99, s[56:57], 6592
    s_load_dword s99, s[56:57], 7552
    s_load_dword s99, s[56:57], 7616
    s_load_dword s99, s[56:57], 8576
    s_load_dword s99, s[56:57], 8640
    s_load_dword s99, s[56:57], 9600
    s_load_dword s99, s[56:57], 9664
    s_load_dword s99, s[56:57], 10624
    s_load_dword s99, s[56:57], 10688
    s_load_dword s99, s[56:57], 11648
    s_load_dword s99, s[56:57], 11712
M_tbl:
    s_barrier
    s_or_b32 s64, s2, s44
    s_cmp_eq_u32 s64, 0
    s_cselect_b32 s64, 0, 0x80000000
    v_mov_b32 v2, s64
    v_mov_b32 v3, s0
    s_barrier
    ds_read_b128 v[120:123], v232 offset:0
    ds_read_b64_tr_b16 v[148:149], v235 offset:128
    ds_read_b64_tr_b16 v[150:151], v235 offset:1664
    ds_read_b64_tr_b16 v[152:153], v236 offset:128
    ds_read_b64_tr_b16 v[154:155], v236 offset:1664
    ds_read_b64_tr_b16 v[156:157], v235 offset:256
    ds_read_b64_tr_b16 v[158:159], v235 offset:1792
    ds_read_b64_tr_b16 v[160:161], v236 offset:256
    ds_read_b64_tr_b16 v[162:163], v236 offset:1792
    ds_read_b128 v[124:127], v232 offset:2048
    ds_read_b64_tr_b16 v[140:141], v235 offset:0
    ds_read_b64_tr_b16 v[142:143], v235 offset:1536
    ds_read_b64_tr_b16 v[144:145], v236 offset:0
    ds_read_b64_tr_b16 v[146:147], v236 offset:1536
    ds_read_b128 v[128:131], v232 offset:4096
    ds_read_b128 v[132:135], v232 offset:6144
    ds_read_b128 v[136:139], v232 offset:8192
    s_add_u32 s52, s52, 49152
    s_cmp_ge_u32 s52, 147456
    s_cselect_b32 s52, 0, s52
    s_waitcnt lgkmcnt(0)
    v_mfma_f32_16x16x32_bf16 v[40:43], v[148:151], v[120:123], 0
    ds_read_b128 v[164:167], v232 offset:1024
    v_mfma_f32_16x16x32_bf16 v[44:47], v[152:155], v[120:123], 0
    ds_read_b64_tr_b16 v[192:193], v235 offset:12416
    v_mfma_f32_16x16x32_bf16 v[80:83], v[120:123], v[156:159], 0
    ds_read_b64_tr_b16 v[194:195], v235 offset:13952
    v_mfma_f32_16x16x32_bf16 v[84:87], v[120:123], v[160:163], 0
    ds_read_b64_tr_b16 v[196:197], v236 offset:12416
    v_mfma_f32_16x16x32_bf16 v[48:51], v[148:151], v[124:127], 0
    ds_read_b64_tr_b16 v[198:199], v236 offset:13952
    v_mfma_f32_16x16x32_bf16 v[52:55], v[152:155], v[124:127], 0
    v_mfma_f32_16x16x32_bf16 v[88:91], v[124:127], v[156:159], 0
    ds_read_b64_tr_b16 v[200:201], v235 offset:12544
    v_mfma_f32_16x16x32_bf16 v[92:95], v[124:127], v[160:163], 0
    ds_read_b64_tr_b16 v[202:203], v235 offset:14080
    v_mfma_f32_16x16x32_bf16 v[8:11], v[140:143], v[124:127], 0
    ds_read_b64_tr_b16 v[204:205], v236 offset:12544
    v_mfma_f32_16x16x32_bf16 v[12:15], v[144:147], v[124:127], 0
    ds_read_b64_tr_b16 v[206:207], v236 offset:14080
    v_mfma_f32_16x16x32_bf16 v[56:59], v[148:151], v[128:131], 0
    v_mfma_f32_16x16x32_bf16 v[60:63], v[152:155], v[128:131], 0
    ds_read_b128 v[168:171], v232 offset:3072
    v_mfma_f32_16x16x32_bf16 v[96:99], v[128:131], v[156:159], 0
    ds_read_b64_tr_b16 v[184:185], v235 offset:12288
    v_mfma_f32_16x16x32_bf16 v[100:103], v[128:131], v[160:163], 0
    ds_read_b64_tr_b16 v[186:187], v235 offset:13824
    v_mfma_f32_16x16x32_bf16 v[16:19], v[140:143], v[128:131], 0
    ds_read_b64_tr_b16 v[188:189], v236 offset:12288
    v_mfma_f32_16x16x32_bf16 v[20:23], v[144:147], v[128:131], 0
    v_mfma_f32_16x16x32_bf16 v[64:67], v[148:151], v[132:135], 0
    ds_read_b64_tr_b16 v[190:191], v236 offset:13824
    v_mfma_f32_16x16x32_bf16 v[68:71], v[152:155], v[132:135], 0
    ds_read_b128 v[172:175], v232 offset:5120
    v_mfma_f32_16x16x32_bf16 v[104:107], v[132:135], v[156:159], 0
    ds_read_b128 v[176:179], v232 offset:7168
    v_mfma_f32_16x16x32_bf16 v[108:111], v[132:135], v[160:163], 0
    ds_read_b128 v[180:183], v232 offset:9216
    v_mfma_f32_16x16x32_bf16 v[24:27], v[140:143], v[132:135], 0
    v_mfma_f32_16x16x32_bf16 v[28:31], v[144:147], v[132:135], 0
    v_add_u32 v232, s52, v233
    v_mfma_f32_16x16x32_bf16 v[72:75], v[148:151], v[136:139], 0
    v_mfma_f32_16x16x32_bf16 v[76:79], v[152:155], v[136:139], 0
    v_add_u32 v235, s52, v239
    v_mfma_f32_16x16x32_bf16 v[112:115], v[136:139], v[156:159], 0
    v_mfma_f32_16x16x32_bf16 v[116:119], v[136:139], v[160:163], 0
    v_add_u32 v236, s52, v240
    v_mfma_f32_16x16x32_bf16 v[32:35], v[140:143], v[136:139], 0
    v_mfma_f32_16x16x32_bf16 v[36:39], v[144:147], v[136:139], 0
    s_waitcnt lgkmcnt(0)
    v_mfma_f32_16x16x32_bf16 v[40:43], v[192:195], v[164:167], v[40:43]
    v_mfma_f32_16x16x32_bf16 v[44:47], v[196:199], v[164:167], v[44:47]
    v_mfma_f32_16x16x32_bf16 v[80:83], v[164:167], v[200:203], v[80:83]
    v_mfma_f32_16x16x32_bf16 v[84:87], v[164:167], v[204:207], v[84:87]
    v_mfma_f32_16x16x32_bf16 v[48:51], v[192:195], v[168:171], v[48:51]
    v_mfma_f32_16x16x32_bf16 v[52:55], v[196:199], v[168:171], v[52:55]
    v_mfma_f32_16x16x32_bf16 v[88:91], v[168:171], v[200:203], v[88:91]
    v_mfma_f32_16x16x32_bf16 v[92:95], v[168:171], v[204:207], v[92:95]
    v_mfma_f32_16x16x32_bf16 v[8:11], v[184:187], v[168:171], v[8:11]
    v_mfma_f32_16x16x32_bf16 v[12:15], v[188:191], v[168:171], v[12:15]
    v_mfma_f32_16x16x32_bf16 v[56:59], v[192:195], v[172:175], v[56:59]
    v_mfma_f32_16x16x32_bf16 v[60:63], v[196:199], v[172:175], v[60:63]
    v_mfma_f32_16x16x32_bf16 v[96:99], v[172:175], v[200:203], v[96:99]
    v_mfma_f32_16x16x32_bf16 v[100:103], v[172:175], v[204:207], v[100:103]
    v_mfma_f32_16x16x32_bf16 v[16:19], v[184:187], v[172:175], v[16:19]
    v_mfma_f32_16x16x32_bf16 v[20:23], v[188:191], v[172:175], v[20:23]
    v_mfma_f32_16x16x32_bf16 v[64:67], v[192:195], v[176:179], v[64:67]
    v_mfma_f32_16x16x32_bf16 v[68:71], v[196:199], v[176:179], v[68:71]
    v_mfma_f32_16x16x32_bf16 v[104:107], v[176:179], v[200:203], v[104:107]
    v_mfma_f32_16x16x32_bf16 v[108:111], v[176:179], v[204:207], v[108:111]
    v_mfma_f32_16x16x32_bf16 v[24:27], v[184:187], v[176:179], v[24:27]
    v_mfma_f32_16x16x32_bf16 v[28:31], v[188:191], v[176:179], v[28:31]
    v_mfma_f32_16x16x32_bf16 v[72:75], v[192:195], v[180:183], v[72:75]
    v_mfma_f32_16x16x32_bf16 v[76:79], v[196:199], v[180:183], v[76:79]
    v_mfma_f32_16x16x32_bf16 v[112:115], v[180:183], v[200:203], v[112:115]
    v_mfma_f32_16x16x32_bf16 v[116:119], v[180:183], v[204:207], v[116:119]
    v_mfma_f32_16x16x32_bf16 v[32:35], v[184:187], v[180:183], v[32:35]
    v_mfma_f32_16x16x32_bf16 v[36:39], v[188:191], v[180:183], v[36:39]
    s_barrier
    s_mov_b64 exec, 1
    buffer_store_dword v3, v2, s[28:31], 0 offen sc1
    s_mov_b64 exec, -1
    s_barrier
    ds_read_b128 v[120:123], v232 offset:0
    ds_read_b64_tr_b16 v[148:149], v235 offset:128
    ds_read_b64_tr_b16 v[150:151], v235 offset:1664
    ds_read_b64_tr_b16 v[152:153], v236 offset:128
    ds_read_b64_tr_b16 v[154:155], v236 offset:1664
    ds_read_b64_tr_b16 v[156:157], v235 offset:256
    ds_read_b64_tr_b16 v[158:159], v235 offset:1792
    ds_read_b64_tr_b16 v[160:161], v236 offset:256
    ds_read_b64_tr_b16 v[162:163], v236 offset:1792
    ds_read_b128 v[124:127], v232 offset:2048
    ds_read_b64_tr_b16 v[140:141], v235 offset:0
    ds_read_b64_tr_b16 v[142:143], v235 offset:1536
    ds_read_b64_tr_b16 v[144:145], v236 offset:0
    ds_read_b64_tr_b16 v[146:147], v236 offset:1536
    ds_read_b128 v[128:131], v232 offset:4096
    ds_read_b128 v[132:135], v232 offset:6144
    ds_read_b128 v[136:139], v232 offset:8192
    s_add_u32 s52, s52, 49152
    s_cmp_ge_u32 s52, 147456
    s_cselect_b32 s52, 0, s52
    s_waitcnt lgkmcnt(0)
    v_mfma_f32_16x16x32_bf16 v[40:43], v[148:151], v[120:123], v[40:43]
    ds_read_b128 v[164:167], v232 offset:1024
    v_mfma_f32_16x16x32_bf16 v[44:47], v[152:155], v[120:123], v[44:47]
    ds_read_b64_tr_b16 v[192:193], v235 offset:12416
    v_mfma_f32_16x16x32_bf16 v[80:83], v[120:123], v[156:159], v[80:83]
    ds_read_b64_tr_b16 v[194:195], v235 offset:13952
    v_mfma_f32_16x16x32_bf16 v[84:87], v[120:123], v[160:163], v[84:87]
    ds_read_b64_tr_b16 v[196:197], v236 offset:12416
    v_mfma_f32_16x16x32_bf16 v[48:51], v[148:151], v[124:127], v[48:51]
    ds_read_b64_tr_b16 v[198:199], v236 offset:13952
    v_mfma_f32_16x16x32_bf16 v[52:55], v[152:155], v[124:127], v[52:55]
    v_mfma_f32_16x16x32_bf16 v[88:91], v[124:127], v[156:159], v[88:91]
    ds_read_b64_tr_b16 v[200:201], v235 offset:12544
    v_mfma_f32_16x16x32_bf16 v[92:95], v[124:127], v[160:163], v[92:95]
    ds_read_b64_tr_b16 v[202:203], v235 offset:14080
    v_mfma_f32_16x16x32_bf16 v[8:11], v[140:143], v[124:127], v[8:11]
    ds_read_b64_tr_b16 v[204:205], v236 offset:12544
    v_mfma_f32_16x16x32_bf16 v[12:15], v[144:147], v[124:127], v[12:15]
    ds_read_b64_tr_b16 v[206:207], v236 offset:14080
    v_mfma_f32_16x16x32_bf16 v[56:59], v[148:151], v[128:131], v[56:59]
    v_mfma_f32_16x16x32_bf16 v[60:63], v[152:155], v[128:131], v[60:63]
    ds_read_b128 v[168:171], v232 offset:3072
    v_mfma_f32_16x16x32_bf16 v[96:99], v[128:131], v[156:159], v[96:99]
    ds_read_b64_tr_b16 v[184:185], v235 offset:12288
    v_mfma_f32_16x16x32_bf16 v[100:103], v[128:131], v[160:163], v[100:103]
    ds_read_b64_tr_b16 v[186:187], v235 offset:13824
    v_mfma_f32_16x16x32_bf16 v[16:19], v[140:143], v[128:131], v[16:19]
    s_movk_i32 s54, 13
M_P_loop0:
    ds_read_b64_tr_b16 v[188:189], v236 offset:12288
    v_mfma_f32_16x16x32_bf16 v[20:23], v[144:147], v[128:131], v[20:23]
    v_mfma_f32_16x16x32_bf16 v[64:67], v[148:151], v[132:135], v[64:67]
    ds_read_b64_tr_b16 v[190:191], v236 offset:13824
    v_mfma_f32_16x16x32_bf16 v[68:71], v[152:155], v[132:135], v[68:71]
    ds_read_b128 v[172:175], v232 offset:5120
    v_mfma_f32_16x16x32_bf16 v[104:107], v[132:135], v[156:159], v[104:107]
    ds_read_b128 v[176:179], v232 offset:7168
    v_mfma_f32_16x16x32_bf16 v[108:111], v[132:135], v[160:163], v[108:111]
    ds_read_b128 v[180:183], v232 offset:9216
    v_mfma_f32_16x16x32_bf16 v[24:27], v[140:143], v[132:135], v[24:27]
    v_mfma_f32_16x16x32_bf16 v[28:31], v[144:147], v[132:135], v[28:31]
    v_add_u32 v232, s52, v233
    v_mfma_f32_16x16x32_bf16 v[72:75], v[148:151], v[136:139], v[72:75]
    v_mfma_f32_16x16x32_bf16 v[76:79], v[152:155], v[136:139], v[76:79]
    v_add_u32 v235, s52, v239
    v_mfma_f32_16x16x32_bf16 v[112:115], v[136:139], v[156:159], v[112:115]
    v_mfma_f32_16x16x32_bf16 v[116:119], v[136:139], v[160:163], v[116:119]
    v_add_u32 v236, s52, v240
    v_mfma_f32_16x16x32_bf16 v[32:35], v[140:143], v[136:139], v[32:35]
    v_mfma_f32_16x16x32_bf16 v[36:39], v[144:147], v[136:139], v[36:39]
    s_waitcnt lgkmcnt(0)
    v_mfma_f32_16x16x32_bf16 v[40:43], v[192:195], v[164:167], v[40:43]
    s_barrier
    v_mfma_f32_16x16x32_bf16 v[44:47], v[196:199], v[164:167], v[44:47]
    ds_read_b128 v[120:123], v232 offset:0
    v_mfma_f32_16x16x32_bf16 v[80:83], v[164:167], v[200:203], v[80:83]
    ds_read_b64_tr_b16 v[148:149], v235 offset:128
    v_mfma_f32_16x16x32_bf16 v[84:87], v[164:167], v[204:207], v[84:87]
    ds_read_b64_tr_b16 v[150:151], v235 offset:1664
    v_mfma_f32_16x16x32_bf16 v[48:51], v[192:195], v[168:171], v[48:51]
    ds_read_b64_tr_b16 v[152:153], v236 offset:128
    v_mfma_f32_16x16x32_bf16 v[52:55], v[196:199], v[168:171], v[52:55]
    ds_read_b64_tr_b16 v[154:155], v236 offset:1664
    v_mfma_f32_16x16x32_bf16 v[88:91], v[168:171], v[200:203], v[88:91]
    ds_read_b64_tr_b16 v[156:157], v235 offset:256
    v_mfma_f32_16x16x32_bf16 v[92:95], v[168:171], v[204:207], v[92:95]
    v_mfma_f32_16x16x32_bf16 v[8:11], v[184:187], v[168:171], v[8:11]
    ds_read_b64_tr_b16 v[158:159], v235 offset:1792
    v_mfma_f32_16x16x32_bf16 v[12:15], v[188:191], v[168:171], v[12:15]
    ds_read_b64_tr_b16 v[160:161], v236 offset:256
    v_mfma_f32_16x16x32_bf16 v[56:59], v[192:195], v[172:175], v[56:59]
    ds_read_b64_tr_b16 v[162:163], v236 offset:1792
    v_mfma_f32_16x16x32_bf16 v[60:63], v[196:199], v[172:175], v[60:63]
    ds_read_b128 v[124:127], v232 offset:2048
    v_mfma_f32_16x16x32_bf16 v[96:99], v[172:175], v[200:203], v[96:99]
    ds_read_b64_tr_b16 v[140:141], v235 offset:0
    v_mfma_f32_16x16x32_bf16 v[100:103], v[172:175], v[204:207], v[100:103]
    ds_read_b64_tr_b16 v[142:143], v235 offset:1536
    v_mfma_f32_16x16x32_bf16 v[16:19], v[184:187], v[172:175], v[16:19]
    v_mfma_f32_16x16x32_bf16 v[20:23], v[188:191], v[172:175], v[20:23]
    ds_read_b64_tr_b16 v[144:145], v236 offset:0
    v_mfma_f32_16x16x32_bf16 v[64:67], v[192:195], v[176:179], v[64:67]
    ds_read_b64_tr_b16 v[146:147], v236 offset:1536
    v_mfma_f32_16x16x32_bf16 v[68:71], v[196:199], v[176:179], v[68:71]
    ds_read_b128 v[128:131], v232 offset:4096
    v_mfma_f32_16x16x32_bf16 v[104:107], v[176:179], v[200:203], v[104:107]
    ds_read_b128 v[132:135], v232 offset:6144
    v_mfma_f32_16x16x32_bf16 v[108:111], v[176:179], v[204:207], v[108:111]
    ds_read_b128 v[136:139], v232 offset:8192
    v_mfma_f32_16x16x32_bf16 v[24:27], v[184:187], v[176:179], v[24:27]
    v_mfma_f32_16x16x32_bf16 v[28:31], v[188:191], v[176:179], v[28:31]
    v_mfma_f32_16x16x32_bf16 v[72:75], v[192:195], v[180:183], v[72:75]
    v_mfma_f32_16x16x32_bf16 v[76:79], v[196:199], v[180:183], v[76:79]
    v_mfma_f32_16x16x32_bf16 v[112:115], v[180:183], v[200:203], v[112:115]
    v_mfma_f32_16x16x32_bf16 v[116:119], v[180:183], v[204:207], v[116:119]
    v_mfma_f32_16x16x32_bf16 v[32:35], v[184:187], v[180:183], v[32:35]
    s_add_u32 s52, s52, 49152
    s_cmp_ge_u32 s52, 147456
    s_cselect_b32 s52, 0, s52
    v_mfma_f32_16x16x32_bf16 v[36:39], v[188:191], v[180:183], v[36:39]
    s_waitcnt lgkmcnt(0)
    v_mfma_f32_16x16x32_bf16 v[40:43], v[148:151], v[120:123], v[40:43]
    ds_read_b128 v[164:167], v232 offset:1024
    v_mfma_f32_16x16x32_bf16 v[44:47], v[152:155], v[120:123], v[44:47]
    ds_read_b64_tr_b16 v[192:193], v235 offset:12416
    v_mfma_f32_16x16x32_bf16 v[80:83], v[120:123], v[156:159], v[80:83]
    ds_read_b64_tr_b16 v[194:195], v235 offset:13952
    v_mfma_f32_16x16x32_bf16 v[84:87], v[120:123], v[160:163], v[84:87]
    ds_read_b64_tr_b16 v[196:197], v236 offset:12416
    v_mfma_f32_16x16x32_bf16 v[48:51], v[148:151], v[124:127], v[48:51]
    ds_read_b64_tr_b16 v[198:199], v236 offset:13952
    v_mfma_f32_16x16x32_bf16 v[52:55], v[152:155], v[124:127], v[52:55]
    v_mfma_f32_16x16x32_bf16 v[88:91], v[124:127], v[156:159], v[88:91]
    ds_read_b64_tr_b16 v[200:201], v235 offset:12544
    v_mfma_f32_16x16x32_bf16 v[92:95], v[124:127], v[160:163], v[92:95]
    ds_read_b64_tr_b16 v[202:203], v235 offset:14080
    v_mfma_f32_16x16x32_bf16 v[8:11], v[140:143], v[124:127], v[8:11]
    ds_read_b64_tr_b16 v[204:205], v236 offset:12544
    v_mfma_f32_16x16x32_bf16 v[12:15], v[144:147], v[124:127], v[12:15]
    ds_read_b64_tr_b16 v[206:207], v236 offset:14080
    v_mfma_f32_16x16x32_bf16 v[56:59], v[148:151], v[128:131], v[56:59]
    v_mfma_f32_16x16x32_bf16 v[60:63], v[152:155], v[128:131], v[60:63]
    ds_read_b128 v[168:171], v232 offset:3072
    v_mfma_f32_16x16x32_bf16 v[96:99], v[128:131], v[156:159], v[96:99]
    ds_read_b64_tr_b16 v[184:185], v235 offset:12288
    v_mfma_f32_16x16x32_bf16 v[100:103], v[128:131], v[160:163], v[100:103]
    s_sub_u32 s54, s54, 1
    ds_read_b64_tr_b16 v[186:187], v235 offset:13824
    v_mfma_f32_16x16x32_bf16 v[16:19], v[140:143], v[128:131], v[16:19]
    s_cbranch_scc0 M_P_loop0
    ds_read_b64_tr_b16 v[188:189], v236 offset:12288
    v_mfma_f32_16x16x32_bf16 v[20:23], v[144:147], v[128:131], v[20:23]
    v_mfma_f32_16x16x32_bf16 v[64:67], v[148:151], v[132:135], v[64:67]
    ds_read_b64_tr_b16 v[190:191], v236 offset:13824
    v_mfma_f32_16x16x32_bf16 v[68:71], v[152:155], v[132:135], v[68:71]
    ds_read_b128 v[172:175], v232 offset:5120
    v_mfma_f32_16x16x32_bf16 v[104:107], v[132:135], v[156:159], v[104:107]
    ds_read_b128 v[176:179], v232 offset:7168
    v_mfma_f32_16x16x32_bf16 v[108:111], v[132:135], v[160:163], v[108:111]
    ds_read_b128 v[180:183], v232 offset:9216
    v_mfma_f32_16x16x32_bf16 v[24:27], v[140:143], v[132:135], v[24:27]
    v_mfma_f32_16x16x32_bf16 v[28:31], v[144:147], v[132:135], v[28:31]
    v_mfma_f32_16x16x32_bf16 v[72:75], v[148:151], v[136:139], v[72:75]
    v_mfma_f32_16x16x32_bf16 v[76:79], v[152:155], v[136:139], v[76:79]
    v_mfma_f32_16x16x32_bf16 v[112:115], v[136:139], v[156:159], v[112:115]
    v_mfma_f32_16x16x32_bf16 v[116:119], v[136:139], v[160:163], v[116:119]
    v_mfma_f32_16x16x32_bf16 v[32:35], v[140:143], v[136:139], v[32:35]
    v_mfma_f32_16x16x32_bf16 v[36:39], v[144:147], v[136:139], v[36:39]
    s_waitcnt lgkmcnt(0)
    v_mfma_f32_16x16x32_bf16 v[40:43], v[192:195], v[164:167], v[40:43]
    s_barrier
    v_mfma_f32_16x16x32_bf16 v[44:47], v[196:199], v[164:167], v[44:47]
    v_mfma_f32_16x16x32_bf16 v[80:83], v[164:167], v[200:203], v[80:83]
    v_mfma_f32_16x16x32_bf16 v[84:87], v[164:167], v[204:207], v[84:87]
    v_mfma_f32_16x16x32_bf16 v[48:51], v[192:195], v[168:171], v[48:51]
    v_mfma_f32_16x16x32_bf16 v[52:55], v[196:199], v[168:171], v[52:55]
    v_mfma_f32_16x16x32_bf16 v[88:91], v[168:171], v[200:203], v[88:91]
    v_mfma_f32_16x16x32_bf16 v[92:95], v[168:171], v[204:207], v[92:95]
    v_mfma_f32_16x16x32_bf16 v[8:11], v[184:187], v[168:171], v[8:11]
    v_mfma_f32_16x16x32_bf16 v[12:15], v[188:191], v[168:171], v[12:15]
    v_mfma_f32_16x16x32_bf16 v[56:59], v[192:195], v[172:175], v[56:59]
    v_mfma_f32_16x16x32_bf16 v[60:63], v[196:199], v[172:175], v[60:63]
    v_mfma_f32_16x16x32_bf16 v[96:99], v[172:175], v[200:203], v[96:99]
    v_mfma_f32_16x16x32_bf16 v[100:103], v[172:175], v[204:207], v[100:103]
    v_mfma_f32_16x16x32_bf16 v[16:19], v[184:187], v[172:175], v[16:19]
    v_mfma_f32_16x16x32_bf16 v[20:23], v[188:191], v[172:175], v[20:23]
    v_mfma_f32_16x16x32_bf16 v[64:67], v[192:195], v[176:179], v[64:67]
    v_mfma_f32_16x16x32_bf16 v[68:71], v[196:199], v[176:179], v[68:71]
    v_mfma_f32_16x16x32_bf16 v[104:107], v[176:179], v[200:203], v[104:107]
    v_mfma_f32_16x16x32_bf16 v[108:111], v[176:179], v[204:207], v[108:111]
    v_mfma_f32_16x16x32_bf16 v[24:27], v[184:187], v[176:179], v[24:27]
    v_mfma_f32_16x16x32_bf16 v[28:31], v[188:191], v[176:179], v[28:31]
    v_mfma_f32_16x16x32_bf16 v[72:75], v[192:195], v[180:183], v[72:75]
    v_mfma_f32_16x16x32_bf16 v[76:79], v[196:199], v[180:183], v[76:79]
    v_mfma_f32_16x16x32_bf16 v[112:115], v[180:183], v[200:203], v[112:115]
    v_mfma_f32_16x16x32_bf16 v[116:119], v[180:183], v[204:207], v[116:119]
    v_mfma_f32_16x16x32_bf16 v[32:35], v[184:187], v[180:183], v[32:35]
    v_mfma_f32_16x16x32_bf16 v[36:39], v[188:191], v[180:183], v[36:39]
    v_cvt_pk_bf16_f32 v120, v40, v41
    v_cvt_pk_bf16_f32 v121, v42, v43
    v_cvt_pk_bf16_f32 v122, v44, v45
    v_cvt_pk_bf16_f32 v123, v46, v47
    v_cvt_pk_bf16_f32 v124, v48, v49
    v_cvt_pk_bf16_f32 v125, v50, v51
    v_cvt_pk_bf16_f32 v126, v52, v53
    v_cvt_pk_bf16_f32 v127, v54, v55
    v_cvt_pk_bf16_f32 v140, v8, v9
    v_cvt_pk_bf16_f32 v141, v10, v11
    v_cvt_pk_bf16_f32 v142, v12, v13
    v_cvt_pk_bf16_f32 v143, v14, v15
    v_cvt_pk_bf16_f32 v128, v56, v57
    v_cvt_pk_bf16_f32 v129, v58, v59
    v_cvt_pk_bf16_f32 v130, v60, v61
    v_cvt_pk_bf16_f32 v131, v62, v63
    v_cvt_pk_bf16_f32 v144, v16, v17
    v_cvt_pk_bf16_f32 v145, v18, v19
    v_cvt_pk_bf16_f32 v146, v20, v21
    v_cvt_pk_bf16_f32 v147, v22, v23
    v_cvt_pk_bf16_f32 v132, v64, v65
    v_cvt_pk_bf16_f32 v133, v66, v67
    v_cvt_pk_bf16_f32 v134, v68, v69
    v_cvt_pk_bf16_f32 v135, v70, v71
    v_cvt_pk_bf16_f32 v148, v24, v25
    v_cvt_pk_bf16_f32 v149, v26, v27
    v_cvt_pk_bf16_f32 v150, v28, v29
    v_cvt_pk_bf16_f32 v151, v30, v31
    v_cvt_pk_bf16_f32 v136, v72, v73
    v_cvt_pk_bf16_f32 v137, v74, v75
    v_cvt_pk_bf16_f32 v138, v76, v77
    v_cvt_pk_bf16_f32 v139, v78, v79
    v_cvt_pk_bf16_f32 v152, v32, v33
    v_cvt_pk_bf16_f32 v153, v34, v35
    v_cvt_pk_bf16_f32 v154, v36, v37
    v_cvt_pk_bf16_f32 v155, v38, v39
    v_mfma_f32_16x16x32_bf16 v[8:11], v[120:123], v[140:143], 0
    v_mfma_f32_16x16x32_bf16 v[12:15], v[124:127], v[140:143], 0
    v_mfma_f32_16x16x32_bf16 v[16:19], v[124:127], v[144:147], 0
    v_mfma_f32_16x16x32_bf16 v[20:23], v[128:131], v[144:147], 0
    v_mfma_f32_16x16x32_bf16 v[24:27], v[128:131], v[148:151], 0
    v_mfma_f32_16x16x32_bf16 v[28:31], v[132:135], v[148:151], 0
    v_mfma_f32_16x16x32_bf16 v[32:35], v[132:135], v[152:155], 0
    v_mfma_f32_16x16x32_bf16 v[36:39], v[136:139], v[152:155], 0
    v_cvt_pk_bf16_f32 v156, v80, v81
    v_cvt_pk_bf16_f32 v157, v82, v83
    v_cvt_pk_bf16_f32 v166, v84, v85
    v_cvt_pk_bf16_f32 v167, v86, v87
    v_cvt_pk_bf16_f32 v158, v88, v89
    v_cvt_pk_bf16_f32 v159, v90, v91
    v_cvt_pk_bf16_f32 v168, v92, v93
    v_cvt_pk_bf16_f32 v169, v94, v95
    v_cvt_pk_bf16_f32 v160, v96, v97
    v_cvt_pk_bf16_f32 v161, v98, v99
    v_cvt_pk_bf16_f32 v170, v100, v101
    v_cvt_pk_bf16_f32 v171, v102, v103
    v_cvt_pk_bf16_f32 v162, v104, v105
    v_cvt_pk_bf16_f32 v163, v106, v107
    v_cvt_pk_bf16_f32 v172, v108, v109
    v_cvt_pk_bf16_f32 v173, v110, v111
    v_cvt_pk_bf16_f32 v164, v112, v113
    v_cvt_pk_bf16_f32 v165, v114, v115
    v_cvt_pk_bf16_f32 v174, v116, v117
    v_cvt_pk_bf16_f32 v175, v118, v119
    s_mov_b32 s64, 0x3e8293ee
    v_mov_b32 v5, 0xf149f2ca
    v_cndmask_b32 v8, v5, v8, s[88:89]
    v_cndmask_b32 v12, v5, v12, s[80:81]
    v_cndmask_b32 v9, v5, v9, s[90:91]
    v_cndmask_b32 v13, v5, v13, s[82:83]
    v_cndmask_b32 v10, v5, v10, s[92:93]
    v_cndmask_b32 v14, v5, v14, s[84:85]
    v_cndmask_b32 v11, v5, v11, s[94:95]
    v_cndmask_b32 v15, v5, v15, s[86:87]
    v_cndmask_b32 v16, v5, v16, s[72:73]
    v_cndmask_b32 v20, v5, v20, s[80:81]
    v_cndmask_b32 v17, v5, v17, s[74:75]
    v_cndmask_b32 v21, v5, v21, s[82:83]
    v_cndmask_b32 v18, v5, v18, s[76:77]
    v_cndmask_b32 v22, v5, v22, s[84:85]
    v_cndmask_b32 v19, v5, v19, s[78:79]
    v_cndmask_b32 v23, v5, v23, s[86:87]
    v_cndmask_b32 v24, v5, v24, s[72:73]
    v_cndmask_b32 v28, v5, v28, s[80:81]
    v_cndmask_b32 v25, v5, v25, s[74:75]
    v_cndmask_b32 v29, v5, v29, s[82:83]
    v_cndmask_b32 v26, v5, v26, s[76:77]
    v_cndmask_b32 v30, v5, v30, s[84:85]
    v_cndmask_b32 v27, v5, v27, s[78:79]
    v_cndmask_b32 v31, v5, v31, s[86:87]
    v_cndmask_b32 v32, v5, v32, s[72:73]
    v_cndmask_b32 v36, v5, v36, s[80:81]
    v_cndmask_b32 v33, v5, v33, s[74:75]
    v_cndmask_b32 v37, v5, v37, s[82:83]
    v_cndmask_b32 v34, v5, v34, s[76:77]
    v_cndmask_b32 v38, v5, v38, s[84:85]
    v_cndmask_b32 v35, v5, v35, s[78:79]
    v_cndmask_b32 v39, v5, v39, s[86:87]
    v_max3_f32 v192, v8, v9, v10
    v_max3_f32 v196, v11, v12, v13
    v_max3_f32 v193, v16, v17, v18
    v_max3_f32 v197, v19, v20, v21
    v_max3_f32 v194, v24, v25, v26
    v_max3_f32 v198, v27, v28, v29
    v_max3_f32 v195, v32, v33, v34
    v_max3_f32 v199, v35, v36, v37
    v_max3_f32 v192, v192, v14, v15
    v_max3_f32 v193, v193, v22, v23
    v_max3_f32 v194, v194, v30, v31
    v_max3_f32 v195, v195, v38, v39
    v_max_f32 v192, v192, v196
    v_max_f32 v193, v193, v197
    v_max_f32 v194, v194, v198
    v_max_f32 v195, v195, v199
    v_mov_b32 v196, v192
    v_mov_b32 v197, v193
    v_mov_b32 v198, v194
    v_mov_b32 v199, v195
    v_permlane32_swap_b32 v192, v196
    v_permlane32_swap_b32 v193, v197
    v_permlane32_swap_b32 v194, v198
    v_permlane32_swap_b32 v195, v199
    v_max_f32 v192, v192, v196
    v_max_f32 v193, v193, v197
    v_max_f32 v194, v194, v198
    v_max_f32 v195, v195, v199
    v_mov_b32 v196, v192
    v_mov_b32 v197, v193
    v_mov_b32 v198, v194
    v_mov_b32 v199, v195
    v_permlane16_swap_b32 v192, v196
    v_permlane16_swap_b32 v193, v197
    v_permlane16_swap_b32 v194, v198
    v_permlane16_swap_b32 v195, v199
    v_max_f32 v192, v192, v196
    v_max_f32 v193, v193, v197
    v_max_f32 v194, v194, v198
    v_max_f32 v195, v195, v199
    v_mul_f32 v192, s64, v192
    v_mul_f32 v193, s64, v193
    v_mul_f32 v194, s64, v194
    v_mul_f32 v195, s64, v195
    v_fma_f32 v8, v8, s64, -v192
    v_fma_f32 v9, v9, s64, -v192
    v_fma_f32 v10, v10, s64, -v192
    v_fma_f32 v11, v11, s64, -v192
    v_fma_f32 v12, v12, s64, -v192
    v_fma_f32 v13, v13, s64, -v192
    v_fma_f32 v14, v14, s64, -v192
    v_fma_f32 v15, v15, s64, -v192
    v_fma_f32 v16, v16, s64, -v193
    v_fma_f32 v17, v17, s64, -v193
    v_fma_f32 v18, v18, s64, -v193
    v_fma_f32 v19, v19, s64, -v193
    v_fma_f32 v20, v20, s64, -v193
    v_fma_f32 v21, v21, s64, -v193
    v_fma_f32 v22, v22, s64, -v193
    v_fma_f32 v23, v23, s64, -v193
    v_fma_f32 v24, v24, s64, -v194
    v_fma_f32 v25, v25, s64, -v194
    v_fma_f32 v26, v26, s64, -v194
    v_fma_f32 v27, v27, s64, -v194
    v_fma_f32 v28, v28, s64, -v194
    v_fma_f32 v29, v29, s64, -v194
    v_fma_f32 v30, v30, s64, -v194
    v_fma_f32 v31, v31, s64, -v194
    v_fma_f32 v32, v32, s64, -v195
    v_fma_f32 v33, v33, s64, -v195
    v_fma_f32 v34, v34, s64, -v195
    v_fma_f32 v35, v35, s64, -v195
    v_fma_f32 v36, v36, s64, -v195
    v_fma_f32 v37, v37, s64, -v195
    v_fma_f32 v38, v38, s64, -v195
    v_fma_f32 v39, v39, s64, -v195
    v_exp_f32 v8, v8
    v_exp_f32 v9, v9
    v_exp_f32 v10, v10
    v_exp_f32 v11, v11
    v_exp_f32 v12, v12
    v_exp_f32 v13, v13
    v_exp_f32 v14, v14
    v_exp_f32 v15, v15
    v_exp_f32 v16, v16
    v_exp_f32 v17, v17
    v_exp_f32 v18, v18
    v_exp_f32 v19, v19
    v_exp_f32 v20, v20
    v_exp_f32 v21, v21
    v_exp_f32 v22, v22
    v_exp_f32 v23, v23
    v_exp_f32 v24, v24
    v_exp_f32 v25, v25
    v_exp_f32 v26, v26
    v_exp_f32 v27, v27
    v_exp_f32 v28, v28
    v_exp_f32 v29, v29
    v_exp_f32 v30, v30
    v_exp_f32 v31, v31
    v_exp_f32 v32, v32
    v_exp_f32 v33, v33
    v_exp_f32 v34, v34
    v_exp_f32 v35, v35
    v_exp_f32 v36, v36
    v_exp_f32 v37, v37
    v_exp_f32 v38, v38
    v_exp_f32 v39, v39
    v_pk_add_f32 v[200:201], v[8:9], v[10:11]
    v_pk_add_f32 v[202:203], v[16:17], v[18:19]
    v_pk_add_f32 v[204:205], v[24:25], v[26:27]
    v_pk_add_f32 v[206:207], v[32:33], v[34:35]
    v_pk_add_f32 v[200:201], v[200:201], v[12:13]
    v_pk_add_f32 v[202:203], v[202:203], v[20:21]
    v_pk_add_f32 v[204:205], v[204:205], v[28:29]
    v_pk_add_f32 v[206:207], v[206:207], v[36:37]
    v_pk_add_f32 v[200:201], v[200:201], v[14:15]
    v_pk_add_f32 v[202:203], v[202:203], v[22:23]
    v_pk_add_f32 v[204:205], v[204:205], v[30:31]
    v_pk_add_f32 v[206:207], v[206:207], v[38:39]
    v_add_f32 v200, v200, v201
    v_add_f32 v202, v202, v203
    v_add_f32 v204, v204, v205
    v_add_f32 v206, v206, v207
    v_mov_b32 v196, v200
    v_mov_b32 v197, v202
    v_mov_b32 v198, v204
    v_mov_b32 v199, v206
    v_permlane32_swap_b32 v200, v196
    v_permlane32_swap_b32 v202, v197
    v_permlane32_swap_b32 v204, v198
    v_permlane32_swap_b32 v206, v199
    v_add_f32 v200, v200, v196
    v_add_f32 v202, v202, v197
    v_add_f32 v204, v204, v198
    v_add_f32 v206, v206, v199
    v_mov_b32 v196, v200
    v_mov_b32 v197, v202
    v_mov_b32 v198, v204
    v_mov_b32 v199, v206
    v_permlane16_swap_b32 v200, v196
    v_permlane16_swap_b32 v202, v197
    v_permlane16_swap_b32 v204, v198
    v_permlane16_swap_b32 v206, v199
    v_add_f32 v200, v200, v196
    v_add_f32 v202, v202, v197
    v_add_f32 v204, v204, v198
    v_add_f32 v206, v206, v199
    v_rcp_f32 v200, v200
    v_rcp_f32 v202, v202
    v_rcp_f32 v204, v204
    v_rcp_f32 v206, v206
    v_pk_mul_f32 v[8:9], v[8:9], v[200:201] op_sel_hi:[1,0]
    v_pk_mul_f32 v[10:11], v[10:11], v[200:201] op_sel_hi:[1,0]
    v_pk_mul_f32 v[12:13], v[12:13], v[200:201] op_sel_hi:[1,0]
    v_pk_mul_f32 v[14:15], v[14:15], v[200:201] op_sel_hi:[1,0]
    v_pk_mul_f32 v[16:17], v[16:17], v[202:203] op_sel_hi:[1,0]
    v_pk_mul_f32 v[18:19], v[18:19], v[202:203] op_sel_hi:[1,0]
    v_pk_mul_f32 v[20:21], v[20:21], v[202:203] op_sel_hi:[1,0]
    v_pk_mul_f32 v[22:23], v[22:23], v[202:203] op_sel_hi:[1,0]
    v_pk_mul_f32 v[24:25], v[24:25], v[204:205] op_sel_hi:[1,0]
    v_pk_mul_f32 v[26:27], v[26:27], v[204:205] op_sel_hi:[1,0]
    v_pk_mul_f32 v[28:29], v[28:29], v[204:205] op_sel_hi:[1,0]
    v_pk_mul_f32 v[30:31], v[30:31], v[204:205] op_sel_hi:[1,0]
    v_pk_mul_f32 v[32:33], v[32:33], v[206:207] op_sel_hi:[1,0]
    v_pk_mul_f32 v[34:35], v[34:35], v[206:207] op_sel_hi:[1,0]
    v_pk_mul_f32 v[36:37], v[36:37], v[206:207] op_sel_hi:[1,0]
    v_pk_mul_f32 v[38:39], v[38:39], v[206:207] op_sel_hi:[1,0]
    v_cvt_pk_bf16_f32 v176, v8, v9
    v_cvt_pk_bf16_f32 v177, v10, v11
    v_cvt_pk_bf16_f32 v178, v12, v13
    v_cvt_pk_bf16_f32 v179, v14, v15
    v_cvt_pk_bf16_f32 v180, v16, v17
    v_cvt_pk_bf16_f32 v181, v18, v19
    v_cvt_pk_bf16_f32 v182, v20, v21
    v_cvt_pk_bf16_f32 v183, v22, v23
    v_cvt_pk_bf16_f32 v184, v24, v25
    v_cvt_pk_bf16_f32 v185, v26, v27
    v_cvt_pk_bf16_f32 v186, v28, v29
    v_cvt_pk_bf16_f32 v187, v30, v31
    v_cvt_pk_bf16_f32 v188, v32, v33
    v_cvt_pk_bf16_f32 v189, v34, v35
    v_cvt_pk_bf16_f32 v190, v36, v37
    v_cvt_pk_bf16_f32 v191, v38, v39
    v_mfma_f32_16x16x32_bf16 v[40:43], v[156:159], v[176:179], 0
    v_mfma_f32_16x16x32_bf16 v[44:47], v[166:169], v[176:179], 0
    v_mfma_f32_16x16x32_bf16 v[48:51], v[158:161], v[180:183], 0
    v_mfma_f32_16x16x32_bf16 v[52:55], v[168:171], v[180:183], 0
    v_mfma_f32_16x16x32_bf16 v[56:59], v[160:163], v[184:187], 0
    v_mfma_f32_16x16x32_bf16 v[60:63], v[170:173], v[184:187], 0
    v_mfma_f32_16x16x32_bf16 v[64:67], v[162:165], v[188:191], 0
    v_mfma_f32_16x16x32_bf16 v[68:71], v[172:175], v[188:191], 0
    s_mov_b32 s72, 0x0
    s_mov_b32 s73, 0x8000
    s_mov_b32 s74, 0x10000
    s_mov_b32 s75, 0x18000
    v_cvt_pk_bf16_f32 v120, v40, v41
    v_cvt_pk_bf16_f32 v121, v42, v43
    v_cvt_pk_bf16_f32 v122, v44, v45
    v_cvt_pk_bf16_f32 v123, v46, v47
    buffer_store_dwordx4 v[120:123], v237, s[28:31], s72 offen sc1
    v_cvt_pk_bf16_f32 v124, v48, v49
    v_cvt_pk_bf16_f32 v125, v50, v51
    v_cvt_pk_bf16_f32 v126, v52, v53
    v_cvt_pk_bf16_f32 v127, v54, v55
    buffer_store_dwordx4 v[124:127], v237, s[28:31], s73 offen sc1
    v_cvt_pk_bf16_f32 v128, v56, v57
    v_cvt_pk_bf16_f32 v129, v58, v59
    v_cvt_pk_bf16_f32 v130, v60, v61
    v_cvt_pk_bf16_f32 v131, v62, v63
    buffer_store_dwordx4 v[128:131], v237, s[28:31], s74 offen sc1
    v_cvt_pk_bf16_f32 v132, v64, v65
    v_cvt_pk_bf16_f32 v133, v66, v67
    v_cvt_pk_bf16_f32 v134, v68, v69
    v_cvt_pk_bf16_f32 v135, v70, v71
    buffer_store_dwordx4 v[132:135], v237, s[28:31], s75 offen sc1
    s_lshl_b32 s64, s44, 13
    s_lshl_b32 s65, s48, 9
    s_add_u32 s64, s64, s65
    s_add_u32 s64, s64, 0xa0000
    v_lshl_add_u32 v200, v1, 3, s64
    s_mov_b32 s76, 0
    s_mov_b32 s77, 32768
    s_mov_b32 s78, 65536
    s_mov_b32 s79, 98304
    s_lshl_b32 s68, s47, 9
    s_add_u32 s68, s68, 0x54000
    s_add_u32 s62, s26, s68
    s_addc_u32 s63, s27, 0
    s_lshr_b32 s68, s48, 2
    s_lshl_b32 s68, s68, 7
    v_mov_b32 v2, 1
    v_mov_b32 v5, 148484
    s_waitcnt vmcnt(0)
    s_mov_b64 exec, 1
    ds_add_rtn_u32 v245, v5, v2
    s_mov_b64 exec, -1
    s_mov_b32 s1, 1
    s_mov_b32 s3, 0x4000
    s_waitcnt lgkmcnt(0)
    v_readfirstlane_b32 s64, v245
    s_nop 3
    s_cmp_lg_u32 s64, 3
    s_cbranch_scc1 M_po_ok
    s_atomic_add s1, s[62:63], 0
    s_atomic_add s1, s[62:63], 128
    s_atomic_add s1, s[62:63], 256
    s_atomic_add s1, s[62:63], 384
M_po_chk:
    s_load_dword s64, s[62:63], s68 glc
    s_sub_u32 s3, s3, 1
    s_cselect_b32 s65, 0, 16
    s_waitcnt lgkmcnt(0)
    s_cmp_lt_u32 s64, s65
    s_cbranch_scc1 M_po_chk
M_po_ok:
    s_barrier
    s_setprio 0
    s_and_b32 s57, s58, 15
    s_lshr_b64 s[58:59], s[58:59], 4
    s_lshl_b32 s56, s57, 11
    s_mul_i32 s57, s57, 0x20000
    s_mov_b32 m0, s53
    s_nop 0
    buffer_load_dwordx4 v208, s[28:31], s56 offen offset:0 lds
    buffer_load_dwordx4 v208, s[28:31], s56 offen offset:1024 lds
    buffer_load_dwordx4 v209, s[28:31], s56 offen offset:2048 lds
    buffer_load_dwordx4 v209, s[28:31], s56 offen offset:3072 lds
    s_add_u32 s53, s53, 24576
    s_cmp_ge_u32 s53, s61
    s_cselect_b32 s53, s60, s53
    s_and_b32 s57, s58, 15
    s_lshr_b64 s[58:59], s[58:59], 4
    s_lshl_b32 s56, s57, 11
    s_mul_i32 s57, s57, 0x20000
    s_mov_b32 m0, s53
    s_nop 0
    buffer_load_dwordx4 v208, s[28:31], s56 offen offset:0 lds
    buffer_load_dwordx4 v208, s[28:31], s56 offen offset:1024 lds
    buffer_load_dwordx4 v209, s[28:31], s56 offen offset:2048 lds
    buffer_load_dwordx4 v209, s[28:31], s56 offen offset:3072 lds
    s_add_u32 s53, s53, 24576
    s_cmp_ge_u32 s53, s61
    s_cselect_b32 s53, s60, s53
    s_and_b32 s57, s58, 15
    s_lshr_b64 s[58:59], s[58:59], 4
    s_lshl_b32 s56, s57, 11
    s_mul_i32 s57, s57, 0x20000
    s_mov_b32 m0, s53
    s_nop 0
    buffer_load_dwordx4 v208, s[28:31], s56 offen offset:0 lds
    buffer_load_dwordx4 v208, s[28:31], s56 offen offset:1024 lds
    buffer_load_dwordx4 v209, s[28:31], s56 offen offset:2048 lds
    buffer_load_dwordx4 v209, s[28:31], s56 offen offset:3072 lds
    s_add_u32 s53, s53, 24576
    s_cmp_ge_u32 s53, s61
    s_cselect_b32 s53, s60, s53
    buffer_load_dwordx2 v[192:193], v200, s[28:31], s76 offen sc1
    buffer_load_dwordx2 v[194:195], v200, s[28:31], s77 offen sc1
    buffer_load_dwordx2 v[196:197], v200, s[28:31], s78 offen sc1
    buffer_load_dwordx2 v[198:199], v200, s[28:31], s79 offen sc1
    s_lshl_b32 s64, s45, 13
    v_lshl_add_u32 v233, v1, 4, s64
    v_lshrrev_b32 v2, 2, v1
    v_lshlrev_b32 v4, 8, v2
    v_and_b32 v5, 3, v1
    v_lshl_add_u32 v4, v5, 3, v4
    v_add_u32 v4, 16384, v4
    v_and_b32 v2, 7, v2
    s_lshl_b32 s64, s46, 2
    v_xor_b32 v2, s64, v2
    v_xor_b32 v3, 0, v2
    v_lshl_add_u32 v239, v3, 5, v4
    v_xor_b32 v3, 1, v2
    v_lshl_add_u32 v240, v3, 5, v4
    v_xor_b32 v3, 2, v2
    v_lshl_add_u32 v241, v3, 5, v4
    v_xor_b32 v3, 3, v2
    v_lshl_add_u32 v242, v3, 5, v4
    s_lshl_b32 s64, s2, 2
    s_add_u32 s64, s64, s44
    s_mul_i32 s64, s64, 7168
    s_add_u32 s64, s64, 5248
    s_add_u32 s10, s12, s64
    s_addc_u32 s11, s13, 0
    s_add_u32 s24, s14, s64
    s_addc_u32 s25, s15, 0
    s_mov_b32 s52, 0
    v_add_u32 v232, s52, v233
    v_add_u32 v235, s52, v239
    v_add_u32 v236, s52, v240
    v_add_u32 v237, s52, v241
    v_add_u32 v238, s52, v242
    s_movk_i32 s54, 2
M_P_loop1:
    s_waitcnt vmcnt(12)
    s_barrier
    s_and_b32 s57, s58, 15
    s_lshr_b64 s[58:59], s[58:59], 4
    s_lshl_b32 s56, s57, 11
    s_mul_i32 s57, s57, 0x20000
    s_mov_b32 m0, s53
    s_nop 0
    buffer_load_dwordx4 v208, s[28:31], s56 offen offset:0 lds
    buffer_load_dwordx4 v208, s[28:31], s56 offen offset:1024 lds
    buffer_load_dwordx4 v209, s[28:31], s56 offen offset:2048 lds
    buffer_load_dwordx4 v209, s[28:31], s56 offen offset:3072 lds
    s_add_u32 s53, s53, 24576
    s_cmp_ge_u32 s53, s61
    s_cselect_b32 s53, s60, s53
    s_sub_u32 s54, s54, 1
    s_cbranch_scc0 M_P_loop1
    s_waitcnt vmcnt(8)
    s_barrier
    s_and_b32 s57, s58, 15
    s_lshr_b64 s[58:59], s[58:59], 4
    s_lshl_b32 s56, s57, 11
    s_mul_i32 s57, s57, 0x20000
    s_add_u32 m0, s53, s70
    s_nop 0
    buffer_load_dwordx4 v210, s[32:35], s57 offen offset:0 lds
    buffer_load_dwordx4 v211, s[32:35], s57 offen offset:1024 lds
    s_mov_b32 m0, s53
    s_nop 0
    buffer_load_dwordx4 v208, s[28:31], s56 offen offset:0 lds
    buffer_load_dwordx4 v208, s[28:31], s56 offen offset:1024 lds
    buffer_load_dwordx4 v209, s[28:31], s56 offen offset:2048 lds
    buffer_load_dwordx4 v209, s[28:31], s56 offen offset:3072 lds
    s_add_u32 s53, s53, 24576
    s_cmp_ge_u32 s53, s61
    s_cselect_b32 s53, s60, s53
    s_mov_b32 s3, 0x4000
M_tb_chk:
    v_xor_b32 v2, s0, v193
    v_xor_b32 v3, s0, v195
    v_xor_b32 v4, s0, v197
    v_xor_b32 v5, s0, v199
    v_or3_b32 v2, v2, v3, v4
    v_or_b32 v2, v2, v5
    v_cmp_ne_u32 vcc, 0, v2
    s_nop 4
    s_cbranch_vccz M_tb_ok
    s_sub_u32 s3, s3, 1
    s_cbranch_scc1 M_tb_ok
    s_sleep 1
    buffer_load_dwordx2 v[192:193], v200, s[28:31], s76 offen sc1
    buffer_load_dwordx2 v[194:195], v200, s[28:31], s77 offen sc1
    buffer_load_dwordx2 v[196:197], v200, s[28:31], s78 offen sc1
    buffer_load_dwordx2 v[198:199], v200, s[28:31], s79 offen sc1
    s_waitcnt vmcnt(0)
    s_branch M_tb_chk
M_tb_ok:
    v_add_f32 v192, v192, v194
    v_add_f32 v196, v196, v198
    v_add_f32 v192, v192, v196
    v_cvt_pk_bf16_f32 v193, v192, v192
    v_lshlrev_b32 v192, 16, v193
    s_cmp_eq_u32 s44, 2
    s_cselect_b32 s64, 1.0, 0
    v_add_f32 v192, s64, v192
    v_cvt_pk_bf16_f32 v193, v192, v192
    v_lshlrev_b32 v192, 16, v193
    s_cmp_lg_u32 s45, s46
    s_cselect_b32 s64, 0x3fb8aa3b, 1.0
    v_mul_f32 v192, s64, v192
    s_lshl_b32 s64, s44, 8
    s_add_u32 s64, s64, 149504
    v_add_u32 v2, s64, v234
    ds_write_b32 v2, v192
    s_lshl_b32 s64, s47, 12
    s_lshl_b32 s65, s48, 8
    s_add_u32 s64, s64, s65
    s_add_u32 s64, s64, 0xc0000
    s_cmp_eq_u32 s44, 3
    s_cselect_b32 s64, s64, 0x80000000
    v_add_u32 v2, s64, v234
    buffer_store_dword v192, v2, s[28:31], 0 offen sc1
    s_waitcnt lgkmcnt(0)
    s_waitcnt vmcnt(11)
    s_barrier
    s_and_b32 s57, s58, 15
    s_lshr_b64 s[58:59], s[58:59], 4
    s_lshl_b32 s56, s57, 11
    s_mul_i32 s57, s57, 0x20000
    s_add_u32 m0, s53, s70
    s_nop 0
    buffer_load_dwordx4 v210, s[32:35], s57 offen offset:0 lds
    buffer_load_dwordx4 v211, s[32:35], s57 offen offset:1024 lds
    s_mov_b32 m0, s53
    s_nop 0
    buffer_load_dwordx4 v208, s[28:31], s56 offen offset:0 lds
    buffer_load_dwordx4 v208, s[28:31], s56 offen offset:1024 lds
    buffer_load_dwordx4 v209, s[28:31], s56 offen offset:2048 lds
    buffer_load_dwordx4 v209, s[28:31], s56 offen offset:3072 lds
    s_add_u32 s53, s53, 24576
    s_cmp_ge_u32 s53, s61
    s_cselect_b32 s53, s60, s53
    s_movk_i32 s54, 1
M_P_loop2:
    s_waitcnt vmcnt(13)
    s_barrier
    s_and_b32 s57, s58, 15
    s_lshr_b64 s[58:59], s[58:59], 4
    s_lshl_b32 s56, s57, 11
    s_mul_i32 s57, s57, 0x20000
    s_add_u32 m0, s53, s70
    s_nop 0
    buffer_load_dwordx4 v210, s[32:35], s57 offen offset:0 lds
    buffer_load_dwordx4 v211, s[32:35], s57 offen offset:1024 lds
    s_mov_b32 m0, s53
    s_nop 0
    buffer_load_dwordx4 v208, s[28:31], s56 offen offset:0 lds
    buffer_load_dwordx4 v208, s[28:31], s56 offen offset:1024 lds
    buffer_load_dwordx4 v209, s[28:31], s56 offen offset:2048 lds
    buffer_load_dwordx4 v209, s[28:31], s56 offen offset:3072 lds
    s_add_u32 s53, s53, 24576
    s_cmp_ge_u32 s53, s61
    s_cselect_b32 s53, s60, s53
    s_sub_u32 s54, s54, 1
    s_cbranch_scc0 M_P_loop2
    s_movk_i32 s54, 4
M_P_loop3:
    s_waitcnt vmcnt(12)
    s_barrier
    s_and_b32 s57, s58, 15
    s_lshr_b64 s[58:59], s[58:59], 4
    s_lshl_b32 s56, s57, 11
    s_mul_i32 s57, s57, 0x20000
    s_add_u32 m0, s53, s70
    s_nop 0
    buffer_load_dwordx4 v210, s[32:35], s57 offen offset:0 lds
    buffer_load_dwordx4 v211, s[32:35], s57 offen offset:1024 lds
    s_mov_b32 m0, s53
    s_nop 0
    buffer_load_dwordx4 v208, s[28:31], s56 offen offset:0 lds
    buffer_load_dwordx4 v208, s[28:31], s56 offen offset:1024 lds
    buffer_load_dwordx4 v209, s[28:31], s56 offen offset:2048 lds
    buffer_load_dwordx4 v209, s[28:31], s56 offen offset:3072 lds
    s_add_u32 s53, s53, 24576
    s_cmp_ge_u32 s53, s61
    s_cselect_b32 s53, s60, s53
    s_sub_u32 s54, s54, 1
    s_cbranch_scc0 M_P_loop3
    s_waitcnt vmcnt(12)
    s_barrier
    s_and_b32 s57, s58, 15
    s_lshr_b64 s[58:59], s[58:59], 4
    s_lshl_b32 s56, s57, 11
    s_mul_i32 s57, s57, 0x20000
    s_add_u32 m0, s53, s70
    s_nop 0
    buffer_load_dwordx4 v210, s[32:35], s57 offen offset:0 lds
    buffer_load_dwordx4 v211, s[32:35], s57 offen offset:1024 lds
    s_mov_b32 m0, s53
    s_nop 0
    buffer_load_dwordx4 v208, s[28:31], s56 offen offset:0 lds
    buffer_load_dwordx4 v208, s[28:31], s56 offen offset:1024 lds
    buffer_load_dwordx4 v209, s[28:31], s56 offen offset:2048 lds
    buffer_load_dwordx4 v209, s[28:31], s56 offen offset:3072 lds
    s_add_u32 s53, s53, 24576
    s_cmp_ge_u32 s53, s61
    s_cselect_b32 s53, s60, s53
    s_lshl_b32 s60, s44, 12
    s_add_u32 s61, s60, 147456
    s_add_u32 s53, s60, 0
    s_bfe_u32 s66, s2, 0x30003
    s_lshr_b32 s55, s2, 6
    s_add_u32 s66, s66, s55
    s_and_b32 s66, s66, 3
    s_mov_b32 s58, 0x76453210
    s_mov_b32 s59, 0xfecdba89
    s_cmp_eq_u32 s66, 1
    s_cselect_b32 s58, 0x75643120, s58
    s_cselect_b32 s59, 0xfdecb9a8, s59
    s_cmp_eq_u32 s66, 2
    s_cselect_b32 s58, 0x67542310, s58
    s_cselect_b32 s59, 0xefdcab98, s59
    s_cmp_eq_u32 s66, 3
    s_cselect_b32 s58, 0x86534210, s58
    s_cselect_b32 s59, 0xfedbca97, s59
    s_lshl_b32 s55, s48, 2
    s_lshr_b64 s[56:57], s[58:59], s55
    s_and_b32 s55, s56, 15
    s_lshl_b32 s55, s55, 2
    s_lshl_b64 s[56:57], 15, s55
    s_andn2_b64 s[58:59], s[58:59], s[56:57]
    s_or_b32 s58, s58, s48
    s_mov_b32 s32, s12
    s_mov_b32 s33, s13
    s_mov_b32 s34, 0x700000
    s_mov_b32 s35, 0x20000
    s_mov_b32 s36, s14
    s_mov_b32 s37, s15
    s_mov_b32 s38, 0x700000
    s_mov_b32 s39, 0x20000
    s_and_b32 s57, s58, 15
    s_lshr_b64 s[58:59], s[58:59], 4
    s_lshl_b32 s56, s57, 11
    s_mul_i32 s57, s57, 0x70000
    s_add_u32 m0, s53, 16384
    s_nop 0
    buffer_load_dwordx4 v212, s[32:35], s57 offen offset:0 lds
    buffer_load_dwordx4 v213, s[32:35], s57 offen offset:1024 lds
    s_waitcnt vmcnt(14)
    s_barrier
    buffer_load_dwordx4 v214, s[32:35], s57 offen offset:2048 lds
    buffer_load_dwordx4 v215, s[32:35], s57 offen offset:3072 lds
    s_add_u32 m0, s53, 32768
    s_nop 0
    buffer_load_dwordx4 v212, s[36:39], s57 offen offset:0 lds
    s_waitcnt vmcnt(11)
    s_barrier
    buffer_load_dwordx4 v213, s[36:39], s57 offen offset:1024 lds
    buffer_load_dwordx4 v214, s[36:39], s57 offen offset:2048 lds
    buffer_load_dwordx4 v215, s[36:39], s57 offen offset:3072 lds
    s_waitcnt vmcnt(8)
    s_barrier
    s_add_u32 s53, s53, 49152
    s_cmp_ge_u32 s53, s61
    s_cselect_b32 s53, s60, s53
    s_barrier
    s_setprio 2
    s_waitcnt vmcnt(0)
    s_barrier
    ds_read_b128 v[136:139], v232 offset:0
    ds_read_b64_tr_b16 v[152:153], v235 offset:0
    ds_read_b64_tr_b16 v[154:155], v235 offset:4096
    ds_read_b64_tr_b16 v[156:157], v236 offset:0
    ds_read_b64_tr_b16 v[158:159], v236 offset:4096
    ds_read_b64_tr_b16 v[160:161], v237 offset:0
    ds_read_b64_tr_b16 v[162:163], v237 offset:4096
    ds_read_b64_tr_b16 v[164:165], v238 offset:0
    ds_read_b64_tr_b16 v[166:167], v238 offset:4096
    ds_read_b64_tr_b16 v[168:169], v235 offset:16384
    ds_read_b64_tr_b16 v[170:171], v235 offset:20480
    ds_read_b64_tr_b16 v[172:173], v236 offset:16384
    ds_read_b64_tr_b16 v[174:175], v236 offset:20480
    ds_read_b64_tr_b16 v[176:177], v237 offset:16384
    ds_read_b64_tr_b16 v[178:179], v237 offset:20480
    ds_read_b64_tr_b16 v[180:181], v238 offset:16384
    ds_read_b64_tr_b16 v[182:183], v238 offset:20480
    ds_read_b128 v[140:143], v232 offset:2048
    ds_read_b128 v[144:147], v232 offset:4096
    ds_read_b128 v[148:151], v232 offset:6144
    s_add_u32 s52, s52, 49152
    s_cmp_ge_u32 s52, 147456
    s_cselect_b32 s52, 0, s52
    s_waitcnt lgkmcnt(0)
    v_mfma_f32_16x16x32_bf16 v[8:11], v[152:155], v[136:139], 0
    ds_read_b128 v[184:187], v232 offset:1024
    v_mfma_f32_16x16x32_bf16 v[12:15], v[156:159], v[136:139], 0
    ds_read_b64_tr_b16 v[200:201], v235 offset:8192
    v_mfma_f32_16x16x32_bf16 v[16:19], v[160:163], v[136:139], 0
    ds_read_b64_tr_b16 v[202:203], v235 offset:12288
    v_mfma_f32_16x16x32_bf16 v[20:23], v[164:167], v[136:139], 0
    ds_read_b64_tr_b16 v[204:205], v236 offset:8192
    v_mfma_f32_16x16x32_bf16 v[24:27], v[168:171], v[136:139], 0
    v_mfma_f32_16x16x32_bf16 v[28:31], v[172:175], v[136:139], 0
    ds_read_b64_tr_b16 v[206:207], v236 offset:12288
    v_mfma_f32_16x16x32_bf16 v[32:35], v[176:179], v[136:139], 0
    ds_read_b64_tr_b16 v[208:209], v237 offset:8192
    v_mfma_f32_16x16x32_bf16 v[36:39], v[180:183], v[136:139], 0
    ds_read_b64_tr_b16 v[210:211], v237 offset:12288
    v_mfma_f32_16x16x32_bf16 v[40:43], v[152:155], v[140:143], 0
    ds_read_b64_tr_b16 v[212:213], v238 offset:8192
    v_mfma_f32_16x16x32_bf16 v[44:47], v[156:159], v[140:143], 0
    v_mfma_f32_16x16x32_bf16 v[48:51], v[160:163], v[140:143], 0
    ds_read_b64_tr_b16 v[214:215], v238 offset:12288
    v_mfma_f32_16x16x32_bf16 v[52:55], v[164:167], v[140:143], 0
    ds_read_b64_tr_b16 v[216:217], v235 offset:24576
    v_mfma_f32_16x16x32_bf16 v[56:59], v[168:171], v[140:143], 0
    ds_read_b64_tr_b16 v[218:219], v235 offset:28672
    v_mfma_f32_16x16x32_bf16 v[60:63], v[172:175], v[140:143], 0
    ds_read_b64_tr_b16 v[220:221], v236 offset:24576
    v_mfma_f32_16x16x32_bf16 v[64:67], v[176:179], v[140:143], 0
    v_mfma_f32_16x16x32_bf16 v[68:71], v[180:183], v[140:143], 0
    ds_read_b64_tr_b16 v[222:223], v236 offset:28672
    v_mfma_f32_16x16x32_bf16 v[72:75], v[152:155], v[144:147], 0
    ds_read_b64_tr_b16 v[224:225], v237 offset:24576
    v_mfma_f32_16x16x32_bf16 v[76:79], v[156:159], v[144:147], 0
    ds_read_b64_tr_b16 v[226:227], v237 offset:28672
    v_mfma_f32_16x16x32_bf16 v[80:83], v[160:163], v[144:147], 0
    ds_read_b64_tr_b16 v[228:229], v238 offset:24576
    v_mfma_f32_16x16x32_bf16 v[84:87], v[164:167], v[144:147], 0
    v_mfma_f32_16x16x32_bf16 v[88:91], v[168:171], v[144:147], 0
    ds_read_b64_tr_b16 v[230:231], v238 offset:28672
    v_mfma_f32_16x16x32_bf16 v[92:95], v[172:175], v[144:147], 0
    ds_read_b128 v[188:191], v232 offset:3072
    v_mfma_f32_16x16x32_bf16 v[96:99], v[176:179], v[144:147], 0
    ds_read_b128 v[192:195], v232 offset:5120
    v_mfma_f32_16x16x32_bf16 v[100:103], v[180:183], v[144:147], 0
    ds_read_b128 v[196:199], v232 offset:7168
    v_mfma_f32_16x16x32_bf16 v[104:107], v[152:155], v[148:151], 0
    v_mfma_f32_16x16x32_bf16 v[108:111], v[156:159], v[148:151], 0
    v_add_u32 v232, s52, v233
    v_mfma_f32_16x16x32_bf16 v[112:115], v[160:163], v[148:151], 0
    v_add_u32 v235, s52, v239
    v_mfma_f32_16x16x32_bf16 v[116:119], v[164:167], v[148:151], 0
    v_add_u32 v236, s52, v240
    v_mfma_f32_16x16x32_bf16 v[120:123], v[168:171], v[148:151], 0
    v_mfma_f32_16x16x32_bf16 v[124:127], v[172:175], v[148:151], 0
    v_add_u32 v237, s52, v241
    v_mfma_f32_16x16x32_bf16 v[128:131], v[176:179], v[148:151], 0
    v_add_u32 v238, s52, v242
    v_mfma_f32_16x16x32_bf16 v[132:135], v[180:183], v[148:151], 0
    s_waitcnt lgkmcnt(0)
    v_mfma_f32_16x16x32_bf16 v[8:11], v[200:203], v[184:187], v[8:11]
    v_mfma_f32_16x16x32_bf16 v[12:15], v[204:207], v[184:187], v[12:15]
    v_mfma_f32_16x16x32_bf16 v[16:19], v[208:211], v[184:187], v[16:19]
    v_mfma_f32_16x16x32_bf16 v[20:23], v[212:215], v[184:187], v[20:23]
    v_mfma_f32_16x16x32_bf16 v[24:27], v[216:219], v[184:187], v[24:27]
    v_mfma_f32_16x16x32_bf16 v[28:31], v[220:223], v[184:187], v[28:31]
    v_mfma_f32_16x16x32_bf16 v[32:35], v[224:227], v[184:187], v[32:35]
    v_mfma_f32_16x16x32_bf16 v[36:39], v[228:231], v[184:187], v[36:39]
    v_mfma_f32_16x16x32_bf16 v[40:43], v[200:203], v[188:191], v[40:43]
    v_mfma_f32_16x16x32_bf16 v[44:47], v[204:207], v[188:191], v[44:47]
    v_mfma_f32_16x16x32_bf16 v[48:51], v[208:211], v[188:191], v[48:51]
    v_mfma_f32_16x16x32_bf16 v[52:55], v[212:215], v[188:191], v[52:55]
    v_mfma_f32_16x16x32_bf16 v[56:59], v[216:219], v[188:191], v[56:59]
    v_mfma_f32_16x16x32_bf16 v[60:63], v[220:223], v[188:191], v[60:63]
    v_mfma_f32_16x16x32_bf16 v[64:67], v[224:227], v[188:191], v[64:67]
    v_mfma_f32_16x16x32_bf16 v[68:71], v[228:231], v[188:191], v[68:71]
    v_mfma_f32_16x16x32_bf16 v[72:75], v[200:203], v[192:195], v[72:75]
    v_mfma_f32_16x16x32_bf16 v[76:79], v[204:207], v[192:195], v[76:79]
    v_mfma_f32_16x16x32_bf16 v[80:83], v[208:211], v[192:195], v[80:83]
    v_mfma_f32_16x16x32_bf16 v[84:87], v[212:215], v[192:195], v[84:87]
    v_mfma_f32_16x16x32_bf16 v[88:91], v[216:219], v[192:195], v[88:91]
    v_mfma_f32_16x16x32_bf16 v[92:95], v[220:223], v[192:195], v[92:95]
    v_mfma_f32_16x16x32_bf16 v[96:99], v[224:227], v[192:195], v[96:99]
    v_mfma_f32_16x16x32_bf16 v[100:103], v[228:231], v[192:195], v[100:103]
    v_mfma_f32_16x16x32_bf16 v[104:107], v[200:203], v[196:199], v[104:107]
    v_mfma_f32_16x16x32_bf16 v[108:111], v[204:207], v[196:199], v[108:111]
    v_mfma_f32_16x16x32_bf16 v[112:115], v[208:211], v[196:199], v[112:115]
    v_mfma_f32_16x16x32_bf16 v[116:119], v[212:215], v[196:199], v[116:119]
    v_mfma_f32_16x16x32_bf16 v[120:123], v[216:219], v[196:199], v[120:123]
    v_mfma_f32_16x16x32_bf16 v[124:127], v[220:223], v[196:199], v[124:127]
    v_mfma_f32_16x16x32_bf16 v[128:131], v[224:227], v[196:199], v[128:131]
    v_mfma_f32_16x16x32_bf16 v[132:135], v[228:231], v[196:199], v[132:135]
    s_barrier
    s_barrier
    ds_read_b128 v[136:139], v232 offset:0
    ds_read_b64_tr_b16 v[152:153], v235 offset:0
    ds_read_b64_tr_b16 v[154:155], v235 offset:4096
    ds_read_b64_tr_b16 v[156:157], v236 offset:0
    ds_read_b64_tr_b16 v[158:159], v236 offset:4096
    ds_read_b64_tr_b16 v[160:161], v237 offset:0
    ds_read_b64_tr_b16 v[162:163], v237 offset:4096
    ds_read_b64_tr_b16 v[164:165], v238 offset:0
    ds_read_b64_tr_b16 v[166:167], v238 offset:4096
    ds_read_b64_tr_b16 v[168:169], v235 offset:16384
    ds_read_b64_tr_b16 v[170:171], v235 offset:20480
    ds_read_b64_tr_b16 v[172:173], v236 offset:16384
    ds_read_b64_tr_b16 v[174:175], v236 offset:20480
    ds_read_b64_tr_b16 v[176:177], v237 offset:16384
    ds_read_b64_tr_b16 v[178:179], v237 offset:20480
    ds_read_b64_tr_b16 v[180:181], v238 offset:16384
    ds_read_b64_tr_b16 v[182:183], v238 offset:20480
    ds_read_b128 v[140:143], v232 offset:2048
    ds_read_b128 v[144:147], v232 offset:4096
    ds_read_b128 v[148:151], v232 offset:6144
    s_add_u32 s52, s52, 49152
    s_cmp_ge_u32 s52, 147456
    s_cselect_b32 s52, 0, s52
    s_waitcnt lgkmcnt(0)
    v_mfma_f32_16x16x32_bf16 v[8:11], v[152:155], v[136:139], v[8:11]
    ds_read_b128 v[184:187], v232 offset:1024
    v_mfma_f32_16x16x32_bf16 v[12:15], v[156:159], v[136:139], v[12:15]
    ds_read_b64_tr_b16 v[200:201], v235 offset:8192
    v_mfma_f32_16x16x32_bf16 v[16:19], v[160:163], v[136:139], v[16:19]
    ds_read_b64_tr_b16 v[202:203], v235 offset:12288
    v_mfma_f32_16x16x32_bf16 v[20:23], v[164:167], v[136:139], v[20:23]
    ds_read_b64_tr_b16 v[204:205], v236 offset:8192
    v_mfma_f32_16x16x32_bf16 v[24:27], v[168:171], v[136:139], v[24:27]
    v_mfma_f32_16x16x32_bf16 v[28:31], v[172:175], v[136:139], v[28:31]
    ds_read_b64_tr_b16 v[206:207], v236 offset:12288
    v_mfma_f32_16x16x32_bf16 v[32:35], v[176:179], v[136:139], v[32:35]
    ds_read_b64_tr_b16 v[208:209], v237 offset:8192
    v_mfma_f32_16x16x32_bf16 v[36:39], v[180:183], v[136:139], v[36:39]
    ds_read_b64_tr_b16 v[210:211], v237 offset:12288
    v_mfma_f32_16x16x32_bf16 v[40:43], v[152:155], v[140:143], v[40:43]
    ds_read_b64_tr_b16 v[212:213], v238 offset:8192
    v_mfma_f32_16x16x32_bf16 v[44:47], v[156:159], v[140:143], v[44:47]
    v_mfma_f32_16x16x32_bf16 v[48:51], v[160:163], v[140:143], v[48:51]
    ds_read_b64_tr_b16 v[214:215], v238 offset:12288
    v_mfma_f32_16x16x32_bf16 v[52:55], v[164:167], v[140:143], v[52:55]
    ds_read_b64_tr_b16 v[216:217], v235 offset:24576
    v_mfma_f32_16x16x32_bf16 v[56:59], v[168:171], v[140:143], v[56:59]
    ds_read_b64_tr_b16 v[218:219], v235 offset:28672
    v_mfma_f32_16x16x32_bf16 v[60:63], v[172:175], v[140:143], v[60:63]
    ds_read_b64_tr_b16 v[220:221], v236 offset:24576
    v_mfma_f32_16x16x32_bf16 v[64:67], v[176:179], v[140:143], v[64:67]
    v_mfma_f32_16x16x32_bf16 v[68:71], v[180:183], v[140:143], v[68:71]
    ds_read_b64_tr_b16 v[222:223], v236 offset:28672
    v_mfma_f32_16x16x32_bf16 v[72:75], v[152:155], v[144:147], v[72:75]
    s_movk_i32 s54, 13
M_P_loop4:
    ds_read_b64_tr_b16 v[224:225], v237 offset:24576
    v_mfma_f32_16x16x32_bf16 v[76:79], v[156:159], v[144:147], v[76:79]
    ds_read_b64_tr_b16 v[226:227], v237 offset:28672
    v_mfma_f32_16x16x32_bf16 v[80:83], v[160:163], v[144:147], v[80:83]
    ds_read_b64_tr_b16 v[228:229], v238 offset:24576
    v_mfma_f32_16x16x32_bf16 v[84:87], v[164:167], v[144:147], v[84:87]
    v_mfma_f32_16x16x32_bf16 v[88:91], v[168:171], v[144:147], v[88:91]
    ds_read_b64_tr_b16 v[230:231], v238 offset:28672
    v_mfma_f32_16x16x32_bf16 v[92:95], v[172:175], v[144:147], v[92:95]
    ds_read_b128 v[188:191], v232 offset:3072
    v_mfma_f32_16x16x32_bf16 v[96:99], v[176:179], v[144:147], v[96:99]
    ds_read_b128 v[192:195], v232 offset:5120
    v_mfma_f32_16x16x32_bf16 v[100:103], v[180:183], v[144:147], v[100:103]
    ds_read_b128 v[196:199], v232 offset:7168
    v_mfma_f32_16x16x32_bf16 v[104:107], v[152:155], v[148:151], v[104:107]
    v_mfma_f32_16x16x32_bf16 v[108:111], v[156:159], v[148:151], v[108:111]
    v_add_u32 v232, s52, v233
    v_mfma_f32_16x16x32_bf16 v[112:115], v[160:163], v[148:151], v[112:115]
    v_add_u32 v235, s52, v239
    v_mfma_f32_16x16x32_bf16 v[116:119], v[164:167], v[148:151], v[116:119]
    v_add_u32 v236, s52, v240
    v_mfma_f32_16x16x32_bf16 v[120:123], v[168:171], v[148:151], v[120:123]
    v_mfma_f32_16x16x32_bf16 v[124:127], v[172:175], v[148:151], v[124:127]
    v_add_u32 v237, s52, v241
    v_mfma_f32_16x16x32_bf16 v[128:131], v[176:179], v[148:151], v[128:131]
    v_add_u32 v238, s52, v242
    v_mfma_f32_16x16x32_bf16 v[132:135], v[180:183], v[148:151], v[132:135]
    s_waitcnt lgkmcnt(0)
    v_mfma_f32_16x16x32_bf16 v[8:11], v[200:203], v[184:187], v[8:11]
    s_barrier
    v_mfma_f32_16x16x32_bf16 v[12:15], v[204:207], v[184:187], v[12:15]
    ds_read_b128 v[136:139], v232 offset:0
    v_mfma_f32_16x16x32_bf16 v[16:19], v[208:211], v[184:187], v[16:19]
    ds_read_b64_tr_b16 v[152:153], v235 offset:0
    v_mfma_f32_16x16x32_bf16 v[20:23], v[212:215], v[184:187], v[20:23]
    ds_read_b64_tr_b16 v[154:155], v235 offset:4096
    v_mfma_f32_16x16x32_bf16 v[24:27], v[216:219], v[184:187], v[24:27]
    ds_read_b64_tr_b16 v[156:157], v236 offset:0
    v_mfma_f32_16x16x32_bf16 v[28:31], v[220:223], v[184:187], v[28:31]
    ds_read_b64_tr_b16 v[158:159], v236 offset:4096
    v_mfma_f32_16x16x32_bf16 v[32:35], v[224:227], v[184:187], v[32:35]
    v_mfma_f32_16x16x32_bf16 v[36:39], v[228:231], v[184:187], v[36:39]
    ds_read_b64_tr_b16 v[160:161], v237 offset:0
    v_mfma_f32_16x16x32_bf16 v[40:43], v[200:203], v[188:191], v[40:43]
    ds_read_b64_tr_b16 v[162:163], v237 offset:4096
    v_mfma_f32_16x16x32_bf16 v[44:47], v[204:207], v[188:191], v[44:47]
    ds_read_b64_tr_b16 v[164:165], v238 offset:0
    v_mfma_f32_16x16x32_bf16 v[48:51], v[208:211], v[188:191], v[48:51]
    ds_read_b64_tr_b16 v[166:167], v238 offset:4096
    v_mfma_f32_16x16x32_bf16 v[52:55], v[212:215], v[188:191], v[52:55]
    ds_read_b64_tr_b16 v[168:169], v235 offset:16384
    v_mfma_f32_16x16x32_bf16 v[56:59], v[216:219], v[188:191], v[56:59]
    v_mfma_f32_16x16x32_bf16 v[60:63], v[220:223], v[188:191], v[60:63]
    ds_read_b64_tr_b16 v[170:171], v235 offset:20480
    v_mfma_f32_16x16x32_bf16 v[64:67], v[224:227], v[188:191], v[64:67]
    ds_read_b64_tr_b16 v[172:173], v236 offset:16384
    v_mfma_f32_16x16x32_bf16 v[68:71], v[228:231], v[188:191], v[68:71]
    ds_read_b64_tr_b16 v[174:175], v236 offset:20480
    v_mfma_f32_16x16x32_bf16 v[72:75], v[200:203], v[192:195], v[72:75]
    ds_read_b64_tr_b16 v[176:177], v237 offset:16384
    v_mfma_f32_16x16x32_bf16 v[76:79], v[204:207], v[192:195], v[76:79]
    ds_read_b64_tr_b16 v[178:179], v237 offset:20480
    v_mfma_f32_16x16x32_bf16 v[80:83], v[208:211], v[192:195], v[80:83]
    v_mfma_f32_16x16x32_bf16 v[84:87], v[212:215], v[192:195], v[84:87]
    ds_read_b64_tr_b16 v[180:181], v238 offset:16384
    v_mfma_f32_16x16x32_bf16 v[88:91], v[216:219], v[192:195], v[88:91]
    ds_read_b64_tr_b16 v[182:183], v238 offset:20480
    v_mfma_f32_16x16x32_bf16 v[92:95], v[220:223], v[192:195], v[92:95]
    ds_read_b128 v[140:143], v232 offset:2048
    v_mfma_f32_16x16x32_bf16 v[96:99], v[224:227], v[192:195], v[96:99]
    ds_read_b128 v[144:147], v232 offset:4096
    v_mfma_f32_16x16x32_bf16 v[100:103], v[228:231], v[192:195], v[100:103]
    ds_read_b128 v[148:151], v232 offset:6144
    v_mfma_f32_16x16x32_bf16 v[104:107], v[200:203], v[196:199], v[104:107]
    v_mfma_f32_16x16x32_bf16 v[108:111], v[204:207], v[196:199], v[108:111]
    v_mfma_f32_16x16x32_bf16 v[112:115], v[208:211], v[196:199], v[112:115]
    v_mfma_f32_16x16x32_bf16 v[116:119], v[212:215], v[196:199], v[116:119]
    v_mfma_f32_16x16x32_bf16 v[120:123], v[216:219], v[196:199], v[120:123]
    v_mfma_f32_16x16x32_bf16 v[124:127], v[220:223], v[196:199], v[124:127]
    v_mfma_f32_16x16x32_bf16 v[128:131], v[224:227], v[196:199], v[128:131]
    s_add_u32 s52, s52, 49152
    s_cmp_ge_u32 s52, 147456
    s_cselect_b32 s52, 0, s52
    v_mfma_f32_16x16x32_bf16 v[132:135], v[228:231], v[196:199], v[132:135]
    s_waitcnt lgkmcnt(0)
    v_mfma_f32_16x16x32_bf16 v[8:11], v[152:155], v[136:139], v[8:11]
    ds_read_b128 v[184:187], v232 offset:1024
    v_mfma_f32_16x16x32_bf16 v[12:15], v[156:159], v[136:139], v[12:15]
    ds_read_b64_tr_b16 v[200:201], v235 offset:8192
    v_mfma_f32_16x16x32_bf16 v[16:19], v[160:163], v[136:139], v[16:19]
    ds_read_b64_tr_b16 v[202:203], v235 offset:12288
    v_mfma_f32_16x16x32_bf16 v[20:23], v[164:167], v[136:139], v[20:23]
    ds_read_b64_tr_b16 v[204:205], v236 offset:8192
    v_mfma_f32_16x16x32_bf16 v[24:27], v[168:171], v[136:139], v[24:27]
    v_mfma_f32_16x16x32_bf16 v[28:31], v[172:175], v[136:139], v[28:31]
    ds_read_b64_tr_b16 v[206:207], v236 offset:12288
    v_mfma_f32_16x16x32_bf16 v[32:35], v[176:179], v[136:139], v[32:35]
    ds_read_b64_tr_b16 v[208:209], v237 offset:8192
    v_mfma_f32_16x16x32_bf16 v[36:39], v[180:183], v[136:139], v[36:39]
    ds_read_b64_tr_b16 v[210:211], v237 offset:12288
    v_mfma_f32_16x16x32_bf16 v[40:43], v[152:155], v[140:143], v[40:43]
    ds_read_b64_tr_b16 v[212:213], v238 offset:8192
    v_mfma_f32_16x16x32_bf16 v[44:47], v[156:159], v[140:143], v[44:47]
    v_mfma_f32_16x16x32_bf16 v[48:51], v[160:163], v[140:143], v[48:51]
    ds_read_b64_tr_b16 v[214:215], v238 offset:12288
    v_mfma_f32_16x16x32_bf16 v[52:55], v[164:167], v[140:143], v[52:55]
    ds_read_b64_tr_b16 v[216:217], v235 offset:24576
    v_mfma_f32_16x16x32_bf16 v[56:59], v[168:171], v[140:143], v[56:59]
    ds_read_b64_tr_b16 v[218:219], v235 offset:28672
    v_mfma_f32_16x16x32_bf16 v[60:63], v[172:175], v[140:143], v[60:63]
    ds_read_b64_tr_b16 v[220:221], v236 offset:24576
    v_mfma_f32_16x16x32_bf16 v[64:67], v[176:179], v[140:143], v[64:67]
    v_mfma_f32_16x16x32_bf16 v[68:71], v[180:183], v[140:143], v[68:71]
    s_sub_u32 s54, s54, 1
    ds_read_b64_tr_b16 v[222:223], v236 offset:28672
    v_mfma_f32_16x16x32_bf16 v[72:75], v[152:155], v[144:147], v[72:75]
    s_cbranch_scc0 M_P_loop4
    ds_read_b64_tr_b16 v[224:225], v237 offset:24576
    v_mfma_f32_16x16x32_bf16 v[76:79], v[156:159], v[144:147], v[76:79]
    ds_read_b64_tr_b16 v[226:227], v237 offset:28672
    v_mfma_f32_16x16x32_bf16 v[80:83], v[160:163], v[144:147], v[80:83]
    ds_read_b64_tr_b16 v[228:229], v238 offset:24576
    v_mfma_f32_16x16x32_bf16 v[84:87], v[164:167], v[144:147], v[84:87]
    v_mfma_f32_16x16x32_bf16 v[88:91], v[168:171], v[144:147], v[88:91]
    ds_read_b64_tr_b16 v[230:231], v238 offset:28672
    v_mfma_f32_16x16x32_bf16 v[92:95], v[172:175], v[144:147], v[92:95]
    ds_read_b128 v[188:191], v232 offset:3072
    v_mfma_f32_16x16x32_bf16 v[96:99], v[176:179], v[144:147], v[96:99]
    ds_read_b128 v[192:195], v232 offset:5120
    v_mfma_f32_16x16x32_bf16 v[100:103], v[180:183], v[144:147], v[100:103]
    ds_read_b128 v[196:199], v232 offset:7168
    v_mfma_f32_16x16x32_bf16 v[104:107], v[152:155], v[148:151], v[104:107]
    v_mfma_f32_16x16x32_bf16 v[108:111], v[156:159], v[148:151], v[108:111]
    v_mfma_f32_16x16x32_bf16 v[112:115], v[160:163], v[148:151], v[112:115]
    v_mfma_f32_16x16x32_bf16 v[116:119], v[164:167], v[148:151], v[116:119]
    v_mfma_f32_16x16x32_bf16 v[120:123], v[168:171], v[148:151], v[120:123]
    v_mfma_f32_16x16x32_bf16 v[124:127], v[172:175], v[148:151], v[124:127]
    v_mfma_f32_16x16x32_bf16 v[128:131], v[176:179], v[148:151], v[128:131]
    v_mfma_f32_16x16x32_bf16 v[132:135], v[180:183], v[148:151], v[132:135]
    s_waitcnt lgkmcnt(0)
    v_mfma_f32_16x16x32_bf16 v[8:11], v[200:203], v[184:187], v[8:11]
    s_barrier
    v_mfma_f32_16x16x32_bf16 v[12:15], v[204:207], v[184:187], v[12:15]
    v_mfma_f32_16x16x32_bf16 v[16:19], v[208:211], v[184:187], v[16:19]
    v_mfma_f32_16x16x32_bf16 v[20:23], v[212:215], v[184:187], v[20:23]
    v_mfma_f32_16x16x32_bf16 v[24:27], v[216:219], v[184:187], v[24:27]
    v_mfma_f32_16x16x32_bf16 v[28:31], v[220:223], v[184:187], v[28:31]
    v_mfma_f32_16x16x32_bf16 v[32:35], v[224:227], v[184:187], v[32:35]
    v_mfma_f32_16x16x32_bf16 v[36:39], v[228:231], v[184:187], v[36:39]
    v_mfma_f32_16x16x32_bf16 v[40:43], v[200:203], v[188:191], v[40:43]
    v_mfma_f32_16x16x32_bf16 v[44:47], v[204:207], v[188:191], v[44:47]
    v_mfma_f32_16x16x32_bf16 v[48:51], v[208:211], v[188:191], v[48:51]
    v_mfma_f32_16x16x32_bf16 v[52:55], v[212:215], v[188:191], v[52:55]
    v_mfma_f32_16x16x32_bf16 v[56:59], v[216:219], v[188:191], v[56:59]
    v_mfma_f32_16x16x32_bf16 v[60:63], v[220:223], v[188:191], v[60:63]
    v_mfma_f32_16x16x32_bf16 v[64:67], v[224:227], v[188:191], v[64:67]
    v_mfma_f32_16x16x32_bf16 v[68:71], v[228:231], v[188:191], v[68:71]
    v_mfma_f32_16x16x32_bf16 v[72:75], v[200:203], v[192:195], v[72:75]
    v_mfma_f32_16x16x32_bf16 v[76:79], v[204:207], v[192:195], v[76:79]
    v_mfma_f32_16x16x32_bf16 v[80:83], v[208:211], v[192:195], v[80:83]
    v_mfma_f32_16x16x32_bf16 v[84:87], v[212:215], v[192:195], v[84:87]
    v_mfma_f32_16x16x32_bf16 v[88:91], v[216:219], v[192:195], v[88:91]
    v_mfma_f32_16x16x32_bf16 v[92:95], v[220:223], v[192:195], v[92:95]
    v_mfma_f32_16x16x32_bf16 v[96:99], v[224:227], v[192:195], v[96:99]
    v_mfma_f32_16x16x32_bf16 v[100:103], v[228:231], v[192:195], v[100:103]
    v_mfma_f32_16x16x32_bf16 v[104:107], v[200:203], v[196:199], v[104:107]
    v_mfma_f32_16x16x32_bf16 v[108:111], v[204:207], v[196:199], v[108:111]
    v_mfma_f32_16x16x32_bf16 v[112:115], v[208:211], v[196:199], v[112:115]
    v_mfma_f32_16x16x32_bf16 v[116:119], v[212:215], v[196:199], v[116:119]
    v_mfma_f32_16x16x32_bf16 v[120:123], v[216:219], v[196:199], v[120:123]
    v_mfma_f32_16x16x32_bf16 v[124:127], v[220:223], v[196:199], v[124:127]
    v_mfma_f32_16x16x32_bf16 v[128:131], v[224:227], v[196:199], v[128:131]
    v_mfma_f32_16x16x32_bf16 v[132:135], v[228:231], v[196:199], v[132:135]
    s_setprio 0
    s_cmp_lg_u32 s69, 0
    s_cbranch_scc1 M_Pidle
    s_lshl_b32 s64, s47, 3
    s_lshl_b32 s65, s44, 1
    s_add_u32 s64, s64, s65
    s_mul_i32 s64, s64, 32768
    s_add_u32 s64, s64, 0x1000000
    v_lshl_add_u32 v184, v1, 4, s64
    v_add_u32 v185, 30720, v184
    s_lshr_b32 s65, s48, 2
    s_sub_u32 s65, s48, s65
    s_add_u32 s65, s65, 16
    s_lshl_b32 s65, s65, 8
    s_or_b32 s65, s65, s69
    v_lshrrev_b32 v3, 4, v1
    s_lshl_b32 s64, s44, 4
    v_add_u32 v2, s64, v3
    s_movk_i32 s64, 7168
    v_mul_u32_u24 v2, s64, v2
    v_add_u32 v2, s65, v2
    v_lshlrev_b32 v3, 1, v3
    v_and_b32 v4, 15, v1
    v_xor_b32 v3, v3, v4
    v_lshl_add_u32 v188, v3, 4, v2
    v_add_u32 v190, 55296, v188
    v_xor_b32 v3, 8, v3
    v_lshl_add_u32 v189, v3, 4, v2
    v_add_u32 v189, 27648, v189
    v_add_u32 v191, 55296, v189
    s_lshl_b32 s60, s44, 12
    s_add_u32 s61, s60, 147456
    s_add_u32 s53, s60, 49152
    s_bfe_u32 s66, s2, 0x30003
    s_lshr_b32 s55, s2, 6
    s_add_u32 s66, s66, s55
    s_mul_i32 s55, s66, 11
    s_lshr_b32 s55, s55, 5
    s_mul_i32 s55, s55, 3
    s_sub_u32 s66, s66, s55
    s_mov_b32 s58, 0x9a867534
    s_mov_b32 s59, 0xfecdb
    s_cmp_eq_u32 s66, 1
    s_cselect_b32 s58, 0xb9786453, s58
    s_cselect_b32 s59, 0xfdeca, s59
    s_cmp_eq_u32 s66, 2
    s_cselect_b32 s58, 0xa8975642, s58
    s_cselect_b32 s59, 0xefdbc, s59
    s_mov_b32 s32, s12
    s_mov_b32 s33, s13
    s_mov_b32 s34, 0x700000
    s_mov_b32 s35, 0x20000
    s_mov_b32 s36, s14
    s_mov_b32 s37, s15
    s_mov_b32 s38, 0x700000
    s_mov_b32 s39, 0x20000
    s_lshl_b32 s70, s48, 12
    s_lshl_b32 s64, s47, 3
    s_lshl_b32 s65, s45, 2
    s_add_u32 s64, s64, s65
    s_mul_i32 s64, s64, 114688
    s_add_u32 s64, s64, s70
    s_lshl_b32 s65, s46, 11
    s_add_u32 s64, s64, s65
    s_add_u32 s64, s64, 0x1500000
    v_lshl_add_u32 v198, v1, 4, s64
    v_mul_f32 v24, v8, v24
    v_exp_f32 v216, -v8
    v_mul_f32 v25, v9, v25
    v_exp_f32 v217, -v9
    v_mul_f32 v26, v10, v26
    v_exp_f32 v218, -v10
    v_mul_f32 v27, v11, v27
    v_exp_f32 v219, -v11
    v_mul_f32 v28, v12, v28
    v_exp_f32 v220, -v12
    v_mul_f32 v29, v13, v29
    v_exp_f32 v221, -v13
    v_mul_f32 v30, v14, v30
    v_exp_f32 v222, -v14
    v_mul_f32 v31, v15, v31
    v_exp_f32 v223, -v15
    s_barrier
    s_and_b32 s57, s58, 15
    s_lshr_b64 s[58:59], s[58:59], 4
    s_lshl_b32 s56, s57, 11
    s_mul_i32 s57, s57, 0x70000
    s_add_u32 m0, s53, 16384
    s_nop 0
    buffer_load_dwordx4 v188, s[32:35], s57 offen offset:0 lds
    v_fma_f32 v216, v216, s67, s67
    v_fma_f32 v217, v217, s67, s67
    v_rcp_f32 v216, v216
    v_fma_f32 v218, v218, s67, s67
    buffer_load_dwordx4 v189, s[32:35], s57 offen offset:1024 lds
    v_rcp_f32 v217, v217
    v_fma_f32 v219, v219, s67, s67
    v_rcp_f32 v218, v218
    v_fma_f32 v220, v220, s67, s67
    buffer_load_dwordx4 v190, s[32:35], s57 offen offset:2048 lds
    v_rcp_f32 v219, v219
    v_fma_f32 v221, v221, s67, s67
    v_rcp_f32 v220, v220
    v_fma_f32 v222, v222, s67, s67
    buffer_load_dwordx4 v191, s[32:35], s57 offen offset:3072 lds
    v_rcp_f32 v221, v221
    v_fma_f32 v223, v223, s67, s67
    v_rcp_f32 v222, v222
    v_rcp_f32 v223, v223
    s_add_u32 m0, s53, 32768
    s_nop 0
    buffer_load_dwordx4 v188, s[36:39], s57 offen offset:0 lds
    v_mul_f32 v24, v24, v216
    v_mul_f32 v25, v25, v217
    v_mul_f32 v26, v26, v218
    v_mul_f32 v27, v27, v219
    buffer_load_dwordx4 v189, s[36:39], s57 offen offset:1024 lds
    v_mul_f32 v28, v28, v220
    v_mul_f32 v29, v29, v221
    v_mul_f32 v30, v30, v222
    v_mul_f32 v31, v31, v223
    buffer_load_dwordx4 v190, s[36:39], s57 offen offset:2048 lds
    v_cvt_pk_bf16_f32 v200, v24, v25
    v_cvt_pk_bf16_f32 v201, v26, v27
    v_cvt_pk_bf16_f32 v202, v28, v29
    v_cvt_pk_bf16_f32 v203, v30, v31
    buffer_load_dwordx4 v191, s[36:39], s57 offen offset:3072 lds
    v_mul_f32 v32, v16, v32
    v_exp_f32 v224, -v16
    v_mul_f32 v33, v17, v33
    s_mov_b32 m0, s53
    s_nop 0
    buffer_load_dwordx4 v184, s[28:31], s56 offen offset:0 lds
    v_exp_f32 v225, -v17
    v_mul_f32 v34, v18, v34
    v_exp_f32 v226, -v18
    v_mul_f32 v35, v19, v35
    buffer_load_dwordx4 v184, s[28:31], s56 offen offset:1024 lds
    v_exp_f32 v227, -v19
    v_mul_f32 v36, v20, v36
    v_exp_f32 v228, -v20
    v_mul_f32 v37, v21, v37
    buffer_load_dwordx4 v185, s[28:31], s56 offen offset:2048 lds
    v_exp_f32 v229, -v21
    v_mul_f32 v38, v22, v38
    v_exp_f32 v230, -v22
    v_mul_f32 v39, v23, v39
    buffer_load_dwordx4 v185, s[28:31], s56 offen offset:3072 lds
    v_exp_f32 v231, -v23
    v_fma_f32 v224, v224, s67, s67
    v_fma_f32 v225, v225, s67, s67
    v_rcp_f32 v224, v224
    s_add_u32 s53, s53, 49152
    s_cmp_ge_u32 s53, s61
    s_cselect_b32 s53, s60, s53
    buffer_store_dwordx4 v[200:203], v198, s[28:31], 0 offen offset:0 sc1
    s_barrier
    s_and_b32 s57, s58, 15
    s_lshr_b64 s[58:59], s[58:59], 4
    s_lshl_b32 s56, s57, 11
    s_mul_i32 s57, s57, 0x70000
    s_add_u32 m0, s53, 16384
    s_nop 0
    buffer_load_dwordx4 v188, s[32:35], s57 offen offset:0 lds
    v_fma_f32 v226, v226, s67, s67
    v_rcp_f32 v225, v225
    v_fma_f32 v227, v227, s67, s67
    v_rcp_f32 v226, v226
    buffer_load_dwordx4 v189, s[32:35], s57 offen offset:1024 lds
    v_fma_f32 v228, v228, s67, s67
    v_rcp_f32 v227, v227
    v_fma_f32 v229, v229, s67, s67
    v_rcp_f32 v228, v228
    buffer_load_dwordx4 v190, s[32:35], s57 offen offset:2048 lds
    v_fma_f32 v230, v230, s67, s67
    v_rcp_f32 v229, v229
    v_fma_f32 v231, v231, s67, s67
    v_rcp_f32 v230, v230
    buffer_load_dwordx4 v191, s[32:35], s57 offen offset:3072 lds
    v_rcp_f32 v231, v231
    v_mul_f32 v32, v32, v224
    v_mul_f32 v33, v33, v225
    v_mul_f32 v34, v34, v226
    s_add_u32 m0, s53, 32768
    s_nop 0
    buffer_load_dwordx4 v188, s[36:39], s57 offen offset:0 lds
    v_mul_f32 v35, v35, v227
    v_mul_f32 v36, v36, v228
    v_mul_f32 v37, v37, v229
    v_mul_f32 v38, v38, v230
    buffer_load_dwordx4 v189, s[36:39], s57 offen offset:1024 lds
    v_mul_f32 v39, v39, v231
    v_cvt_pk_bf16_f32 v204, v32, v33
    v_cvt_pk_bf16_f32 v205, v34, v35
    v_cvt_pk_bf16_f32 v206, v36, v37
    buffer_load_dwordx4 v190, s[36:39], s57 offen offset:2048 lds
    v_cvt_pk_bf16_f32 v207, v38, v39
    v_mul_f32 v56, v40, v56
    buffer_load_dwordx4 v191, s[36:39], s57 offen offset:3072 lds
    v_exp_f32 v216, -v40
    v_mul_f32 v57, v41, v57
    v_exp_f32 v217, -v41
    v_mul_f32 v58, v42, v58
    s_mov_b32 m0, s53
    s_nop 0
    buffer_load_dwordx4 v184, s[28:31], s56 offen offset:0 lds
    v_exp_f32 v218, -v42
    v_mul_f32 v59, v43, v59
    v_exp_f32 v219, -v43
    v_mul_f32 v60, v44, v60
    buffer_load_dwordx4 v184, s[28:31], s56 offen offset:1024 lds
    v_exp_f32 v220, -v44
    v_mul_f32 v61, v45, v61
    v_exp_f32 v221, -v45
    v_mul_f32 v62, v46, v62
    buffer_load_dwordx4 v185, s[28:31], s56 offen offset:2048 lds
    v_exp_f32 v222, -v46
    v_mul_f32 v63, v47, v63
    v_exp_f32 v223, -v47
    v_fma_f32 v216, v216, s67, s67
    buffer_load_dwordx4 v185, s[28:31], s56 offen offset:3072 lds
    v_fma_f32 v217, v217, s67, s67
    v_rcp_f32 v216, v216
    v_fma_f32 v218, v218, s67, s67
    v_rcp_f32 v217, v217
    s_add_u32 s53, s53, 49152
    s_cmp_ge_u32 s53, s61
    s_cselect_b32 s53, s60, s53
    buffer_store_dwordx4 v[204:207], v198, s[28:31], 0 offen offset:1024 sc1
    v_add_u32 v198, 114688, v198
    s_waitcnt vmcnt(14)
    s_barrier
    s_and_b32 s57, s58, 15
    s_lshr_b64 s[58:59], s[58:59], 4
    s_lshl_b32 s56, s57, 11
    s_mul_i32 s57, s57, 0x70000
    s_add_u32 m0, s53, 16384
    s_nop 0
    buffer_load_dwordx4 v188, s[32:35], s57 offen offset:0 lds
    v_fma_f32 v219, v219, s67, s67
    v_rcp_f32 v218, v218
    v_fma_f32 v220, v220, s67, s67
    v_rcp_f32 v219, v219
    buffer_load_dwordx4 v189, s[32:35], s57 offen offset:1024 lds
    v_fma_f32 v221, v221, s67, s67
    v_rcp_f32 v220, v220
    v_fma_f32 v222, v222, s67, s67
    v_rcp_f32 v221, v221
    buffer_load_dwordx4 v190, s[32:35], s57 offen offset:2048 lds
    v_fma_f32 v223, v223, s67, s67
    v_rcp_f32 v222, v222
    v_rcp_f32 v223, v223
    v_mul_f32 v56, v56, v216
    buffer_load_dwordx4 v191, s[32:35], s57 offen offset:3072 lds
    v_mul_f32 v57, v57, v217
    v_mul_f32 v58, v58, v218
    v_mul_f32 v59, v59, v219
    v_mul_f32 v60, v60, v220
    s_add_u32 m0, s53, 32768
    s_nop 0
    buffer_load_dwordx4 v188, s[36:39], s57 offen offset:0 lds
    v_mul_f32 v61, v61, v221
    v_mul_f32 v62, v62, v222
    v_mul_f32 v63, v63, v223
    v_cvt_pk_bf16_f32 v208, v56, v57
    buffer_load_dwordx4 v189, s[36:39], s57 offen offset:1024 lds
    v_cvt_pk_bf16_f32 v209, v58, v59
    v_cvt_pk_bf16_f32 v210, v60, v61
    v_cvt_pk_bf16_f32 v211, v62, v63
    buffer_load_dwordx4 v190, s[36:39], s57 offen offset:2048 lds
    v_mul_f32 v64, v48, v64
    v_exp_f32 v224, -v48
    v_mul_f32 v65, v49, v65
    v_exp_f32 v225, -v49
    buffer_load_dwordx4 v191, s[36:39], s57 offen offset:3072 lds
    v_mul_f32 v66, v50, v66
    v_exp_f32 v226, -v50
    v_mul_f32 v67, v51, v67
    v_exp_f32 v227, -v51
    s_mov_b32 m0, s53
    s_nop 0
    buffer_load_dwordx4 v184, s[28:31], s56 offen offset:0 lds
    v_mul_f32 v68, v52, v68
    v_exp_f32 v228, -v52
    v_mul_f32 v69, v53, v69
    v_exp_f32 v229, -v53
    buffer_load_dwordx4 v184, s[28:31], s56 offen offset:1024 lds
    v_mul_f32 v70, v54, v70
    v_exp_f32 v230, -v54
    v_mul_f32 v71, v55, v71
    v_exp_f32 v231, -v55
    buffer_load_dwordx4 v185, s[28:31], s56 offen offset:2048 lds
    v_fma_f32 v224, v224, s67, s67
    v_fma_f32 v225, v225, s67, s67
    v_rcp_f32 v224, v224
    v_fma_f32 v226, v226, s67, s67
    buffer_load_dwordx4 v185, s[28:31], s56 offen offset:3072 lds
    v_rcp_f32 v225, v225
    v_fma_f32 v227, v227, s67, s67
    v_rcp_f32 v226, v226
    v_fma_f32 v228, v228, s67, s67
    s_add_u32 s53, s53, 49152
    s_cmp_ge_u32 s53, s61
    s_cselect_b32 s53, s60, s53
    buffer_store_dwordx4 v[208:211], v198, s[28:31], 0 offen offset:0 sc1
    s_waitcnt vmcnt(14)
    s_barrier
    s_and_b32 s57, s58, 15
    s_lshr_b64 s[58:59], s[58:59], 4
    s_lshl_b32 s56, s57, 11
    s_mul_i32 s57, s57, 0x70000
    s_add_u32 m0, s53, 16384
    s_nop 0
    buffer_load_dwordx4 v188, s[32:35], s57 offen offset:0 lds
    v_rcp_f32 v227, v227
    v_fma_f32 v229, v229, s67, s67
    v_rcp_f32 v228, v228
    v_fma_f32 v230, v230, s67, s67
    buffer_load_dwordx4 v189, s[32:35], s57 offen offset:1024 lds
    v_rcp_f32 v229, v229
    v_fma_f32 v231, v231, s67, s67
    v_rcp_f32 v230, v230
    v_rcp_f32 v231, v231
    buffer_load_dwordx4 v190, s[32:35], s57 offen offset:2048 lds
    v_mul_f32 v64, v64, v224
    v_mul_f32 v65, v65, v225
    v_mul_f32 v66, v66, v226
    v_mul_f32 v67, v67, v227
    buffer_load_dwordx4 v191, s[32:35], s57 offen offset:3072 lds
    v_mul_f32 v68, v68, v228
    v_mul_f32 v69, v69, v229
    v_mul_f32 v70, v70, v230
    v_mul_f32 v71, v71, v231
    s_add_u32 m0, s53, 32768
    s_nop 0
    buffer_load_dwordx4 v188, s[36:39], s57 offen offset:0 lds
    v_cvt_pk_bf16_f32 v212, v64, v65
    v_cvt_pk_bf16_f32 v213, v66, v67
    v_cvt_pk_bf16_f32 v214, v68, v69
    v_cvt_pk_bf16_f32 v215, v70, v71
    buffer_load_dwordx4 v189, s[36:39], s57 offen offset:1024 lds
    v_mul_f32 v88, v72, v88
    v_exp_f32 v216, -v72
    buffer_load_dwordx4 v190, s[36:39], s57 offen offset:2048 lds
    v_mul_f32 v89, v73, v89
    v_exp_f32 v217, -v73
    v_mul_f32 v90, v74, v90
    v_exp_f32 v218, -v74
    buffer_load_dwordx4 v191, s[36:39], s57 offen offset:3072 lds
    v_mul_f32 v91, v75, v91
    v_exp_f32 v219, -v75
    v_mul_f32 v92, v76, v92
    v_exp_f32 v220, -v76
    s_mov_b32 m0, s53
    s_nop 0
    buffer_load_dwordx4 v184, s[28:31], s56 offen offset:0 lds
    v_mul_f32 v93, v77, v93
    v_exp_f32 v221, -v77
    v_mul_f32 v94, v78, v94
    v_exp_f32 v222, -v78
    buffer_load_dwordx4 v184, s[28:31], s56 offen offset:1024 lds
    v_mul_f32 v95, v79, v95
    v_exp_f32 v223, -v79
    v_fma_f32 v216, v216, s67, s67
    v_fma_f32 v217, v217, s67, s67
    buffer_load_dwordx4 v185, s[28:31], s56 offen offset:2048 lds
    v_rcp_f32 v216, v216
    v_fma_f32 v218, v218, s67, s67
    v_rcp_f32 v217, v217
    v_fma_f32 v219, v219, s67, s67
    buffer_load_dwordx4 v185, s[28:31], s56 offen offset:3072 lds
    v_rcp_f32 v218, v218
    v_fma_f32 v220, v220, s67, s67
    v_rcp_f32 v219, v219
    v_fma_f32 v221, v221, s67, s67
    s_add_u32 s53, s53, 49152
    s_cmp_ge_u32 s53, s61
    s_cselect_b32 s53, s60, s53
    buffer_store_dwordx4 v[212:215], v198, s[28:31], 0 offen offset:1024 sc1
    v_add_u32 v198, 114688, v198
    s_waitcnt vmcnt(14)
    s_barrier
    s_and_b32 s57, s58, 15
    s_lshr_b64 s[58:59], s[58:59], 4
    s_lshl_b32 s56, s57, 11
    s_mul_i32 s57, s57, 0x70000
    s_add_u32 m0, s53, 16384
    s_nop 0
    buffer_load_dwordx4 v188, s[32:35], s57 offen offset:0 lds
    v_rcp_f32 v220, v220
    v_fma_f32 v222, v222, s67, s67
    v_rcp_f32 v221, v221
    v_fma_f32 v223, v223, s67, s67
    buffer_load_dwordx4 v189, s[32:35], s57 offen offset:1024 lds
    v_rcp_f32 v222, v222
    v_rcp_f32 v223, v223
    v_mul_f32 v88, v88, v216
    v_mul_f32 v89, v89, v217
    buffer_load_dwordx4 v190, s[32:35], s57 offen offset:2048 lds
    v_mul_f32 v90, v90, v218
    v_mul_f32 v91, v91, v219
    v_mul_f32 v92, v92, v220
    v_mul_f32 v93, v93, v221
    buffer_load_dwordx4 v191, s[32:35], s57 offen offset:3072 lds
    v_mul_f32 v94, v94, v222
    v_mul_f32 v95, v95, v223
    v_cvt_pk_bf16_f32 v200, v88, v89
    v_cvt_pk_bf16_f32 v201, v90, v91
    s_add_u32 m0, s53, 32768
    s_nop 0
    buffer_load_dwordx4 v188, s[36:39], s57 offen offset:0 lds
    v_cvt_pk_bf16_f32 v202, v92, v93
    v_cvt_pk_bf16_f32 v203, v94, v95
    v_mul_f32 v96, v80, v96
    buffer_load_dwordx4 v189, s[36:39], s57 offen offset:1024 lds
    v_exp_f32 v224, -v80
    v_mul_f32 v97, v81, v97
    v_exp_f32 v225, -v81
    v_mul_f32 v98, v82, v98
    buffer_load_dwordx4 v190, s[36:39], s57 offen offset:2048 lds
    v_exp_f32 v226, -v82
    v_mul_f32 v99, v83, v99
    v_exp_f32 v227, -v83
    v_mul_f32 v100, v84, v100
    buffer_load_dwordx4 v191, s[36:39], s57 offen offset:3072 lds
    v_exp_f32 v228, -v84
    v_mul_f32 v101, v85, v101
    v_exp_f32 v229, -v85
    v_mul_f32 v102, v86, v102
    s_mov_b32 m0, s53
    s_nop 0
    buffer_load_dwordx4 v184, s[28:31], s56 offen offset:0 lds
    v_exp_f32 v230, -v86
    v_mul_f32 v103, v87, v103
    v_exp_f32 v231, -v87
    v_fma_f32 v224, v224, s67, s67
    buffer_load_dwordx4 v184, s[28:31], s56 offen offset:1024 lds
    v_fma_f32 v225, v225, s67, s67
    v_rcp_f32 v224, v224
    v_fma_f32 v226, v226, s67, s67
    v_rcp_f32 v225, v225
    buffer_load_dwordx4 v185, s[28:31], s56 offen offset:2048 lds
    v_fma_f32 v227, v227, s67, s67
    v_rcp_f32 v226, v226
    v_fma_f32 v228, v228, s67, s67
    v_rcp_f32 v227, v227
    buffer_load_dwordx4 v185, s[28:31], s56 offen offset:3072 lds
    v_fma_f32 v229, v229, s67, s67
    v_rcp_f32 v228, v228
    v_fma_f32 v230, v230, s67, s67
    v_rcp_f32 v229, v229
    s_add_u32 s53, s53, 49152
    s_cmp_ge_u32 s53, s61
    s_cselect_b32 s53, s60, s53
    buffer_store_dwordx4 v[200:203], v198, s[28:31], 0 offen offset:0 sc1
    s_waitcnt vmcnt(14)
    s_barrier
    s_and_b32 s57, s58, 15
    s_lshr_b64 s[58:59], s[58:59], 4
    s_lshl_b32 s56, s57, 11
    s_mul_i32 s57, s57, 0x70000
    s_add_u32 m0, s53, 16384
    s_nop 0
    buffer_load_dwordx4 v188, s[32:35], s57 offen offset:0 lds
    v_fma_f32 v231, v231, s67, s67
    v_rcp_f32 v230, v230
    v_rcp_f32 v231, v231
    v_mul_f32 v96, v96, v224
    buffer_load_dwordx4 v189, s[32:35], s57 offen offset:1024 lds
    v_mul_f32 v97, v97, v225
    v_mul_f32 v98, v98, v226
    v_mul_f32 v99, v99, v227
    v_mul_f32 v100, v100, v228
    buffer_load_dwordx4 v190, s[32:35], s57 offen offset:2048 lds
    v_mul_f32 v101, v101, v229
    v_mul_f32 v102, v102, v230
    v_mul_f32 v103, v103, v231
    v_cvt_pk_bf16_f32 v204, v96, v97
    buffer_load_dwordx4 v191, s[32:35], s57 offen offset:3072 lds
    v_cvt_pk_bf16_f32 v205, v98, v99
    v_cvt_pk_bf16_f32 v206, v100, v101
    v_cvt_pk_bf16_f32 v207, v102, v103
    s_add_u32 m0, s53, 32768
    s_nop 0
    buffer_load_dwordx4 v188, s[36:39], s57 offen offset:0 lds
    v_mul_f32 v120, v104, v120
    v_exp_f32 v216, -v104
    v_mul_f32 v121, v105, v121
    buffer_load_dwordx4 v189, s[36:39], s57 offen offset:1024 lds
    v_exp_f32 v217, -v105
    v_mul_f32 v122, v106, v122
    v_exp_f32 v218, -v106
    v_mul_f32 v123, v107, v123
    buffer_load_dwordx4 v190, s[36:39], s57 offen offset:2048 lds
    v_exp_f32 v219, -v107
    v_mul_f32 v124, v108, v124
    v_exp_f32 v220, -v108
    v_mul_f32 v125, v109, v125
    buffer_load_dwordx4 v191, s[36:39], s57 offen offset:3072 lds
    v_exp_f32 v221, -v109
    v_mul_f32 v126, v110, v126
    v_exp_f32 v222, -v110
    v_mul_f32 v127, v111, v127
    s_mov_b32 m0, s53
    s_nop 0
    buffer_load_dwordx4 v184, s[28:31], s56 offen offset:0 lds
    v_exp_f32 v223, -v111
    v_fma_f32 v216, v216, s67, s67
    v_fma_f32 v217, v217, s67, s67
    v_rcp_f32 v216, v216
    buffer_load_dwordx4 v184, s[28:31], s56 offen offset:1024 lds
    v_fma_f32 v218, v218, s67, s67
    v_rcp_f32 v217, v217
    v_fma_f32 v219, v219, s67, s67
    v_rcp_f32 v218, v218
    buffer_load_dwordx4 v185, s[28:31], s56 offen offset:2048 lds
    v_fma_f32 v220, v220, s67, s67
    v_rcp_f32 v219, v219
    v_fma_f32 v221, v221, s67, s67
    v_rcp_f32 v220, v220
    buffer_load_dwordx4 v185, s[28:31], s56 offen offset:3072 lds
    v_fma_f32 v222, v222, s67, s67
    v_rcp_f32 v221, v221
    v_fma_f32 v223, v223, s67, s67
    v_rcp_f32 v222, v222
    s_add_u32 s53, s53, 49152
    s_cmp_ge_u32 s53, s61
    s_cselect_b32 s53, s60, s53
    buffer_store_dwordx4 v[204:207], v198, s[28:31], 0 offen offset:1024 sc1
    v_add_u32 v198, 114688, v198
    s_waitcnt vmcnt(14)
    s_barrier
    s_and_b32 s57, s58, 15
    s_lshr_b64 s[58:59], s[58:59], 4
    s_lshl_b32 s56, s57, 11
    s_mul_i32 s57, s57, 0x70000
    s_add_u32 m0, s53, 16384
    s_nop 0
    buffer_load_dwordx4 v188, s[32:35], s57 offen offset:0 lds
    v_rcp_f32 v223, v223
    v_mul_f32 v120, v120, v216
    v_mul_f32 v121, v121, v217
    v_mul_f32 v122, v122, v218
    buffer_load_dwordx4 v189, s[32:35], s57 offen offset:1024 lds
    v_mul_f32 v123, v123, v219
    v_mul_f32 v124, v124, v220
    v_mul_f32 v125, v125, v221
    v_mul_f32 v126, v126, v222
    buffer_load_dwordx4 v190, s[32:35], s57 offen offset:2048 lds
    v_mul_f32 v127, v127, v223
    v_cvt_pk_bf16_f32 v208, v120, v121
    v_cvt_pk_bf16_f32 v209, v122, v123
    v_cvt_pk_bf16_f32 v210, v124, v125
    buffer_load_dwordx4 v191, s[32:35], s57 offen offset:3072 lds
    v_cvt_pk_bf16_f32 v211, v126, v127
    v_mul_f32 v128, v112, v128
    v_exp_f32 v224, -v112
    s_add_u32 m0, s53, 32768
    s_nop 0
    buffer_load_dwordx4 v188, s[36:39], s57 offen offset:0 lds
    v_mul_f32 v129, v113, v129
    v_exp_f32 v225, -v113
    v_mul_f32 v130, v114, v130
    v_exp_f32 v226, -v114
    buffer_load_dwordx4 v189, s[36:39], s57 offen offset:1024 lds
    v_mul_f32 v131, v115, v131
    v_exp_f32 v227, -v115
    v_mul_f32 v132, v116, v132
    v_exp_f32 v228, -v116
    buffer_load_dwordx4 v190, s[36:39], s57 offen offset:2048 lds
    v_mul_f32 v133, v117, v133
    v_exp_f32 v229, -v117
    v_mul_f32 v134, v118, v134
    v_exp_f32 v230, -v118
    buffer_load_dwordx4 v191, s[36:39], s57 offen offset:3072 lds
    v_mul_f32 v135, v119, v135
    v_exp_f32 v231, -v119
    v_fma_f32 v224, v224, s67, s67
    v_fma_f32 v225, v225, s67, s67
    s_mov_b32 m0, s53
    s_nop 0
    buffer_load_dwordx4 v184, s[28:31], s56 offen offset:0 lds
    v_rcp_f32 v224, v224
    v_fma_f32 v226, v226, s67, s67
    v_rcp_f32 v225, v225
    v_fma_f32 v227, v227, s67, s67
    buffer_load_dwordx4 v184, s[28:31], s56 offen offset:1024 lds
    v_rcp_f32 v226, v226
    v_fma_f32 v228, v228, s67, s67
    v_rcp_f32 v227, v227
    v_fma_f32 v229, v229, s67, s67
    buffer_load_dwordx4 v185, s[28:31], s56 offen offset:2048 lds
    v_rcp_f32 v228, v228
    v_fma_f32 v230, v230, s67, s67
    v_rcp_f32 v229, v229
    v_fma_f32 v231, v231, s67, s67
    buffer_load_dwordx4 v185, s[28:31], s56 offen offset:3072 lds
    v_rcp_f32 v230, v230
    v_rcp_f32 v231, v231
    v_mul_f32 v128, v128, v224
    v_mul_f32 v129, v129, v225
    s_add_u32 s53, s53, 49152
    s_cmp_ge_u32 s53, s61
    s_cselect_b32 s53, s60, s53
    buffer_store_dwordx4 v[208:211], v198, s[28:31], 0 offen offset:0 sc1
    s_waitcnt vmcnt(14)
    s_barrier
    s_and_b32 s57, s58, 15
    s_lshr_b64 s[58:59], s[58:59], 4
    s_lshl_b32 s56, s57, 11
    s_mul_i32 s57, s57, 0x70000
    s_add_u32 m0, s53, 16384
    s_nop 0
    buffer_load_dwordx4 v188, s[32:35], s57 offen offset:0 lds
    v_mul_f32 v130, v130, v226
    v_mul_f32 v131, v131, v227
    v_mul_f32 v132, v132, v228
    v_mul_f32 v133, v133, v229
    buffer_load_dwordx4 v189, s[32:35], s57 offen offset:1024 lds
    v_mul_f32 v134, v134, v230
    v_mul_f32 v135, v135, v231
    v_cvt_pk_bf16_f32 v212, v128, v129
    v_cvt_pk_bf16_f32 v213, v130, v131
    buffer_load_dwordx4 v190, s[32:35], s57 offen offset:2048 lds
    v_cvt_pk_bf16_f32 v214, v132, v133
    v_cvt_pk_bf16_f32 v215, v134, v135
    buffer_load_dwordx4 v191, s[32:35], s57 offen offset:3072 lds
    s_add_u32 m0, s53, 32768
    s_nop 0
    buffer_load_dwordx4 v188, s[36:39], s57 offen offset:0 lds
    buffer_load_dwordx4 v189, s[36:39], s57 offen offset:1024 lds
    buffer_load_dwordx4 v190, s[36:39], s57 offen offset:2048 lds
    buffer_load_dwordx4 v191, s[36:39], s57 offen offset:3072 lds
    s_mov_b32 m0, s53
    s_nop 0
    buffer_load_dwordx4 v184, s[28:31], s56 offen offset:0 lds
    buffer_load_dwordx4 v184, s[28:31], s56 offen offset:1024 lds
    buffer_load_dwordx4 v185, s[28:31], s56 offen offset:2048 lds
    buffer_load_dwordx4 v185, s[28:31], s56 offen offset:3072 lds
    s_add_u32 s53, s53, 49152
    s_cmp_ge_u32 s53, s61
    s_cselect_b32 s53, s60, s53
    buffer_store_dwordx4 v[212:215], v198, s[28:31], 0 offen offset:1024 sc1
    s_waitcnt vmcnt(14)
    s_barrier
    s_and_b32 s57, s58, 15
    s_lshr_b64 s[58:59], s[58:59], 4
    s_lshl_b32 s56, s57, 11
    s_mul_i32 s57, s57, 0x70000
    s_add_u32 m0, s53, 16384
    s_nop 0
    buffer_load_dwordx4 v188, s[32:35], s57 offen offset:0 lds
    buffer_load_dwordx4 v189, s[32:35], s57 offen offset:1024 lds
    buffer_load_dwordx4 v190, s[32:35], s57 offen offset:2048 lds
    buffer_load_dwordx4 v191, s[32:35], s57 offen offset:3072 lds
    s_add_u32 m0, s53, 32768
    s_nop 0
    buffer_load_dwordx4 v188, s[36:39], s57 offen offset:0 lds
    buffer_load_dwordx4 v189, s[36:39], s57 offen offset:1024 lds
    buffer_load_dwordx4 v190, s[36:39], s57 offen offset:2048 lds
    buffer_load_dwordx4 v191, s[36:39], s57 offen offset:3072 lds
    s_mov_b32 m0, s53
    s_nop 0
    buffer_load_dwordx4 v184, s[28:31], s56 offen offset:0 lds
    buffer_load_dwordx4 v184, s[28:31], s56 offen offset:1024 lds
    buffer_load_dwordx4 v185, s[28:31], s56 offen offset:2048 lds
    buffer_load_dwordx4 v185, s[28:31], s56 offen offset:3072 lds
    s_add_u32 s53, s53, 49152
    s_cmp_ge_u32 s53, s61
    s_cselect_b32 s53, s60, s53
    s_lshl_b32 s64, s47, 8
    s_lshl_b32 s65, s48, 4
    s_add_u32 s64, s64, s65
    s_lshl_b32 s65, s44, 2
    s_add_u32 s64, s64, s65
    s_add_u32 s64, s64, 0x51000
    v_mov_b32 v2, s0
    s_waitcnt vmcnt(12)
    s_mov_b64 exec, 1
    buffer_store_dword v2, v234, s[28:31], s64 offen sc1
    s_mov_b64 exec, -1
    s_lshl_b32 s64, s50, 3
    s_lshl_b32 s65, s44, 1
    s_add_u32 s64, s64, s65
    s_mul_i32 s64, s64, 114688
    s_add_u32 s64, s64, 0x1500000
    v_lshl_add_u32 v192, v1, 4, s64
    v_add_u32 v193, 112640, v192
    s_lshl_b32 s65, s51, 8
    v_lshrrev_b32 v3, 4, v1
    s_lshl_b32 s64, s44, 4
    v_add_u32 v2, s64, v3
    s_movk_i32 s64, 2048
    v_mul_u32_u24 v2, s64, v2
    v_add_u32 v2, s65, v2
    v_lshlrev_b32 v3, 1, v3
    v_and_b32 v4, 15, v1
    v_xor_b32 v3, v3, v4
    v_lshl_add_u32 v194, v3, 4, v2
    v_add_u32 v196, 14336, v194
    v_xor_b32 v3, 8, v3
    v_lshl_add_u32 v195, v3, 4, v2
    v_add_u32 v195, 7168, v195
    v_add_u32 v197, 14336, v195
    s_barrier
    s_and_b32 s57, s58, 15
    s_lshr_b64 s[58:59], s[58:59], 4
    s_lshl_b32 s56, s57, 11
    s_mul_i32 s57, s57, 0x70000
    s_add_u32 m0, s53, 16384
    s_nop 0
    buffer_load_dwordx4 v188, s[32:35], s57 offen offset:0 lds
    buffer_load_dwordx4 v189, s[32:35], s57 offen offset:1024 lds
    buffer_load_dwordx4 v190, s[32:35], s57 offen offset:2048 lds
    buffer_load_dwordx4 v191, s[32:35], s57 offen offset:3072 lds
    s_add_u32 m0, s53, 32768
    s_nop 0
    buffer_load_dwordx4 v188, s[36:39], s57 offen offset:0 lds
    buffer_load_dwordx4 v189, s[36:39], s57 offen offset:1024 lds
    buffer_load_dwordx4 v190, s[36:39], s57 offen offset:2048 lds
    buffer_load_dwordx4 v191, s[36:39], s57 offen offset:3072 lds
    s_mov_b32 m0, s53
    s_nop 0
    buffer_load_dwordx4 v184, s[28:31], s56 offen offset:0 lds
    buffer_load_dwordx4 v184, s[28:31], s56 offen offset:1024 lds
    buffer_load_dwordx4 v185, s[28:31], s56 offen offset:2048 lds
    buffer_load_dwordx4 v185, s[28:31], s56 offen offset:3072 lds
    s_add_u32 s53, s53, 49152
    s_cmp_ge_u32 s53, s61
    s_cselect_b32 s53, s60, s53
    s_waitcnt vmcnt(13)
    s_barrier
    s_and_b32 s57, s58, 15
    s_lshr_b64 s[58:59], s[58:59], 4
    s_lshl_b32 s56, s57, 11
    s_mul_i32 s57, s57, 0x70000
    s_add_u32 m0, s53, 16384
    s_nop 0
    buffer_load_dwordx4 v188, s[32:35], s57 offen offset:0 lds
    buffer_load_dwordx4 v189, s[32:35], s57 offen offset:1024 lds
    buffer_load_dwordx4 v190, s[32:35], s57 offen offset:2048 lds
    buffer_load_dwordx4 v191, s[32:35], s57 offen offset:3072 lds
    s_add_u32 m0, s53, 32768
    s_nop 0
    buffer_load_dwordx4 v188, s[36:39], s57 offen offset:0 lds
    buffer_load_dwordx4 v189, s[36:39], s57 offen offset:1024 lds
    buffer_load_dwordx4 v190, s[36:39], s57 offen offset:2048 lds
    buffer_load_dwordx4 v191, s[36:39], s57 offen offset:3072 lds
    s_mov_b32 m0, s53
    s_nop 0
    buffer_load_dwordx4 v184, s[28:31], s56 offen offset:0 lds
    buffer_load_dwordx4 v184, s[28:31], s56 offen offset:1024 lds
    buffer_load_dwordx4 v185, s[28:31], s56 offen offset:2048 lds
    buffer_load_dwordx4 v185, s[28:31], s56 offen offset:3072 lds
    s_add_u32 s53, s53, 49152
    s_cmp_ge_u32 s53, s61
    s_cselect_b32 s53, s60, s53
    s_waitcnt vmcnt(12)
    s_barrier
    s_and_b32 s57, s58, 15
    s_lshr_b64 s[58:59], s[58:59], 4
    s_lshl_b32 s56, s57, 11
    s_mul_i32 s57, s57, 0x70000
    s_add_u32 m0, s53, 16384
    s_nop 0
    buffer_load_dwordx4 v188, s[32:35], s57 offen offset:0 lds
    buffer_load_dwordx4 v189, s[32:35], s57 offen offset:1024 lds
    buffer_load_dwordx4 v190, s[32:35], s57 offen offset:2048 lds
    buffer_load_dwordx4 v191, s[32:35], s57 offen offset:3072 lds
    s_add_u32 m0, s53, 32768
    s_nop 0
    buffer_load_dwordx4 v188, s[36:39], s57 offen offset:0 lds
    buffer_load_dwordx4 v189, s[36:39], s57 offen offset:1024 lds
    buffer_load_dwordx4 v190, s[36:39], s57 offen offset:2048 lds
    buffer_load_dwordx4 v191, s[36:39], s57 offen offset:3072 lds
    s_mov_b32 m0, s53
    s_nop 0
    buffer_load_dwordx4 v184, s[28:31], s56 offen offset:0 lds
    buffer_load_dwordx4 v184, s[28:31], s56 offen offset:1024 lds
    buffer_load_dwordx4 v185, s[28:31], s56 offen offset:2048 lds
    buffer_load_dwordx4 v185, s[28:31], s56 offen offset:3072 lds
    s_add_u32 s53, s53, 49152
    s_cmp_ge_u32 s53, s61
    s_cselect_b32 s53, s60, s53
    s_waitcnt vmcnt(12)
    s_barrier
    s_lshl_b32 s68, s50, 8
    s_add_u32 s68, s68, 0x51000
    buffer_load_dword v245, v234, s[28:31], s68 offen sc1
    s_and_b32 s57, s58, 15
    s_lshr_b64 s[58:59], s[58:59], 4
    s_lshl_b32 s56, s57, 11
    s_mul_i32 s57, s57, 0x70000
    s_add_u32 m0, s53, 16384
    s_nop 0
    buffer_load_dwordx4 v188, s[32:35], s57 offen offset:0 lds
    buffer_load_dwordx4 v189, s[32:35], s57 offen offset:1024 lds
    buffer_load_dwordx4 v190, s[32:35], s57 offen offset:2048 lds
    buffer_load_dwordx4 v191, s[32:35], s57 offen offset:3072 lds
    s_add_u32 m0, s53, 32768
    s_nop 0
    buffer_load_dwordx4 v188, s[36:39], s57 offen offset:0 lds
    buffer_load_dwordx4 v189, s[36:39], s57 offen offset:1024 lds
    buffer_load_dwordx4 v190, s[36:39], s57 offen offset:2048 lds
    buffer_load_dwordx4 v191, s[36:39], s57 offen offset:3072 lds
    s_mov_b32 m0, s53
    s_nop 0
    buffer_load_dwordx4 v184, s[28:31], s56 offen offset:0 lds
    buffer_load_dwordx4 v184, s[28:31], s56 offen offset:1024 lds
    buffer_load_dwordx4 v185, s[28:31], s56 offen offset:2048 lds
    buffer_load_dwordx4 v185, s[28:31], s56 offen offset:3072 lds
    s_add_u32 s53, s53, 49152
    s_cmp_ge_u32 s53, s61
    s_cselect_b32 s53, s60, s53
    s_waitcnt vmcnt(13)
    s_barrier
M_Pjoin:
    s_waitcnt vmcnt(12)
    s_mov_b32 s3, 0x4000
M_pa_chk:
    v_cmp_ne_u32 vcc, s0, v245
    s_nop 4
    s_cbranch_vccz M_pa_ok
    s_sub_u32 s3, s3, 1
    s_cbranch_scc1 M_pa_ok
    s_sleep 4
    s_cmp_eq_u32 s69, 0
    s_cbranch_scc1 M_pa_rl
    s_sleep 48
M_pa_rl:
    buffer_load_dword v245, v234, s[28:31], s68 offen sc1
    s_waitcnt vmcnt(0)
    s_branch M_pa_chk
M_pa_ok:
    s_lshl_b32 s60, s44, 12
    s_add_u32 s61, s60, 163840
    s_add_u32 s53, s60, 98304
    s_add_u32 s66, s50, s51
    s_and_b32 s66, s66, 3
    s_mov_b32 s58, 0x76453201
    s_mov_b32 s59, 0xfecdba89
    s_cmp_eq_u32 s66, 1
    s_cselect_b32 s58, 0x75643120, s58
    s_cselect_b32 s59, 0xfdecb9a8, s59
    s_cmp_eq_u32 s66, 2
    s_cselect_b32 s58, 0x67542310, s58
    s_cselect_b32 s59, 0xefdcab98, s59
    s_cmp_eq_u32 s66, 3
    s_cselect_b32 s58, 0x86534210, s58
    s_cselect_b32 s59, 0xfedbca97, s59
    s_cmp_eq_u32 s49, 0
    s_cselect_b32 s55, 16, 0
    s_mov_b32 s32, s16
    s_mov_b32 s33, s17
    s_mov_b32 s34, 0x700000
    s_mov_b32 s35, 0x20000
    s_and_b32 s57, s58, 15
    s_lshr_b64 s[58:59], s[58:59], 4
    s_add_u32 s57, s57, s55
    s_lshl_b32 s56, s57, 11
    s_mul_i32 s57, s57, 0x20000
    s_add_u32 m0, s53, 16384
    s_nop 0
    buffer_load_dwordx4 v194, s[32:35], s57 offen offset:0 lds
    buffer_load_dwordx4 v195, s[32:35], s57 offen offset:1024 lds
    buffer_load_dwordx4 v196, s[32:35], s57 offen offset:2048 lds
    buffer_load_dwordx4 v197, s[32:35], s57 offen offset:3072 lds
    s_mov_b32 m0, s53
    s_nop 0
    buffer_load_dwordx4 v192, s[28:31], s56 offen offset:0 lds
    buffer_load_dwordx4 v192, s[28:31], s56 offen offset:1024 lds
    buffer_load_dwordx4 v193, s[28:31], s56 offen offset:2048 lds
    buffer_load_dwordx4 v193, s[28:31], s56 offen offset:3072 lds
    s_add_u32 s53, s53, 32768
    s_cmp_ge_u32 s53, s61
    s_cselect_b32 s53, s60, s53
    s_and_b32 s57, s58, 15
    s_lshr_b64 s[58:59], s[58:59], 4
    s_add_u32 s57, s57, s55
    s_lshl_b32 s56, s57, 11
    s_mul_i32 s57, s57, 0x20000
    s_add_u32 m0, s53, 16384
    s_nop 0
    buffer_load_dwordx4 v194, s[32:35], s57 offen offset:0 lds
    buffer_load_dwordx4 v195, s[32:35], s57 offen offset:1024 lds
    buffer_load_dwordx4 v196, s[32:35], s57 offen offset:2048 lds
    buffer_load_dwordx4 v197, s[32:35], s57 offen offset:3072 lds
    v_and_b32 v2, 15, v1
    s_lshl_b32 s70, s50, 1
    s_add_u32 s70, s70, s45
    s_lshl_b32 s71, s51, 1
    s_add_u32 s71, s71, s46
    s_lshl_b32 s64, s70, 17
    s_lshl_b32 s65, s71, 7
    s_add_u32 s64, s64, s65
    v_lshl_add_u32 v2, v2, 11, s64
    v_bfe_u32 v3, v1, 4, 1
    v_lshl_add_u32 v2, v3, 5, v2
    v_lshrrev_b32 v3, 5, v1
    v_lshl_add_u32 v184, v3, 4, v2
    s_cmp_eq_u32 s49, 0
    s_cselect_b32 s63, 0x80000000, 0
    s_mul_i32 s64, s70, 131072
    s_lshl_b32 s65, s71, 11
    s_add_u32 s64, s64, s65
    s_add_u32 s64, s64, 0xb00000
    s_or_b32 s64, s64, s63
    v_lshl_add_u32 v188, v1, 4, s64
    s_lshl_b32 s64, s50, 12
    s_lshl_b32 s65, s71, 8
    s_add_u32 s64, s64, s65
    s_add_u32 s64, s64, 0xc0000
    s_or_b32 s64, s64, s63
    v_and_b32 v2, 48, v1
    v_add_u32 v185, s64, v2
    s_lshl_b32 s64, s50, 3
    s_add_u32 s64, s64, s51
    s_lshl_b32 s64, s64, 2
    s_add_u32 s64, s64, s44
    s_lshl_b32 s65, s64, 13
    s_add_u32 s65, s65, 0x2400000
    v_lshl_add_u32 v186, v1, 4, s65
    s_lshl_b32 s65, s64, 2
    s_add_u32 s65, s65, 0x50000
    v_mov_b32 v187, s65
    s_mul_i32 s62, s49, 6
    s_mov_b32 s52, 98304
    s_waitcnt vmcnt(12)
    s_barrier
    s_mov_b32 m0, s53
    s_nop 0
    buffer_load_dwordx4 v192, s[28:31], s56 offen offset:0 lds
    buffer_load_dwordx4 v192, s[28:31], s56 offen offset:1024 lds
    buffer_load_dwordx4 v193, s[28:31], s56 offen offset:2048 lds
    buffer_load_dwordx4 v193, s[28:31], s56 offen offset:3072 lds
    s_add_u32 s53, s53, 32768
    s_cmp_ge_u32 s53, s61
    s_cselect_b32 s53, s60, s53
    s_and_b32 s57, s58, 15
    s_lshr_b64 s[58:59], s[58:59], 4
    s_add_u32 s57, s57, s55
    s_lshl_b32 s56, s57, 11
    s_mul_i32 s57, s57, 0x20000
    s_add_u32 m0, s53, 16384
    s_nop 0
    buffer_load_dwordx4 v194, s[32:35], s57 offen offset:0 lds
    buffer_load_dwordx4 v195, s[32:35], s57 offen offset:1024 lds
    buffer_load_dwordx4 v196, s[32:35], s57 offen offset:2048 lds
    buffer_load_dwordx4 v197, s[32:35], s57 offen offset:3072 lds
    s_mov_b32 m0, s53
    s_nop 0
    buffer_load_dwordx4 v192, s[28:31], s56 offen offset:0 lds
    buffer_load_dwordx4 v192, s[28:31], s56 offen offset:1024 lds
    buffer_load_dwordx4 v193, s[28:31], s56 offen offset:2048 lds
    buffer_load_dwordx4 v193, s[28:31], s56 offen offset:3072 lds
    s_add_u32 s53, s53, 32768
    s_cmp_ge_u32 s53, s61
    s_cselect_b32 s53, s60, s53
    v_add_u32 v232, s52, v233
    v_add_u32 v235, s52, v239
    v_add_u32 v236, s52, v240
    v_add_u32 v237, s52, v241
    v_add_u32 v238, s52, v242
    s_mov_b32 s72, 0x0
    s_mov_b32 s76, 0x0
    s_mov_b32 s73, 0x8000
    s_mov_b32 s77, 0x8000
    s_mov_b32 s74, 0x10000
    s_mov_b32 s78, 0x10000
    s_mov_b32 s75, 0x18000
    s_mov_b32 s79, 0x18000
    s_mov_b32 s80, 0x0
    s_mov_b32 s81, 0x1000
    s_mov_b32 s40, s22
    s_mov_b32 s41, s23
    s_mov_b32 s42, 0x400000
    s_mov_b32 s43, 0x20000
    s_waitcnt vmcnt(16)
    s_barrier
    s_setprio 2
    ds_read_b128 v[72:75], v232 offset:0
    ds_read_b64_tr_b16 v[88:89], v235 offset:0
    ds_read_b64_tr_b16 v[90:91], v235 offset:4096
    ds_read_b64_tr_b16 v[92:93], v236 offset:0
    ds_read_b64_tr_b16 v[94:95], v236 offset:4096
    ds_read_b128 v[76:79], v232 offset:2048
    ds_read_b64_tr_b16 v[96:97], v237 offset:0
    ds_read_b64_tr_b16 v[98:99], v237 offset:4096
    ds_read_b64_tr_b16 v[100:101], v238 offset:0
    ds_read_b64_tr_b16 v[102:103], v238 offset:4096
    ds_read_b128 v[80:83], v232 offset:4096
    ds_read_b128 v[84:87], v232 offset:6144
    s_and_b32 s57, s58, 15
    s_lshr_b64 s[58:59], s[58:59], 4
    s_add_u32 s57, s57, s55
    s_lshl_b32 s56, s57, 11
    s_mul_i32 s57, s57, 0x20000
    s_add_u32 m0, s53, 16384
    s_nop 0
    buffer_load_dwordx4 v194, s[32:35], s57 offen offset:0 lds
    buffer_load_dwordx4 v195, s[32:35], s57 offen offset:1024 lds
    buffer_load_dwordx4 v196, s[32:35], s57 offen offset:2048 lds
    buffer_load_dwordx4 v197, s[32:35], s57 offen offset:3072 lds
    s_mov_b32 m0, s53
    s_nop 0
    buffer_load_dwordx4 v192, s[28:31], s56 offen offset:0 lds
    buffer_load_dwordx4 v192, s[28:31], s56 offen offset:1024 lds
    buffer_load_dwordx4 v193, s[28:31], s56 offen offset:2048 lds
    buffer_load_dwordx4 v193, s[28:31], s56 offen offset:3072 lds
    s_add_u32 s53, s53, 32768
    s_cmp_ge_u32 s53, s61
    s_cselect_b32 s53, s60, s53
    s_add_u32 s52, s52, 32768
    s_cmp_ge_u32 s52, 163840
    s_cselect_b32 s52, 0, s52
    s_waitcnt lgkmcnt(0)
    v_mfma_f32_16x16x32_bf16 v[8:11], v[88:91], v[72:75], 0
    ds_read_b128 v[104:107], v232 offset:1024
    v_mfma_f32_16x16x32_bf16 v[12:15], v[92:95], v[72:75], 0
    ds_read_b64_tr_b16 v[120:121], v235 offset:8192
    v_mfma_f32_16x16x32_bf16 v[16:19], v[96:99], v[72:75], 0
    ds_read_b64_tr_b16 v[122:123], v235 offset:12288
    v_mfma_f32_16x16x32_bf16 v[20:23], v[100:103], v[72:75], 0
    ds_read_b64_tr_b16 v[124:125], v236 offset:8192
    v_mfma_f32_16x16x32_bf16 v[24:27], v[88:91], v[76:79], 0
    ds_read_b64_tr_b16 v[126:127], v236 offset:12288
    v_mfma_f32_16x16x32_bf16 v[28:31], v[92:95], v[76:79], 0
    ds_read_b128 v[108:111], v232 offset:3072
    v_mfma_f32_16x16x32_bf16 v[32:35], v[96:99], v[76:79], 0
    ds_read_b64_tr_b16 v[128:129], v237 offset:8192
    v_mfma_f32_16x16x32_bf16 v[36:39], v[100:103], v[76:79], 0
    ds_read_b64_tr_b16 v[130:131], v237 offset:12288
    v_mfma_f32_16x16x32_bf16 v[40:43], v[88:91], v[80:83], 0
    ds_read_b64_tr_b16 v[132:133], v238 offset:8192
    v_mfma_f32_16x16x32_bf16 v[44:47], v[92:95], v[80:83], 0
    ds_read_b64_tr_b16 v[134:135], v238 offset:12288
    v_mfma_f32_16x16x32_bf16 v[48:51], v[96:99], v[80:83], 0
    ds_read_b128 v[112:115], v232 offset:5120
    v_mfma_f32_16x16x32_bf16 v[52:55], v[100:103], v[80:83], 0
    ds_read_b128 v[116:119], v232 offset:7168
    v_mfma_f32_16x16x32_bf16 v[56:59], v[88:91], v[84:87], 0
    v_add_u32 v232, s52, v233
    v_add_u32 v235, s52, v239
    v_mfma_f32_16x16x32_bf16 v[60:63], v[92:95], v[84:87], 0
    v_add_u32 v236, s52, v240
    v_mfma_f32_16x16x32_bf16 v[64:67], v[96:99], v[84:87], 0
    v_add_u32 v237, s52, v241
    v_mfma_f32_16x16x32_bf16 v[68:71], v[100:103], v[84:87], 0
    v_add_u32 v238, s52, v242
    s_waitcnt lgkmcnt(0)
    v_mfma_f32_16x16x32_bf16 v[8:11], v[120:123], v[104:107], v[8:11]
    s_waitcnt vmcnt(16)
    s_barrier
    v_mfma_f32_16x16x32_bf16 v[12:15], v[124:127], v[104:107], v[12:15]
    ds_read_b128 v[72:75], v232 offset:0
    ds_read_b64_tr_b16 v[88:89], v235 offset:0
    v_mfma_f32_16x16x32_bf16 v[16:19], v[128:131], v[104:107], v[16:19]
    ds_read_b64_tr_b16 v[90:91], v235 offset:4096
    v_mfma_f32_16x16x32_bf16 v[20:23], v[132:135], v[104:107], v[20:23]
    ds_read_b64_tr_b16 v[92:93], v236 offset:0
    v_mfma_f32_16x16x32_bf16 v[24:27], v[120:123], v[108:111], v[24:27]
    ds_read_b64_tr_b16 v[94:95], v236 offset:4096
    v_mfma_f32_16x16x32_bf16 v[28:31], v[124:127], v[108:111], v[28:31]
    ds_read_b128 v[76:79], v232 offset:2048
    v_mfma_f32_16x16x32_bf16 v[32:35], v[128:131], v[108:111], v[32:35]
    ds_read_b64_tr_b16 v[96:97], v237 offset:0
    v_mfma_f32_16x16x32_bf16 v[36:39], v[132:135], v[108:111], v[36:39]
    ds_read_b64_tr_b16 v[98:99], v237 offset:4096
    v_mfma_f32_16x16x32_bf16 v[40:43], v[120:123], v[112:115], v[40:43]
    ds_read_b64_tr_b16 v[100:101], v238 offset:0
    v_mfma_f32_16x16x32_bf16 v[44:47], v[124:127], v[112:115], v[44:47]
    ds_read_b64_tr_b16 v[102:103], v238 offset:4096
    v_mfma_f32_16x16x32_bf16 v[48:51], v[128:131], v[112:115], v[48:51]
    ds_read_b128 v[80:83], v232 offset:4096
    v_mfma_f32_16x16x32_bf16 v[52:55], v[132:135], v[112:115], v[52:55]
    ds_read_b128 v[84:87], v232 offset:6144
    v_mfma_f32_16x16x32_bf16 v[56:59], v[120:123], v[116:119], v[56:59]
    v_mfma_f32_16x16x32_bf16 v[60:63], v[124:127], v[116:119], v[60:63]
    v_mfma_f32_16x16x32_bf16 v[64:67], v[128:131], v[116:119], v[64:67]
    s_add_u32 s52, s52, 32768
    s_cmp_ge_u32 s52, 163840
    s_cselect_b32 s52, 0, s52
    v_mfma_f32_16x16x32_bf16 v[68:71], v[132:135], v[116:119], v[68:71]
    s_waitcnt lgkmcnt(0)
    v_mfma_f32_16x16x32_bf16 v[8:11], v[88:91], v[72:75], v[8:11]
    ds_read_b128 v[104:107], v232 offset:1024
    v_mfma_f32_16x16x32_bf16 v[12:15], v[92:95], v[72:75], v[12:15]
    ds_read_b64_tr_b16 v[120:121], v235 offset:8192
    v_mfma_f32_16x16x32_bf16 v[16:19], v[96:99], v[72:75], v[16:19]
    ds_read_b64_tr_b16 v[122:123], v235 offset:12288
    v_mfma_f32_16x16x32_bf16 v[20:23], v[100:103], v[72:75], v[20:23]
    ds_read_b64_tr_b16 v[124:125], v236 offset:8192
    v_mfma_f32_16x16x32_bf16 v[24:27], v[88:91], v[76:79], v[24:27]
    ds_read_b64_tr_b16 v[126:127], v236 offset:12288
    v_mfma_f32_16x16x32_bf16 v[28:31], v[92:95], v[76:79], v[28:31]
    ds_read_b128 v[108:111], v232 offset:3072
    v_mfma_f32_16x16x32_bf16 v[32:35], v[96:99], v[76:79], v[32:35]
    ds_read_b64_tr_b16 v[128:129], v237 offset:8192
    v_mfma_f32_16x16x32_bf16 v[36:39], v[100:103], v[76:79], v[36:39]
    ds_read_b64_tr_b16 v[130:131], v237 offset:12288
    v_mfma_f32_16x16x32_bf16 v[40:43], v[88:91], v[80:83], v[40:43]
    ds_read_b64_tr_b16 v[132:133], v238 offset:8192
    v_mfma_f32_16x16x32_bf16 v[44:47], v[92:95], v[80:83], v[44:47]
    ds_read_b64_tr_b16 v[134:135], v238 offset:12288
    v_mfma_f32_16x16x32_bf16 v[48:51], v[96:99], v[80:83], v[48:51]
    ds_read_b128 v[112:115], v232 offset:5120
    v_mfma_f32_16x16x32_bf16 v[52:55], v[100:103], v[80:83], v[52:55]
    ds_read_b128 v[116:119], v232 offset:7168
    v_mfma_f32_16x16x32_bf16 v[56:59], v[88:91], v[84:87], v[56:59]
    v_add_u32 v232, s52, v233
    v_add_u32 v235, s52, v239
    v_mfma_f32_16x16x32_bf16 v[60:63], v[92:95], v[84:87], v[60:63]
    v_add_u32 v236, s52, v240
    v_mfma_f32_16x16x32_bf16 v[64:67], v[96:99], v[84:87], v[64:67]
    v_add_u32 v237, s52, v241
    v_mfma_f32_16x16x32_bf16 v[68:71], v[100:103], v[84:87], v[68:71]
    v_add_u32 v238, s52, v242
    s_waitcnt lgkmcnt(0)
    v_mfma_f32_16x16x32_bf16 v[8:11], v[120:123], v[104:107], v[8:11]
    s_waitcnt vmcnt(8)
    s_barrier
    v_mfma_f32_16x16x32_bf16 v[12:15], v[124:127], v[104:107], v[12:15]
    ds_read_b128 v[72:75], v232 offset:0
    ds_read_b64_tr_b16 v[88:89], v235 offset:0
    v_mfma_f32_16x16x32_bf16 v[16:19], v[128:131], v[104:107], v[16:19]
    ds_read_b64_tr_b16 v[90:91], v235 offset:4096
    v_mfma_f32_16x16x32_bf16 v[20:23], v[132:135], v[104:107], v[20:23]
    ds_read_b64_tr_b16 v[92:93], v236 offset:0
    v_mfma_f32_16x16x32_bf16 v[24:27], v[120:123], v[108:111], v[24:27]
    ds_read_b64_tr_b16 v[94:95], v236 offset:4096
    v_mfma_f32_16x16x32_bf16 v[28:31], v[124:127], v[108:111], v[28:31]
    ds_read_b128 v[76:79], v232 offset:2048
    v_mfma_f32_16x16x32_bf16 v[32:35], v[128:131], v[108:111], v[32:35]
    ds_read_b64_tr_b16 v[96:97], v237 offset:0
    v_mfma_f32_16x16x32_bf16 v[36:39], v[132:135], v[108:111], v[36:39]
    ds_read_b64_tr_b16 v[98:99], v237 offset:4096
    v_mfma_f32_16x16x32_bf16 v[40:43], v[120:123], v[112:115], v[40:43]
    ds_read_b64_tr_b16 v[100:101], v238 offset:0
    v_mfma_f32_16x16x32_bf16 v[44:47], v[124:127], v[112:115], v[44:47]
    ds_read_b64_tr_b16 v[102:103], v238 offset:4096
    v_mfma_f32_16x16x32_bf16 v[48:51], v[128:131], v[112:115], v[48:51]
    ds_read_b128 v[80:83], v232 offset:4096
    v_mfma_f32_16x16x32_bf16 v[52:55], v[132:135], v[112:115], v[52:55]
    ds_read_b128 v[84:87], v232 offset:6144
    v_mfma_f32_16x16x32_bf16 v[56:59], v[120:123], v[116:119], v[56:59]
    v_mfma_f32_16x16x32_bf16 v[60:63], v[124:127], v[116:119], v[60:63]
    v_mfma_f32_16x16x32_bf16 v[64:67], v[128:131], v[116:119], v[64:67]
    s_add_u32 s52, s52, 32768
    s_cmp_ge_u32 s52, 163840
    s_cselect_b32 s52, 0, s52
    v_mfma_f32_16x16x32_bf16 v[68:71], v[132:135], v[116:119], v[68:71]
    s_waitcnt lgkmcnt(0)
    v_mfma_f32_16x16x32_bf16 v[8:11], v[88:91], v[72:75], v[8:11]
    ds_read_b128 v[104:107], v232 offset:1024
    v_mfma_f32_16x16x32_bf16 v[12:15], v[92:95], v[72:75], v[12:15]
    ds_read_b64_tr_b16 v[120:121], v235 offset:8192
    v_mfma_f32_16x16x32_bf16 v[16:19], v[96:99], v[72:75], v[16:19]
    ds_read_b64_tr_b16 v[122:123], v235 offset:12288
    v_mfma_f32_16x16x32_bf16 v[20:23], v[100:103], v[72:75], v[20:23]
    ds_read_b64_tr_b16 v[124:125], v236 offset:8192
    v_mfma_f32_16x16x32_bf16 v[24:27], v[88:91], v[76:79], v[24:27]
    ds_read_b64_tr_b16 v[126:127], v236 offset:12288
    v_mfma_f32_16x16x32_bf16 v[28:31], v[92:95], v[76:79], v[28:31]
    ds_read_b128 v[108:111], v232 offset:3072
    v_mfma_f32_16x16x32_bf16 v[32:35], v[96:99], v[76:79], v[32:35]
    ds_read_b64_tr_b16 v[128:129], v237 offset:8192
    v_mfma_f32_16x16x32_bf16 v[36:39], v[100:103], v[76:79], v[36:39]
    ds_read_b64_tr_b16 v[130:131], v237 offset:12288
    v_mfma_f32_16x16x32_bf16 v[40:43], v[88:91], v[80:83], v[40:43]
    ds_read_b64_tr_b16 v[132:133], v238 offset:8192
    v_mfma_f32_16x16x32_bf16 v[44:47], v[92:95], v[80:83], v[44:47]
    ds_read_b64_tr_b16 v[134:135], v238 offset:12288
    v_mfma_f32_16x16x32_bf16 v[48:51], v[96:99], v[80:83], v[48:51]
    ds_read_b128 v[112:115], v232 offset:5120
    v_mfma_f32_16x16x32_bf16 v[52:55], v[100:103], v[80:83], v[52:55]
    ds_read_b128 v[116:119], v232 offset:7168
    v_mfma_f32_16x16x32_bf16 v[56:59], v[88:91], v[84:87], v[56:59]
    v_add_u32 v232, s52, v233
    v_add_u32 v235, s52, v239
    v_mfma_f32_16x16x32_bf16 v[60:63], v[92:95], v[84:87], v[60:63]
    v_add_u32 v236, s52, v240
    v_mfma_f32_16x16x32_bf16 v[64:67], v[96:99], v[84:87], v[64:67]
    v_add_u32 v237, s52, v241
    v_mfma_f32_16x16x32_bf16 v[68:71], v[100:103], v[84:87], v[68:71]
    v_add_u32 v238, s52, v242
    s_waitcnt lgkmcnt(0)
    v_mfma_f32_16x16x32_bf16 v[8:11], v[120:123], v[104:107], v[8:11]
    s_waitcnt vmcnt(0)
    s_barrier
    v_mfma_f32_16x16x32_bf16 v[12:15], v[124:127], v[104:107], v[12:15]
    ds_read_b128 v[72:75], v232 offset:0
    ds_read_b64_tr_b16 v[88:89], v235 offset:0
    v_mfma_f32_16x16x32_bf16 v[16:19], v[128:131], v[104:107], v[16:19]
    ds_read_b64_tr_b16 v[90:91], v235 offset:4096
    v_mfma_f32_16x16x32_bf16 v[20:23], v[132:135], v[104:107], v[20:23]
    ds_read_b64_tr_b16 v[92:93], v236 offset:0
    v_mfma_f32_16x16x32_bf16 v[24:27], v[120:123], v[108:111], v[24:27]
    ds_read_b64_tr_b16 v[94:95], v236 offset:4096
    v_mfma_f32_16x16x32_bf16 v[28:31], v[124:127], v[108:111], v[28:31]
    ds_read_b128 v[76:79], v232 offset:2048
    v_mfma_f32_16x16x32_bf16 v[32:35], v[128:131], v[108:111], v[32:35]
    ds_read_b64_tr_b16 v[96:97], v237 offset:0
    v_mfma_f32_16x16x32_bf16 v[36:39], v[132:135], v[108:111], v[36:39]
    ds_read_b64_tr_b16 v[98:99], v237 offset:4096
    v_mfma_f32_16x16x32_bf16 v[40:43], v[120:123], v[112:115], v[40:43]
    ds_read_b64_tr_b16 v[100:101], v238 offset:0
    v_mfma_f32_16x16x32_bf16 v[44:47], v[124:127], v[112:115], v[44:47]
    ds_read_b64_tr_b16 v[102:103], v238 offset:4096
    v_mfma_f32_16x16x32_bf16 v[48:51], v[128:131], v[112:115], v[48:51]
    ds_read_b128 v[80:83], v232 offset:4096
    v_mfma_f32_16x16x32_bf16 v[52:55], v[132:135], v[112:115], v[52:55]
    ds_read_b128 v[84:87], v232 offset:6144
    v_mfma_f32_16x16x32_bf16 v[56:59], v[120:123], v[116:119], v[56:59]
    v_mfma_f32_16x16x32_bf16 v[60:63], v[124:127], v[116:119], v[60:63]
    v_mfma_f32_16x16x32_bf16 v[64:67], v[128:131], v[116:119], v[64:67]
    s_add_u32 s52, s52, 32768
    s_cmp_ge_u32 s52, 163840
    s_cselect_b32 s52, 0, s52
    v_mfma_f32_16x16x32_bf16 v[68:71], v[132:135], v[116:119], v[68:71]
    s_waitcnt lgkmcnt(0)
    v_mfma_f32_16x16x32_bf16 v[8:11], v[88:91], v[72:75], v[8:11]
    ds_read_b128 v[104:107], v232 offset:1024
    v_mfma_f32_16x16x32_bf16 v[12:15], v[92:95], v[72:75], v[12:15]
    ds_read_b64_tr_b16 v[120:121], v235 offset:8192
    v_mfma_f32_16x16x32_bf16 v[16:19], v[96:99], v[72:75], v[16:19]
    ds_read_b64_tr_b16 v[122:123], v235 offset:12288
    v_mfma_f32_16x16x32_bf16 v[20:23], v[100:103], v[72:75], v[20:23]
    ds_read_b64_tr_b16 v[124:125], v236 offset:8192
    v_mfma_f32_16x16x32_bf16 v[24:27], v[88:91], v[76:79], v[24:27]
    ds_read_b64_tr_b16 v[126:127], v236 offset:12288
    v_mfma_f32_16x16x32_bf16 v[28:31], v[92:95], v[76:79], v[28:31]
    ds_read_b128 v[108:111], v232 offset:3072
    v_mfma_f32_16x16x32_bf16 v[32:35], v[96:99], v[76:79], v[32:35]
    ds_read_b64_tr_b16 v[128:129], v237 offset:8192
    v_mfma_f32_16x16x32_bf16 v[36:39], v[100:103], v[76:79], v[36:39]
    ds_read_b64_tr_b16 v[130:131], v237 offset:12288
    v_mfma_f32_16x16x32_bf16 v[40:43], v[88:91], v[80:83], v[40:43]
    s_add_u32 s54, s62, 17
M_P_loop5:
    ds_read_b64_tr_b16 v[132:133], v238 offset:8192
    v_mfma_f32_16x16x32_bf16 v[44:47], v[92:95], v[80:83], v[44:47]
    ds_read_b64_tr_b16 v[134:135], v238 offset:12288
    v_mfma_f32_16x16x32_bf16 v[48:51], v[96:99], v[80:83], v[48:51]
    ds_read_b128 v[112:115], v232 offset:5120
    v_mfma_f32_16x16x32_bf16 v[52:55], v[100:103], v[80:83], v[52:55]
    ds_read_b128 v[116:119], v232 offset:7168
    v_mfma_f32_16x16x32_bf16 v[56:59], v[88:91], v[84:87], v[56:59]
    v_add_u32 v232, s52, v233
    v_add_u32 v235, s52, v239
    v_mfma_f32_16x16x32_bf16 v[60:63], v[92:95], v[84:87], v[60:63]
    v_add_u32 v236, s52, v240
    v_mfma_f32_16x16x32_bf16 v[64:67], v[96:99], v[84:87], v[64:67]
    v_add_u32 v237, s52, v241
    v_mfma_f32_16x16x32_bf16 v[68:71], v[100:103], v[84:87], v[68:71]
    v_add_u32 v238, s52, v242
    s_waitcnt lgkmcnt(0)
    v_mfma_f32_16x16x32_bf16 v[8:11], v[120:123], v[104:107], v[8:11]
    s_barrier
    v_mfma_f32_16x16x32_bf16 v[12:15], v[124:127], v[104:107], v[12:15]
    ds_read_b128 v[72:75], v232 offset:0
    ds_read_b64_tr_b16 v[88:89], v235 offset:0
    v_mfma_f32_16x16x32_bf16 v[16:19], v[128:131], v[104:107], v[16:19]
    ds_read_b64_tr_b16 v[90:91], v235 offset:4096
    v_mfma_f32_16x16x32_bf16 v[20:23], v[132:135], v[104:107], v[20:23]
    ds_read_b64_tr_b16 v[92:93], v236 offset:0
    v_mfma_f32_16x16x32_bf16 v[24:27], v[120:123], v[108:111], v[24:27]
    ds_read_b64_tr_b16 v[94:95], v236 offset:4096
    v_mfma_f32_16x16x32_bf16 v[28:31], v[124:127], v[108:111], v[28:31]
    ds_read_b128 v[76:79], v232 offset:2048
    v_mfma_f32_16x16x32_bf16 v[32:35], v[128:131], v[108:111], v[32:35]
    ds_read_b64_tr_b16 v[96:97], v237 offset:0
    v_mfma_f32_16x16x32_bf16 v[36:39], v[132:135], v[108:111], v[36:39]
    ds_read_b64_tr_b16 v[98:99], v237 offset:4096
    v_mfma_f32_16x16x32_bf16 v[40:43], v[120:123], v[112:115], v[40:43]
    ds_read_b64_tr_b16 v[100:101], v238 offset:0
    v_mfma_f32_16x16x32_bf16 v[44:47], v[124:127], v[112:115], v[44:47]
    ds_read_b64_tr_b16 v[102:103], v238 offset:4096
    v_mfma_f32_16x16x32_bf16 v[48:51], v[128:131], v[112:115], v[48:51]
    ds_read_b128 v[80:83], v232 offset:4096
    v_mfma_f32_16x16x32_bf16 v[52:55], v[132:135], v[112:115], v[52:55]
    ds_read_b128 v[84:87], v232 offset:6144
    v_mfma_f32_16x16x32_bf16 v[56:59], v[120:123], v[116:119], v[56:59]
    v_mfma_f32_16x16x32_bf16 v[60:63], v[124:127], v[116:119], v[60:63]
    v_mfma_f32_16x16x32_bf16 v[64:67], v[128:131], v[116:119], v[64:67]
    s_add_u32 s52, s52, 32768
    s_cmp_ge_u32 s52, 163840
    s_cselect_b32 s52, 0, s52
    v_mfma_f32_16x16x32_bf16 v[68:71], v[132:135], v[116:119], v[68:71]
    s_waitcnt lgkmcnt(0)
    v_mfma_f32_16x16x32_bf16 v[8:11], v[88:91], v[72:75], v[8:11]
    ds_read_b128 v[104:107], v232 offset:1024
    v_mfma_f32_16x16x32_bf16 v[12:15], v[92:95], v[72:75], v[12:15]
    ds_read_b64_tr_b16 v[120:121], v235 offset:8192
    v_mfma_f32_16x16x32_bf16 v[16:19], v[96:99], v[72:75], v[16:19]
    ds_read_b64_tr_b16 v[122:123], v235 offset:12288
    v_mfma_f32_16x16x32_bf16 v[20:23], v[100:103], v[72:75], v[20:23]
    ds_read_b64_tr_b16 v[124:125], v236 offset:8192
    v_mfma_f32_16x16x32_bf16 v[24:27], v[88:91], v[76:79], v[24:27]
    ds_read_b64_tr_b16 v[126:127], v236 offset:12288
    v_mfma_f32_16x16x32_bf16 v[28:31], v[92:95], v[76:79], v[28:31]
    ds_read_b128 v[108:111], v232 offset:3072
    v_mfma_f32_16x16x32_bf16 v[32:35], v[96:99], v[76:79], v[32:35]
    ds_read_b64_tr_b16 v[128:129], v237 offset:8192
    v_mfma_f32_16x16x32_bf16 v[36:39], v[100:103], v[76:79], v[36:39]
    s_sub_u32 s54, s54, 1
    ds_read_b64_tr_b16 v[130:131], v237 offset:12288
    v_mfma_f32_16x16x32_bf16 v[40:43], v[88:91], v[80:83], v[40:43]
    s_cbranch_scc0 M_P_loop5
    ds_read_b64_tr_b16 v[132:133], v238 offset:8192
    v_mfma_f32_16x16x32_bf16 v[44:47], v[92:95], v[80:83], v[44:47]
    ds_read_b64_tr_b16 v[134:135], v238 offset:12288
    v_mfma_f32_16x16x32_bf16 v[48:51], v[96:99], v[80:83], v[48:51]
    ds_read_b128 v[112:115], v232 offset:5120
    v_mfma_f32_16x16x32_bf16 v[52:55], v[100:103], v[80:83], v[52:55]
    ds_read_b128 v[116:119], v232 offset:7168
    v_mfma_f32_16x16x32_bf16 v[56:59], v[88:91], v[84:87], v[56:59]
    v_add_u32 v232, s52, v233
    v_add_u32 v235, s52, v239
    v_mfma_f32_16x16x32_bf16 v[60:63], v[92:95], v[84:87], v[60:63]
    v_add_u32 v236, s52, v240
    v_mfma_f32_16x16x32_bf16 v[64:67], v[96:99], v[84:87], v[64:67]
    v_add_u32 v237, s52, v241
    v_mfma_f32_16x16x32_bf16 v[68:71], v[100:103], v[84:87], v[68:71]
    v_add_u32 v238, s52, v242
    s_waitcnt lgkmcnt(0)
    v_mfma_f32_16x16x32_bf16 v[8:11], v[120:123], v[104:107], v[8:11]
    s_barrier
    v_mfma_f32_16x16x32_bf16 v[12:15], v[124:127], v[104:107], v[12:15]
    ds_read_b128 v[72:75], v232 offset:0
    ds_read_b64_tr_b16 v[88:89], v235 offset:0
    v_mfma_f32_16x16x32_bf16 v[16:19], v[128:131], v[104:107], v[16:19]
    ds_read_b64_tr_b16 v[90:91], v235 offset:4096
    v_mfma_f32_16x16x32_bf16 v[20:23], v[132:135], v[104:107], v[20:23]
    ds_read_b64_tr_b16 v[92:93], v236 offset:0
    v_mfma_f32_16x16x32_bf16 v[24:27], v[120:123], v[108:111], v[24:27]
    ds_read_b64_tr_b16 v[94:95], v236 offset:4096
    v_mfma_f32_16x16x32_bf16 v[28:31], v[124:127], v[108:111], v[28:31]
    ds_read_b128 v[76:79], v232 offset:2048
    v_mfma_f32_16x16x32_bf16 v[32:35], v[128:131], v[108:111], v[32:35]
    ds_read_b64_tr_b16 v[96:97], v237 offset:0
    v_mfma_f32_16x16x32_bf16 v[36:39], v[132:135], v[108:111], v[36:39]
    ds_read_b64_tr_b16 v[98:99], v237 offset:4096
    v_mfma_f32_16x16x32_bf16 v[40:43], v[120:123], v[112:115], v[40:43]
    ds_read_b64_tr_b16 v[100:101], v238 offset:0
    v_mfma_f32_16x16x32_bf16 v[44:47], v[124:127], v[112:115], v[44:47]
    ds_read_b64_tr_b16 v[102:103], v238 offset:4096
    v_mfma_f32_16x16x32_bf16 v[48:51], v[128:131], v[112:115], v[48:51]
    ds_read_b128 v[80:83], v232 offset:4096
    v_mfma_f32_16x16x32_bf16 v[52:55], v[132:135], v[112:115], v[52:55]
    ds_read_b128 v[84:87], v232 offset:6144
    v_mfma_f32_16x16x32_bf16 v[56:59], v[120:123], v[116:119], v[56:59]
    v_mfma_f32_16x16x32_bf16 v[60:63], v[124:127], v[116:119], v[60:63]
    v_mfma_f32_16x16x32_bf16 v[64:67], v[128:131], v[116:119], v[64:67]
    s_add_u32 s52, s52, 32768
    s_cmp_ge_u32 s52, 163840
    s_cselect_b32 s52, 0, s52
    v_mfma_f32_16x16x32_bf16 v[68:71], v[132:135], v[116:119], v[68:71]
    s_waitcnt lgkmcnt(0)
    v_mfma_f32_16x16x32_bf16 v[8:11], v[88:91], v[72:75], v[8:11]
    ds_read_b128 v[104:107], v232 offset:1024
    v_mfma_f32_16x16x32_bf16 v[12:15], v[92:95], v[72:75], v[12:15]
    ds_read_b64_tr_b16 v[120:121], v235 offset:8192
    buffer_load_dwordx4 v[136:139], v188, s[28:31], s76 offen offset:0
    v_mfma_f32_16x16x32_bf16 v[16:19], v[96:99], v[72:75], v[16:19]
    ds_read_b64_tr_b16 v[122:123], v235 offset:12288
    v_mfma_f32_16x16x32_bf16 v[20:23], v[100:103], v[72:75], v[20:23]
    ds_read_b64_tr_b16 v[124:125], v236 offset:8192
    v_mfma_f32_16x16x32_bf16 v[24:27], v[88:91], v[76:79], v[24:27]
    ds_read_b64_tr_b16 v[126:127], v236 offset:12288
    v_mfma_f32_16x16x32_bf16 v[28:31], v[92:95], v[76:79], v[28:31]
    ds_read_b128 v[108:111], v232 offset:3072
    v_mfma_f32_16x16x32_bf16 v[32:35], v[96:99], v[76:79], v[32:35]
    ds_read_b64_tr_b16 v[128:129], v237 offset:8192
    buffer_load_dwordx4 v[140:143], v188, s[28:31], s76 offen offset:1024
    v_mfma_f32_16x16x32_bf16 v[36:39], v[100:103], v[76:79], v[36:39]
    ds_read_b64_tr_b16 v[130:131], v237 offset:12288
    v_mfma_f32_16x16x32_bf16 v[40:43], v[88:91], v[80:83], v[40:43]
    ds_read_b64_tr_b16 v[132:133], v238 offset:8192
    v_mfma_f32_16x16x32_bf16 v[44:47], v[92:95], v[80:83], v[44:47]
    ds_read_b64_tr_b16 v[134:135], v238 offset:12288
    v_mfma_f32_16x16x32_bf16 v[48:51], v[96:99], v[80:83], v[48:51]
    ds_read_b128 v[112:115], v232 offset:5120
    v_mfma_f32_16x16x32_bf16 v[52:55], v[100:103], v[80:83], v[52:55]
    ds_read_b128 v[116:119], v232 offset:7168
    buffer_load_dwordx4 v[144:147], v188, s[28:31], s77 offen offset:0
    v_mfma_f32_16x16x32_bf16 v[56:59], v[88:91], v[84:87], v[56:59]
    v_add_u32 v232, s52, v233
    v_add_u32 v235, s52, v239
    v_mfma_f32_16x16x32_bf16 v[60:63], v[92:95], v[84:87], v[60:63]
    v_add_u32 v236, s52, v240
    v_mfma_f32_16x16x32_bf16 v[64:67], v[96:99], v[84:87], v[64:67]
    v_add_u32 v237, s52, v241
    v_mfma_f32_16x16x32_bf16 v[68:71], v[100:103], v[84:87], v[68:71]
    v_add_u32 v238, s52, v242
    s_waitcnt lgkmcnt(0)
    v_mfma_f32_16x16x32_bf16 v[8:11], v[120:123], v[104:107], v[8:11]
    s_barrier
    v_mfma_f32_16x16x32_bf16 v[12:15], v[124:127], v[104:107], v[12:15]
    ds_read_b128 v[72:75], v232 offset:0
    ds_read_b64_tr_b16 v[88:89], v235 offset:0
    buffer_load_dwordx4 v[148:151], v188, s[28:31], s77 offen offset:1024
    v_mfma_f32_16x16x32_bf16 v[16:19], v[128:131], v[104:107], v[16:19]
    ds_read_b64_tr_b16 v[90:91], v235 offset:4096
    v_mfma_f32_16x16x32_bf16 v[20:23], v[132:135], v[104:107], v[20:23]
    ds_read_b64_tr_b16 v[92:93], v236 offset:0
    v_mfma_f32_16x16x32_bf16 v[24:27], v[120:123], v[108:111], v[24:27]
    ds_read_b64_tr_b16 v[94:95], v236 offset:4096
    v_mfma_f32_16x16x32_bf16 v[28:31], v[124:127], v[108:111], v[28:31]
    ds_read_b128 v[76:79], v232 offset:2048
    v_mfma_f32_16x16x32_bf16 v[32:35], v[128:131], v[108:111], v[32:35]
    ds_read_b64_tr_b16 v[96:97], v237 offset:0
    buffer_load_dwordx4 v[152:155], v188, s[28:31], s78 offen offset:0
    v_mfma_f32_16x16x32_bf16 v[36:39], v[132:135], v[108:111], v[36:39]
    ds_read_b64_tr_b16 v[98:99], v237 offset:4096
    v_mfma_f32_16x16x32_bf16 v[40:43], v[120:123], v[112:115], v[40:43]
    ds_read_b64_tr_b16 v[100:101], v238 offset:0
    v_mfma_f32_16x16x32_bf16 v[44:47], v[124:127], v[112:115], v[44:47]
    ds_read_b64_tr_b16 v[102:103], v238 offset:4096
    v_mfma_f32_16x16x32_bf16 v[48:51], v[128:131], v[112:115], v[48:51]
    ds_read_b128 v[80:83], v232 offset:4096
    v_mfma_f32_16x16x32_bf16 v[52:55], v[132:135], v[112:115], v[52:55]
    ds_read_b128 v[84:87], v232 offset:6144
    buffer_load_dwordx4 v[156:159], v188, s[28:31], s78 offen offset:1024
    v_mfma_f32_16x16x32_bf16 v[56:59], v[120:123], v[116:119], v[56:59]
    v_mfma_f32_16x16x32_bf16 v[60:63], v[124:127], v[116:119], v[60:63]
    v_mfma_f32_16x16x32_bf16 v[64:67], v[128:131], v[116:119], v[64:67]
    s_add_u32 s52, s52, 32768
    s_cmp_ge_u32 s52, 163840
    s_cselect_b32 s52, 0, s52
    v_mfma_f32_16x16x32_bf16 v[68:71], v[132:135], v[116:119], v[68:71]
    s_waitcnt lgkmcnt(0)
    v_mfma_f32_16x16x32_bf16 v[8:11], v[88:91], v[72:75], v[8:11]
    ds_read_b128 v[104:107], v232 offset:1024
    v_mfma_f32_16x16x32_bf16 v[12:15], v[92:95], v[72:75], v[12:15]
    ds_read_b64_tr_b16 v[120:121], v235 offset:8192
    buffer_load_dwordx4 v[160:163], v188, s[28:31], s79 offen offset:0
    v_mfma_f32_16x16x32_bf16 v[16:19], v[96:99], v[72:75], v[16:19]
    ds_read_b64_tr_b16 v[122:123], v235 offset:12288
    v_mfma_f32_16x16x32_bf16 v[20:23], v[100:103], v[72:75], v[20:23]
    ds_read_b64_tr_b16 v[124:125], v236 offset:8192
    v_mfma_f32_16x16x32_bf16 v[24:27], v[88:91], v[76:79], v[24:27]
    ds_read_b64_tr_b16 v[126:127], v236 offset:12288
    v_mfma_f32_16x16x32_bf16 v[28:31], v[92:95], v[76:79], v[28:31]
    ds_read_b128 v[108:111], v232 offset:3072
    v_mfma_f32_16x16x32_bf16 v[32:35], v[96:99], v[76:79], v[32:35]
    ds_read_b64_tr_b16 v[128:129], v237 offset:8192
    buffer_load_dwordx4 v[164:167], v188, s[28:31], s79 offen offset:1024
    v_mfma_f32_16x16x32_bf16 v[36:39], v[100:103], v[76:79], v[36:39]
    ds_read_b64_tr_b16 v[130:131], v237 offset:12288
    v_mfma_f32_16x16x32_bf16 v[40:43], v[88:91], v[80:83], v[40:43]
    ds_read_b64_tr_b16 v[132:133], v238 offset:8192
    v_mfma_f32_16x16x32_bf16 v[44:47], v[92:95], v[80:83], v[44:47]
    ds_read_b64_tr_b16 v[134:135], v238 offset:12288
    v_mfma_f32_16x16x32_bf16 v[48:51], v[96:99], v[80:83], v[48:51]
    ds_read_b128 v[112:115], v232 offset:5120
    v_mfma_f32_16x16x32_bf16 v[52:55], v[100:103], v[80:83], v[52:55]
    ds_read_b128 v[116:119], v232 offset:7168
    buffer_load_dwordx4 v[168:171], v185, s[28:31], 0 offen offset:0
    v_mfma_f32_16x16x32_bf16 v[56:59], v[88:91], v[84:87], v[56:59]
    v_add_u32 v232, s52, v233
    v_add_u32 v235, s52, v239
    v_mfma_f32_16x16x32_bf16 v[60:63], v[92:95], v[84:87], v[60:63]
    v_add_u32 v236, s52, v240
    v_mfma_f32_16x16x32_bf16 v[64:67], v[96:99], v[84:87], v[64:67]
    v_add_u32 v237, s52, v241
    v_mfma_f32_16x16x32_bf16 v[68:71], v[100:103], v[84:87], v[68:71]
    v_add_u32 v238, s52, v242
    s_waitcnt lgkmcnt(0)
    v_mfma_f32_16x16x32_bf16 v[8:11], v[120:123], v[104:107], v[8:11]
    s_barrier
    v_mfma_f32_16x16x32_bf16 v[12:15], v[124:127], v[104:107], v[12:15]
    ds_read_b128 v[72:75], v232 offset:0
    ds_read_b64_tr_b16 v[88:89], v235 offset:0
    buffer_load_dwordx4 v[172:175], v185, s[28:31], 0 offen offset:64
    v_mfma_f32_16x16x32_bf16 v[16:19], v[128:131], v[104:107], v[16:19]
    ds_read_b64_tr_b16 v[90:91], v235 offset:4096
    v_mfma_f32_16x16x32_bf16 v[20:23], v[132:135], v[104:107], v[20:23]
    ds_read_b64_tr_b16 v[92:93], v236 offset:0
    v_mfma_f32_16x16x32_bf16 v[24:27], v[120:123], v[108:111], v[24:27]
    ds_read_b64_tr_b16 v[94:95], v236 offset:4096
    v_mfma_f32_16x16x32_bf16 v[28:31], v[124:127], v[108:111], v[28:31]
    ds_read_b128 v[76:79], v232 offset:2048
    v_mfma_f32_16x16x32_bf16 v[32:35], v[128:131], v[108:111], v[32:35]
    ds_read_b64_tr_b16 v[96:97], v237 offset:0
    buffer_load_dwordx4 v[176:179], v185, s[28:31], 0 offen offset:128
    v_mfma_f32_16x16x32_bf16 v[36:39], v[132:135], v[108:111], v[36:39]
    ds_read_b64_tr_b16 v[98:99], v237 offset:4096
    v_mfma_f32_16x16x32_bf16 v[40:43], v[120:123], v[112:115], v[40:43]
    ds_read_b64_tr_b16 v[100:101], v238 offset:0
    v_mfma_f32_16x16x32_bf16 v[44:47], v[124:127], v[112:115], v[44:47]
    ds_read_b64_tr_b16 v[102:103], v238 offset:4096
    v_mfma_f32_16x16x32_bf16 v[48:51], v[128:131], v[112:115], v[48:51]
    ds_read_b128 v[80:83], v232 offset:4096
    v_mfma_f32_16x16x32_bf16 v[52:55], v[132:135], v[112:115], v[52:55]
    ds_read_b128 v[84:87], v232 offset:6144
    buffer_load_dwordx4 v[180:183], v185, s[28:31], 0 offen offset:192
    v_mfma_f32_16x16x32_bf16 v[56:59], v[120:123], v[116:119], v[56:59]
    v_mfma_f32_16x16x32_bf16 v[60:63], v[124:127], v[116:119], v[60:63]
    v_mfma_f32_16x16x32_bf16 v[64:67], v[128:131], v[116:119], v[64:67]
    s_add_u32 s52, s52, 32768
    s_cmp_ge_u32 s52, 163840
    s_cselect_b32 s52, 0, s52
    v_mfma_f32_16x16x32_bf16 v[68:71], v[132:135], v[116:119], v[68:71]
    s_waitcnt lgkmcnt(0)
    v_mfma_f32_16x16x32_bf16 v[8:11], v[88:91], v[72:75], v[8:11]
    ds_read_b128 v[104:107], v232 offset:1024
    v_mfma_f32_16x16x32_bf16 v[12:15], v[92:95], v[72:75], v[12:15]
    ds_read_b64_tr_b16 v[120:121], v235 offset:8192
    buffer_load_dword v245, v187, s[28:31], 0 offen sc1
    v_mfma_f32_16x16x32_bf16 v[16:19], v[96:99], v[72:75], v[16:19]
    ds_read_b64_tr_b16 v[122:123], v235 offset:12288
    v_mfma_f32_16x16x32_bf16 v[20:23], v[100:103], v[72:75], v[20:23]
    ds_read_b64_tr_b16 v[124:125], v236 offset:8192
    v_mfma_f32_16x16x32_bf16 v[24:27], v[88:91], v[76:79], v[24:27]
    ds_read_b64_tr_b16 v[126:127], v236 offset:12288
    v_mfma_f32_16x16x32_bf16 v[28:31], v[92:95], v[76:79], v[28:31]
    ds_read_b128 v[108:111], v232 offset:3072
    v_mfma_f32_16x16x32_bf16 v[32:35], v[96:99], v[76:79], v[32:35]
    ds_read_b64_tr_b16 v[128:129], v237 offset:8192
    v_mfma_f32_16x16x32_bf16 v[36:39], v[100:103], v[76:79], v[36:39]
    ds_read_b64_tr_b16 v[130:131], v237 offset:12288
    v_mfma_f32_16x16x32_bf16 v[40:43], v[88:91], v[80:83], v[40:43]
    ds_read_b64_tr_b16 v[132:133], v238 offset:8192
    v_mfma_f32_16x16x32_bf16 v[44:47], v[92:95], v[80:83], v[44:47]
    ds_read_b64_tr_b16 v[134:135], v238 offset:12288
    v_mfma_f32_16x16x32_bf16 v[48:51], v[96:99], v[80:83], v[48:51]
    ds_read_b128 v[112:115], v232 offset:5120
    v_mfma_f32_16x16x32_bf16 v[52:55], v[100:103], v[80:83], v[52:55]
    ds_read_b128 v[116:119], v232 offset:7168
    v_mfma_f32_16x16x32_bf16 v[56:59], v[88:91], v[84:87], v[56:59]
    v_mfma_f32_16x16x32_bf16 v[60:63], v[92:95], v[84:87], v[60:63]
    v_mfma_f32_16x16x32_bf16 v[64:67], v[96:99], v[84:87], v[64:67]
    v_mfma_f32_16x16x32_bf16 v[68:71], v[100:103], v[84:87], v[68:71]
    s_waitcnt lgkmcnt(0)
    v_mfma_f32_16x16x32_bf16 v[8:11], v[120:123], v[104:107], v[8:11]
    v_mfma_f32_16x16x32_bf16 v[12:15], v[124:127], v[104:107], v[12:15]
    v_mfma_f32_16x16x32_bf16 v[16:19], v[128:131], v[104:107], v[16:19]
    v_mfma_f32_16x16x32_bf16 v[20:23], v[132:135], v[104:107], v[20:23]
    v_mfma_f32_16x16x32_bf16 v[24:27], v[120:123], v[108:111], v[24:27]
    v_mfma_f32_16x16x32_bf16 v[28:31], v[124:127], v[108:111], v[28:31]
    v_mfma_f32_16x16x32_bf16 v[32:35], v[128:131], v[108:111], v[32:35]
    v_mfma_f32_16x16x32_bf16 v[36:39], v[132:135], v[108:111], v[36:39]
    v_mfma_f32_16x16x32_bf16 v[40:43], v[120:123], v[112:115], v[40:43]
    v_mfma_f32_16x16x32_bf16 v[44:47], v[124:127], v[112:115], v[44:47]
    v_mfma_f32_16x16x32_bf16 v[48:51], v[128:131], v[112:115], v[48:51]
    v_mfma_f32_16x16x32_bf16 v[52:55], v[132:135], v[112:115], v[52:55]
    v_mfma_f32_16x16x32_bf16 v[56:59], v[120:123], v[116:119], v[56:59]
    v_mfma_f32_16x16x32_bf16 v[60:63], v[124:127], v[116:119], v[60:63]
    v_mfma_f32_16x16x32_bf16 v[64:67], v[128:131], v[116:119], v[64:67]
    v_mfma_f32_16x16x32_bf16 v[68:71], v[132:135], v[116:119], v[68:71]
    s_mov_b32 s3, 0x4000
    s_cmp_lg_u32 s49, 0
    s_cbranch_scc1 M_A
    v_cvt_pk_bf16_f32 v72, v8, v9
    v_cvt_pk_bf16_f32 v73, v10, v11
    v_cvt_pk_bf16_f32 v74, v12, v13
    v_cvt_pk_bf16_f32 v75, v14, v15
    buffer_store_dwordx4 v[72:75], v186, s[28:31], s80 offen offset:0 sc1
    v_cvt_pk_bf16_f32 v76, v16, v17
    v_cvt_pk_bf16_f32 v77, v18, v19
    v_cvt_pk_bf16_f32 v78, v20, v21
    v_cvt_pk_bf16_f32 v79, v22, v23
    buffer_store_dwordx4 v[76:79], v186, s[28:31], s80 offen offset:1024 sc1
    v_cvt_pk_bf16_f32 v80, v24, v25
    v_cvt_pk_bf16_f32 v81, v26, v27
    v_cvt_pk_bf16_f32 v82, v28, v29
    v_cvt_pk_bf16_f32 v83, v30, v31
    buffer_store_dwordx4 v[80:83], v186, s[28:31], s80 offen offset:2048 sc1
    v_cvt_pk_bf16_f32 v84, v32, v33
    v_cvt_pk_bf16_f32 v85, v34, v35
    v_cvt_pk_bf16_f32 v86, v36, v37
    v_cvt_pk_bf16_f32 v87, v38, v39
    buffer_store_dwordx4 v[84:87], v186, s[28:31], s80 offen offset:3072 sc1
    v_cvt_pk_bf16_f32 v88, v40, v41
    v_cvt_pk_bf16_f32 v89, v42, v43
    v_cvt_pk_bf16_f32 v90, v44, v45
    v_cvt_pk_bf16_f32 v91, v46, v47
    buffer_store_dwordx4 v[88:91], v186, s[28:31], s81 offen offset:0 sc1
    v_cvt_pk_bf16_f32 v92, v48, v49
    v_cvt_pk_bf16_f32 v93, v50, v51
    v_cvt_pk_bf16_f32 v94, v52, v53
    v_cvt_pk_bf16_f32 v95, v54, v55
    buffer_store_dwordx4 v[92:95], v186, s[28:31], s81 offen offset:1024 sc1
    v_cvt_pk_bf16_f32 v96, v56, v57
    v_cvt_pk_bf16_f32 v97, v58, v59
    v_cvt_pk_bf16_f32 v98, v60, v61
    v_cvt_pk_bf16_f32 v99, v62, v63
    buffer_store_dwordx4 v[96:99], v186, s[28:31], s81 offen offset:2048 sc1
    v_cvt_pk_bf16_f32 v100, v64, v65
    v_cvt_pk_bf16_f32 v101, v66, v67
    v_cvt_pk_bf16_f32 v102, v68, v69
    v_cvt_pk_bf16_f32 v103, v70, v71
    buffer_store_dwordx4 v[100:103], v186, s[28:31], s81 offen offset:3072 sc1
    v_mov_b32 v2, s0
    s_waitcnt vmcnt(0)
    s_mov_b64 exec, 1
    buffer_store_dword v2, v187, s[28:31], 0 offen sc1
    s_branch M_fin
M_poll:
    s_sub_u32 s3, s3, 1
    s_cbranch_scc1 M_got
    s_sleep 1
    buffer_load_dword v245, v187, s[28:31], 0 offen sc1
M_A:
    s_waitcnt vmcnt(0)
    v_readfirstlane_b32 s64, v245
    s_nop 3
    s_cmp_lg_u32 s64, s0
    s_cbranch_scc1 M_poll
M_got:
    s_nop 7
    buffer_load_dwordx4 v[72:75], v186, s[28:31], s80 offen offset:0 sc1
    buffer_load_dwordx4 v[76:79], v186, s[28:31], s80 offen offset:1024 sc1
    buffer_load_dwordx4 v[80:83], v186, s[28:31], s80 offen offset:2048 sc1
    buffer_load_dwordx4 v[84:87], v186, s[28:31], s80 offen offset:3072 sc1
    buffer_load_dwordx4 v[88:91], v186, s[28:31], s81 offen offset:0 sc1
    buffer_load_dwordx4 v[92:95], v186, s[28:31], s81 offen offset:1024 sc1
    buffer_load_dwordx4 v[96:99], v186, s[28:31], s81 offen offset:2048 sc1
    buffer_load_dwordx4 v[100:103], v186, s[28:31], s81 offen offset:3072 sc1
    v_lshlrev_b32 v200, 16, v136
    v_and_b32 v201, 0xffff0000, v136
    v_lshlrev_b32 v202, 16, v137
    v_and_b32 v203, 0xffff0000, v137
    v_lshlrev_b32 v204, 16, v138
    v_and_b32 v205, 0xffff0000, v138
    v_lshlrev_b32 v206, 16, v139
    v_and_b32 v207, 0xffff0000, v139
    s_waitcnt vmcnt(7)
    v_lshlrev_b32 v104, 16, v72
    v_and_b32 v105, 0xffff0000, v72
    v_lshlrev_b32 v106, 16, v73
    v_and_b32 v107, 0xffff0000, v73
    v_lshlrev_b32 v108, 16, v74
    v_and_b32 v109, 0xffff0000, v74
    v_lshlrev_b32 v110, 16, v75
    v_and_b32 v111, 0xffff0000, v75
    v_pk_add_f32 v[8:9], v[8:9], v[104:105]
    v_pk_add_f32 v[10:11], v[10:11], v[106:107]
    v_pk_add_f32 v[12:13], v[12:13], v[108:109]
    v_pk_add_f32 v[14:15], v[14:15], v[110:111]
    v_pk_fma_f32 v[200:201], v[8:9], v[168:169], v[200:201]
    v_pk_fma_f32 v[202:203], v[10:11], v[170:171], v[202:203]
    v_pk_fma_f32 v[204:205], v[12:13], v[172:173], v[204:205]
    v_pk_fma_f32 v[206:207], v[14:15], v[174:175], v[206:207]
    v_cvt_pk_bf16_f32 v136, v200, v201
    v_cvt_pk_bf16_f32 v137, v202, v203
    v_cvt_pk_bf16_f32 v138, v204, v205
    v_cvt_pk_bf16_f32 v139, v206, v207
    s_nop 0
    v_permlane16_swap_b32 v136, v138
    v_permlane16_swap_b32 v137, v139
    buffer_store_dwordx4 v[136:139], v184, s[40:43], s72 offen offset:0
    v_lshlrev_b32 v208, 16, v140
    v_and_b32 v209, 0xffff0000, v140
    v_lshlrev_b32 v210, 16, v141
    v_and_b32 v211, 0xffff0000, v141
    v_lshlrev_b32 v212, 16, v142
    v_and_b32 v213, 0xffff0000, v142
    v_lshlrev_b32 v214, 16, v143
    v_and_b32 v215, 0xffff0000, v143
    s_waitcnt vmcnt(7)
    v_lshlrev_b32 v112, 16, v76
    v_and_b32 v113, 0xffff0000, v76
    v_lshlrev_b32 v114, 16, v77
    v_and_b32 v115, 0xffff0000, v77
    v_lshlrev_b32 v116, 16, v78
    v_and_b32 v117, 0xffff0000, v78
    v_lshlrev_b32 v118, 16, v79
    v_and_b32 v119, 0xffff0000, v79
    v_pk_add_f32 v[16:17], v[16:17], v[112:113]
    v_pk_add_f32 v[18:19], v[18:19], v[114:115]
    v_pk_add_f32 v[20:21], v[20:21], v[116:117]
    v_pk_add_f32 v[22:23], v[22:23], v[118:119]
    v_pk_fma_f32 v[208:209], v[16:17], v[176:177], v[208:209]
    v_pk_fma_f32 v[210:211], v[18:19], v[178:179], v[210:211]
    v_pk_fma_f32 v[212:213], v[20:21], v[180:181], v[212:213]
    v_pk_fma_f32 v[214:215], v[22:23], v[182:183], v[214:215]
    v_cvt_pk_bf16_f32 v140, v208, v209
    v_cvt_pk_bf16_f32 v141, v210, v211
    v_cvt_pk_bf16_f32 v142, v212, v213
    v_cvt_pk_bf16_f32 v143, v214, v215
    s_nop 0
    v_permlane16_swap_b32 v140, v142
    v_permlane16_swap_b32 v141, v143
    buffer_store_dwordx4 v[140:143], v184, s[40:43], s72 offen offset:64
    v_lshlrev_b32 v200, 16, v144
    v_and_b32 v201, 0xffff0000, v144
    v_lshlrev_b32 v202, 16, v145
    v_and_b32 v203, 0xffff0000, v145
    v_lshlrev_b32 v204, 16, v146
    v_and_b32 v205, 0xffff0000, v146
    v_lshlrev_b32 v206, 16, v147
    v_and_b32 v207, 0xffff0000, v147
    s_waitcnt vmcnt(7)
    v_lshlrev_b32 v120, 16, v80
    v_and_b32 v121, 0xffff0000, v80
    v_lshlrev_b32 v122, 16, v81
    v_and_b32 v123, 0xffff0000, v81
    v_lshlrev_b32 v124, 16, v82
    v_and_b32 v125, 0xffff0000, v82
    v_lshlrev_b32 v126, 16, v83
    v_and_b32 v127, 0xffff0000, v83
    v_pk_add_f32 v[24:25], v[24:25], v[120:121]
    v_pk_add_f32 v[26:27], v[26:27], v[122:123]
    v_pk_add_f32 v[28:29], v[28:29], v[124:125]
    v_pk_add_f32 v[30:31], v[30:31], v[126:127]
    v_pk_fma_f32 v[200:201], v[24:25], v[168:169], v[200:201]
    v_pk_fma_f32 v[202:203], v[26:27], v[170:171], v[202:203]
    v_pk_fma_f32 v[204:205], v[28:29], v[172:173], v[204:205]
    v_pk_fma_f32 v[206:207], v[30:31], v[174:175], v[206:207]
    v_cvt_pk_bf16_f32 v144, v200, v201
    v_cvt_pk_bf16_f32 v145, v202, v203
    v_cvt_pk_bf16_f32 v146, v204, v205
    v_cvt_pk_bf16_f32 v147, v206, v207
    s_nop 0
    v_permlane16_swap_b32 v144, v146
    v_permlane16_swap_b32 v145, v147
    buffer_store_dwordx4 v[144:147], v184, s[40:43], s73 offen offset:0
    v_lshlrev_b32 v208, 16, v148
    v_and_b32 v209, 0xffff0000, v148
    v_lshlrev_b32 v210, 16, v149
    v_and_b32 v211, 0xffff0000, v149
    v_lshlrev_b32 v212, 16, v150
    v_and_b32 v213, 0xffff0000, v150
    v_lshlrev_b32 v214, 16, v151
    v_and_b32 v215, 0xffff0000, v151
    s_waitcnt vmcnt(7)
    v_lshlrev_b32 v128, 16, v84
    v_and_b32 v129, 0xffff0000, v84
    v_lshlrev_b32 v130, 16, v85
    v_and_b32 v131, 0xffff0000, v85
    v_lshlrev_b32 v132, 16, v86
    v_and_b32 v133, 0xffff0000, v86
    v_lshlrev_b32 v134, 16, v87
    v_and_b32 v135, 0xffff0000, v87
    v_pk_add_f32 v[32:33], v[32:33], v[128:129]
    v_pk_add_f32 v[34:35], v[34:35], v[130:131]
    v_pk_add_f32 v[36:37], v[36:37], v[132:133]
    v_pk_add_f32 v[38:39], v[38:39], v[134:135]
    v_pk_fma_f32 v[208:209], v[32:33], v[176:177], v[208:209]
    v_pk_fma_f32 v[210:211], v[34:35], v[178:179], v[210:211]
    v_pk_fma_f32 v[212:213], v[36:37], v[180:181], v[212:213]
    v_pk_fma_f32 v[214:215], v[38:39], v[182:183], v[214:215]
    v_cvt_pk_bf16_f32 v148, v208, v209
    v_cvt_pk_bf16_f32 v149, v210, v211
    v_cvt_pk_bf16_f32 v150, v212, v213
    v_cvt_pk_bf16_f32 v151, v214, v215
    s_nop 0
    v_permlane16_swap_b32 v148, v150
    v_permlane16_swap_b32 v149, v151
    buffer_store_dwordx4 v[148:151], v184, s[40:43], s73 offen offset:64
    v_lshlrev_b32 v200, 16, v152
    v_and_b32 v201, 0xffff0000, v152
    v_lshlrev_b32 v202, 16, v153
    v_and_b32 v203, 0xffff0000, v153
    v_lshlrev_b32 v204, 16, v154
    v_and_b32 v205, 0xffff0000, v154
    v_lshlrev_b32 v206, 16, v155
    v_and_b32 v207, 0xffff0000, v155
    s_waitcnt vmcnt(7)
    v_lshlrev_b32 v104, 16, v88
    v_and_b32 v105, 0xffff0000, v88
    v_lshlrev_b32 v106, 16, v89
    v_and_b32 v107, 0xffff0000, v89
    v_lshlrev_b32 v108, 16, v90
    v_and_b32 v109, 0xffff0000, v90
    v_lshlrev_b32 v110, 16, v91
    v_and_b32 v111, 0xffff0000, v91
    v_pk_add_f32 v[40:41], v[40:41], v[104:105]
    v_pk_add_f32 v[42:43], v[42:43], v[106:107]
    v_pk_add_f32 v[44:45], v[44:45], v[108:109]
    v_pk_add_f32 v[46:47], v[46:47], v[110:111]
    v_pk_fma_f32 v[200:201], v[40:41], v[168:169], v[200:201]
    v_pk_fma_f32 v[202:203], v[42:43], v[170:171], v[202:203]
    v_pk_fma_f32 v[204:205], v[44:45], v[172:173], v[204:205]
    v_pk_fma_f32 v[206:207], v[46:47], v[174:175], v[206:207]
    v_cvt_pk_bf16_f32 v152, v200, v201
    v_cvt_pk_bf16_f32 v153, v202, v203
    v_cvt_pk_bf16_f32 v154, v204, v205
    v_cvt_pk_bf16_f32 v155, v206, v207
    s_nop 0
    v_permlane16_swap_b32 v152, v154
    v_permlane16_swap_b32 v153, v155
    buffer_store_dwordx4 v[152:155], v184, s[40:43], s74 offen offset:0
    v_lshlrev_b32 v208, 16, v156
    v_and_b32 v209, 0xffff0000, v156
    v_lshlrev_b32 v210, 16, v157
    v_and_b32 v211, 0xffff0000, v157
    v_lshlrev_b32 v212, 16, v158
    v_and_b32 v213, 0xffff0000, v158
    v_lshlrev_b32 v214, 16, v159
    v_and_b32 v215, 0xffff0000, v159
    s_waitcnt vmcnt(7)
    v_lshlrev_b32 v112, 16, v92
    v_and_b32 v113, 0xffff0000, v92
    v_lshlrev_b32 v114, 16, v93
    v_and_b32 v115, 0xffff0000, v93
    v_lshlrev_b32 v116, 16, v94
    v_and_b32 v117, 0xffff0000, v94
    v_lshlrev_b32 v118, 16, v95
    v_and_b32 v119, 0xffff0000, v95
    v_pk_add_f32 v[48:49], v[48:49], v[112:113]
    v_pk_add_f32 v[50:51], v[50:51], v[114:115]
    v_pk_add_f32 v[52:53], v[52:53], v[116:117]
    v_pk_add_f32 v[54:55], v[54:55], v[118:119]
    v_pk_fma_f32 v[208:209], v[48:49], v[176:177], v[208:209]
    v_pk_fma_f32 v[210:211], v[50:51], v[178:179], v[210:211]
    v_pk_fma_f32 v[212:213], v[52:53], v[180:181], v[212:213]
    v_pk_fma_f32 v[214:215], v[54:55], v[182:183], v[214:215]
    v_cvt_pk_bf16_f32 v156, v208, v209
    v_cvt_pk_bf16_f32 v157, v210, v211
    v_cvt_pk_bf16_f32 v158, v212, v213
    v_cvt_pk_bf16_f32 v159, v214, v215
    s_nop 0
    v_permlane16_swap_b32 v156, v158
    v_permlane16_swap_b32 v157, v159
    buffer_store_dwordx4 v[156:159], v184, s[40:43], s74 offen offset:64
    v_lshlrev_b32 v200, 16, v160
    v_and_b32 v201, 0xffff0000, v160
    v_lshlrev_b32 v202, 16, v161
    v_and_b32 v203, 0xffff0000, v161
    v_lshlrev_b32 v204, 16, v162
    v_and_b32 v205, 0xffff0000, v162
    v_lshlrev_b32 v206, 16, v163
    v_and_b32 v207, 0xffff0000, v163
    s_waitcnt vmcnt(7)
    v_lshlrev_b32 v120, 16, v96
    v_and_b32 v121, 0xffff0000, v96
    v_lshlrev_b32 v122, 16, v97
    v_and_b32 v123, 0xffff0000, v97
    v_lshlrev_b32 v124, 16, v98
    v_and_b32 v125, 0xffff0000, v98
    v_lshlrev_b32 v126, 16, v99
    v_and_b32 v127, 0xffff0000, v99
    v_pk_add_f32 v[56:57], v[56:57], v[120:121]
    v_pk_add_f32 v[58:59], v[58:59], v[122:123]
    v_pk_add_f32 v[60:61], v[60:61], v[124:125]
    v_pk_add_f32 v[62:63], v[62:63], v[126:127]
    v_pk_fma_f32 v[200:201], v[56:57], v[168:169], v[200:201]
    v_pk_fma_f32 v[202:203], v[58:59], v[170:171], v[202:203]
    v_pk_fma_f32 v[204:205], v[60:61], v[172:173], v[204:205]
    v_pk_fma_f32 v[206:207], v[62:63], v[174:175], v[206:207]
    v_cvt_pk_bf16_f32 v160, v200, v201
    v_cvt_pk_bf16_f32 v161, v202, v203
    v_cvt_pk_bf16_f32 v162, v204, v205
    v_cvt_pk_bf16_f32 v163, v206, v207
    s_nop 0
    v_permlane16_swap_b32 v160, v162
    v_permlane16_swap_b32 v161, v163
    buffer_store_dwordx4 v[160:163], v184, s[40:43], s75 offen offset:0
    v_lshlrev_b32 v208, 16, v164
    v_and_b32 v209, 0xffff0000, v164
    v_lshlrev_b32 v210, 16, v165
    v_and_b32 v211, 0xffff0000, v165
    v_lshlrev_b32 v212, 16, v166
    v_and_b32 v213, 0xffff0000, v166
    v_lshlrev_b32 v214, 16, v167
    v_and_b32 v215, 0xffff0000, v167
    s_waitcnt vmcnt(7)
    v_lshlrev_b32 v128, 16, v100
    v_and_b32 v129, 0xffff0000, v100
    v_lshlrev_b32 v130, 16, v101
    v_and_b32 v131, 0xffff0000, v101
    v_lshlrev_b32 v132, 16, v102
    v_and_b32 v133, 0xffff0000, v102
    v_lshlrev_b32 v134, 16, v103
    v_and_b32 v135, 0xffff0000, v103
    v_pk_add_f32 v[64:65], v[64:65], v[128:129]
    v_pk_add_f32 v[66:67], v[66:67], v[130:131]
    v_pk_add_f32 v[68:69], v[68:69], v[132:133]
    v_pk_add_f32 v[70:71], v[70:71], v[134:135]
    v_pk_fma_f32 v[208:209], v[64:65], v[176:177], v[208:209]
    v_pk_fma_f32 v[210:211], v[66:67], v[178:179], v[210:211]
    v_pk_fma_f32 v[212:213], v[68:69], v[180:181], v[212:213]
    v_pk_fma_f32 v[214:215], v[70:71], v[182:183], v[214:215]
    v_cvt_pk_bf16_f32 v164, v208, v209
    v_cvt_pk_bf16_f32 v165, v210, v211
    v_cvt_pk_bf16_f32 v166, v212, v213
    v_cvt_pk_bf16_f32 v167, v214, v215
    s_nop 0
    v_permlane16_swap_b32 v164, v166
    v_permlane16_swap_b32 v165, v167
    buffer_store_dwordx4 v[164:167], v184, s[40:43], s75 offen offset:64
    s_branch M_fin
M_Pidle:
    s_nop 7
    s_barrier
    s_lshl_b32 s70, s48, 12
    s_lshl_b32 s64, s47, 3
    s_lshl_b32 s65, s45, 2
    s_add_u32 s64, s64, s65
    s_mul_i32 s64, s64, 114688
    s_add_u32 s64, s64, s70
    s_lshl_b32 s65, s46, 11
    s_add_u32 s64, s64, s65
    s_add_u32 s64, s64, 0x1500000
    v_lshl_add_u32 v198, v1, 4, s64
    v_mul_f32 v24, v8, v24
    v_exp_f32 v216, -v8
    v_mul_f32 v25, v9, v25
    v_exp_f32 v217, -v9
    v_mul_f32 v26, v10, v26
    v_exp_f32 v218, -v10
    v_mul_f32 v27, v11, v27
    v_exp_f32 v219, -v11
    v_mul_f32 v28, v12, v28
    v_exp_f32 v220, -v12
    v_mul_f32 v29, v13, v29
    v_exp_f32 v221, -v13
    v_mul_f32 v30, v14, v30
    v_exp_f32 v222, -v14
    v_mul_f32 v31, v15, v31
    v_exp_f32 v223, -v15
    v_fma_f32 v216, v216, s67, s67
    v_fma_f32 v217, v217, s67, s67
    v_rcp_f32 v216, v216
    v_fma_f32 v218, v218, s67, s67
    v_rcp_f32 v217, v217
    v_fma_f32 v219, v219, s67, s67
    v_rcp_f32 v218, v218
    v_fma_f32 v220, v220, s67, s67
    v_rcp_f32 v219, v219
    v_fma_f32 v221, v221, s67, s67
    v_rcp_f32 v220, v220
    v_fma_f32 v222, v222, s67, s67
    v_rcp_f32 v221, v221
    v_fma_f32 v223, v223, s67, s67
    v_rcp_f32 v222, v222
    v_rcp_f32 v223, v223
    v_mul_f32 v24, v24, v216
    v_mul_f32 v25, v25, v217
    v_mul_f32 v26, v26, v218
    v_mul_f32 v27, v27, v219
    v_mul_f32 v28, v28, v220
    v_mul_f32 v29, v29, v221
    v_mul_f32 v30, v30, v222
    v_mul_f32 v31, v31, v223
    v_cvt_pk_bf16_f32 v200, v24, v25
    v_cvt_pk_bf16_f32 v201, v26, v27
    v_cvt_pk_bf16_f32 v202, v28, v29
    v_cvt_pk_bf16_f32 v203, v30, v31
    buffer_store_dwordx4 v[200:203], v198, s[28:31], 0 offen offset:0 sc1
    v_mul_f32 v32, v16, v32
    v_exp_f32 v224, -v16
    v_mul_f32 v33, v17, v33
    v_exp_f32 v225, -v17
    v_mul_f32 v34, v18, v34
    v_exp_f32 v226, -v18
    v_mul_f32 v35, v19, v35
    v_exp_f32 v227, -v19
    v_mul_f32 v36, v20, v36
    v_exp_f32 v228, -v20
    v_mul_f32 v37, v21, v37
    v_exp_f32 v229, -v21
    v_mul_f32 v38, v22, v38
    v_exp_f32 v230, -v22
    v_mul_f32 v39, v23, v39
    v_exp_f32 v231, -v23
    v_fma_f32 v224, v224, s67, s67
    v_fma_f32 v225, v225, s67, s67
    v_rcp_f32 v224, v224
    v_fma_f32 v226, v226, s67, s67
    v_rcp_f32 v225, v225
    v_fma_f32 v227, v227, s67, s67
    v_rcp_f32 v226, v226
    v_fma_f32 v228, v228, s67, s67
    v_rcp_f32 v227, v227
    v_fma_f32 v229, v229, s67, s67
    v_rcp_f32 v228, v228
    v_fma_f32 v230, v230, s67, s67
    v_rcp_f32 v229, v229
    v_fma_f32 v231, v231, s67, s67
    v_rcp_f32 v230, v230
    v_rcp_f32 v231, v231
    v_mul_f32 v32, v32, v224
    v_mul_f32 v33, v33, v225
    v_mul_f32 v34, v34, v226
    v_mul_f32 v35, v35, v227
    v_mul_f32 v36, v36, v228
    v_mul_f32 v37, v37, v229
    v_mul_f32 v38, v38, v230
    v_mul_f32 v39, v39, v231
    v_cvt_pk_bf16_f32 v204, v32, v33
    v_cvt_pk_bf16_f32 v205, v34, v35
    v_cvt_pk_bf16_f32 v206, v36, v37
    v_cvt_pk_bf16_f32 v207, v38, v39
    buffer_store_dwordx4 v[204:207], v198, s[28:31], 0 offen offset:1024 sc1
    v_add_u32 v198, 114688, v198
    v_mul_f32 v56, v40, v56
    v_exp_f32 v216, -v40
    v_mul_f32 v57, v41, v57
    v_exp_f32 v217, -v41
    v_mul_f32 v58, v42, v58
    v_exp_f32 v218, -v42
    v_mul_f32 v59, v43, v59
    v_exp_f32 v219, -v43
    v_mul_f32 v60, v44, v60
    v_exp_f32 v220, -v44
    v_mul_f32 v61, v45, v61
    v_exp_f32 v221, -v45
    v_mul_f32 v62, v46, v62
    v_exp_f32 v222, -v46
    v_mul_f32 v63, v47, v63
    v_exp_f32 v223, -v47
    v_fma_f32 v216, v216, s67, s67
    v_fma_f32 v217, v217, s67, s67
    v_rcp_f32 v216, v216
    v_fma_f32 v218, v218, s67, s67
    v_rcp_f32 v217, v217
    v_fma_f32 v219, v219, s67, s67
    v_rcp_f32 v218, v218
    v_fma_f32 v220, v220, s67, s67
    v_rcp_f32 v219, v219
    v_fma_f32 v221, v221, s67, s67
    v_rcp_f32 v220, v220
    v_fma_f32 v222, v222, s67, s67
    v_rcp_f32 v221, v221
    v_fma_f32 v223, v223, s67, s67
    v_rcp_f32 v222, v222
    v_rcp_f32 v223, v223
    v_mul_f32 v56, v56, v216
    v_mul_f32 v57, v57, v217
    v_mul_f32 v58, v58, v218
    v_mul_f32 v59, v59, v219
    v_mul_f32 v60, v60, v220
    v_mul_f32 v61, v61, v221
    v_mul_f32 v62, v62, v222
    v_mul_f32 v63, v63, v223
    v_cvt_pk_bf16_f32 v208, v56, v57
    v_cvt_pk_bf16_f32 v209, v58, v59
    v_cvt_pk_bf16_f32 v210, v60, v61
    v_cvt_pk_bf16_f32 v211, v62, v63
    buffer_store_dwordx4 v[208:211], v198, s[28:31], 0 offen offset:0 sc1
    v_mul_f32 v64, v48, v64
    v_exp_f32 v224, -v48
    v_mul_f32 v65, v49, v65
    v_exp_f32 v225, -v49
    v_mul_f32 v66, v50, v66
    v_exp_f32 v226, -v50
    v_mul_f32 v67, v51, v67
    v_exp_f32 v227, -v51
    v_mul_f32 v68, v52, v68
    v_exp_f32 v228, -v52
    v_mul_f32 v69, v53, v69
    v_exp_f32 v229, -v53
    v_mul_f32 v70, v54, v70
    v_exp_f32 v230, -v54
    v_mul_f32 v71, v55, v71
    v_exp_f32 v231, -v55
    v_fma_f32 v224, v224, s67, s67
    v_fma_f32 v225, v225, s67, s67
    v_rcp_f32 v224, v224
    v_fma_f32 v226, v226, s67, s67
    v_rcp_f32 v225, v225
    v_fma_f32 v227, v227, s67, s67
    v_rcp_f32 v226, v226
    v_fma_f32 v228, v228, s67, s67
    v_rcp_f32 v227, v227
    v_fma_f32 v229, v229, s67, s67
    v_rcp_f32 v228, v228
    v_fma_f32 v230, v230, s67, s67
    v_rcp_f32 v229, v229
    v_fma_f32 v231, v231, s67, s67
    v_rcp_f32 v230, v230
    v_rcp_f32 v231, v231
    v_mul_f32 v64, v64, v224
    v_mul_f32 v65, v65, v225
    v_mul_f32 v66, v66, v226
    v_mul_f32 v67, v67, v227
    v_mul_f32 v68, v68, v228
    v_mul_f32 v69, v69, v229
    v_mul_f32 v70, v70, v230
    v_mul_f32 v71, v71, v231
    v_cvt_pk_bf16_f32 v212, v64, v65
    v_cvt_pk_bf16_f32 v213, v66, v67
    v_cvt_pk_bf16_f32 v214, v68, v69
    v_cvt_pk_bf16_f32 v215, v70, v71
    buffer_store_dwordx4 v[212:215], v198, s[28:31], 0 offen offset:1024 sc1
    v_add_u32 v198, 114688, v198
    v_mul_f32 v88, v72, v88
    v_exp_f32 v216, -v72
    v_mul_f32 v89, v73, v89
    v_exp_f32 v217, -v73
    v_mul_f32 v90, v74, v90
    v_exp_f32 v218, -v74
    v_mul_f32 v91, v75, v91
    v_exp_f32 v219, -v75
    v_mul_f32 v92, v76, v92
    v_exp_f32 v220, -v76
    v_mul_f32 v93, v77, v93
    v_exp_f32 v221, -v77
    v_mul_f32 v94, v78, v94
    v_exp_f32 v222, -v78
    v_mul_f32 v95, v79, v95
    v_exp_f32 v223, -v79
    v_fma_f32 v216, v216, s67, s67
    v_fma_f32 v217, v217, s67, s67
    v_rcp_f32 v216, v216
    v_fma_f32 v218, v218, s67, s67
    v_rcp_f32 v217, v217
    v_fma_f32 v219, v219, s67, s67
    v_rcp_f32 v218, v218
    v_fma_f32 v220, v220, s67, s67
    v_rcp_f32 v219, v219
    v_fma_f32 v221, v221, s67, s67
    v_rcp_f32 v220, v220
    v_fma_f32 v222, v222, s67, s67
    v_rcp_f32 v221, v221
    v_fma_f32 v223, v223, s67, s67
    v_rcp_f32 v222, v222
    v_rcp_f32 v223, v223
    v_mul_f32 v88, v88, v216
    v_mul_f32 v89, v89, v217
    v_mul_f32 v90, v90, v218
    v_mul_f32 v91, v91, v219
    v_mul_f32 v92, v92, v220
    v_mul_f32 v93, v93, v221
    v_mul_f32 v94, v94, v222
    v_mul_f32 v95, v95, v223
    v_cvt_pk_bf16_f32 v200, v88, v89
    v_cvt_pk_bf16_f32 v201, v90, v91
    v_cvt_pk_bf16_f32 v202, v92, v93
    v_cvt_pk_bf16_f32 v203, v94, v95
    buffer_store_dwordx4 v[200:203], v198, s[28:31], 0 offen offset:0 sc1
    v_mul_f32 v96, v80, v96
    v_exp_f32 v224, -v80
    v_mul_f32 v97, v81, v97
    v_exp_f32 v225, -v81
    v_mul_f32 v98, v82, v98
    v_exp_f32 v226, -v82
    v_mul_f32 v99, v83, v99
    v_exp_f32 v227, -v83
    v_mul_f32 v100, v84, v100
    v_exp_f32 v228, -v84
    v_mul_f32 v101, v85, v101
    v_exp_f32 v229, -v85
    v_mul_f32 v102, v86, v102
    v_exp_f32 v230, -v86
    v_mul_f32 v103, v87, v103
    v_exp_f32 v231, -v87
    v_fma_f32 v224, v224, s67, s67
    v_fma_f32 v225, v225, s67, s67
    v_rcp_f32 v224, v224
    v_fma_f32 v226, v226, s67, s67
    v_rcp_f32 v225, v225
    v_fma_f32 v227, v227, s67, s67
    v_rcp_f32 v226, v226
    v_fma_f32 v228, v228, s67, s67
    v_rcp_f32 v227, v227
    v_fma_f32 v229, v229, s67, s67
    v_rcp_f32 v228, v228
    v_fma_f32 v230, v230, s67, s67
    v_rcp_f32 v229, v229
    v_fma_f32 v231, v231, s67, s67
    v_rcp_f32 v230, v230
    v_rcp_f32 v231, v231
    v_mul_f32 v96, v96, v224
    v_mul_f32 v97, v97, v225
    v_mul_f32 v98, v98, v226
    v_mul_f32 v99, v99, v227
    v_mul_f32 v100, v100, v228
    v_mul_f32 v101, v101, v229
    v_mul_f32 v102, v102, v230
    v_mul_f32 v103, v103, v231
    v_cvt_pk_bf16_f32 v204, v96, v97
    v_cvt_pk_bf16_f32 v205, v98, v99
    v_cvt_pk_bf16_f32 v206, v100, v101
    v_cvt_pk_bf16_f32 v207, v102, v103
    buffer_store_dwordx4 v[204:207], v198, s[28:31], 0 offen offset:1024 sc1
    v_add_u32 v198, 114688, v198
    v_mul_f32 v120, v104, v120
    v_exp_f32 v216, -v104
    v_mul_f32 v121, v105, v121
    v_exp_f32 v217, -v105
    v_mul_f32 v122, v106, v122
    v_exp_f32 v218, -v106
    v_mul_f32 v123, v107, v123
    v_exp_f32 v219, -v107
    v_mul_f32 v124, v108, v124
    v_exp_f32 v220, -v108
    v_mul_f32 v125, v109, v125
    v_exp_f32 v221, -v109
    v_mul_f32 v126, v110, v126
    v_exp_f32 v222, -v110
    v_mul_f32 v127, v111, v127
    v_exp_f32 v223, -v111
    v_fma_f32 v216, v216, s67, s67
    v_fma_f32 v217, v217, s67, s67
    v_rcp_f32 v216, v216
    v_fma_f32 v218, v218, s67, s67
    v_rcp_f32 v217, v217
    v_fma_f32 v219, v219, s67, s67
    v_rcp_f32 v218, v218
    v_fma_f32 v220, v220, s67, s67
    v_rcp_f32 v219, v219
    v_fma_f32 v221, v221, s67, s67
    v_rcp_f32 v220, v220
    v_fma_f32 v222, v222, s67, s67
    v_rcp_f32 v221, v221
    v_fma_f32 v223, v223, s67, s67
    v_rcp_f32 v222, v222
    v_rcp_f32 v223, v223
    v_mul_f32 v120, v120, v216
    v_mul_f32 v121, v121, v217
    v_mul_f32 v122, v122, v218
    v_mul_f32 v123, v123, v219
    v_mul_f32 v124, v124, v220
    v_mul_f32 v125, v125, v221
    v_mul_f32 v126, v126, v222
    v_mul_f32 v127, v127, v223
    v_cvt_pk_bf16_f32 v208, v120, v121
    v_cvt_pk_bf16_f32 v209, v122, v123
    v_cvt_pk_bf16_f32 v210, v124, v125
    v_cvt_pk_bf16_f32 v211, v126, v127
    buffer_store_dwordx4 v[208:211], v198, s[28:31], 0 offen offset:0 sc1
    v_mul_f32 v128, v112, v128
    v_exp_f32 v224, -v112
    v_mul_f32 v129, v113, v129
    v_exp_f32 v225, -v113
    v_mul_f32 v130, v114, v130
    v_exp_f32 v226, -v114
    v_mul_f32 v131, v115, v131
    v_exp_f32 v227, -v115
    v_mul_f32 v132, v116, v132
    v_exp_f32 v228, -v116
    v_mul_f32 v133, v117, v133
    v_exp_f32 v229, -v117
    v_mul_f32 v134, v118, v134
    v_exp_f32 v230, -v118
    v_mul_f32 v135, v119, v135
    v_exp_f32 v231, -v119
    v_fma_f32 v224, v224, s67, s67
    v_fma_f32 v225, v225, s67, s67
    v_rcp_f32 v224, v224
    v_fma_f32 v226, v226, s67, s67
    v_rcp_f32 v225, v225
    v_fma_f32 v227, v227, s67, s67
    v_rcp_f32 v226, v226
    v_fma_f32 v228, v228, s67, s67
    v_rcp_f32 v227, v227
    v_fma_f32 v229, v229, s67, s67
    v_rcp_f32 v228, v228
    v_fma_f32 v230, v230, s67, s67
    v_rcp_f32 v229, v229
    v_fma_f32 v231, v231, s67, s67
    v_rcp_f32 v230, v230
    v_rcp_f32 v231, v231
    v_mul_f32 v128, v128, v224
    v_mul_f32 v129, v129, v225
    v_mul_f32 v130, v130, v226
    v_mul_f32 v131, v131, v227
    v_mul_f32 v132, v132, v228
    v_mul_f32 v133, v133, v229
    v_mul_f32 v134, v134, v230
    v_mul_f32 v135, v135, v231
    v_cvt_pk_bf16_f32 v212, v128, v129
    v_cvt_pk_bf16_f32 v213, v130, v131
    v_cvt_pk_bf16_f32 v214, v132, v133
    v_cvt_pk_bf16_f32 v215, v134, v135
    buffer_store_dwordx4 v[212:215], v198, s[28:31], 0 offen offset:1024 sc1
    s_lshl_b32 s64, s50, 3
    s_lshl_b32 s65, s44, 1
    s_add_u32 s64, s64, s65
    s_mul_i32 s64, s64, 114688
    s_add_u32 s64, s64, 0x1500000
    v_lshl_add_u32 v192, v1, 4, s64
    v_add_u32 v193, 112640, v192
    s_lshl_b32 s65, s51, 8
    v_lshrrev_b32 v3, 4, v1
    s_lshl_b32 s64, s44, 4
    v_add_u32 v2, s64, v3
    s_movk_i32 s64, 2048
    v_mul_u32_u24 v2, s64, v2
    v_add_u32 v2, s65, v2
    v_lshlrev_b32 v3, 1, v3
    v_and_b32 v4, 15, v1
    v_xor_b32 v3, v3, v4
    v_lshl_add_u32 v194, v3, 4, v2
    v_add_u32 v196, 14336, v194
    v_xor_b32 v3, 8, v3
    v_lshl_add_u32 v195, v3, 4, v2
    v_add_u32 v195, 7168, v195
    v_add_u32 v197, 14336, v195
    s_lshl_b32 s64, s47, 8
    s_lshl_b32 s65, s48, 4
    s_add_u32 s64, s64, s65
    s_lshl_b32 s65, s44, 2
    s_add_u32 s64, s64, s65
    s_add_u32 s64, s64, 0x51000
    v_mov_b32 v2, s0
    s_waitcnt vmcnt(0)
    s_mov_b64 exec, 1
    buffer_store_dword v2, v234, s[28:31], s64 offen sc1
    s_mov_b64 exec, -1
    s_barrier
    s_lshl_b32 s68, s50, 8
    s_add_u32 s68, s68, 0x51000
    buffer_load_dword v245, v234, s[28:31], s68 offen sc1
    s_waitcnt vmcnt(0)
    s_branch M_Pjoin
M_Q:
    s_setprio 0
    s_sub_u32 s44, s44, 4
    s_lshl_b32 s62, s47, 4
    s_add_u32 s62, s62, s48
    s_lshl_b32 s62, s62, 2
    s_add_u32 s62, s62, s44
    s_lshl_b32 s64, s62, 12
    v_lshl_add_u32 v2, v1, 4, s64
    s_waitcnt lgkmcnt(0)
    s_load_dword s0, s[26:27], 0
    s_mov_b32 s40, s4
    s_mov_b32 s41, s5
    s_mov_b32 s42, 0x400000
    s_mov_b32 s43, 0x20000
    buffer_load_dwordx4 v[104:107], v2, s[40:43], 0 offen offset:0
    buffer_load_dwordx4 v[108:111], v2, s[40:43], 0 offen offset:1024
    buffer_load_dwordx4 v[112:115], v2, s[40:43], 0 offen offset:2048
    buffer_load_dwordx4 v[116:119], v2, s[40:43], 0 offen offset:3072
    s_barrier
    s_or_b32 s65, s48, s44
    s_cmp_lg_u32 s65, 0
    s_cbranch_scc1 M_noclr
    s_lshl_b32 s64, s47, 9
    s_add_u32 s64, s64, 0x54000
    s_add_u32 s56, s26, s64
    s_addc_u32 s57, s27, 0
    s_mov_b32 s84, 0
    s_mov_b32 s85, 0
    s_mov_b32 s86, 0
    s_mov_b32 s87, 0
    s_mov_b32 s88, 0
    s_mov_b32 s89, 0
    s_mov_b32 s90, 0
    s_mov_b32 s91, 0
    s_mov_b32 s92, 0
    s_mov_b32 s93, 0
    s_mov_b32 s94, 0
    s_mov_b32 s95, 0
    s_atomic_swap s84, s[56:57], 0 glc
    s_atomic_swap s85, s[56:57], 128 glc
    s_atomic_swap s86, s[56:57], 256 glc
    s_atomic_swap s87, s[56:57], 384 glc
    s_atomic_swap s88, s[56:57], 8192 glc
    s_atomic_swap s89, s[56:57], 8320 glc
    s_atomic_swap s90, s[56:57], 8448 glc
    s_atomic_swap s91, s[56:57], 8576 glc
    s_atomic_swap s92, s[56:57], 16384 glc
    s_atomic_swap s93, s[56:57], 16512 glc
    s_atomic_swap s94, s[56:57], 16640 glc
    s_atomic_swap s95, s[56:57], 16768 glc
M_noclr:
    v_bfe_u32 v2, v0, 3, 5
    v_and_b32 v3, 7, v0
    v_lshlrev_b32 v14, 5, v3
    v_add_u32 v14, 149504, v14
    s_lshl_b32 s64, s48, 7
    v_lshl_add_u32 v4, v3, 4, s64
    s_lshl_b32 s70, s47, 7
    v_add_u32 v12, s70, v2
    v_lshl_add_u32 v8, v12, 11, v4
    s_max_u32 s70, s70, 16
    s_sub_u32 s70, s70, 16
    v_and_b32 v5, 15, v2
    v_add_u32 v13, s70, v5
    v_lshl_add_u32 v9, v13, 11, v4
    v_and_b32 v4, 7, v2
    v_lshlrev_b32 v4, 3, v4
    v_add_u32 v4, 0x10000, v4
    v_lshrrev_b32 v12, 3, v12
    v_lshl_add_u32 v12, v12, 7, v4
    v_lshrrev_b32 v13, 3, v13
    v_lshl_add_u32 v13, v13, 7, v4
    v_lshlrev_b32 v3, 8, v3
    v_lshl_add_u32 v3, v5, 4, v3
    s_mul_i32 s64, s47, 294912
    s_lshl_b32 s65, s48, 11
    s_add_u32 s64, s64, s65
    s_add_u32 s64, s64, 0x100000
    s_cmp_ge_u32 s44, 2
    s_cselect_b32 s65, 0x80000000, s64
    v_add_u32 v11, s65, v3
    s_cselect_b32 s65, 32768, 0
    s_add_u32 s64, s64, s65
    s_add_u32 s64, s64, 32768
    v_add_u32 v10, s64, v3
    v_mov_b32 v19, v3
    s_lshr_b32 s64, s44, 1
    s_lshl_b32 s64, s64, 11
    s_add_u32 s64, s64, 2048
    v_add_u32 v15, s64, v3
    s_mov_b32 s53, 0
    s_lshl_b32 s72, s44, 12
    s_add_u32 s72, s72, 2048
    s_lshl_b32 s73, s44, 9
    s_mul_i32 s74, s44, 6144
    s_add_u32 s74, s74, 18432
    s_add_u32 s75, s74, 4096
    s_bfe_u32 s66, s2, 0x30003
    s_lshr_b32 s55, s2, 6
    s_add_u32 s66, s66, s55
    s_and_b32 s66, s66, 3
    s_mov_b32 s58, 0x76453210
    s_mov_b32 s59, 0xfecdba89
    s_cmp_eq_u32 s66, 1
    s_cselect_b32 s58, 0x75643120, s58
    s_cselect_b32 s59, 0xfdecb9a8, s59
    s_cmp_eq_u32 s66, 2
    s_cselect_b32 s58, 0x67542310, s58
    s_cselect_b32 s59, 0xefdcab98, s59
    s_cmp_eq_u32 s66, 3
    s_cselect_b32 s58, 0x86534210, s58
    s_cselect_b32 s59, 0xfedbca97, s59
    s_lshl_b32 s55, s48, 2
    s_lshr_b64 s[56:57], s[58:59], s55
    s_and_b32 s55, s56, 15
    s_lshl_b32 s55, s55, 2
    s_lshl_b64 s[56:57], 15, s55
    s_andn2_b64 s[58:59], s[58:59], s[56:57]
    s_or_b32 s58, s58, s48
    s_lshl_b32 s65, s48, 7
    s_mul_i32 s64, s44, 98304
    s_add_u32 s65, s65, s64
    s_movk_i32 s64, 6144
    v_add_u32 v2, 0, v1
    v_mul_u32_u24 v3, 0xab, v2
    v_lshrrev_b32 v3, 12, v3
    v_mul_u32_u24 v4, 24, v3
    v_sub_u32 v2, v2, v4
    v_and_b32 v4, 2, v3
    v_lshrrev_b32 v5, 3, v3
    v_lshl_or_b32 v4, v5, 2, v4
    v_xor_b32 v2, v2, v4
    v_mul_u32_u24 v3, s64, v3
    v_lshrrev_b32 v4, 3, v2
    v_lshl_add_u32 v3, v4, 11, v3
    v_and_b32 v2, 7, v2
    v_lshl_add_u32 v3, v2, 4, v3
    v_add_u32 v187, s65, v3
    v_add_u32 v2, 64, v1
    v_mul_u32_u24 v3, 0xab, v2
    v_lshrrev_b32 v3, 12, v3
    v_mul_u32_u24 v4, 24, v3
    v_sub_u32 v2, v2, v4
    v_and_b32 v4, 2, v3
    v_lshrrev_b32 v5, 3, v3
    v_lshl_or_b32 v4, v5, 2, v4
    v_xor_b32 v2, v2, v4
    v_mul_u32_u24 v3, s64, v3
    v_lshrrev_b32 v4, 3, v2
    v_lshl_add_u32 v3, v4, 11, v3
    v_and_b32 v2, 7, v2
    v_lshl_add_u32 v3, v2, 4, v3
    v_subrev_u32 v3, 1024, v3
    v_add_u32 v188, s65, v3
    v_add_u32 v2, 128, v1
    v_mul_u32_u24 v3, 0xab, v2
    v_lshrrev_b32 v3, 12, v3
    v_mul_u32_u24 v4, 24, v3
    v_sub_u32 v2, v2, v4
    v_and_b32 v4, 2, v3
    v_lshrrev_b32 v5, 3, v3
    v_lshl_or_b32 v4, v5, 2, v4
    v_xor_b32 v2, v2, v4
    v_mul_u32_u24 v3, s64, v3
    v_lshrrev_b32 v4, 3, v2
    v_lshl_add_u32 v3, v4, 11, v3
    v_and_b32 v2, 7, v2
    v_lshl_add_u32 v3, v2, 4, v3
    v_subrev_u32 v3, 2048, v3
    v_add_u32 v189, s65, v3
    v_add_u32 v2, 192, v1
    v_mul_u32_u24 v3, 0xab, v2
    v_lshrrev_b32 v3, 12, v3
    v_mul_u32_u24 v4, 24, v3
    v_sub_u32 v2, v2, v4
    v_and_b32 v4, 2, v3
    v_lshrrev_b32 v5, 3, v3
    v_lshl_or_b32 v4, v5, 2, v4
    v_xor_b32 v2, v2, v4
    v_mul_u32_u24 v3, s64, v3
    v_lshrrev_b32 v4, 3, v2
    v_lshl_add_u32 v3, v4, 11, v3
    v_and_b32 v2, 7, v2
    v_lshl_add_u32 v3, v2, 4, v3
    v_subrev_u32 v3, 3072, v3
    v_add_u32 v190, s65, v3
    v_add_u32 v2, 256, v1
    v_mul_u32_u24 v3, 0xab, v2
    v_lshrrev_b32 v3, 12, v3
    v_mul_u32_u24 v4, 24, v3
    v_sub_u32 v2, v2, v4
    v_and_b32 v4, 2, v3
    v_lshrrev_b32 v5, 3, v3
    v_lshl_or_b32 v4, v5, 2, v4
    v_xor_b32 v2, v2, v4
    v_mul_u32_u24 v3, s64, v3
    v_lshrrev_b32 v4, 3, v2
    v_lshl_add_u32 v3, v4, 11, v3
    v_and_b32 v2, 7, v2
    v_lshl_add_u32 v3, v2, 4, v3
    v_add_u32 v191, s65, v3
    v_add_u32 v2, 320, v1
    v_mul_u32_u24 v3, 0xab, v2
    v_lshrrev_b32 v3, 12, v3
    v_mul_u32_u24 v4, 24, v3
    v_sub_u32 v2, v2, v4
    v_and_b32 v4, 2, v3
    v_lshrrev_b32 v5, 3, v3
    v_lshl_or_b32 v4, v5, 2, v4
    v_xor_b32 v2, v2, v4
    v_mul_u32_u24 v3, s64, v3
    v_lshrrev_b32 v4, 3, v2
    v_lshl_add_u32 v3, v4, 11, v3
    v_and_b32 v2, 7, v2
    v_lshl_add_u32 v3, v2, 4, v3
    v_subrev_u32 v3, 1024, v3
    v_add_u32 v192, s65, v3
    s_mul_i32 s64, s47, 294912
    s_add_u32 s64, s64, 0x100000
    s_add_u32 s65, s64, s73
    v_lshl_add_u32 v186, v1, 4, s65
    s_mul_i32 s65, s44, 65536
    s_add_u32 s64, s64, s65
    s_add_u32 s64, s64, 32768
    v_lshl_add_u32 v184, v1, 4, s64
    v_add_u32 v185, 30720, v184
    s_mov_b32 s32, s6
    s_mov_b32 s33, s7
    s_mov_b32 s34, 0x600000
    s_mov_b32 s35, 0x20000
    s_mov_b32 s28, s26
    s_mov_b32 s29, s27
    s_mov_b32 s30, 0x3000000
    s_mov_b32 s31, 0x20000
    s_lshr_b32 s45, s44, 1
    s_and_b32 s46, s44, 1
    s_bfe_u32 s49, s2, 0x10003
    s_and_b32 s50, s2, 3
    s_lshl_b32 s50, s50, 2
    s_bfe_u32 s64, s2, 0x20004
    s_add_u32 s50, s50, s64
    s_and_b32 s51, s2, 4
    s_lshr_b32 s64, s2, 6
    s_add_u32 s51, s51, s64
    s_cmp_ge_u32 s2, 192
    s_cselect_b32 s69, 0x80000000, 0
    s_mov_b32 s67, 0x40053526
    v_lshlrev_b32 v234, 2, v1
    v_lshrrev_b32 v3, 3, v1
    s_lshl_b32 s64, s44, 4
    v_add_lshl_u32 v2, v3, s64, 11
    s_lshl_b32 s64, s48, 7
    v_add_u32 v2, s64, v2
    v_and_b32 v3, 6, v3
    v_and_b32 v4, 7, v1
    v_xor_b32 v3, v3, v4
    v_lshl_add_u32 v193, v3, 4, v2
    v_add_u32 v194, 15360, v193
    s_lshl_b32 s64, s47, 3
    s_lshl_b32 s65, s44, 1
    s_add_u32 s64, s64, s65
    s_mul_i32 s64, s64, 32768
    s_add_u32 s64, s64, 0x1000000
    v_lshl_add_u32 v206, v1, 4, s64
    v_add_u32 v207, 30720, v206
    s_lshl_b32 s65, s48, 8
    v_lshrrev_b32 v3, 4, v1
    s_lshl_b32 s64, s44, 4
    v_add_u32 v2, s64, v3
    s_movk_i32 s64, 7168
    v_mul_u32_u24 v2, s64, v2
    v_add_u32 v2, s65, v2
    v_lshlrev_b32 v3, 1, v3
    v_and_b32 v4, 15, v1
    v_xor_b32 v3, v3, v4
    v_lshl_add_u32 v208, v3, 4, v2
    v_add_u32 v210, 55296, v208
    v_xor_b32 v3, 8, v3
    v_lshl_add_u32 v209, v3, 4, v2
    v_add_u32 v209, 27648, v209
    v_add_u32 v211, 55296, v209
    s_lshr_b32 s65, s48, 2
    s_sub_u32 s65, s48, s65
    s_add_u32 s65, s65, 16
    s_lshl_b32 s65, s65, 8
    s_or_b32 s65, s65, s69
    v_lshrrev_b32 v3, 4, v1
    s_lshl_b32 s64, s44, 4
    v_add_u32 v2, s64, v3
    s_movk_i32 s64, 7168
    v_mul_u32_u24 v2, s64, v2
    v_add_u32 v2, s65, v2
    v_lshlrev_b32 v3, 1, v3
    v_and_b32 v4, 15, v1
    v_xor_b32 v3, v3, v4
    v_lshl_add_u32 v212, v3, 4, v2
    v_add_u32 v214, 55296, v212
    v_xor_b32 v3, 8, v3
    v_lshl_add_u32 v213, v3, 4, v2
    v_add_u32 v213, 27648, v213
    v_add_u32 v215, 55296, v213
    s_lshl_b32 s64, s50, 3
    s_lshl_b32 s65, s44, 1
    s_add_u32 s64, s64, s65
    s_mul_i32 s64, s64, 114688
    s_add_u32 s64, s64, 0x1500000
    v_lshl_add_u32 v246, v1, 4, s64
    v_add_u32 v247, 112640, v246
    s_lshl_b32 s65, s51, 8
    v_lshrrev_b32 v3, 4, v1
    s_lshl_b32 s64, s44, 4
    v_add_u32 v2, s64, v3
    s_movk_i32 s64, 2048
    v_mul_u32_u24 v2, s64, v2
    v_add_u32 v2, s65, v2
    v_lshlrev_b32 v3, 1, v3
    v_and_b32 v4, 15, v1
    v_xor_b32 v3, v3, v4
    v_lshl_add_u32 v248, v3, 4, v2
    v_add_u32 v250, 14336, v248
    v_xor_b32 v3, 8, v3
    v_lshl_add_u32 v249, v3, 4, v2
    v_add_u32 v249, 7168, v249
    v_add_u32 v251, 14336, v249
    s_lshl_b32 s64, s44, 12
    v_lshl_add_u32 v233, v1, 4, s64
    v_lshrrev_b32 v2, 2, v1
    v_lshlrev_b32 v4, 7, v2
    v_and_b32 v5, 3, v1
    v_lshl_add_u32 v4, v5, 3, v4
    v_add_u32 v4, 16384, v4
    v_bfe_u32 v2, v1, 3, 2
    v_xor_b32 v3, 0, v2
    v_lshl_add_u32 v239, v3, 5, v4
    v_xor_b32 v3, 1, v2
    v_lshl_add_u32 v240, v3, 5, v4
    v_xor_b32 v3, 2, v2
    v_lshl_add_u32 v241, v3, 5, v4
    v_xor_b32 v3, 3, v2
    v_lshl_add_u32 v242, v3, 5, v4
    s_mov_b32 s52, 49152
    v_add_u32 v232, s52, v233
    v_add_u32 v235, s52, v239
    v_add_u32 v236, s52, v240
    v_add_u32 v237, s52, v241
    v_add_u32 v238, s52, v242
    s_lshl_b32 s70, s47, 2
    s_add_u32 s70, s70, s44
    s_lshl_b32 s64, s70, 16
    s_lshl_b32 s65, s48, 7
    s_add_u32 s64, s64, s65
    v_and_b32 v2, 15, v1
    v_lshl_add_u32 v2, v2, 11, s64
    v_bfe_u32 v3, v1, 4, 1
    v_lshl_add_u32 v2, v3, 5, v2
    v_lshrrev_b32 v3, 5, v1
    v_lshl_add_u32 v196, v3, 4, v2
    s_mul_i32 s64, s70, 65536
    s_lshl_b32 s65, s48, 11
    s_add_u32 s64, s64, s65
    v_lshl_add_u32 v197, v1, 4, s64
    s_lshl_b32 s64, s70, 12
    s_add_u32 s64, s64, 0x60000
    v_lshl_add_u32 v198, v1, 3, s64
    v_and_b32 v2, 48, v1
    v_add_u32 v199, 149504, v2
    v_mov_b32 v72, 148480
    v_mov_b32 v73, 0
    ds_write_b32 v72, v73 offset:0
    ds_write_b32 v72, v73 offset:4
    ds_write_b32 v72, v73 offset:8
    ds_write_b32 v72, v73 offset:12
    ds_write_b32 v72, v73 offset:16
    ds_write_b32 v72, v73 offset:20
    v_and_b32 v16, 255, v0
    s_lshr_b32 s80, s2, 6
    s_lshl_b32 s81, s80, 8
    s_and_b32 s82, s2, 63
    s_lshl_b32 s83, s82, 7
    s_add_u32 s83, s83, 4096
    s_lshl_b32 s80, s80, 15
    s_lshl_b32 s82, s82, 9
    s_add_u32 s80, s80, s82
    s_add_u32 s80, s80, 0xa0000
    v_lshrrev_b32 v72, 3, v16
    v_add_u32 v72, s81, v72
    v_lshlrev_b32 v18, 1, v72
    s_movk_i32 s64, 12288
    v_mul_lo_u32 v72, s64, v72
    v_and_b32 v17, 7, v0
    v_lshl_add_u32 v72, v17, 4, v72
    v_add_u32 v17, s83, v72
    s_lshl_b32 s64, s2, 8
    v_add_lshl_u32 v243, v16, s64, 5
    s_mov_b32 s36, s20
    s_mov_b32 s37, s21
    s_mov_b32 s38, 0xc00000
    s_mov_b32 s39, 0x20000
    s_lshl_b32 s64, s2, 2
    s_add_u32 s64, s64, s44
    s_mul_i32 s64, s64, 7168
    s_add_u32 s64, s64, 4096
    s_add_u32 s10, s12, s64
    s_addc_u32 s11, s13, 0
    s_add_u32 s24, s14, s64
    s_addc_u32 s25, s15, 0
    s_waitcnt lgkmcnt(0)
    s_add_u32 s0, s0, 1
    s_barrier
    s_waitcnt vmcnt(0)
    v_lshlrev_b32 v120, 16, v104
    v_and_b32 v121, 0xffff0000, v104
    v_lshlrev_b32 v122, 16, v105
    v_and_b32 v123, 0xffff0000, v105
    v_lshlrev_b32 v124, 16, v106
    v_and_b32 v125, 0xffff0000, v106
    v_lshlrev_b32 v126, 16, v107
    v_and_b32 v127, 0xffff0000, v107
    v_lshlrev_b32 v128, 16, v108
    v_and_b32 v129, 0xffff0000, v108
    v_lshlrev_b32 v130, 16, v109
    v_and_b32 v131, 0xffff0000, v109
    v_lshlrev_b32 v132, 16, v110
    v_and_b32 v133, 0xffff0000, v110
    v_lshlrev_b32 v134, 16, v111
    v_and_b32 v135, 0xffff0000, v111
    v_lshlrev_b32 v136, 16, v112
    v_and_b32 v137, 0xffff0000, v112
    v_lshlrev_b32 v138, 16, v113
    v_and_b32 v139, 0xffff0000, v113
    v_lshlrev_b32 v140, 16, v114
    v_and_b32 v141, 0xffff0000, v114
    v_lshlrev_b32 v142, 16, v115
    v_and_b32 v143, 0xffff0000, v115
    v_lshlrev_b32 v144, 16, v116
    v_and_b32 v145, 0xffff0000, v116
    v_lshlrev_b32 v146, 16, v117
    v_and_b32 v147, 0xffff0000, v117
    v_lshlrev_b32 v148, 16, v118
    v_and_b32 v149, 0xffff0000, v118
    v_lshlrev_b32 v150, 16, v119
    v_and_b32 v151, 0xffff0000, v119
    v_pk_add_f32 v[104:105], v[120:121], v[122:123]
    v_pk_mul_f32 v[108:109], v[120:121], v[120:121]
    v_pk_add_f32 v[106:107], v[136:137], v[138:139]
    v_pk_mul_f32 v[110:111], v[136:137], v[136:137]
    v_pk_fma_f32 v[108:109], v[122:123], v[122:123], v[108:109]
    v_pk_fma_f32 v[110:111], v[138:139], v[138:139], v[110:111]
    v_pk_add_f32 v[104:105], v[104:105], v[124:125]
    v_pk_fma_f32 v[108:109], v[124:125], v[124:125], v[108:109]
    v_pk_add_f32 v[106:107], v[106:107], v[140:141]
    v_pk_fma_f32 v[110:111], v[140:141], v[140:141], v[110:111]
    v_pk_add_f32 v[104:105], v[104:105], v[126:127]
    v_pk_fma_f32 v[108:109], v[126:127], v[126:127], v[108:109]
    v_pk_add_f32 v[106:107], v[106:107], v[142:143]
    v_pk_fma_f32 v[110:111], v[142:143], v[142:143], v[110:111]
    v_pk_add_f32 v[104:105], v[104:105], v[128:129]
    v_pk_fma_f32 v[108:109], v[128:129], v[128:129], v[108:109]
    v_pk_add_f32 v[106:107], v[106:107], v[144:145]
    v_pk_fma_f32 v[110:111], v[144:145], v[144:145], v[110:111]
    v_pk_add_f32 v[104:105], v[104:105], v[130:131]
    v_pk_fma_f32 v[108:109], v[130:131], v[130:131], v[108:109]
    v_pk_add_f32 v[106:107], v[106:107], v[146:147]
    v_pk_fma_f32 v[110:111], v[146:147], v[146:147], v[110:111]
    v_pk_add_f32 v[104:105], v[104:105], v[132:133]
    v_pk_fma_f32 v[108:109], v[132:133], v[132:133], v[108:109]
    v_pk_add_f32 v[106:107], v[106:107], v[148:149]
    v_pk_fma_f32 v[110:111], v[148:149], v[148:149], v[110:111]
    v_pk_add_f32 v[104:105], v[104:105], v[134:135]
    v_pk_fma_f32 v[108:109], v[134:135], v[134:135], v[108:109]
    v_pk_add_f32 v[106:107], v[106:107], v[150:151]
    v_pk_fma_f32 v[110:111], v[150:151], v[150:151], v[110:111]
    v_add_f32 v152, v104, v105
    v_add_f32 v153, v108, v109
    v_add_f32 v156, v106, v107
    v_add_f32 v157, v110, v111
    v_add_f32_dpp v152, v152, v152 quad_perm:[1,0,3,2] row_mask:0xf bank_mask:0xf
    v_add_f32_dpp v153, v153, v153 quad_perm:[1,0,3,2] row_mask:0xf bank_mask:0xf
    v_add_f32_dpp v156, v156, v156 quad_perm:[1,0,3,2] row_mask:0xf bank_mask:0xf
    v_add_f32_dpp v157, v157, v157 quad_perm:[1,0,3,2] row_mask:0xf bank_mask:0xf
    v_add_f32_dpp v152, v152, v152 quad_perm:[2,3,0,1] row_mask:0xf bank_mask:0xf
    v_add_f32_dpp v153, v153, v153 quad_perm:[2,3,0,1] row_mask:0xf bank_mask:0xf
    v_add_f32_dpp v156, v156, v156 quad_perm:[2,3,0,1] row_mask:0xf bank_mask:0xf
    v_add_f32_dpp v157, v157, v157 quad_perm:[2,3,0,1] row_mask:0xf bank_mask:0xf
    v_add_f32_dpp v152, v152, v152 row_half_mirror row_mask:0xf bank_mask:0xf
    v_add_f32_dpp v153, v153, v153 row_half_mirror row_mask:0xf bank_mask:0xf
    v_add_f32_dpp v156, v156, v156 row_half_mirror row_mask:0xf bank_mask:0xf
    v_add_f32_dpp v157, v157, v157 row_half_mirror row_mask:0xf bank_mask:0xf
    v_add_f32_dpp v152, v152, v152 row_mirror row_mask:0xf bank_mask:0xf
    v_add_f32_dpp v153, v153, v153 row_mirror row_mask:0xf bank_mask:0xf
    v_add_f32_dpp v156, v156, v156 row_mirror row_mask:0xf bank_mask:0xf
    v_add_f32_dpp v157, v157, v157 row_mirror row_mask:0xf bank_mask:0xf
    v_mov_b32 v154, v152
    v_mov_b32 v155, v153
    v_mov_b32 v158, v156
    v_mov_b32 v159, v157
    v_permlane32_swap_b32 v152, v154
    v_permlane32_swap_b32 v153, v155
    v_permlane32_swap_b32 v156, v158
    v_permlane32_swap_b32 v157, v159
    v_add_f32 v152, v152, v154
    v_add_f32 v153, v153, v155
    v_add_f32 v156, v156, v158
    v_add_f32 v157, v157, v159
    v_mov_b32 v154, v152
    v_mov_b32 v155, v153
    v_mov_b32 v158, v156
    v_mov_b32 v159, v157
    v_permlane16_swap_b32 v152, v154
    v_permlane16_swap_b32 v153, v155
    v_permlane16_swap_b32 v156, v158
    v_permlane16_swap_b32 v157, v159
    v_add_f32 v152, v152, v154
    v_add_f32 v153, v153, v155
    v_add_f32 v156, v156, v158
    v_add_f32 v157, v157, v159
    v_mul_f32 v152, 0x3a800000, v152
    v_mul_f32 v153, 0x3a800000, v153
    v_mul_f32 v156, 0x3a800000, v156
    v_mul_f32 v157, 0x3a800000, v157
    v_fma_f32 v153, -v152, v152, v153
    v_fma_f32 v157, -v156, v156, v157
    v_max_f32 v153, 0, v153
    v_max_f32 v157, 0, v157
    v_cvt_pk_bf16_f32 v154, v152, v153
    v_lshlrev_b32 v152, 16, v154
    v_and_b32 v153, 0xffff0000, v154
    v_cvt_pk_bf16_f32 v158, v156, v157
    v_lshlrev_b32 v156, 16, v158
    v_and_b32 v157, 0xffff0000, v158
    v_add_f32 v153, 0x3727c5ac, v153
    v_add_f32 v157, 0x3727c5ac, v157
    v_cvt_pk_bf16_f32 v154, v153, v153
    v_lshlrev_b32 v153, 16, v154
    v_cvt_pk_bf16_f32 v158, v157, v157
    v_lshlrev_b32 v157, 16, v158
    v_sqrt_f32 v153, v153
    v_sqrt_f32 v157, v157
    v_cvt_pk_bf16_f32 v154, v153, v153
    v_lshlrev_b32 v153, 16, v154
    v_cvt_pk_bf16_f32 v158, v157, v157
    v_lshlrev_b32 v157, 16, v158
    v_lshrrev_b32 v153, 16, v153
    v_or_b32 v160, v152, v153
    v_mov_b32 v161, s0
    v_lshrrev_b32 v157, 16, v157
    v_or_b32 v162, v156, v157
    v_mov_b32 v163, s0
    s_lshl_b32 s64, s44, 4
    s_add_u32 s64, s64, 150528
    v_mov_b32 v2, s64
    v_mov_b32 v3, 148500
    v_mov_b32 v4, 1
    s_mov_b64 exec, 1
    ds_write_b128 v2, v[160:163]
    ds_add_rtn_u32 v5, v3, v4
    s_mov_b64 exec, 15
    v_lshlrev_b32 v2, 4, v1
    v_add_u32 v3, 150528, v2
    ds_read_b128 v[164:167], v3
    s_lshr_b32 s64, s62, 2
    s_lshl_b32 s64, s64, 7
    s_add_u32 s64, s64, 0x10000
    s_waitcnt lgkmcnt(0)
    v_readfirstlane_b32 s65, v5
    s_nop 3
    s_cmp_eq_u32 s65, 3
    s_cselect_b32 s64, s64, 0x80000000
    v_add_u32 v2, s64, v2
    buffer_store_dwordx4 v[164:167], v2, s[28:31], 0 offen sc1
    s_mov_b64 exec, -1
    s_mov_b32 s64, 0x0
    buffer_load_dwordx4 v[80:83], v8, s[40:43], s64 offen
    s_mov_b32 s64, 0x10000
    buffer_load_dwordx4 v[84:87], v8, s[40:43], s64 offen
    s_mov_b32 s64, 0x20000
    buffer_load_dwordx4 v[88:91], v8, s[40:43], s64 offen
    s_mov_b32 s64, 0x30000
    buffer_load_dwordx4 v[92:95], v8, s[40:43], s64 offen
    buffer_load_dwordx4 v[96:99], v9, s[40:43], 0 offen
    v_mov_b32 v74, -1
    v_mov_b32 v75, -1
    s_lshl_b32 s64, s48, 8
    s_mov_b32 exec_hi, 0
    buffer_store_dwordx2 v[74:75], v198, s[28:31], s64 offen sc1
    s_mov_b32 exec_hi, -1
    s_mov_b32 s40, s18
    s_mov_b32 s41, s19
    s_mov_b32 s42, 0x800
    s_mov_b32 s43, 0x20000
    buffer_load_ushort v24, v18, s[40:43], 0 offen offset:0
    buffer_load_ushort v25, v18, s[40:43], 0 offen offset:64
    buffer_load_ushort v26, v18, s[40:43], 0 offen offset:128
    buffer_load_ushort v27, v18, s[40:43], 0 offen offset:192
    buffer_load_ushort v28, v18, s[40:43], 0 offen offset:256
    buffer_load_ushort v29, v18, s[40:43], 0 offen offset:320
    buffer_load_ushort v30, v18, s[40:43], 0 offen offset:384
    buffer_load_ushort v31, v18, s[40:43], 0 offen offset:448
    buffer_load_dwordx2 v[168:169], v12, s[28:31], 0 offen offset:0 sc1
    buffer_load_dwordx2 v[170:171], v12, s[28:31], 0 offen offset:512 sc1
    buffer_load_dwordx2 v[172:173], v12, s[28:31], 0 offen offset:1024 sc1
    buffer_load_dwordx2 v[174:175], v12, s[28:31], 0 offen offset:1536 sc1
    buffer_load_dwordx2 v[176:177], v13, s[28:31], 0 offen sc1
    s_waitcnt vmcnt(14)
    v_lshlrev_b32 v120, 16, v80
    v_and_b32 v121, 0xffff0000, v80
    v_lshlrev_b32 v122, 16, v81
    v_and_b32 v123, 0xffff0000, v81
    v_lshlrev_b32 v124, 16, v82
    v_and_b32 v125, 0xffff0000, v82
    v_lshlrev_b32 v126, 16, v83
    v_and_b32 v127, 0xffff0000, v83
    v_lshlrev_b32 v128, 16, v84
    v_and_b32 v129, 0xffff0000, v84
    v_lshlrev_b32 v130, 16, v85
    v_and_b32 v131, 0xffff0000, v85
    v_lshlrev_b32 v132, 16, v86
    v_and_b32 v133, 0xffff0000, v86
    v_lshlrev_b32 v134, 16, v87
    v_and_b32 v135, 0xffff0000, v87
    v_lshlrev_b32 v136, 16, v88
    v_and_b32 v137, 0xffff0000, v88
    v_lshlrev_b32 v138, 16, v89
    v_and_b32 v139, 0xffff0000, v89
    v_lshlrev_b32 v140, 16, v90
    v_and_b32 v141, 0xffff0000, v90
    v_lshlrev_b32 v142, 16, v91
    v_and_b32 v143, 0xffff0000, v91
    v_lshlrev_b32 v144, 16, v92
    v_and_b32 v145, 0xffff0000, v92
    v_lshlrev_b32 v146, 16, v93
    v_and_b32 v147, 0xffff0000, v93
    v_lshlrev_b32 v148, 16, v94
    v_and_b32 v149, 0xffff0000, v94
    v_lshlrev_b32 v150, 16, v95
    v_and_b32 v151, 0xffff0000, v95
    v_lshlrev_b32 v152, 16, v96
    v_and_b32 v153, 0xffff0000, v96
    v_lshlrev_b32 v154, 16, v97
    v_and_b32 v155, 0xffff0000, v97
    v_lshlrev_b32 v156, 16, v98
    v_and_b32 v157, 0xffff0000, v98
    v_lshlrev_b32 v158, 16, v99
    v_and_b32 v159, 0xffff0000, v99
    s_waitcnt vmcnt(0)
    s_mov_b32 s3, 0x4000
M_s1_chk:
    v_xor_b32 v72, s0, v169
    v_xor_b32 v73, s0, v171
    v_xor_b32 v74, s0, v173
    v_xor_b32 v75, s0, v175
    v_xor_b32 v76, s0, v177
    v_or3_b32 v72, v72, v73, v74
    v_or3_b32 v72, v72, v75, v76
    v_cmp_ne_u32 vcc, 0, v72
    s_nop 4
    s_cbranch_vccz M_s1_ok
    s_sub_u32 s3, s3, 1
    s_cbranch_scc1 M_s1_ok
    s_sleep 2
    v_cmp_ne_u32 vcc, s0, v169
    s_nop 4
    s_mov_b64 exec, vcc
    buffer_load_dwordx2 v[168:169], v12, s[28:31], 0 offen offset:0 sc1
    s_mov_b64 exec, -1
    v_cmp_ne_u32 vcc, s0, v171
    s_nop 4
    s_mov_b64 exec, vcc
    buffer_load_dwordx2 v[170:171], v12, s[28:31], 0 offen offset:512 sc1
    s_mov_b64 exec, -1
    v_cmp_ne_u32 vcc, s0, v173
    s_nop 4
    s_mov_b64 exec, vcc
    buffer_load_dwordx2 v[172:173], v12, s[28:31], 0 offen offset:1024 sc1
    s_mov_b64 exec, -1
    v_cmp_ne_u32 vcc, s0, v175
    s_nop 4
    s_mov_b64 exec, vcc
    buffer_load_dwordx2 v[174:175], v12, s[28:31], 0 offen offset:1536 sc1
    s_mov_b64 exec, -1
    v_cmp_ne_u32 vcc, s0, v177
    s_nop 4
    s_mov_b64 exec, vcc
    buffer_load_dwordx2 v[176:177], v13, s[28:31], 0 offen sc1
    s_mov_b64 exec, -1
    s_waitcnt vmcnt(0)
    s_branch M_s1_chk
M_s1_ok:
    v_lshlrev_b32 v169, 16, v168
    v_and_b32 v168, 0xffff0000, v168
    v_lshlrev_b32 v171, 16, v170
    v_and_b32 v170, 0xffff0000, v170
    v_lshlrev_b32 v173, 16, v172
    v_and_b32 v172, 0xffff0000, v172
    v_lshlrev_b32 v175, 16, v174
    v_and_b32 v174, 0xffff0000, v174
    v_lshlrev_b32 v177, 16, v176
    v_and_b32 v176, 0xffff0000, v176
    v_rcp_f32 v169, v169
    v_rcp_f32 v171, v171
    v_rcp_f32 v173, v173
    v_rcp_f32 v175, v175
    v_rcp_f32 v177, v177
    v_pk_add_f32 v[120:121], v[120:121], v[168:169] op_sel_hi:[1,0] neg_lo:[0,1] neg_hi:[0,1]
    v_pk_add_f32 v[122:123], v[122:123], v[168:169] op_sel_hi:[1,0] neg_lo:[0,1] neg_hi:[0,1]
    v_pk_add_f32 v[124:125], v[124:125], v[168:169] op_sel_hi:[1,0] neg_lo:[0,1] neg_hi:[0,1]
    v_pk_add_f32 v[126:127], v[126:127], v[168:169] op_sel_hi:[1,0] neg_lo:[0,1] neg_hi:[0,1]
    v_cvt_pk_bf16_f32 v72, v120, v121
    v_lshlrev_b32 v120, 16, v72
    v_and_b32 v121, 0xffff0000, v72
    v_cvt_pk_bf16_f32 v73, v122, v123
    v_lshlrev_b32 v122, 16, v73
    v_and_b32 v123, 0xffff0000, v73
    v_cvt_pk_bf16_f32 v74, v124, v125
    v_lshlrev_b32 v124, 16, v74
    v_and_b32 v125, 0xffff0000, v74
    v_cvt_pk_bf16_f32 v75, v126, v127
    v_lshlrev_b32 v126, 16, v75
    v_and_b32 v127, 0xffff0000, v75
    v_pk_mul_f32 v[120:121], v[120:121], v[168:169] op_sel:[0,1] op_sel_hi:[1,1]
    v_pk_mul_f32 v[122:123], v[122:123], v[168:169] op_sel:[0,1] op_sel_hi:[1,1]
    v_pk_mul_f32 v[124:125], v[124:125], v[168:169] op_sel:[0,1] op_sel_hi:[1,1]
    v_pk_mul_f32 v[126:127], v[126:127], v[168:169] op_sel:[0,1] op_sel_hi:[1,1]
    v_cvt_pk_bf16_f32 v72, v120, v121
    v_lshlrev_b32 v120, 16, v72
    v_and_b32 v121, 0xffff0000, v72
    v_cvt_pk_bf16_f32 v73, v122, v123
    v_lshlrev_b32 v122, 16, v73
    v_and_b32 v123, 0xffff0000, v73
    v_cvt_pk_bf16_f32 v74, v124, v125
    v_lshlrev_b32 v124, 16, v74
    v_and_b32 v125, 0xffff0000, v74
    v_cvt_pk_bf16_f32 v75, v126, v127
    v_lshlrev_b32 v126, 16, v75
    v_and_b32 v127, 0xffff0000, v75
    v_pk_add_f32 v[128:129], v[128:129], v[170:171] op_sel_hi:[1,0] neg_lo:[0,1] neg_hi:[0,1]
    v_pk_add_f32 v[130:131], v[130:131], v[170:171] op_sel_hi:[1,0] neg_lo:[0,1] neg_hi:[0,1]
    v_pk_add_f32 v[132:133], v[132:133], v[170:171] op_sel_hi:[1,0] neg_lo:[0,1] neg_hi:[0,1]
    v_pk_add_f32 v[134:135], v[134:135], v[170:171] op_sel_hi:[1,0] neg_lo:[0,1] neg_hi:[0,1]
    v_cvt_pk_bf16_f32 v72, v128, v129
    v_lshlrev_b32 v128, 16, v72
    v_and_b32 v129, 0xffff0000, v72
    v_cvt_pk_bf16_f32 v73, v130, v131
    v_lshlrev_b32 v130, 16, v73
    v_and_b32 v131, 0xffff0000, v73
    v_cvt_pk_bf16_f32 v74, v132, v133
    v_lshlrev_b32 v132, 16, v74
    v_and_b32 v133, 0xffff0000, v74
    v_cvt_pk_bf16_f32 v75, v134, v135
    v_lshlrev_b32 v134, 16, v75
    v_and_b32 v135, 0xffff0000, v75
    v_pk_mul_f32 v[128:129], v[128:129], v[170:171] op_sel:[0,1] op_sel_hi:[1,1]
    v_pk_mul_f32 v[130:131], v[130:131], v[170:171] op_sel:[0,1] op_sel_hi:[1,1]
    v_pk_mul_f32 v[132:133], v[132:133], v[170:171] op_sel:[0,1] op_sel_hi:[1,1]
    v_pk_mul_f32 v[134:135], v[134:135], v[170:171] op_sel:[0,1] op_sel_hi:[1,1]
    v_cvt_pk_bf16_f32 v72, v128, v129
    v_lshlrev_b32 v128, 16, v72
    v_and_b32 v129, 0xffff0000, v72
    v_cvt_pk_bf16_f32 v73, v130, v131
    v_lshlrev_b32 v130, 16, v73
    v_and_b32 v131, 0xffff0000, v73
    v_cvt_pk_bf16_f32 v74, v132, v133
    v_lshlrev_b32 v132, 16, v74
    v_and_b32 v133, 0xffff0000, v74
    v_cvt_pk_bf16_f32 v75, v134, v135
    v_lshlrev_b32 v134, 16, v75
    v_and_b32 v135, 0xffff0000, v75
    v_pk_add_f32 v[136:137], v[136:137], v[172:173] op_sel_hi:[1,0] neg_lo:[0,1] neg_hi:[0,1]
    v_pk_add_f32 v[138:139], v[138:139], v[172:173] op_sel_hi:[1,0] neg_lo:[0,1] neg_hi:[0,1]
    v_pk_add_f32 v[140:141], v[140:141], v[172:173] op_sel_hi:[1,0] neg_lo:[0,1] neg_hi:[0,1]
    v_pk_add_f32 v[142:143], v[142:143], v[172:173] op_sel_hi:[1,0] neg_lo:[0,1] neg_hi:[0,1]
    v_cvt_pk_bf16_f32 v72, v136, v137
    v_lshlrev_b32 v136, 16, v72
    v_and_b32 v137, 0xffff0000, v72
    v_cvt_pk_bf16_f32 v73, v138, v139
    v_lshlrev_b32 v138, 16, v73
    v_and_b32 v139, 0xffff0000, v73
    v_cvt_pk_bf16_f32 v74, v140, v141
    v_lshlrev_b32 v140, 16, v74
    v_and_b32 v141, 0xffff0000, v74
    v_cvt_pk_bf16_f32 v75, v142, v143
    v_lshlrev_b32 v142, 16, v75
    v_and_b32 v143, 0xffff0000, v75
    v_pk_mul_f32 v[136:137], v[136:137], v[172:173] op_sel:[0,1] op_sel_hi:[1,1]
    v_pk_mul_f32 v[138:139], v[138:139], v[172:173] op_sel:[0,1] op_sel_hi:[1,1]
    v_pk_mul_f32 v[140:141], v[140:141], v[172:173] op_sel:[0,1] op_sel_hi:[1,1]
    v_pk_mul_f32 v[142:143], v[142:143], v[172:173] op_sel:[0,1] op_sel_hi:[1,1]
    v_cvt_pk_bf16_f32 v72, v136, v137
    v_lshlrev_b32 v136, 16, v72
    v_and_b32 v137, 0xffff0000, v72
    v_cvt_pk_bf16_f32 v73, v138, v139
    v_lshlrev_b32 v138, 16, v73
    v_and_b32 v139, 0xffff0000, v73
    v_cvt_pk_bf16_f32 v74, v140, v141
    v_lshlrev_b32 v140, 16, v74
    v_and_b32 v141, 0xffff0000, v74
    v_cvt_pk_bf16_f32 v75, v142, v143
    v_lshlrev_b32 v142, 16, v75
    v_and_b32 v143, 0xffff0000, v75
    v_pk_add_f32 v[144:145], v[144:145], v[174:175] op_sel_hi:[1,0] neg_lo:[0,1] neg_hi:[0,1]
    v_pk_add_f32 v[146:147], v[146:147], v[174:175] op_sel_hi:[1,0] neg_lo:[0,1] neg_hi:[0,1]
    v_pk_add_f32 v[148:149], v[148:149], v[174:175] op_sel_hi:[1,0] neg_lo:[0,1] neg_hi:[0,1]
    v_pk_add_f32 v[150:151], v[150:151], v[174:175] op_sel_hi:[1,0] neg_lo:[0,1] neg_hi:[0,1]
    v_cvt_pk_bf16_f32 v72, v144, v145
    v_lshlrev_b32 v144, 16, v72
    v_and_b32 v145, 0xffff0000, v72
    v_cvt_pk_bf16_f32 v73, v146, v147
    v_lshlrev_b32 v146, 16, v73
    v_and_b32 v147, 0xffff0000, v73
    v_cvt_pk_bf16_f32 v74, v148, v149
    v_lshlrev_b32 v148, 16, v74
    v_and_b32 v149, 0xffff0000, v74
    v_cvt_pk_bf16_f32 v75, v150, v151
    v_lshlrev_b32 v150, 16, v75
    v_and_b32 v151, 0xffff0000, v75
    v_pk_mul_f32 v[144:145], v[144:145], v[174:175] op_sel:[0,1] op_sel_hi:[1,1]
    v_pk_mul_f32 v[146:147], v[146:147], v[174:175] op_sel:[0,1] op_sel_hi:[1,1]
    v_pk_mul_f32 v[148:149], v[148:149], v[174:175] op_sel:[0,1] op_sel_hi:[1,1]
    v_pk_mul_f32 v[150:151], v[150:151], v[174:175] op_sel:[0,1] op_sel_hi:[1,1]
    v_cvt_pk_bf16_f32 v72, v144, v145
    v_lshlrev_b32 v144, 16, v72
    v_and_b32 v145, 0xffff0000, v72
    v_cvt_pk_bf16_f32 v73, v146, v147
    v_lshlrev_b32 v146, 16, v73
    v_and_b32 v147, 0xffff0000, v73
    v_cvt_pk_bf16_f32 v74, v148, v149
    v_lshlrev_b32 v148, 16, v74
    v_and_b32 v149, 0xffff0000, v74
    v_cvt_pk_bf16_f32 v75, v150, v151
    v_lshlrev_b32 v150, 16, v75
    v_and_b32 v151, 0xffff0000, v75
    v_pk_add_f32 v[152:153], v[152:153], v[176:177] op_sel_hi:[1,0] neg_lo:[0,1] neg_hi:[0,1]
    v_pk_add_f32 v[154:155], v[154:155], v[176:177] op_sel_hi:[1,0] neg_lo:[0,1] neg_hi:[0,1]
    v_pk_add_f32 v[156:157], v[156:157], v[176:177] op_sel_hi:[1,0] neg_lo:[0,1] neg_hi:[0,1]
    v_pk_add_f32 v[158:159], v[158:159], v[176:177] op_sel_hi:[1,0] neg_lo:[0,1] neg_hi:[0,1]
    v_cvt_pk_bf16_f32 v72, v152, v153
    v_lshlrev_b32 v152, 16, v72
    v_and_b32 v153, 0xffff0000, v72
    v_cvt_pk_bf16_f32 v73, v154, v155
    v_lshlrev_b32 v154, 16, v73
    v_and_b32 v155, 0xffff0000, v73
    v_cvt_pk_bf16_f32 v74, v156, v157
    v_lshlrev_b32 v156, 16, v74
    v_and_b32 v157, 0xffff0000, v74
    v_cvt_pk_bf16_f32 v75, v158, v159
    v_lshlrev_b32 v158, 16, v75
    v_and_b32 v159, 0xffff0000, v75
    v_pk_mul_f32 v[152:153], v[152:153], v[176:177] op_sel:[0,1] op_sel_hi:[1,1]
    v_pk_mul_f32 v[154:155], v[154:155], v[176:177] op_sel:[0,1] op_sel_hi:[1,1]
    v_pk_mul_f32 v[156:157], v[156:157], v[176:177] op_sel:[0,1] op_sel_hi:[1,1]
    v_pk_mul_f32 v[158:159], v[158:159], v[176:177] op_sel:[0,1] op_sel_hi:[1,1]
    v_cvt_pk_bf16_f32 v72, v152, v153
    v_lshlrev_b32 v152, 16, v72
    v_and_b32 v153, 0xffff0000, v72
    v_cvt_pk_bf16_f32 v73, v154, v155
    v_lshlrev_b32 v154, 16, v73
    v_and_b32 v155, 0xffff0000, v73
    v_cvt_pk_bf16_f32 v74, v156, v157
    v_lshlrev_b32 v156, 16, v74
    v_and_b32 v157, 0xffff0000, v74
    v_cvt_pk_bf16_f32 v75, v158, v159
    v_lshlrev_b32 v158, 16, v75
    v_and_b32 v159, 0xffff0000, v75
    s_lshl_b32 s68, s47, 9
    s_add_u32 s68, s68, 0x58000
    s_add_u32 s62, s26, s68
    s_addc_u32 s63, s27, 0
    s_lshr_b32 s68, s48, 2
    s_lshl_b32 s68, s68, 7
    v_mov_b32 v2, 1
    v_mov_b32 v5, 148496
    s_and_b32 s57, s58, 15
    s_lshr_b64 s[58:59], s[58:59], 4
    s_lshl_b32 s56, s57, 11
    s_mul_i32 s57, s57, 0x60000
    s_add_u32 m0, s53, s74
    s_nop 0
    buffer_load_dwordx4 v187, s[32:35], s57 offen offset:0 lds
    buffer_load_dwordx4 v188, s[32:35], s57 offen offset:1024 lds
    buffer_load_dwordx4 v189, s[32:35], s57 offen offset:2048 lds
    buffer_load_dwordx4 v190, s[32:35], s57 offen offset:3072 lds
    s_add_u32 m0, s53, s75
    s_nop 0
    buffer_load_dwordx4 v191, s[32:35], s57 offen offset:0 lds
    buffer_load_dwordx4 v192, s[32:35], s57 offen offset:1024 lds
    s_add_u32 s53, s53, 49152
    s_cmp_ge_u32 s53, 147456
    s_cselect_b32 s53, 0, s53
    s_barrier
    ds_read_b128 v[32:35], v14 offset:0
    ds_read_b128 v[36:39], v14 offset:16
    ds_read_b128 v[40:43], v14 offset:256
    ds_read_b128 v[44:47], v14 offset:272
    s_waitcnt lgkmcnt(0)
    v_pk_mul_f32 v[120:121], v[120:121], v[40:41]
    v_pk_mul_f32 v[122:123], v[122:123], v[42:43]
    v_pk_mul_f32 v[124:125], v[124:125], v[44:45]
    v_pk_mul_f32 v[126:127], v[126:127], v[46:47]
    v_cvt_pk_bf16_f32 v72, v120, v121
    v_lshlrev_b32 v120, 16, v72
    v_and_b32 v121, 0xffff0000, v72
    v_cvt_pk_bf16_f32 v73, v122, v123
    v_lshlrev_b32 v122, 16, v73
    v_and_b32 v123, 0xffff0000, v73
    v_cvt_pk_bf16_f32 v74, v124, v125
    v_lshlrev_b32 v124, 16, v74
    v_and_b32 v125, 0xffff0000, v74
    v_cvt_pk_bf16_f32 v75, v126, v127
    v_lshlrev_b32 v126, 16, v75
    v_and_b32 v127, 0xffff0000, v75
    v_pk_add_f32 v[120:121], v[120:121], v[32:33]
    v_pk_add_f32 v[122:123], v[122:123], v[34:35]
    v_pk_add_f32 v[124:125], v[124:125], v[36:37]
    v_pk_add_f32 v[126:127], v[126:127], v[38:39]
    v_cvt_pk_bf16_f32 v80, v120, v121
    v_cvt_pk_bf16_f32 v81, v122, v123
    v_cvt_pk_bf16_f32 v82, v124, v125
    v_cvt_pk_bf16_f32 v83, v126, v127
    s_mov_b32 s64, 0x0
    buffer_store_dwordx4 v[80:83], v10, s[28:31], s64 offen sc1
    ds_write_b128 v15, v[80:83] offset:0
    v_pk_mul_f32 v[128:129], v[128:129], v[40:41]
    v_pk_mul_f32 v[130:131], v[130:131], v[42:43]
    v_pk_mul_f32 v[132:133], v[132:133], v[44:45]
    v_pk_mul_f32 v[134:135], v[134:135], v[46:47]
    v_cvt_pk_bf16_f32 v72, v128, v129
    v_lshlrev_b32 v128, 16, v72
    v_and_b32 v129, 0xffff0000, v72
    v_cvt_pk_bf16_f32 v73, v130, v131
    v_lshlrev_b32 v130, 16, v73
    v_and_b32 v131, 0xffff0000, v73
    v_cvt_pk_bf16_f32 v74, v132, v133
    v_lshlrev_b32 v132, 16, v74
    v_and_b32 v133, 0xffff0000, v74
    v_cvt_pk_bf16_f32 v75, v134, v135
    v_lshlrev_b32 v134, 16, v75
    v_and_b32 v135, 0xffff0000, v75
    v_pk_add_f32 v[128:129], v[128:129], v[32:33]
    v_pk_add_f32 v[130:131], v[130:131], v[34:35]
    v_pk_add_f32 v[132:133], v[132:133], v[36:37]
    v_pk_add_f32 v[134:135], v[134:135], v[38:39]
    v_cvt_pk_bf16_f32 v84, v128, v129
    v_cvt_pk_bf16_f32 v85, v130, v131
    v_cvt_pk_bf16_f32 v86, v132, v133
    v_cvt_pk_bf16_f32 v87, v134, v135
    s_mov_b32 s64, 0x10000
    buffer_store_dwordx4 v[84:87], v10, s[28:31], s64 offen sc1
    ds_write_b128 v15, v[84:87] offset:4096
    v_pk_mul_f32 v[136:137], v[136:137], v[40:41]
    v_pk_mul_f32 v[138:139], v[138:139], v[42:43]
    v_pk_mul_f32 v[140:141], v[140:141], v[44:45]
    v_pk_mul_f32 v[142:143], v[142:143], v[46:47]
    v_cvt_pk_bf16_f32 v72, v136, v137
    v_lshlrev_b32 v136, 16, v72
    v_and_b32 v137, 0xffff0000, v72
    v_cvt_pk_bf16_f32 v73, v138, v139
    v_lshlrev_b32 v138, 16, v73
    v_and_b32 v139, 0xffff0000, v73
    v_cvt_pk_bf16_f32 v74, v140, v141
    v_lshlrev_b32 v140, 16, v74
    v_and_b32 v141, 0xffff0000, v74
    v_cvt_pk_bf16_f32 v75, v142, v143
    v_lshlrev_b32 v142, 16, v75
    v_and_b32 v143, 0xffff0000, v75
    v_pk_add_f32 v[136:137], v[136:137], v[32:33]
    v_pk_add_f32 v[138:139], v[138:139], v[34:35]
    v_pk_add_f32 v[140:141], v[140:141], v[36:37]
    v_pk_add_f32 v[142:143], v[142:143], v[38:39]
    v_cvt_pk_bf16_f32 v88, v136, v137
    v_cvt_pk_bf16_f32 v89, v138, v139
    v_cvt_pk_bf16_f32 v90, v140, v141
    v_cvt_pk_bf16_f32 v91, v142, v143
    s_mov_b32 s64, 0x20000
    buffer_store_dwordx4 v[88:91], v10, s[28:31], s64 offen sc1
    ds_write_b128 v15, v[88:91] offset:8192
    v_pk_mul_f32 v[144:145], v[144:145], v[40:41]
    v_pk_mul_f32 v[146:147], v[146:147], v[42:43]
    v_pk_mul_f32 v[148:149], v[148:149], v[44:45]
    v_pk_mul_f32 v[150:151], v[150:151], v[46:47]
    v_cvt_pk_bf16_f32 v72, v144, v145
    v_lshlrev_b32 v144, 16, v72
    v_and_b32 v145, 0xffff0000, v72
    v_cvt_pk_bf16_f32 v73, v146, v147
    v_lshlrev_b32 v146, 16, v73
    v_and_b32 v147, 0xffff0000, v73
    v_cvt_pk_bf16_f32 v74, v148, v149
    v_lshlrev_b32 v148, 16, v74
    v_and_b32 v149, 0xffff0000, v74
    v_cvt_pk_bf16_f32 v75, v150, v151
    v_lshlrev_b32 v150, 16, v75
    v_and_b32 v151, 0xffff0000, v75
    v_pk_add_f32 v[144:145], v[144:145], v[32:33]
    v_pk_add_f32 v[146:147], v[146:147], v[34:35]
    v_pk_add_f32 v[148:149], v[148:149], v[36:37]
    v_pk_add_f32 v[150:151], v[150:151], v[38:39]
    v_cvt_pk_bf16_f32 v92, v144, v145
    v_cvt_pk_bf16_f32 v93, v146, v147
    v_cvt_pk_bf16_f32 v94, v148, v149
    v_cvt_pk_bf16_f32 v95, v150, v151
    s_mov_b32 s64, 0x30000
    buffer_store_dwordx4 v[92:95], v10, s[28:31], s64 offen sc1
    ds_write_b128 v15, v[92:95] offset:12288
    v_pk_mul_f32 v[152:153], v[152:153], v[40:41]
    v_pk_mul_f32 v[154:155], v[154:155], v[42:43]
    v_pk_mul_f32 v[156:157], v[156:157], v[44:45]
    v_pk_mul_f32 v[158:159], v[158:159], v[46:47]
    v_cvt_pk_bf16_f32 v72, v152, v153
    v_lshlrev_b32 v152, 16, v72
    v_and_b32 v153, 0xffff0000, v72
    v_cvt_pk_bf16_f32 v73, v154, v155
    v_lshlrev_b32 v154, 16, v73
    v_and_b32 v155, 0xffff0000, v73
    v_cvt_pk_bf16_f32 v74, v156, v157
    v_lshlrev_b32 v156, 16, v74
    v_and_b32 v157, 0xffff0000, v74
    v_cvt_pk_bf16_f32 v75, v158, v159
    v_lshlrev_b32 v158, 16, v75
    v_and_b32 v159, 0xffff0000, v75
    v_pk_add_f32 v[152:153], v[152:153], v[32:33]
    v_pk_add_f32 v[154:155], v[154:155], v[34:35]
    v_pk_add_f32 v[156:157], v[156:157], v[36:37]
    v_pk_add_f32 v[158:159], v[158:159], v[38:39]
    v_cvt_pk_bf16_f32 v96, v152, v153
    v_cvt_pk_bf16_f32 v97, v154, v155
    v_cvt_pk_bf16_f32 v98, v156, v157
    v_cvt_pk_bf16_f32 v99, v158, v159
    buffer_store_dwordx4 v[96:99], v11, s[28:31], 0 offen sc1
    ds_write_b128 v19, v[96:99] offset:0
    s_waitcnt lgkmcnt(0)
    s_waitcnt vmcnt(5)
    s_barrier
    s_and_b32 s57, s58, 15
    s_lshr_b64 s[58:59], s[58:59], 4
    s_lshl_b32 s56, s57, 11
    s_mul_i32 s57, s57, 0x60000
    s_add_u32 m0, s53, s74
    s_nop 0
    buffer_load_dwordx4 v187, s[32:35], s57 offen offset:0 lds
    buffer_load_dwordx4 v188, s[32:35], s57 offen offset:1024 lds
    buffer_load_dwordx4 v189, s[32:35], s57 offen offset:2048 lds
    buffer_load_dwordx4 v190, s[32:35], s57 offen offset:3072 lds
    s_add_u32 m0, s53, s75
    s_nop 0
    buffer_load_dwordx4 v191, s[32:35], s57 offen offset:0 lds
    buffer_load_dwordx4 v192, s[32:35], s57 offen offset:1024 lds
    s_add_u32 s53, s53, 49152
    s_cmp_ge_u32 s53, 147456
    s_cselect_b32 s53, 0, s53
    s_mov_b32 s64, 0x0
    buffer_load_dwordx4 v[32:35], v17, s[36:39], s64 offen
    s_mov_b32 s64, 0x60000
    buffer_load_dwordx4 v[36:39], v17, s[36:39], s64 offen
    s_mov_b32 s64, 0xc0000
    buffer_load_dwordx4 v[40:43], v17, s[36:39], s64 offen
    s_mov_b32 s53, 0
    s_bfe_u32 s66, s2, 0x30003
    s_lshr_b32 s55, s2, 6
    s_add_u32 s66, s66, s55
    s_and_b32 s66, s66, 3
    s_mov_b32 s58, 0x76453210
    s_mov_b32 s59, 0xfecdba89
    s_cmp_eq_u32 s66, 1
    s_cselect_b32 s58, 0x75643120, s58
    s_cselect_b32 s59, 0xfdecb9a8, s59
    s_cmp_eq_u32 s66, 2
    s_cselect_b32 s58, 0x67542310, s58
    s_cselect_b32 s59, 0xefdcab98, s59
    s_cmp_eq_u32 s66, 3
    s_cselect_b32 s58, 0x86534210, s58
    s_cselect_b32 s59, 0xfedbca97, s59
    s_lshl_b32 s55, s48, 2
    s_lshr_b64 s[56:57], s[58:59], s55
    s_and_b32 s55, s56, 15
    s_lshl_b32 s55, s55, 2
    s_lshl_b64 s[56:57], 15, s55
    s_andn2_b64 s[58:59], s[58:59], s[56:57]
    s_or_b32 s58, s58, s48
    s_waitcnt vmcnt(9)
    s_mov_b64 exec, 1
    ds_add_rtn_u32 v245, v5, v2
    s_mov_b64 exec, -1
    s_mov_b32 s1, 1
    s_mov_b32 s3, 0x4000
    s_waitcnt lgkmcnt(0)
    v_readfirstlane_b32 s64, v245
    s_nop 3
    s_cmp_lg_u32 s64, 3
    s_cbranch_scc1 M_p1_ok
    s_atomic_add s1, s[62:63], 0
    s_atomic_add s1, s[62:63], 128
    s_atomic_add s1, s[62:63], 256
    s_atomic_add s1, s[62:63], 384
M_p1_chk:
    s_load_dword s64, s[62:63], s68 glc
    s_sub_u32 s3, s3, 1
    s_cselect_b32 s65, 0, 16
    s_waitcnt lgkmcnt(0)
    s_cmp_lt_u32 s64, s65
    s_cbranch_scc1 M_p1_chk
M_p1_ok:
    s_barrier
    s_and_b32 s57, s58, 15
    s_lshr_b64 s[58:59], s[58:59], 4
    s_lshl_b32 s56, s57, 11
    s_mul_i32 s57, s57, 0x60000
    s_add_u32 s53, s53, 49152
    s_cmp_ge_u32 s53, 147456
    s_cselect_b32 s53, 0, s53
    s_and_b32 s57, s58, 15
    s_lshr_b64 s[58:59], s[58:59], 4
    s_lshl_b32 s56, s57, 11
    s_mul_i32 s57, s57, 0x60000
    s_add_u32 m0, s53, s72
    s_nop 0
    buffer_load_dwordx4 v184, s[28:31], s56 offen offset:0 lds
    buffer_load_dwordx4 v184, s[28:31], s56 offen offset:1024 lds
    buffer_load_dwordx4 v185, s[28:31], s56 offen offset:2048 lds
    buffer_load_dwordx4 v185, s[28:31], s56 offen offset:3072 lds
    s_add_u32 m0, s53, s73
    s_mov_b32 exec_hi, 0
    buffer_load_dwordx4 v186, s[28:31], s56 offen offset:0 lds
    s_mov_b32 exec_hi, -1
    s_add_u32 s53, s53, 49152
    s_cmp_ge_u32 s53, 147456
    s_cselect_b32 s53, 0, s53
    s_and_b32 s57, s58, 15
    s_lshr_b64 s[58:59], s[58:59], 4
    s_lshl_b32 s56, s57, 11
    s_mul_i32 s57, s57, 0x60000
    s_add_u32 m0, s53, s74
    s_nop 0
    buffer_load_dwordx4 v187, s[32:35], s57 offen offset:0 lds
    buffer_load_dwordx4 v188, s[32:35], s57 offen offset:1024 lds
    buffer_load_dwordx4 v189, s[32:35], s57 offen offset:2048 lds
    buffer_load_dwordx4 v190, s[32:35], s57 offen offset:3072 lds
    s_add_u32 m0, s53, s75
    s_nop 0
    buffer_load_dwordx4 v191, s[32:35], s57 offen offset:0 lds
    buffer_load_dwordx4 v192, s[32:35], s57 offen offset:1024 lds
    s_add_u32 m0, s53, s72
    s_nop 0
    buffer_load_dwordx4 v184, s[28:31], s56 offen offset:0 lds
    buffer_load_dwordx4 v184, s[28:31], s56 offen offset:1024 lds
    buffer_load_dwordx4 v185, s[28:31], s56 offen offset:2048 lds
    buffer_load_dwordx4 v185, s[28:31], s56 offen offset:3072 lds
    s_add_u32 m0, s53, s73
    s_mov_b32 exec_hi, 0
    buffer_load_dwordx4 v186, s[28:31], s56 offen offset:0 lds
    s_mov_b32 exec_hi, -1
    s_add_u32 s53, s53, 49152
    s_cmp_ge_u32 s53, 147456
    s_cselect_b32 s53, 0, s53
    s_waitcnt vmcnt(11)
    s_barrier
    s_and_b32 s57, s58, 15
    s_lshr_b64 s[58:59], s[58:59], 4
    s_lshl_b32 s56, s57, 11
    s_mul_i32 s57, s57, 0x60000
    s_add_u32 m0, s53, s74
    s_nop 0
    buffer_load_dwordx4 v187, s[32:35], s57 offen offset:0 lds
    buffer_load_dwordx4 v188, s[32:35], s57 offen offset:1024 lds
    s_load_dword s99, s[10:11], -3712
    buffer_load_dwordx4 v189, s[32:35], s57 offen offset:2048 lds
    buffer_load_dwordx4 v190, s[32:35], s57 offen offset:3072 lds
    s_load_dword s99, s[24:25], -3712
    s_add_u32 m0, s53, s75
    s_nop 0
    buffer_load_dwordx4 v191, s[32:35], s57 offen offset:0 lds
    buffer_load_dwordx4 v192, s[32:35], s57 offen offset:1024 lds
    s_load_dword s99, s[10:11], -3648
    s_add_u32 m0, s53, s72
    s_nop 0
    buffer_load_dwordx4 v184, s[28:31], s56 offen offset:0 lds
    buffer_load_dwordx4 v184, s[28:31], s56 offen offset:1024 lds
    s_load_dword s99, s[24:25], -3648
    buffer_load_dwordx4 v185, s[28:31], s56 offen offset:2048 lds
    buffer_load_dwordx4 v185, s[28:31], s56 offen offset:3072 lds
    s_load_dword s99, s[10:11], -2688
    s_add_u32 m0, s53, s73
    s_mov_b32 exec_hi, 0
    buffer_load_dwordx4 v186, s[28:31], s56 offen offset:0 lds
    s_mov_b32 exec_hi, -1
    s_add_u32 s53, s53, 49152
    s_cmp_ge_u32 s53, 147456
    s_cselect_b32 s53, 0, s53
    s_load_dword s99, s[24:25], -2688
    s_waitcnt vmcnt(11)
    s_barrier
    s_and_b32 s57, s58, 15
    s_lshr_b64 s[58:59], s[58:59], 4
    s_lshl_b32 s56, s57, 11
    s_mul_i32 s57, s57, 0x60000
    s_add_u32 m0, s53, s74
    s_nop 0
    buffer_load_dwordx4 v187, s[32:35], s57 offen offset:0 lds
    buffer_load_dwordx4 v188, s[32:35], s57 offen offset:1024 lds
    s_load_dword s99, s[10:11], -2624
    buffer_load_dwordx4 v189, s[32:35], s57 offen offset:2048 lds
    buffer_load_dwordx4 v190, s[32:35], s57 offen offset:3072 lds
    s_load_dword s99, s[24:25], -2624
    s_add_u32 m0, s53, s75
    s_nop 0
    buffer_load_dwordx4 v191, s[32:35], s57 offen offset:0 lds
    buffer_load_dwordx4 v192, s[32:35], s57 offen offset:1024 lds
    s_load_dword s99, s[10:11], -1664
    s_add_u32 m0, s53, s72
    s_nop 0
    buffer_load_dwordx4 v184, s[28:31], s56 offen offset:0 lds
    buffer_load_dwordx4 v184, s[28:31], s56 offen offset:1024 lds
    s_load_dword s99, s[24:25], -1664
    buffer_load_dwordx4 v185, s[28:31], s56 offen offset:2048 lds
    buffer_load_dwordx4 v185, s[28:31], s56 offen offset:3072 lds
    s_load_dword s99, s[10:11], -1600
    s_add_u32 m0, s53, s73
    s_mov_b32 exec_hi, 0
    buffer_load_dwordx4 v186, s[28:31], s56 offen offset:0 lds
    s_mov_b32 exec_hi, -1
    s_add_u32 s53, s53, 49152
    s_cmp_ge_u32 s53, 147456
    s_cselect_b32 s53, 0, s53
    s_load_dword s99, s[24:25], -1600
    s_waitcnt vmcnt(11)
    s_barrier
    s_and_b32 s57, s58, 15
    s_lshr_b64 s[58:59], s[58:59], 4
    s_lshl_b32 s56, s57, 11
    s_mul_i32 s57, s57, 0x60000
    s_add_u32 m0, s53, s74
    s_nop 0
    buffer_load_dwordx4 v187, s[32:35], s57 offen offset:0 lds
    buffer_load_dwordx4 v188, s[32:35], s57 offen offset:1024 lds
    buffer_load_dwordx4 v189, s[32:35], s57 offen offset:2048 lds
    s_load_dword s99, s[10:11], -640
    buffer_load_dwordx4 v190, s[32:35], s57 offen offset:3072 lds
    s_add_u32 m0, s53, s75
    s_nop 0
    buffer_load_dwordx4 v191, s[32:35], s57 offen offset:0 lds
    buffer_load_dwordx4 v192, s[32:35], s57 offen offset:1024 lds
    s_load_dword s99, s[24:25], -640
    s_add_u32 m0, s53, s72
    s_nop 0
    buffer_load_dwordx4 v184, s[28:31], s56 offen offset:0 lds
    buffer_load_dwordx4 v184, s[28:31], s56 offen offset:1024 lds
    buffer_load_dwordx4 v185, s[28:31], s56 offen offset:2048 lds
    s_load_dword s99, s[10:11], -576
    buffer_load_dwordx4 v185, s[28:31], s56 offen offset:3072 lds
    s_add_u32 m0, s53, s73
    s_mov_b32 exec_hi, 0
    buffer_load_dwordx4 v186, s[28:31], s56 offen offset:0 lds
    s_mov_b32 exec_hi, -1
    s_add_u32 s53, s53, 49152
    s_cmp_ge_u32 s53, 147456
    s_cselect_b32 s53, 0, s53
    s_load_dword s99, s[24:25], -576
    s_movk_i32 s54, 8
M_Q_loop0:
    s_waitcnt vmcnt(11)
    s_barrier
    s_and_b32 s57, s58, 15
    s_lshr_b64 s[58:59], s[58:59], 4
    s_lshl_b32 s56, s57, 11
    s_mul_i32 s57, s57, 0x60000
    s_add_u32 m0, s53, s74
    s_nop 0
    buffer_load_dwordx4 v187, s[32:35], s57 offen offset:0 lds
    buffer_load_dwordx4 v188, s[32:35], s57 offen offset:1024 lds
    s_load_dword s99, s[10:11], 0
    buffer_load_dwordx4 v189, s[32:35], s57 offen offset:2048 lds
    buffer_load_dwordx4 v190, s[32:35], s57 offen offset:3072 lds
    s_add_u32 m0, s53, s75
    s_nop 0
    buffer_load_dwordx4 v191, s[32:35], s57 offen offset:0 lds
    s_load_dword s99, s[24:25], 0
    buffer_load_dwordx4 v192, s[32:35], s57 offen offset:1024 lds
    s_add_u32 m0, s53, s72
    s_nop 0
    buffer_load_dwordx4 v184, s[28:31], s56 offen offset:0 lds
    s_load_dword s99, s[10:11], 64
    buffer_load_dwordx4 v184, s[28:31], s56 offen offset:1024 lds
    buffer_load_dwordx4 v185, s[28:31], s56 offen offset:2048 lds
    buffer_load_dwordx4 v185, s[28:31], s56 offen offset:3072 lds
    s_load_dword s99, s[24:25], 64
    s_add_u32 m0, s53, s73
    s_mov_b32 exec_hi, 0
    buffer_load_dwordx4 v186, s[28:31], s56 offen offset:0 lds
    s_mov_b32 exec_hi, -1
    s_add_u32 s53, s53, 49152
    s_cmp_ge_u32 s53, 147456
    s_cselect_b32 s53, 0, s53
    s_add_u32 s10, s10, 128
    s_addc_u32 s11, s11, 0
    s_add_u32 s24, s24, 128
    s_addc_u32 s25, s25, 0
    s_sub_u32 s54, s54, 1
    s_cbranch_scc0 M_Q_loop0
    s_waitcnt vmcnt(11)
    s_barrier
    s_and_b32 s57, s58, 15
    s_lshr_b64 s[58:59], s[58:59], 4
    s_lshl_b32 s56, s57, 11
    s_mul_i32 s57, s57, 0x60000
    s_add_u32 m0, s53, s74
    s_nop 0
    buffer_load_dwordx4 v187, s[32:35], s57 offen offset:0 lds
    buffer_load_dwordx4 v188, s[32:35], s57 offen offset:1024 lds
    buffer_load_dwordx4 v189, s[32:35], s57 offen offset:2048 lds
    buffer_load_dwordx4 v190, s[32:35], s57 offen offset:3072 lds
    s_add_u32 m0, s53, s75
    s_nop 0
    buffer_load_dwordx4 v191, s[32:35], s57 offen offset:0 lds
    buffer_load_dwordx4 v192, s[32:35], s57 offen offset:1024 lds
    s_add_u32 m0, s53, s72
    s_nop 0
    buffer_load_dwordx4 v184, s[28:31], s56 offen offset:0 lds
    buffer_load_dwordx4 v184, s[28:31], s56 offen offset:1024 lds
    buffer_load_dwordx4 v185, s[28:31], s56 offen offset:2048 lds
    buffer_load_dwordx4 v185, s[28:31], s56 offen offset:3072 lds
    s_add_u32 m0, s53, s73
    s_mov_b32 exec_hi, 0
    buffer_load_dwordx4 v186, s[28:31], s56 offen offset:0 lds
    s_mov_b32 exec_hi, -1
    s_add_u32 s53, s53, 49152
    s_cmp_ge_u32 s53, 147456
    s_cselect_b32 s53, 0, s53
    s_mov_b32 s64, 0x120000
    buffer_load_dwordx4 v[44:47], v17, s[36:39], s64 offen
    s_mov_b32 s64, 0x180000
    buffer_load_dwordx4 v[48:51], v17, s[36:39], s64 offen
    s_mov_b32 s64, 0x1e0000
    buffer_load_dwordx4 v[52:55], v17, s[36:39], s64 offen
    s_mov_b32 s64, 0x240000
    buffer_load_dwordx4 v[56:59], v17, s[36:39], s64 offen
    s_mov_b32 s64, 0x2a0000
    buffer_load_dwordx4 v[60:63], v17, s[36:39], s64 offen
    s_lshl_b32 s60, s44, 12
    s_add_u32 s61, s60, 147456
    s_add_u32 s53, s60, 49152
    s_lshl_b32 s70, s44, 11
    s_sub_u32 s70, 16384, s70
    s_bfe_u32 s66, s2, 0x30003
    s_lshr_b32 s55, s2, 6
    s_add_u32 s66, s66, s55
    s_and_b32 s66, s66, 3
    s_mov_b32 s58, 0x76453210
    s_mov_b32 s59, 0xfecdba89
    s_cmp_eq_u32 s66, 1
    s_cselect_b32 s58, 0x75643120, s58
    s_cselect_b32 s59, 0xfdecb9a8, s59
    s_cmp_eq_u32 s66, 2
    s_cselect_b32 s58, 0x67542310, s58
    s_cselect_b32 s59, 0xefdcab98, s59
    s_cmp_eq_u32 s66, 3
    s_cselect_b32 s58, 0x86534210, s58
    s_cselect_b32 s59, 0xfedbca97, s59
    s_mov_b32 s32, s8
    s_mov_b32 s33, s9
    s_mov_b32 s34, 0x200000
    s_mov_b32 s35, 0x20000
    s_waitcnt vmcnt(16)
    s_barrier
    s_waitcnt vmcnt(5)
    s_barrier
    s_barrier
    s_and_b32 s57, s58, 15
    s_lshr_b64 s[58:59], s[58:59], 4
    s_lshl_b32 s56, s57, 11
    s_mul_i32 s57, s57, 0x20000
    s_add_u32 m0, s53, s70
    s_nop 0
    buffer_load_dwordx4 v193, s[32:35], s57 offen offset:0 lds
    buffer_load_dwordx4 v194, s[32:35], s57 offen offset:1024 lds
    s_add_u32 s53, s53, 24576
    s_cmp_ge_u32 s53, s61
    s_cselect_b32 s53, s60, s53
    s_and_b32 s57, s58, 15
    s_lshr_b64 s[58:59], s[58:59], 4
    s_lshl_b32 s56, s57, 11
    s_mul_i32 s57, s57, 0x20000
    s_add_u32 m0, s53, s70
    s_nop 0
    buffer_load_dwordx4 v193, s[32:35], s57 offen offset:0 lds
    buffer_load_dwordx4 v194, s[32:35], s57 offen offset:1024 lds
    s_add_u32 s53, s53, 24576
    s_cmp_ge_u32 s53, s61
    s_cselect_b32 s53, s60, s53
    s_and_b32 s57, s58, 15
    s_lshr_b64 s[58:59], s[58:59], 4
    s_lshl_b32 s56, s57, 11
    s_mul_i32 s57, s57, 0x20000
    s_add_u32 m0, s53, s70
    s_nop 0
    buffer_load_dwordx4 v193, s[32:35], s57 offen offset:0 lds
    buffer_load_dwordx4 v194, s[32:35], s57 offen offset:1024 lds
    s_add_u32 s53, s53, 24576
    s_cmp_ge_u32 s53, s61
    s_cselect_b32 s53, s60, s53
    s_and_b32 s57, s58, 15
    s_lshr_b64 s[58:59], s[58:59], 4
    s_lshl_b32 s56, s57, 11
    s_mul_i32 s57, s57, 0x20000
    s_add_u32 m0, s53, s70
    s_nop 0
    buffer_load_dwordx4 v193, s[32:35], s57 offen offset:0 lds
    buffer_load_dwordx4 v194, s[32:35], s57 offen offset:1024 lds
    s_add_u32 s53, s53, 24576
    s_cmp_ge_u32 s53, s61
    s_cselect_b32 s53, s60, s53
    s_and_b32 s57, s58, 15
    s_lshr_b64 s[58:59], s[58:59], 4
    s_lshl_b32 s56, s57, 11
    s_mul_i32 s57, s57, 0x20000
    s_add_u32 m0, s53, s70
    s_nop 0
    buffer_load_dwordx4 v193, s[32:35], s57 offen offset:0 lds
    buffer_load_dwordx4 v194, s[32:35], s57 offen offset:1024 lds
    s_add_u32 s53, s53, 24576
    s_cmp_ge_u32 s53, s61
    s_cselect_b32 s53, s60, s53
    s_and_b32 s57, s58, 15
    s_lshr_b64 s[58:59], s[58:59], 4
    s_lshl_b32 s56, s57, 11
    s_mul_i32 s57, s57, 0x20000
    s_add_u32 m0, s53, s70
    s_nop 0
    buffer_load_dwordx4 v193, s[32:35], s57 offen offset:0 lds
    buffer_load_dwordx4 v194, s[32:35], s57 offen offset:1024 lds
    s_add_u32 s53, s53, 24576
    s_cmp_ge_u32 s53, s61
    s_cselect_b32 s53, s60, s53
    s_mov_b32 s40, s8
    s_mov_b32 s41, s9
    s_mov_b32 s42, 0x200000
    s_mov_b32 s43, 0x20000
    s_mov_b32 s64, 0x0
    buffer_load_dword v244, v243, s[40:43], s64 offen
    v_lshlrev_b32 v24, 16, v24
    v_lshlrev_b32 v25, 16, v25
    v_lshlrev_b32 v26, 16, v26
    v_lshlrev_b32 v27, 16, v27
    v_lshlrev_b32 v28, 16, v28
    v_lshlrev_b32 v29, 16, v29
    v_lshlrev_b32 v30, 16, v30
    v_lshlrev_b32 v31, 16, v31
    v_mul_f32 v72, 0xbfb8aa3b, v24
    v_mul_f32 v73, 0xbfb8aa3b, v25
    v_mul_f32 v74, 0xbfb8aa3b, v26
    v_mul_f32 v75, 0xbfb8aa3b, v27
    v_mul_f32 v76, 0xbfb8aa3b, v28
    v_mul_f32 v77, 0xbfb8aa3b, v29
    v_mul_f32 v78, 0xbfb8aa3b, v30
    v_mul_f32 v79, 0xbfb8aa3b, v31
    v_exp_f32 v72, v72
    v_exp_f32 v73, v73
    v_exp_f32 v74, v74
    v_exp_f32 v75, v75
    v_exp_f32 v76, v76
    v_exp_f32 v77, v77
    v_exp_f32 v78, v78
    v_exp_f32 v79, v79
    v_add_f32 v72, 1.0, v72
    v_add_f32 v73, 1.0, v73
    v_add_f32 v74, 1.0, v74
    v_add_f32 v75, 1.0, v75
    v_add_f32 v76, 1.0, v76
    v_add_f32 v77, 1.0, v77
    v_add_f32 v78, 1.0, v78
    v_add_f32 v79, 1.0, v79
    v_rcp_f32 v72, v72
    v_rcp_f32 v73, v73
    v_rcp_f32 v74, v74
    v_rcp_f32 v75, v75
    v_rcp_f32 v76, v76
    v_rcp_f32 v77, v77
    v_rcp_f32 v78, v78
    v_rcp_f32 v79, v79
    v_mul_f32 v24, v24, v72
    v_mul_f32 v25, v25, v73
    v_mul_f32 v26, v26, v74
    v_mul_f32 v27, v27, v75
    v_mul_f32 v28, v28, v76
    v_mul_f32 v29, v29, v77
    v_mul_f32 v30, v30, v78
    v_mul_f32 v31, v31, v79
    v_cvt_pk_bf16_f32 v72, v24, v24
    v_lshlrev_b32 v24, 16, v72
    v_cvt_pk_bf16_f32 v73, v25, v25
    v_lshlrev_b32 v25, 16, v73
    v_cvt_pk_bf16_f32 v74, v26, v26
    v_lshlrev_b32 v26, 16, v74
    v_cvt_pk_bf16_f32 v75, v27, v27
    v_lshlrev_b32 v27, 16, v75
    v_cvt_pk_bf16_f32 v76, v28, v28
    v_lshlrev_b32 v28, 16, v76
    v_cvt_pk_bf16_f32 v77, v29, v29
    v_lshlrev_b32 v29, 16, v77
    v_cvt_pk_bf16_f32 v78, v30, v30
    v_lshlrev_b32 v30, 16, v78
    v_cvt_pk_bf16_f32 v79, v31, v31
    v_lshlrev_b32 v31, 16, v79
    v_lshlrev_b32 v72, 16, v32
    v_and_b32 v73, 0xffff0000, v32
    v_lshlrev_b32 v74, 16, v33
    v_and_b32 v75, 0xffff0000, v33
    v_lshlrev_b32 v76, 16, v34
    v_and_b32 v77, 0xffff0000, v34
    v_lshlrev_b32 v78, 16, v35
    v_and_b32 v79, 0xffff0000, v35
    v_mul_f32 v64, v24, v72
    v_mul_f32 v65, v24, v73
    v_mul_f32 v66, v24, v74
    v_mul_f32 v67, v24, v75
    v_mul_f32 v68, v24, v76
    v_mul_f32 v69, v24, v77
    v_mul_f32 v70, v24, v78
    v_mul_f32 v71, v24, v79
    v_lshlrev_b32 v72, 16, v36
    v_and_b32 v73, 0xffff0000, v36
    v_lshlrev_b32 v74, 16, v37
    v_and_b32 v75, 0xffff0000, v37
    v_lshlrev_b32 v76, 16, v38
    v_and_b32 v77, 0xffff0000, v38
    v_lshlrev_b32 v78, 16, v39
    v_and_b32 v79, 0xffff0000, v39
    v_fmac_f32 v64, v25, v72
    v_fmac_f32 v65, v25, v73
    v_fmac_f32 v66, v25, v74
    v_fmac_f32 v67, v25, v75
    v_fmac_f32 v68, v25, v76
    v_fmac_f32 v69, v25, v77
    v_fmac_f32 v70, v25, v78
    v_fmac_f32 v71, v25, v79
    v_lshlrev_b32 v72, 16, v40
    v_and_b32 v73, 0xffff0000, v40
    v_lshlrev_b32 v74, 16, v41
    v_and_b32 v75, 0xffff0000, v41
    v_lshlrev_b32 v76, 16, v42
    v_and_b32 v77, 0xffff0000, v42
    v_lshlrev_b32 v78, 16, v43
    v_and_b32 v79, 0xffff0000, v43
    v_fmac_f32 v64, v26, v72
    v_fmac_f32 v65, v26, v73
    v_fmac_f32 v66, v26, v74
    v_fmac_f32 v67, v26, v75
    v_fmac_f32 v68, v26, v76
    v_fmac_f32 v69, v26, v77
    v_fmac_f32 v70, v26, v78
    v_fmac_f32 v71, v26, v79
    s_waitcnt vmcnt(17)
    v_lshlrev_b32 v72, 16, v44
    v_and_b32 v73, 0xffff0000, v44
    v_lshlrev_b32 v74, 16, v45
    v_and_b32 v75, 0xffff0000, v45
    v_lshlrev_b32 v76, 16, v46
    v_and_b32 v77, 0xffff0000, v46
    v_lshlrev_b32 v78, 16, v47
    v_and_b32 v79, 0xffff0000, v47
    v_fmac_f32 v64, v27, v72
    v_fmac_f32 v65, v27, v73
    v_fmac_f32 v66, v27, v74
    v_fmac_f32 v67, v27, v75
    v_fmac_f32 v68, v27, v76
    v_fmac_f32 v69, v27, v77
    v_fmac_f32 v70, v27, v78
    v_fmac_f32 v71, v27, v79
    s_waitcnt vmcnt(16)
    v_lshlrev_b32 v72, 16, v48
    v_and_b32 v73, 0xffff0000, v48
    v_lshlrev_b32 v74, 16, v49
    v_and_b32 v75, 0xffff0000, v49
    v_lshlrev_b32 v76, 16, v50
    v_and_b32 v77, 0xffff0000, v50
    v_lshlrev_b32 v78, 16, v51
    v_and_b32 v79, 0xffff0000, v51
    v_fmac_f32 v64, v28, v72
    v_fmac_f32 v65, v28, v73
    v_fmac_f32 v66, v28, v74
    v_fmac_f32 v67, v28, v75
    v_fmac_f32 v68, v28, v76
    v_fmac_f32 v69, v28, v77
    v_fmac_f32 v70, v28, v78
    v_fmac_f32 v71, v28, v79
    s_waitcnt vmcnt(15)
    v_lshlrev_b32 v72, 16, v52
    v_and_b32 v73, 0xffff0000, v52
    v_lshlrev_b32 v74, 16, v53
    v_and_b32 v75, 0xffff0000, v53
    v_lshlrev_b32 v76, 16, v54
    v_and_b32 v77, 0xffff0000, v54
    v_lshlrev_b32 v78, 16, v55
    v_and_b32 v79, 0xffff0000, v55
    v_fmac_f32 v64, v29, v72
    v_fmac_f32 v65, v29, v73
    v_fmac_f32 v66, v29, v74
    v_fmac_f32 v67, v29, v75
    v_fmac_f32 v68, v29, v76
    v_fmac_f32 v69, v29, v77
    v_fmac_f32 v70, v29, v78
    v_fmac_f32 v71, v29, v79
    s_waitcnt vmcnt(14)
    v_lshlrev_b32 v72, 16, v56
    v_and_b32 v73, 0xffff0000, v56
    v_lshlrev_b32 v74, 16, v57
    v_and_b32 v75, 0xffff0000, v57
    v_lshlrev_b32 v76, 16, v58
    v_and_b32 v77, 0xffff0000, v58
    v_lshlrev_b32 v78, 16, v59
    v_and_b32 v79, 0xffff0000, v59
    v_fmac_f32 v64, v30, v72
    v_fmac_f32 v65, v30, v73
    v_fmac_f32 v66, v30, v74
    v_fmac_f32 v67, v30, v75
    v_fmac_f32 v68, v30, v76
    v_fmac_f32 v69, v30, v77
    v_fmac_f32 v70, v30, v78
    v_fmac_f32 v71, v30, v79
    s_waitcnt vmcnt(13)
    v_lshlrev_b32 v72, 16, v60
    v_and_b32 v73, 0xffff0000, v60
    v_lshlrev_b32 v74, 16, v61
    v_and_b32 v75, 0xffff0000, v61
    v_lshlrev_b32 v76, 16, v62
    v_and_b32 v77, 0xffff0000, v62
    v_lshlrev_b32 v78, 16, v63
    v_and_b32 v79, 0xffff0000, v63
    v_fmac_f32 v64, v31, v72
    v_fmac_f32 v65, v31, v73
    v_fmac_f32 v66, v31, v74
    v_fmac_f32 v67, v31, v75
    v_fmac_f32 v68, v31, v76
    v_fmac_f32 v69, v31, v77
    v_fmac_f32 v70, v31, v78
    v_fmac_f32 v71, v31, v79
    v_add_f32_dpp v64, v64, v64 row_ror:8 row_mask:0xf bank_mask:0xf
    v_add_f32_dpp v65, v65, v65 row_ror:8 row_mask:0xf bank_mask:0xf
    v_add_f32_dpp v66, v66, v66 row_ror:8 row_mask:0xf bank_mask:0xf
    v_add_f32_dpp v67, v67, v67 row_ror:8 row_mask:0xf bank_mask:0xf
    v_add_f32_dpp v68, v68, v68 row_ror:8 row_mask:0xf bank_mask:0xf
    v_add_f32_dpp v69, v69, v69 row_ror:8 row_mask:0xf bank_mask:0xf
    v_add_f32_dpp v70, v70, v70 row_ror:8 row_mask:0xf bank_mask:0xf
    v_add_f32_dpp v71, v71, v71 row_ror:8 row_mask:0xf bank_mask:0xf
    v_mov_b32 v72, v64
    v_mov_b32 v73, v65
    v_mov_b32 v74, v66
    v_mov_b32 v75, v67
    v_mov_b32 v76, v68
    v_mov_b32 v77, v69
    v_mov_b32 v78, v70
    v_mov_b32 v79, v71
    v_permlane32_swap_b32 v64, v72
    v_permlane32_swap_b32 v65, v73
    v_permlane32_swap_b32 v66, v74
    v_permlane32_swap_b32 v67, v75
    v_permlane32_swap_b32 v68, v76
    v_permlane32_swap_b32 v69, v77
    v_permlane32_swap_b32 v70, v78
    v_permlane32_swap_b32 v71, v79
    v_add_f32 v64, v64, v72
    v_add_f32 v65, v65, v73
    v_add_f32 v66, v66, v74
    v_add_f32 v67, v67, v75
    v_add_f32 v68, v68, v76
    v_add_f32 v69, v69, v77
    v_add_f32 v70, v70, v78
    v_add_f32 v71, v71, v79
    v_mov_b32 v72, v64
    v_mov_b32 v73, v65
    v_mov_b32 v74, v66
    v_mov_b32 v75, v67
    v_mov_b32 v76, v68
    v_mov_b32 v77, v69
    v_mov_b32 v78, v70
    v_mov_b32 v79, v71
    v_permlane16_swap_b32 v64, v72
    v_permlane16_swap_b32 v65, v73
    v_permlane16_swap_b32 v66, v74
    v_permlane16_swap_b32 v67, v75
    v_permlane16_swap_b32 v68, v76
    v_permlane16_swap_b32 v69, v77
    v_permlane16_swap_b32 v70, v78
    v_permlane16_swap_b32 v71, v79
    v_add_f32 v64, v64, v72
    v_add_f32 v65, v65, v73
    v_add_f32 v66, v66, v74
    v_add_f32 v67, v67, v75
    v_add_f32 v68, v68, v76
    v_add_f32 v69, v69, v77
    v_add_f32 v70, v70, v78
    v_add_f32 v71, v71, v79
    s_lshl_b32 s64, s44, 8
    s_add_u32 s64, s64, 147456
    v_and_b32 v72, 7, v0
    v_lshl_add_u32 v72, v72, 5, s64
    ds_write_b128 v72, v[64:67]
    ds_write_b128 v72, v[68:71] offset:16
    v_mov_b32 v73, 148480
    v_mov_b32 v74, 1
    s_waitcnt lgkmcnt(0)
    s_mov_b64 exec, 1
    ds_add_rtn_u32 v75, v73, v74
    s_mov_b64 exec, -1
    v_add_u32 v73, 147456, v234
    s_waitcnt lgkmcnt(0)
    ds_read_b32 v64, v73 offset:0
    ds_read_b32 v65, v73 offset:256
    ds_read_b32 v66, v73 offset:512
    ds_read_b32 v67, v73 offset:768
    v_readfirstlane_b32 s64, v75
    s_nop 3
    s_cmp_eq_u32 s64, 3
    s_cselect_b32 s80, s80, 0x80000000
    v_lshl_add_u32 v72, v1, 3, s80
    s_waitcnt lgkmcnt(0)
    v_add_f32 v64, v64, v65
    v_add_f32 v66, v66, v67
    v_add_f32 v64, v64, v66
    v_mov_b32 v65, s0
    buffer_store_dwordx2 v[64:65], v72, s[28:31], 0 offen sc1
    s_mov_b32 s40, s4
    s_mov_b32 s41, s5
    s_mov_b32 s42, 0x400000
    s_mov_b32 s43, 0x20000
    s_mov_b32 s64, 0x8000
    buffer_load_dwordx4 v[88:91], v196, s[40:43], 0 offen offset:0
    buffer_load_dwordx4 v[92:95], v196, s[40:43], 0 offen offset:64
    buffer_load_dwordx4 v[96:99], v196, s[40:43], s64 offen offset:0
    buffer_load_dwordx4 v[100:103], v196, s[40:43], s64 offen offset:64
    s_lshl_b32 s60, s44, 12
    s_add_u32 s61, s60, 147456
    s_add_u32 s53, s60, 0
    s_bfe_u32 s66, s2, 0x30003
    s_lshr_b32 s55, s2, 6
    s_add_u32 s66, s66, s55
    s_and_b32 s66, s66, 3
    s_mov_b32 s58, 0x76453210
    s_mov_b32 s59, 0xfecdba89
    s_cmp_eq_u32 s66, 1
    s_cselect_b32 s58, 0x75643120, s58
    s_cselect_b32 s59, 0xfdecb9a8, s59
    s_cmp_eq_u32 s66, 2
    s_cselect_b32 s58, 0x67542310, s58
    s_cselect_b32 s59, 0xefdcab98, s59
    s_cmp_eq_u32 s66, 3
    s_cselect_b32 s58, 0x86534210, s58
    s_cselect_b32 s59, 0xfedbca97, s59
    s_lshl_b32 s55, s48, 2
    s_lshr_b64 s[56:57], s[58:59], s55
    s_and_b32 s55, s56, 15
    s_lshl_b32 s55, s55, 2
    s_lshl_b64 s[56:57], 15, s55
    s_andn2_b64 s[58:59], s[58:59], s[56:57]
    s_or_b32 s58, s58, s48
    s_mov_b32 s32, s12
    s_mov_b32 s33, s13
    s_mov_b32 s34, 0x700000
    s_mov_b32 s35, 0x20000
    s_mov_b32 s36, s14
    s_mov_b32 s37, s15
    s_mov_b32 s38, 0x700000
    s_mov_b32 s39, 0x20000
    s_mov_b32 s72, 0xb00000
    s_mov_b32 s74, 0x1000000
    s_mov_b32 s73, 0xb08000
    s_mov_b32 s75, 0x1008000
    s_lshl_b32 s76, s48, 8
    s_waitcnt vmcnt(0)
    v_permlane16_swap_b32 v88, v90
    v_permlane16_swap_b32 v89, v91
    v_permlane16_swap_b32 v92, v94
    v_permlane16_swap_b32 v93, v95
    v_permlane16_swap_b32 v96, v98
    v_permlane16_swap_b32 v97, v99
    v_permlane16_swap_b32 v100, v102
    v_permlane16_swap_b32 v101, v103
    v_lshlrev_b32 v104, 16, v88
    v_and_b32 v105, 0xffff0000, v88
    v_lshlrev_b32 v106, 16, v89
    v_and_b32 v107, 0xffff0000, v89
    v_lshlrev_b32 v108, 16, v90
    v_and_b32 v109, 0xffff0000, v90
    v_lshlrev_b32 v110, 16, v91
    v_and_b32 v111, 0xffff0000, v91
    v_lshlrev_b32 v112, 16, v92
    v_and_b32 v113, 0xffff0000, v92
    v_lshlrev_b32 v114, 16, v93
    v_and_b32 v115, 0xffff0000, v93
    v_lshlrev_b32 v116, 16, v94
    v_and_b32 v117, 0xffff0000, v94
    v_lshlrev_b32 v118, 16, v95
    v_and_b32 v119, 0xffff0000, v95
    v_lshlrev_b32 v120, 16, v96
    v_and_b32 v121, 0xffff0000, v96
    v_lshlrev_b32 v122, 16, v97
    v_and_b32 v123, 0xffff0000, v97
    v_lshlrev_b32 v124, 16, v98
    v_and_b32 v125, 0xffff0000, v98
    v_lshlrev_b32 v126, 16, v99
    v_and_b32 v127, 0xffff0000, v99
    v_lshlrev_b32 v128, 16, v100
    v_and_b32 v129, 0xffff0000, v100
    v_lshlrev_b32 v130, 16, v101
    v_and_b32 v131, 0xffff0000, v101
    v_lshlrev_b32 v132, 16, v102
    v_and_b32 v133, 0xffff0000, v102
    v_lshlrev_b32 v134, 16, v103
    v_and_b32 v135, 0xffff0000, v103
    s_setprio 2
    s_barrier
    s_barrier
    ds_read_b128 v[40:43], v232 offset:0
    ds_read_b64_tr_b16 v[48:49], v235 offset:0
    ds_read_b64_tr_b16 v[50:51], v235 offset:2048
    ds_read_b64_tr_b16 v[52:53], v236 offset:0
    ds_read_b64_tr_b16 v[54:55], v236 offset:2048
    ds_read_b64_tr_b16 v[56:57], v237 offset:0
    ds_read_b64_tr_b16 v[58:59], v237 offset:2048
    ds_read_b64_tr_b16 v[60:61], v238 offset:0
    ds_read_b64_tr_b16 v[62:63], v238 offset:2048
    ds_read_b128 v[44:47], v232 offset:2048
    s_add_u32 s52, s52, 24576
    s_cmp_ge_u32 s52, 147456
    s_cselect_b32 s52, 0, s52
    s_waitcnt lgkmcnt(0)
    v_mfma_f32_16x16x32_bf16 v[8:11], v[48:51], v[40:43], 0
    ds_read_b128 v[64:67], v232 offset:1024
    ds_read_b64_tr_b16 v[72:73], v235 offset:4096
    v_mfma_f32_16x16x32_bf16 v[12:15], v[52:55], v[40:43], 0
    ds_read_b64_tr_b16 v[74:75], v235 offset:6144
    ds_read_b64_tr_b16 v[76:77], v236 offset:4096
    v_mfma_f32_16x16x32_bf16 v[16:19], v[56:59], v[40:43], 0
    ds_read_b64_tr_b16 v[78:79], v236 offset:6144
    ds_read_b64_tr_b16 v[80:81], v237 offset:4096
    v_mfma_f32_16x16x32_bf16 v[20:23], v[60:63], v[40:43], 0
    ds_read_b64_tr_b16 v[82:83], v237 offset:6144
    ds_read_b64_tr_b16 v[84:85], v238 offset:4096
    v_mfma_f32_16x16x32_bf16 v[24:27], v[48:51], v[44:47], 0
    ds_read_b64_tr_b16 v[86:87], v238 offset:6144
    ds_read_b128 v[68:71], v232 offset:3072
    v_mfma_f32_16x16x32_bf16 v[28:31], v[52:55], v[44:47], 0
    v_add_u32 v232, s52, v233
    v_add_u32 v235, s52, v239
    v_mfma_f32_16x16x32_bf16 v[32:35], v[56:59], v[44:47], 0
    v_add_u32 v236, s52, v240
    v_add_u32 v237, s52, v241
    v_mfma_f32_16x16x32_bf16 v[36:39], v[60:63], v[44:47], 0
    v_add_u32 v238, s52, v242
    s_waitcnt lgkmcnt(0)
    v_mfma_f32_16x16x32_bf16 v[8:11], v[72:75], v[64:67], v[8:11]
    s_barrier
    v_mfma_f32_16x16x32_bf16 v[12:15], v[76:79], v[64:67], v[12:15]
    ds_read_b128 v[40:43], v232 offset:0
    ds_read_b64_tr_b16 v[48:49], v235 offset:0
    ds_read_b64_tr_b16 v[50:51], v235 offset:2048
    v_mfma_f32_16x16x32_bf16 v[16:19], v[80:83], v[64:67], v[16:19]
    ds_read_b64_tr_b16 v[52:53], v236 offset:0
    ds_read_b64_tr_b16 v[54:55], v236 offset:2048
    v_mfma_f32_16x16x32_bf16 v[20:23], v[84:87], v[64:67], v[20:23]
    ds_read_b64_tr_b16 v[56:57], v237 offset:0
    ds_read_b64_tr_b16 v[58:59], v237 offset:2048
    ds_read_b64_tr_b16 v[60:61], v238 offset:0
    v_mfma_f32_16x16x32_bf16 v[24:27], v[72:75], v[68:71], v[24:27]
    ds_read_b64_tr_b16 v[62:63], v238 offset:2048
    ds_read_b128 v[44:47], v232 offset:2048
    v_mfma_f32_16x16x32_bf16 v[28:31], v[76:79], v[68:71], v[28:31]
    v_mfma_f32_16x16x32_bf16 v[32:35], v[80:83], v[68:71], v[32:35]
    s_add_u32 s52, s52, 24576
    s_cmp_ge_u32 s52, 147456
    s_cselect_b32 s52, 0, s52
    v_mfma_f32_16x16x32_bf16 v[36:39], v[84:87], v[68:71], v[36:39]
    s_waitcnt lgkmcnt(0)
    v_mfma_f32_16x16x32_bf16 v[8:11], v[48:51], v[40:43], v[8:11]
    ds_read_b128 v[64:67], v232 offset:1024
    ds_read_b64_tr_b16 v[72:73], v235 offset:4096
    v_mfma_f32_16x16x32_bf16 v[12:15], v[52:55], v[40:43], v[12:15]
    ds_read_b64_tr_b16 v[74:75], v235 offset:6144
    ds_read_b64_tr_b16 v[76:77], v236 offset:4096
    v_mfma_f32_16x16x32_bf16 v[16:19], v[56:59], v[40:43], v[16:19]
    ds_read_b64_tr_b16 v[78:79], v236 offset:6144
    ds_read_b64_tr_b16 v[80:81], v237 offset:4096
    v_mfma_f32_16x16x32_bf16 v[20:23], v[60:63], v[40:43], v[20:23]
    ds_read_b64_tr_b16 v[82:83], v237 offset:6144
    ds_read_b64_tr_b16 v[84:85], v238 offset:4096
    v_mfma_f32_16x16x32_bf16 v[24:27], v[48:51], v[44:47], v[24:27]
    s_movk_i32 s54, 10
M_Q_loop1:
    ds_read_b64_tr_b16 v[86:87], v238 offset:6144
    ds_read_b128 v[68:71], v232 offset:3072
    v_mfma_f32_16x16x32_bf16 v[28:31], v[52:55], v[44:47], v[28:31]
    v_add_u32 v232, s52, v233
    v_add_u32 v235, s52, v239
    v_mfma_f32_16x16x32_bf16 v[32:35], v[56:59], v[44:47], v[32:35]
    v_add_u32 v236, s52, v240
    v_add_u32 v237, s52, v241
    v_mfma_f32_16x16x32_bf16 v[36:39], v[60:63], v[44:47], v[36:39]
    v_add_u32 v238, s52, v242
    s_waitcnt lgkmcnt(0)
    v_mfma_f32_16x16x32_bf16 v[8:11], v[72:75], v[64:67], v[8:11]
    s_barrier
    v_mfma_f32_16x16x32_bf16 v[12:15], v[76:79], v[64:67], v[12:15]
    ds_read_b128 v[40:43], v232 offset:0
    ds_read_b64_tr_b16 v[48:49], v235 offset:0
    ds_read_b64_tr_b16 v[50:51], v235 offset:2048
    v_mfma_f32_16x16x32_bf16 v[16:19], v[80:83], v[64:67], v[16:19]
    ds_read_b64_tr_b16 v[52:53], v236 offset:0
    ds_read_b64_tr_b16 v[54:55], v236 offset:2048
    v_mfma_f32_16x16x32_bf16 v[20:23], v[84:87], v[64:67], v[20:23]
    ds_read_b64_tr_b16 v[56:57], v237 offset:0
    ds_read_b64_tr_b16 v[58:59], v237 offset:2048
    ds_read_b64_tr_b16 v[60:61], v238 offset:0
    v_mfma_f32_16x16x32_bf16 v[24:27], v[72:75], v[68:71], v[24:27]
    ds_read_b64_tr_b16 v[62:63], v238 offset:2048
    ds_read_b128 v[44:47], v232 offset:2048
    v_mfma_f32_16x16x32_bf16 v[28:31], v[76:79], v[68:71], v[28:31]
    v_mfma_f32_16x16x32_bf16 v[32:35], v[80:83], v[68:71], v[32:35]
    s_add_u32 s52, s52, 24576
    s_cmp_ge_u32 s52, 147456
    s_cselect_b32 s52, 0, s52
    v_mfma_f32_16x16x32_bf16 v[36:39], v[84:87], v[68:71], v[36:39]
    s_waitcnt lgkmcnt(0)
    v_mfma_f32_16x16x32_bf16 v[8:11], v[48:51], v[40:43], v[8:11]
    ds_read_b128 v[64:67], v232 offset:1024
    ds_read_b64_tr_b16 v[72:73], v235 offset:4096
    v_mfma_f32_16x16x32_bf16 v[12:15], v[52:55], v[40:43], v[12:15]
    ds_read_b64_tr_b16 v[74:75], v235 offset:6144
    ds_read_b64_tr_b16 v[76:77], v236 offset:4096
    v_mfma_f32_16x16x32_bf16 v[16:19], v[56:59], v[40:43], v[16:19]
    ds_read_b64_tr_b16 v[78:79], v236 offset:6144
    ds_read_b64_tr_b16 v[80:81], v237 offset:4096
    v_mfma_f32_16x16x32_bf16 v[20:23], v[60:63], v[40:43], v[20:23]
    s_sub_u32 s54, s54, 1
    ds_read_b64_tr_b16 v[82:83], v237 offset:6144
    ds_read_b64_tr_b16 v[84:85], v238 offset:4096
    v_mfma_f32_16x16x32_bf16 v[24:27], v[48:51], v[44:47], v[24:27]
    s_cbranch_scc0 M_Q_loop1
    ds_read_b64_tr_b16 v[86:87], v238 offset:6144
    ds_read_b128 v[68:71], v232 offset:3072
    v_mfma_f32_16x16x32_bf16 v[28:31], v[52:55], v[44:47], v[28:31]
    v_add_u32 v232, s52, v233
    v_add_u32 v235, s52, v239
    v_mfma_f32_16x16x32_bf16 v[32:35], v[56:59], v[44:47], v[32:35]
    v_add_u32 v236, s52, v240
    v_add_u32 v237, s52, v241
    v_mfma_f32_16x16x32_bf16 v[36:39], v[60:63], v[44:47], v[36:39]
    v_add_u32 v238, s52, v242
    s_waitcnt lgkmcnt(0)
    v_mfma_f32_16x16x32_bf16 v[8:11], v[72:75], v[64:67], v[8:11]
    s_barrier
    v_mfma_f32_16x16x32_bf16 v[12:15], v[76:79], v[64:67], v[12:15]
    ds_read_b128 v[40:43], v232 offset:0
    ds_read_b64_tr_b16 v[48:49], v235 offset:0
    ds_read_b64_tr_b16 v[50:51], v235 offset:2048
    v_mfma_f32_16x16x32_bf16 v[16:19], v[80:83], v[64:67], v[16:19]
    ds_read_b64_tr_b16 v[52:53], v236 offset:0
    ds_read_b64_tr_b16 v[54:55], v236 offset:2048
    v_mfma_f32_16x16x32_bf16 v[20:23], v[84:87], v[64:67], v[20:23]
    ds_read_b64_tr_b16 v[56:57], v237 offset:0
    ds_read_b64_tr_b16 v[58:59], v237 offset:2048
    ds_read_b64_tr_b16 v[60:61], v238 offset:0
    v_mfma_f32_16x16x32_bf16 v[24:27], v[72:75], v[68:71], v[24:27]
    ds_read_b64_tr_b16 v[62:63], v238 offset:2048
    ds_read_b128 v[44:47], v232 offset:2048
    v_mfma_f32_16x16x32_bf16 v[28:31], v[76:79], v[68:71], v[28:31]
    v_mfma_f32_16x16x32_bf16 v[32:35], v[80:83], v[68:71], v[32:35]
    s_add_u32 s52, s52, 24576
    s_cmp_ge_u32 s52, 147456
    s_cselect_b32 s52, 0, s52
    v_mfma_f32_16x16x32_bf16 v[36:39], v[84:87], v[68:71], v[36:39]
    s_waitcnt lgkmcnt(0)
    v_mfma_f32_16x16x32_bf16 v[8:11], v[48:51], v[40:43], v[8:11]
    ds_read_b128 v[64:67], v232 offset:1024
    ds_read_b64_tr_b16 v[72:73], v235 offset:4096
    v_mfma_f32_16x16x32_bf16 v[12:15], v[52:55], v[40:43], v[12:15]
    ds_read_b64_tr_b16 v[74:75], v235 offset:6144
    ds_read_b64_tr_b16 v[76:77], v236 offset:4096
    ds_read_b128 v[136:139], v199 offset:0
    v_mfma_f32_16x16x32_bf16 v[16:19], v[56:59], v[40:43], v[16:19]
    ds_read_b64_tr_b16 v[78:79], v236 offset:6144
    ds_read_b64_tr_b16 v[80:81], v237 offset:4096
    ds_read_b128 v[140:143], v199 offset:64
    v_mfma_f32_16x16x32_bf16 v[20:23], v[60:63], v[40:43], v[20:23]
    ds_read_b64_tr_b16 v[82:83], v237 offset:6144
    ds_read_b64_tr_b16 v[84:85], v238 offset:4096
    v_mfma_f32_16x16x32_bf16 v[24:27], v[48:51], v[44:47], v[24:27]
    ds_read_b64_tr_b16 v[86:87], v238 offset:6144
    ds_read_b128 v[68:71], v232 offset:3072
    ds_read_b128 v[144:147], v199 offset:128
    v_mfma_f32_16x16x32_bf16 v[28:31], v[52:55], v[44:47], v[28:31]
    v_add_u32 v232, s52, v233
    v_add_u32 v235, s52, v239
    v_mfma_f32_16x16x32_bf16 v[32:35], v[56:59], v[44:47], v[32:35]
    v_add_u32 v236, s52, v240
    v_add_u32 v237, s52, v241
    ds_read_b128 v[148:151], v199 offset:192
    v_mfma_f32_16x16x32_bf16 v[36:39], v[60:63], v[44:47], v[36:39]
    v_add_u32 v238, s52, v242
    s_waitcnt lgkmcnt(0)
    v_mfma_f32_16x16x32_bf16 v[8:11], v[72:75], v[64:67], v[8:11]
    s_barrier
    v_mfma_f32_16x16x32_bf16 v[12:15], v[76:79], v[64:67], v[12:15]
    ds_read_b128 v[40:43], v232 offset:0
    ds_read_b64_tr_b16 v[48:49], v235 offset:0
    ds_read_b64_tr_b16 v[50:51], v235 offset:2048
    ds_read_b128 v[152:155], v199 offset:256
    v_mfma_f32_16x16x32_bf16 v[16:19], v[80:83], v[64:67], v[16:19]
    ds_read_b64_tr_b16 v[52:53], v236 offset:0
    ds_read_b64_tr_b16 v[54:55], v236 offset:2048
    ds_read_b128 v[156:159], v199 offset:320
    v_mfma_f32_16x16x32_bf16 v[20:23], v[84:87], v[64:67], v[20:23]
    ds_read_b64_tr_b16 v[56:57], v237 offset:0
    ds_read_b64_tr_b16 v[58:59], v237 offset:2048
    ds_read_b64_tr_b16 v[60:61], v238 offset:0
    v_mfma_f32_16x16x32_bf16 v[24:27], v[72:75], v[68:71], v[24:27]
    ds_read_b64_tr_b16 v[62:63], v238 offset:2048
    ds_read_b128 v[44:47], v232 offset:2048
    ds_read_b128 v[160:163], v199 offset:384
    v_mfma_f32_16x16x32_bf16 v[28:31], v[76:79], v[68:71], v[28:31]
    v_mfma_f32_16x16x32_bf16 v[32:35], v[80:83], v[68:71], v[32:35]
    s_add_u32 s52, s52, 24576
    s_cmp_ge_u32 s52, 147456
    s_cselect_b32 s52, 0, s52
    ds_read_b128 v[164:167], v199 offset:448
    v_mfma_f32_16x16x32_bf16 v[36:39], v[84:87], v[68:71], v[36:39]
    s_waitcnt lgkmcnt(0)
    v_mfma_f32_16x16x32_bf16 v[8:11], v[48:51], v[40:43], v[8:11]
    ds_read_b128 v[64:67], v232 offset:1024
    ds_read_b64_tr_b16 v[72:73], v235 offset:4096
    v_mfma_f32_16x16x32_bf16 v[12:15], v[52:55], v[40:43], v[12:15]
    ds_read_b64_tr_b16 v[74:75], v235 offset:6144
    ds_read_b64_tr_b16 v[76:77], v236 offset:4096
    ds_read_b128 v[168:171], v199 offset:512
    v_mfma_f32_16x16x32_bf16 v[16:19], v[56:59], v[40:43], v[16:19]
    ds_read_b64_tr_b16 v[78:79], v236 offset:6144
    ds_read_b64_tr_b16 v[80:81], v237 offset:4096
    ds_read_b128 v[172:175], v199 offset:576
    v_mfma_f32_16x16x32_bf16 v[20:23], v[60:63], v[40:43], v[20:23]
    ds_read_b64_tr_b16 v[82:83], v237 offset:6144
    ds_read_b64_tr_b16 v[84:85], v238 offset:4096
    v_mfma_f32_16x16x32_bf16 v[24:27], v[48:51], v[44:47], v[24:27]
    ds_read_b64_tr_b16 v[86:87], v238 offset:6144
    ds_read_b128 v[68:71], v232 offset:3072
    ds_read_b128 v[176:179], v199 offset:640
    v_mfma_f32_16x16x32_bf16 v[28:31], v[52:55], v[44:47], v[28:31]
    v_add_u32 v232, s52, v233
    v_add_u32 v235, s52, v239
    v_mfma_f32_16x16x32_bf16 v[32:35], v[56:59], v[44:47], v[32:35]
    v_add_u32 v236, s52, v240
    v_add_u32 v237, s52, v241
    ds_read_b128 v[180:183], v199 offset:704
    v_mfma_f32_16x16x32_bf16 v[36:39], v[60:63], v[44:47], v[36:39]
    v_add_u32 v238, s52, v242
    s_waitcnt lgkmcnt(0)
    v_mfma_f32_16x16x32_bf16 v[8:11], v[72:75], v[64:67], v[8:11]
    s_barrier
    v_mfma_f32_16x16x32_bf16 v[12:15], v[76:79], v[64:67], v[12:15]
    ds_read_b128 v[40:43], v232 offset:0
    ds_read_b64_tr_b16 v[48:49], v235 offset:0
    ds_read_b64_tr_b16 v[50:51], v235 offset:2048
    v_mfma_f32_16x16x32_bf16 v[16:19], v[80:83], v[64:67], v[16:19]
    ds_read_b64_tr_b16 v[52:53], v236 offset:0
    ds_read_b64_tr_b16 v[54:55], v236 offset:2048
    v_mfma_f32_16x16x32_bf16 v[20:23], v[84:87], v[64:67], v[20:23]
    ds_read_b64_tr_b16 v[56:57], v237 offset:0
    ds_read_b64_tr_b16 v[58:59], v237 offset:2048
    ds_read_b64_tr_b16 v[60:61], v238 offset:0
    v_mfma_f32_16x16x32_bf16 v[24:27], v[72:75], v[68:71], v[24:27]
    ds_read_b64_tr_b16 v[62:63], v238 offset:2048
    ds_read_b128 v[44:47], v232 offset:2048
    v_mfma_f32_16x16x32_bf16 v[28:31], v[76:79], v[68:71], v[28:31]
    v_mfma_f32_16x16x32_bf16 v[32:35], v[80:83], v[68:71], v[32:35]
    s_add_u32 s52, s52, 24576
    s_cmp_ge_u32 s52, 147456
    s_cselect_b32 s52, 0, s52
    v_mfma_f32_16x16x32_bf16 v[36:39], v[84:87], v[68:71], v[36:39]
    s_waitcnt lgkmcnt(0)
    v_mfma_f32_16x16x32_bf16 v[8:11], v[48:51], v[40:43], v[8:11]
    ds_read_b128 v[64:67], v232 offset:1024
    ds_read_b64_tr_b16 v[72:73], v235 offset:4096
    v_mfma_f32_16x16x32_bf16 v[12:15], v[52:55], v[40:43], v[12:15]
    ds_read_b64_tr_b16 v[74:75], v235 offset:6144
    ds_read_b64_tr_b16 v[76:77], v236 offset:4096
    v_mfma_f32_16x16x32_bf16 v[16:19], v[56:59], v[40:43], v[16:19]
    ds_read_b64_tr_b16 v[78:79], v236 offset:6144
    ds_read_b64_tr_b16 v[80:81], v237 offset:4096
    v_mfma_f32_16x16x32_bf16 v[20:23], v[60:63], v[40:43], v[20:23]
    ds_read_b64_tr_b16 v[82:83], v237 offset:6144
    ds_read_b64_tr_b16 v[84:85], v238 offset:4096
    v_mfma_f32_16x16x32_bf16 v[24:27], v[48:51], v[44:47], v[24:27]
    ds_read_b64_tr_b16 v[86:87], v238 offset:6144
    ds_read_b128 v[68:71], v232 offset:3072
    v_mfma_f32_16x16x32_bf16 v[28:31], v[52:55], v[44:47], v[28:31]
    v_mfma_f32_16x16x32_bf16 v[32:35], v[56:59], v[44:47], v[32:35]
    v_mfma_f32_16x16x32_bf16 v[36:39], v[60:63], v[44:47], v[36:39]
    s_waitcnt lgkmcnt(0)
    v_mfma_f32_16x16x32_bf16 v[8:11], v[72:75], v[64:67], v[8:11]
    s_barrier
    v_mfma_f32_16x16x32_bf16 v[12:15], v[76:79], v[64:67], v[12:15]
    v_mfma_f32_16x16x32_bf16 v[16:19], v[80:83], v[64:67], v[16:19]
    v_mfma_f32_16x16x32_bf16 v[20:23], v[84:87], v[64:67], v[20:23]
    v_mfma_f32_16x16x32_bf16 v[24:27], v[72:75], v[68:71], v[24:27]
    v_mfma_f32_16x16x32_bf16 v[28:31], v[76:79], v[68:71], v[28:31]
    v_mfma_f32_16x16x32_bf16 v[32:35], v[80:83], v[68:71], v[32:35]
    v_mfma_f32_16x16x32_bf16 v[36:39], v[84:87], v[68:71], v[36:39]
    v_pk_fma_f32 v[104:105], v[8:9], v[136:137], v[104:105]
    v_pk_fma_f32 v[106:107], v[10:11], v[138:139], v[106:107]
    v_pk_fma_f32 v[108:109], v[12:13], v[140:141], v[108:109]
    v_pk_fma_f32 v[110:111], v[14:15], v[142:143], v[110:111]
    v_pk_fma_f32 v[112:113], v[16:17], v[144:145], v[112:113]
    v_pk_fma_f32 v[114:115], v[18:19], v[146:147], v[114:115]
    v_pk_fma_f32 v[116:117], v[20:21], v[148:149], v[116:117]
    v_pk_fma_f32 v[118:119], v[22:23], v[150:151], v[118:119]
    v_pk_fma_f32 v[120:121], v[24:25], v[136:137], v[120:121]
    v_pk_fma_f32 v[122:123], v[26:27], v[138:139], v[122:123]
    v_pk_fma_f32 v[124:125], v[28:29], v[140:141], v[124:125]
    v_pk_fma_f32 v[126:127], v[30:31], v[142:143], v[126:127]
    v_pk_fma_f32 v[128:129], v[32:33], v[144:145], v[128:129]
    v_pk_fma_f32 v[130:131], v[34:35], v[146:147], v[130:131]
    v_pk_fma_f32 v[132:133], v[36:37], v[148:149], v[132:133]
    v_pk_fma_f32 v[134:135], v[38:39], v[150:151], v[134:135]
    v_cvt_pk_bf16_f32 v88, v104, v105
    v_cvt_pk_bf16_f32 v89, v106, v107
    v_cvt_pk_bf16_f32 v90, v108, v109
    v_cvt_pk_bf16_f32 v91, v110, v111
    v_cvt_pk_bf16_f32 v92, v112, v113
    v_cvt_pk_bf16_f32 v93, v114, v115
    v_cvt_pk_bf16_f32 v94, v116, v117
    v_cvt_pk_bf16_f32 v95, v118, v119
    v_cvt_pk_bf16_f32 v96, v120, v121
    v_cvt_pk_bf16_f32 v97, v122, v123
    v_cvt_pk_bf16_f32 v98, v124, v125
    v_cvt_pk_bf16_f32 v99, v126, v127
    v_cvt_pk_bf16_f32 v100, v128, v129
    v_cvt_pk_bf16_f32 v101, v130, v131
    v_cvt_pk_bf16_f32 v102, v132, v133
    v_cvt_pk_bf16_f32 v103, v134, v135
    v_lshlrev_b32 v104, 16, v88
    v_and_b32 v105, 0xffff0000, v88
    v_lshlrev_b32 v106, 16, v89
    v_and_b32 v107, 0xffff0000, v89
    v_lshlrev_b32 v108, 16, v90
    v_and_b32 v109, 0xffff0000, v90
    v_lshlrev_b32 v110, 16, v91
    v_and_b32 v111, 0xffff0000, v91
    v_lshlrev_b32 v112, 16, v92
    v_and_b32 v113, 0xffff0000, v92
    v_lshlrev_b32 v114, 16, v93
    v_and_b32 v115, 0xffff0000, v93
    v_lshlrev_b32 v116, 16, v94
    v_and_b32 v117, 0xffff0000, v94
    v_lshlrev_b32 v118, 16, v95
    v_and_b32 v119, 0xffff0000, v95
    v_lshlrev_b32 v120, 16, v96
    v_and_b32 v121, 0xffff0000, v96
    v_lshlrev_b32 v122, 16, v97
    v_and_b32 v123, 0xffff0000, v97
    v_lshlrev_b32 v124, 16, v98
    v_and_b32 v125, 0xffff0000, v98
    v_lshlrev_b32 v126, 16, v99
    v_and_b32 v127, 0xffff0000, v99
    v_lshlrev_b32 v128, 16, v100
    v_and_b32 v129, 0xffff0000, v100
    v_lshlrev_b32 v130, 16, v101
    v_and_b32 v131, 0xffff0000, v101
    v_lshlrev_b32 v132, 16, v102
    v_and_b32 v133, 0xffff0000, v102
    v_lshlrev_b32 v134, 16, v103
    v_and_b32 v135, 0xffff0000, v103
    v_pk_add_f32 v[40:41], v[104:105], v[106:107]
    v_pk_mul_f32 v[44:45], v[104:105], v[104:105]
    v_pk_add_f32 v[42:43], v[120:121], v[122:123]
    v_pk_mul_f32 v[46:47], v[120:121], v[120:121]
    v_pk_fma_f32 v[44:45], v[106:107], v[106:107], v[44:45]
    v_pk_fma_f32 v[46:47], v[122:123], v[122:123], v[46:47]
    v_pk_add_f32 v[40:41], v[40:41], v[108:109]
    v_pk_fma_f32 v[44:45], v[108:109], v[108:109], v[44:45]
    v_pk_add_f32 v[42:43], v[42:43], v[124:125]
    v_pk_fma_f32 v[46:47], v[124:125], v[124:125], v[46:47]
    v_pk_add_f32 v[40:41], v[40:41], v[110:111]
    v_pk_fma_f32 v[44:45], v[110:111], v[110:111], v[44:45]
    v_pk_add_f32 v[42:43], v[42:43], v[126:127]
    v_pk_fma_f32 v[46:47], v[126:127], v[126:127], v[46:47]
    v_pk_add_f32 v[40:41], v[40:41], v[112:113]
    v_pk_fma_f32 v[44:45], v[112:113], v[112:113], v[44:45]
    v_pk_add_f32 v[42:43], v[42:43], v[128:129]
    v_pk_fma_f32 v[46:47], v[128:129], v[128:129], v[46:47]
    v_pk_add_f32 v[40:41], v[40:41], v[114:115]
    v_pk_fma_f32 v[44:45], v[114:115], v[114:115], v[44:45]
    v_pk_add_f32 v[42:43], v[42:43], v[130:131]
    v_pk_fma_f32 v[46:47], v[130:131], v[130:131], v[46:47]
    v_pk_add_f32 v[40:41], v[40:41], v[116:117]
    v_pk_fma_f32 v[44:45], v[116:117], v[116:117], v[44:45]
    v_pk_add_f32 v[42:43], v[42:43], v[132:133]
    v_pk_fma_f32 v[46:47], v[132:133], v[132:133], v[46:47]
    v_pk_add_f32 v[40:41], v[40:41], v[118:119]
    v_pk_fma_f32 v[44:45], v[118:119], v[118:119], v[44:45]
    v_pk_add_f32 v[42:43], v[42:43], v[134:135]
    v_pk_fma_f32 v[46:47], v[134:135], v[134:135], v[46:47]
    v_add_f32 v40, v40, v41
    v_add_f32 v42, v42, v43
    v_add_f32 v44, v44, v45
    v_add_f32 v46, v46, v47
    v_permlane16_swap_b32 v40, v42
    s_nop 0
    v_permlane16_swap_b32 v44, v46
    v_add_f32 v48, v40, v42
    v_add_f32 v49, v44, v46
    v_mov_b32 v50, v48
    v_mov_b32 v51, v49
    s_nop 0
    v_permlane32_swap_b32 v48, v50
    v_permlane32_swap_b32 v49, v51
    v_add_f32 v48, v48, v50
    v_add_f32 v49, v49, v51
    s_mov_b32 exec_hi, 0
    buffer_store_dwordx2 v[48:49], v198, s[28:31], s76 offen sc1
    s_mov_b32 exec_hi, -1
    buffer_load_dwordx2 v[56:57], v198, s[28:31], 0 offen offset:0 sc1
    buffer_load_dwordx2 v[58:59], v198, s[28:31], 0 offen offset:512 sc1
    buffer_load_dwordx2 v[60:61], v198, s[28:31], 0 offen offset:1024 sc1
    buffer_load_dwordx2 v[62:63], v198, s[28:31], 0 offen offset:1536 sc1
    buffer_load_dwordx2 v[64:65], v198, s[28:31], 0 offen offset:2048 sc1
    buffer_load_dwordx2 v[66:67], v198, s[28:31], 0 offen offset:2560 sc1
    buffer_load_dwordx2 v[68:69], v198, s[28:31], 0 offen offset:3072 sc1
    buffer_load_dwordx2 v[70:71], v198, s[28:31], 0 offen offset:3584 sc1
    s_waitcnt vmcnt(0)
    s_mov_b32 s3, 0x4000
M_sp_chk:
    v_cmp_eq_u32 s[80:81], -1, v57
    v_cmp_eq_u32 s[82:83], -1, v59
    v_cmp_eq_u32 s[84:85], -1, v61
    v_cmp_eq_u32 s[86:87], -1, v63
    v_cmp_eq_u32 s[88:89], -1, v65
    v_cmp_eq_u32 s[90:91], -1, v67
    v_cmp_eq_u32 s[92:93], -1, v69
    v_cmp_eq_u32 s[94:95], -1, v71
    v_max3_u32 v52, v57, v59, v61
    v_max3_u32 v53, v63, v65, v67
    v_max3_u32 v52, v52, v69, v71
    v_max_u32 v52, v52, v53
    v_cmp_eq_u32 vcc, -1, v52
    s_nop 4
    s_cbranch_vccz M_sp_ok
    s_sub_u32 s3, s3, 1
    s_cbranch_scc1 M_sp_ok
    s_mov_b64 exec, s[80:81]
    buffer_load_dwordx2 v[56:57], v198, s[28:31], 0 offen offset:0 sc1
    s_mov_b64 exec, s[82:83]
    buffer_load_dwordx2 v[58:59], v198, s[28:31], 0 offen offset:512 sc1
    s_mov_b64 exec, s[84:85]
    buffer_load_dwordx2 v[60:61], v198, s[28:31], 0 offen offset:1024 sc1
    s_mov_b64 exec, s[86:87]
    buffer_load_dwordx2 v[62:63], v198, s[28:31], 0 offen offset:1536 sc1
    s_mov_b64 exec, s[88:89]
    buffer_load_dwordx2 v[64:65], v198, s[28:31], 0 offen offset:2048 sc1
    s_mov_b64 exec, s[90:91]
    buffer_load_dwordx2 v[66:67], v198, s[28:31], 0 offen offset:2560 sc1
    s_mov_b64 exec, s[92:93]
    buffer_load_dwordx2 v[68:69], v198, s[28:31], 0 offen offset:3072 sc1
    s_mov_b64 exec, s[94:95]
    buffer_load_dwordx2 v[70:71], v198, s[28:31], 0 offen offset:3584 sc1
    s_mov_b64 exec, -1
    s_waitcnt vmcnt(0)
    s_branch M_sp_chk
M_sp_ok:
    buffer_store_dwordx4 v[88:91], v197, s[28:31], s72 offen offset:0 sc1
    buffer_store_dwordx4 v[92:95], v197, s[28:31], s72 offen offset:1024 sc1
    buffer_store_dwordx4 v[96:99], v197, s[28:31], s73 offen offset:0 sc1
    buffer_store_dwordx4 v[100:103], v197, s[28:31], s73 offen offset:1024 sc1
    v_pk_add_f32 v[56:57], v[56:57], v[58:59]
    v_pk_add_f32 v[60:61], v[60:61], v[62:63]
    v_pk_add_f32 v[64:65], v[64:65], v[66:67]
    v_pk_add_f32 v[68:69], v[68:69], v[70:71]
    v_pk_add_f32 v[56:57], v[56:57], v[60:61]
    v_pk_add_f32 v[64:65], v[64:65], v[68:69]
    v_pk_add_f32 v[56:57], v[56:57], v[64:65]
    v_mov_b32 v50, v56
    v_mov_b32 v51, v57
    s_nop 0
    v_permlane32_swap_b32 v56, v50
    v_permlane32_swap_b32 v57, v51
    v_add_f32 v56, v56, v50
    v_add_f32 v57, v57, v51
    v_mul_f32 v56, 0x3a800000, v56
    v_mul_f32 v57, 0x3a800000, v57
    v_fma_f32 v57, -v56, v56, v57
    v_max_f32 v57, 0, v57
    v_cvt_pk_bf16_f32 v50, v56, v57
    v_lshlrev_b32 v56, 16, v50
    v_and_b32 v57, 0xffff0000, v50
    v_add_f32 v57, 0x3727c5ac, v57
    v_cvt_pk_bf16_f32 v50, v57, v57
    v_lshlrev_b32 v57, 16, v50
    v_sqrt_f32 v57, v57
    s_nop 0
    v_cvt_pk_bf16_f32 v50, v57, v57
    v_lshlrev_b32 v57, 16, v50
    v_rcp_f32 v40, v57
    s_nop 0
    v_mul_f32 v44, -v56, v40
    v_mov_b32 v42, v40
    v_mov_b32 v46, v44
    s_nop 0
    v_permlane16_swap_b32 v40, v42
    v_permlane16_swap_b32 v44, v46
    v_pk_fma_f32 v[104:105], v[104:105], v[40:41], v[44:45] op_sel_hi:[1,0,0]
    v_pk_fma_f32 v[106:107], v[106:107], v[40:41], v[44:45] op_sel_hi:[1,0,0]
    v_pk_fma_f32 v[108:109], v[108:109], v[40:41], v[44:45] op_sel_hi:[1,0,0]
    v_pk_fma_f32 v[110:111], v[110:111], v[40:41], v[44:45] op_sel_hi:[1,0,0]
    v_pk_fma_f32 v[112:113], v[112:113], v[40:41], v[44:45] op_sel_hi:[1,0,0]
    v_pk_fma_f32 v[114:115], v[114:115], v[40:41], v[44:45] op_sel_hi:[1,0,0]
    v_pk_fma_f32 v[116:117], v[116:117], v[40:41], v[44:45] op_sel_hi:[1,0,0]
    v_pk_fma_f32 v[118:119], v[118:119], v[40:41], v[44:45] op_sel_hi:[1,0,0]
    v_pk_fma_f32 v[104:105], v[104:105], v[168:169], v[152:153]
    v_pk_fma_f32 v[106:107], v[106:107], v[170:171], v[154:155]
    v_pk_fma_f32 v[108:109], v[108:109], v[172:173], v[156:157]
    v_pk_fma_f32 v[110:111], v[110:111], v[174:175], v[158:159]
    v_pk_fma_f32 v[112:113], v[112:113], v[176:177], v[160:161]
    v_pk_fma_f32 v[114:115], v[114:115], v[178:179], v[162:163]
    v_pk_fma_f32 v[116:117], v[116:117], v[180:181], v[164:165]
    v_pk_fma_f32 v[118:119], v[118:119], v[182:183], v[166:167]
    v_cvt_pk_bf16_f32 v72, v104, v105
    v_cvt_pk_bf16_f32 v73, v106, v107
    v_cvt_pk_bf16_f32 v74, v108, v109
    v_cvt_pk_bf16_f32 v75, v110, v111
    buffer_store_dwordx4 v[72:75], v197, s[28:31], s74 offen offset:0 sc1
    ds_write_b128 v233, v[72:75] offset:0
    v_cvt_pk_bf16_f32 v76, v112, v113
    v_cvt_pk_bf16_f32 v77, v114, v115
    v_cvt_pk_bf16_f32 v78, v116, v117
    v_cvt_pk_bf16_f32 v79, v118, v119
    buffer_store_dwordx4 v[76:79], v197, s[28:31], s74 offen offset:1024 sc1
    ds_write_b128 v233, v[76:79] offset:1024
    v_pk_fma_f32 v[120:121], v[120:121], v[42:43], v[46:47] op_sel_hi:[1,0,0]
    v_pk_fma_f32 v[122:123], v[122:123], v[42:43], v[46:47] op_sel_hi:[1,0,0]
    v_pk_fma_f32 v[124:125], v[124:125], v[42:43], v[46:47] op_sel_hi:[1,0,0]
    v_pk_fma_f32 v[126:127], v[126:127], v[42:43], v[46:47] op_sel_hi:[1,0,0]
    v_pk_fma_f32 v[128:129], v[128:129], v[42:43], v[46:47] op_sel_hi:[1,0,0]
    v_pk_fma_f32 v[130:131], v[130:131], v[42:43], v[46:47] op_sel_hi:[1,0,0]
    v_pk_fma_f32 v[132:133], v[132:133], v[42:43], v[46:47] op_sel_hi:[1,0,0]
    v_pk_fma_f32 v[134:135], v[134:135], v[42:43], v[46:47] op_sel_hi:[1,0,0]
    v_pk_fma_f32 v[120:121], v[120:121], v[168:169], v[152:153]
    v_pk_fma_f32 v[122:123], v[122:123], v[170:171], v[154:155]
    v_pk_fma_f32 v[124:125], v[124:125], v[172:173], v[156:157]
    v_pk_fma_f32 v[126:127], v[126:127], v[174:175], v[158:159]
    v_pk_fma_f32 v[128:129], v[128:129], v[176:177], v[160:161]
    v_pk_fma_f32 v[130:131], v[130:131], v[178:179], v[162:163]
    v_pk_fma_f32 v[132:133], v[132:133], v[180:181], v[164:165]
    v_pk_fma_f32 v[134:135], v[134:135], v[182:183], v[166:167]
    v_cvt_pk_bf16_f32 v80, v120, v121
    v_cvt_pk_bf16_f32 v81, v122, v123
    v_cvt_pk_bf16_f32 v82, v124, v125
    v_cvt_pk_bf16_f32 v83, v126, v127
    buffer_store_dwordx4 v[80:83], v197, s[28:31], s75 offen offset:0 sc1
    ds_write_b128 v233, v[80:83] offset:2048
    v_cvt_pk_bf16_f32 v84, v128, v129
    v_cvt_pk_bf16_f32 v85, v130, v131
    v_cvt_pk_bf16_f32 v86, v132, v133
    v_cvt_pk_bf16_f32 v87, v134, v135
    buffer_store_dwordx4 v[84:87], v197, s[28:31], s75 offen offset:1024 sc1
    ds_write_b128 v233, v[84:87] offset:3072
    s_waitcnt lgkmcnt(0)
    s_barrier
    s_and_b32 s57, s58, 15
    s_lshr_b64 s[58:59], s[58:59], 4
    s_lshl_b32 s56, s57, 11
    s_mul_i32 s57, s57, 0x70000
    s_add_u32 s53, s53, 49152
    s_cmp_ge_u32 s53, s61
    s_cselect_b32 s53, s60, s53
    s_and_b32 s57, s58, 15
    s_lshr_b64 s[58:59], s[58:59], 4
    s_lshl_b32 s56, s57, 11
    s_mul_i32 s57, s57, 0x70000
    s_add_u32 m0, s53, 16384
    s_nop 0
    buffer_load_dwordx4 v208, s[32:35], s57 offen offset:0 lds
    buffer_load_dwordx4 v209, s[32:35], s57 offen offset:1024 lds
    buffer_load_dwordx4 v210, s[32:35], s57 offen offset:2048 lds
    buffer_load_dwordx4 v211, s[32:35], s57 offen offset:3072 lds
    s_add_u32 m0, s53, 32768
    s_nop 0
    buffer_load_dwordx4 v208, s[36:39], s57 offen offset:0 lds
    buffer_load_dwordx4 v209, s[36:39], s57 offen offset:1024 lds
    buffer_load_dwordx4 v210, s[36:39], s57 offen offset:2048 lds
    buffer_load_dwordx4 v211, s[36:39], s57 offen offset:3072 lds
    s_add_u32 s53, s53, 49152
    s_cmp_ge_u32 s53, s61
    s_cselect_b32 s53, s60, s53
    s_lshl_b32 s60, s44, 12
    s_add_u32 s61, s60, 147456
    s_add_u32 s53, s60, 0
    s_bfe_u32 s66, s2, 0x30003
    s_lshr_b32 s55, s2, 6
    s_add_u32 s66, s66, s55
    s_and_b32 s66, s66, 3
    s_mov_b32 s58, 0x76453210
    s_mov_b32 s59, 0xfecdba89
    s_cmp_eq_u32 s66, 1
    s_cselect_b32 s58, 0x75643120, s58
    s_cselect_b32 s59, 0xfdecb9a8, s59
    s_cmp_eq_u32 s66, 2
    s_cselect_b32 s58, 0x67542310, s58
    s_cselect_b32 s59, 0xefdcab98, s59
    s_cmp_eq_u32 s66, 3
    s_cselect_b32 s58, 0x86534210, s58
    s_cselect_b32 s59, 0xfedbca97, s59
    s_lshl_b32 s55, s48, 2
    s_lshr_b64 s[56:57], s[58:59], s55
    s_and_b32 s55, s56, 15
    s_lshl_b32 s55, s55, 2
    s_lshl_b64 s[56:57], 15, s55
    s_andn2_b64 s[58:59], s[58:59], s[56:57]
    s_or_b32 s58, s58, s48
    s_mov_b32 s32, s12
    s_mov_b32 s33, s13
    s_mov_b32 s34, 0x700000
    s_mov_b32 s35, 0x20000
    s_mov_b32 s36, s14
    s_mov_b32 s37, s15
    s_mov_b32 s38, 0x700000
    s_mov_b32 s39, 0x20000
    s_lshl_b32 s68, s47, 9
    s_add_u32 s68, s68, 0x56000
    s_add_u32 s62, s26, s68
    s_addc_u32 s63, s27, 0
    s_lshr_b32 s68, s48, 2
    s_lshl_b32 s68, s68, 7
    v_mov_b32 v2, 1
    v_mov_b32 v5, 148488
    s_waitcnt vmcnt(8)
    s_mov_b64 exec, 1
    ds_add_rtn_u32 v245, v5, v2
    s_mov_b64 exec, -1
    s_mov_b32 s1, 1
    s_mov_b32 s3, 0x4000
    s_waitcnt lgkmcnt(0)
    v_readfirstlane_b32 s64, v245
    s_nop 3
    s_cmp_lg_u32 s64, 3
    s_cbranch_scc1 M_ph_ok
    s_atomic_add s1, s[62:63], 0
    s_atomic_add s1, s[62:63], 128
    s_atomic_add s1, s[62:63], 256
    s_atomic_add s1, s[62:63], 384
M_ph_chk:
    s_load_dword s64, s[62:63], s68 glc
    s_sub_u32 s3, s3, 1
    s_cselect_b32 s65, 0, 16
    s_waitcnt lgkmcnt(0)
    s_cmp_lt_u32 s64, s65
    s_cbranch_scc1 M_ph_chk
M_ph_ok:
    s_barrier
    s_setprio 0
    s_and_b32 s57, s58, 15
    s_lshr_b64 s[58:59], s[58:59], 4
    s_lshl_b32 s56, s57, 11
    s_mul_i32 s57, s57, 0x70000
    s_add_u32 s53, s53, 49152
    s_cmp_ge_u32 s53, s61
    s_cselect_b32 s53, s60, s53
    s_and_b32 s57, s58, 15
    s_lshr_b64 s[58:59], s[58:59], 4
    s_lshl_b32 s56, s57, 11
    s_mul_i32 s57, s57, 0x70000
    s_mov_b32 m0, s53
    s_nop 0
    buffer_load_dwordx4 v206, s[28:31], s56 offen offset:0 lds
    buffer_load_dwordx4 v206, s[28:31], s56 offen offset:1024 lds
    buffer_load_dwordx4 v207, s[28:31], s56 offen offset:2048 lds
    buffer_load_dwordx4 v207, s[28:31], s56 offen offset:3072 lds
    s_add_u32 s53, s53, 49152
    s_cmp_ge_u32 s53, s61
    s_cselect_b32 s53, s60, s53
    s_and_b32 s57, s58, 15
    s_lshr_b64 s[58:59], s[58:59], 4
    s_lshl_b32 s56, s57, 11
    s_mul_i32 s57, s57, 0x70000
    s_add_u32 m0, s53, 16384
    s_nop 0
    buffer_load_dwordx4 v208, s[32:35], s57 offen offset:0 lds
    buffer_load_dwordx4 v209, s[32:35], s57 offen offset:1024 lds
    buffer_load_dwordx4 v210, s[32:35], s57 offen offset:2048 lds
    buffer_load_dwordx4 v211, s[32:35], s57 offen offset:3072 lds
    s_add_u32 m0, s53, 32768
    s_nop 0
    buffer_load_dwordx4 v208, s[36:39], s57 offen offset:0 lds
    buffer_load_dwordx4 v209, s[36:39], s57 offen offset:1024 lds
    buffer_load_dwordx4 v210, s[36:39], s57 offen offset:2048 lds
    buffer_load_dwordx4 v211, s[36:39], s57 offen offset:3072 lds
    s_mov_b32 m0, s53
    s_nop 0
    buffer_load_dwordx4 v206, s[28:31], s56 offen offset:0 lds
    buffer_load_dwordx4 v206, s[28:31], s56 offen offset:1024 lds
    buffer_load_dwordx4 v207, s[28:31], s56 offen offset:2048 lds
    buffer_load_dwordx4 v207, s[28:31], s56 offen offset:3072 lds
    s_add_u32 s53, s53, 49152
    s_cmp_ge_u32 s53, s61
    s_cselect_b32 s53, s60, s53
    s_lshl_b32 s64, s45, 13
    v_lshl_add_u32 v233, v1, 4, s64
    v_lshrrev_b32 v2, 2, v1
    v_lshlrev_b32 v4, 8, v2
    v_and_b32 v5, 3, v1
    v_lshl_add_u32 v4, v5, 3, v4
    v_add_u32 v4, 16384, v4
    v_and_b32 v2, 7, v2
    s_lshl_b32 s64, s46, 2
    v_xor_b32 v2, s64, v2
    v_xor_b32 v3, 0, v2
    v_lshl_add_u32 v239, v3, 5, v4
    v_xor_b32 v3, 1, v2
    v_lshl_add_u32 v240, v3, 5, v4
    v_xor_b32 v3, 2, v2
    v_lshl_add_u32 v241, v3, 5, v4
    v_xor_b32 v3, 3, v2
    v_lshl_add_u32 v242, v3, 5, v4
    s_mov_b32 s52, 49152
    v_add_u32 v232, s52, v233
    v_add_u32 v235, s52, v239
    v_add_u32 v236, s52, v240
    v_add_u32 v237, s52, v241
    v_add_u32 v238, s52, v242
    s_lshl_b32 s64, s2, 2
    s_add_u32 s64, s64, s44
    s_mul_i32 s64, s64, 7168
    s_add_u32 s64, s64, 5248
    s_add_u32 s10, s12, s64
    s_addc_u32 s11, s13, 0
    s_add_u32 s24, s14, s64
    s_addc_u32 s25, s15, 0
    s_movk_i32 s54, 9
M_Q_loop2:
    s_waitcnt vmcnt(12)
    s_barrier
    s_and_b32 s57, s58, 15
    s_lshr_b64 s[58:59], s[58:59], 4
    s_lshl_b32 s56, s57, 11
    s_mul_i32 s57, s57, 0x70000
    s_add_u32 m0, s53, 16384
    s_nop 0
    buffer_load_dwordx4 v208, s[32:35], s57 offen offset:0 lds
    s_load_dword s99, s[10:11], 0
    buffer_load_dwordx4 v209, s[32:35], s57 offen offset:1024 lds
    buffer_load_dwordx4 v210, s[32:35], s57 offen offset:2048 lds
    s_load_dword s99, s[24:25], 0
    buffer_load_dwordx4 v211, s[32:35], s57 offen offset:3072 lds
    s_add_u32 m0, s53, 32768
    s_nop 0
    buffer_load_dwordx4 v208, s[36:39], s57 offen offset:0 lds
    s_load_dword s99, s[10:11], 64
    buffer_load_dwordx4 v209, s[36:39], s57 offen offset:1024 lds
    buffer_load_dwordx4 v210, s[36:39], s57 offen offset:2048 lds
    s_load_dword s99, s[24:25], 64
    buffer_load_dwordx4 v211, s[36:39], s57 offen offset:3072 lds
    s_mov_b32 m0, s53
    s_nop 0
    buffer_load_dwordx4 v206, s[28:31], s56 offen offset:0 lds
    s_load_dword s99, s[10:11], 128
    buffer_load_dwordx4 v206, s[28:31], s56 offen offset:1024 lds
    buffer_load_dwordx4 v207, s[28:31], s56 offen offset:2048 lds
    s_load_dword s99, s[24:25], 128
    buffer_load_dwordx4 v207, s[28:31], s56 offen offset:3072 lds
    s_add_u32 s53, s53, 49152
    s_cmp_ge_u32 s53, s61
    s_cselect_b32 s53, s60, s53
    s_add_u32 s10, s10, 192
    s_addc_u32 s11, s11, 0
    s_add_u32 s24, s24, 192
    s_addc_u32 s25, s25, 0
    s_sub_u32 s54, s54, 1
    s_cbranch_scc0 M_Q_loop2
    s_movk_i32 s54, 2
M_Q_loop3:
    s_waitcnt vmcnt(12)
    s_barrier
    s_and_b32 s57, s58, 15
    s_lshr_b64 s[58:59], s[58:59], 4
    s_lshl_b32 s56, s57, 11
    s_mul_i32 s57, s57, 0x70000
    s_add_u32 m0, s53, 16384
    s_nop 0
    buffer_load_dwordx4 v208, s[32:35], s57 offen offset:0 lds
    buffer_load_dwordx4 v209, s[32:35], s57 offen offset:1024 lds
    buffer_load_dwordx4 v210, s[32:35], s57 offen offset:2048 lds
    buffer_load_dwordx4 v211, s[32:35], s57 offen offset:3072 lds
    s_add_u32 m0, s53, 32768
    s_nop 0
    buffer_load_dwordx4 v208, s[36:39], s57 offen offset:0 lds
    buffer_load_dwordx4 v209, s[36:39], s57 offen offset:1024 lds
    buffer_load_dwordx4 v210, s[36:39], s57 offen offset:2048 lds
    buffer_load_dwordx4 v211, s[36:39], s57 offen offset:3072 lds
    s_mov_b32 m0, s53
    s_nop 0
    buffer_load_dwordx4 v206, s[28:31], s56 offen offset:0 lds
    buffer_load_dwordx4 v206, s[28:31], s56 offen offset:1024 lds
    buffer_load_dwordx4 v207, s[28:31], s56 offen offset:2048 lds
    buffer_load_dwordx4 v207, s[28:31], s56 offen offset:3072 lds
    s_add_u32 s53, s53, 49152
    s_cmp_ge_u32 s53, s61
    s_cselect_b32 s53, s60, s53
    s_sub_u32 s54, s54, 1
    s_cbranch_scc0 M_Q_loop3
    s_waitcnt vmcnt(12)
    s_barrier
    s_bfe_u32 s66, s2, 0x30003
    s_lshr_b32 s55, s2, 6
    s_add_u32 s66, s66, s55
    s_mul_i32 s55, s66, 11
    s_lshr_b32 s55, s55, 5
    s_mul_i32 s55, s55, 3
    s_sub_u32 s66, s66, s55
    s_mov_b32 s58, 0x67534201
    s_mov_b32 s59, 0xfecdb9a8
    s_cmp_eq_u32 s66, 1
    s_cselect_b32 s58, 0x86453120, s58
    s_cselect_b32 s59, 0xfdecab97, s59
    s_cmp_eq_u32 s66, 2
    s_cselect_b32 s58, 0x75642310, s58
    s_cselect_b32 s59, 0xefdbca89, s59
    v_or_b32 v206, s69, v206
    v_or_b32 v207, s69, v207
    s_and_b32 s57, s58, 15
    s_lshr_b64 s[58:59], s[58:59], 4
    s_lshl_b32 s56, s57, 11
    s_mul_i32 s57, s57, 0x70000
    s_add_u32 m0, s53, 16384
    s_nop 0
    buffer_load_dwordx4 v212, s[32:35], s57 offen offset:0 lds
    buffer_load_dwordx4 v213, s[32:35], s57 offen offset:1024 lds
    buffer_load_dwordx4 v214, s[32:35], s57 offen offset:2048 lds
    buffer_load_dwordx4 v215, s[32:35], s57 offen offset:3072 lds
    s_add_u32 m0, s53, 32768
    s_nop 0
    buffer_load_dwordx4 v212, s[36:39], s57 offen offset:0 lds
    buffer_load_dwordx4 v213, s[36:39], s57 offen offset:1024 lds
    buffer_load_dwordx4 v214, s[36:39], s57 offen offset:2048 lds
    buffer_load_dwordx4 v215, s[36:39], s57 offen offset:3072 lds
    s_mov_b32 m0, s53
    s_nop 0
    buffer_load_dwordx4 v206, s[28:31], s56 offen offset:0 lds
    buffer_load_dwordx4 v206, s[28:31], s56 offen offset:1024 lds
    buffer_load_dwordx4 v207, s[28:31], s56 offen offset:2048 lds
    buffer_load_dwordx4 v207, s[28:31], s56 offen offset:3072 lds
    s_add_u32 s53, s53, 49152
    s_cmp_ge_u32 s53, s61
    s_cselect_b32 s53, s60, s53
    s_waitcnt vmcnt(12)
    s_barrier
    s_and_b32 s57, s58, 15
    s_lshr_b64 s[58:59], s[58:59], 4
    s_lshl_b32 s56, s57, 11
    s_mul_i32 s57, s57, 0x70000
    s_add_u32 m0, s53, 16384
    s_nop 0
    buffer_load_dwordx4 v212, s[32:35], s57 offen offset:0 lds
    buffer_load_dwordx4 v213, s[32:35], s57 offen offset:1024 lds
    buffer_load_dwordx4 v214, s[32:35], s57 offen offset:2048 lds
    buffer_load_dwordx4 v215, s[32:35], s57 offen offset:3072 lds
    s_add_u32 m0, s53, 32768
    s_nop 0
    buffer_load_dwordx4 v212, s[36:39], s57 offen offset:0 lds
    buffer_load_dwordx4 v213, s[36:39], s57 offen offset:1024 lds
    buffer_load_dwordx4 v214, s[36:39], s57 offen offset:2048 lds
    buffer_load_dwordx4 v215, s[36:39], s57 offen offset:3072 lds
    s_mov_b32 m0, s53
    s_nop 0
    buffer_load_dwordx4 v206, s[28:31], s56 offen offset:0 lds
    buffer_load_dwordx4 v206, s[28:31], s56 offen offset:1024 lds
    buffer_load_dwordx4 v207, s[28:31], s56 offen offset:2048 lds
    buffer_load_dwordx4 v207, s[28:31], s56 offen offset:3072 lds
    s_add_u32 s53, s53, 49152
    s_cmp_ge_u32 s53, s61
    s_cselect_b32 s53, s60, s53
    s_waitcnt vmcnt(12)
    s_barrier
    s_cmp_lg_u32 s69, 0
    s_cbranch_scc1 M_Qidle
    ds_read_b128 v[136:139], v232 offset:0
    ds_read_b64_tr_b16 v[152:153], v235 offset:0
    ds_read_b64_tr_b16 v[154:155], v235 offset:4096
    ds_read_b64_tr_b16 v[156:157], v236 offset:0
    ds_read_b64_tr_b16 v[158:159], v236 offset:4096
    ds_read_b64_tr_b16 v[160:161], v237 offset:0
    ds_read_b64_tr_b16 v[162:163], v237 offset:4096
    ds_read_b64_tr_b16 v[164:165], v238 offset:0
    ds_read_b64_tr_b16 v[166:167], v238 offset:4096
    ds_read_b64_tr_b16 v[168:169], v235 offset:16384
    ds_read_b64_tr_b16 v[170:171], v235 offset:20480
    ds_read_b64_tr_b16 v[172:173], v236 offset:16384
    ds_read_b64_tr_b16 v[174:175], v236 offset:20480
    ds_read_b64_tr_b16 v[176:177], v237 offset:16384
    ds_read_b64_tr_b16 v[178:179], v237 offset:20480
    ds_read_b64_tr_b16 v[180:181], v238 offset:16384
    ds_read_b64_tr_b16 v[182:183], v238 offset:20480
    ds_read_b128 v[140:143], v232 offset:2048
    ds_read_b128 v[144:147], v232 offset:4096
    ds_read_b128 v[148:151], v232 offset:6144
    s_and_b32 s57, s58, 15
    s_lshr_b64 s[58:59], s[58:59], 4
    s_lshl_b32 s56, s57, 11
    s_mul_i32 s57, s57, 0x70000
    s_add_u32 m0, s53, 16384
    s_nop 0
    buffer_load_dwordx4 v212, s[32:35], s57 offen offset:0 lds
    buffer_load_dwordx4 v213, s[32:35], s57 offen offset:1024 lds
    buffer_load_dwordx4 v214, s[32:35], s57 offen offset:2048 lds
    buffer_load_dwordx4 v215, s[32:35], s57 offen offset:3072 lds
    s_add_u32 m0, s53, 32768
    s_nop 0
    buffer_load_dwordx4 v212, s[36:39], s57 offen offset:0 lds
    buffer_load_dwordx4 v213, s[36:39], s57 offen offset:1024 lds
    buffer_load_dwordx4 v214, s[36:39], s57 offen offset:2048 lds
    buffer_load_dwordx4 v215, s[36:39], s57 offen offset:3072 lds
    s_mov_b32 m0, s53
    s_nop 0
    buffer_load_dwordx4 v206, s[28:31], s56 offen offset:0 lds
    buffer_load_dwordx4 v206, s[28:31], s56 offen offset:1024 lds
    buffer_load_dwordx4 v207, s[28:31], s56 offen offset:2048 lds
    buffer_load_dwordx4 v207, s[28:31], s56 offen offset:3072 lds
    s_add_u32 s53, s53, 49152
    s_cmp_ge_u32 s53, s61
    s_cselect_b32 s53, s60, s53
    s_setprio 2
    s_add_u32 s52, s52, 49152
    s_cmp_ge_u32 s52, 147456
    s_cselect_b32 s52, 0, s52
    s_waitcnt lgkmcnt(0)
    v_mfma_f32_16x16x32_bf16 v[8:11], v[152:155], v[136:139], 0
    ds_read_b128 v[184:187], v232 offset:1024
    v_mfma_f32_16x16x32_bf16 v[12:15], v[156:159], v[136:139], 0
    ds_read_b64_tr_b16 v[200:201], v235 offset:8192
    v_mfma_f32_16x16x32_bf16 v[16:19], v[160:163], v[136:139], 0
    ds_read_b64_tr_b16 v[202:203], v235 offset:12288
    v_mfma_f32_16x16x32_bf16 v[20:23], v[164:167], v[136:139], 0
    ds_read_b64_tr_b16 v[204:205], v236 offset:8192
    v_mfma_f32_16x16x32_bf16 v[24:27], v[168:171], v[136:139], 0
    v_mfma_f32_16x16x32_bf16 v[28:31], v[172:175], v[136:139], 0
    ds_read_b64_tr_b16 v[206:207], v236 offset:12288
    v_mfma_f32_16x16x32_bf16 v[32:35], v[176:179], v[136:139], 0
    ds_read_b64_tr_b16 v[208:209], v237 offset:8192
    v_mfma_f32_16x16x32_bf16 v[36:39], v[180:183], v[136:139], 0
    ds_read_b64_tr_b16 v[210:211], v237 offset:12288
    v_mfma_f32_16x16x32_bf16 v[40:43], v[152:155], v[140:143], 0
    ds_read_b64_tr_b16 v[212:213], v238 offset:8192
    v_mfma_f32_16x16x32_bf16 v[44:47], v[156:159], v[140:143], 0
    v_mfma_f32_16x16x32_bf16 v[48:51], v[160:163], v[140:143], 0
    ds_read_b64_tr_b16 v[214:215], v238 offset:12288
    v_mfma_f32_16x16x32_bf16 v[52:55], v[164:167], v[140:143], 0
    ds_read_b64_tr_b16 v[216:217], v235 offset:24576
    v_mfma_f32_16x16x32_bf16 v[56:59], v[168:171], v[140:143], 0
    ds_read_b64_tr_b16 v[218:219], v235 offset:28672
    v_mfma_f32_16x16x32_bf16 v[60:63], v[172:175], v[140:143], 0
    ds_read_b64_tr_b16 v[220:221], v236 offset:24576
    v_mfma_f32_16x16x32_bf16 v[64:67], v[176:179], v[140:143], 0
    v_mfma_f32_16x16x32_bf16 v[68:71], v[180:183], v[140:143], 0
    ds_read_b64_tr_b16 v[222:223], v236 offset:28672
    v_mfma_f32_16x16x32_bf16 v[72:75], v[152:155], v[144:147], 0
    ds_read_b64_tr_b16 v[224:225], v237 offset:24576
    v_mfma_f32_16x16x32_bf16 v[76:79], v[156:159], v[144:147], 0
    ds_read_b64_tr_b16 v[226:227], v237 offset:28672
    v_mfma_f32_16x16x32_bf16 v[80:83], v[160:163], v[144:147], 0
    ds_read_b64_tr_b16 v[228:229], v238 offset:24576
    v_mfma_f32_16x16x32_bf16 v[84:87], v[164:167], v[144:147], 0
    v_mfma_f32_16x16x32_bf16 v[88:91], v[168:171], v[144:147], 0
    ds_read_b64_tr_b16 v[230:231], v238 offset:28672
    v_mfma_f32_16x16x32_bf16 v[92:95], v[172:175], v[144:147], 0
    ds_read_b128 v[188:191], v232 offset:3072
    v_mfma_f32_16x16x32_bf16 v[96:99], v[176:179], v[144:147], 0
    ds_read_b128 v[192:195], v232 offset:5120
    v_mfma_f32_16x16x32_bf16 v[100:103], v[180:183], v[144:147], 0
    ds_read_b128 v[196:199], v232 offset:7168
    v_mfma_f32_16x16x32_bf16 v[104:107], v[152:155], v[148:151], 0
    v_mfma_f32_16x16x32_bf16 v[108:111], v[156:159], v[148:151], 0
    v_add_u32 v232, s52, v233
    v_mfma_f32_16x16x32_bf16 v[112:115], v[160:163], v[148:151], 0
    v_add_u32 v235, s52, v239
    v_mfma_f32_16x16x32_bf16 v[116:119], v[164:167], v[148:151], 0
    v_add_u32 v236, s52, v240
    v_mfma_f32_16x16x32_bf16 v[120:123], v[168:171], v[148:151], 0
    v_mfma_f32_16x16x32_bf16 v[124:127], v[172:175], v[148:151], 0
    v_add_u32 v237, s52, v241
    v_mfma_f32_16x16x32_bf16 v[128:131], v[176:179], v[148:151], 0
    v_add_u32 v238, s52, v242
    v_mfma_f32_16x16x32_bf16 v[132:135], v[180:183], v[148:151], 0
    s_waitcnt lgkmcnt(0)
    v_mfma_f32_16x16x32_bf16 v[8:11], v[200:203], v[184:187], v[8:11]
    s_waitcnt vmcnt(12)
    s_barrier
    v_mfma_f32_16x16x32_bf16 v[12:15], v[204:207], v[184:187], v[12:15]
    ds_read_b128 v[136:139], v232 offset:0
    v_mfma_f32_16x16x32_bf16 v[16:19], v[208:211], v[184:187], v[16:19]
    ds_read_b64_tr_b16 v[152:153], v235 offset:0
    v_mfma_f32_16x16x32_bf16 v[20:23], v[212:215], v[184:187], v[20:23]
    ds_read_b64_tr_b16 v[154:155], v235 offset:4096
    v_mfma_f32_16x16x32_bf16 v[24:27], v[216:219], v[184:187], v[24:27]
    ds_read_b64_tr_b16 v[156:157], v236 offset:0
    v_mfma_f32_16x16x32_bf16 v[28:31], v[220:223], v[184:187], v[28:31]
    ds_read_b64_tr_b16 v[158:159], v236 offset:4096
    v_mfma_f32_16x16x32_bf16 v[32:35], v[224:227], v[184:187], v[32:35]
    v_mfma_f32_16x16x32_bf16 v[36:39], v[228:231], v[184:187], v[36:39]
    ds_read_b64_tr_b16 v[160:161], v237 offset:0
    v_mfma_f32_16x16x32_bf16 v[40:43], v[200:203], v[188:191], v[40:43]
    ds_read_b64_tr_b16 v[162:163], v237 offset:4096
    v_mfma_f32_16x16x32_bf16 v[44:47], v[204:207], v[188:191], v[44:47]
    ds_read_b64_tr_b16 v[164:165], v238 offset:0
    v_mfma_f32_16x16x32_bf16 v[48:51], v[208:211], v[188:191], v[48:51]
    ds_read_b64_tr_b16 v[166:167], v238 offset:4096
    v_mfma_f32_16x16x32_bf16 v[52:55], v[212:215], v[188:191], v[52:55]
    ds_read_b64_tr_b16 v[168:169], v235 offset:16384
    v_mfma_f32_16x16x32_bf16 v[56:59], v[216:219], v[188:191], v[56:59]
    v_mfma_f32_16x16x32_bf16 v[60:63], v[220:223], v[188:191], v[60:63]
    ds_read_b64_tr_b16 v[170:171], v235 offset:20480
    v_mfma_f32_16x16x32_bf16 v[64:67], v[224:227], v[188:191], v[64:67]
    ds_read_b64_tr_b16 v[172:173], v236 offset:16384
    v_mfma_f32_16x16x32_bf16 v[68:71], v[228:231], v[188:191], v[68:71]
    ds_read_b64_tr_b16 v[174:175], v236 offset:20480
    v_mfma_f32_16x16x32_bf16 v[72:75], v[200:203], v[192:195], v[72:75]
    ds_read_b64_tr_b16 v[176:177], v237 offset:16384
    v_mfma_f32_16x16x32_bf16 v[76:79], v[204:207], v[192:195], v[76:79]
    ds_read_b64_tr_b16 v[178:179], v237 offset:20480
    v_mfma_f32_16x16x32_bf16 v[80:83], v[208:211], v[192:195], v[80:83]
    v_mfma_f32_16x16x32_bf16 v[84:87], v[212:215], v[192:195], v[84:87]
    ds_read_b64_tr_b16 v[180:181], v238 offset:16384
    v_mfma_f32_16x16x32_bf16 v[88:91], v[216:219], v[192:195], v[88:91]
    ds_read_b64_tr_b16 v[182:183], v238 offset:20480
    v_mfma_f32_16x16x32_bf16 v[92:95], v[220:223], v[192:195], v[92:95]
    ds_read_b128 v[140:143], v232 offset:2048
    v_mfma_f32_16x16x32_bf16 v[96:99], v[224:227], v[192:195], v[96:99]
    ds_read_b128 v[144:147], v232 offset:4096
    v_mfma_f32_16x16x32_bf16 v[100:103], v[228:231], v[192:195], v[100:103]
    ds_read_b128 v[148:151], v232 offset:6144
    v_mfma_f32_16x16x32_bf16 v[104:107], v[200:203], v[196:199], v[104:107]
    v_mfma_f32_16x16x32_bf16 v[108:111], v[204:207], v[196:199], v[108:111]
    v_mfma_f32_16x16x32_bf16 v[112:115], v[208:211], v[196:199], v[112:115]
    v_mfma_f32_16x16x32_bf16 v[116:119], v[212:215], v[196:199], v[116:119]
    v_mfma_f32_16x16x32_bf16 v[120:123], v[216:219], v[196:199], v[120:123]
    v_mfma_f32_16x16x32_bf16 v[124:127], v[220:223], v[196:199], v[124:127]
    v_mfma_f32_16x16x32_bf16 v[128:131], v[224:227], v[196:199], v[128:131]
    s_add_u32 s52, s52, 49152
    s_cmp_ge_u32 s52, 147456
    s_cselect_b32 s52, 0, s52
    v_mfma_f32_16x16x32_bf16 v[132:135], v[228:231], v[196:199], v[132:135]
    s_waitcnt lgkmcnt(0)
    v_mfma_f32_16x16x32_bf16 v[8:11], v[152:155], v[136:139], v[8:11]
    ds_read_b128 v[184:187], v232 offset:1024
    v_mfma_f32_16x16x32_bf16 v[12:15], v[156:159], v[136:139], v[12:15]
    ds_read_b64_tr_b16 v[200:201], v235 offset:8192
    v_mfma_f32_16x16x32_bf16 v[16:19], v[160:163], v[136:139], v[16:19]
    ds_read_b64_tr_b16 v[202:203], v235 offset:12288
    v_mfma_f32_16x16x32_bf16 v[20:23], v[164:167], v[136:139], v[20:23]
    ds_read_b64_tr_b16 v[204:205], v236 offset:8192
    v_mfma_f32_16x16x32_bf16 v[24:27], v[168:171], v[136:139], v[24:27]
    v_mfma_f32_16x16x32_bf16 v[28:31], v[172:175], v[136:139], v[28:31]
    ds_read_b64_tr_b16 v[206:207], v236 offset:12288
    v_mfma_f32_16x16x32_bf16 v[32:35], v[176:179], v[136:139], v[32:35]
    ds_read_b64_tr_b16 v[208:209], v237 offset:8192
    v_mfma_f32_16x16x32_bf16 v[36:39], v[180:183], v[136:139], v[36:39]
    ds_read_b64_tr_b16 v[210:211], v237 offset:12288
    v_mfma_f32_16x16x32_bf16 v[40:43], v[152:155], v[140:143], v[40:43]
    ds_read_b64_tr_b16 v[212:213], v238 offset:8192
    v_mfma_f32_16x16x32_bf16 v[44:47], v[156:159], v[140:143], v[44:47]
    v_mfma_f32_16x16x32_bf16 v[48:51], v[160:163], v[140:143], v[48:51]
    ds_read_b64_tr_b16 v[214:215], v238 offset:12288
    v_mfma_f32_16x16x32_bf16 v[52:55], v[164:167], v[140:143], v[52:55]
    ds_read_b64_tr_b16 v[216:217], v235 offset:24576
    v_mfma_f32_16x16x32_bf16 v[56:59], v[168:171], v[140:143], v[56:59]
    ds_read_b64_tr_b16 v[218:219], v235 offset:28672
    v_mfma_f32_16x16x32_bf16 v[60:63], v[172:175], v[140:143], v[60:63]
    ds_read_b64_tr_b16 v[220:221], v236 offset:24576
    v_mfma_f32_16x16x32_bf16 v[64:67], v[176:179], v[140:143], v[64:67]
    v_mfma_f32_16x16x32_bf16 v[68:71], v[180:183], v[140:143], v[68:71]
    ds_read_b64_tr_b16 v[222:223], v236 offset:28672
    v_mfma_f32_16x16x32_bf16 v[72:75], v[152:155], v[144:147], v[72:75]
    ds_read_b64_tr_b16 v[224:225], v237 offset:24576
    v_mfma_f32_16x16x32_bf16 v[76:79], v[156:159], v[144:147], v[76:79]
    ds_read_b64_tr_b16 v[226:227], v237 offset:28672
    v_mfma_f32_16x16x32_bf16 v[80:83], v[160:163], v[144:147], v[80:83]
    ds_read_b64_tr_b16 v[228:229], v238 offset:24576
    v_mfma_f32_16x16x32_bf16 v[84:87], v[164:167], v[144:147], v[84:87]
    v_mfma_f32_16x16x32_bf16 v[88:91], v[168:171], v[144:147], v[88:91]
    ds_read_b64_tr_b16 v[230:231], v238 offset:28672
    v_mfma_f32_16x16x32_bf16 v[92:95], v[172:175], v[144:147], v[92:95]
    ds_read_b128 v[188:191], v232 offset:3072
    v_mfma_f32_16x16x32_bf16 v[96:99], v[176:179], v[144:147], v[96:99]
    ds_read_b128 v[192:195], v232 offset:5120
    v_mfma_f32_16x16x32_bf16 v[100:103], v[180:183], v[144:147], v[100:103]
    ds_read_b128 v[196:199], v232 offset:7168
    v_mfma_f32_16x16x32_bf16 v[104:107], v[152:155], v[148:151], v[104:107]
    v_mfma_f32_16x16x32_bf16 v[108:111], v[156:159], v[148:151], v[108:111]
    v_add_u32 v232, s52, v233
    v_mfma_f32_16x16x32_bf16 v[112:115], v[160:163], v[148:151], v[112:115]
    v_add_u32 v235, s52, v239
    v_mfma_f32_16x16x32_bf16 v[116:119], v[164:167], v[148:151], v[116:119]
    v_add_u32 v236, s52, v240
    v_mfma_f32_16x16x32_bf16 v[120:123], v[168:171], v[148:151], v[120:123]
    v_mfma_f32_16x16x32_bf16 v[124:127], v[172:175], v[148:151], v[124:127]
    v_add_u32 v237, s52, v241
    v_mfma_f32_16x16x32_bf16 v[128:131], v[176:179], v[148:151], v[128:131]
    v_add_u32 v238, s52, v242
    v_mfma_f32_16x16x32_bf16 v[132:135], v[180:183], v[148:151], v[132:135]
    s_waitcnt lgkmcnt(0)
    v_mfma_f32_16x16x32_bf16 v[8:11], v[200:203], v[184:187], v[8:11]
    s_waitcnt vmcnt(0)
    s_barrier
    v_mfma_f32_16x16x32_bf16 v[12:15], v[204:207], v[184:187], v[12:15]
    ds_read_b128 v[136:139], v232 offset:0
    v_mfma_f32_16x16x32_bf16 v[16:19], v[208:211], v[184:187], v[16:19]
    ds_read_b64_tr_b16 v[152:153], v235 offset:0
    v_mfma_f32_16x16x32_bf16 v[20:23], v[212:215], v[184:187], v[20:23]
    ds_read_b64_tr_b16 v[154:155], v235 offset:4096
    v_mfma_f32_16x16x32_bf16 v[24:27], v[216:219], v[184:187], v[24:27]
    ds_read_b64_tr_b16 v[156:157], v236 offset:0
    v_mfma_f32_16x16x32_bf16 v[28:31], v[220:223], v[184:187], v[28:31]
    ds_read_b64_tr_b16 v[158:159], v236 offset:4096
    v_mfma_f32_16x16x32_bf16 v[32:35], v[224:227], v[184:187], v[32:35]
    v_mfma_f32_16x16x32_bf16 v[36:39], v[228:231], v[184:187], v[36:39]
    ds_read_b64_tr_b16 v[160:161], v237 offset:0
    v_mfma_f32_16x16x32_bf16 v[40:43], v[200:203], v[188:191], v[40:43]
    ds_read_b64_tr_b16 v[162:163], v237 offset:4096
    v_mfma_f32_16x16x32_bf16 v[44:47], v[204:207], v[188:191], v[44:47]
    ds_read_b64_tr_b16 v[164:165], v238 offset:0
    v_mfma_f32_16x16x32_bf16 v[48:51], v[208:211], v[188:191], v[48:51]
    ds_read_b64_tr_b16 v[166:167], v238 offset:4096
    v_mfma_f32_16x16x32_bf16 v[52:55], v[212:215], v[188:191], v[52:55]
    ds_read_b64_tr_b16 v[168:169], v235 offset:16384
    v_mfma_f32_16x16x32_bf16 v[56:59], v[216:219], v[188:191], v[56:59]
    v_mfma_f32_16x16x32_bf16 v[60:63], v[220:223], v[188:191], v[60:63]
    ds_read_b64_tr_b16 v[170:171], v235 offset:20480
    v_mfma_f32_16x16x32_bf16 v[64:67], v[224:227], v[188:191], v[64:67]
    ds_read_b64_tr_b16 v[172:173], v236 offset:16384
    v_mfma_f32_16x16x32_bf16 v[68:71], v[228:231], v[188:191], v[68:71]
    ds_read_b64_tr_b16 v[174:175], v236 offset:20480
    v_mfma_f32_16x16x32_bf16 v[72:75], v[200:203], v[192:195], v[72:75]
    ds_read_b64_tr_b16 v[176:177], v237 offset:16384
    v_mfma_f32_16x16x32_bf16 v[76:79], v[204:207], v[192:195], v[76:79]
    ds_read_b64_tr_b16 v[178:179], v237 offset:20480
    v_mfma_f32_16x16x32_bf16 v[80:83], v[208:211], v[192:195], v[80:83]
    v_mfma_f32_16x16x32_bf16 v[84:87], v[212:215], v[192:195], v[84:87]
    ds_read_b64_tr_b16 v[180:181], v238 offset:16384
    v_mfma_f32_16x16x32_bf16 v[88:91], v[216:219], v[192:195], v[88:91]
    ds_read_b64_tr_b16 v[182:183], v238 offset:20480
    v_mfma_f32_16x16x32_bf16 v[92:95], v[220:223], v[192:195], v[92:95]
    ds_read_b128 v[140:143], v232 offset:2048
    v_mfma_f32_16x16x32_bf16 v[96:99], v[224:227], v[192:195], v[96:99]
    ds_read_b128 v[144:147], v232 offset:4096
    v_mfma_f32_16x16x32_bf16 v[100:103], v[228:231], v[192:195], v[100:103]
    ds_read_b128 v[148:151], v232 offset:6144
    v_mfma_f32_16x16x32_bf16 v[104:107], v[200:203], v[196:199], v[104:107]
    v_mfma_f32_16x16x32_bf16 v[108:111], v[204:207], v[196:199], v[108:111]
    v_mfma_f32_16x16x32_bf16 v[112:115], v[208:211], v[196:199], v[112:115]
    v_mfma_f32_16x16x32_bf16 v[116:119], v[212:215], v[196:199], v[116:119]
    v_mfma_f32_16x16x32_bf16 v[120:123], v[216:219], v[196:199], v[120:123]
    v_mfma_f32_16x16x32_bf16 v[124:127], v[220:223], v[196:199], v[124:127]
    v_mfma_f32_16x16x32_bf16 v[128:131], v[224:227], v[196:199], v[128:131]
    s_add_u32 s52, s52, 49152
    s_cmp_ge_u32 s52, 147456
    s_cselect_b32 s52, 0, s52
    v_mfma_f32_16x16x32_bf16 v[132:135], v[228:231], v[196:199], v[132:135]
    s_waitcnt lgkmcnt(0)
    v_mfma_f32_16x16x32_bf16 v[8:11], v[152:155], v[136:139], v[8:11]
    ds_read_b128 v[184:187], v232 offset:1024
    v_mfma_f32_16x16x32_bf16 v[12:15], v[156:159], v[136:139], v[12:15]
    ds_read_b64_tr_b16 v[200:201], v235 offset:8192
    v_mfma_f32_16x16x32_bf16 v[16:19], v[160:163], v[136:139], v[16:19]
    ds_read_b64_tr_b16 v[202:203], v235 offset:12288
    v_mfma_f32_16x16x32_bf16 v[20:23], v[164:167], v[136:139], v[20:23]
    ds_read_b64_tr_b16 v[204:205], v236 offset:8192
    v_mfma_f32_16x16x32_bf16 v[24:27], v[168:171], v[136:139], v[24:27]
    v_mfma_f32_16x16x32_bf16 v[28:31], v[172:175], v[136:139], v[28:31]
    ds_read_b64_tr_b16 v[206:207], v236 offset:12288
    v_mfma_f32_16x16x32_bf16 v[32:35], v[176:179], v[136:139], v[32:35]
    ds_read_b64_tr_b16 v[208:209], v237 offset:8192
    v_mfma_f32_16x16x32_bf16 v[36:39], v[180:183], v[136:139], v[36:39]
    ds_read_b64_tr_b16 v[210:211], v237 offset:12288
    v_mfma_f32_16x16x32_bf16 v[40:43], v[152:155], v[140:143], v[40:43]
    ds_read_b64_tr_b16 v[212:213], v238 offset:8192
    v_mfma_f32_16x16x32_bf16 v[44:47], v[156:159], v[140:143], v[44:47]
    v_mfma_f32_16x16x32_bf16 v[48:51], v[160:163], v[140:143], v[48:51]
    ds_read_b64_tr_b16 v[214:215], v238 offset:12288
    v_mfma_f32_16x16x32_bf16 v[52:55], v[164:167], v[140:143], v[52:55]
    ds_read_b64_tr_b16 v[216:217], v235 offset:24576
    v_mfma_f32_16x16x32_bf16 v[56:59], v[168:171], v[140:143], v[56:59]
    ds_read_b64_tr_b16 v[218:219], v235 offset:28672
    v_mfma_f32_16x16x32_bf16 v[60:63], v[172:175], v[140:143], v[60:63]
    ds_read_b64_tr_b16 v[220:221], v236 offset:24576
    v_mfma_f32_16x16x32_bf16 v[64:67], v[176:179], v[140:143], v[64:67]
    v_mfma_f32_16x16x32_bf16 v[68:71], v[180:183], v[140:143], v[68:71]
    ds_read_b64_tr_b16 v[222:223], v236 offset:28672
    v_mfma_f32_16x16x32_bf16 v[72:75], v[152:155], v[144:147], v[72:75]
    s_movk_i32 s54, 12
M_Q_loop4:
    ds_read_b64_tr_b16 v[224:225], v237 offset:24576
    v_mfma_f32_16x16x32_bf16 v[76:79], v[156:159], v[144:147], v[76:79]
    ds_read_b64_tr_b16 v[226:227], v237 offset:28672
    v_mfma_f32_16x16x32_bf16 v[80:83], v[160:163], v[144:147], v[80:83]
    ds_read_b64_tr_b16 v[228:229], v238 offset:24576
    v_mfma_f32_16x16x32_bf16 v[84:87], v[164:167], v[144:147], v[84:87]
    v_mfma_f32_16x16x32_bf16 v[88:91], v[168:171], v[144:147], v[88:91]
    ds_read_b64_tr_b16 v[230:231], v238 offset:28672
    v_mfma_f32_16x16x32_bf16 v[92:95], v[172:175], v[144:147], v[92:95]
    ds_read_b128 v[188:191], v232 offset:3072
    v_mfma_f32_16x16x32_bf16 v[96:99], v[176:179], v[144:147], v[96:99]
    ds_read_b128 v[192:195], v232 offset:5120
    v_mfma_f32_16x16x32_bf16 v[100:103], v[180:183], v[144:147], v[100:103]
    ds_read_b128 v[196:199], v232 offset:7168
    v_mfma_f32_16x16x32_bf16 v[104:107], v[152:155], v[148:151], v[104:107]
    v_mfma_f32_16x16x32_bf16 v[108:111], v[156:159], v[148:151], v[108:111]
    v_add_u32 v232, s52, v233
    v_mfma_f32_16x16x32_bf16 v[112:115], v[160:163], v[148:151], v[112:115]
    v_add_u32 v235, s52, v239
    v_mfma_f32_16x16x32_bf16 v[116:119], v[164:167], v[148:151], v[116:119]
    v_add_u32 v236, s52, v240
    v_mfma_f32_16x16x32_bf16 v[120:123], v[168:171], v[148:151], v[120:123]
    v_mfma_f32_16x16x32_bf16 v[124:127], v[172:175], v[148:151], v[124:127]
    v_add_u32 v237, s52, v241
    v_mfma_f32_16x16x32_bf16 v[128:131], v[176:179], v[148:151], v[128:131]
    v_add_u32 v238, s52, v242
    v_mfma_f32_16x16x32_bf16 v[132:135], v[180:183], v[148:151], v[132:135]
    s_waitcnt lgkmcnt(0)
    v_mfma_f32_16x16x32_bf16 v[8:11], v[200:203], v[184:187], v[8:11]
    s_barrier
    v_mfma_f32_16x16x32_bf16 v[12:15], v[204:207], v[184:187], v[12:15]
    ds_read_b128 v[136:139], v232 offset:0
    v_mfma_f32_16x16x32_bf16 v[16:19], v[208:211], v[184:187], v[16:19]
    ds_read_b64_tr_b16 v[152:153], v235 offset:0
    v_mfma_f32_16x16x32_bf16 v[20:23], v[212:215], v[184:187], v[20:23]
    ds_read_b64_tr_b16 v[154:155], v235 offset:4096
    v_mfma_f32_16x16x32_bf16 v[24:27], v[216:219], v[184:187], v[24:27]
    ds_read_b64_tr_b16 v[156:157], v236 offset:0
    v_mfma_f32_16x16x32_bf16 v[28:31], v[220:223], v[184:187], v[28:31]
    ds_read_b64_tr_b16 v[158:159], v236 offset:4096
    v_mfma_f32_16x16x32_bf16 v[32:35], v[224:227], v[184:187], v[32:35]
    v_mfma_f32_16x16x32_bf16 v[36:39], v[228:231], v[184:187], v[36:39]
    ds_read_b64_tr_b16 v[160:161], v237 offset:0
    v_mfma_f32_16x16x32_bf16 v[40:43], v[200:203], v[188:191], v[40:43]
    ds_read_b64_tr_b16 v[162:163], v237 offset:4096
    v_mfma_f32_16x16x32_bf16 v[44:47], v[204:207], v[188:191], v[44:47]
    ds_read_b64_tr_b16 v[164:165], v238 offset:0
    v_mfma_f32_16x16x32_bf16 v[48:51], v[208:211], v[188:191], v[48:51]
    ds_read_b64_tr_b16 v[166:167], v238 offset:4096
    v_mfma_f32_16x16x32_bf16 v[52:55], v[212:215], v[188:191], v[52:55]
    ds_read_b64_tr_b16 v[168:169], v235 offset:16384
    v_mfma_f32_16x16x32_bf16 v[56:59], v[216:219], v[188:191], v[56:59]
    v_mfma_f32_16x16x32_bf16 v[60:63], v[220:223], v[188:191], v[60:63]
    ds_read_b64_tr_b16 v[170:171], v235 offset:20480
    v_mfma_f32_16x16x32_bf16 v[64:67], v[224:227], v[188:191], v[64:67]
    ds_read_b64_tr_b16 v[172:173], v236 offset:16384
    v_mfma_f32_16x16x32_bf16 v[68:71], v[228:231], v[188:191], v[68:71]
    ds_read_b64_tr_b16 v[174:175], v236 offset:20480
    v_mfma_f32_16x16x32_bf16 v[72:75], v[200:203], v[192:195], v[72:75]
    ds_read_b64_tr_b16 v[176:177], v237 offset:16384
    v_mfma_f32_16x16x32_bf16 v[76:79], v[204:207], v[192:195], v[76:79]
    ds_read_b64_tr_b16 v[178:179], v237 offset:20480
    v_mfma_f32_16x16x32_bf16 v[80:83], v[208:211], v[192:195], v[80:83]
    v_mfma_f32_16x16x32_bf16 v[84:87], v[212:215], v[192:195], v[84:87]
    ds_read_b64_tr_b16 v[180:181], v238 offset:16384
    v_mfma_f32_16x16x32_bf16 v[88:91], v[216:219], v[192:195], v[88:91]
    ds_read_b64_tr_b16 v[182:183], v238 offset:20480
    v_mfma_f32_16x16x32_bf16 v[92:95], v[220:223], v[192:195], v[92:95]
    ds_read_b128 v[140:143], v232 offset:2048
    v_mfma_f32_16x16x32_bf16 v[96:99], v[224:227], v[192:195], v[96:99]
    ds_read_b128 v[144:147], v232 offset:4096
    v_mfma_f32_16x16x32_bf16 v[100:103], v[228:231], v[192:195], v[100:103]
    ds_read_b128 v[148:151], v232 offset:6144
    v_mfma_f32_16x16x32_bf16 v[104:107], v[200:203], v[196:199], v[104:107]
    v_mfma_f32_16x16x32_bf16 v[108:111], v[204:207], v[196:199], v[108:111]
    v_mfma_f32_16x16x32_bf16 v[112:115], v[208:211], v[196:199], v[112:115]
    v_mfma_f32_16x16x32_bf16 v[116:119], v[212:215], v[196:199], v[116:119]
    v_mfma_f32_16x16x32_bf16 v[120:123], v[216:219], v[196:199], v[120:123]
    v_mfma_f32_16x16x32_bf16 v[124:127], v[220:223], v[196:199], v[124:127]
    v_mfma_f32_16x16x32_bf16 v[128:131], v[224:227], v[196:199], v[128:131]
    s_add_u32 s52, s52, 49152
    s_cmp_ge_u32 s52, 147456
    s_cselect_b32 s52, 0, s52
    v_mfma_f32_16x16x32_bf16 v[132:135], v[228:231], v[196:199], v[132:135]
    s_waitcnt lgkmcnt(0)
    v_mfma_f32_16x16x32_bf16 v[8:11], v[152:155], v[136:139], v[8:11]
    ds_read_b128 v[184:187], v232 offset:1024
    v_mfma_f32_16x16x32_bf16 v[12:15], v[156:159], v[136:139], v[12:15]
    ds_read_b64_tr_b16 v[200:201], v235 offset:8192
    v_mfma_f32_16x16x32_bf16 v[16:19], v[160:163], v[136:139], v[16:19]
    ds_read_b64_tr_b16 v[202:203], v235 offset:12288
    v_mfma_f32_16x16x32_bf16 v[20:23], v[164:167], v[136:139], v[20:23]
    ds_read_b64_tr_b16 v[204:205], v236 offset:8192
    v_mfma_f32_16x16x32_bf16 v[24:27], v[168:171], v[136:139], v[24:27]
    v_mfma_f32_16x16x32_bf16 v[28:31], v[172:175], v[136:139], v[28:31]
    ds_read_b64_tr_b16 v[206:207], v236 offset:12288
    v_mfma_f32_16x16x32_bf16 v[32:35], v[176:179], v[136:139], v[32:35]
    ds_read_b64_tr_b16 v[208:209], v237 offset:8192
    v_mfma_f32_16x16x32_bf16 v[36:39], v[180:183], v[136:139], v[36:39]
    ds_read_b64_tr_b16 v[210:211], v237 offset:12288
    v_mfma_f32_16x16x32_bf16 v[40:43], v[152:155], v[140:143], v[40:43]
    ds_read_b64_tr_b16 v[212:213], v238 offset:8192
    v_mfma_f32_16x16x32_bf16 v[44:47], v[156:159], v[140:143], v[44:47]
    v_mfma_f32_16x16x32_bf16 v[48:51], v[160:163], v[140:143], v[48:51]
    ds_read_b64_tr_b16 v[214:215], v238 offset:12288
    v_mfma_f32_16x16x32_bf16 v[52:55], v[164:167], v[140:143], v[52:55]
    ds_read_b64_tr_b16 v[216:217], v235 offset:24576
    v_mfma_f32_16x16x32_bf16 v[56:59], v[168:171], v[140:143], v[56:59]
    ds_read_b64_tr_b16 v[218:219], v235 offset:28672
    v_mfma_f32_16x16x32_bf16 v[60:63], v[172:175], v[140:143], v[60:63]
    ds_read_b64_tr_b16 v[220:221], v236 offset:24576
    v_mfma_f32_16x16x32_bf16 v[64:67], v[176:179], v[140:143], v[64:67]
    v_mfma_f32_16x16x32_bf16 v[68:71], v[180:183], v[140:143], v[68:71]
    s_sub_u32 s54, s54, 1
    ds_read_b64_tr_b16 v[222:223], v236 offset:28672
    v_mfma_f32_16x16x32_bf16 v[72:75], v[152:155], v[144:147], v[72:75]
    s_cbranch_scc0 M_Q_loop4
    ds_read_b64_tr_b16 v[224:225], v237 offset:24576
    v_mfma_f32_16x16x32_bf16 v[76:79], v[156:159], v[144:147], v[76:79]
    ds_read_b64_tr_b16 v[226:227], v237 offset:28672
    v_mfma_f32_16x16x32_bf16 v[80:83], v[160:163], v[144:147], v[80:83]
    ds_read_b64_tr_b16 v[228:229], v238 offset:24576
    v_mfma_f32_16x16x32_bf16 v[84:87], v[164:167], v[144:147], v[84:87]
    v_mfma_f32_16x16x32_bf16 v[88:91], v[168:171], v[144:147], v[88:91]
    ds_read_b64_tr_b16 v[230:231], v238 offset:28672
    v_mfma_f32_16x16x32_bf16 v[92:95], v[172:175], v[144:147], v[92:95]
    ds_read_b128 v[188:191], v232 offset:3072
    v_mfma_f32_16x16x32_bf16 v[96:99], v[176:179], v[144:147], v[96:99]
    ds_read_b128 v[192:195], v232 offset:5120
    v_mfma_f32_16x16x32_bf16 v[100:103], v[180:183], v[144:147], v[100:103]
    ds_read_b128 v[196:199], v232 offset:7168
    v_mfma_f32_16x16x32_bf16 v[104:107], v[152:155], v[148:151], v[104:107]
    v_mfma_f32_16x16x32_bf16 v[108:111], v[156:159], v[148:151], v[108:111]
    v_mfma_f32_16x16x32_bf16 v[112:115], v[160:163], v[148:151], v[112:115]
    v_mfma_f32_16x16x32_bf16 v[116:119], v[164:167], v[148:151], v[116:119]
    v_mfma_f32_16x16x32_bf16 v[120:123], v[168:171], v[148:151], v[120:123]
    v_mfma_f32_16x16x32_bf16 v[124:127], v[172:175], v[148:151], v[124:127]
    v_mfma_f32_16x16x32_bf16 v[128:131], v[176:179], v[148:151], v[128:131]
    v_mfma_f32_16x16x32_bf16 v[132:135], v[180:183], v[148:151], v[132:135]
    s_waitcnt lgkmcnt(0)
    v_mfma_f32_16x16x32_bf16 v[8:11], v[200:203], v[184:187], v[8:11]
    s_barrier
    v_mfma_f32_16x16x32_bf16 v[12:15], v[204:207], v[184:187], v[12:15]
    v_mfma_f32_16x16x32_bf16 v[16:19], v[208:211], v[184:187], v[16:19]
    v_mfma_f32_16x16x32_bf16 v[20:23], v[212:215], v[184:187], v[20:23]
    v_mfma_f32_16x16x32_bf16 v[24:27], v[216:219], v[184:187], v[24:27]
    v_mfma_f32_16x16x32_bf16 v[28:31], v[220:223], v[184:187], v[28:31]
    v_mfma_f32_16x16x32_bf16 v[32:35], v[224:227], v[184:187], v[32:35]
    v_mfma_f32_16x16x32_bf16 v[36:39], v[228:231], v[184:187], v[36:39]
    v_mfma_f32_16x16x32_bf16 v[40:43], v[200:203], v[188:191], v[40:43]
    v_mfma_f32_16x16x32_bf16 v[44:47], v[204:207], v[188:191], v[44:47]
    v_mfma_f32_16x16x32_bf16 v[48:51], v[208:211], v[188:191], v[48:51]
    v_mfma_f32_16x16x32_bf16 v[52:55], v[212:215], v[188:191], v[52:55]
    v_mfma_f32_16x16x32_bf16 v[56:59], v[216:219], v[188:191], v[56:59]
    v_mfma_f32_16x16x32_bf16 v[60:63], v[220:223], v[188:191], v[60:63]
    v_mfma_f32_16x16x32_bf16 v[64:67], v[224:227], v[188:191], v[64:67]
    v_mfma_f32_16x16x32_bf16 v[68:71], v[228:231], v[188:191], v[68:71]
    v_mfma_f32_16x16x32_bf16 v[72:75], v[200:203], v[192:195], v[72:75]
    v_mfma_f32_16x16x32_bf16 v[76:79], v[204:207], v[192:195], v[76:79]
    v_mfma_f32_16x16x32_bf16 v[80:83], v[208:211], v[192:195], v[80:83]
    v_mfma_f32_16x16x32_bf16 v[84:87], v[212:215], v[192:195], v[84:87]
    v_mfma_f32_16x16x32_bf16 v[88:91], v[216:219], v[192:195], v[88:91]
    v_mfma_f32_16x16x32_bf16 v[92:95], v[220:223], v[192:195], v[92:95]
    v_mfma_f32_16x16x32_bf16 v[96:99], v[224:227], v[192:195], v[96:99]
    v_mfma_f32_16x16x32_bf16 v[100:103], v[228:231], v[192:195], v[100:103]
    v_mfma_f32_16x16x32_bf16 v[104:107], v[200:203], v[196:199], v[104:107]
    v_mfma_f32_16x16x32_bf16 v[108:111], v[204:207], v[196:199], v[108:111]
    v_mfma_f32_16x16x32_bf16 v[112:115], v[208:211], v[196:199], v[112:115]
    v_mfma_f32_16x16x32_bf16 v[116:119], v[212:215], v[196:199], v[116:119]
    v_mfma_f32_16x16x32_bf16 v[120:123], v[216:219], v[196:199], v[120:123]
    v_mfma_f32_16x16x32_bf16 v[124:127], v[220:223], v[196:199], v[124:127]
    v_mfma_f32_16x16x32_bf16 v[128:131], v[224:227], v[196:199], v[128:131]
    v_mfma_f32_16x16x32_bf16 v[132:135], v[228:231], v[196:199], v[132:135]
M_Qjoin:
    s_setprio 0
    s_lshl_b32 s60, s44, 12
    s_add_u32 s61, s60, 163840
    s_add_u32 s53, s60, 65536
    s_add_u32 s66, s50, s51
    s_and_b32 s66, s66, 3
    s_mov_b32 s58, 0xba897645
    s_mov_b32 s59, 0xfecd
    s_cmp_eq_u32 s66, 1
    s_cselect_b32 s58, 0xb9a87564, s58
    s_cselect_b32 s59, 0xfdec, s59
    s_cmp_eq_u32 s66, 2
    s_cselect_b32 s58, 0xab986754, s58
    s_cselect_b32 s59, 0xefdc, s59
    s_cmp_eq_u32 s66, 3
    s_cselect_b32 s58, 0xca978653, s58
    s_cselect_b32 s59, 0xfedb, s59
    s_cmp_eq_u32 s49, 0
    s_cselect_b32 s55, 16, 0
    s_mov_b32 s32, s16
    s_mov_b32 s33, s17
    s_mov_b32 s34, 0x700000
    s_mov_b32 s35, 0x20000
    s_lshr_b32 s62, s48, 2
    s_sub_u32 s62, s48, s62
    s_add_u32 s62, s62, 16
    s_lshl_b32 s70, s62, 12
    s_lshl_b32 s64, s47, 3
    s_lshl_b32 s65, s45, 2
    s_add_u32 s64, s64, s65
    s_mul_i32 s64, s64, 114688
    s_add_u32 s64, s64, s70
    s_lshl_b32 s65, s46, 11
    s_add_u32 s64, s64, s65
    s_add_u32 s64, s64, 0x1500000
    s_or_b32 s64, s64, s69
    v_lshl_add_u32 v198, v1, 4, s64
    v_mul_f32 v24, v8, v24
    v_exp_f32 v216, -v8
    v_mul_f32 v25, v9, v25
    v_exp_f32 v217, -v9
    v_mul_f32 v26, v10, v26
    v_exp_f32 v218, -v10
    v_mul_f32 v27, v11, v27
    v_exp_f32 v219, -v11
    v_mul_f32 v28, v12, v28
    v_exp_f32 v220, -v12
    v_mul_f32 v29, v13, v29
    v_exp_f32 v221, -v13
    v_mul_f32 v30, v14, v30
    v_exp_f32 v222, -v14
    v_mul_f32 v31, v15, v31
    v_exp_f32 v223, -v15
    v_fma_f32 v216, v216, s67, s67
    v_fma_f32 v217, v217, s67, s67
    v_rcp_f32 v216, v216
    v_fma_f32 v218, v218, s67, s67
    v_rcp_f32 v217, v217
    v_fma_f32 v219, v219, s67, s67
    v_rcp_f32 v218, v218
    v_fma_f32 v220, v220, s67, s67
    v_rcp_f32 v219, v219
    v_fma_f32 v221, v221, s67, s67
    v_rcp_f32 v220, v220
    v_fma_f32 v222, v222, s67, s67
    v_rcp_f32 v221, v221
    v_fma_f32 v223, v223, s67, s67
    s_mul_i32 s62, s49, 0
    s_mul_i32 s63, s49, 6
    s_barrier
    s_and_b32 s57, s58, 15
    s_lshr_b64 s[58:59], s[58:59], 4
    s_add_u32 s57, s57, s55
    s_lshl_b32 s56, s57, 11
    s_mul_i32 s57, s57, 0x20000
    s_add_u32 m0, s53, 16384
    s_nop 0
    buffer_load_dwordx4 v248, s[32:35], s57 offen offset:0 lds
    v_rcp_f32 v222, v222
    v_rcp_f32 v223, v223
    v_mul_f32 v24, v24, v216
    v_mul_f32 v25, v25, v217
    v_mul_f32 v26, v26, v218
    v_mul_f32 v27, v27, v219
    v_mul_f32 v28, v28, v220
    v_mul_f32 v29, v29, v221
    buffer_load_dwordx4 v249, s[32:35], s57 offen offset:1024 lds
    v_mul_f32 v30, v30, v222
    v_mul_f32 v31, v31, v223
    v_cvt_pk_bf16_f32 v200, v24, v25
    v_cvt_pk_bf16_f32 v201, v26, v27
    v_cvt_pk_bf16_f32 v202, v28, v29
    v_cvt_pk_bf16_f32 v203, v30, v31
    v_mul_f32 v32, v16, v32
    buffer_load_dwordx4 v250, s[32:35], s57 offen offset:2048 lds
    v_exp_f32 v224, -v16
    v_mul_f32 v33, v17, v33
    v_exp_f32 v225, -v17
    v_mul_f32 v34, v18, v34
    v_exp_f32 v226, -v18
    v_mul_f32 v35, v19, v35
    v_exp_f32 v227, -v19
    v_mul_f32 v36, v20, v36
    buffer_load_dwordx4 v251, s[32:35], s57 offen offset:3072 lds
    v_exp_f32 v228, -v20
    v_mul_f32 v37, v21, v37
    v_exp_f32 v229, -v21
    v_mul_f32 v38, v22, v38
    v_exp_f32 v230, -v22
    v_mul_f32 v39, v23, v39
    v_exp_f32 v231, -v23
    v_fma_f32 v224, v224, s67, s67
    s_mov_b32 m0, s53
    s_nop 0
    buffer_load_dwordx4 v246, s[28:31], s56 offen offset:0 lds
    v_fma_f32 v225, v225, s67, s67
    v_rcp_f32 v224, v224
    v_fma_f32 v226, v226, s67, s67
    v_rcp_f32 v225, v225
    v_fma_f32 v227, v227, s67, s67
    v_rcp_f32 v226, v226
    v_fma_f32 v228, v228, s67, s67
    v_rcp_f32 v227, v227
    buffer_load_dwordx4 v246, s[28:31], s56 offen offset:1024 lds
    v_fma_f32 v229, v229, s67, s67
    v_rcp_f32 v228, v228
    v_fma_f32 v230, v230, s67, s67
    v_rcp_f32 v229, v229
    v_fma_f32 v231, v231, s67, s67
    v_rcp_f32 v230, v230
    v_rcp_f32 v231, v231
    v_mul_f32 v32, v32, v224
    buffer_load_dwordx4 v247, s[28:31], s56 offen offset:2048 lds
    v_mul_f32 v33, v33, v225
    v_mul_f32 v34, v34, v226
    v_mul_f32 v35, v35, v227
    v_mul_f32 v36, v36, v228
    v_mul_f32 v37, v37, v229
    v_mul_f32 v38, v38, v230
    v_mul_f32 v39, v39, v231
    v_cvt_pk_bf16_f32 v204, v32, v33
    buffer_load_dwordx4 v247, s[28:31], s56 offen offset:3072 lds
    v_cvt_pk_bf16_f32 v205, v34, v35
    v_cvt_pk_bf16_f32 v206, v36, v37
    v_cvt_pk_bf16_f32 v207, v38, v39
    v_mul_f32 v56, v40, v56
    v_exp_f32 v216, -v40
    v_mul_f32 v57, v41, v57
    s_add_u32 s53, s53, 32768
    s_cmp_ge_u32 s53, s61
    s_cselect_b32 s53, s60, s53
    buffer_store_dwordx4 v[200:203], v198, s[28:31], 0 offen offset:0 sc1
    buffer_store_dwordx4 v[204:207], v198, s[28:31], 0 offen offset:1024 sc1
    v_add_u32 v198, 114688, v198
    s_barrier
    s_and_b32 s57, s58, 15
    s_lshr_b64 s[58:59], s[58:59], 4
    s_add_u32 s57, s57, s55
    s_lshl_b32 s56, s57, 11
    s_mul_i32 s57, s57, 0x20000
    s_add_u32 m0, s53, 16384
    s_nop 0
    buffer_load_dwordx4 v248, s[32:35], s57 offen offset:0 lds
    v_exp_f32 v217, -v41
    v_mul_f32 v58, v42, v58
    v_exp_f32 v218, -v42
    v_mul_f32 v59, v43, v59
    v_exp_f32 v219, -v43
    v_mul_f32 v60, v44, v60
    v_exp_f32 v220, -v44
    v_mul_f32 v61, v45, v61
    buffer_load_dwordx4 v249, s[32:35], s57 offen offset:1024 lds
    v_exp_f32 v221, -v45
    v_mul_f32 v62, v46, v62
    v_exp_f32 v222, -v46
    v_mul_f32 v63, v47, v63
    v_exp_f32 v223, -v47
    v_fma_f32 v216, v216, s67, s67
    v_fma_f32 v217, v217, s67, s67
    v_rcp_f32 v216, v216
    buffer_load_dwordx4 v250, s[32:35], s57 offen offset:2048 lds
    v_fma_f32 v218, v218, s67, s67
    v_rcp_f32 v217, v217
    v_fma_f32 v219, v219, s67, s67
    v_rcp_f32 v218, v218
    v_fma_f32 v220, v220, s67, s67
    v_rcp_f32 v219, v219
    v_fma_f32 v221, v221, s67, s67
    v_rcp_f32 v220, v220
    buffer_load_dwordx4 v251, s[32:35], s57 offen offset:3072 lds
    v_fma_f32 v222, v222, s67, s67
    v_rcp_f32 v221, v221
    v_fma_f32 v223, v223, s67, s67
    v_rcp_f32 v222, v222
    v_rcp_f32 v223, v223
    v_mul_f32 v56, v56, v216
    v_mul_f32 v57, v57, v217
    v_mul_f32 v58, v58, v218
    s_mov_b32 m0, s53
    s_nop 0
    buffer_load_dwordx4 v246, s[28:31], s56 offen offset:0 lds
    v_mul_f32 v59, v59, v219
    v_mul_f32 v60, v60, v220
    v_mul_f32 v61, v61, v221
    v_mul_f32 v62, v62, v222
    v_mul_f32 v63, v63, v223
    v_cvt_pk_bf16_f32 v208, v56, v57
    v_cvt_pk_bf16_f32 v209, v58, v59
    v_cvt_pk_bf16_f32 v210, v60, v61
    buffer_load_dwordx4 v246, s[28:31], s56 offen offset:1024 lds
    v_cvt_pk_bf16_f32 v211, v62, v63
    v_mul_f32 v64, v48, v64
    v_exp_f32 v224, -v48
    v_mul_f32 v65, v49, v65
    v_exp_f32 v225, -v49
    v_mul_f32 v66, v50, v66
    v_exp_f32 v226, -v50
    buffer_load_dwordx4 v247, s[28:31], s56 offen offset:2048 lds
    v_mul_f32 v67, v51, v67
    v_exp_f32 v227, -v51
    v_mul_f32 v68, v52, v68
    v_exp_f32 v228, -v52
    v_mul_f32 v69, v53, v69
    v_exp_f32 v229, -v53
    v_mul_f32 v70, v54, v70
    v_exp_f32 v230, -v54
    buffer_load_dwordx4 v247, s[28:31], s56 offen offset:3072 lds
    v_mul_f32 v71, v55, v71
    v_exp_f32 v231, -v55
    v_fma_f32 v224, v224, s67, s67
    v_fma_f32 v225, v225, s67, s67
    v_rcp_f32 v224, v224
    v_fma_f32 v226, v226, s67, s67
    v_rcp_f32 v225, v225
    v_fma_f32 v227, v227, s67, s67
    s_add_u32 s53, s53, 32768
    s_cmp_ge_u32 s53, s61
    s_cselect_b32 s53, s60, s53
    buffer_store_dwordx4 v[208:211], v198, s[28:31], 0 offen offset:0 sc1
    s_barrier
    s_and_b32 s57, s58, 15
    s_lshr_b64 s[58:59], s[58:59], 4
    s_add_u32 s57, s57, s55
    s_lshl_b32 s56, s57, 11
    s_mul_i32 s57, s57, 0x20000
    s_add_u32 m0, s53, 16384
    s_nop 0
    buffer_load_dwordx4 v248, s[32:35], s57 offen offset:0 lds
    v_rcp_f32 v226, v226
    v_fma_f32 v228, v228, s67, s67
    v_rcp_f32 v227, v227
    v_fma_f32 v229, v229, s67, s67
    v_rcp_f32 v228, v228
    v_fma_f32 v230, v230, s67, s67
    v_rcp_f32 v229, v229
    v_fma_f32 v231, v231, s67, s67
    buffer_load_dwordx4 v249, s[32:35], s57 offen offset:1024 lds
    v_rcp_f32 v230, v230
    v_rcp_f32 v231, v231
    v_mul_f32 v64, v64, v224
    v_mul_f32 v65, v65, v225
    v_mul_f32 v66, v66, v226
    v_mul_f32 v67, v67, v227
    v_mul_f32 v68, v68, v228
    v_mul_f32 v69, v69, v229
    buffer_load_dwordx4 v250, s[32:35], s57 offen offset:2048 lds
    v_mul_f32 v70, v70, v230
    v_mul_f32 v71, v71, v231
    v_cvt_pk_bf16_f32 v212, v64, v65
    v_cvt_pk_bf16_f32 v213, v66, v67
    v_cvt_pk_bf16_f32 v214, v68, v69
    v_cvt_pk_bf16_f32 v215, v70, v71
    buffer_load_dwordx4 v251, s[32:35], s57 offen offset:3072 lds
    v_mul_f32 v88, v72, v88
    v_exp_f32 v216, -v72
    v_mul_f32 v89, v73, v89
    v_exp_f32 v217, -v73
    v_mul_f32 v90, v74, v90
    v_exp_f32 v218, -v74
    v_mul_f32 v91, v75, v91
    v_exp_f32 v219, -v75
    s_mov_b32 m0, s53
    s_nop 0
    buffer_load_dwordx4 v246, s[28:31], s56 offen offset:0 lds
    v_mul_f32 v92, v76, v92
    v_exp_f32 v220, -v76
    v_mul_f32 v93, v77, v93
    v_exp_f32 v221, -v77
    v_mul_f32 v94, v78, v94
    v_exp_f32 v222, -v78
    v_mul_f32 v95, v79, v95
    v_exp_f32 v223, -v79
    buffer_load_dwordx4 v246, s[28:31], s56 offen offset:1024 lds
    v_fma_f32 v216, v216, s67, s67
    v_fma_f32 v217, v217, s67, s67
    v_rcp_f32 v216, v216
    v_fma_f32 v218, v218, s67, s67
    v_rcp_f32 v217, v217
    v_fma_f32 v219, v219, s67, s67
    v_rcp_f32 v218, v218
    v_fma_f32 v220, v220, s67, s67
    buffer_load_dwordx4 v247, s[28:31], s56 offen offset:2048 lds
    v_rcp_f32 v219, v219
    v_fma_f32 v221, v221, s67, s67
    v_rcp_f32 v220, v220
    v_fma_f32 v222, v222, s67, s67
    v_rcp_f32 v221, v221
    v_fma_f32 v223, v223, s67, s67
    v_rcp_f32 v222, v222
    v_rcp_f32 v223, v223
    buffer_load_dwordx4 v247, s[28:31], s56 offen offset:3072 lds
    v_mul_f32 v88, v88, v216
    v_mul_f32 v89, v89, v217
    v_mul_f32 v90, v90, v218
    v_mul_f32 v91, v91, v219
    v_mul_f32 v92, v92, v220
    v_mul_f32 v93, v93, v221
    v_mul_f32 v94, v94, v222
    v_mul_f32 v95, v95, v223
    s_add_u32 s53, s53, 32768
    s_cmp_ge_u32 s53, s61
    s_cselect_b32 s53, s60, s53
    buffer_store_dwordx4 v[212:215], v198, s[28:31], 0 offen offset:1024 sc1
    v_add_u32 v198, 114688, v198
    s_waitcnt vmcnt(20)
    s_barrier
    s_and_b32 s57, s58, 15
    s_lshr_b64 s[58:59], s[58:59], 4
    s_add_u32 s57, s57, s55
    s_lshl_b32 s56, s57, 11
    s_mul_i32 s57, s57, 0x20000
    s_add_u32 m0, s53, 16384
    s_nop 0
    buffer_load_dwordx4 v248, s[32:35], s57 offen offset:0 lds
    v_cvt_pk_bf16_f32 v200, v88, v89
    v_cvt_pk_bf16_f32 v201, v90, v91
    v_cvt_pk_bf16_f32 v202, v92, v93
    v_cvt_pk_bf16_f32 v203, v94, v95
    v_mul_f32 v96, v80, v96
    v_exp_f32 v224, -v80
    v_mul_f32 v97, v81, v97
    buffer_load_dwordx4 v249, s[32:35], s57 offen offset:1024 lds
    v_exp_f32 v225, -v81
    v_mul_f32 v98, v82, v98
    v_exp_f32 v226, -v82
    v_mul_f32 v99, v83, v99
    v_exp_f32 v227, -v83
    v_mul_f32 v100, v84, v100
    v_exp_f32 v228, -v84
    v_mul_f32 v101, v85, v101
    buffer_load_dwordx4 v250, s[32:35], s57 offen offset:2048 lds
    v_exp_f32 v229, -v85
    v_mul_f32 v102, v86, v102
    v_exp_f32 v230, -v86
    v_mul_f32 v103, v87, v103
    v_exp_f32 v231, -v87
    v_fma_f32 v224, v224, s67, s67
    v_fma_f32 v225, v225, s67, s67
    v_rcp_f32 v224, v224
    buffer_load_dwordx4 v251, s[32:35], s57 offen offset:3072 lds
    v_fma_f32 v226, v226, s67, s67
    v_rcp_f32 v225, v225
    v_fma_f32 v227, v227, s67, s67
    v_rcp_f32 v226, v226
    v_fma_f32 v228, v228, s67, s67
    v_rcp_f32 v227, v227
    v_fma_f32 v229, v229, s67, s67
    v_rcp_f32 v228, v228
    s_mov_b32 m0, s53
    s_nop 0
    buffer_load_dwordx4 v246, s[28:31], s56 offen offset:0 lds
    v_fma_f32 v230, v230, s67, s67
    v_rcp_f32 v229, v229
    v_fma_f32 v231, v231, s67, s67
    v_rcp_f32 v230, v230
    v_rcp_f32 v231, v231
    v_mul_f32 v96, v96, v224
    v_mul_f32 v97, v97, v225
    v_mul_f32 v98, v98, v226
    buffer_load_dwordx4 v246, s[28:31], s56 offen offset:1024 lds
    v_mul_f32 v99, v99, v227
    v_mul_f32 v100, v100, v228
    v_mul_f32 v101, v101, v229
    v_mul_f32 v102, v102, v230
    v_mul_f32 v103, v103, v231
    v_cvt_pk_bf16_f32 v204, v96, v97
    v_cvt_pk_bf16_f32 v205, v98, v99
    v_cvt_pk_bf16_f32 v206, v100, v101
    buffer_load_dwordx4 v247, s[28:31], s56 offen offset:2048 lds
    v_cvt_pk_bf16_f32 v207, v102, v103
    v_mul_f32 v120, v104, v120
    v_exp_f32 v216, -v104
    v_mul_f32 v121, v105, v121
    v_exp_f32 v217, -v105
    v_mul_f32 v122, v106, v122
    buffer_load_dwordx4 v247, s[28:31], s56 offen offset:3072 lds
    v_exp_f32 v218, -v106
    v_mul_f32 v123, v107, v123
    v_exp_f32 v219, -v107
    v_mul_f32 v124, v108, v124
    v_exp_f32 v220, -v108
    v_mul_f32 v125, v109, v125
    v_exp_f32 v221, -v109
    v_mul_f32 v126, v110, v126
    s_add_u32 s53, s53, 32768
    s_cmp_ge_u32 s53, s61
    s_cselect_b32 s53, s60, s53
    buffer_store_dwordx4 v[200:203], v198, s[28:31], 0 offen offset:0 sc1
    buffer_store_dwordx4 v[204:207], v198, s[28:31], 0 offen offset:1024 sc1
    v_add_u32 v198, 114688, v198
    s_waitcnt vmcnt(20)
    s_barrier
    s_and_b32 s57, s58, 15
    s_lshr_b64 s[58:59], s[58:59], 4
    s_add_u32 s57, s57, s55
    s_lshl_b32 s56, s57, 11
    s_mul_i32 s57, s57, 0x20000
    s_add_u32 m0, s53, 16384
    s_nop 0
    buffer_load_dwordx4 v248, s[32:35], s57 offen offset:0 lds
    v_exp_f32 v222, -v110
    v_mul_f32 v127, v111, v127
    v_exp_f32 v223, -v111
    v_fma_f32 v216, v216, s67, s67
    v_fma_f32 v217, v217, s67, s67
    v_rcp_f32 v216, v216
    v_fma_f32 v218, v218, s67, s67
    v_rcp_f32 v217, v217
    buffer_load_dwordx4 v249, s[32:35], s57 offen offset:1024 lds
    v_fma_f32 v219, v219, s67, s67
    v_rcp_f32 v218, v218
    v_fma_f32 v220, v220, s67, s67
    v_rcp_f32 v219, v219
    v_fma_f32 v221, v221, s67, s67
    v_rcp_f32 v220, v220
    v_fma_f32 v222, v222, s67, s67
    v_rcp_f32 v221, v221
    buffer_load_dwordx4 v250, s[32:35], s57 offen offset:2048 lds
    v_fma_f32 v223, v223, s67, s67
    v_rcp_f32 v222, v222
    v_rcp_f32 v223, v223
    v_mul_f32 v120, v120, v216
    v_mul_f32 v121, v121, v217
    v_mul_f32 v122, v122, v218
    v_mul_f32 v123, v123, v219
    v_mul_f32 v124, v124, v220
    buffer_load_dwordx4 v251, s[32:35], s57 offen offset:3072 lds
    v_mul_f32 v125, v125, v221
    v_mul_f32 v126, v126, v222
    v_mul_f32 v127, v127, v223
    v_cvt_pk_bf16_f32 v208, v120, v121
    v_cvt_pk_bf16_f32 v209, v122, v123
    v_cvt_pk_bf16_f32 v210, v124, v125
    v_cvt_pk_bf16_f32 v211, v126, v127
    s_mov_b32 m0, s53
    s_nop 0
    buffer_load_dwordx4 v246, s[28:31], s56 offen offset:0 lds
    v_mul_f32 v128, v112, v128
    v_exp_f32 v224, -v112
    v_mul_f32 v129, v113, v129
    v_exp_f32 v225, -v113
    v_mul_f32 v130, v114, v130
    v_exp_f32 v226, -v114
    v_mul_f32 v131, v115, v131
    v_exp_f32 v227, -v115
    buffer_load_dwordx4 v246, s[28:31], s56 offen offset:1024 lds
    v_mul_f32 v132, v116, v132
    v_exp_f32 v228, -v116
    v_mul_f32 v133, v117, v133
    v_exp_f32 v229, -v117
    v_mul_f32 v134, v118, v134
    v_exp_f32 v230, -v118
    v_mul_f32 v135, v119, v135
    v_exp_f32 v231, -v119
    buffer_load_dwordx4 v247, s[28:31], s56 offen offset:2048 lds
    v_fma_f32 v224, v224, s67, s67
    v_fma_f32 v225, v225, s67, s67
    v_rcp_f32 v224, v224
    v_fma_f32 v226, v226, s67, s67
    v_rcp_f32 v225, v225
    v_fma_f32 v227, v227, s67, s67
    v_rcp_f32 v226, v226
    v_fma_f32 v228, v228, s67, s67
    buffer_load_dwordx4 v247, s[28:31], s56 offen offset:3072 lds
    v_rcp_f32 v227, v227
    v_fma_f32 v229, v229, s67, s67
    v_rcp_f32 v228, v228
    v_fma_f32 v230, v230, s67, s67
    v_rcp_f32 v229, v229
    v_fma_f32 v231, v231, s67, s67
    v_rcp_f32 v230, v230
    v_rcp_f32 v231, v231
    s_add_u32 s53, s53, 32768
    s_cmp_ge_u32 s53, s61
    s_cselect_b32 s53, s60, s53
    buffer_store_dwordx4 v[208:211], v198, s[28:31], 0 offen offset:0 sc1
    s_waitcnt vmcnt(20)
    s_barrier
    s_and_b32 s57, s58, 15
    s_lshr_b64 s[58:59], s[58:59], 4
    s_add_u32 s57, s57, s55
    s_lshl_b32 s56, s57, 11
    s_mul_i32 s57, s57, 0x20000
    s_add_u32 m0, s53, 16384
    s_nop 0
    buffer_load_dwordx4 v248, s[32:35], s57 offen offset:0 lds
    v_mul_f32 v128, v128, v224
    v_mul_f32 v129, v129, v225
    v_mul_f32 v130, v130, v226
    v_mul_f32 v131, v131, v227
    v_mul_f32 v132, v132, v228
    v_mul_f32 v133, v133, v229
    v_mul_f32 v134, v134, v230
    v_mul_f32 v135, v135, v231
    buffer_load_dwordx4 v249, s[32:35], s57 offen offset:1024 lds
    v_cvt_pk_bf16_f32 v212, v128, v129
    v_cvt_pk_bf16_f32 v213, v130, v131
    v_cvt_pk_bf16_f32 v214, v132, v133
    v_cvt_pk_bf16_f32 v215, v134, v135
    buffer_load_dwordx4 v250, s[32:35], s57 offen offset:2048 lds
    buffer_load_dwordx4 v251, s[32:35], s57 offen offset:3072 lds
    s_mov_b32 m0, s53
    s_nop 0
    buffer_load_dwordx4 v246, s[28:31], s56 offen offset:0 lds
    buffer_load_dwordx4 v246, s[28:31], s56 offen offset:1024 lds
    buffer_load_dwordx4 v247, s[28:31], s56 offen offset:2048 lds
    buffer_load_dwordx4 v247, s[28:31], s56 offen offset:3072 lds
    s_add_u32 s53, s53, 32768
    s_cmp_ge_u32 s53, s61
    s_cselect_b32 s53, s60, s53
    buffer_store_dwordx4 v[212:215], v198, s[28:31], 0 offen offset:1024 sc1
    s_waitcnt vmcnt(20)
    s_barrier
    s_and_b32 s57, s58, 15
    s_lshr_b64 s[58:59], s[58:59], 4
    s_add_u32 s57, s57, s55
    s_lshl_b32 s56, s57, 11
    s_mul_i32 s57, s57, 0x20000
    s_add_u32 m0, s53, 16384
    s_nop 0
    buffer_load_dwordx4 v248, s[32:35], s57 offen offset:0 lds
    buffer_load_dwordx4 v249, s[32:35], s57 offen offset:1024 lds
    buffer_load_dwordx4 v250, s[32:35], s57 offen offset:2048 lds
    buffer_load_dwordx4 v251, s[32:35], s57 offen offset:3072 lds
    s_mov_b32 m0, s53
    s_nop 0
    buffer_load_dwordx4 v246, s[28:31], s56 offen offset:0 lds
    buffer_load_dwordx4 v246, s[28:31], s56 offen offset:1024 lds
    buffer_load_dwordx4 v247, s[28:31], s56 offen offset:2048 lds
    buffer_load_dwordx4 v247, s[28:31], s56 offen offset:3072 lds
    s_add_u32 s53, s53, 32768
    s_cmp_ge_u32 s53, s61
    s_cselect_b32 s53, s60, s53
    s_lshl_b32 s64, s47, 8
    s_lshl_b32 s65, s48, 4
    s_add_u32 s64, s64, s65
    s_lshl_b32 s65, s44, 2
    s_add_u32 s64, s64, s65
    s_add_u32 s64, s64, 0x52000
    v_mov_b32 v2, s0
    s_waitcnt vmcnt(8)
    s_mov_b64 exec, 1
    buffer_store_dword v2, v234, s[28:31], s64 offen sc1
    s_mov_b64 exec, -1
    s_movk_i32 s54, 1
M_Q_loop5:
    s_barrier
    s_and_b32 s57, s58, 15
    s_lshr_b64 s[58:59], s[58:59], 4
    s_add_u32 s57, s57, s55
    s_lshl_b32 s56, s57, 11
    s_mul_i32 s57, s57, 0x20000
    s_add_u32 m0, s53, 16384
    s_nop 0
    buffer_load_dwordx4 v248, s[32:35], s57 offen offset:0 lds
    buffer_load_dwordx4 v249, s[32:35], s57 offen offset:1024 lds
    buffer_load_dwordx4 v250, s[32:35], s57 offen offset:2048 lds
    buffer_load_dwordx4 v251, s[32:35], s57 offen offset:3072 lds
    s_mov_b32 m0, s53
    s_nop 0
    buffer_load_dwordx4 v246, s[28:31], s56 offen offset:0 lds
    buffer_load_dwordx4 v246, s[28:31], s56 offen offset:1024 lds
    buffer_load_dwordx4 v247, s[28:31], s56 offen offset:2048 lds
    buffer_load_dwordx4 v247, s[28:31], s56 offen offset:3072 lds
    s_add_u32 s53, s53, 32768
    s_cmp_ge_u32 s53, s61
    s_cselect_b32 s53, s60, s53
    s_sub_u32 s54, s54, 1
    s_cbranch_scc0 M_Q_loop5
    s_waitcnt vmcnt(17)
    s_barrier
    s_and_b32 s57, s58, 15
    s_lshr_b64 s[58:59], s[58:59], 4
    s_add_u32 s57, s57, s55
    s_lshl_b32 s56, s57, 11
    s_mul_i32 s57, s57, 0x20000
    s_add_u32 m0, s53, 16384
    s_nop 0
    buffer_load_dwordx4 v248, s[32:35], s57 offen offset:0 lds
    buffer_load_dwordx4 v249, s[32:35], s57 offen offset:1024 lds
    buffer_load_dwordx4 v250, s[32:35], s57 offen offset:2048 lds
    buffer_load_dwordx4 v251, s[32:35], s57 offen offset:3072 lds
    s_mov_b32 m0, s53
    s_nop 0
    buffer_load_dwordx4 v246, s[28:31], s56 offen offset:0 lds
    buffer_load_dwordx4 v246, s[28:31], s56 offen offset:1024 lds
    buffer_load_dwordx4 v247, s[28:31], s56 offen offset:2048 lds
    buffer_load_dwordx4 v247, s[28:31], s56 offen offset:3072 lds
    s_add_u32 s53, s53, 32768
    s_cmp_ge_u32 s53, s61
    s_cselect_b32 s53, s60, s53
    s_waitcnt vmcnt(16)
    s_barrier
    s_and_b32 s57, s58, 15
    s_lshr_b64 s[58:59], s[58:59], 4
    s_add_u32 s57, s57, s55
    s_lshl_b32 s56, s57, 11
    s_mul_i32 s57, s57, 0x20000
    s_add_u32 m0, s53, 16384
    s_nop 0
    buffer_load_dwordx4 v248, s[32:35], s57 offen offset:0 lds
    buffer_load_dwordx4 v249, s[32:35], s57 offen offset:1024 lds
    buffer_load_dwordx4 v250, s[32:35], s57 offen offset:2048 lds
    buffer_load_dwordx4 v251, s[32:35], s57 offen offset:3072 lds
    s_mov_b32 m0, s53
    s_nop 0
    buffer_load_dwordx4 v246, s[28:31], s56 offen offset:0 lds
    buffer_load_dwordx4 v246, s[28:31], s56 offen offset:1024 lds
    buffer_load_dwordx4 v247, s[28:31], s56 offen offset:2048 lds
    buffer_load_dwordx4 v247, s[28:31], s56 offen offset:3072 lds
    s_add_u32 s53, s53, 32768
    s_cmp_ge_u32 s53, s61
    s_cselect_b32 s53, s60, s53
    s_waitcnt vmcnt(16)
    s_barrier
    s_lshl_b32 s68, s50, 8
    s_add_u32 s68, s68, 0x52000
    buffer_load_dword v245, v234, s[28:31], s68 offen sc1
    s_and_b32 s57, s58, 15
    s_lshr_b64 s[58:59], s[58:59], 4
    s_add_u32 s57, s57, s55
    s_lshl_b32 s56, s57, 11
    s_mul_i32 s57, s57, 0x20000
    s_add_u32 m0, s53, 16384
    s_nop 0
    buffer_load_dwordx4 v248, s[32:35], s57 offen offset:0 lds
    buffer_load_dwordx4 v249, s[32:35], s57 offen offset:1024 lds
    buffer_load_dwordx4 v250, s[32:35], s57 offen offset:2048 lds
    buffer_load_dwordx4 v251, s[32:35], s57 offen offset:3072 lds
    s_mov_b32 m0, s53
    s_nop 0
    buffer_load_dwordx4 v246, s[28:31], s56 offen offset:0 lds
    buffer_load_dwordx4 v246, s[28:31], s56 offen offset:1024 lds
    buffer_load_dwordx4 v247, s[28:31], s56 offen offset:2048 lds
    buffer_load_dwordx4 v247, s[28:31], s56 offen offset:3072 lds
    s_add_u32 s53, s53, 32768
    s_cmp_ge_u32 s53, s61
    s_cselect_b32 s53, s60, s53
    s_waitcnt vmcnt(17)
    s_barrier
    s_waitcnt vmcnt(8)
    s_mov_b32 s3, 0x4000
M_pb_chk:
    v_cmp_ne_u32 vcc, s0, v245
    s_nop 4
    s_cbranch_vccz M_pb_ok
    s_sub_u32 s3, s3, 1
    s_cbranch_scc1 M_pb_ok
    s_sleep 4
    s_cmp_eq_u32 s69, 0
    s_cbranch_scc1 M_pb_rl
    s_sleep 48
M_pb_rl:
    buffer_load_dword v245, v234, s[28:31], s68 offen sc1
    s_waitcnt vmcnt(0)
    s_branch M_pb_chk
M_pb_ok:
    s_add_u32 s66, s50, s51
    s_and_b32 s66, s66, 3
    s_mov_b32 s58, 0x76453201
    s_mov_b32 s59, 0xecdba89
    s_cmp_eq_u32 s66, 1
    s_cselect_b32 s58, 0x75643120, s58
    s_cselect_b32 s59, 0xdecb9a8, s59
    s_cmp_eq_u32 s66, 2
    s_cselect_b32 s58, 0x67542310, s58
    s_cselect_b32 s59, 0xedcab98, s59
    s_cmp_eq_u32 s66, 3
    s_cselect_b32 s58, 0x86534210, s58
    s_cselect_b32 s59, 0xedbca97, s59
    s_mov_b32 s56, 0x76453201
    s_mov_b32 s57, 0x8
    s_cmp_eq_u32 s66, 1
    s_cselect_b32 s56, 0x75643120, s56
    s_cselect_b32 s57, 0x8, s57
    s_cmp_eq_u32 s66, 2
    s_cselect_b32 s56, 0x67542310, s56
    s_cselect_b32 s57, 0x8, s57
    s_cmp_eq_u32 s66, 3
    s_cselect_b32 s56, 0x86534210, s56
    s_cselect_b32 s57, 0x7, s57
    s_cmp_eq_u32 s49, 0
    s_cselect_b64 s[58:59], s[56:57], s[58:59]
    s_cselect_b32 s55, 47, 32
    s_and_b32 s57, s58, 15
    s_lshr_b64 s[58:59], s[58:59], 4
    s_add_u32 s57, s57, s55
    s_lshl_b32 s56, s57, 11
    s_mul_i32 s57, s57, 0x20000
    s_add_u32 m0, s53, 16384
    s_nop 0
    buffer_load_dwordx4 v248, s[32:35], s57 offen offset:0 lds
    buffer_load_dwordx4 v249, s[32:35], s57 offen offset:1024 lds
    buffer_load_dwordx4 v250, s[32:35], s57 offen offset:2048 lds
    buffer_load_dwordx4 v251, s[32:35], s57 offen offset:3072 lds
    s_mov_b32 m0, s53
    s_nop 0
    buffer_load_dwordx4 v246, s[28:31], s56 offen offset:0 lds
    buffer_load_dwordx4 v246, s[28:31], s56 offen offset:1024 lds
    buffer_load_dwordx4 v247, s[28:31], s56 offen offset:2048 lds
    buffer_load_dwordx4 v247, s[28:31], s56 offen offset:3072 lds
    s_add_u32 s53, s53, 32768
    s_cmp_ge_u32 s53, s61
    s_cselect_b32 s53, s60, s53
    s_barrier
    s_and_b32 s57, s58, 15
    s_lshr_b64 s[58:59], s[58:59], 4
    s_add_u32 s57, s57, s55
    s_lshl_b32 s56, s57, 11
    s_mul_i32 s57, s57, 0x20000
    s_add_u32 m0, s53, 16384
    s_nop 0
    buffer_load_dwordx4 v248, s[32:35], s57 offen offset:0 lds
    buffer_load_dwordx4 v249, s[32:35], s57 offen offset:1024 lds
    buffer_load_dwordx4 v250, s[32:35], s57 offen offset:2048 lds
    buffer_load_dwordx4 v251, s[32:35], s57 offen offset:3072 lds
    s_mov_b32 m0, s53
    s_nop 0
    buffer_load_dwordx4 v246, s[28:31], s56 offen offset:0 lds
    buffer_load_dwordx4 v246, s[28:31], s56 offen offset:1024 lds
    buffer_load_dwordx4 v247, s[28:31], s56 offen offset:2048 lds
    buffer_load_dwordx4 v247, s[28:31], s56 offen offset:3072 lds
    s_add_u32 s53, s53, 32768
    s_cmp_ge_u32 s53, s61
    s_cselect_b32 s53, s60, s53
    s_add_u32 s54, s63, 6
M_Q_loop6:
    s_waitcnt vmcnt(16)
    s_barrier
    s_and_b32 s57, s58, 15
    s_lshr_b64 s[58:59], s[58:59], 4
    s_add_u32 s57, s57, s55
    s_lshl_b32 s56, s57, 11
    s_mul_i32 s57, s57, 0x20000
    s_add_u32 m0, s53, 16384
    s_nop 0
    buffer_load_dwordx4 v248, s[32:35], s57 offen offset:0 lds
    buffer_load_dwordx4 v249, s[32:35], s57 offen offset:1024 lds
    buffer_load_dwordx4 v250, s[32:35], s57 offen offset:2048 lds
    buffer_load_dwordx4 v251, s[32:35], s57 offen offset:3072 lds
    s_mov_b32 m0, s53
    s_nop 0
    buffer_load_dwordx4 v246, s[28:31], s56 offen offset:0 lds
    buffer_load_dwordx4 v246, s[28:31], s56 offen offset:1024 lds
    buffer_load_dwordx4 v247, s[28:31], s56 offen offset:2048 lds
    buffer_load_dwordx4 v247, s[28:31], s56 offen offset:3072 lds
    s_add_u32 s53, s53, 32768
    s_cmp_ge_u32 s53, s61
    s_cselect_b32 s53, s60, s53
    s_sub_u32 s54, s54, 1
    s_cbranch_scc0 M_Q_loop6
    s_waitcnt vmcnt(16)
    s_barrier
    s_waitcnt vmcnt(8)
    s_barrier
    s_waitcnt vmcnt(0)
    s_barrier
    s_branch M_fin
M_Qidle:
    s_waitcnt vmcnt(0)
    s_barrier
    v_and_b32 v2, 255, v0
    s_and_b32 s64, s2, 63
    s_lshl_b32 s64, s64, 8
    v_add_lshl_u32 v243, v2, s64, 6
    s_mov_b32 s40, s16
    s_mov_b32 s41, s17
    s_mov_b32 s42, 0x100000
    s_mov_b32 s43, 0x20000
    s_mov_b32 s64, 0x0
    buffer_load_dword v244, v243, s[40:43], s64 offen
    s_waitcnt vmcnt(0)
    s_mov_b32 s40, s16
    s_mov_b32 s41, s17
    s_mov_b32 s42, 0x200000
    s_mov_b32 s43, 0x20000
    s_mov_b32 s64, 0x100000
    buffer_load_dword v244, v243, s[40:43], s64 offen
    s_waitcnt vmcnt(0)
    s_mov_b32 s40, s16
    s_mov_b32 s41, s17
    s_mov_b32 s42, 0x300000
    s_mov_b32 s43, 0x20000
    s_mov_b32 s64, 0x200000
    buffer_load_dword v244, v243, s[40:43], s64 offen
    s_waitcnt vmcnt(0)
    s_mov_b32 s40, s16
    s_mov_b32 s41, s17
    s_mov_b32 s42, 0x400000
    s_mov_b32 s43, 0x20000
    s_mov_b32 s64, 0x300000
    buffer_load_dword v244, v243, s[40:43], s64 offen
    s_waitcnt vmcnt(0)
    s_mov_b32 s40, s16
    s_mov_b32 s41, s17
    s_mov_b32 s42, 0x500000
    s_mov_b32 s43, 0x20000
    s_mov_b32 s64, 0x400000
    buffer_load_dword v244, v243, s[40:43], s64 offen
    s_waitcnt vmcnt(0)
    s_mov_b32 s40, s16
    s_mov_b32 s41, s17
    s_mov_b32 s42, 0x600000
    s_mov_b32 s43, 0x20000
    s_mov_b32 s64, 0x500000
    buffer_load_dword v244, v243, s[40:43], s64 offen
    s_waitcnt vmcnt(0)
    s_mov_b32 s40, s16
    s_mov_b32 s41, s17
    s_mov_b32 s42, 0x700000
    s_mov_b32 s43, 0x20000
    s_mov_b32 s64, 0x600000
    buffer_load_dword v244, v243, s[40:43], s64 offen
    s_waitcnt vmcnt(0)
    s_waitcnt vmcnt(0)
    s_barrier
    s_barrier
    s_barrier
    s_branch M_Qjoin
M_fin:
M_end:
    s_endpgm

.section .rodata,"a"
.p2align 6
.amdhsa_kernel adaLN_cond__sliding_local_dilated__glu_gated_swiglu__prompt_kernel
  .amdhsa_next_free_vgpr 252
  .amdhsa_next_free_sgpr 102
  .amdhsa_accum_offset 252
  .amdhsa_group_segment_fixed_size 0
  .amdhsa_kernarg_size 96
  .amdhsa_user_sgpr_count 2
  .amdhsa_user_sgpr_kernarg_segment_ptr 1
  .amdhsa_system_sgpr_workgroup_id_x 1
  .amdhsa_float_denorm_mode_32 3
.end_amdhsa_kernel
```

```asm
; @launch grid=(256,1,1) block=(512,1,1) lds=163840
.amdgcn_target "amdgcn-amd-amdhsa--gfx950"
.text
.globl adaLN_cond__sliding_local_dilated__glu_gated_swiglu__prompt_kernel
.p2align 8
.type adaLN_cond__sliding_local_dilated__glu_gated_swiglu__prompt_kernel,@function
adaLN_cond__sliding_local_dilated__glu_gated_swiglu__prompt_kernel:
    s_cmp_ge_u32 s2, 256
    s_cbranch_scc1 M_end
    s_load_dwordx16 s[4:19], s[0:1], 0
    s_load_dwordx8 s[20:27], s[0:1], 64
    v_lshrrev_b32 v2, 6, v0
    v_and_b32 v1, 63, v0
    v_readfirstlane_b32 s44, v2
    s_and_b32 s47, s2, 1
    s_lshl_b32 s47, s47, 3
    s_bfe_u32 s64, s2, 0x30003
    s_add_u32 s47, s47, s64
    s_and_b32 s48, s2, 6
    s_lshl_b32 s48, s48, 1
    s_lshr_b32 s64, s2, 6
    s_add_u32 s48, s48, s64
    s_getpc_b64 s[28:29]
M_pc:
    s_lshr_b32 s64, s2, 3
    s_lshl_b32 s64, s64, 3
    s_add_u32 s64, s64, s44
    s_lshl_b32 s64, s64, 8
    v_lshl_add_u32 v2, v1, 7, s64
    v_min_u32 v2, M_end-M_pc, v2
    s_mov_b64 exec, 3
    global_load_dword v244, v2, s[28:29]
    s_mov_b64 exec, -1
    s_cmp_ge_u32 s44, 4
    s_cbranch_scc1 M_Q
    s_lshr_b32 s70, s47, 1
    s_lshl_b32 s70, s70, 7
    s_and_b32 s71, s47, 1
    s_lshl_b32 s71, s71, 4
    s_add_u32 s71, s71, s48
    s_lshl_b32 s71, s71, 7
    v_lshrrev_b32 v48, 3, v0
    v_add_u32 v48, s70, v48
    v_lshlrev_b32 v9, 1, v48
    s_movk_i32 s64, 12288
    v_mul_lo_u32 v48, s64, v48
    v_and_b32 v8, 7, v0
    v_lshl_add_u32 v48, v8, 4, v48
    v_add_u32 v8, s71, v48
    s_waitcnt lgkmcnt(0)
    s_load_dword s0, s[26:27], 0
    s_mov_b32 s40, s18
    s_mov_b32 s41, s19
    s_mov_b32 s42, 0x800
    s_mov_b32 s43, 0x20000
    s_mov_b32 s36, s20
    s_mov_b32 s37, s21
    s_mov_b32 s38, 0xc00000
    s_mov_b32 s39, 0x20000
    s_barrier
    buffer_load_ushort v20, v9, s[40:43], 0 offen offset:0
    buffer_load_ushort v21, v9, s[40:43], 0 offen offset:64
    buffer_load_ushort v22, v9, s[40:43], 0 offen offset:128
    buffer_load_ushort v23, v9, s[40:43], 0 offen offset:192
    s_mov_b32 s64, 0x0
    buffer_load_dwordx4 v[24:27], v8, s[36:39], s64 offen
    s_mov_b32 s64, 0x60000
    buffer_load_dwordx4 v[28:31], v8, s[36:39], s64 offen
    s_mov_b32 s64, 0xc0000
    buffer_load_dwordx4 v[32:35], v8, s[36:39], s64 offen
    s_mov_b32 s64, 0x120000
    buffer_load_dwordx4 v[36:39], v8, s[36:39], s64 offen
    s_mov_b32 s28, s26
    s_mov_b32 s29, s27
    s_mov_b32 s30, 0x3000000
    s_mov_b32 s31, 0x20000
    s_lshl_b32 s64, s48, 13
    s_add_u32 s64, s64, 0x20000
    s_lshl_b32 s65, s47, 9
    s_add_u32 s62, s64, s65
    s_lshl_b32 s65, s44, 9
    s_add_u32 s64, s64, s65
    v_lshl_add_u32 v16, v1, 3, s64
    s_lshr_b32 s45, s44, 1
    s_and_b32 s46, s44, 1
    s_bfe_u32 s49, s2, 0x10003
    s_and_b32 s50, s2, 3
    s_lshl_b32 s50, s50, 2
    s_bfe_u32 s64, s2, 0x20004
    s_add_u32 s50, s50, s64
    s_and_b32 s51, s2, 4
    s_lshr_b32 s64, s2, 6
    s_add_u32 s51, s51, s64
    s_cmp_ge_u32 s2, 192
    s_cselect_b32 s69, 0x80000000, 0
    s_mov_b32 s67, 0x40053526
    v_lshlrev_b32 v234, 2, v1
    s_mov_b32 s52, 0
    s_lshl_b32 s64, s45, 13
    v_lshl_add_u32 v233, v1, 4, s64
    v_lshrrev_b32 v3, 4, v1
    v_bfe_u32 v2, v1, 2, 2
    v_lshl_add_u32 v4, v3, 3, v2
    v_mul_u32_u24 v4, 384, v4
    v_and_b32 v5, 3, v1
    v_lshl_add_u32 v4, v5, 3, v4
    v_add_u32 v4, 18432, v4
    v_bfe_u32 v2, v1, 3, 2
    s_lshl_b32 s64, s46, 1
    v_xor_b32 v2, s64, v2
    v_lshl_add_u32 v239, v2, 5, v4
    v_xor_b32 v2, 1, v2
    v_lshl_add_u32 v240, v2, 5, v4
    v_and_b32 v2, 15, v1
    v_lshlrev_b32 v3, 2, v3
    v_sub_u32 v3, v2, v3
    s_mov_b32 s64, 0x80000001
    v_sub_u32 v4, -2, v3
    v_and_b32 v4, s64, v4
    v_cmp_eq_u32 s[72:73], 0, v4
    v_subrev_u32 v4, 0, v3
    v_and_b32 v4, s64, v4
    v_cmp_eq_u32 s[80:81], 0, v4
    v_sub_u32 v4, -1, v3
    v_and_b32 v4, s64, v4
    v_cmp_eq_u32 s[74:75], 0, v4
    v_subrev_u32 v4, 1, v3
    v_and_b32 v4, s64, v4
    v_cmp_eq_u32 s[82:83], 0, v4
    v_sub_u32 v4, 0, v3
    v_and_b32 v4, s64, v4
    v_cmp_eq_u32 s[76:77], 0, v4
    v_subrev_u32 v4, 2, v3
    v_and_b32 v4, s64, v4
    v_cmp_eq_u32 s[84:85], 0, v4
    v_sub_u32 v4, 1, v3
    v_and_b32 v4, s64, v4
    v_cmp_eq_u32 s[78:79], 0, v4
    v_subrev_u32 v4, 3, v3
    v_and_b32 v4, s64, v4
    v_cmp_eq_u32 s[86:87], 0, v4
    s_lshl_b32 s64, s47, 1
    s_add_u32 s64, s64, s45
    s_cmp_eq_u32 s64, 0
    s_cselect_b64 s[88:89], 0, s[72:73]
    s_cselect_b64 s[90:91], 0, s[74:75]
    s_cselect_b64 s[92:93], 0, s[76:77]
    s_cselect_b64 s[94:95], 0, s[78:79]
    s_mul_i32 s64, s64, 131072
    s_lshl_b32 s65, s48, 11
    s_add_u32 s64, s64, s65
    s_lshl_b32 s65, s46, 10
    s_add_u32 s64, s64, s65
    s_add_u32 s64, s64, 0x600000
    v_lshl_add_u32 v237, v1, 4, s64
    s_lshl_b32 s64, s2, 8
    v_add_lshl_u32 v243, v0, s64, 5
    s_lshl_b32 s64, s47, 3
    s_lshl_b32 s65, s44, 1
    s_add_u32 s64, s64, s65
    s_mul_i32 s64, s64, 32768
    s_add_u32 s64, s64, 0x600000
    v_lshl_add_u32 v208, v1, 4, s64
    v_add_u32 v209, 30720, v208
    v_lshrrev_b32 v3, 3, v1
    s_lshl_b32 s64, s44, 4
    v_add_lshl_u32 v2, v3, s64, 11
    s_lshl_b32 s64, s48, 7
    v_add_u32 v2, s64, v2
    v_and_b32 v3, 6, v3
    v_and_b32 v4, 7, v1
    v_xor_b32 v3, v3, v4
    v_lshl_add_u32 v210, v3, 4, v2
    v_add_u32 v211, 15360, v210
    s_lshl_b32 s65, s48, 8
    v_lshrrev_b32 v3, 4, v1
    s_lshl_b32 s64, s44, 4
    v_add_u32 v2, s64, v3
    s_movk_i32 s64, 7168
    v_mul_u32_u24 v2, s64, v2
    v_add_u32 v2, s65, v2
    v_lshlrev_b32 v3, 1, v3
    v_and_b32 v4, 15, v1
    v_xor_b32 v3, v3, v4
    v_lshl_add_u32 v212, v3, 4, v2
    v_add_u32 v214, 55296, v212
    v_xor_b32 v3, 8, v3
    v_lshl_add_u32 v213, v3, 4, v2
    v_add_u32 v213, 27648, v213
    v_add_u32 v215, 55296, v213
    v_add_u32 v232, s52, v233
    v_add_u32 v235, s52, v239
    v_add_u32 v236, s52, v240
    s_lshl_b32 s60, s44, 12
    s_add_u32 s61, s60, 147456
    s_add_u32 s53, s60, 49152
    s_lshl_b32 s70, s44, 11
    s_sub_u32 s70, 16384, s70
    s_bfe_u32 s66, s2, 0x30003
    s_lshr_b32 s55, s2, 6
    s_add_u32 s66, s66, s55
    s_and_b32 s66, s66, 3
    s_mov_b32 s58, 0x76453210
    s_mov_b32 s59, 0xfecdba89
    s_cmp_eq_u32 s66, 1
    s_cselect_b32 s58, 0x75643120, s58
    s_cselect_b32 s59, 0xfdecb9a8, s59
    s_cmp_eq_u32 s66, 2
    s_cselect_b32 s58, 0x67542310, s58
    s_cselect_b32 s59, 0xefdcab98, s59
    s_cmp_eq_u32 s66, 3
    s_cselect_b32 s58, 0x86534210, s58
    s_cselect_b32 s59, 0xfedbca97, s59
    s_mov_b32 s32, s8
    s_mov_b32 s33, s9
    s_mov_b32 s34, 0x200000
    s_mov_b32 s35, 0x20000
    s_waitcnt lgkmcnt(0)
    s_add_u32 s0, s0, 1
    s_setprio 2
    s_barrier
    s_waitcnt vmcnt(4)
    v_lshlrev_b32 v20, 16, v20
    v_lshlrev_b32 v21, 16, v21
    v_lshlrev_b32 v22, 16, v22
    v_lshlrev_b32 v23, 16, v23
    v_mul_f32 v48, 0xbfb8aa3b, v20
    v_mul_f32 v49, 0xbfb8aa3b, v21
    v_mul_f32 v50, 0xbfb8aa3b, v22
    v_mul_f32 v51, 0xbfb8aa3b, v23
    v_exp_f32 v48, v48
    v_exp_f32 v49, v49
    v_exp_f32 v50, v50
    v_exp_f32 v51, v51
    v_add_f32 v48, 1.0, v48
    v_add_f32 v49, 1.0, v49
    v_add_f32 v50, 1.0, v50
    v_add_f32 v51, 1.0, v51
    v_rcp_f32 v48, v48
    v_rcp_f32 v49, v49
    v_rcp_f32 v50, v50
    v_rcp_f32 v51, v51
    v_mul_f32 v20, v20, v48
    v_mul_f32 v21, v21, v49
    v_mul_f32 v22, v22, v50
    v_mul_f32 v23, v23, v51
    v_cvt_pk_bf16_f32 v48, v20, v20
    v_lshlrev_b32 v20, 16, v48
    v_cvt_pk_bf16_f32 v49, v21, v21
    v_lshlrev_b32 v21, 16, v49
    v_cvt_pk_bf16_f32 v50, v22, v22
    v_lshlrev_b32 v22, 16, v50
    v_cvt_pk_bf16_f32 v51, v23, v23
    v_lshlrev_b32 v23, 16, v51
    s_waitcnt vmcnt(3)
    v_lshlrev_b32 v48, 16, v24
    v_and_b32 v49, 0xffff0000, v24
    v_lshlrev_b32 v50, 16, v25
    v_and_b32 v51, 0xffff0000, v25
    v_lshlrev_b32 v52, 16, v26
    v_and_b32 v53, 0xffff0000, v26
    v_lshlrev_b32 v54, 16, v27
    v_and_b32 v55, 0xffff0000, v27
    v_mul_f32 v40, v20, v48
    v_mul_f32 v41, v20, v49
    v_mul_f32 v42, v20, v50
    v_mul_f32 v43, v20, v51
    v_mul_f32 v44, v20, v52
    v_mul_f32 v45, v20, v53
    v_mul_f32 v46, v20, v54
    v_mul_f32 v47, v20, v55
    s_waitcnt vmcnt(2)
    v_lshlrev_b32 v48, 16, v28
    v_and_b32 v49, 0xffff0000, v28
    v_lshlrev_b32 v50, 16, v29
    v_and_b32 v51, 0xffff0000, v29
    v_lshlrev_b32 v52, 16, v30
    v_and_b32 v53, 0xffff0000, v30
    v_lshlrev_b32 v54, 16, v31
    v_and_b32 v55, 0xffff0000, v31
    v_fmac_f32 v40, v21, v48
    v_fmac_f32 v41, v21, v49
    v_fmac_f32 v42, v21, v50
    v_fmac_f32 v43, v21, v51
    v_fmac_f32 v44, v21, v52
    v_fmac_f32 v45, v21, v53
    v_fmac_f32 v46, v21, v54
    v_fmac_f32 v47, v21, v55
    s_waitcnt vmcnt(1)
    v_lshlrev_b32 v48, 16, v32
    v_and_b32 v49, 0xffff0000, v32
    v_lshlrev_b32 v50, 16, v33
    v_and_b32 v51, 0xffff0000, v33
    v_lshlrev_b32 v52, 16, v34
    v_and_b32 v53, 0xffff0000, v34
    v_lshlrev_b32 v54, 16, v35
    v_and_b32 v55, 0xffff0000, v35
    v_fmac_f32 v40, v22, v48
    v_fmac_f32 v41, v22, v49
    v_fmac_f32 v42, v22, v50
    v_fmac_f32 v43, v22, v51
    v_fmac_f32 v44, v22, v52
    v_fmac_f32 v45, v22, v53
    v_fmac_f32 v46, v22, v54
    v_fmac_f32 v47, v22, v55
    s_waitcnt vmcnt(0)
    v_lshlrev_b32 v48, 16, v36
    v_and_b32 v49, 0xffff0000, v36
    v_lshlrev_b32 v50, 16, v37
    v_and_b32 v51, 0xffff0000, v37
    v_lshlrev_b32 v52, 16, v38
    v_and_b32 v53, 0xffff0000, v38
    v_lshlrev_b32 v54, 16, v39
    v_and_b32 v55, 0xffff0000, v39
    v_fmac_f32 v40, v23, v48
    v_fmac_f32 v41, v23, v49
    v_fmac_f32 v42, v23, v50
    v_fmac_f32 v43, v23, v51
    v_fmac_f32 v44, v23, v52
    v_fmac_f32 v45, v23, v53
    v_fmac_f32 v46, v23, v54
    v_fmac_f32 v47, v23, v55
    v_add_f32_dpp v40, v40, v40 row_ror:8 row_mask:0xf bank_mask:0xf
    v_add_f32_dpp v41, v41, v41 row_ror:8 row_mask:0xf bank_mask:0xf
    v_add_f32_dpp v42, v42, v42 row_ror:8 row_mask:0xf bank_mask:0xf
    v_add_f32_dpp v43, v43, v43 row_ror:8 row_mask:0xf bank_mask:0xf
    v_add_f32_dpp v44, v44, v44 row_ror:8 row_mask:0xf bank_mask:0xf
    v_add_f32_dpp v45, v45, v45 row_ror:8 row_mask:0xf bank_mask:0xf
    v_add_f32_dpp v46, v46, v46 row_ror:8 row_mask:0xf bank_mask:0xf
    v_add_f32_dpp v47, v47, v47 row_ror:8 row_mask:0xf bank_mask:0xf
    v_mov_b32 v48, v40
    v_mov_b32 v49, v41
    v_mov_b32 v50, v42
    v_mov_b32 v51, v43
    v_mov_b32 v52, v44
    v_mov_b32 v53, v45
    v_mov_b32 v54, v46
    v_mov_b32 v55, v47
    v_permlane32_swap_b32 v40, v48
    v_permlane32_swap_b32 v41, v49
    v_permlane32_swap_b32 v42, v50
    v_permlane32_swap_b32 v43, v51
    v_permlane32_swap_b32 v44, v52
    v_permlane32_swap_b32 v45, v53
    v_permlane32_swap_b32 v46, v54
    v_permlane32_swap_b32 v47, v55
    v_add_f32 v40, v40, v48
    v_add_f32 v41, v41, v49
    v_add_f32 v42, v42, v50
    v_add_f32 v43, v43, v51
    v_add_f32 v44, v44, v52
    v_add_f32 v45, v45, v53
    v_add_f32 v46, v46, v54
    v_add_f32 v47, v47, v55
    v_mov_b32 v48, v40
    v_mov_b32 v49, v41
    v_mov_b32 v50, v42
    v_mov_b32 v51, v43
    v_mov_b32 v52, v44
    v_mov_b32 v53, v45
    v_mov_b32 v54, v46
    v_mov_b32 v55, v47
    v_permlane16_swap_b32 v40, v48
    v_permlane16_swap_b32 v41, v49
    v_permlane16_swap_b32 v42, v50
    v_permlane16_swap_b32 v43, v51
    v_permlane16_swap_b32 v44, v52
    v_permlane16_swap_b32 v45, v53
    v_permlane16_swap_b32 v46, v54
    v_permlane16_swap_b32 v47, v55
    v_add_f32 v40, v40, v48
    v_add_f32 v41, v41, v49
    v_add_f32 v42, v42, v50
    v_add_f32 v43, v43, v51
    v_add_f32 v44, v44, v52
    v_add_f32 v45, v45, v53
    v_add_f32 v46, v46, v54
    v_add_f32 v47, v47, v55
    s_lshl_b32 s64, s44, 8
    s_add_u32 s64, s64, 147456
    v_and_b32 v48, 7, v0
    v_lshl_add_u32 v48, v48, 5, s64
    ds_write_b128 v48, v[40:43]
    ds_write_b128 v48, v[44:47] offset:16
    v_mov_b32 v49, 148492
    v_mov_b32 v50, 1
    s_waitcnt lgkmcnt(0)
    s_mov_b64 exec, 1
    ds_add_rtn_u32 v51, v49, v50
    s_mov_b64 exec, -1
    v_add_u32 v49, 147456, v234
    s_waitcnt lgkmcnt(0)
    ds_read_b32 v40, v49 offset:0
    ds_read_b32 v41, v49 offset:256
    ds_read_b32 v42, v49 offset:512
    ds_read_b32 v43, v49 offset:768
    v_readfirstlane_b32 s64, v51
    s_nop 3
    s_cmp_eq_u32 s64, 3
    s_cselect_b32 s62, s62, 0x80000000
    v_lshl_add_u32 v48, v1, 3, s62
    s_waitcnt lgkmcnt(0)
    v_add_f32 v40, v40, v41
    v_add_f32 v42, v42, v43
    v_add_f32 v40, v40, v42
    v_mov_b32 v41, s0
    buffer_store_dwordx2 v[40:41], v48, s[28:31], 0 offen sc1
    s_cmp_ge_u32 s44, 2
    s_cbranch_scc1 M_spf
    s_movk_i32 s63, 4096
    buffer_load_dwordx2 v[88:89], v16, s[28:31], 0 offen offset:0 sc1
    buffer_load_dwordx2 v[90:91], v16, s[28:31], 0 offen offset:1024 sc1
    buffer_load_dwordx2 v[92:93], v16, s[28:31], 0 offen offset:2048 sc1
    buffer_load_dwordx2 v[94:95], v16, s[28:31], 0 offen offset:3072 sc1
    buffer_load_dwordx2 v[96:97], v16, s[28:31], s63 offen offset:0 sc1
    buffer_load_dwordx2 v[98:99], v16, s[28:31], s63 offen offset:1024 sc1
    buffer_load_dwordx2 v[100:101], v16, s[28:31], s63 offen offset:2048 sc1
    buffer_load_dwordx2 v[102:103], v16, s[28:31], s63 offen offset:3072 sc1
    s_waitcnt vmcnt(0)
    s_mov_b32 s3, 0x40000
M_pt_chk:
    v_xor_b32 v48, s0, v89
    v_xor_b32 v49, s0, v91
    v_xor_b32 v50, s0, v93
    v_xor_b32 v51, s0, v95
    v_xor_b32 v52, s0, v97
    v_xor_b32 v53, s0, v99
    v_xor_b32 v54, s0, v101
    v_xor_b32 v55, s0, v103
    v_or3_b32 v48, v48, v49, v50
    v_or3_b32 v48, v48, v51, v52
    v_or3_b32 v48, v48, v53, v54
    v_or_b32 v48, v48, v55
    v_cmp_ne_u32 vcc, 0, v48
    s_nop 4
    s_cbranch_vccz M_pt_ok
    s_sub_u32 s3, s3, 1
    s_cbranch_scc1 M_pt_ok
    v_cmp_ne_u32 vcc, s0, v89
    s_nop 4
    s_mov_b64 exec, vcc
    buffer_load_dwordx2 v[88:89], v16, s[28:31], 0 offen offset:0 sc1
    s_mov_b64 exec, -1
    v_cmp_ne_u32 vcc, s0, v91
    s_nop 4
    s_mov_b64 exec, vcc
    buffer_load_dwordx2 v[90:91], v16, s[28:31], 0 offen offset:1024 sc1
    s_mov_b64 exec, -1
    v_cmp_ne_u32 vcc, s0, v93
    s_nop 4
    s_mov_b64 exec, vcc
    buffer_load_dwordx2 v[92:93], v16, s[28:31], 0 offen offset:2048 sc1
    s_mov_b64 exec, -1
    v_cmp_ne_u32 vcc, s0, v95
    s_nop 4
    s_mov_b64 exec, vcc
    buffer_load_dwordx2 v[94:95], v16, s[28:31], 0 offen offset:3072 sc1
    s_mov_b64 exec, -1
    v_cmp_ne_u32 vcc, s0, v97
    s_nop 4
    s_mov_b64 exec, vcc
    buffer_load_dwordx2 v[96:97], v16, s[28:31], s63 offen offset:0 sc1
    s_mov_b64 exec, -1
    v_cmp_ne_u32 vcc, s0, v99
    s_nop 4
    s_mov_b64 exec, vcc
    buffer_load_dwordx2 v[98:99], v16, s[28:31], s63 offen offset:1024 sc1
    s_mov_b64 exec, -1
    v_cmp_ne_u32 vcc, s0, v101
    s_nop 4
    s_mov_b64 exec, vcc
    buffer_load_dwordx2 v[100:101], v16, s[28:31], s63 offen offset:2048 sc1
    s_mov_b64 exec, -1
    v_cmp_ne_u32 vcc, s0, v103
    s_nop 4
    s_mov_b64 exec, vcc
    buffer_load_dwordx2 v[102:103], v16, s[28:31], s63 offen offset:3072 sc1
    s_mov_b64 exec, -1
    s_waitcnt vmcnt(0)
    s_branch M_pt_chk
M_pt_ok:
    v_add_f32 v88, v88, v90
    v_add_f32 v92, v92, v94
    v_add_f32 v96, v96, v98
    v_add_f32 v100, v100, v102
    v_add_f32 v88, v88, v92
    v_add_f32 v96, v96, v100
    v_add_f32 v88, v88, v96
    v_cvt_pk_bf16_f32 v89, v88, v88
    v_lshlrev_b32 v88, 16, v89
    s_cmp_eq_u32 s44, 1
    s_cselect_b32 s64, 1.0, 0
    v_add_f32 v88, s64, v88
    v_cvt_pk_bf16_f32 v89, v88, v88
    v_lshlrev_b32 v88, 16, v89
    s_lshl_b32 s64, s44, 8
    s_add_u32 s64, s64, 149504
    v_add_u32 v2, s64, v234
    ds_write_b32 v2, v88
    s_waitcnt lgkmcnt(0)
    s_branch M_tbl
M_spf:
    s_lshl_b32 s64, s2, 1
    s_add_u32 s64, s64, s46
    s_mul_i32 s65, s64, 12288
    s_add_u32 s56, s6, s65
    s_addc_u32 s57, s7, 0
    s_load_dword s99, s[56:57], 384
    s_load_dword s99, s[56:57], 448
    s_load_dword s99, s[56:57], 1408
    s_load_dword s99, s[56:57], 1472
    s_load_dword s99, s[56:57], 2432
    s_load_dword s99, s[56:57], 2496
    s_load_dword s99, s[56:57], 3456
    s_load_dword s99, s[56:57], 3520
    s_load_dword s99, s[56:57], 4480
    s_load_dword s99, s[56:57], 4544
    s_load_dword s99, s[56:57], 5504
    s_load_dword s99, s[56:57], 5568
    s_load_dword s99, s[56:57], 6528
    s_load_dword s99, s[56:57], 6592
    s_load_dword s99, s[56:57], 7552
    s_load_dword s99, s[56:57], 7616
    s_load_dword s99, s[56:57], 8576
    s_load_dword s99, s[56:57], 8640
    s_load_dword s99, s[56:57], 9600
    s_load_dword s99, s[56:57], 9664
    s_load_dword s99, s[56:57], 10624
    s_load_dword s99, s[56:57], 10688
    s_load_dword s99, s[56:57], 11648
    s_load_dword s99, s[56:57], 11712
M_tbl:
    s_barrier
    s_or_b32 s64, s2, s44
    s_cmp_eq_u32 s64, 0
    s_cselect_b32 s64, 0, 0x80000000
    v_mov_b32 v2, s64
    v_mov_b32 v3, s0
    s_barrier
    ds_read_b128 v[120:123], v232 offset:0
    ds_read_b64_tr_b16 v[148:149], v235 offset:128
    ds_read_b64_tr_b16 v[150:151], v235 offset:1664
    ds_read_b64_tr_b16 v[152:153], v236 offset:128
    ds_read_b64_tr_b16 v[154:155], v236 offset:1664
    ds_read_b64_tr_b16 v[156:157], v235 offset:256
    ds_read_b64_tr_b16 v[158:159], v235 offset:1792
    ds_read_b64_tr_b16 v[160:161], v236 offset:256
    ds_read_b64_tr_b16 v[162:163], v236 offset:1792
    ds_read_b128 v[124:127], v232 offset:2048
    ds_read_b64_tr_b16 v[140:141], v235 offset:0
    ds_read_b64_tr_b16 v[142:143], v235 offset:1536
    ds_read_b64_tr_b16 v[144:145], v236 offset:0
    ds_read_b64_tr_b16 v[146:147], v236 offset:1536
    ds_read_b128 v[128:131], v232 offset:4096
    ds_read_b128 v[132:135], v232 offset:6144
    ds_read_b128 v[136:139], v232 offset:8192
    s_add_u32 s52, s52, 49152
    s_cmp_ge_u32 s52, 147456
    s_cselect_b32 s52, 0, s52
    s_waitcnt lgkmcnt(0)
    v_mfma_f32_16x16x32_bf16 v[40:43], v[148:151], v[120:123], 0
    ds_read_b128 v[164:167], v232 offset:1024
    v_mfma_f32_16x16x32_bf16 v[44:47], v[152:155], v[120:123], 0
    ds_read_b64_tr_b16 v[192:193], v235 offset:12416
    v_mfma_f32_16x16x32_bf16 v[80:83], v[120:123], v[156:159], 0
    ds_read_b64_tr_b16 v[194:195], v235 offset:13952
    v_mfma_f32_16x16x32_bf16 v[84:87], v[120:123], v[160:163], 0
    ds_read_b64_tr_b16 v[196:197], v236 offset:12416
    v_mfma_f32_16x16x32_bf16 v[48:51], v[148:151], v[124:127], 0
    ds_read_b64_tr_b16 v[198:199], v236 offset:13952
    v_mfma_f32_16x16x32_bf16 v[52:55], v[152:155], v[124:127], 0
    v_mfma_f32_16x16x32_bf16 v[88:91], v[124:127], v[156:159], 0
    ds_read_b64_tr_b16 v[200:201], v235 offset:12544
    v_mfma_f32_16x16x32_bf16 v[92:95], v[124:127], v[160:163], 0
    ds_read_b64_tr_b16 v[202:203], v235 offset:14080
    v_mfma_f32_16x16x32_bf16 v[8:11], v[140:143], v[124:127], 0
    ds_read_b64_tr_b16 v[204:205], v236 offset:12544
    v_mfma_f32_16x16x32_bf16 v[12:15], v[144:147], v[124:127], 0
    ds_read_b64_tr_b16 v[206:207], v236 offset:14080
    v_mfma_f32_16x16x32_bf16 v[56:59], v[148:151], v[128:131], 0
    v_mfma_f32_16x16x32_bf16 v[60:63], v[152:155], v[128:131], 0
    ds_read_b128 v[168:171], v232 offset:3072
    v_mfma_f32_16x16x32_bf16 v[96:99], v[128:131], v[156:159], 0
    ds_read_b64_tr_b16 v[184:185], v235 offset:12288
    v_mfma_f32_16x16x32_bf16 v[100:103], v[128:131], v[160:163], 0
    ds_read_b64_tr_b16 v[186:187], v235 offset:13824
    v_mfma_f32_16x16x32_bf16 v[16:19], v[140:143], v[128:131], 0
    ds_read_b64_tr_b16 v[188:189], v236 offset:12288
    v_mfma_f32_16x16x32_bf16 v[20:23], v[144:147], v[128:131], 0
    v_mfma_f32_16x16x32_bf16 v[64:67], v[148:151], v[132:135], 0
    ds_read_b64_tr_b16 v[190:191], v236 offset:13824
    v_mfma_f32_16x16x32_bf16 v[68:71], v[152:155], v[132:135], 0
    ds_read_b128 v[172:175], v232 offset:5120
    v_mfma_f32_16x16x32_bf16 v[104:107], v[132:135], v[156:159], 0
    ds_read_b128 v[176:179], v232 offset:7168
    v_mfma_f32_16x16x32_bf16 v[108:111], v[132:135], v[160:163], 0
    ds_read_b128 v[180:183], v232 offset:9216
    v_mfma_f32_16x16x32_bf16 v[24:27], v[140:143], v[132:135], 0
    v_mfma_f32_16x16x32_bf16 v[28:31], v[144:147], v[132:135], 0
    v_add_u32 v232, s52, v233
    v_mfma_f32_16x16x32_bf16 v[72:75], v[148:151], v[136:139], 0
    v_mfma_f32_16x16x32_bf16 v[76:79], v[152:155], v[136:139], 0
    v_add_u32 v235, s52, v239
    v_mfma_f32_16x16x32_bf16 v[112:115], v[136:139], v[156:159], 0
    v_mfma_f32_16x16x32_bf16 v[116:119], v[136:139], v[160:163], 0
    v_add_u32 v236, s52, v240
    v_mfma_f32_16x16x32_bf16 v[32:35], v[140:143], v[136:139], 0
    v_mfma_f32_16x16x32_bf16 v[36:39], v[144:147], v[136:139], 0
    s_waitcnt lgkmcnt(0)
    v_mfma_f32_16x16x32_bf16 v[40:43], v[192:195], v[164:167], v[40:43]
    v_mfma_f32_16x16x32_bf16 v[44:47], v[196:199], v[164:167], v[44:47]
    v_mfma_f32_16x16x32_bf16 v[80:83], v[164:167], v[200:203], v[80:83]
    v_mfma_f32_16x16x32_bf16 v[84:87], v[164:167], v[204:207], v[84:87]
    v_mfma_f32_16x16x32_bf16 v[48:51], v[192:195], v[168:171], v[48:51]
    v_mfma_f32_16x16x32_bf16 v[52:55], v[196:199], v[168:171], v[52:55]
    v_mfma_f32_16x16x32_bf16 v[88:91], v[168:171], v[200:203], v[88:91]
    v_mfma_f32_16x16x32_bf16 v[92:95], v[168:171], v[204:207], v[92:95]
    v_mfma_f32_16x16x32_bf16 v[8:11], v[184:187], v[168:171], v[8:11]
    v_mfma_f32_16x16x32_bf16 v[12:15], v[188:191], v[168:171], v[12:15]
    v_mfma_f32_16x16x32_bf16 v[56:59], v[192:195], v[172:175], v[56:59]
    v_mfma_f32_16x16x32_bf16 v[60:63], v[196:199], v[172:175], v[60:63]
    v_mfma_f32_16x16x32_bf16 v[96:99], v[172:175], v[200:203], v[96:99]
    v_mfma_f32_16x16x32_bf16 v[100:103], v[172:175], v[204:207], v[100:103]
    v_mfma_f32_16x16x32_bf16 v[16:19], v[184:187], v[172:175], v[16:19]
    v_mfma_f32_16x16x32_bf16 v[20:23], v[188:191], v[172:175], v[20:23]
    v_mfma_f32_16x16x32_bf16 v[64:67], v[192:195], v[176:179], v[64:67]
    v_mfma_f32_16x16x32_bf16 v[68:71], v[196:199], v[176:179], v[68:71]
    v_mfma_f32_16x16x32_bf16 v[104:107], v[176:179], v[200:203], v[104:107]
    v_mfma_f32_16x16x32_bf16 v[108:111], v[176:179], v[204:207], v[108:111]
    v_mfma_f32_16x16x32_bf16 v[24:27], v[184:187], v[176:179], v[24:27]
    v_mfma_f32_16x16x32_bf16 v[28:31], v[188:191], v[176:179], v[28:31]
    v_mfma_f32_16x16x32_bf16 v[72:75], v[192:195], v[180:183], v[72:75]
    v_mfma_f32_16x16x32_bf16 v[76:79], v[196:199], v[180:183], v[76:79]
    v_mfma_f32_16x16x32_bf16 v[112:115], v[180:183], v[200:203], v[112:115]
    v_mfma_f32_16x16x32_bf16 v[116:119], v[180:183], v[204:207], v[116:119]
    v_mfma_f32_16x16x32_bf16 v[32:35], v[184:187], v[180:183], v[32:35]
    v_mfma_f32_16x16x32_bf16 v[36:39], v[188:191], v[180:183], v[36:39]
    s_barrier
    s_mov_b64 exec, 1
    buffer_store_dword v3, v2, s[28:31], 0 offen sc1
    s_mov_b64 exec, -1
    s_barrier
    ds_read_b128 v[120:123], v232 offset:0
    ds_read_b64_tr_b16 v[148:149], v235 offset:128
    ds_read_b64_tr_b16 v[150:151], v235 offset:1664
    ds_read_b64_tr_b16 v[152:153], v236 offset:128
    ds_read_b64_tr_b16 v[154:155], v236 offset:1664
    ds_read_b64_tr_b16 v[156:157], v235 offset:256
    ds_read_b64_tr_b16 v[158:159], v235 offset:1792
    ds_read_b64_tr_b16 v[160:161], v236 offset:256
    ds_read_b64_tr_b16 v[162:163], v236 offset:1792
    ds_read_b128 v[124:127], v232 offset:2048
    ds_read_b64_tr_b16 v[140:141], v235 offset:0
    ds_read_b64_tr_b16 v[142:143], v235 offset:1536
    ds_read_b64_tr_b16 v[144:145], v236 offset:0
    ds_read_b64_tr_b16 v[146:147], v236 offset:1536
    ds_read_b128 v[128:131], v232 offset:4096
    ds_read_b128 v[132:135], v232 offset:6144
    ds_read_b128 v[136:139], v232 offset:8192
    s_add_u32 s52, s52, 49152
    s_cmp_ge_u32 s52, 147456
    s_cselect_b32 s52, 0, s52
    s_waitcnt lgkmcnt(0)
    v_mfma_f32_16x16x32_bf16 v[40:43], v[148:151], v[120:123], v[40:43]
    ds_read_b128 v[164:167], v232 offset:1024
    v_mfma_f32_16x16x32_bf16 v[44:47], v[152:155], v[120:123], v[44:47]
    ds_read_b64_tr_b16 v[192:193], v235 offset:12416
    v_mfma_f32_16x16x32_bf16 v[80:83], v[120:123], v[156:159], v[80:83]
    ds_read_b64_tr_b16 v[194:195], v235 offset:13952
    v_mfma_f32_16x16x32_bf16 v[84:87], v[120:123], v[160:163], v[84:87]
    ds_read_b64_tr_b16 v[196:197], v236 offset:12416
    v_mfma_f32_16x16x32_bf16 v[48:51], v[148:151], v[124:127], v[48:51]
    ds_read_b64_tr_b16 v[198:199], v236 offset:13952
    v_mfma_f32_16x16x32_bf16 v[52:55], v[152:155], v[124:127], v[52:55]
    v_mfma_f32_16x16x32_bf16 v[88:91], v[124:127], v[156:159], v[88:91]
    ds_read_b64_tr_b16 v[200:201], v235 offset:12544
    v_mfma_f32_16x16x32_bf16 v[92:95], v[124:127], v[160:163], v[92:95]
    ds_read_b64_tr_b16 v[202:203], v235 offset:14080
    v_mfma_f32_16x16x32_bf16 v[8:11], v[140:143], v[124:127], v[8:11]
    ds_read_b64_tr_b16 v[204:205], v236 offset:12544
    v_mfma_f32_16x16x32_bf16 v[12:15], v[144:147], v[124:127], v[12:15]
    ds_read_b64_tr_b16 v[206:207], v236 offset:14080
    v_mfma_f32_16x16x32_bf16 v[56:59], v[148:151], v[128:131], v[56:59]
    v_mfma_f32_16x16x32_bf16 v[60:63], v[152:155], v[128:131], v[60:63]
    ds_read_b128 v[168:171], v232 offset:3072
    v_mfma_f32_16x16x32_bf16 v[96:99], v[128:131], v[156:159], v[96:99]
    ds_read_b64_tr_b16 v[184:185], v235 offset:12288
    v_mfma_f32_16x16x32_bf16 v[100:103], v[128:131], v[160:163], v[100:103]
    ds_read_b64_tr_b16 v[186:187], v235 offset:13824
    v_mfma_f32_16x16x32_bf16 v[16:19], v[140:143], v[128:131], v[16:19]
    s_movk_i32 s54, 13
M_P_loop0:
    ds_read_b64_tr_b16 v[188:189], v236 offset:12288
    v_mfma_f32_16x16x32_bf16 v[20:23], v[144:147], v[128:131], v[20:23]
    v_mfma_f32_16x16x32_bf16 v[64:67], v[148:151], v[132:135], v[64:67]
    ds_read_b64_tr_b16 v[190:191], v236 offset:13824
    v_mfma_f32_16x16x32_bf16 v[68:71], v[152:155], v[132:135], v[68:71]
    ds_read_b128 v[172:175], v232 offset:5120
    v_mfma_f32_16x16x32_bf16 v[104:107], v[132:135], v[156:159], v[104:107]
    ds_read_b128 v[176:179], v232 offset:7168
    v_mfma_f32_16x16x32_bf16 v[108:111], v[132:135], v[160:163], v[108:111]
    ds_read_b128 v[180:183], v232 offset:9216
    v_mfma_f32_16x16x32_bf16 v[24:27], v[140:143], v[132:135], v[24:27]
    v_mfma_f32_16x16x32_bf16 v[28:31], v[144:147], v[132:135], v[28:31]
    v_add_u32 v232, s52, v233
    v_mfma_f32_16x16x32_bf16 v[72:75], v[148:151], v[136:139], v[72:75]
    v_mfma_f32_16x16x32_bf16 v[76:79], v[152:155], v[136:139], v[76:79]
    v_add_u32 v235, s52, v239
    v_mfma_f32_16x16x32_bf16 v[112:115], v[136:139], v[156:159], v[112:115]
    v_mfma_f32_16x16x32_bf16 v[116:119], v[136:139], v[160:163], v[116:119]
    v_add_u32 v236, s52, v240
    v_mfma_f32_16x16x32_bf16 v[32:35], v[140:143], v[136:139], v[32:35]
    v_mfma_f32_16x16x32_bf16 v[36:39], v[144:147], v[136:139], v[36:39]
    s_waitcnt lgkmcnt(0)
    v_mfma_f32_16x16x32_bf16 v[40:43], v[192:195], v[164:167], v[40:43]
    s_barrier
    v_mfma_f32_16x16x32_bf16 v[44:47], v[196:199], v[164:167], v[44:47]
    ds_read_b128 v[120:123], v232 offset:0
    v_mfma_f32_16x16x32_bf16 v[80:83], v[164:167], v[200:203], v[80:83]
    ds_read_b64_tr_b16 v[148:149], v235 offset:128
    v_mfma_f32_16x16x32_bf16 v[84:87], v[164:167], v[204:207], v[84:87]
    ds_read_b64_tr_b16 v[150:151], v235 offset:1664
    v_mfma_f32_16x16x32_bf16 v[48:51], v[192:195], v[168:171], v[48:51]
    ds_read_b64_tr_b16 v[152:153], v236 offset:128
    v_mfma_f32_16x16x32_bf16 v[52:55], v[196:199], v[168:171], v[52:55]
    ds_read_b64_tr_b16 v[154:155], v236 offset:1664
    v_mfma_f32_16x16x32_bf16 v[88:91], v[168:171], v[200:203], v[88:91]
    ds_read_b64_tr_b16 v[156:157], v235 offset:256
    v_mfma_f32_16x16x32_bf16 v[92:95], v[168:171], v[204:207], v[92:95]
    v_mfma_f32_16x16x32_bf16 v[8:11], v[184:187], v[168:171], v[8:11]
    ds_read_b64_tr_b16 v[158:159], v235 offset:1792
    v_mfma_f32_16x16x32_bf16 v[12:15], v[188:191], v[168:171], v[12:15]
    ds_read_b64_tr_b16 v[160:161], v236 offset:256
    v_mfma_f32_16x16x32_bf16 v[56:59], v[192:195], v[172:175], v[56:59]
    ds_read_b64_tr_b16 v[162:163], v236 offset:1792
    v_mfma_f32_16x16x32_bf16 v[60:63], v[196:199], v[172:175], v[60:63]
    ds_read_b128 v[124:127], v232 offset:2048
    v_mfma_f32_16x16x32_bf16 v[96:99], v[172:175], v[200:203], v[96:99]
    ds_read_b64_tr_b16 v[140:141], v235 offset:0
    v_mfma_f32_16x16x32_bf16 v[100:103], v[172:175], v[204:207], v[100:103]
    ds_read_b64_tr_b16 v[142:143], v235 offset:1536
    v_mfma_f32_16x16x32_bf16 v[16:19], v[184:187], v[172:175], v[16:19]
    v_mfma_f32_16x16x32_bf16 v[20:23], v[188:191], v[172:175], v[20:23]
    ds_read_b64_tr_b16 v[144:145], v236 offset:0
    v_mfma_f32_16x16x32_bf16 v[64:67], v[192:195], v[176:179], v[64:67]
    ds_read_b64_tr_b16 v[146:147], v236 offset:1536
    v_mfma_f32_16x16x32_bf16 v[68:71], v[196:199], v[176:179], v[68:71]
    ds_read_b128 v[128:131], v232 offset:4096
    v_mfma_f32_16x16x32_bf16 v[104:107], v[176:179], v[200:203], v[104:107]
    ds_read_b128 v[132:135], v232 offset:6144
    v_mfma_f32_16x16x32_bf16 v[108:111], v[176:179], v[204:207], v[108:111]
    ds_read_b128 v[136:139], v232 offset:8192
    v_mfma_f32_16x16x32_bf16 v[24:27], v[184:187], v[176:179], v[24:27]
    v_mfma_f32_16x16x32_bf16 v[28:31], v[188:191], v[176:179], v[28:31]
    v_mfma_f32_16x16x32_bf16 v[72:75], v[192:195], v[180:183], v[72:75]
    v_mfma_f32_16x16x32_bf16 v[76:79], v[196:199], v[180:183], v[76:79]
    v_mfma_f32_16x16x32_bf16 v[112:115], v[180:183], v[200:203], v[112:115]
    v_mfma_f32_16x16x32_bf16 v[116:119], v[180:183], v[204:207], v[116:119]
    v_mfma_f32_16x16x32_bf16 v[32:35], v[184:187], v[180:183], v[32:35]
    s_add_u32 s52, s52, 49152
    s_cmp_ge_u32 s52, 147456
    s_cselect_b32 s52, 0, s52
    v_mfma_f32_16x16x32_bf16 v[36:39], v[188:191], v[180:183], v[36:39]
    s_waitcnt lgkmcnt(0)
    v_mfma_f32_16x16x32_bf16 v[40:43], v[148:151], v[120:123], v[40:43]
    ds_read_b128 v[164:167], v232 offset:1024
    v_mfma_f32_16x16x32_bf16 v[44:47], v[152:155], v[120:123], v[44:47]
    ds_read_b64_tr_b16 v[192:193], v235 offset:12416
    v_mfma_f32_16x16x32_bf16 v[80:83], v[120:123], v[156:159], v[80:83]
    ds_read_b64_tr_b16 v[194:195], v235 offset:13952
    v_mfma_f32_16x16x32_bf16 v[84:87], v[120:123], v[160:163], v[84:87]
    ds_read_b64_tr_b16 v[196:197], v236 offset:12416
    v_mfma_f32_16x16x32_bf16 v[48:51], v[148:151], v[124:127], v[48:51]
    ds_read_b64_tr_b16 v[198:199], v236 offset:13952
    v_mfma_f32_16x16x32_bf16 v[52:55], v[152:155], v[124:127], v[52:55]
    v_mfma_f32_16x16x32_bf16 v[88:91], v[124:127], v[156:159], v[88:91]
    ds_read_b64_tr_b16 v[200:201], v235 offset:12544
    v_mfma_f32_16x16x32_bf16 v[92:95], v[124:127], v[160:163], v[92:95]
    ds_read_b64_tr_b16 v[202:203], v235 offset:14080
    v_mfma_f32_16x16x32_bf16 v[8:11], v[140:143], v[124:127], v[8:11]
    ds_read_b64_tr_b16 v[204:205], v236 offset:12544
    v_mfma_f32_16x16x32_bf16 v[12:15], v[144:147], v[124:127], v[12:15]
    ds_read_b64_tr_b16 v[206:207], v236 offset:14080
    v_mfma_f32_16x16x32_bf16 v[56:59], v[148:151], v[128:131], v[56:59]
    v_mfma_f32_16x16x32_bf16 v[60:63], v[152:155], v[128:131], v[60:63]
    ds_read_b128 v[168:171], v232 offset:3072
    v_mfma_f32_16x16x32_bf16 v[96:99], v[128:131], v[156:159], v[96:99]
    ds_read_b64_tr_b16 v[184:185], v235 offset:12288
    v_mfma_f32_16x16x32_bf16 v[100:103], v[128:131], v[160:163], v[100:103]
    s_sub_u32 s54, s54, 1
    ds_read_b64_tr_b16 v[186:187], v235 offset:13824
    v_mfma_f32_16x16x32_bf16 v[16:19], v[140:143], v[128:131], v[16:19]
    s_cbranch_scc0 M_P_loop0
    ds_read_b64_tr_b16 v[188:189], v236 offset:12288
    v_mfma_f32_16x16x32_bf16 v[20:23], v[144:147], v[128:131], v[20:23]
    v_mfma_f32_16x16x32_bf16 v[64:67], v[148:151], v[132:135], v[64:67]
    ds_read_b64_tr_b16 v[190:191], v236 offset:13824
    v_mfma_f32_16x16x32_bf16 v[68:71], v[152:155], v[132:135], v[68:71]
    ds_read_b128 v[172:175], v232 offset:5120
    v_mfma_f32_16x16x32_bf16 v[104:107], v[132:135], v[156:159], v[104:107]
    ds_read_b128 v[176:179], v232 offset:7168
    v_mfma_f32_16x16x32_bf16 v[108:111], v[132:135], v[160:163], v[108:111]
    ds_read_b128 v[180:183], v232 offset:9216
    v_mfma_f32_16x16x32_bf16 v[24:27], v[140:143], v[132:135], v[24:27]
    v_mfma_f32_16x16x32_bf16 v[28:31], v[144:147], v[132:135], v[28:31]
    v_mfma_f32_16x16x32_bf16 v[72:75], v[148:151], v[136:139], v[72:75]
    v_mfma_f32_16x16x32_bf16 v[76:79], v[152:155], v[136:139], v[76:79]
    v_mfma_f32_16x16x32_bf16 v[112:115], v[136:139], v[156:159], v[112:115]
    v_mfma_f32_16x16x32_bf16 v[116:119], v[136:139], v[160:163], v[116:119]
    v_mfma_f32_16x16x32_bf16 v[32:35], v[140:143], v[136:139], v[32:35]
    v_mfma_f32_16x16x32_bf16 v[36:39], v[144:147], v[136:139], v[36:39]
    s_waitcnt lgkmcnt(0)
    v_mfma_f32_16x16x32_bf16 v[40:43], v[192:195], v[164:167], v[40:43]
    s_barrier
    v_mfma_f32_16x16x32_bf16 v[44:47], v[196:199], v[164:167], v[44:47]
    v_mfma_f32_16x16x32_bf16 v[80:83], v[164:167], v[200:203], v[80:83]
    v_mfma_f32_16x16x32_bf16 v[84:87], v[164:167], v[204:207], v[84:87]
    v_mfma_f32_16x16x32_bf16 v[48:51], v[192:195], v[168:171], v[48:51]
    v_mfma_f32_16x16x32_bf16 v[52:55], v[196:199], v[168:171], v[52:55]
    v_mfma_f32_16x16x32_bf16 v[88:91], v[168:171], v[200:203], v[88:91]
    v_mfma_f32_16x16x32_bf16 v[92:95], v[168:171], v[204:207], v[92:95]
    v_mfma_f32_16x16x32_bf16 v[8:11], v[184:187], v[168:171], v[8:11]
    v_mfma_f32_16x16x32_bf16 v[12:15], v[188:191], v[168:171], v[12:15]
    v_mfma_f32_16x16x32_bf16 v[56:59], v[192:195], v[172:175], v[56:59]
    v_mfma_f32_16x16x32_bf16 v[60:63], v[196:199], v[172:175], v[60:63]
    v_mfma_f32_16x16x32_bf16 v[96:99], v[172:175], v[200:203], v[96:99]
    v_mfma_f32_16x16x32_bf16 v[100:103], v[172:175], v[204:207], v[100:103]
    v_mfma_f32_16x16x32_bf16 v[16:19], v[184:187], v[172:175], v[16:19]
    v_mfma_f32_16x16x32_bf16 v[20:23], v[188:191], v[172:175], v[20:23]
    v_mfma_f32_16x16x32_bf16 v[64:67], v[192:195], v[176:179], v[64:67]
    v_mfma_f32_16x16x32_bf16 v[68:71], v[196:199], v[176:179], v[68:71]
    v_mfma_f32_16x16x32_bf16 v[104:107], v[176:179], v[200:203], v[104:107]
    v_mfma_f32_16x16x32_bf16 v[108:111], v[176:179], v[204:207], v[108:111]
    v_mfma_f32_16x16x32_bf16 v[24:27], v[184:187], v[176:179], v[24:27]
    v_mfma_f32_16x16x32_bf16 v[28:31], v[188:191], v[176:179], v[28:31]
    v_mfma_f32_16x16x32_bf16 v[72:75], v[192:195], v[180:183], v[72:75]
    v_mfma_f32_16x16x32_bf16 v[76:79], v[196:199], v[180:183], v[76:79]
    v_mfma_f32_16x16x32_bf16 v[112:115], v[180:183], v[200:203], v[112:115]
    v_mfma_f32_16x16x32_bf16 v[116:119], v[180:183], v[204:207], v[116:119]
    v_mfma_f32_16x16x32_bf16 v[32:35], v[184:187], v[180:183], v[32:35]
    v_mfma_f32_16x16x32_bf16 v[36:39], v[188:191], v[180:183], v[36:39]
    v_cvt_pk_bf16_f32 v120, v40, v41
    v_cvt_pk_bf16_f32 v121, v42, v43
    v_cvt_pk_bf16_f32 v122, v44, v45
    v_cvt_pk_bf16_f32 v123, v46, v47
    v_cvt_pk_bf16_f32 v124, v48, v49
    v_cvt_pk_bf16_f32 v125, v50, v51
    v_cvt_pk_bf16_f32 v126, v52, v53
    v_cvt_pk_bf16_f32 v127, v54, v55
    v_cvt_pk_bf16_f32 v140, v8, v9
    v_cvt_pk_bf16_f32 v141, v10, v11
    v_cvt_pk_bf16_f32 v142, v12, v13
    v_cvt_pk_bf16_f32 v143, v14, v15
    v_cvt_pk_bf16_f32 v128, v56, v57
    v_cvt_pk_bf16_f32 v129, v58, v59
    v_cvt_pk_bf16_f32 v130, v60, v61
    v_cvt_pk_bf16_f32 v131, v62, v63
    v_cvt_pk_bf16_f32 v144, v16, v17
    v_cvt_pk_bf16_f32 v145, v18, v19
    v_cvt_pk_bf16_f32 v146, v20, v21
    v_cvt_pk_bf16_f32 v147, v22, v23
    v_cvt_pk_bf16_f32 v132, v64, v65
    v_cvt_pk_bf16_f32 v133, v66, v67
    v_cvt_pk_bf16_f32 v134, v68, v69
    v_cvt_pk_bf16_f32 v135, v70, v71
    v_cvt_pk_bf16_f32 v148, v24, v25
    v_cvt_pk_bf16_f32 v149, v26, v27
    v_cvt_pk_bf16_f32 v150, v28, v29
    v_cvt_pk_bf16_f32 v151, v30, v31
    v_cvt_pk_bf16_f32 v136, v72, v73
    v_cvt_pk_bf16_f32 v137, v74, v75
    v_cvt_pk_bf16_f32 v138, v76, v77
    v_cvt_pk_bf16_f32 v139, v78, v79
    v_cvt_pk_bf16_f32 v152, v32, v33
    v_cvt_pk_bf16_f32 v153, v34, v35
    v_cvt_pk_bf16_f32 v154, v36, v37
    v_cvt_pk_bf16_f32 v155, v38, v39
    v_mfma_f32_16x16x32_bf16 v[8:11], v[120:123], v[140:143], 0
    v_mfma_f32_16x16x32_bf16 v[12:15], v[124:127], v[140:143], 0
    v_mfma_f32_16x16x32_bf16 v[16:19], v[124:127], v[144:147], 0
    v_mfma_f32_16x16x32_bf16 v[20:23], v[128:131], v[144:147], 0
    v_mfma_f32_16x16x32_bf16 v[24:27], v[128:131], v[148:151], 0
    v_mfma_f32_16x16x32_bf16 v[28:31], v[132:135], v[148:151], 0
    v_mfma_f32_16x16x32_bf16 v[32:35], v[132:135], v[152:155], 0
    v_mfma_f32_16x16x32_bf16 v[36:39], v[136:139], v[152:155], 0
    v_cvt_pk_bf16_f32 v156, v80, v81
    v_cvt_pk_bf16_f32 v157, v82, v83
    v_cvt_pk_bf16_f32 v166, v84, v85
    v_cvt_pk_bf16_f32 v167, v86, v87
    v_cvt_pk_bf16_f32 v158, v88, v89
    v_cvt_pk_bf16_f32 v159, v90, v91
    v_cvt_pk_bf16_f32 v168, v92, v93
    v_cvt_pk_bf16_f32 v169, v94, v95
    v_cvt_pk_bf16_f32 v160, v96, v97
    v_cvt_pk_bf16_f32 v161, v98, v99
    v_cvt_pk_bf16_f32 v170, v100, v101
    v_cvt_pk_bf16_f32 v171, v102, v103
    v_cvt_pk_bf16_f32 v162, v104, v105
    v_cvt_pk_bf16_f32 v163, v106, v107
    v_cvt_pk_bf16_f32 v172, v108, v109
    v_cvt_pk_bf16_f32 v173, v110, v111
    v_cvt_pk_bf16_f32 v164, v112, v113
    v_cvt_pk_bf16_f32 v165, v114, v115
    v_cvt_pk_bf16_f32 v174, v116, v117
    v_cvt_pk_bf16_f32 v175, v118, v119
    s_mov_b32 s64, 0x3e8293ee
    v_mov_b32 v5, 0xf149f2ca
    v_cndmask_b32 v8, v5, v8, s[88:89]
    v_cndmask_b32 v12, v5, v12, s[80:81]
    v_cndmask_b32 v9, v5, v9, s[90:91]
    v_cndmask_b32 v13, v5, v13, s[82:83]
    v_cndmask_b32 v10, v5, v10, s[92:93]
    v_cndmask_b32 v14, v5, v14, s[84:85]
    v_cndmask_b32 v11, v5, v11, s[94:95]
    v_cndmask_b32 v15, v5, v15, s[86:87]
    v_cndmask_b32 v16, v5, v16, s[72:73]
    v_cndmask_b32 v20, v5, v20, s[80:81]
    v_cndmask_b32 v17, v5, v17, s[74:75]
    v_cndmask_b32 v21, v5, v21, s[82:83]
    v_cndmask_b32 v18, v5, v18, s[76:77]
    v_cndmask_b32 v22, v5, v22, s[84:85]
    v_cndmask_b32 v19, v5, v19, s[78:79]
    v_cndmask_b32 v23, v5, v23, s[86:87]
    v_cndmask_b32 v24, v5, v24, s[72:73]
    v_cndmask_b32 v28, v5, v28, s[80:81]
    v_cndmask_b32 v25, v5, v25, s[74:75]
    v_cndmask_b32 v29, v5, v29, s[82:83]
    v_cndmask_b32 v26, v5, v26, s[76:77]
    v_cndmask_b32 v30, v5, v30, s[84:85]
    v_cndmask_b32 v27, v5, v27, s[78:79]
    v_cndmask_b32 v31, v5, v31, s[86:87]
    v_cndmask_b32 v32, v5, v32, s[72:73]
    v_cndmask_b32 v36, v5, v36, s[80:81]
    v_cndmask_b32 v33, v5, v33, s[74:75]
    v_cndmask_b32 v37, v5, v37, s[82:83]
    v_cndmask_b32 v34, v5, v34, s[76:77]
    v_cndmask_b32 v38, v5, v38, s[84:85]
    v_cndmask_b32 v35, v5, v35, s[78:79]
    v_cndmask_b32 v39, v5, v39, s[86:87]
    v_max3_f32 v192, v8, v9, v10
    v_max3_f32 v196, v11, v12, v13
    v_max3_f32 v193, v16, v17, v18
    v_max3_f32 v197, v19, v20, v21
    v_max3_f32 v194, v24, v25, v26
    v_max3_f32 v198, v27, v28, v29
    v_max3_f32 v195, v32, v33, v34
    v_max3_f32 v199, v35, v36, v37
    v_max3_f32 v192, v192, v14, v15
    v_max3_f32 v193, v193, v22, v23
    v_max3_f32 v194, v194, v30, v31
    v_max3_f32 v195, v195, v38, v39
    v_max_f32 v192, v192, v196
    v_max_f32 v193, v193, v197
    v_max_f32 v194, v194, v198
    v_max_f32 v195, v195, v199
    v_mov_b32 v196, v192
    v_mov_b32 v197, v193
    v_mov_b32 v198, v194
    v_mov_b32 v199, v195
    v_permlane32_swap_b32 v192, v196
    v_permlane32_swap_b32 v193, v197
    v_permlane32_swap_b32 v194, v198
    v_permlane32_swap_b32 v195, v199
    v_max_f32 v192, v192, v196
    v_max_f32 v193, v193, v197
    v_max_f32 v194, v194, v198
    v_max_f32 v195, v195, v199
    v_mov_b32 v196, v192
    v_mov_b32 v197, v193
    v_mov_b32 v198, v194
    v_mov_b32 v199, v195
    v_permlane16_swap_b32 v192, v196
    v_permlane16_swap_b32 v193, v197
    v_permlane16_swap_b32 v194, v198
    v_permlane16_swap_b32 v195, v199
    v_max_f32 v192, v192, v196
    v_max_f32 v193, v193, v197
    v_max_f32 v194, v194, v198
    v_max_f32 v195, v195, v199
    v_mul_f32 v192, s64, v192
    v_mul_f32 v193, s64, v193
    v_mul_f32 v194, s64, v194
    v_mul_f32 v195, s64, v195
    v_fma_f32 v8, v8, s64, -v192
    v_fma_f32 v9, v9, s64, -v192
    v_fma_f32 v10, v10, s64, -v192
    v_fma_f32 v11, v11, s64, -v192
    v_fma_f32 v12, v12, s64, -v192
    v_fma_f32 v13, v13, s64, -v192
    v_fma_f32 v14, v14, s64, -v192
    v_fma_f32 v15, v15, s64, -v192
    v_fma_f32 v16, v16, s64, -v193
    v_fma_f32 v17, v17, s64, -v193
    v_fma_f32 v18, v18, s64, -v193
    v_fma_f32 v19, v19, s64, -v193
    v_fma_f32 v20, v20, s64, -v193
    v_fma_f32 v21, v21, s64, -v193
    v_fma_f32 v22, v22, s64, -v193
    v_fma_f32 v23, v23, s64, -v193
    v_fma_f32 v24, v24, s64, -v194
    v_fma_f32 v25, v25, s64, -v194
    v_fma_f32 v26, v26, s64, -v194
    v_fma_f32 v27, v27, s64, -v194
    v_fma_f32 v28, v28, s64, -v194
    v_fma_f32 v29, v29, s64, -v194
    v_fma_f32 v30, v30, s64, -v194
    v_fma_f32 v31, v31, s64, -v194
    v_fma_f32 v32, v32, s64, -v195
    v_fma_f32 v33, v33, s64, -v195
    v_fma_f32 v34, v34, s64, -v195
    v_fma_f32 v35, v35, s64, -v195
    v_fma_f32 v36, v36, s64, -v195
    v_fma_f32 v37, v37, s64, -v195
    v_fma_f32 v38, v38, s64, -v195
    v_fma_f32 v39, v39, s64, -v195
    v_exp_f32 v8, v8
    v_exp_f32 v9, v9
    v_exp_f32 v10, v10
    v_exp_f32 v11, v11
    v_exp_f32 v12, v12
    v_exp_f32 v13, v13
    v_exp_f32 v14, v14
    v_exp_f32 v15, v15
    v_exp_f32 v16, v16
    v_exp_f32 v17, v17
    v_exp_f32 v18, v18
    v_exp_f32 v19, v19
    v_exp_f32 v20, v20
    v_exp_f32 v21, v21
    v_exp_f32 v22, v22
    v_exp_f32 v23, v23
    v_exp_f32 v24, v24
    v_exp_f32 v25, v25
    v_exp_f32 v26, v26
    v_exp_f32 v27, v27
    v_exp_f32 v28, v28
    v_exp_f32 v29, v29
    v_exp_f32 v30, v30
    v_exp_f32 v31, v31
    v_exp_f32 v32, v32
    v_exp_f32 v33, v33
    v_exp_f32 v34, v34
    v_exp_f32 v35, v35
    v_exp_f32 v36, v36
    v_exp_f32 v37, v37
    v_exp_f32 v38, v38
    v_exp_f32 v39, v39
    v_pk_add_f32 v[200:201], v[8:9], v[10:11]
    v_pk_add_f32 v[202:203], v[16:17], v[18:19]
    v_pk_add_f32 v[204:205], v[24:25], v[26:27]
    v_pk_add_f32 v[206:207], v[32:33], v[34:35]
    v_pk_add_f32 v[200:201], v[200:201], v[12:13]
    v_pk_add_f32 v[202:203], v[202:203], v[20:21]
    v_pk_add_f32 v[204:205], v[204:205], v[28:29]
    v_pk_add_f32 v[206:207], v[206:207], v[36:37]
    v_pk_add_f32 v[200:201], v[200:201], v[14:15]
    v_pk_add_f32 v[202:203], v[202:203], v[22:23]
    v_pk_add_f32 v[204:205], v[204:205], v[30:31]
    v_pk_add_f32 v[206:207], v[206:207], v[38:39]
    v_add_f32 v200, v200, v201
    v_add_f32 v202, v202, v203
    v_add_f32 v204, v204, v205
    v_add_f32 v206, v206, v207
    v_mov_b32 v196, v200
    v_mov_b32 v197, v202
    v_mov_b32 v198, v204
    v_mov_b32 v199, v206
    v_permlane32_swap_b32 v200, v196
    v_permlane32_swap_b32 v202, v197
    v_permlane32_swap_b32 v204, v198
    v_permlane32_swap_b32 v206, v199
    v_add_f32 v200, v200, v196
    v_add_f32 v202, v202, v197
    v_add_f32 v204, v204, v198
    v_add_f32 v206, v206, v199
    v_mov_b32 v196, v200
    v_mov_b32 v197, v202
    v_mov_b32 v198, v204
    v_mov_b32 v199, v206
    v_permlane16_swap_b32 v200, v196
    v_permlane16_swap_b32 v202, v197
    v_permlane16_swap_b32 v204, v198
    v_permlane16_swap_b32 v206, v199
    v_add_f32 v200, v200, v196
    v_add_f32 v202, v202, v197
    v_add_f32 v204, v204, v198
    v_add_f32 v206, v206, v199
    v_rcp_f32 v200, v200
    v_rcp_f32 v202, v202
    v_rcp_f32 v204, v204
    v_rcp_f32 v206, v206
    v_pk_mul_f32 v[8:9], v[8:9], v[200:201] op_sel_hi:[1,0]
    v_pk_mul_f32 v[10:11], v[10:11], v[200:201] op_sel_hi:[1,0]
    v_pk_mul_f32 v[12:13], v[12:13], v[200:201] op_sel_hi:[1,0]
    v_pk_mul_f32 v[14:15], v[14:15], v[200:201] op_sel_hi:[1,0]
    v_pk_mul_f32 v[16:17], v[16:17], v[202:203] op_sel_hi:[1,0]
    v_pk_mul_f32 v[18:19], v[18:19], v[202:203] op_sel_hi:[1,0]
    v_pk_mul_f32 v[20:21], v[20:21], v[202:203] op_sel_hi:[1,0]
    v_pk_mul_f32 v[22:23], v[22:23], v[202:203] op_sel_hi:[1,0]
    v_pk_mul_f32 v[24:25], v[24:25], v[204:205] op_sel_hi:[1,0]
    v_pk_mul_f32 v[26:27], v[26:27], v[204:205] op_sel_hi:[1,0]
    v_pk_mul_f32 v[28:29], v[28:29], v[204:205] op_sel_hi:[1,0]
    v_pk_mul_f32 v[30:31], v[30:31], v[204:205] op_sel_hi:[1,0]
    v_pk_mul_f32 v[32:33], v[32:33], v[206:207] op_sel_hi:[1,0]
    v_pk_mul_f32 v[34:35], v[34:35], v[206:207] op_sel_hi:[1,0]
    v_pk_mul_f32 v[36:37], v[36:37], v[206:207] op_sel_hi:[1,0]
    v_pk_mul_f32 v[38:39], v[38:39], v[206:207] op_sel_hi:[1,0]
    v_cvt_pk_bf16_f32 v176, v8, v9
    v_cvt_pk_bf16_f32 v177, v10, v11
    v_cvt_pk_bf16_f32 v178, v12, v13
    v_cvt_pk_bf16_f32 v179, v14, v15
    v_cvt_pk_bf16_f32 v180, v16, v17
    v_cvt_pk_bf16_f32 v181, v18, v19
    v_cvt_pk_bf16_f32 v182, v20, v21
    v_cvt_pk_bf16_f32 v183, v22, v23
    v_cvt_pk_bf16_f32 v184, v24, v25
    v_cvt_pk_bf16_f32 v185, v26, v27
    v_cvt_pk_bf16_f32 v186, v28, v29
    v_cvt_pk_bf16_f32 v187, v30, v31
    v_cvt_pk_bf16_f32 v188, v32, v33
    v_cvt_pk_bf16_f32 v189, v34, v35
    v_cvt_pk_bf16_f32 v190, v36, v37
    v_cvt_pk_bf16_f32 v191, v38, v39
    v_mfma_f32_16x16x32_bf16 v[40:43], v[156:159], v[176:179], 0
    v_mfma_f32_16x16x32_bf16 v[44:47], v[166:169], v[176:179], 0
    v_mfma_f32_16x16x32_bf16 v[48:51], v[158:161], v[180:183], 0
    v_mfma_f32_16x16x32_bf16 v[52:55], v[168:171], v[180:183], 0
    v_mfma_f32_16x16x32_bf16 v[56:59], v[160:163], v[184:187], 0
    v_mfma_f32_16x16x32_bf16 v[60:63], v[170:173], v[184:187], 0
    v_mfma_f32_16x16x32_bf16 v[64:67], v[162:165], v[188:191], 0
    v_mfma_f32_16x16x32_bf16 v[68:71], v[172:175], v[188:191], 0
    s_mov_b32 s72, 0x0
    s_mov_b32 s73, 0x8000
    s_mov_b32 s74, 0x10000
    s_mov_b32 s75, 0x18000
    v_cvt_pk_bf16_f32 v120, v40, v41
    v_cvt_pk_bf16_f32 v121, v42, v43
    v_cvt_pk_bf16_f32 v122, v44, v45
    v_cvt_pk_bf16_f32 v123, v46, v47
    buffer_store_dwordx4 v[120:123], v237, s[28:31], s72 offen sc1
    v_cvt_pk_bf16_f32 v124, v48, v49
    v_cvt_pk_bf16_f32 v125, v50, v51
    v_cvt_pk_bf16_f32 v126, v52, v53
    v_cvt_pk_bf16_f32 v127, v54, v55
    buffer_store_dwordx4 v[124:127], v237, s[28:31], s73 offen sc1
    v_cvt_pk_bf16_f32 v128, v56, v57
    v_cvt_pk_bf16_f32 v129, v58, v59
    v_cvt_pk_bf16_f32 v130, v60, v61
    v_cvt_pk_bf16_f32 v131, v62, v63
    buffer_store_dwordx4 v[128:131], v237, s[28:31], s74 offen sc1
    v_cvt_pk_bf16_f32 v132, v64, v65
    v_cvt_pk_bf16_f32 v133, v66, v67
    v_cvt_pk_bf16_f32 v134, v68, v69
    v_cvt_pk_bf16_f32 v135, v70, v71
    buffer_store_dwordx4 v[132:135], v237, s[28:31], s75 offen sc1
    s_lshl_b32 s64, s44, 13
    s_lshl_b32 s65, s48, 9
    s_add_u32 s64, s64, s65
    s_add_u32 s64, s64, 0xa0000
    v_lshl_add_u32 v200, v1, 3, s64
    s_mov_b32 s76, 0
    s_mov_b32 s77, 32768
    s_mov_b32 s78, 65536
    s_mov_b32 s79, 98304
    s_lshl_b32 s68, s47, 9
    s_add_u32 s68, s68, 0x54000
    s_add_u32 s62, s26, s68
    s_addc_u32 s63, s27, 0
    s_lshr_b32 s68, s48, 2
    s_lshl_b32 s68, s68, 7
    v_mov_b32 v2, 1
    v_mov_b32 v5, 148484
    s_waitcnt vmcnt(0)
    s_mov_b64 exec, 1
    ds_add_rtn_u32 v245, v5, v2
    s_mov_b64 exec, -1
    s_mov_b32 s1, 1
    s_mov_b32 s3, 0x40000
    s_waitcnt lgkmcnt(0)
    v_readfirstlane_b32 s64, v245
    s_nop 3
    s_cmp_lg_u32 s64, 3
    s_cbranch_scc1 M_po_ok
    s_atomic_add s1, s[62:63], 0
    s_atomic_add s1, s[62:63], 128
    s_atomic_add s1, s[62:63], 256
    s_atomic_add s1, s[62:63], 384
M_po_chk:
    s_load_dword s64, s[62:63], s68 glc
    s_sub_u32 s3, s3, 1
    s_cselect_b32 s65, 0, 16
    s_waitcnt lgkmcnt(0)
    s_cmp_lt_u32 s64, s65
    s_cbranch_scc1 M_po_chk
M_po_ok:
    s_barrier
    s_setprio 0
    s_and_b32 s57, s58, 15
    s_lshr_b64 s[58:59], s[58:59], 4
    s_lshl_b32 s56, s57, 11
    s_mul_i32 s57, s57, 0x20000
    s_mov_b32 m0, s53
    s_nop 0
    buffer_load_dwordx4 v208, s[28:31], s56 offen offset:0 lds
    buffer_load_dwordx4 v208, s[28:31], s56 offen offset:1024 lds
    buffer_load_dwordx4 v209, s[28:31], s56 offen offset:2048 lds
    buffer_load_dwordx4 v209, s[28:31], s56 offen offset:3072 lds
    s_add_u32 s53, s53, 24576
    s_cmp_ge_u32 s53, s61
    s_cselect_b32 s53, s60, s53
    s_and_b32 s57, s58, 15
    s_lshr_b64 s[58:59], s[58:59], 4
    s_lshl_b32 s56, s57, 11
    s_mul_i32 s57, s57, 0x20000
    s_mov_b32 m0, s53
    s_nop 0
    buffer_load_dwordx4 v208, s[28:31], s56 offen offset:0 lds
    buffer_load_dwordx4 v208, s[28:31], s56 offen offset:1024 lds
    buffer_load_dwordx4 v209, s[28:31], s56 offen offset:2048 lds
    buffer_load_dwordx4 v209, s[28:31], s56 offen offset:3072 lds
    s_add_u32 s53, s53, 24576
    s_cmp_ge_u32 s53, s61
    s_cselect_b32 s53, s60, s53
    s_and_b32 s57, s58, 15
    s_lshr_b64 s[58:59], s[58:59], 4
    s_lshl_b32 s56, s57, 11
    s_mul_i32 s57, s57, 0x20000
    s_mov_b32 m0, s53
    s_nop 0
    buffer_load_dwordx4 v208, s[28:31], s56 offen offset:0 lds
    buffer_load_dwordx4 v208, s[28:31], s56 offen offset:1024 lds
    buffer_load_dwordx4 v209, s[28:31], s56 offen offset:2048 lds
    buffer_load_dwordx4 v209, s[28:31], s56 offen offset:3072 lds
    s_add_u32 s53, s53, 24576
    s_cmp_ge_u32 s53, s61
    s_cselect_b32 s53, s60, s53
    buffer_load_dwordx2 v[192:193], v200, s[28:31], s76 offen sc1
    buffer_load_dwordx2 v[194:195], v200, s[28:31], s77 offen sc1
    buffer_load_dwordx2 v[196:197], v200, s[28:31], s78 offen sc1
    buffer_load_dwordx2 v[198:199], v200, s[28:31], s79 offen sc1
    s_lshl_b32 s64, s45, 13
    v_lshl_add_u32 v233, v1, 4, s64
    v_lshrrev_b32 v2, 2, v1
    v_lshlrev_b32 v4, 8, v2
    v_and_b32 v5, 3, v1
    v_lshl_add_u32 v4, v5, 3, v4
    v_add_u32 v4, 16384, v4
    v_and_b32 v2, 7, v2
    s_lshl_b32 s64, s46, 2
    v_xor_b32 v2, s64, v2
    v_xor_b32 v3, 0, v2
    v_lshl_add_u32 v239, v3, 5, v4
    v_xor_b32 v3, 1, v2
    v_lshl_add_u32 v240, v3, 5, v4
    v_xor_b32 v3, 2, v2
    v_lshl_add_u32 v241, v3, 5, v4
    v_xor_b32 v3, 3, v2
    v_lshl_add_u32 v242, v3, 5, v4
    s_lshl_b32 s64, s2, 2
    s_add_u32 s64, s64, s44
    s_mul_i32 s64, s64, 7168
    s_add_u32 s64, s64, 5248
    s_add_u32 s10, s12, s64
    s_addc_u32 s11, s13, 0
    s_add_u32 s24, s14, s64
    s_addc_u32 s25, s15, 0
    s_mov_b32 s52, 0
    v_add_u32 v232, s52, v233
    v_add_u32 v235, s52, v239
    v_add_u32 v236, s52, v240
    v_add_u32 v237, s52, v241
    v_add_u32 v238, s52, v242
    s_movk_i32 s54, 2
M_P_loop1:
    s_waitcnt vmcnt(12)
    s_barrier
    s_and_b32 s57, s58, 15
    s_lshr_b64 s[58:59], s[58:59], 4
    s_lshl_b32 s56, s57, 11
    s_mul_i32 s57, s57, 0x20000
    s_mov_b32 m0, s53
    s_nop 0
    buffer_load_dwordx4 v208, s[28:31], s56 offen offset:0 lds
    buffer_load_dwordx4 v208, s[28:31], s56 offen offset:1024 lds
    buffer_load_dwordx4 v209, s[28:31], s56 offen offset:2048 lds
    buffer_load_dwordx4 v209, s[28:31], s56 offen offset:3072 lds
    s_add_u32 s53, s53, 24576
    s_cmp_ge_u32 s53, s61
    s_cselect_b32 s53, s60, s53
    s_sub_u32 s54, s54, 1
    s_cbranch_scc0 M_P_loop1
    s_waitcnt vmcnt(8)
    s_barrier
    s_and_b32 s57, s58, 15
    s_lshr_b64 s[58:59], s[58:59], 4
    s_lshl_b32 s56, s57, 11
    s_mul_i32 s57, s57, 0x20000
    s_add_u32 m0, s53, s70
    s_nop 0
    buffer_load_dwordx4 v210, s[32:35], s57 offen offset:0 lds
    buffer_load_dwordx4 v211, s[32:35], s57 offen offset:1024 lds
    s_mov_b32 m0, s53
    s_nop 0
    buffer_load_dwordx4 v208, s[28:31], s56 offen offset:0 lds
    buffer_load_dwordx4 v208, s[28:31], s56 offen offset:1024 lds
    buffer_load_dwordx4 v209, s[28:31], s56 offen offset:2048 lds
    buffer_load_dwordx4 v209, s[28:31], s56 offen offset:3072 lds
    s_add_u32 s53, s53, 24576
    s_cmp_ge_u32 s53, s61
    s_cselect_b32 s53, s60, s53
    s_mov_b32 s3, 0x40000
M_tb_chk:
    v_xor_b32 v2, s0, v193
    v_xor_b32 v3, s0, v195
    v_xor_b32 v4, s0, v197
    v_xor_b32 v5, s0, v199
    v_or3_b32 v2, v2, v3, v4
    v_or_b32 v2, v2, v5
    v_cmp_ne_u32 vcc, 0, v2
    s_nop 4
    s_cbranch_vccz M_tb_ok
    s_sub_u32 s3, s3, 1
    s_cbranch_scc1 M_tb_ok
    s_sleep 1
    buffer_load_dwordx2 v[192:193], v200, s[28:31], s76 offen sc1
    buffer_load_dwordx2 v[194:195], v200, s[28:31], s77 offen sc1
    buffer_load_dwordx2 v[196:197], v200, s[28:31], s78 offen sc1
    buffer_load_dwordx2 v[198:199], v200, s[28:31], s79 offen sc1
    s_waitcnt vmcnt(0)
    s_branch M_tb_chk
M_tb_ok:
    v_add_f32 v192, v192, v194
    v_add_f32 v196, v196, v198
    v_add_f32 v192, v192, v196
    v_cvt_pk_bf16_f32 v193, v192, v192
    v_lshlrev_b32 v192, 16, v193
    s_cmp_eq_u32 s44, 2
    s_cselect_b32 s64, 1.0, 0
    v_add_f32 v192, s64, v192
    v_cvt_pk_bf16_f32 v193, v192, v192
    v_lshlrev_b32 v192, 16, v193
    s_cmp_lg_u32 s45, s46
    s_cselect_b32 s64, 0x3fb8aa3b, 1.0
    v_mul_f32 v192, s64, v192
    s_lshl_b32 s64, s44, 8
    s_add_u32 s64, s64, 149504
    v_add_u32 v2, s64, v234
    ds_write_b32 v2, v192
    s_lshl_b32 s64, s47, 12
    s_lshl_b32 s65, s48, 8
    s_add_u32 s64, s64, s65
    s_add_u32 s64, s64, 0xc0000
    s_cmp_eq_u32 s44, 3
    s_cselect_b32 s64, s64, 0x80000000
    v_add_u32 v2, s64, v234
    buffer_store_dword v192, v2, s[28:31], 0 offen sc1
    s_waitcnt lgkmcnt(0)
    s_waitcnt vmcnt(11)
    s_barrier
    s_and_b32 s57, s58, 15
    s_lshr_b64 s[58:59], s[58:59], 4
    s_lshl_b32 s56, s57, 11
    s_mul_i32 s57, s57, 0x20000
    s_add_u32 m0, s53, s70
    s_nop 0
    buffer_load_dwordx4 v210, s[32:35], s57 offen offset:0 lds
    buffer_load_dwordx4 v211, s[32:35], s57 offen offset:1024 lds
    s_mov_b32 m0, s53
    s_nop 0
    buffer_load_dwordx4 v208, s[28:31], s56 offen offset:0 lds
    buffer_load_dwordx4 v208, s[28:31], s56 offen offset:1024 lds
    buffer_load_dwordx4 v209, s[28:31], s56 offen offset:2048 lds
    buffer_load_dwordx4 v209, s[28:31], s56 offen offset:3072 lds
    s_add_u32 s53, s53, 24576
    s_cmp_ge_u32 s53, s61
    s_cselect_b32 s53, s60, s53
    s_movk_i32 s54, 1
M_P_loop2:
    s_waitcnt vmcnt(13)
    s_barrier
    s_and_b32 s57, s58, 15
    s_lshr_b64 s[58:59], s[58:59], 4
    s_lshl_b32 s56, s57, 11
    s_mul_i32 s57, s57, 0x20000
    s_add_u32 m0, s53, s70
    s_nop 0
    buffer_load_dwordx4 v210, s[32:35], s57 offen offset:0 lds
    buffer_load_dwordx4 v211, s[32:35], s57 offen offset:1024 lds
    s_mov_b32 m0, s53
    s_nop 0
    buffer_load_dwordx4 v208, s[28:31], s56 offen offset:0 lds
    buffer_load_dwordx4 v208, s[28:31], s56 offen offset:1024 lds
    buffer_load_dwordx4 v209, s[28:31], s56 offen offset:2048 lds
    buffer_load_dwordx4 v209, s[28:31], s56 offen offset:3072 lds
    s_add_u32 s53, s53, 24576
    s_cmp_ge_u32 s53, s61
    s_cselect_b32 s53, s60, s53
    s_sub_u32 s54, s54, 1
    s_cbranch_scc0 M_P_loop2
    s_movk_i32 s54, 4
M_P_loop3:
    s_waitcnt vmcnt(12)
    s_barrier
    s_and_b32 s57, s58, 15
    s_lshr_b64 s[58:59], s[58:59], 4
    s_lshl_b32 s56, s57, 11
    s_mul_i32 s57, s57, 0x20000
    s_add_u32 m0, s53, s70
    s_nop 0
    buffer_load_dwordx4 v210, s[32:35], s57 offen offset:0 lds
    buffer_load_dwordx4 v211, s[32:35], s57 offen offset:1024 lds
    s_mov_b32 m0, s53
    s_nop 0
    buffer_load_dwordx4 v208, s[28:31], s56 offen offset:0 lds
    buffer_load_dwordx4 v208, s[28:31], s56 offen offset:1024 lds
    buffer_load_dwordx4 v209, s[28:31], s56 offen offset:2048 lds
    buffer_load_dwordx4 v209, s[28:31], s56 offen offset:3072 lds
    s_add_u32 s53, s53, 24576
    s_cmp_ge_u32 s53, s61
    s_cselect_b32 s53, s60, s53
    s_sub_u32 s54, s54, 1
    s_cbranch_scc0 M_P_loop3
    s_waitcnt vmcnt(12)
    s_barrier
    s_and_b32 s57, s58, 15
    s_lshr_b64 s[58:59], s[58:59], 4
    s_lshl_b32 s56, s57, 11
    s_mul_i32 s57, s57, 0x20000
    s_add_u32 m0, s53, s70
    s_nop 0
    buffer_load_dwordx4 v210, s[32:35], s57 offen offset:0 lds
    buffer_load_dwordx4 v211, s[32:35], s57 offen offset:1024 lds
    s_mov_b32 m0, s53
    s_nop 0
    buffer_load_dwordx4 v208, s[28:31], s56 offen offset:0 lds
    buffer_load_dwordx4 v208, s[28:31], s56 offen offset:1024 lds
    buffer_load_dwordx4 v209, s[28:31], s56 offen offset:2048 lds
    buffer_load_dwordx4 v209, s[28:31], s56 offen offset:3072 lds
    s_add_u32 s53, s53, 24576
    s_cmp_ge_u32 s53, s61
    s_cselect_b32 s53, s60, s53
    s_lshl_b32 s60, s44, 12
    s_add_u32 s61, s60, 147456
    s_add_u32 s53, s60, 0
    s_bfe_u32 s66, s2, 0x30003
    s_lshr_b32 s55, s2, 6
    s_add_u32 s66, s66, s55
    s_and_b32 s66, s66, 3
    s_mov_b32 s58, 0x76453210
    s_mov_b32 s59, 0xfecdba89
    s_cmp_eq_u32 s66, 1
    s_cselect_b32 s58, 0x75643120, s58
    s_cselect_b32 s59, 0xfdecb9a8, s59
    s_cmp_eq_u32 s66, 2
    s_cselect_b32 s58, 0x67542310, s58
    s_cselect_b32 s59, 0xefdcab98, s59
    s_cmp_eq_u32 s66, 3
    s_cselect_b32 s58, 0x86534210, s58
    s_cselect_b32 s59, 0xfedbca97, s59
    s_lshl_b32 s55, s48, 2
    s_lshr_b64 s[56:57], s[58:59], s55
    s_and_b32 s55, s56, 15
    s_lshl_b32 s55, s55, 2
    s_lshl_b64 s[56:57], 15, s55
    s_andn2_b64 s[58:59], s[58:59], s[56:57]
    s_or_b32 s58, s58, s48
    s_mov_b32 s32, s12
    s_mov_b32 s33, s13
    s_mov_b32 s34, 0x700000
    s_mov_b32 s35, 0x20000
    s_mov_b32 s36, s14
    s_mov_b32 s37, s15
    s_mov_b32 s38, 0x700000
    s_mov_b32 s39, 0x20000
    s_and_b32 s57, s58, 15
    s_lshr_b64 s[58:59], s[58:59], 4
    s_lshl_b32 s56, s57, 11
    s_mul_i32 s57, s57, 0x70000
    s_add_u32 m0, s53, 16384
    s_nop 0
    buffer_load_dwordx4 v212, s[32:35], s57 offen offset:0 lds
    buffer_load_dwordx4 v213, s[32:35], s57 offen offset:1024 lds
    s_waitcnt vmcnt(14)
    s_barrier
    buffer_load_dwordx4 v214, s[32:35], s57 offen offset:2048 lds
    buffer_load_dwordx4 v215, s[32:35], s57 offen offset:3072 lds
    s_add_u32 m0, s53, 32768
    s_nop 0
    buffer_load_dwordx4 v212, s[36:39], s57 offen offset:0 lds
    s_waitcnt vmcnt(11)
    s_barrier
    buffer_load_dwordx4 v213, s[36:39], s57 offen offset:1024 lds
    buffer_load_dwordx4 v214, s[36:39], s57 offen offset:2048 lds
    buffer_load_dwordx4 v215, s[36:39], s57 offen offset:3072 lds
    s_waitcnt vmcnt(8)
    s_barrier
    s_add_u32 s53, s53, 49152
    s_cmp_ge_u32 s53, s61
    s_cselect_b32 s53, s60, s53
    s_barrier
    s_setprio 2
    s_waitcnt vmcnt(0)
    s_barrier
    ds_read_b128 v[136:139], v232 offset:0
    ds_read_b64_tr_b16 v[152:153], v235 offset:0
    ds_read_b64_tr_b16 v[154:155], v235 offset:4096
    ds_read_b64_tr_b16 v[156:157], v236 offset:0
    ds_read_b64_tr_b16 v[158:159], v236 offset:4096
    ds_read_b64_tr_b16 v[160:161], v237 offset:0
    ds_read_b64_tr_b16 v[162:163], v237 offset:4096
    ds_read_b64_tr_b16 v[164:165], v238 offset:0
    ds_read_b64_tr_b16 v[166:167], v238 offset:4096
    ds_read_b64_tr_b16 v[168:169], v235 offset:16384
    ds_read_b64_tr_b16 v[170:171], v235 offset:20480
    ds_read_b64_tr_b16 v[172:173], v236 offset:16384
    ds_read_b64_tr_b16 v[174:175], v236 offset:20480
    ds_read_b64_tr_b16 v[176:177], v237 offset:16384
    ds_read_b64_tr_b16 v[178:179], v237 offset:20480
    ds_read_b64_tr_b16 v[180:181], v238 offset:16384
    ds_read_b64_tr_b16 v[182:183], v238 offset:20480
    ds_read_b128 v[140:143], v232 offset:2048
    ds_read_b128 v[144:147], v232 offset:4096
    ds_read_b128 v[148:151], v232 offset:6144
    s_add_u32 s52, s52, 49152
    s_cmp_ge_u32 s52, 147456
    s_cselect_b32 s52, 0, s52
    s_waitcnt lgkmcnt(0)
    v_mfma_f32_16x16x32_bf16 v[8:11], v[152:155], v[136:139], 0
    ds_read_b128 v[184:187], v232 offset:1024
    v_mfma_f32_16x16x32_bf16 v[12:15], v[156:159], v[136:139], 0
    ds_read_b64_tr_b16 v[200:201], v235 offset:8192
    v_mfma_f32_16x16x32_bf16 v[16:19], v[160:163], v[136:139], 0
    ds_read_b64_tr_b16 v[202:203], v235 offset:12288
    v_mfma_f32_16x16x32_bf16 v[20:23], v[164:167], v[136:139], 0
    ds_read_b64_tr_b16 v[204:205], v236 offset:8192
    v_mfma_f32_16x16x32_bf16 v[24:27], v[168:171], v[136:139], 0
    v_mfma_f32_16x16x32_bf16 v[28:31], v[172:175], v[136:139], 0
    ds_read_b64_tr_b16 v[206:207], v236 offset:12288
    v_mfma_f32_16x16x32_bf16 v[32:35], v[176:179], v[136:139], 0
    ds_read_b64_tr_b16 v[208:209], v237 offset:8192
    v_mfma_f32_16x16x32_bf16 v[36:39], v[180:183], v[136:139], 0
    ds_read_b64_tr_b16 v[210:211], v237 offset:12288
    v_mfma_f32_16x16x32_bf16 v[40:43], v[152:155], v[140:143], 0
    ds_read_b64_tr_b16 v[212:213], v238 offset:8192
    v_mfma_f32_16x16x32_bf16 v[44:47], v[156:159], v[140:143], 0
    v_mfma_f32_16x16x32_bf16 v[48:51], v[160:163], v[140:143], 0
    ds_read_b64_tr_b16 v[214:215], v238 offset:12288
    v_mfma_f32_16x16x32_bf16 v[52:55], v[164:167], v[140:143], 0
    ds_read_b64_tr_b16 v[216:217], v235 offset:24576
    v_mfma_f32_16x16x32_bf16 v[56:59], v[168:171], v[140:143], 0
    ds_read_b64_tr_b16 v[218:219], v235 offset:28672
    v_mfma_f32_16x16x32_bf16 v[60:63], v[172:175], v[140:143], 0
    ds_read_b64_tr_b16 v[220:221], v236 offset:24576
    v_mfma_f32_16x16x32_bf16 v[64:67], v[176:179], v[140:143], 0
    v_mfma_f32_16x16x32_bf16 v[68:71], v[180:183], v[140:143], 0
    ds_read_b64_tr_b16 v[222:223], v236 offset:28672
    v_mfma_f32_16x16x32_bf16 v[72:75], v[152:155], v[144:147], 0
    ds_read_b64_tr_b16 v[224:225], v237 offset:24576
    v_mfma_f32_16x16x32_bf16 v[76:79], v[156:159], v[144:147], 0
    ds_read_b64_tr_b16 v[226:227], v237 offset:28672
    v_mfma_f32_16x16x32_bf16 v[80:83], v[160:163], v[144:147], 0
    ds_read_b64_tr_b16 v[228:229], v238 offset:24576
    v_mfma_f32_16x16x32_bf16 v[84:87], v[164:167], v[144:147], 0
    v_mfma_f32_16x16x32_bf16 v[88:91], v[168:171], v[144:147], 0
    ds_read_b64_tr_b16 v[230:231], v238 offset:28672
    v_mfma_f32_16x16x32_bf16 v[92:95], v[172:175], v[144:147], 0
    ds_read_b128 v[188:191], v232 offset:3072
    v_mfma_f32_16x16x32_bf16 v[96:99], v[176:179], v[144:147], 0
    ds_read_b128 v[192:195], v232 offset:5120
    v_mfma_f32_16x16x32_bf16 v[100:103], v[180:183], v[144:147], 0
    ds_read_b128 v[196:199], v232 offset:7168
    v_mfma_f32_16x16x32_bf16 v[104:107], v[152:155], v[148:151], 0
    v_mfma_f32_16x16x32_bf16 v[108:111], v[156:159], v[148:151], 0
    v_add_u32 v232, s52, v233
    v_mfma_f32_16x16x32_bf16 v[112:115], v[160:163], v[148:151], 0
    v_add_u32 v235, s52, v239
    v_mfma_f32_16x16x32_bf16 v[116:119], v[164:167], v[148:151], 0
    v_add_u32 v236, s52, v240
    v_mfma_f32_16x16x32_bf16 v[120:123], v[168:171], v[148:151], 0
    v_mfma_f32_16x16x32_bf16 v[124:127], v[172:175], v[148:151], 0
    v_add_u32 v237, s52, v241
    v_mfma_f32_16x16x32_bf16 v[128:131], v[176:179], v[148:151], 0
    v_add_u32 v238, s52, v242
    v_mfma_f32_16x16x32_bf16 v[132:135], v[180:183], v[148:151], 0
    s_waitcnt lgkmcnt(0)
    v_mfma_f32_16x16x32_bf16 v[8:11], v[200:203], v[184:187], v[8:11]
    v_mfma_f32_16x16x32_bf16 v[12:15], v[204:207], v[184:187], v[12:15]
    v_mfma_f32_16x16x32_bf16 v[16:19], v[208:211], v[184:187], v[16:19]
    v_mfma_f32_16x16x32_bf16 v[20:23], v[212:215], v[184:187], v[20:23]
    v_mfma_f32_16x16x32_bf16 v[24:27], v[216:219], v[184:187], v[24:27]
    v_mfma_f32_16x16x32_bf16 v[28:31], v[220:223], v[184:187], v[28:31]
    v_mfma_f32_16x16x32_bf16 v[32:35], v[224:227], v[184:187], v[32:35]
    v_mfma_f32_16x16x32_bf16 v[36:39], v[228:231], v[184:187], v[36:39]
    v_mfma_f32_16x16x32_bf16 v[40:43], v[200:203], v[188:191], v[40:43]
    v_mfma_f32_16x16x32_bf16 v[44:47], v[204:207], v[188:191], v[44:47]
    v_mfma_f32_16x16x32_bf16 v[48:51], v[208:211], v[188:191], v[48:51]
    v_mfma_f32_16x16x32_bf16 v[52:55], v[212:215], v[188:191], v[52:55]
    v_mfma_f32_16x16x32_bf16 v[56:59], v[216:219], v[188:191], v[56:59]
    v_mfma_f32_16x16x32_bf16 v[60:63], v[220:223], v[188:191], v[60:63]
    v_mfma_f32_16x16x32_bf16 v[64:67], v[224:227], v[188:191], v[64:67]
    v_mfma_f32_16x16x32_bf16 v[68:71], v[228:231], v[188:191], v[68:71]
    v_mfma_f32_16x16x32_bf16 v[72:75], v[200:203], v[192:195], v[72:75]
    v_mfma_f32_16x16x32_bf16 v[76:79], v[204:207], v[192:195], v[76:79]
    v_mfma_f32_16x16x32_bf16 v[80:83], v[208:211], v[192:195], v[80:83]
    v_mfma_f32_16x16x32_bf16 v[84:87], v[212:215], v[192:195], v[84:87]
    v_mfma_f32_16x16x32_bf16 v[88:91], v[216:219], v[192:195], v[88:91]
    v_mfma_f32_16x16x32_bf16 v[92:95], v[220:223], v[192:195], v[92:95]
    v_mfma_f32_16x16x32_bf16 v[96:99], v[224:227], v[192:195], v[96:99]
    v_mfma_f32_16x16x32_bf16 v[100:103], v[228:231], v[192:195], v[100:103]
    v_mfma_f32_16x16x32_bf16 v[104:107], v[200:203], v[196:199], v[104:107]
    v_mfma_f32_16x16x32_bf16 v[108:111], v[204:207], v[196:199], v[108:111]
    v_mfma_f32_16x16x32_bf16 v[112:115], v[208:211], v[196:199], v[112:115]
    v_mfma_f32_16x16x32_bf16 v[116:119], v[212:215], v[196:199], v[116:119]
    v_mfma_f32_16x16x32_bf16 v[120:123], v[216:219], v[196:199], v[120:123]
    v_mfma_f32_16x16x32_bf16 v[124:127], v[220:223], v[196:199], v[124:127]
    v_mfma_f32_16x16x32_bf16 v[128:131], v[224:227], v[196:199], v[128:131]
    v_mfma_f32_16x16x32_bf16 v[132:135], v[228:231], v[196:199], v[132:135]
    s_barrier
    s_barrier
    ds_read_b128 v[136:139], v232 offset:0
    ds_read_b64_tr_b16 v[152:153], v235 offset:0
    ds_read_b64_tr_b16 v[154:155], v235 offset:4096
    ds_read_b64_tr_b16 v[156:157], v236 offset:0
    ds_read_b64_tr_b16 v[158:159], v236 offset:4096
    ds_read_b64_tr_b16 v[160:161], v237 offset:0
    ds_read_b64_tr_b16 v[162:163], v237 offset:4096
    ds_read_b64_tr_b16 v[164:165], v238 offset:0
    ds_read_b64_tr_b16 v[166:167], v238 offset:4096
    ds_read_b64_tr_b16 v[168:169], v235 offset:16384
    ds_read_b64_tr_b16 v[170:171], v235 offset:20480
    ds_read_b64_tr_b16 v[172:173], v236 offset:16384
    ds_read_b64_tr_b16 v[174:175], v236 offset:20480
    ds_read_b64_tr_b16 v[176:177], v237 offset:16384
    ds_read_b64_tr_b16 v[178:179], v237 offset:20480
    ds_read_b64_tr_b16 v[180:181], v238 offset:16384
    ds_read_b64_tr_b16 v[182:183], v238 offset:20480
    ds_read_b128 v[140:143], v232 offset:2048
    ds_read_b128 v[144:147], v232 offset:4096
    ds_read_b128 v[148:151], v232 offset:6144
    s_add_u32 s52, s52, 49152
    s_cmp_ge_u32 s52, 147456
    s_cselect_b32 s52, 0, s52
    s_waitcnt lgkmcnt(0)
    v_mfma_f32_16x16x32_bf16 v[8:11], v[152:155], v[136:139], v[8:11]
    ds_read_b128 v[184:187], v232 offset:1024
    v_mfma_f32_16x16x32_bf16 v[12:15], v[156:159], v[136:139], v[12:15]
    ds_read_b64_tr_b16 v[200:201], v235 offset:8192
    v_mfma_f32_16x16x32_bf16 v[16:19], v[160:163], v[136:139], v[16:19]
    ds_read_b64_tr_b16 v[202:203], v235 offset:12288
    v_mfma_f32_16x16x32_bf16 v[20:23], v[164:167], v[136:139], v[20:23]
    ds_read_b64_tr_b16 v[204:205], v236 offset:8192
    v_mfma_f32_16x16x32_bf16 v[24:27], v[168:171], v[136:139], v[24:27]
    v_mfma_f32_16x16x32_bf16 v[28:31], v[172:175], v[136:139], v[28:31]
    ds_read_b64_tr_b16 v[206:207], v236 offset:12288
    v_mfma_f32_16x16x32_bf16 v[32:35], v[176:179], v[136:139], v[32:35]
    ds_read_b64_tr_b16 v[208:209], v237 offset:8192
    v_mfma_f32_16x16x32_bf16 v[36:39], v[180:183], v[136:139], v[36:39]
    ds_read_b64_tr_b16 v[210:211], v237 offset:12288
    v_mfma_f32_16x16x32_bf16 v[40:43], v[152:155], v[140:143], v[40:43]
    ds_read_b64_tr_b16 v[212:213], v238 offset:8192
    v_mfma_f32_16x16x32_bf16 v[44:47], v[156:159], v[140:143], v[44:47]
    v_mfma_f32_16x16x32_bf16 v[48:51], v[160:163], v[140:143], v[48:51]
    ds_read_b64_tr_b16 v[214:215], v238 offset:12288
    v_mfma_f32_16x16x32_bf16 v[52:55], v[164:167], v[140:143], v[52:55]
    ds_read_b64_tr_b16 v[216:217], v235 offset:24576
    v_mfma_f32_16x16x32_bf16 v[56:59], v[168:171], v[140:143], v[56:59]
    ds_read_b64_tr_b16 v[218:219], v235 offset:28672
    v_mfma_f32_16x16x32_bf16 v[60:63], v[172:175], v[140:143], v[60:63]
    ds_read_b64_tr_b16 v[220:221], v236 offset:24576
    v_mfma_f32_16x16x32_bf16 v[64:67], v[176:179], v[140:143], v[64:67]
    v_mfma_f32_16x16x32_bf16 v[68:71], v[180:183], v[140:143], v[68:71]
    ds_read_b64_tr_b16 v[222:223], v236 offset:28672
    v_mfma_f32_16x16x32_bf16 v[72:75], v[152:155], v[144:147], v[72:75]
    s_movk_i32 s54, 13
M_P_loop4:
    ds_read_b64_tr_b16 v[224:225], v237 offset:24576
    v_mfma_f32_16x16x32_bf16 v[76:79], v[156:159], v[144:147], v[76:79]
    ds_read_b64_tr_b16 v[226:227], v237 offset:28672
    v_mfma_f32_16x16x32_bf16 v[80:83], v[160:163], v[144:147], v[80:83]
    ds_read_b64_tr_b16 v[228:229], v238 offset:24576
    v_mfma_f32_16x16x32_bf16 v[84:87], v[164:167], v[144:147], v[84:87]
    v_mfma_f32_16x16x32_bf16 v[88:91], v[168:171], v[144:147], v[88:91]
    ds_read_b64_tr_b16 v[230:231], v238 offset:28672
    v_mfma_f32_16x16x32_bf16 v[92:95], v[172:175], v[144:147], v[92:95]
    ds_read_b128 v[188:191], v232 offset:3072
    v_mfma_f32_16x16x32_bf16 v[96:99], v[176:179], v[144:147], v[96:99]
    ds_read_b128 v[192:195], v232 offset:5120
    v_mfma_f32_16x16x32_bf16 v[100:103], v[180:183], v[144:147], v[100:103]
    ds_read_b128 v[196:199], v232 offset:7168
    v_mfma_f32_16x16x32_bf16 v[104:107], v[152:155], v[148:151], v[104:107]
    v_mfma_f32_16x16x32_bf16 v[108:111], v[156:159], v[148:151], v[108:111]
    v_add_u32 v232, s52, v233
    v_mfma_f32_16x16x32_bf16 v[112:115], v[160:163], v[148:151], v[112:115]
    v_add_u32 v235, s52, v239
    v_mfma_f32_16x16x32_bf16 v[116:119], v[164:167], v[148:151], v[116:119]
    v_add_u32 v236, s52, v240
    v_mfma_f32_16x16x32_bf16 v[120:123], v[168:171], v[148:151], v[120:123]
    v_mfma_f32_16x16x32_bf16 v[124:127], v[172:175], v[148:151], v[124:127]
    v_add_u32 v237, s52, v241
    v_mfma_f32_16x16x32_bf16 v[128:131], v[176:179], v[148:151], v[128:131]
    v_add_u32 v238, s52, v242
    v_mfma_f32_16x16x32_bf16 v[132:135], v[180:183], v[148:151], v[132:135]
    s_waitcnt lgkmcnt(0)
    v_mfma_f32_16x16x32_bf16 v[8:11], v[200:203], v[184:187], v[8:11]
    s_barrier
    v_mfma_f32_16x16x32_bf16 v[12:15], v[204:207], v[184:187], v[12:15]
    ds_read_b128 v[136:139], v232 offset:0
    v_mfma_f32_16x16x32_bf16 v[16:19], v[208:211], v[184:187], v[16:19]
    ds_read_b64_tr_b16 v[152:153], v235 offset:0
    v_mfma_f32_16x16x32_bf16 v[20:23], v[212:215], v[184:187], v[20:23]
    ds_read_b64_tr_b16 v[154:155], v235 offset:4096
    v_mfma_f32_16x16x32_bf16 v[24:27], v[216:219], v[184:187], v[24:27]
    ds_read_b64_tr_b16 v[156:157], v236 offset:0
    v_mfma_f32_16x16x32_bf16 v[28:31], v[220:223], v[184:187], v[28:31]
    ds_read_b64_tr_b16 v[158:159], v236 offset:4096
    v_mfma_f32_16x16x32_bf16 v[32:35], v[224:227], v[184:187], v[32:35]
    v_mfma_f32_16x16x32_bf16 v[36:39], v[228:231], v[184:187], v[36:39]
    ds_read_b64_tr_b16 v[160:161], v237 offset:0
    v_mfma_f32_16x16x32_bf16 v[40:43], v[200:203], v[188:191], v[40:43]
    ds_read_b64_tr_b16 v[162:163], v237 offset:4096
    v_mfma_f32_16x16x32_bf16 v[44:47], v[204:207], v[188:191], v[44:47]
    ds_read_b64_tr_b16 v[164:165], v238 offset:0
    v_mfma_f32_16x16x32_bf16 v[48:51], v[208:211], v[188:191], v[48:51]
    ds_read_b64_tr_b16 v[166:167], v238 offset:4096
    v_mfma_f32_16x16x32_bf16 v[52:55], v[212:215], v[188:191], v[52:55]
    ds_read_b64_tr_b16 v[168:169], v235 offset:16384
    v_mfma_f32_16x16x32_bf16 v[56:59], v[216:219], v[188:191], v[56:59]
    v_mfma_f32_16x16x32_bf16 v[60:63], v[220:223], v[188:191], v[60:63]
    ds_read_b64_tr_b16 v[170:171], v235 offset:20480
    v_mfma_f32_16x16x32_bf16 v[64:67], v[224:227], v[188:191], v[64:67]
    ds_read_b64_tr_b16 v[172:173], v236 offset:16384
    v_mfma_f32_16x16x32_bf16 v[68:71], v[228:231], v[188:191], v[68:71]
    ds_read_b64_tr_b16 v[174:175], v236 offset:20480
    v_mfma_f32_16x16x32_bf16 v[72:75], v[200:203], v[192:195], v[72:75]
    ds_read_b64_tr_b16 v[176:177], v237 offset:16384
    v_mfma_f32_16x16x32_bf16 v[76:79], v[204:207], v[192:195], v[76:79]
    ds_read_b64_tr_b16 v[178:179], v237 offset:20480
    v_mfma_f32_16x16x32_bf16 v[80:83], v[208:211], v[192:195], v[80:83]
    v_mfma_f32_16x16x32_bf16 v[84:87], v[212:215], v[192:195], v[84:87]
    ds_read_b64_tr_b16 v[180:181], v238 offset:16384
    v_mfma_f32_16x16x32_bf16 v[88:91], v[216:219], v[192:195], v[88:91]
    ds_read_b64_tr_b16 v[182:183], v238 offset:20480
    v_mfma_f32_16x16x32_bf16 v[92:95], v[220:223], v[192:195], v[92:95]
    ds_read_b128 v[140:143], v232 offset:2048
    v_mfma_f32_16x16x32_bf16 v[96:99], v[224:227], v[192:195], v[96:99]
    ds_read_b128 v[144:147], v232 offset:4096
    v_mfma_f32_16x16x32_bf16 v[100:103], v[228:231], v[192:195], v[100:103]
    ds_read_b128 v[148:151], v232 offset:6144
    v_mfma_f32_16x16x32_bf16 v[104:107], v[200:203], v[196:199], v[104:107]
    v_mfma_f32_16x16x32_bf16 v[108:111], v[204:207], v[196:199], v[108:111]
    v_mfma_f32_16x16x32_bf16 v[112:115], v[208:211], v[196:199], v[112:115]
    v_mfma_f32_16x16x32_bf16 v[116:119], v[212:215], v[196:199], v[116:119]
    v_mfma_f32_16x16x32_bf16 v[120:123], v[216:219], v[196:199], v[120:123]
    v_mfma_f32_16x16x32_bf16 v[124:127], v[220:223], v[196:199], v[124:127]
    v_mfma_f32_16x16x32_bf16 v[128:131], v[224:227], v[196:199], v[128:131]
    s_add_u32 s52, s52, 49152
    s_cmp_ge_u32 s52, 147456
    s_cselect_b32 s52, 0, s52
    v_mfma_f32_16x16x32_bf16 v[132:135], v[228:231], v[196:199], v[132:135]
    s_waitcnt lgkmcnt(0)
    v_mfma_f32_16x16x32_bf16 v[8:11], v[152:155], v[136:139], v[8:11]
    ds_read_b128 v[184:187], v232 offset:1024
    v_mfma_f32_16x16x32_bf16 v[12:15], v[156:159], v[136:139], v[12:15]
    ds_read_b64_tr_b16 v[200:201], v235 offset:8192
    v_mfma_f32_16x16x32_bf16 v[16:19], v[160:163], v[136:139], v[16:19]
    ds_read_b64_tr_b16 v[202:203], v235 offset:12288
    v_mfma_f32_16x16x32_bf16 v[20:23], v[164:167], v[136:139], v[20:23]
    ds_read_b64_tr_b16 v[204:205], v236 offset:8192
    v_mfma_f32_16x16x32_bf16 v[24:27], v[168:171], v[136:139], v[24:27]
    v_mfma_f32_16x16x32_bf16 v[28:31], v[172:175], v[136:139], v[28:31]
    ds_read_b64_tr_b16 v[206:207], v236 offset:12288
    v_mfma_f32_16x16x32_bf16 v[32:35], v[176:179], v[136:139], v[32:35]
    ds_read_b64_tr_b16 v[208:209], v237 offset:8192
    v_mfma_f32_16x16x32_bf16 v[36:39], v[180:183], v[136:139], v[36:39]
    ds_read_b64_tr_b16 v[210:211], v237 offset:12288
    v_mfma_f32_16x16x32_bf16 v[40:43], v[152:155], v[140:143], v[40:43]
    ds_read_b64_tr_b16 v[212:213], v238 offset:8192
    v_mfma_f32_16x16x32_bf16 v[44:47], v[156:159], v[140:143], v[44:47]
    v_mfma_f32_16x16x32_bf16 v[48:51], v[160:163], v[140:143], v[48:51]
    ds_read_b64_tr_b16 v[214:215], v238 offset:12288
    v_mfma_f32_16x16x32_bf16 v[52:55], v[164:167], v[140:143], v[52:55]
    ds_read_b64_tr_b16 v[216:217], v235 offset:24576
    v_mfma_f32_16x16x32_bf16 v[56:59], v[168:171], v[140:143], v[56:59]
    ds_read_b64_tr_b16 v[218:219], v235 offset:28672
    v_mfma_f32_16x16x32_bf16 v[60:63], v[172:175], v[140:143], v[60:63]
    ds_read_b64_tr_b16 v[220:221], v236 offset:24576
    v_mfma_f32_16x16x32_bf16 v[64:67], v[176:179], v[140:143], v[64:67]
    v_mfma_f32_16x16x32_bf16 v[68:71], v[180:183], v[140:143], v[68:71]
    s_sub_u32 s54, s54, 1
    ds_read_b64_tr_b16 v[222:223], v236 offset:28672
    v_mfma_f32_16x16x32_bf16 v[72:75], v[152:155], v[144:147], v[72:75]
    s_cbranch_scc0 M_P_loop4
    ds_read_b64_tr_b16 v[224:225], v237 offset:24576
    v_mfma_f32_16x16x32_bf16 v[76:79], v[156:159], v[144:147], v[76:79]
    ds_read_b64_tr_b16 v[226:227], v237 offset:28672
    v_mfma_f32_16x16x32_bf16 v[80:83], v[160:163], v[144:147], v[80:83]
    ds_read_b64_tr_b16 v[228:229], v238 offset:24576
    v_mfma_f32_16x16x32_bf16 v[84:87], v[164:167], v[144:147], v[84:87]
    v_mfma_f32_16x16x32_bf16 v[88:91], v[168:171], v[144:147], v[88:91]
    ds_read_b64_tr_b16 v[230:231], v238 offset:28672
    v_mfma_f32_16x16x32_bf16 v[92:95], v[172:175], v[144:147], v[92:95]
    ds_read_b128 v[188:191], v232 offset:3072
    v_mfma_f32_16x16x32_bf16 v[96:99], v[176:179], v[144:147], v[96:99]
    ds_read_b128 v[192:195], v232 offset:5120
    v_mfma_f32_16x16x32_bf16 v[100:103], v[180:183], v[144:147], v[100:103]
    ds_read_b128 v[196:199], v232 offset:7168
    v_mfma_f32_16x16x32_bf16 v[104:107], v[152:155], v[148:151], v[104:107]
    v_mfma_f32_16x16x32_bf16 v[108:111], v[156:159], v[148:151], v[108:111]
    v_mfma_f32_16x16x32_bf16 v[112:115], v[160:163], v[148:151], v[112:115]
    v_mfma_f32_16x16x32_bf16 v[116:119], v[164:167], v[148:151], v[116:119]
    v_mfma_f32_16x16x32_bf16 v[120:123], v[168:171], v[148:151], v[120:123]
    v_mfma_f32_16x16x32_bf16 v[124:127], v[172:175], v[148:151], v[124:127]
    v_mfma_f32_16x16x32_bf16 v[128:131], v[176:179], v[148:151], v[128:131]
    v_mfma_f32_16x16x32_bf16 v[132:135], v[180:183], v[148:151], v[132:135]
    s_waitcnt lgkmcnt(0)
    v_mfma_f32_16x16x32_bf16 v[8:11], v[200:203], v[184:187], v[8:11]
    s_barrier
    v_mfma_f32_16x16x32_bf16 v[12:15], v[204:207], v[184:187], v[12:15]
    v_mfma_f32_16x16x32_bf16 v[16:19], v[208:211], v[184:187], v[16:19]
    v_mfma_f32_16x16x32_bf16 v[20:23], v[212:215], v[184:187], v[20:23]
    v_mfma_f32_16x16x32_bf16 v[24:27], v[216:219], v[184:187], v[24:27]
    v_mfma_f32_16x16x32_bf16 v[28:31], v[220:223], v[184:187], v[28:31]
    v_mfma_f32_16x16x32_bf16 v[32:35], v[224:227], v[184:187], v[32:35]
    v_mfma_f32_16x16x32_bf16 v[36:39], v[228:231], v[184:187], v[36:39]
    v_mfma_f32_16x16x32_bf16 v[40:43], v[200:203], v[188:191], v[40:43]
    v_mfma_f32_16x16x32_bf16 v[44:47], v[204:207], v[188:191], v[44:47]
    v_mfma_f32_16x16x32_bf16 v[48:51], v[208:211], v[188:191], v[48:51]
    v_mfma_f32_16x16x32_bf16 v[52:55], v[212:215], v[188:191], v[52:55]
    v_mfma_f32_16x16x32_bf16 v[56:59], v[216:219], v[188:191], v[56:59]
    v_mfma_f32_16x16x32_bf16 v[60:63], v[220:223], v[188:191], v[60:63]
    v_mfma_f32_16x16x32_bf16 v[64:67], v[224:227], v[188:191], v[64:67]
    v_mfma_f32_16x16x32_bf16 v[68:71], v[228:231], v[188:191], v[68:71]
    v_mfma_f32_16x16x32_bf16 v[72:75], v[200:203], v[192:195], v[72:75]
    v_mfma_f32_16x16x32_bf16 v[76:79], v[204:207], v[192:195], v[76:79]
    v_mfma_f32_16x16x32_bf16 v[80:83], v[208:211], v[192:195], v[80:83]
    v_mfma_f32_16x16x32_bf16 v[84:87], v[212:215], v[192:195], v[84:87]
    v_mfma_f32_16x16x32_bf16 v[88:91], v[216:219], v[192:195], v[88:91]
    v_mfma_f32_16x16x32_bf16 v[92:95], v[220:223], v[192:195], v[92:95]
    v_mfma_f32_16x16x32_bf16 v[96:99], v[224:227], v[192:195], v[96:99]
    v_mfma_f32_16x16x32_bf16 v[100:103], v[228:231], v[192:195], v[100:103]
    v_mfma_f32_16x16x32_bf16 v[104:107], v[200:203], v[196:199], v[104:107]
    v_mfma_f32_16x16x32_bf16 v[108:111], v[204:207], v[196:199], v[108:111]
    v_mfma_f32_16x16x32_bf16 v[112:115], v[208:211], v[196:199], v[112:115]
    v_mfma_f32_16x16x32_bf16 v[116:119], v[212:215], v[196:199], v[116:119]
    v_mfma_f32_16x16x32_bf16 v[120:123], v[216:219], v[196:199], v[120:123]
    v_mfma_f32_16x16x32_bf16 v[124:127], v[220:223], v[196:199], v[124:127]
    v_mfma_f32_16x16x32_bf16 v[128:131], v[224:227], v[196:199], v[128:131]
    v_mfma_f32_16x16x32_bf16 v[132:135], v[228:231], v[196:199], v[132:135]
    s_setprio 0
    s_cmp_lg_u32 s69, 0
    s_cbranch_scc1 M_Pidle
    s_lshl_b32 s64, s47, 3
    s_lshl_b32 s65, s44, 1
    s_add_u32 s64, s64, s65
    s_mul_i32 s64, s64, 32768
    s_add_u32 s64, s64, 0x1000000
    v_lshl_add_u32 v184, v1, 4, s64
    v_add_u32 v185, 30720, v184
    s_lshr_b32 s65, s48, 2
    s_sub_u32 s65, s48, s65
    s_add_u32 s65, s65, 16
    s_lshl_b32 s65, s65, 8
    s_or_b32 s65, s65, s69
    v_lshrrev_b32 v3, 4, v1
    s_lshl_b32 s64, s44, 4
    v_add_u32 v2, s64, v3
    s_movk_i32 s64, 7168
    v_mul_u32_u24 v2, s64, v2
    v_add_u32 v2, s65, v2
    v_lshlrev_b32 v3, 1, v3
    v_and_b32 v4, 15, v1
    v_xor_b32 v3, v3, v4
    v_lshl_add_u32 v188, v3, 4, v2
    v_add_u32 v190, 55296, v188
    v_xor_b32 v3, 8, v3
    v_lshl_add_u32 v189, v3, 4, v2
    v_add_u32 v189, 27648, v189
    v_add_u32 v191, 55296, v189
    s_lshl_b32 s60, s44, 12
    s_add_u32 s61, s60, 147456
    s_add_u32 s53, s60, 49152
    s_bfe_u32 s66, s2, 0x30003
    s_lshr_b32 s55, s2, 6
    s_add_u32 s66, s66, s55
    s_mul_i32 s55, s66, 11
    s_lshr_b32 s55, s55, 5
    s_mul_i32 s55, s55, 3
    s_sub_u32 s66, s66, s55
    s_mov_b32 s58, 0x9a867534
    s_mov_b32 s59, 0xfecdb
    s_cmp_eq_u32 s66, 1
    s_cselect_b32 s58, 0xb9786453, s58
    s_cselect_b32 s59, 0xfdeca, s59
    s_cmp_eq_u32 s66, 2
    s_cselect_b32 s58, 0xa8975642, s58
    s_cselect_b32 s59, 0xefdbc, s59
    s_mov_b32 s32, s12
    s_mov_b32 s33, s13
    s_mov_b32 s34, 0x700000
    s_mov_b32 s35, 0x20000
    s_mov_b32 s36, s14
    s_mov_b32 s37, s15
    s_mov_b32 s38, 0x700000
    s_mov_b32 s39, 0x20000
    s_lshl_b32 s70, s48, 12
    s_lshl_b32 s64, s47, 3
    s_lshl_b32 s65, s45, 2
    s_add_u32 s64, s64, s65
    s_mul_i32 s64, s64, 114688
    s_add_u32 s64, s64, s70
    s_lshl_b32 s65, s46, 11
    s_add_u32 s64, s64, s65
    s_add_u32 s64, s64, 0x1500000
    v_lshl_add_u32 v198, v1, 4, s64
    v_mul_f32 v24, v8, v24
    v_exp_f32 v216, -v8
    v_mul_f32 v25, v9, v25
    v_exp_f32 v217, -v9
    v_mul_f32 v26, v10, v26
    v_exp_f32 v218, -v10
    v_mul_f32 v27, v11, v27
    v_exp_f32 v219, -v11
    v_mul_f32 v28, v12, v28
    v_exp_f32 v220, -v12
    v_mul_f32 v29, v13, v29
    v_exp_f32 v221, -v13
    v_mul_f32 v30, v14, v30
    v_exp_f32 v222, -v14
    v_mul_f32 v31, v15, v31
    v_exp_f32 v223, -v15
    s_barrier
    s_and_b32 s57, s58, 15
    s_lshr_b64 s[58:59], s[58:59], 4
    s_lshl_b32 s56, s57, 11
    s_mul_i32 s57, s57, 0x70000
    s_add_u32 m0, s53, 16384
    s_nop 0
    buffer_load_dwordx4 v188, s[32:35], s57 offen offset:0 lds
    v_fma_f32 v216, v216, s67, s67
    v_fma_f32 v217, v217, s67, s67
    v_rcp_f32 v216, v216
    v_fma_f32 v218, v218, s67, s67
    buffer_load_dwordx4 v189, s[32:35], s57 offen offset:1024 lds
    v_rcp_f32 v217, v217
    v_fma_f32 v219, v219, s67, s67
    v_rcp_f32 v218, v218
    v_fma_f32 v220, v220, s67, s67
    buffer_load_dwordx4 v190, s[32:35], s57 offen offset:2048 lds
    v_rcp_f32 v219, v219
    v_fma_f32 v221, v221, s67, s67
    v_rcp_f32 v220, v220
    v_fma_f32 v222, v222, s67, s67
    buffer_load_dwordx4 v191, s[32:35], s57 offen offset:3072 lds
    v_rcp_f32 v221, v221
    v_fma_f32 v223, v223, s67, s67
    v_rcp_f32 v222, v222
    v_rcp_f32 v223, v223
    s_add_u32 m0, s53, 32768
    s_nop 0
    buffer_load_dwordx4 v188, s[36:39], s57 offen offset:0 lds
    v_mul_f32 v24, v24, v216
    v_mul_f32 v25, v25, v217
    v_mul_f32 v26, v26, v218
    v_mul_f32 v27, v27, v219
    buffer_load_dwordx4 v189, s[36:39], s57 offen offset:1024 lds
    v_mul_f32 v28, v28, v220
    v_mul_f32 v29, v29, v221
    v_mul_f32 v30, v30, v222
    v_mul_f32 v31, v31, v223
    buffer_load_dwordx4 v190, s[36:39], s57 offen offset:2048 lds
    v_cvt_pk_bf16_f32 v200, v24, v25
    v_cvt_pk_bf16_f32 v201, v26, v27
    v_cvt_pk_bf16_f32 v202, v28, v29
    v_cvt_pk_bf16_f32 v203, v30, v31
    buffer_load_dwordx4 v191, s[36:39], s57 offen offset:3072 lds
    v_mul_f32 v32, v16, v32
    v_exp_f32 v224, -v16
    v_mul_f32 v33, v17, v33
    s_mov_b32 m0, s53
    s_nop 0
    buffer_load_dwordx4 v184, s[28:31], s56 offen offset:0 lds
    v_exp_f32 v225, -v17
    v_mul_f32 v34, v18, v34
    v_exp_f32 v226, -v18
    v_mul_f32 v35, v19, v35
    buffer_load_dwordx4 v184, s[28:31], s56 offen offset:1024 lds
    v_exp_f32 v227, -v19
    v_mul_f32 v36, v20, v36
    v_exp_f32 v228, -v20
    v_mul_f32 v37, v21, v37
    buffer_load_dwordx4 v185, s[28:31], s56 offen offset:2048 lds
    v_exp_f32 v229, -v21
    v_mul_f32 v38, v22, v38
    v_exp_f32 v230, -v22
    v_mul_f32 v39, v23, v39
    buffer_load_dwordx4 v185, s[28:31], s56 offen offset:3072 lds
    v_exp_f32 v231, -v23
    v_fma_f32 v224, v224, s67, s67
    v_fma_f32 v225, v225, s67, s67
    v_rcp_f32 v224, v224
    s_add_u32 s53, s53, 49152
    s_cmp_ge_u32 s53, s61
    s_cselect_b32 s53, s60, s53
    buffer_store_dwordx4 v[200:203], v198, s[28:31], 0 offen offset:0 sc1
    s_barrier
    s_and_b32 s57, s58, 15
    s_lshr_b64 s[58:59], s[58:59], 4
    s_lshl_b32 s56, s57, 11
    s_mul_i32 s57, s57, 0x70000
    s_add_u32 m0, s53, 16384
    s_nop 0
    buffer_load_dwordx4 v188, s[32:35], s57 offen offset:0 lds
    v_fma_f32 v226, v226, s67, s67
    v_rcp_f32 v225, v225
    v_fma_f32 v227, v227, s67, s67
    v_rcp_f32 v226, v226
    buffer_load_dwordx4 v189, s[32:35], s57 offen offset:1024 lds
    v_fma_f32 v228, v228, s67, s67
    v_rcp_f32 v227, v227
    v_fma_f32 v229, v229, s67, s67
    v_rcp_f32 v228, v228
    buffer_load_dwordx4 v190, s[32:35], s57 offen offset:2048 lds
    v_fma_f32 v230, v230, s67, s67
    v_rcp_f32 v229, v229
    v_fma_f32 v231, v231, s67, s67
    v_rcp_f32 v230, v230
    buffer_load_dwordx4 v191, s[32:35], s57 offen offset:3072 lds
    v_rcp_f32 v231, v231
    v_mul_f32 v32, v32, v224
    v_mul_f32 v33, v33, v225
    v_mul_f32 v34, v34, v226
    s_add_u32 m0, s53, 32768
    s_nop 0
    buffer_load_dwordx4 v188, s[36:39], s57 offen offset:0 lds
    v_mul_f32 v35, v35, v227
    v_mul_f32 v36, v36, v228
    v_mul_f32 v37, v37, v229
    v_mul_f32 v38, v38, v230
    buffer_load_dwordx4 v189, s[36:39], s57 offen offset:1024 lds
    v_mul_f32 v39, v39, v231
    v_cvt_pk_bf16_f32 v204, v32, v33
    v_cvt_pk_bf16_f32 v205, v34, v35
    v_cvt_pk_bf16_f32 v206, v36, v37
    buffer_load_dwordx4 v190, s[36:39], s57 offen offset:2048 lds
    v_cvt_pk_bf16_f32 v207, v38, v39
    v_mul_f32 v56, v40, v56
    buffer_load_dwordx4 v191, s[36:39], s57 offen offset:3072 lds
    v_exp_f32 v216, -v40
    v_mul_f32 v57, v41, v57
    v_exp_f32 v217, -v41
    v_mul_f32 v58, v42, v58
    s_mov_b32 m0, s53
    s_nop 0
    buffer_load_dwordx4 v184, s[28:31], s56 offen offset:0 lds
    v_exp_f32 v218, -v42
    v_mul_f32 v59, v43, v59
    v_exp_f32 v219, -v43
    v_mul_f32 v60, v44, v60
    buffer_load_dwordx4 v184, s[28:31], s56 offen offset:1024 lds
    v_exp_f32 v220, -v44
    v_mul_f32 v61, v45, v61
    v_exp_f32 v221, -v45
    v_mul_f32 v62, v46, v62
    buffer_load_dwordx4 v185, s[28:31], s56 offen offset:2048 lds
    v_exp_f32 v222, -v46
    v_mul_f32 v63, v47, v63
    v_exp_f32 v223, -v47
    v_fma_f32 v216, v216, s67, s67
    buffer_load_dwordx4 v185, s[28:31], s56 offen offset:3072 lds
    v_fma_f32 v217, v217, s67, s67
    v_rcp_f32 v216, v216
    v_fma_f32 v218, v218, s67, s67
    v_rcp_f32 v217, v217
    s_add_u32 s53, s53, 49152
    s_cmp_ge_u32 s53, s61
    s_cselect_b32 s53, s60, s53
    buffer_store_dwordx4 v[204:207], v198, s[28:31], 0 offen offset:1024 sc1
    v_add_u32 v198, 114688, v198
    s_waitcnt vmcnt(14)
    s_barrier
    s_and_b32 s57, s58, 15
    s_lshr_b64 s[58:59], s[58:59], 4
    s_lshl_b32 s56, s57, 11
    s_mul_i32 s57, s57, 0x70000
    s_add_u32 m0, s53, 16384
    s_nop 0
    buffer_load_dwordx4 v188, s[32:35], s57 offen offset:0 lds
    v_fma_f32 v219, v219, s67, s67
    v_rcp_f32 v218, v218
    v_fma_f32 v220, v220, s67, s67
    v_rcp_f32 v219, v219
    buffer_load_dwordx4 v189, s[32:35], s57 offen offset:1024 lds
    v_fma_f32 v221, v221, s67, s67
    v_rcp_f32 v220, v220
    v_fma_f32 v222, v222, s67, s67
    v_rcp_f32 v221, v221
    buffer_load_dwordx4 v190, s[32:35], s57 offen offset:2048 lds
    v_fma_f32 v223, v223, s67, s67
    v_rcp_f32 v222, v222
    v_rcp_f32 v223, v223
    v_mul_f32 v56, v56, v216
    buffer_load_dwordx4 v191, s[32:35], s57 offen offset:3072 lds
    v_mul_f32 v57, v57, v217
    v_mul_f32 v58, v58, v218
    v_mul_f32 v59, v59, v219
    v_mul_f32 v60, v60, v220
    s_add_u32 m0, s53, 32768
    s_nop 0
    buffer_load_dwordx4 v188, s[36:39], s57 offen offset:0 lds
    v_mul_f32 v61, v61, v221
    v_mul_f32 v62, v62, v222
    v_mul_f32 v63, v63, v223
    v_cvt_pk_bf16_f32 v208, v56, v57
    buffer_load_dwordx4 v189, s[36:39], s57 offen offset:1024 lds
    v_cvt_pk_bf16_f32 v209, v58, v59
    v_cvt_pk_bf16_f32 v210, v60, v61
    v_cvt_pk_bf16_f32 v211, v62, v63
    buffer_load_dwordx4 v190, s[36:39], s57 offen offset:2048 lds
    v_mul_f32 v64, v48, v64
    v_exp_f32 v224, -v48
    v_mul_f32 v65, v49, v65
    v_exp_f32 v225, -v49
    buffer_load_dwordx4 v191, s[36:39], s57 offen offset:3072 lds
    v_mul_f32 v66, v50, v66
    v_exp_f32 v226, -v50
    v_mul_f32 v67, v51, v67
    v_exp_f32 v227, -v51
    s_mov_b32 m0, s53
    s_nop 0
    buffer_load_dwordx4 v184, s[28:31], s56 offen offset:0 lds
    v_mul_f32 v68, v52, v68
    v_exp_f32 v228, -v52
    v_mul_f32 v69, v53, v69
    v_exp_f32 v229, -v53
    buffer_load_dwordx4 v184, s[28:31], s56 offen offset:1024 lds
    v_mul_f32 v70, v54, v70
    v_exp_f32 v230, -v54
    v_mul_f32 v71, v55, v71
    v_exp_f32 v231, -v55
    buffer_load_dwordx4 v185, s[28:31], s56 offen offset:2048 lds
    v_fma_f32 v224, v224, s67, s67
    v_fma_f32 v225, v225, s67, s67
    v_rcp_f32 v224, v224
    v_fma_f32 v226, v226, s67, s67
    buffer_load_dwordx4 v185, s[28:31], s56 offen offset:3072 lds
    v_rcp_f32 v225, v225
    v_fma_f32 v227, v227, s67, s67
    v_rcp_f32 v226, v226
    v_fma_f32 v228, v228, s67, s67
    s_add_u32 s53, s53, 49152
    s_cmp_ge_u32 s53, s61
    s_cselect_b32 s53, s60, s53
    buffer_store_dwordx4 v[208:211], v198, s[28:31], 0 offen offset:0 sc1
    s_waitcnt vmcnt(14)
    s_barrier
    s_and_b32 s57, s58, 15
    s_lshr_b64 s[58:59], s[58:59], 4
    s_lshl_b32 s56, s57, 11
    s_mul_i32 s57, s57, 0x70000
    s_add_u32 m0, s53, 16384
    s_nop 0
    buffer_load_dwordx4 v188, s[32:35], s57 offen offset:0 lds
    v_rcp_f32 v227, v227
    v_fma_f32 v229, v229, s67, s67
    v_rcp_f32 v228, v228
    v_fma_f32 v230, v230, s67, s67
    buffer_load_dwordx4 v189, s[32:35], s57 offen offset:1024 lds
    v_rcp_f32 v229, v229
    v_fma_f32 v231, v231, s67, s67
    v_rcp_f32 v230, v230
    v_rcp_f32 v231, v231
    buffer_load_dwordx4 v190, s[32:35], s57 offen offset:2048 lds
    v_mul_f32 v64, v64, v224
    v_mul_f32 v65, v65, v225
    v_mul_f32 v66, v66, v226
    v_mul_f32 v67, v67, v227
    buffer_load_dwordx4 v191, s[32:35], s57 offen offset:3072 lds
    v_mul_f32 v68, v68, v228
    v_mul_f32 v69, v69, v229
    v_mul_f32 v70, v70, v230
    v_mul_f32 v71, v71, v231
    s_add_u32 m0, s53, 32768
    s_nop 0
    buffer_load_dwordx4 v188, s[36:39], s57 offen offset:0 lds
    v_cvt_pk_bf16_f32 v212, v64, v65
    v_cvt_pk_bf16_f32 v213, v66, v67
    v_cvt_pk_bf16_f32 v214, v68, v69
    v_cvt_pk_bf16_f32 v215, v70, v71
    buffer_load_dwordx4 v189, s[36:39], s57 offen offset:1024 lds
    v_mul_f32 v88, v72, v88
    v_exp_f32 v216, -v72
    buffer_load_dwordx4 v190, s[36:39], s57 offen offset:2048 lds
    v_mul_f32 v89, v73, v89
    v_exp_f32 v217, -v73
    v_mul_f32 v90, v74, v90
    v_exp_f32 v218, -v74
    buffer_load_dwordx4 v191, s[36:39], s57 offen offset:3072 lds
    v_mul_f32 v91, v75, v91
    v_exp_f32 v219, -v75
    v_mul_f32 v92, v76, v92
    v_exp_f32 v220, -v76
    s_mov_b32 m0, s53
    s_nop 0
    buffer_load_dwordx4 v184, s[28:31], s56 offen offset:0 lds
    v_mul_f32 v93, v77, v93
    v_exp_f32 v221, -v77
    v_mul_f32 v94, v78, v94
    v_exp_f32 v222, -v78
    buffer_load_dwordx4 v184, s[28:31], s56 offen offset:1024 lds
    v_mul_f32 v95, v79, v95
    v_exp_f32 v223, -v79
    v_fma_f32 v216, v216, s67, s67
    v_fma_f32 v217, v217, s67, s67
    buffer_load_dwordx4 v185, s[28:31], s56 offen offset:2048 lds
    v_rcp_f32 v216, v216
    v_fma_f32 v218, v218, s67, s67
    v_rcp_f32 v217, v217
    v_fma_f32 v219, v219, s67, s67
    buffer_load_dwordx4 v185, s[28:31], s56 offen offset:3072 lds
    v_rcp_f32 v218, v218
    v_fma_f32 v220, v220, s67, s67
    v_rcp_f32 v219, v219
    v_fma_f32 v221, v221, s67, s67
    s_add_u32 s53, s53, 49152
    s_cmp_ge_u32 s53, s61
    s_cselect_b32 s53, s60, s53
    buffer_store_dwordx4 v[212:215], v198, s[28:31], 0 offen offset:1024 sc1
    v_add_u32 v198, 114688, v198
    s_waitcnt vmcnt(14)
    s_barrier
    s_and_b32 s57, s58, 15
    s_lshr_b64 s[58:59], s[58:59], 4
    s_lshl_b32 s56, s57, 11
    s_mul_i32 s57, s57, 0x70000
    s_add_u32 m0, s53, 16384
    s_nop 0
    buffer_load_dwordx4 v188, s[32:35], s57 offen offset:0 lds
    v_rcp_f32 v220, v220
    v_fma_f32 v222, v222, s67, s67
    v_rcp_f32 v221, v221
    v_fma_f32 v223, v223, s67, s67
    buffer_load_dwordx4 v189, s[32:35], s57 offen offset:1024 lds
    v_rcp_f32 v222, v222
    v_rcp_f32 v223, v223
    v_mul_f32 v88, v88, v216
    v_mul_f32 v89, v89, v217
    buffer_load_dwordx4 v190, s[32:35], s57 offen offset:2048 lds
    v_mul_f32 v90, v90, v218
    v_mul_f32 v91, v91, v219
    v_mul_f32 v92, v92, v220
    v_mul_f32 v93, v93, v221
    buffer_load_dwordx4 v191, s[32:35], s57 offen offset:3072 lds
    v_mul_f32 v94, v94, v222
    v_mul_f32 v95, v95, v223
    v_cvt_pk_bf16_f32 v200, v88, v89
    v_cvt_pk_bf16_f32 v201, v90, v91
    s_add_u32 m0, s53, 32768
    s_nop 0
    buffer_load_dwordx4 v188, s[36:39], s57 offen offset:0 lds
    v_cvt_pk_bf16_f32 v202, v92, v93
    v_cvt_pk_bf16_f32 v203, v94, v95
    v_mul_f32 v96, v80, v96
    buffer_load_dwordx4 v189, s[36:39], s57 offen offset:1024 lds
    v_exp_f32 v224, -v80
    v_mul_f32 v97, v81, v97
    v_exp_f32 v225, -v81
    v_mul_f32 v98, v82, v98
    buffer_load_dwordx4 v190, s[36:39], s57 offen offset:2048 lds
    v_exp_f32 v226, -v82
    v_mul_f32 v99, v83, v99
    v_exp_f32 v227, -v83
    v_mul_f32 v100, v84, v100
    buffer_load_dwordx4 v191, s[36:39], s57 offen offset:3072 lds
    v_exp_f32 v228, -v84
    v_mul_f32 v101, v85, v101
    v_exp_f32 v229, -v85
    v_mul_f32 v102, v86, v102
    s_mov_b32 m0, s53
    s_nop 0
    buffer_load_dwordx4 v184, s[28:31], s56 offen offset:0 lds
    v_exp_f32 v230, -v86
    v_mul_f32 v103, v87, v103
    v_exp_f32 v231, -v87
    v_fma_f32 v224, v224, s67, s67
    buffer_load_dwordx4 v184, s[28:31], s56 offen offset:1024 lds
    v_fma_f32 v225, v225, s67, s67
    v_rcp_f32 v224, v224
    v_fma_f32 v226, v226, s67, s67
    v_rcp_f32 v225, v225
    buffer_load_dwordx4 v185, s[28:31], s56 offen offset:2048 lds
    v_fma_f32 v227, v227, s67, s67
    v_rcp_f32 v226, v226
    v_fma_f32 v228, v228, s67, s67
    v_rcp_f32 v227, v227
    buffer_load_dwordx4 v185, s[28:31], s56 offen offset:3072 lds
    v_fma_f32 v229, v229, s67, s67
    v_rcp_f32 v228, v228
    v_fma_f32 v230, v230, s67, s67
    v_rcp_f32 v229, v229
    s_add_u32 s53, s53, 49152
    s_cmp_ge_u32 s53, s61
    s_cselect_b32 s53, s60, s53
    buffer_store_dwordx4 v[200:203], v198, s[28:31], 0 offen offset:0 sc1
    s_waitcnt vmcnt(14)
    s_barrier
    s_and_b32 s57, s58, 15
    s_lshr_b64 s[58:59], s[58:59], 4
    s_lshl_b32 s56, s57, 11
    s_mul_i32 s57, s57, 0x70000
    s_add_u32 m0, s53, 16384
    s_nop 0
    buffer_load_dwordx4 v188, s[32:35], s57 offen offset:0 lds
    v_fma_f32 v231, v231, s67, s67
    v_rcp_f32 v230, v230
    v_rcp_f32 v231, v231
    v_mul_f32 v96, v96, v224
    buffer_load_dwordx4 v189, s[32:35], s57 offen offset:1024 lds
    v_mul_f32 v97, v97, v225
    v_mul_f32 v98, v98, v226
    v_mul_f32 v99, v99, v227
    v_mul_f32 v100, v100, v228
    buffer_load_dwordx4 v190, s[32:35], s57 offen offset:2048 lds
    v_mul_f32 v101, v101, v229
    v_mul_f32 v102, v102, v230
    v_mul_f32 v103, v103, v231
    v_cvt_pk_bf16_f32 v204, v96, v97
    buffer_load_dwordx4 v191, s[32:35], s57 offen offset:3072 lds
    v_cvt_pk_bf16_f32 v205, v98, v99
    v_cvt_pk_bf16_f32 v206, v100, v101
    v_cvt_pk_bf16_f32 v207, v102, v103
    s_add_u32 m0, s53, 32768
    s_nop 0
    buffer_load_dwordx4 v188, s[36:39], s57 offen offset:0 lds
    v_mul_f32 v120, v104, v120
    v_exp_f32 v216, -v104
    v_mul_f32 v121, v105, v121
    buffer_load_dwordx4 v189, s[36:39], s57 offen offset:1024 lds
    v_exp_f32 v217, -v105
    v_mul_f32 v122, v106, v122
    v_exp_f32 v218, -v106
    v_mul_f32 v123, v107, v123
    buffer_load_dwordx4 v190, s[36:39], s57 offen offset:2048 lds
    v_exp_f32 v219, -v107
    v_mul_f32 v124, v108, v124
    v_exp_f32 v220, -v108
    v_mul_f32 v125, v109, v125
    buffer_load_dwordx4 v191, s[36:39], s57 offen offset:3072 lds
    v_exp_f32 v221, -v109
    v_mul_f32 v126, v110, v126
    v_exp_f32 v222, -v110
    v_mul_f32 v127, v111, v127
    s_mov_b32 m0, s53
    s_nop 0
    buffer_load_dwordx4 v184, s[28:31], s56 offen offset:0 lds
    v_exp_f32 v223, -v111
    v_fma_f32 v216, v216, s67, s67
    v_fma_f32 v217, v217, s67, s67
    v_rcp_f32 v216, v216
    buffer_load_dwordx4 v184, s[28:31], s56 offen offset:1024 lds
    v_fma_f32 v218, v218, s67, s67
    v_rcp_f32 v217, v217
    v_fma_f32 v219, v219, s67, s67
    v_rcp_f32 v218, v218
    buffer_load_dwordx4 v185, s[28:31], s56 offen offset:2048 lds
    v_fma_f32 v220, v220, s67, s67
    v_rcp_f32 v219, v219
    v_fma_f32 v221, v221, s67, s67
    v_rcp_f32 v220, v220
    buffer_load_dwordx4 v185, s[28:31], s56 offen offset:3072 lds
    v_fma_f32 v222, v222, s67, s67
    v_rcp_f32 v221, v221
    v_fma_f32 v223, v223, s67, s67
    v_rcp_f32 v222, v222
    s_add_u32 s53, s53, 49152
    s_cmp_ge_u32 s53, s61
    s_cselect_b32 s53, s60, s53
    buffer_store_dwordx4 v[204:207], v198, s[28:31], 0 offen offset:1024 sc1
    v_add_u32 v198, 114688, v198
    s_waitcnt vmcnt(14)
    s_barrier
    s_and_b32 s57, s58, 15
    s_lshr_b64 s[58:59], s[58:59], 4
    s_lshl_b32 s56, s57, 11
    s_mul_i32 s57, s57, 0x70000
    s_add_u32 m0, s53, 16384
    s_nop 0
    buffer_load_dwordx4 v188, s[32:35], s57 offen offset:0 lds
    v_rcp_f32 v223, v223
    v_mul_f32 v120, v120, v216
    v_mul_f32 v121, v121, v217
    v_mul_f32 v122, v122, v218
    buffer_load_dwordx4 v189, s[32:35], s57 offen offset:1024 lds
    v_mul_f32 v123, v123, v219
    v_mul_f32 v124, v124, v220
    v_mul_f32 v125, v125, v221
    v_mul_f32 v126, v126, v222
    buffer_load_dwordx4 v190, s[32:35], s57 offen offset:2048 lds
    v_mul_f32 v127, v127, v223
    v_cvt_pk_bf16_f32 v208, v120, v121
    v_cvt_pk_bf16_f32 v209, v122, v123
    v_cvt_pk_bf16_f32 v210, v124, v125
    buffer_load_dwordx4 v191, s[32:35], s57 offen offset:3072 lds
    v_cvt_pk_bf16_f32 v211, v126, v127
    v_mul_f32 v128, v112, v128
    v_exp_f32 v224, -v112
    s_add_u32 m0, s53, 32768
    s_nop 0
    buffer_load_dwordx4 v188, s[36:39], s57 offen offset:0 lds
    v_mul_f32 v129, v113, v129
    v_exp_f32 v225, -v113
    v_mul_f32 v130, v114, v130
    v_exp_f32 v226, -v114
    buffer_load_dwordx4 v189, s[36:39], s57 offen offset:1024 lds
    v_mul_f32 v131, v115, v131
    v_exp_f32 v227, -v115
    v_mul_f32 v132, v116, v132
    v_exp_f32 v228, -v116
    buffer_load_dwordx4 v190, s[36:39], s57 offen offset:2048 lds
    v_mul_f32 v133, v117, v133
    v_exp_f32 v229, -v117
    v_mul_f32 v134, v118, v134
    v_exp_f32 v230, -v118
    buffer_load_dwordx4 v191, s[36:39], s57 offen offset:3072 lds
    v_mul_f32 v135, v119, v135
    v_exp_f32 v231, -v119
    v_fma_f32 v224, v224, s67, s67
    v_fma_f32 v225, v225, s67, s67
    s_mov_b32 m0, s53
    s_nop 0
    buffer_load_dwordx4 v184, s[28:31], s56 offen offset:0 lds
    v_rcp_f32 v224, v224
    v_fma_f32 v226, v226, s67, s67
    v_rcp_f32 v225, v225
    v_fma_f32 v227, v227, s67, s67
    buffer_load_dwordx4 v184, s[28:31], s56 offen offset:1024 lds
    v_rcp_f32 v226, v226
    v_fma_f32 v228, v228, s67, s67
    v_rcp_f32 v227, v227
    v_fma_f32 v229, v229, s67, s67
    buffer_load_dwordx4 v185, s[28:31], s56 offen offset:2048 lds
    v_rcp_f32 v228, v228
    v_fma_f32 v230, v230, s67, s67
    v_rcp_f32 v229, v229
    v_fma_f32 v231, v231, s67, s67
    buffer_load_dwordx4 v185, s[28:31], s56 offen offset:3072 lds
    v_rcp_f32 v230, v230
    v_rcp_f32 v231, v231
    v_mul_f32 v128, v128, v224
    v_mul_f32 v129, v129, v225
    s_add_u32 s53, s53, 49152
    s_cmp_ge_u32 s53, s61
    s_cselect_b32 s53, s60, s53
    buffer_store_dwordx4 v[208:211], v198, s[28:31], 0 offen offset:0 sc1
    s_waitcnt vmcnt(14)
    s_barrier
    s_and_b32 s57, s58, 15
    s_lshr_b64 s[58:59], s[58:59], 4
    s_lshl_b32 s56, s57, 11
    s_mul_i32 s57, s57, 0x70000
    s_add_u32 m0, s53, 16384
    s_nop 0
    buffer_load_dwordx4 v188, s[32:35], s57 offen offset:0 lds
    v_mul_f32 v130, v130, v226
    v_mul_f32 v131, v131, v227
    v_mul_f32 v132, v132, v228
    v_mul_f32 v133, v133, v229
    buffer_load_dwordx4 v189, s[32:35], s57 offen offset:1024 lds
    v_mul_f32 v134, v134, v230
    v_mul_f32 v135, v135, v231
    v_cvt_pk_bf16_f32 v212, v128, v129
    v_cvt_pk_bf16_f32 v213, v130, v131
    buffer_load_dwordx4 v190, s[32:35], s57 offen offset:2048 lds
    v_cvt_pk_bf16_f32 v214, v132, v133
    v_cvt_pk_bf16_f32 v215, v134, v135
    buffer_load_dwordx4 v191, s[32:35], s57 offen offset:3072 lds
    s_add_u32 m0, s53, 32768
    s_nop 0
    buffer_load_dwordx4 v188, s[36:39], s57 offen offset:0 lds
    buffer_load_dwordx4 v189, s[36:39], s57 offen offset:1024 lds
    buffer_load_dwordx4 v190, s[36:39], s57 offen offset:2048 lds
    buffer_load_dwordx4 v191, s[36:39], s57 offen offset:3072 lds
    s_mov_b32 m0, s53
    s_nop 0
    buffer_load_dwordx4 v184, s[28:31], s56 offen offset:0 lds
    buffer_load_dwordx4 v184, s[28:31], s56 offen offset:1024 lds
    buffer_load_dwordx4 v185, s[28:31], s56 offen offset:2048 lds
    buffer_load_dwordx4 v185, s[28:31], s56 offen offset:3072 lds
    s_add_u32 s53, s53, 49152
    s_cmp_ge_u32 s53, s61
    s_cselect_b32 s53, s60, s53
    buffer_store_dwordx4 v[212:215], v198, s[28:31], 0 offen offset:1024 sc1
    s_waitcnt vmcnt(14)
    s_barrier
    s_and_b32 s57, s58, 15
    s_lshr_b64 s[58:59], s[58:59], 4
    s_lshl_b32 s56, s57, 11
    s_mul_i32 s57, s57, 0x70000
    s_add_u32 m0, s53, 16384
    s_nop 0
    buffer_load_dwordx4 v188, s[32:35], s57 offen offset:0 lds
    buffer_load_dwordx4 v189, s[32:35], s57 offen offset:1024 lds
    buffer_load_dwordx4 v190, s[32:35], s57 offen offset:2048 lds
    buffer_load_dwordx4 v191, s[32:35], s57 offen offset:3072 lds
    s_add_u32 m0, s53, 32768
    s_nop 0
    buffer_load_dwordx4 v188, s[36:39], s57 offen offset:0 lds
    buffer_load_dwordx4 v189, s[36:39], s57 offen offset:1024 lds
    buffer_load_dwordx4 v190, s[36:39], s57 offen offset:2048 lds
    buffer_load_dwordx4 v191, s[36:39], s57 offen offset:3072 lds
    s_mov_b32 m0, s53
    s_nop 0
    buffer_load_dwordx4 v184, s[28:31], s56 offen offset:0 lds
    buffer_load_dwordx4 v184, s[28:31], s56 offen offset:1024 lds
    buffer_load_dwordx4 v185, s[28:31], s56 offen offset:2048 lds
    buffer_load_dwordx4 v185, s[28:31], s56 offen offset:3072 lds
    s_add_u32 s53, s53, 49152
    s_cmp_ge_u32 s53, s61
    s_cselect_b32 s53, s60, s53
    s_lshl_b32 s64, s47, 8
    s_lshl_b32 s65, s48, 4
    s_add_u32 s64, s64, s65
    s_lshl_b32 s65, s44, 2
    s_add_u32 s64, s64, s65
    s_add_u32 s64, s64, 0x51000
    v_mov_b32 v2, s0
    s_waitcnt vmcnt(12)
    s_mov_b64 exec, 1
    buffer_store_dword v2, v234, s[28:31], s64 offen sc1
    s_mov_b64 exec, -1
    s_lshl_b32 s64, s50, 3
    s_lshl_b32 s65, s44, 1
    s_add_u32 s64, s64, s65
    s_mul_i32 s64, s64, 114688
    s_add_u32 s64, s64, 0x1500000
    v_lshl_add_u32 v192, v1, 4, s64
    v_add_u32 v193, 112640, v192
    s_lshl_b32 s65, s51, 8
    v_lshrrev_b32 v3, 4, v1
    s_lshl_b32 s64, s44, 4
    v_add_u32 v2, s64, v3
    s_movk_i32 s64, 2048
    v_mul_u32_u24 v2, s64, v2
    v_add_u32 v2, s65, v2
    v_lshlrev_b32 v3, 1, v3
    v_and_b32 v4, 15, v1
    v_xor_b32 v3, v3, v4
    v_lshl_add_u32 v194, v3, 4, v2
    v_add_u32 v196, 14336, v194
    v_xor_b32 v3, 8, v3
    v_lshl_add_u32 v195, v3, 4, v2
    v_add_u32 v195, 7168, v195
    v_add_u32 v197, 14336, v195
    s_barrier
    s_and_b32 s57, s58, 15
    s_lshr_b64 s[58:59], s[58:59], 4
    s_lshl_b32 s56, s57, 11
    s_mul_i32 s57, s57, 0x70000
    s_add_u32 m0, s53, 16384
    s_nop 0
    buffer_load_dwordx4 v188, s[32:35], s57 offen offset:0 lds
    buffer_load_dwordx4 v189, s[32:35], s57 offen offset:1024 lds
    buffer_load_dwordx4 v190, s[32:35], s57 offen offset:2048 lds
    buffer_load_dwordx4 v191, s[32:35], s57 offen offset:3072 lds
    s_add_u32 m0, s53, 32768
    s_nop 0
    buffer_load_dwordx4 v188, s[36:39], s57 offen offset:0 lds
    buffer_load_dwordx4 v189, s[36:39], s57 offen offset:1024 lds
    buffer_load_dwordx4 v190, s[36:39], s57 offen offset:2048 lds
    buffer_load_dwordx4 v191, s[36:39], s57 offen offset:3072 lds
    s_mov_b32 m0, s53
    s_nop 0
    buffer_load_dwordx4 v184, s[28:31], s56 offen offset:0 lds
    buffer_load_dwordx4 v184, s[28:31], s56 offen offset:1024 lds
    buffer_load_dwordx4 v185, s[28:31], s56 offen offset:2048 lds
    buffer_load_dwordx4 v185, s[28:31], s56 offen offset:3072 lds
    s_add_u32 s53, s53, 49152
    s_cmp_ge_u32 s53, s61
    s_cselect_b32 s53, s60, s53
    s_waitcnt vmcnt(13)
    s_barrier
    s_and_b32 s57, s58, 15
    s_lshr_b64 s[58:59], s[58:59], 4
    s_lshl_b32 s56, s57, 11
    s_mul_i32 s57, s57, 0x70000
    s_add_u32 m0, s53, 16384
    s_nop 0
    buffer_load_dwordx4 v188, s[32:35], s57 offen offset:0 lds
    buffer_load_dwordx4 v189, s[32:35], s57 offen offset:1024 lds
    buffer_load_dwordx4 v190, s[32:35], s57 offen offset:2048 lds
    buffer_load_dwordx4 v191, s[32:35], s57 offen offset:3072 lds
    s_add_u32 m0, s53, 32768
    s_nop 0
    buffer_load_dwordx4 v188, s[36:39], s57 offen offset:0 lds
    buffer_load_dwordx4 v189, s[36:39], s57 offen offset:1024 lds
    buffer_load_dwordx4 v190, s[36:39], s57 offen offset:2048 lds
    buffer_load_dwordx4 v191, s[36:39], s57 offen offset:3072 lds
    s_mov_b32 m0, s53
    s_nop 0
    buffer_load_dwordx4 v184, s[28:31], s56 offen offset:0 lds
    buffer_load_dwordx4 v184, s[28:31], s56 offen offset:1024 lds
    buffer_load_dwordx4 v185, s[28:31], s56 offen offset:2048 lds
    buffer_load_dwordx4 v185, s[28:31], s56 offen offset:3072 lds
    s_add_u32 s53, s53, 49152
    s_cmp_ge_u32 s53, s61
    s_cselect_b32 s53, s60, s53
    s_waitcnt vmcnt(12)
    s_barrier
    s_and_b32 s57, s58, 15
    s_lshr_b64 s[58:59], s[58:59], 4
    s_lshl_b32 s56, s57, 11
    s_mul_i32 s57, s57, 0x70000
    s_add_u32 m0, s53, 16384
    s_nop 0
    buffer_load_dwordx4 v188, s[32:35], s57 offen offset:0 lds
    buffer_load_dwordx4 v189, s[32:35], s57 offen offset:1024 lds
    buffer_load_dwordx4 v190, s[32:35], s57 offen offset:2048 lds
    buffer_load_dwordx4 v191, s[32:35], s57 offen offset:3072 lds
    s_add_u32 m0, s53, 32768
    s_nop 0
    buffer_load_dwordx4 v188, s[36:39], s57 offen offset:0 lds
    buffer_load_dwordx4 v189, s[36:39], s57 offen offset:1024 lds
    buffer_load_dwordx4 v190, s[36:39], s57 offen offset:2048 lds
    buffer_load_dwordx4 v191, s[36:39], s57 offen offset:3072 lds
    s_mov_b32 m0, s53
    s_nop 0
    buffer_load_dwordx4 v184, s[28:31], s56 offen offset:0 lds
    buffer_load_dwordx4 v184, s[28:31], s56 offen offset:1024 lds
    buffer_load_dwordx4 v185, s[28:31], s56 offen offset:2048 lds
    buffer_load_dwordx4 v185, s[28:31], s56 offen offset:3072 lds
    s_add_u32 s53, s53, 49152
    s_cmp_ge_u32 s53, s61
    s_cselect_b32 s53, s60, s53
    s_waitcnt vmcnt(12)
    s_barrier
    s_lshl_b32 s68, s50, 8
    s_add_u32 s68, s68, 0x51000
    buffer_load_dword v245, v234, s[28:31], s68 offen sc1
    s_and_b32 s57, s58, 15
    s_lshr_b64 s[58:59], s[58:59], 4
    s_lshl_b32 s56, s57, 11
    s_mul_i32 s57, s57, 0x70000
    s_add_u32 m0, s53, 16384
    s_nop 0
    buffer_load_dwordx4 v188, s[32:35], s57 offen offset:0 lds
    buffer_load_dwordx4 v189, s[32:35], s57 offen offset:1024 lds
    buffer_load_dwordx4 v190, s[32:35], s57 offen offset:2048 lds
    buffer_load_dwordx4 v191, s[32:35], s57 offen offset:3072 lds
    s_add_u32 m0, s53, 32768
    s_nop 0
    buffer_load_dwordx4 v188, s[36:39], s57 offen offset:0 lds
    buffer_load_dwordx4 v189, s[36:39], s57 offen offset:1024 lds
    buffer_load_dwordx4 v190, s[36:39], s57 offen offset:2048 lds
    buffer_load_dwordx4 v191, s[36:39], s57 offen offset:3072 lds
    s_mov_b32 m0, s53
    s_nop 0
    buffer_load_dwordx4 v184, s[28:31], s56 offen offset:0 lds
    buffer_load_dwordx4 v184, s[28:31], s56 offen offset:1024 lds
    buffer_load_dwordx4 v185, s[28:31], s56 offen offset:2048 lds
    buffer_load_dwordx4 v185, s[28:31], s56 offen offset:3072 lds
    s_add_u32 s53, s53, 49152
    s_cmp_ge_u32 s53, s61
    s_cselect_b32 s53, s60, s53
    s_waitcnt vmcnt(13)
    s_barrier
M_Pjoin:
    s_waitcnt vmcnt(12)
    s_mov_b32 s3, 0x40000
M_pa_chk:
    v_cmp_ne_u32 vcc, s0, v245
    s_nop 4
    s_cbranch_vccz M_pa_ok
    s_sub_u32 s3, s3, 1
    s_cbranch_scc1 M_pa_ok
    s_sleep 4
    s_cmp_eq_u32 s69, 0
    s_cbranch_scc1 M_pa_rl
    s_sleep 48
M_pa_rl:
    buffer_load_dword v245, v234, s[28:31], s68 offen sc1
    s_waitcnt vmcnt(0)
    s_branch M_pa_chk
M_pa_ok:
    s_lshl_b32 s60, s44, 12
    s_add_u32 s61, s60, 163840
    s_add_u32 s53, s60, 98304
    s_add_u32 s66, s50, s51
    s_and_b32 s66, s66, 3
    s_mov_b32 s58, 0x76453201
    s_mov_b32 s59, 0xfecdba89
    s_cmp_eq_u32 s66, 1
    s_cselect_b32 s58, 0x75643120, s58
    s_cselect_b32 s59, 0xfdecb9a8, s59
    s_cmp_eq_u32 s66, 2
    s_cselect_b32 s58, 0x67542310, s58
    s_cselect_b32 s59, 0xefdcab98, s59
    s_cmp_eq_u32 s66, 3
    s_cselect_b32 s58, 0x86534210, s58
    s_cselect_b32 s59, 0xfedbca97, s59
    s_cmp_eq_u32 s49, 0
    s_cselect_b32 s55, 16, 0
    s_mov_b32 s32, s16
    s_mov_b32 s33, s17
    s_mov_b32 s34, 0x700000
    s_mov_b32 s35, 0x20000
    s_and_b32 s57, s58, 15
    s_lshr_b64 s[58:59], s[58:59], 4
    s_add_u32 s57, s57, s55
    s_lshl_b32 s56, s57, 11
    s_mul_i32 s57, s57, 0x20000
    s_add_u32 m0, s53, 16384
    s_nop 0
    buffer_load_dwordx4 v194, s[32:35], s57 offen offset:0 lds
    buffer_load_dwordx4 v195, s[32:35], s57 offen offset:1024 lds
    buffer_load_dwordx4 v196, s[32:35], s57 offen offset:2048 lds
    buffer_load_dwordx4 v197, s[32:35], s57 offen offset:3072 lds
    s_mov_b32 m0, s53
    s_nop 0
    buffer_load_dwordx4 v192, s[28:31], s56 offen offset:0 lds
    buffer_load_dwordx4 v192, s[28:31], s56 offen offset:1024 lds
    buffer_load_dwordx4 v193, s[28:31], s56 offen offset:2048 lds
    buffer_load_dwordx4 v193, s[28:31], s56 offen offset:3072 lds
    s_add_u32 s53, s53, 32768
    s_cmp_ge_u32 s53, s61
    s_cselect_b32 s53, s60, s53
    s_and_b32 s57, s58, 15
    s_lshr_b64 s[58:59], s[58:59], 4
    s_add_u32 s57, s57, s55
    s_lshl_b32 s56, s57, 11
    s_mul_i32 s57, s57, 0x20000
    s_add_u32 m0, s53, 16384
    s_nop 0
    buffer_load_dwordx4 v194, s[32:35], s57 offen offset:0 lds
    buffer_load_dwordx4 v195, s[32:35], s57 offen offset:1024 lds
    buffer_load_dwordx4 v196, s[32:35], s57 offen offset:2048 lds
    buffer_load_dwordx4 v197, s[32:35], s57 offen offset:3072 lds
    v_and_b32 v2, 15, v1
    s_lshl_b32 s70, s50, 1
    s_add_u32 s70, s70, s45
    s_lshl_b32 s71, s51, 1
    s_add_u32 s71, s71, s46
    s_lshl_b32 s64, s70, 17
    s_lshl_b32 s65, s71, 7
    s_add_u32 s64, s64, s65
    v_lshl_add_u32 v2, v2, 11, s64
    v_bfe_u32 v3, v1, 4, 1
    v_lshl_add_u32 v2, v3, 5, v2
    v_lshrrev_b32 v3, 5, v1
    v_lshl_add_u32 v184, v3, 4, v2
    s_cmp_eq_u32 s49, 0
    s_cselect_b32 s63, 0x80000000, 0
    s_mul_i32 s64, s70, 131072
    s_lshl_b32 s65, s71, 11
    s_add_u32 s64, s64, s65
    s_add_u32 s64, s64, 0xb00000
    s_or_b32 s64, s64, s63
    v_lshl_add_u32 v188, v1, 4, s64
    s_lshl_b32 s64, s50, 12
    s_lshl_b32 s65, s71, 8
    s_add_u32 s64, s64, s65
    s_add_u32 s64, s64, 0xc0000
    s_or_b32 s64, s64, s63
    v_and_b32 v2, 48, v1
    v_add_u32 v185, s64, v2
    s_lshl_b32 s64, s50, 3
    s_add_u32 s64, s64, s51
    s_lshl_b32 s64, s64, 2
    s_add_u32 s64, s64, s44
    s_lshl_b32 s65, s64, 13
    s_add_u32 s65, s65, 0x2400000
    v_lshl_add_u32 v186, v1, 4, s65
    s_lshl_b32 s65, s64, 2
    s_add_u32 s65, s65, 0x50000
    v_mov_b32 v187, s65
    s_mul_i32 s62, s49, 6
    s_mov_b32 s52, 98304
    s_waitcnt vmcnt(12)
    s_barrier
    s_mov_b32 m0, s53
    s_nop 0
    buffer_load_dwordx4 v192, s[28:31], s56 offen offset:0 lds
    buffer_load_dwordx4 v192, s[28:31], s56 offen offset:1024 lds
    buffer_load_dwordx4 v193, s[28:31], s56 offen offset:2048 lds
    buffer_load_dwordx4 v193, s[28:31], s56 offen offset:3072 lds
    s_add_u32 s53, s53, 32768
    s_cmp_ge_u32 s53, s61
    s_cselect_b32 s53, s60, s53
    s_and_b32 s57, s58, 15
    s_lshr_b64 s[58:59], s[58:59], 4
    s_add_u32 s57, s57, s55
    s_lshl_b32 s56, s57, 11
    s_mul_i32 s57, s57, 0x20000
    s_add_u32 m0, s53, 16384
    s_nop 0
    buffer_load_dwordx4 v194, s[32:35], s57 offen offset:0 lds
    buffer_load_dwordx4 v195, s[32:35], s57 offen offset:1024 lds
    buffer_load_dwordx4 v196, s[32:35], s57 offen offset:2048 lds
    buffer_load_dwordx4 v197, s[32:35], s57 offen offset:3072 lds
    s_mov_b32 m0, s53
    s_nop 0
    buffer_load_dwordx4 v192, s[28:31], s56 offen offset:0 lds
    buffer_load_dwordx4 v192, s[28:31], s56 offen offset:1024 lds
    buffer_load_dwordx4 v193, s[28:31], s56 offen offset:2048 lds
    buffer_load_dwordx4 v193, s[28:31], s56 offen offset:3072 lds
    s_add_u32 s53, s53, 32768
    s_cmp_ge_u32 s53, s61
    s_cselect_b32 s53, s60, s53
    v_add_u32 v232, s52, v233
    v_add_u32 v235, s52, v239
    v_add_u32 v236, s52, v240
    v_add_u32 v237, s52, v241
    v_add_u32 v238, s52, v242
    s_mov_b32 s72, 0x0
    s_mov_b32 s76, 0x0
    s_mov_b32 s73, 0x8000
    s_mov_b32 s77, 0x8000
    s_mov_b32 s74, 0x10000
    s_mov_b32 s78, 0x10000
    s_mov_b32 s75, 0x18000
    s_mov_b32 s79, 0x18000
    s_mov_b32 s80, 0x0
    s_mov_b32 s81, 0x1000
    s_mov_b32 s40, s22
    s_mov_b32 s41, s23
    s_mov_b32 s42, 0x400000
    s_mov_b32 s43, 0x20000
    s_waitcnt vmcnt(16)
    s_barrier
    s_setprio 2
    ds_read_b128 v[72:75], v232 offset:0
    ds_read_b64_tr_b16 v[88:89], v235 offset:0
    ds_read_b64_tr_b16 v[90:91], v235 offset:4096
    ds_read_b64_tr_b16 v[92:93], v236 offset:0
    ds_read_b64_tr_b16 v[94:95], v236 offset:4096
    ds_read_b128 v[76:79], v232 offset:2048
    ds_read_b64_tr_b16 v[96:97], v237 offset:0
    ds_read_b64_tr_b16 v[98:99], v237 offset:4096
    ds_read_b64_tr_b16 v[100:101], v238 offset:0
    ds_read_b64_tr_b16 v[102:103], v238 offset:4096
    ds_read_b128 v[80:83], v232 offset:4096
    ds_read_b128 v[84:87], v232 offset:6144
    s_and_b32 s57, s58, 15
    s_lshr_b64 s[58:59], s[58:59], 4
    s_add_u32 s57, s57, s55
    s_lshl_b32 s56, s57, 11
    s_mul_i32 s57, s57, 0x20000
    s_add_u32 m0, s53, 16384
    s_nop 0
    buffer_load_dwordx4 v194, s[32:35], s57 offen offset:0 lds
    buffer_load_dwordx4 v195, s[32:35], s57 offen offset:1024 lds
    buffer_load_dwordx4 v196, s[32:35], s57 offen offset:2048 lds
    buffer_load_dwordx4 v197, s[32:35], s57 offen offset:3072 lds
    s_mov_b32 m0, s53
    s_nop 0
    buffer_load_dwordx4 v192, s[28:31], s56 offen offset:0 lds
    buffer_load_dwordx4 v192, s[28:31], s56 offen offset:1024 lds
    buffer_load_dwordx4 v193, s[28:31], s56 offen offset:2048 lds
    buffer_load_dwordx4 v193, s[28:31], s56 offen offset:3072 lds
    s_add_u32 s53, s53, 32768
    s_cmp_ge_u32 s53, s61
    s_cselect_b32 s53, s60, s53
    s_add_u32 s52, s52, 32768
    s_cmp_ge_u32 s52, 163840
    s_cselect_b32 s52, 0, s52
    s_waitcnt lgkmcnt(0)
    v_mfma_f32_16x16x32_bf16 v[8:11], v[88:91], v[72:75], 0
    ds_read_b128 v[104:107], v232 offset:1024
    v_mfma_f32_16x16x32_bf16 v[12:15], v[92:95], v[72:75], 0
    ds_read_b64_tr_b16 v[120:121], v235 offset:8192
    v_mfma_f32_16x16x32_bf16 v[16:19], v[96:99], v[72:75], 0
    ds_read_b64_tr_b16 v[122:123], v235 offset:12288
    v_mfma_f32_16x16x32_bf16 v[20:23], v[100:103], v[72:75], 0
    ds_read_b64_tr_b16 v[124:125], v236 offset:8192
    v_mfma_f32_16x16x32_bf16 v[24:27], v[88:91], v[76:79], 0
    ds_read_b64_tr_b16 v[126:127], v236 offset:12288
    v_mfma_f32_16x16x32_bf16 v[28:31], v[92:95], v[76:79], 0
    ds_read_b128 v[108:111], v232 offset:3072
    v_mfma_f32_16x16x32_bf16 v[32:35], v[96:99], v[76:79], 0
    ds_read_b64_tr_b16 v[128:129], v237 offset:8192
    v_mfma_f32_16x16x32_bf16 v[36:39], v[100:103], v[76:79], 0
    ds_read_b64_tr_b16 v[130:131], v237 offset:12288
    v_mfma_f32_16x16x32_bf16 v[40:43], v[88:91], v[80:83], 0
    ds_read_b64_tr_b16 v[132:133], v238 offset:8192
    v_mfma_f32_16x16x32_bf16 v[44:47], v[92:95], v[80:83], 0
    ds_read_b64_tr_b16 v[134:135], v238 offset:12288
    v_mfma_f32_16x16x32_bf16 v[48:51], v[96:99], v[80:83], 0
    ds_read_b128 v[112:115], v232 offset:5120
    v_mfma_f32_16x16x32_bf16 v[52:55], v[100:103], v[80:83], 0
    ds_read_b128 v[116:119], v232 offset:7168
    v_mfma_f32_16x16x32_bf16 v[56:59], v[88:91], v[84:87], 0
    v_add_u32 v232, s52, v233
    v_add_u32 v235, s52, v239
    v_mfma_f32_16x16x32_bf16 v[60:63], v[92:95], v[84:87], 0
    v_add_u32 v236, s52, v240
    v_mfma_f32_16x16x32_bf16 v[64:67], v[96:99], v[84:87], 0
    v_add_u32 v237, s52, v241
    v_mfma_f32_16x16x32_bf16 v[68:71], v[100:103], v[84:87], 0
    v_add_u32 v238, s52, v242
    s_waitcnt lgkmcnt(0)
    v_mfma_f32_16x16x32_bf16 v[8:11], v[120:123], v[104:107], v[8:11]
    s_waitcnt vmcnt(16)
    s_barrier
    v_mfma_f32_16x16x32_bf16 v[12:15], v[124:127], v[104:107], v[12:15]
    ds_read_b128 v[72:75], v232 offset:0
    ds_read_b64_tr_b16 v[88:89], v235 offset:0
    v_mfma_f32_16x16x32_bf16 v[16:19], v[128:131], v[104:107], v[16:19]
    ds_read_b64_tr_b16 v[90:91], v235 offset:4096
    v_mfma_f32_16x16x32_bf16 v[20:23], v[132:135], v[104:107], v[20:23]
    ds_read_b64_tr_b16 v[92:93], v236 offset:0
    v_mfma_f32_16x16x32_bf16 v[24:27], v[120:123], v[108:111], v[24:27]
    ds_read_b64_tr_b16 v[94:95], v236 offset:4096
    v_mfma_f32_16x16x32_bf16 v[28:31], v[124:127], v[108:111], v[28:31]
    ds_read_b128 v[76:79], v232 offset:2048
    v_mfma_f32_16x16x32_bf16 v[32:35], v[128:131], v[108:111], v[32:35]
    ds_read_b64_tr_b16 v[96:97], v237 offset:0
    v_mfma_f32_16x16x32_bf16 v[36:39], v[132:135], v[108:111], v[36:39]
    ds_read_b64_tr_b16 v[98:99], v237 offset:4096
    v_mfma_f32_16x16x32_bf16 v[40:43], v[120:123], v[112:115], v[40:43]
    ds_read_b64_tr_b16 v[100:101], v238 offset:0
    v_mfma_f32_16x16x32_bf16 v[44:47], v[124:127], v[112:115], v[44:47]
    ds_read_b64_tr_b16 v[102:103], v238 offset:4096
    v_mfma_f32_16x16x32_bf16 v[48:51], v[128:131], v[112:115], v[48:51]
    ds_read_b128 v[80:83], v232 offset:4096
    v_mfma_f32_16x16x32_bf16 v[52:55], v[132:135], v[112:115], v[52:55]
    ds_read_b128 v[84:87], v232 offset:6144
    v_mfma_f32_16x16x32_bf16 v[56:59], v[120:123], v[116:119], v[56:59]
    v_mfma_f32_16x16x32_bf16 v[60:63], v[124:127], v[116:119], v[60:63]
    v_mfma_f32_16x16x32_bf16 v[64:67], v[128:131], v[116:119], v[64:67]
    s_add_u32 s52, s52, 32768
    s_cmp_ge_u32 s52, 163840
    s_cselect_b32 s52, 0, s52
    v_mfma_f32_16x16x32_bf16 v[68:71], v[132:135], v[116:119], v[68:71]
    s_waitcnt lgkmcnt(0)
    v_mfma_f32_16x16x32_bf16 v[8:11], v[88:91], v[72:75], v[8:11]
    ds_read_b128 v[104:107], v232 offset:1024
    v_mfma_f32_16x16x32_bf16 v[12:15], v[92:95], v[72:75], v[12:15]
    ds_read_b64_tr_b16 v[120:121], v235 offset:8192
    v_mfma_f32_16x16x32_bf16 v[16:19], v[96:99], v[72:75], v[16:19]
    ds_read_b64_tr_b16 v[122:123], v235 offset:12288
    v_mfma_f32_16x16x32_bf16 v[20:23], v[100:103], v[72:75], v[20:23]
    ds_read_b64_tr_b16 v[124:125], v236 offset:8192
    v_mfma_f32_16x16x32_bf16 v[24:27], v[88:91], v[76:79], v[24:27]
    ds_read_b64_tr_b16 v[126:127], v236 offset:12288
    v_mfma_f32_16x16x32_bf16 v[28:31], v[92:95], v[76:79], v[28:31]
    ds_read_b128 v[108:111], v232 offset:3072
    v_mfma_f32_16x16x32_bf16 v[32:35], v[96:99], v[76:79], v[32:35]
    ds_read_b64_tr_b16 v[128:129], v237 offset:8192
    v_mfma_f32_16x16x32_bf16 v[36:39], v[100:103], v[76:79], v[36:39]
    ds_read_b64_tr_b16 v[130:131], v237 offset:12288
    v_mfma_f32_16x16x32_bf16 v[40:43], v[88:91], v[80:83], v[40:43]
    ds_read_b64_tr_b16 v[132:133], v238 offset:8192
    v_mfma_f32_16x16x32_bf16 v[44:47], v[92:95], v[80:83], v[44:47]
    ds_read_b64_tr_b16 v[134:135], v238 offset:12288
    v_mfma_f32_16x16x32_bf16 v[48:51], v[96:99], v[80:83], v[48:51]
    ds_read_b128 v[112:115], v232 offset:5120
    v_mfma_f32_16x16x32_bf16 v[52:55], v[100:103], v[80:83], v[52:55]
    ds_read_b128 v[116:119], v232 offset:7168
    v_mfma_f32_16x16x32_bf16 v[56:59], v[88:91], v[84:87], v[56:59]
    v_add_u32 v232, s52, v233
    v_add_u32 v235, s52, v239
    v_mfma_f32_16x16x32_bf16 v[60:63], v[92:95], v[84:87], v[60:63]
    v_add_u32 v236, s52, v240
    v_mfma_f32_16x16x32_bf16 v[64:67], v[96:99], v[84:87], v[64:67]
    v_add_u32 v237, s52, v241
    v_mfma_f32_16x16x32_bf16 v[68:71], v[100:103], v[84:87], v[68:71]
    v_add_u32 v238, s52, v242
    s_waitcnt lgkmcnt(0)
    v_mfma_f32_16x16x32_bf16 v[8:11], v[120:123], v[104:107], v[8:11]
    s_waitcnt vmcnt(8)
    s_barrier
    v_mfma_f32_16x16x32_bf16 v[12:15], v[124:127], v[104:107], v[12:15]
    ds_read_b128 v[72:75], v232 offset:0
    ds_read_b64_tr_b16 v[88:89], v235 offset:0
    v_mfma_f32_16x16x32_bf16 v[16:19], v[128:131], v[104:107], v[16:19]
    ds_read_b64_tr_b16 v[90:91], v235 offset:4096
    v_mfma_f32_16x16x32_bf16 v[20:23], v[132:135], v[104:107], v[20:23]
    ds_read_b64_tr_b16 v[92:93], v236 offset:0
    v_mfma_f32_16x16x32_bf16 v[24:27], v[120:123], v[108:111], v[24:27]
    ds_read_b64_tr_b16 v[94:95], v236 offset:4096
    v_mfma_f32_16x16x32_bf16 v[28:31], v[124:127], v[108:111], v[28:31]
    ds_read_b128 v[76:79], v232 offset:2048
    v_mfma_f32_16x16x32_bf16 v[32:35], v[128:131], v[108:111], v[32:35]
    ds_read_b64_tr_b16 v[96:97], v237 offset:0
    v_mfma_f32_16x16x32_bf16 v[36:39], v[132:135], v[108:111], v[36:39]
    ds_read_b64_tr_b16 v[98:99], v237 offset:4096
    v_mfma_f32_16x16x32_bf16 v[40:43], v[120:123], v[112:115], v[40:43]
    ds_read_b64_tr_b16 v[100:101], v238 offset:0
    v_mfma_f32_16x16x32_bf16 v[44:47], v[124:127], v[112:115], v[44:47]
    ds_read_b64_tr_b16 v[102:103], v238 offset:4096
    v_mfma_f32_16x16x32_bf16 v[48:51], v[128:131], v[112:115], v[48:51]
    ds_read_b128 v[80:83], v232 offset:4096
    v_mfma_f32_16x16x32_bf16 v[52:55], v[132:135], v[112:115], v[52:55]
    ds_read_b128 v[84:87], v232 offset:6144
    v_mfma_f32_16x16x32_bf16 v[56:59], v[120:123], v[116:119], v[56:59]
    v_mfma_f32_16x16x32_bf16 v[60:63], v[124:127], v[116:119], v[60:63]
    v_mfma_f32_16x16x32_bf16 v[64:67], v[128:131], v[116:119], v[64:67]
    s_add_u32 s52, s52, 32768
    s_cmp_ge_u32 s52, 163840
    s_cselect_b32 s52, 0, s52
    v_mfma_f32_16x16x32_bf16 v[68:71], v[132:135], v[116:119], v[68:71]
    s_waitcnt lgkmcnt(0)
    v_mfma_f32_16x16x32_bf16 v[8:11], v[88:91], v[72:75], v[8:11]
    ds_read_b128 v[104:107], v232 offset:1024
    v_mfma_f32_16x16x32_bf16 v[12:15], v[92:95], v[72:75], v[12:15]
    ds_read_b64_tr_b16 v[120:121], v235 offset:8192
    v_mfma_f32_16x16x32_bf16 v[16:19], v[96:99], v[72:75], v[16:19]
    ds_read_b64_tr_b16 v[122:123], v235 offset:12288
    v_mfma_f32_16x16x32_bf16 v[20:23], v[100:103], v[72:75], v[20:23]
    ds_read_b64_tr_b16 v[124:125], v236 offset:8192
    v_mfma_f32_16x16x32_bf16 v[24:27], v[88:91], v[76:79], v[24:27]
    ds_read_b64_tr_b16 v[126:127], v236 offset:12288
    v_mfma_f32_16x16x32_bf16 v[28:31], v[92:95], v[76:79], v[28:31]
    ds_read_b128 v[108:111], v232 offset:3072
    v_mfma_f32_16x16x32_bf16 v[32:35], v[96:99], v[76:79], v[32:35]
    ds_read_b64_tr_b16 v[128:129], v237 offset:8192
    v_mfma_f32_16x16x32_bf16 v[36:39], v[100:103], v[76:79], v[36:39]
    ds_read_b64_tr_b16 v[130:131], v237 offset:12288
    v_mfma_f32_16x16x32_bf16 v[40:43], v[88:91], v[80:83], v[40:43]
    ds_read_b64_tr_b16 v[132:133], v238 offset:8192
    v_mfma_f32_16x16x32_bf16 v[44:47], v[92:95], v[80:83], v[44:47]
    ds_read_b64_tr_b16 v[134:135], v238 offset:12288
    v_mfma_f32_16x16x32_bf16 v[48:51], v[96:99], v[80:83], v[48:51]
    ds_read_b128 v[112:115], v232 offset:5120
    v_mfma_f32_16x16x32_bf16 v[52:55], v[100:103], v[80:83], v[52:55]
    ds_read_b128 v[116:119], v232 offset:7168
    v_mfma_f32_16x16x32_bf16 v[56:59], v[88:91], v[84:87], v[56:59]
    v_add_u32 v232, s52, v233
    v_add_u32 v235, s52, v239
    v_mfma_f32_16x16x32_bf16 v[60:63], v[92:95], v[84:87], v[60:63]
    v_add_u32 v236, s52, v240
    v_mfma_f32_16x16x32_bf16 v[64:67], v[96:99], v[84:87], v[64:67]
    v_add_u32 v237, s52, v241
    v_mfma_f32_16x16x32_bf16 v[68:71], v[100:103], v[84:87], v[68:71]
    v_add_u32 v238, s52, v242
    s_waitcnt lgkmcnt(0)
    v_mfma_f32_16x16x32_bf16 v[8:11], v[120:123], v[104:107], v[8:11]
    s_waitcnt vmcnt(0)
    s_barrier
    v_mfma_f32_16x16x32_bf16 v[12:15], v[124:127], v[104:107], v[12:15]
    ds_read_b128 v[72:75], v232 offset:0
    ds_read_b64_tr_b16 v[88:89], v235 offset:0
    v_mfma_f32_16x16x32_bf16 v[16:19], v[128:131], v[104:107], v[16:19]
    ds_read_b64_tr_b16 v[90:91], v235 offset:4096
    v_mfma_f32_16x16x32_bf16 v[20:23], v[132:135], v[104:107], v[20:23]
    ds_read_b64_tr_b16 v[92:93], v236 offset:0
    v_mfma_f32_16x16x32_bf16 v[24:27], v[120:123], v[108:111], v[24:27]
    ds_read_b64_tr_b16 v[94:95], v236 offset:4096
    v_mfma_f32_16x16x32_bf16 v[28:31], v[124:127], v[108:111], v[28:31]
    ds_read_b128 v[76:79], v232 offset:2048
    v_mfma_f32_16x16x32_bf16 v[32:35], v[128:131], v[108:111], v[32:35]
    ds_read_b64_tr_b16 v[96:97], v237 offset:0
    v_mfma_f32_16x16x32_bf16 v[36:39], v[132:135], v[108:111], v[36:39]
    ds_read_b64_tr_b16 v[98:99], v237 offset:4096
    v_mfma_f32_16x16x32_bf16 v[40:43], v[120:123], v[112:115], v[40:43]
    ds_read_b64_tr_b16 v[100:101], v238 offset:0
    v_mfma_f32_16x16x32_bf16 v[44:47], v[124:127], v[112:115], v[44:47]
    ds_read_b64_tr_b16 v[102:103], v238 offset:4096
    v_mfma_f32_16x16x32_bf16 v[48:51], v[128:131], v[112:115], v[48:51]
    ds_read_b128 v[80:83], v232 offset:4096
    v_mfma_f32_16x16x32_bf16 v[52:55], v[132:135], v[112:115], v[52:55]
    ds_read_b128 v[84:87], v232 offset:6144
    v_mfma_f32_16x16x32_bf16 v[56:59], v[120:123], v[116:119], v[56:59]
    v_mfma_f32_16x16x32_bf16 v[60:63], v[124:127], v[116:119], v[60:63]
    v_mfma_f32_16x16x32_bf16 v[64:67], v[128:131], v[116:119], v[64:67]
    s_add_u32 s52, s52, 32768
    s_cmp_ge_u32 s52, 163840
    s_cselect_b32 s52, 0, s52
    v_mfma_f32_16x16x32_bf16 v[68:71], v[132:135], v[116:119], v[68:71]
    s_waitcnt lgkmcnt(0)
    v_mfma_f32_16x16x32_bf16 v[8:11], v[88:91], v[72:75], v[8:11]
    ds_read_b128 v[104:107], v232 offset:1024
    v_mfma_f32_16x16x32_bf16 v[12:15], v[92:95], v[72:75], v[12:15]
    ds_read_b64_tr_b16 v[120:121], v235 offset:8192
    v_mfma_f32_16x16x32_bf16 v[16:19], v[96:99], v[72:75], v[16:19]
    ds_read_b64_tr_b16 v[122:123], v235 offset:12288
    v_mfma_f32_16x16x32_bf16 v[20:23], v[100:103], v[72:75], v[20:23]
    ds_read_b64_tr_b16 v[124:125], v236 offset:8192
    v_mfma_f32_16x16x32_bf16 v[24:27], v[88:91], v[76:79], v[24:27]
    ds_read_b64_tr_b16 v[126:127], v236 offset:12288
    v_mfma_f32_16x16x32_bf16 v[28:31], v[92:95], v[76:79], v[28:31]
    ds_read_b128 v[108:111], v232 offset:3072
    v_mfma_f32_16x16x32_bf16 v[32:35], v[96:99], v[76:79], v[32:35]
    ds_read_b64_tr_b16 v[128:129], v237 offset:8192
    v_mfma_f32_16x16x32_bf16 v[36:39], v[100:103], v[76:79], v[36:39]
    ds_read_b64_tr_b16 v[130:131], v237 offset:12288
    v_mfma_f32_16x16x32_bf16 v[40:43], v[88:91], v[80:83], v[40:43]
    s_add_u32 s54, s62, 17
M_P_loop5:
    ds_read_b64_tr_b16 v[132:133], v238 offset:8192
    v_mfma_f32_16x16x32_bf16 v[44:47], v[92:95], v[80:83], v[44:47]
    ds_read_b64_tr_b16 v[134:135], v238 offset:12288
    v_mfma_f32_16x16x32_bf16 v[48:51], v[96:99], v[80:83], v[48:51]
    ds_read_b128 v[112:115], v232 offset:5120
    v_mfma_f32_16x16x32_bf16 v[52:55], v[100:103], v[80:83], v[52:55]
    ds_read_b128 v[116:119], v232 offset:7168
    v_mfma_f32_16x16x32_bf16 v[56:59], v[88:91], v[84:87], v[56:59]
    v_add_u32 v232, s52, v233
    v_add_u32 v235, s52, v239
    v_mfma_f32_16x16x32_bf16 v[60:63], v[92:95], v[84:87], v[60:63]
    v_add_u32 v236, s52, v240
    v_mfma_f32_16x16x32_bf16 v[64:67], v[96:99], v[84:87], v[64:67]
    v_add_u32 v237, s52, v241
    v_mfma_f32_16x16x32_bf16 v[68:71], v[100:103], v[84:87], v[68:71]
    v_add_u32 v238, s52, v242
    s_waitcnt lgkmcnt(0)
    v_mfma_f32_16x16x32_bf16 v[8:11], v[120:123], v[104:107], v[8:11]
    s_barrier
    v_mfma_f32_16x16x32_bf16 v[12:15], v[124:127], v[104:107], v[12:15]
    ds_read_b128 v[72:75], v232 offset:0
    ds_read_b64_tr_b16 v[88:89], v235 offset:0
    v_mfma_f32_16x16x32_bf16 v[16:19], v[128:131], v[104:107], v[16:19]
    ds_read_b64_tr_b16 v[90:91], v235 offset:4096
    v_mfma_f32_16x16x32_bf16 v[20:23], v[132:135], v[104:107], v[20:23]
    ds_read_b64_tr_b16 v[92:93], v236 offset:0
    v_mfma_f32_16x16x32_bf16 v[24:27], v[120:123], v[108:111], v[24:27]
    ds_read_b64_tr_b16 v[94:95], v236 offset:4096
    v_mfma_f32_16x16x32_bf16 v[28:31], v[124:127], v[108:111], v[28:31]
    ds_read_b128 v[76:79], v232 offset:2048
    v_mfma_f32_16x16x32_bf16 v[32:35], v[128:131], v[108:111], v[32:35]
    ds_read_b64_tr_b16 v[96:97], v237 offset:0
    v_mfma_f32_16x16x32_bf16 v[36:39], v[132:135], v[108:111], v[36:39]
    ds_read_b64_tr_b16 v[98:99], v237 offset:4096
    v_mfma_f32_16x16x32_bf16 v[40:43], v[120:123], v[112:115], v[40:43]
    ds_read_b64_tr_b16 v[100:101], v238 offset:0
    v_mfma_f32_16x16x32_bf16 v[44:47], v[124:127], v[112:115], v[44:47]
    ds_read_b64_tr_b16 v[102:103], v238 offset:4096
    v_mfma_f32_16x16x32_bf16 v[48:51], v[128:131], v[112:115], v[48:51]
    ds_read_b128 v[80:83], v232 offset:4096
    v_mfma_f32_16x16x32_bf16 v[52:55], v[132:135], v[112:115], v[52:55]
    ds_read_b128 v[84:87], v232 offset:6144
    v_mfma_f32_16x16x32_bf16 v[56:59], v[120:123], v[116:119], v[56:59]
    v_mfma_f32_16x16x32_bf16 v[60:63], v[124:127], v[116:119], v[60:63]
    v_mfma_f32_16x16x32_bf16 v[64:67], v[128:131], v[116:119], v[64:67]
    s_add_u32 s52, s52, 32768
    s_cmp_ge_u32 s52, 163840
    s_cselect_b32 s52, 0, s52
    v_mfma_f32_16x16x32_bf16 v[68:71], v[132:135], v[116:119], v[68:71]
    s_waitcnt lgkmcnt(0)
    v_mfma_f32_16x16x32_bf16 v[8:11], v[88:91], v[72:75], v[8:11]
    ds_read_b128 v[104:107], v232 offset:1024
    v_mfma_f32_16x16x32_bf16 v[12:15], v[92:95], v[72:75], v[12:15]
    ds_read_b64_tr_b16 v[120:121], v235 offset:8192
    v_mfma_f32_16x16x32_bf16 v[16:19], v[96:99], v[72:75], v[16:19]
    ds_read_b64_tr_b16 v[122:123], v235 offset:12288
    v_mfma_f32_16x16x32_bf16 v[20:23], v[100:103], v[72:75], v[20:23]
    ds_read_b64_tr_b16 v[124:125], v236 offset:8192
    v_mfma_f32_16x16x32_bf16 v[24:27], v[88:91], v[76:79], v[24:27]
    ds_read_b64_tr_b16 v[126:127], v236 offset:12288
    v_mfma_f32_16x16x32_bf16 v[28:31], v[92:95], v[76:79], v[28:31]
    ds_read_b128 v[108:111], v232 offset:3072
    v_mfma_f32_16x16x32_bf16 v[32:35], v[96:99], v[76:79], v[32:35]
    ds_read_b64_tr_b16 v[128:129], v237 offset:8192
    v_mfma_f32_16x16x32_bf16 v[36:39], v[100:103], v[76:79], v[36:39]
    s_sub_u32 s54, s54, 1
    ds_read_b64_tr_b16 v[130:131], v237 offset:12288
    v_mfma_f32_16x16x32_bf16 v[40:43], v[88:91], v[80:83], v[40:43]
    s_cbranch_scc0 M_P_loop5
    ds_read_b64_tr_b16 v[132:133], v238 offset:8192
    v_mfma_f32_16x16x32_bf16 v[44:47], v[92:95], v[80:83], v[44:47]
    ds_read_b64_tr_b16 v[134:135], v238 offset:12288
    v_mfma_f32_16x16x32_bf16 v[48:51], v[96:99], v[80:83], v[48:51]
    ds_read_b128 v[112:115], v232 offset:5120
    v_mfma_f32_16x16x32_bf16 v[52:55], v[100:103], v[80:83], v[52:55]
    ds_read_b128 v[116:119], v232 offset:7168
    v_mfma_f32_16x16x32_bf16 v[56:59], v[88:91], v[84:87], v[56:59]
    v_add_u32 v232, s52, v233
    v_add_u32 v235, s52, v239
    v_mfma_f32_16x16x32_bf16 v[60:63], v[92:95], v[84:87], v[60:63]
    v_add_u32 v236, s52, v240
    v_mfma_f32_16x16x32_bf16 v[64:67], v[96:99], v[84:87], v[64:67]
    v_add_u32 v237, s52, v241
    v_mfma_f32_16x16x32_bf16 v[68:71], v[100:103], v[84:87], v[68:71]
    v_add_u32 v238, s52, v242
    s_waitcnt lgkmcnt(0)
    v_mfma_f32_16x16x32_bf16 v[8:11], v[120:123], v[104:107], v[8:11]
    s_barrier
    v_mfma_f32_16x16x32_bf16 v[12:15], v[124:127], v[104:107], v[12:15]
    ds_read_b128 v[72:75], v232 offset:0
    ds_read_b64_tr_b16 v[88:89], v235 offset:0
    v_mfma_f32_16x16x32_bf16 v[16:19], v[128:131], v[104:107], v[16:19]
    ds_read_b64_tr_b16 v[90:91], v235 offset:4096
    v_mfma_f32_16x16x32_bf16 v[20:23], v[132:135], v[104:107], v[20:23]
    ds_read_b64_tr_b16 v[92:93], v236 offset:0
    v_mfma_f32_16x16x32_bf16 v[24:27], v[120:123], v[108:111], v[24:27]
    ds_read_b64_tr_b16 v[94:95], v236 offset:4096
    v_mfma_f32_16x16x32_bf16 v[28:31], v[124:127], v[108:111], v[28:31]
    ds_read_b128 v[76:79], v232 offset:2048
    v_mfma_f32_16x16x32_bf16 v[32:35], v[128:131], v[108:111], v[32:35]
    ds_read_b64_tr_b16 v[96:97], v237 offset:0
    v_mfma_f32_16x16x32_bf16 v[36:39], v[132:135], v[108:111], v[36:39]
    ds_read_b64_tr_b16 v[98:99], v237 offset:4096
    v_mfma_f32_16x16x32_bf16 v[40:43], v[120:123], v[112:115], v[40:43]
    ds_read_b64_tr_b16 v[100:101], v238 offset:0
    v_mfma_f32_16x16x32_bf16 v[44:47], v[124:127], v[112:115], v[44:47]
    ds_read_b64_tr_b16 v[102:103], v238 offset:4096
    v_mfma_f32_16x16x32_bf16 v[48:51], v[128:131], v[112:115], v[48:51]
    ds_read_b128 v[80:83], v232 offset:4096
    v_mfma_f32_16x16x32_bf16 v[52:55], v[132:135], v[112:115], v[52:55]
    ds_read_b128 v[84:87], v232 offset:6144
    v_mfma_f32_16x16x32_bf16 v[56:59], v[120:123], v[116:119], v[56:59]
    v_mfma_f32_16x16x32_bf16 v[60:63], v[124:127], v[116:119], v[60:63]
    v_mfma_f32_16x16x32_bf16 v[64:67], v[128:131], v[116:119], v[64:67]
    s_add_u32 s52, s52, 32768
    s_cmp_ge_u32 s52, 163840
    s_cselect_b32 s52, 0, s52
    v_mfma_f32_16x16x32_bf16 v[68:71], v[132:135], v[116:119], v[68:71]
    s_waitcnt lgkmcnt(0)
    v_mfma_f32_16x16x32_bf16 v[8:11], v[88:91], v[72:75], v[8:11]
    ds_read_b128 v[104:107], v232 offset:1024
    v_mfma_f32_16x16x32_bf16 v[12:15], v[92:95], v[72:75], v[12:15]
    ds_read_b64_tr_b16 v[120:121], v235 offset:8192
    buffer_load_dwordx4 v[136:139], v188, s[28:31], s76 offen offset:0
    v_mfma_f32_16x16x32_bf16 v[16:19], v[96:99], v[72:75], v[16:19]
    ds_read_b64_tr_b16 v[122:123], v235 offset:12288
    v_mfma_f32_16x16x32_bf16 v[20:23], v[100:103], v[72:75], v[20:23]
    ds_read_b64_tr_b16 v[124:125], v236 offset:8192
    v_mfma_f32_16x16x32_bf16 v[24:27], v[88:91], v[76:79], v[24:27]
    ds_read_b64_tr_b16 v[126:127], v236 offset:12288
    v_mfma_f32_16x16x32_bf16 v[28:31], v[92:95], v[76:79], v[28:31]
    ds_read_b128 v[108:111], v232 offset:3072
    v_mfma_f32_16x16x32_bf16 v[32:35], v[96:99], v[76:79], v[32:35]
    ds_read_b64_tr_b16 v[128:129], v237 offset:8192
    buffer_load_dwordx4 v[140:143], v188, s[28:31], s76 offen offset:1024
    v_mfma_f32_16x16x32_bf16 v[36:39], v[100:103], v[76:79], v[36:39]
    ds_read_b64_tr_b16 v[130:131], v237 offset:12288
    v_mfma_f32_16x16x32_bf16 v[40:43], v[88:91], v[80:83], v[40:43]
    ds_read_b64_tr_b16 v[132:133], v238 offset:8192
    v_mfma_f32_16x16x32_bf16 v[44:47], v[92:95], v[80:83], v[44:47]
    ds_read_b64_tr_b16 v[134:135], v238 offset:12288
    v_mfma_f32_16x16x32_bf16 v[48:51], v[96:99], v[80:83], v[48:51]
    ds_read_b128 v[112:115], v232 offset:5120
    v_mfma_f32_16x16x32_bf16 v[52:55], v[100:103], v[80:83], v[52:55]
    ds_read_b128 v[116:119], v232 offset:7168
    buffer_load_dwordx4 v[144:147], v188, s[28:31], s77 offen offset:0
    v_mfma_f32_16x16x32_bf16 v[56:59], v[88:91], v[84:87], v[56:59]
    v_add_u32 v232, s52, v233
    v_add_u32 v235, s52, v239
    v_mfma_f32_16x16x32_bf16 v[60:63], v[92:95], v[84:87], v[60:63]
    v_add_u32 v236, s52, v240
    v_mfma_f32_16x16x32_bf16 v[64:67], v[96:99], v[84:87], v[64:67]
    v_add_u32 v237, s52, v241
    v_mfma_f32_16x16x32_bf16 v[68:71], v[100:103], v[84:87], v[68:71]
    v_add_u32 v238, s52, v242
    s_waitcnt lgkmcnt(0)
    v_mfma_f32_16x16x32_bf16 v[8:11], v[120:123], v[104:107], v[8:11]
    s_barrier
    v_mfma_f32_16x16x32_bf16 v[12:15], v[124:127], v[104:107], v[12:15]
    ds_read_b128 v[72:75], v232 offset:0
    ds_read_b64_tr_b16 v[88:89], v235 offset:0
    buffer_load_dwordx4 v[148:151], v188, s[28:31], s77 offen offset:1024
    v_mfma_f32_16x16x32_bf16 v[16:19], v[128:131], v[104:107], v[16:19]
    ds_read_b64_tr_b16 v[90:91], v235 offset:4096
    v_mfma_f32_16x16x32_bf16 v[20:23], v[132:135], v[104:107], v[20:23]
    ds_read_b64_tr_b16 v[92:93], v236 offset:0
    v_mfma_f32_16x16x32_bf16 v[24:27], v[120:123], v[108:111], v[24:27]
    ds_read_b64_tr_b16 v[94:95], v236 offset:4096
    v_mfma_f32_16x16x32_bf16 v[28:31], v[124:127], v[108:111], v[28:31]
    ds_read_b128 v[76:79], v232 offset:2048
    v_mfma_f32_16x16x32_bf16 v[32:35], v[128:131], v[108:111], v[32:35]
    ds_read_b64_tr_b16 v[96:97], v237 offset:0
    buffer_load_dwordx4 v[152:155], v188, s[28:31], s78 offen offset:0
    v_mfma_f32_16x16x32_bf16 v[36:39], v[132:135], v[108:111], v[36:39]
    ds_read_b64_tr_b16 v[98:99], v237 offset:4096
    v_mfma_f32_16x16x32_bf16 v[40:43], v[120:123], v[112:115], v[40:43]
    ds_read_b64_tr_b16 v[100:101], v238 offset:0
    v_mfma_f32_16x16x32_bf16 v[44:47], v[124:127], v[112:115], v[44:47]
    ds_read_b64_tr_b16 v[102:103], v238 offset:4096
    v_mfma_f32_16x16x32_bf16 v[48:51], v[128:131], v[112:115], v[48:51]
    ds_read_b128 v[80:83], v232 offset:4096
    v_mfma_f32_16x16x32_bf16 v[52:55], v[132:135], v[112:115], v[52:55]
    ds_read_b128 v[84:87], v232 offset:6144
    buffer_load_dwordx4 v[156:159], v188, s[28:31], s78 offen offset:1024
    v_mfma_f32_16x16x32_bf16 v[56:59], v[120:123], v[116:119], v[56:59]
    v_mfma_f32_16x16x32_bf16 v[60:63], v[124:127], v[116:119], v[60:63]
    v_mfma_f32_16x16x32_bf16 v[64:67], v[128:131], v[116:119], v[64:67]
    s_add_u32 s52, s52, 32768
    s_cmp_ge_u32 s52, 163840
    s_cselect_b32 s52, 0, s52
    v_mfma_f32_16x16x32_bf16 v[68:71], v[132:135], v[116:119], v[68:71]
    s_waitcnt lgkmcnt(0)
    v_mfma_f32_16x16x32_bf16 v[8:11], v[88:91], v[72:75], v[8:11]
    ds_read_b128 v[104:107], v232 offset:1024
    v_mfma_f32_16x16x32_bf16 v[12:15], v[92:95], v[72:75], v[12:15]
    ds_read_b64_tr_b16 v[120:121], v235 offset:8192
    buffer_load_dwordx4 v[160:163], v188, s[28:31], s79 offen offset:0
    v_mfma_f32_16x16x32_bf16 v[16:19], v[96:99], v[72:75], v[16:19]
    ds_read_b64_tr_b16 v[122:123], v235 offset:12288
    v_mfma_f32_16x16x32_bf16 v[20:23], v[100:103], v[72:75], v[20:23]
    ds_read_b64_tr_b16 v[124:125], v236 offset:8192
    v_mfma_f32_16x16x32_bf16 v[24:27], v[88:91], v[76:79], v[24:27]
    ds_read_b64_tr_b16 v[126:127], v236 offset:12288
    v_mfma_f32_16x16x32_bf16 v[28:31], v[92:95], v[76:79], v[28:31]
    ds_read_b128 v[108:111], v232 offset:3072
    v_mfma_f32_16x16x32_bf16 v[32:35], v[96:99], v[76:79], v[32:35]
    ds_read_b64_tr_b16 v[128:129], v237 offset:8192
    buffer_load_dwordx4 v[164:167], v188, s[28:31], s79 offen offset:1024
    v_mfma_f32_16x16x32_bf16 v[36:39], v[100:103], v[76:79], v[36:39]
    ds_read_b64_tr_b16 v[130:131], v237 offset:12288
    v_mfma_f32_16x16x32_bf16 v[40:43], v[88:91], v[80:83], v[40:43]
    ds_read_b64_tr_b16 v[132:133], v238 offset:8192
    v_mfma_f32_16x16x32_bf16 v[44:47], v[92:95], v[80:83], v[44:47]
    ds_read_b64_tr_b16 v[134:135], v238 offset:12288
    v_mfma_f32_16x16x32_bf16 v[48:51], v[96:99], v[80:83], v[48:51]
    ds_read_b128 v[112:115], v232 offset:5120
    v_mfma_f32_16x16x32_bf16 v[52:55], v[100:103], v[80:83], v[52:55]
    ds_read_b128 v[116:119], v232 offset:7168
    buffer_load_dwordx4 v[168:171], v185, s[28:31], 0 offen offset:0
    v_mfma_f32_16x16x32_bf16 v[56:59], v[88:91], v[84:87], v[56:59]
    v_add_u32 v232, s52, v233
    v_add_u32 v235, s52, v239
    v_mfma_f32_16x16x32_bf16 v[60:63], v[92:95], v[84:87], v[60:63]
    v_add_u32 v236, s52, v240
    v_mfma_f32_16x16x32_bf16 v[64:67], v[96:99], v[84:87], v[64:67]
    v_add_u32 v237, s52, v241
    v_mfma_f32_16x16x32_bf16 v[68:71], v[100:103], v[84:87], v[68:71]
    v_add_u32 v238, s52, v242
    s_waitcnt lgkmcnt(0)
    v_mfma_f32_16x16x32_bf16 v[8:11], v[120:123], v[104:107], v[8:11]
    s_barrier
    v_mfma_f32_16x16x32_bf16 v[12:15], v[124:127], v[104:107], v[12:15]
    ds_read_b128 v[72:75], v232 offset:0
    ds_read_b64_tr_b16 v[88:89], v235 offset:0
    buffer_load_dwordx4 v[172:175], v185, s[28:31], 0 offen offset:64
    v_mfma_f32_16x16x32_bf16 v[16:19], v[128:131], v[104:107], v[16:19]
    ds_read_b64_tr_b16 v[90:91], v235 offset:4096
    v_mfma_f32_16x16x32_bf16 v[20:23], v[132:135], v[104:107], v[20:23]
    ds_read_b64_tr_b16 v[92:93], v236 offset:0
    v_mfma_f32_16x16x32_bf16 v[24:27], v[120:123], v[108:111], v[24:27]
    ds_read_b64_tr_b16 v[94:95], v236 offset:4096
    v_mfma_f32_16x16x32_bf16 v[28:31], v[124:127], v[108:111], v[28:31]
    ds_read_b128 v[76:79], v232 offset:2048
    v_mfma_f32_16x16x32_bf16 v[32:35], v[128:131], v[108:111], v[32:35]
    ds_read_b64_tr_b16 v[96:97], v237 offset:0
    buffer_load_dwordx4 v[176:179], v185, s[28:31], 0 offen offset:128
    v_mfma_f32_16x16x32_bf16 v[36:39], v[132:135], v[108:111], v[36:39]
    ds_read_b64_tr_b16 v[98:99], v237 offset:4096
    v_mfma_f32_16x16x32_bf16 v[40:43], v[120:123], v[112:115], v[40:43]
    ds_read_b64_tr_b16 v[100:101], v238 offset:0
    v_mfma_f32_16x16x32_bf16 v[44:47], v[124:127], v[112:115], v[44:47]
    ds_read_b64_tr_b16 v[102:103], v238 offset:4096
    v_mfma_f32_16x16x32_bf16 v[48:51], v[128:131], v[112:115], v[48:51]
    ds_read_b128 v[80:83], v232 offset:4096
    v_mfma_f32_16x16x32_bf16 v[52:55], v[132:135], v[112:115], v[52:55]
    ds_read_b128 v[84:87], v232 offset:6144
    buffer_load_dwordx4 v[180:183], v185, s[28:31], 0 offen offset:192
    v_mfma_f32_16x16x32_bf16 v[56:59], v[120:123], v[116:119], v[56:59]
    v_mfma_f32_16x16x32_bf16 v[60:63], v[124:127], v[116:119], v[60:63]
    v_mfma_f32_16x16x32_bf16 v[64:67], v[128:131], v[116:119], v[64:67]
    s_add_u32 s52, s52, 32768
    s_cmp_ge_u32 s52, 163840
    s_cselect_b32 s52, 0, s52
    v_mfma_f32_16x16x32_bf16 v[68:71], v[132:135], v[116:119], v[68:71]
    s_waitcnt lgkmcnt(0)
    v_mfma_f32_16x16x32_bf16 v[8:11], v[88:91], v[72:75], v[8:11]
    ds_read_b128 v[104:107], v232 offset:1024
    v_mfma_f32_16x16x32_bf16 v[12:15], v[92:95], v[72:75], v[12:15]
    ds_read_b64_tr_b16 v[120:121], v235 offset:8192
    buffer_load_dword v245, v187, s[28:31], 0 offen sc1
    v_mfma_f32_16x16x32_bf16 v[16:19], v[96:99], v[72:75], v[16:19]
    ds_read_b64_tr_b16 v[122:123], v235 offset:12288
    v_mfma_f32_16x16x32_bf16 v[20:23], v[100:103], v[72:75], v[20:23]
    ds_read_b64_tr_b16 v[124:125], v236 offset:8192
    v_mfma_f32_16x16x32_bf16 v[24:27], v[88:91], v[76:79], v[24:27]
    ds_read_b64_tr_b16 v[126:127], v236 offset:12288
    v_mfma_f32_16x16x32_bf16 v[28:31], v[92:95], v[76:79], v[28:31]
    ds_read_b128 v[108:111], v232 offset:3072
    v_mfma_f32_16x16x32_bf16 v[32:35], v[96:99], v[76:79], v[32:35]
    ds_read_b64_tr_b16 v[128:129], v237 offset:8192
    v_mfma_f32_16x16x32_bf16 v[36:39], v[100:103], v[76:79], v[36:39]
    ds_read_b64_tr_b16 v[130:131], v237 offset:12288
    v_mfma_f32_16x16x32_bf16 v[40:43], v[88:91], v[80:83], v[40:43]
    ds_read_b64_tr_b16 v[132:133], v238 offset:8192
    v_mfma_f32_16x16x32_bf16 v[44:47], v[92:95], v[80:83], v[44:47]
    ds_read_b64_tr_b16 v[134:135], v238 offset:12288
    v_mfma_f32_16x16x32_bf16 v[48:51], v[96:99], v[80:83], v[48:51]
    ds_read_b128 v[112:115], v232 offset:5120
    v_mfma_f32_16x16x32_bf16 v[52:55], v[100:103], v[80:83], v[52:55]
    ds_read_b128 v[116:119], v232 offset:7168
    v_mfma_f32_16x16x32_bf16 v[56:59], v[88:91], v[84:87], v[56:59]
    v_mfma_f32_16x16x32_bf16 v[60:63], v[92:95], v[84:87], v[60:63]
    v_mfma_f32_16x16x32_bf16 v[64:67], v[96:99], v[84:87], v[64:67]
    v_mfma_f32_16x16x32_bf16 v[68:71], v[100:103], v[84:87], v[68:71]
    s_waitcnt lgkmcnt(0)
    v_mfma_f32_16x16x32_bf16 v[8:11], v[120:123], v[104:107], v[8:11]
    v_mfma_f32_16x16x32_bf16 v[12:15], v[124:127], v[104:107], v[12:15]
    v_mfma_f32_16x16x32_bf16 v[16:19], v[128:131], v[104:107], v[16:19]
    v_mfma_f32_16x16x32_bf16 v[20:23], v[132:135], v[104:107], v[20:23]
    v_mfma_f32_16x16x32_bf16 v[24:27], v[120:123], v[108:111], v[24:27]
    v_mfma_f32_16x16x32_bf16 v[28:31], v[124:127], v[108:111], v[28:31]
    v_mfma_f32_16x16x32_bf16 v[32:35], v[128:131], v[108:111], v[32:35]
    v_mfma_f32_16x16x32_bf16 v[36:39], v[132:135], v[108:111], v[36:39]
    v_mfma_f32_16x16x32_bf16 v[40:43], v[120:123], v[112:115], v[40:43]
    v_mfma_f32_16x16x32_bf16 v[44:47], v[124:127], v[112:115], v[44:47]
    v_mfma_f32_16x16x32_bf16 v[48:51], v[128:131], v[112:115], v[48:51]
    v_mfma_f32_16x16x32_bf16 v[52:55], v[132:135], v[112:115], v[52:55]
    v_mfma_f32_16x16x32_bf16 v[56:59], v[120:123], v[116:119], v[56:59]
    v_mfma_f32_16x16x32_bf16 v[60:63], v[124:127], v[116:119], v[60:63]
    v_mfma_f32_16x16x32_bf16 v[64:67], v[128:131], v[116:119], v[64:67]
    v_mfma_f32_16x16x32_bf16 v[68:71], v[132:135], v[116:119], v[68:71]
    s_mov_b32 s3, 0x40000
    s_cmp_lg_u32 s49, 0
    s_cbranch_scc1 M_A
    v_cvt_pk_bf16_f32 v72, v8, v9
    v_cvt_pk_bf16_f32 v73, v10, v11
    v_cvt_pk_bf16_f32 v74, v12, v13
    v_cvt_pk_bf16_f32 v75, v14, v15
    buffer_store_dwordx4 v[72:75], v186, s[28:31], s80 offen offset:0 sc1
    v_cvt_pk_bf16_f32 v76, v16, v17
    v_cvt_pk_bf16_f32 v77, v18, v19
    v_cvt_pk_bf16_f32 v78, v20, v21
    v_cvt_pk_bf16_f32 v79, v22, v23
    buffer_store_dwordx4 v[76:79], v186, s[28:31], s80 offen offset:1024 sc1
    v_cvt_pk_bf16_f32 v80, v24, v25
    v_cvt_pk_bf16_f32 v81, v26, v27
    v_cvt_pk_bf16_f32 v82, v28, v29
    v_cvt_pk_bf16_f32 v83, v30, v31
    buffer_store_dwordx4 v[80:83], v186, s[28:31], s80 offen offset:2048 sc1
    v_cvt_pk_bf16_f32 v84, v32, v33
    v_cvt_pk_bf16_f32 v85, v34, v35
    v_cvt_pk_bf16_f32 v86, v36, v37
    v_cvt_pk_bf16_f32 v87, v38, v39
    buffer_store_dwordx4 v[84:87], v186, s[28:31], s80 offen offset:3072 sc1
    v_cvt_pk_bf16_f32 v88, v40, v41
    v_cvt_pk_bf16_f32 v89, v42, v43
    v_cvt_pk_bf16_f32 v90, v44, v45
    v_cvt_pk_bf16_f32 v91, v46, v47
    buffer_store_dwordx4 v[88:91], v186, s[28:31], s81 offen offset:0 sc1
    v_cvt_pk_bf16_f32 v92, v48, v49
    v_cvt_pk_bf16_f32 v93, v50, v51
    v_cvt_pk_bf16_f32 v94, v52, v53
    v_cvt_pk_bf16_f32 v95, v54, v55
    buffer_store_dwordx4 v[92:95], v186, s[28:31], s81 offen offset:1024 sc1
    v_cvt_pk_bf16_f32 v96, v56, v57
    v_cvt_pk_bf16_f32 v97, v58, v59
    v_cvt_pk_bf16_f32 v98, v60, v61
    v_cvt_pk_bf16_f32 v99, v62, v63
    buffer_store_dwordx4 v[96:99], v186, s[28:31], s81 offen offset:2048 sc1
    v_cvt_pk_bf16_f32 v100, v64, v65
    v_cvt_pk_bf16_f32 v101, v66, v67
    v_cvt_pk_bf16_f32 v102, v68, v69
    v_cvt_pk_bf16_f32 v103, v70, v71
    buffer_store_dwordx4 v[100:103], v186, s[28:31], s81 offen offset:3072 sc1
    v_mov_b32 v2, s0
    s_waitcnt vmcnt(0)
    s_mov_b64 exec, 1
    buffer_store_dword v2, v187, s[28:31], 0 offen sc1
    s_branch M_fin
M_poll:
    s_sub_u32 s3, s3, 1
    s_cbranch_scc1 M_got
    s_sleep 1
    buffer_load_dword v245, v187, s[28:31], 0 offen sc1
M_A:
    s_waitcnt vmcnt(0)
    v_readfirstlane_b32 s64, v245
    s_nop 3
    s_cmp_lg_u32 s64, s0
    s_cbranch_scc1 M_poll
M_got:
    s_nop 7
    buffer_load_dwordx4 v[72:75], v186, s[28:31], s80 offen offset:0 sc1
    buffer_load_dwordx4 v[76:79], v186, s[28:31], s80 offen offset:1024 sc1
    buffer_load_dwordx4 v[80:83], v186, s[28:31], s80 offen offset:2048 sc1
    buffer_load_dwordx4 v[84:87], v186, s[28:31], s80 offen offset:3072 sc1
    buffer_load_dwordx4 v[88:91], v186, s[28:31], s81 offen offset:0 sc1
    buffer_load_dwordx4 v[92:95], v186, s[28:31], s81 offen offset:1024 sc1
    buffer_load_dwordx4 v[96:99], v186, s[28:31], s81 offen offset:2048 sc1
    buffer_load_dwordx4 v[100:103], v186, s[28:31], s81 offen offset:3072 sc1
    v_lshlrev_b32 v200, 16, v136
    v_and_b32 v201, 0xffff0000, v136
    v_lshlrev_b32 v202, 16, v137
    v_and_b32 v203, 0xffff0000, v137
    v_lshlrev_b32 v204, 16, v138
    v_and_b32 v205, 0xffff0000, v138
    v_lshlrev_b32 v206, 16, v139
    v_and_b32 v207, 0xffff0000, v139
    s_waitcnt vmcnt(7)
    v_lshlrev_b32 v104, 16, v72
    v_and_b32 v105, 0xffff0000, v72
    v_lshlrev_b32 v106, 16, v73
    v_and_b32 v107, 0xffff0000, v73
    v_lshlrev_b32 v108, 16, v74
    v_and_b32 v109, 0xffff0000, v74
    v_lshlrev_b32 v110, 16, v75
    v_and_b32 v111, 0xffff0000, v75
    v_pk_add_f32 v[8:9], v[8:9], v[104:105]
    v_pk_add_f32 v[10:11], v[10:11], v[106:107]
    v_pk_add_f32 v[12:13], v[12:13], v[108:109]
    v_pk_add_f32 v[14:15], v[14:15], v[110:111]
    v_pk_fma_f32 v[200:201], v[8:9], v[168:169], v[200:201]
    v_pk_fma_f32 v[202:203], v[10:11], v[170:171], v[202:203]
    v_pk_fma_f32 v[204:205], v[12:13], v[172:173], v[204:205]
    v_pk_fma_f32 v[206:207], v[14:15], v[174:175], v[206:207]
    v_cvt_pk_bf16_f32 v136, v200, v201
    v_cvt_pk_bf16_f32 v137, v202, v203
    v_cvt_pk_bf16_f32 v138, v204, v205
    v_cvt_pk_bf16_f32 v139, v206, v207
    s_nop 0
    v_permlane16_swap_b32 v136, v138
    v_permlane16_swap_b32 v137, v139
    buffer_store_dwordx4 v[136:139], v184, s[40:43], s72 offen offset:0
    v_lshlrev_b32 v208, 16, v140
    v_and_b32 v209, 0xffff0000, v140
    v_lshlrev_b32 v210, 16, v141
    v_and_b32 v211, 0xffff0000, v141
    v_lshlrev_b32 v212, 16, v142
    v_and_b32 v213, 0xffff0000, v142
    v_lshlrev_b32 v214, 16, v143
    v_and_b32 v215, 0xffff0000, v143
    s_waitcnt vmcnt(7)
    v_lshlrev_b32 v112, 16, v76
    v_and_b32 v113, 0xffff0000, v76
    v_lshlrev_b32 v114, 16, v77
    v_and_b32 v115, 0xffff0000, v77
    v_lshlrev_b32 v116, 16, v78
    v_and_b32 v117, 0xffff0000, v78
    v_lshlrev_b32 v118, 16, v79
    v_and_b32 v119, 0xffff0000, v79
    v_pk_add_f32 v[16:17], v[16:17], v[112:113]
    v_pk_add_f32 v[18:19], v[18:19], v[114:115]
    v_pk_add_f32 v[20:21], v[20:21], v[116:117]
    v_pk_add_f32 v[22:23], v[22:23], v[118:119]
    v_pk_fma_f32 v[208:209], v[16:17], v[176:177], v[208:209]
    v_pk_fma_f32 v[210:211], v[18:19], v[178:179], v[210:211]
    v_pk_fma_f32 v[212:213], v[20:21], v[180:181], v[212:213]
    v_pk_fma_f32 v[214:215], v[22:23], v[182:183], v[214:215]
    v_cvt_pk_bf16_f32 v140, v208, v209
    v_cvt_pk_bf16_f32 v141, v210, v211
    v_cvt_pk_bf16_f32 v142, v212, v213
    v_cvt_pk_bf16_f32 v143, v214, v215
    s_nop 0
    v_permlane16_swap_b32 v140, v142
    v_permlane16_swap_b32 v141, v143
    buffer_store_dwordx4 v[140:143], v184, s[40:43], s72 offen offset:64
    v_lshlrev_b32 v200, 16, v144
    v_and_b32 v201, 0xffff0000, v144
    v_lshlrev_b32 v202, 16, v145
    v_and_b32 v203, 0xffff0000, v145
    v_lshlrev_b32 v204, 16, v146
    v_and_b32 v205, 0xffff0000, v146
    v_lshlrev_b32 v206, 16, v147
    v_and_b32 v207, 0xffff0000, v147
    s_waitcnt vmcnt(7)
    v_lshlrev_b32 v120, 16, v80
    v_and_b32 v121, 0xffff0000, v80
    v_lshlrev_b32 v122, 16, v81
    v_and_b32 v123, 0xffff0000, v81
    v_lshlrev_b32 v124, 16, v82
    v_and_b32 v125, 0xffff0000, v82
    v_lshlrev_b32 v126, 16, v83
    v_and_b32 v127, 0xffff0000, v83
    v_pk_add_f32 v[24:25], v[24:25], v[120:121]
    v_pk_add_f32 v[26:27], v[26:27], v[122:123]
    v_pk_add_f32 v[28:29], v[28:29], v[124:125]
    v_pk_add_f32 v[30:31], v[30:31], v[126:127]
    v_pk_fma_f32 v[200:201], v[24:25], v[168:169], v[200:201]
    v_pk_fma_f32 v[202:203], v[26:27], v[170:171], v[202:203]
    v_pk_fma_f32 v[204:205], v[28:29], v[172:173], v[204:205]
    v_pk_fma_f32 v[206:207], v[30:31], v[174:175], v[206:207]
    v_cvt_pk_bf16_f32 v144, v200, v201
    v_cvt_pk_bf16_f32 v145, v202, v203
    v_cvt_pk_bf16_f32 v146, v204, v205
    v_cvt_pk_bf16_f32 v147, v206, v207
    s_nop 0
    v_permlane16_swap_b32 v144, v146
    v_permlane16_swap_b32 v145, v147
    buffer_store_dwordx4 v[144:147], v184, s[40:43], s73 offen offset:0
    v_lshlrev_b32 v208, 16, v148
    v_and_b32 v209, 0xffff0000, v148
    v_lshlrev_b32 v210, 16, v149
    v_and_b32 v211, 0xffff0000, v149
    v_lshlrev_b32 v212, 16, v150
    v_and_b32 v213, 0xffff0000, v150
    v_lshlrev_b32 v214, 16, v151
    v_and_b32 v215, 0xffff0000, v151
    s_waitcnt vmcnt(7)
    v_lshlrev_b32 v128, 16, v84
    v_and_b32 v129, 0xffff0000, v84
    v_lshlrev_b32 v130, 16, v85
    v_and_b32 v131, 0xffff0000, v85
    v_lshlrev_b32 v132, 16, v86
    v_and_b32 v133, 0xffff0000, v86
    v_lshlrev_b32 v134, 16, v87
    v_and_b32 v135, 0xffff0000, v87
    v_pk_add_f32 v[32:33], v[32:33], v[128:129]
    v_pk_add_f32 v[34:35], v[34:35], v[130:131]
    v_pk_add_f32 v[36:37], v[36:37], v[132:133]
    v_pk_add_f32 v[38:39], v[38:39], v[134:135]
    v_pk_fma_f32 v[208:209], v[32:33], v[176:177], v[208:209]
    v_pk_fma_f32 v[210:211], v[34:35], v[178:179], v[210:211]
    v_pk_fma_f32 v[212:213], v[36:37], v[180:181], v[212:213]
    v_pk_fma_f32 v[214:215], v[38:39], v[182:183], v[214:215]
    v_cvt_pk_bf16_f32 v148, v208, v209
    v_cvt_pk_bf16_f32 v149, v210, v211
    v_cvt_pk_bf16_f32 v150, v212, v213
    v_cvt_pk_bf16_f32 v151, v214, v215
    s_nop 0
    v_permlane16_swap_b32 v148, v150
    v_permlane16_swap_b32 v149, v151
    buffer_store_dwordx4 v[148:151], v184, s[40:43], s73 offen offset:64
    v_lshlrev_b32 v200, 16, v152
    v_and_b32 v201, 0xffff0000, v152
    v_lshlrev_b32 v202, 16, v153
    v_and_b32 v203, 0xffff0000, v153
    v_lshlrev_b32 v204, 16, v154
    v_and_b32 v205, 0xffff0000, v154
    v_lshlrev_b32 v206, 16, v155
    v_and_b32 v207, 0xffff0000, v155
    s_waitcnt vmcnt(7)
    v_lshlrev_b32 v104, 16, v88
    v_and_b32 v105, 0xffff0000, v88
    v_lshlrev_b32 v106, 16, v89
    v_and_b32 v107, 0xffff0000, v89
    v_lshlrev_b32 v108, 16, v90
    v_and_b32 v109, 0xffff0000, v90
    v_lshlrev_b32 v110, 16, v91
    v_and_b32 v111, 0xffff0000, v91
    v_pk_add_f32 v[40:41], v[40:41], v[104:105]
    v_pk_add_f32 v[42:43], v[42:43], v[106:107]
    v_pk_add_f32 v[44:45], v[44:45], v[108:109]
    v_pk_add_f32 v[46:47], v[46:47], v[110:111]
    v_pk_fma_f32 v[200:201], v[40:41], v[168:169], v[200:201]
    v_pk_fma_f32 v[202:203], v[42:43], v[170:171], v[202:203]
    v_pk_fma_f32 v[204:205], v[44:45], v[172:173], v[204:205]
    v_pk_fma_f32 v[206:207], v[46:47], v[174:175], v[206:207]
    v_cvt_pk_bf16_f32 v152, v200, v201
    v_cvt_pk_bf16_f32 v153, v202, v203
    v_cvt_pk_bf16_f32 v154, v204, v205
    v_cvt_pk_bf16_f32 v155, v206, v207
    s_nop 0
    v_permlane16_swap_b32 v152, v154
    v_permlane16_swap_b32 v153, v155
    buffer_store_dwordx4 v[152:155], v184, s[40:43], s74 offen offset:0
    v_lshlrev_b32 v208, 16, v156
    v_and_b32 v209, 0xffff0000, v156
    v_lshlrev_b32 v210, 16, v157
    v_and_b32 v211, 0xffff0000, v157
    v_lshlrev_b32 v212, 16, v158
    v_and_b32 v213, 0xffff0000, v158
    v_lshlrev_b32 v214, 16, v159
    v_and_b32 v215, 0xffff0000, v159
    s_waitcnt vmcnt(7)
    v_lshlrev_b32 v112, 16, v92
    v_and_b32 v113, 0xffff0000, v92
    v_lshlrev_b32 v114, 16, v93
    v_and_b32 v115, 0xffff0000, v93
    v_lshlrev_b32 v116, 16, v94
    v_and_b32 v117, 0xffff0000, v94
    v_lshlrev_b32 v118, 16, v95
    v_and_b32 v119, 0xffff0000, v95
    v_pk_add_f32 v[48:49], v[48:49], v[112:113]
    v_pk_add_f32 v[50:51], v[50:51], v[114:115]
    v_pk_add_f32 v[52:53], v[52:53], v[116:117]
    v_pk_add_f32 v[54:55], v[54:55], v[118:119]
    v_pk_fma_f32 v[208:209], v[48:49], v[176:177], v[208:209]
    v_pk_fma_f32 v[210:211], v[50:51], v[178:179], v[210:211]
    v_pk_fma_f32 v[212:213], v[52:53], v[180:181], v[212:213]
    v_pk_fma_f32 v[214:215], v[54:55], v[182:183], v[214:215]
    v_cvt_pk_bf16_f32 v156, v208, v209
    v_cvt_pk_bf16_f32 v157, v210, v211
    v_cvt_pk_bf16_f32 v158, v212, v213
    v_cvt_pk_bf16_f32 v159, v214, v215
    s_nop 0
    v_permlane16_swap_b32 v156, v158
    v_permlane16_swap_b32 v157, v159
    buffer_store_dwordx4 v[156:159], v184, s[40:43], s74 offen offset:64
    v_lshlrev_b32 v200, 16, v160
    v_and_b32 v201, 0xffff0000, v160
    v_lshlrev_b32 v202, 16, v161
    v_and_b32 v203, 0xffff0000, v161
    v_lshlrev_b32 v204, 16, v162
    v_and_b32 v205, 0xffff0000, v162
    v_lshlrev_b32 v206, 16, v163
    v_and_b32 v207, 0xffff0000, v163
    s_waitcnt vmcnt(7)
    v_lshlrev_b32 v120, 16, v96
    v_and_b32 v121, 0xffff0000, v96
    v_lshlrev_b32 v122, 16, v97
    v_and_b32 v123, 0xffff0000, v97
    v_lshlrev_b32 v124, 16, v98
    v_and_b32 v125, 0xffff0000, v98
    v_lshlrev_b32 v126, 16, v99
    v_and_b32 v127, 0xffff0000, v99
    v_pk_add_f32 v[56:57], v[56:57], v[120:121]
    v_pk_add_f32 v[58:59], v[58:59], v[122:123]
    v_pk_add_f32 v[60:61], v[60:61], v[124:125]
    v_pk_add_f32 v[62:63], v[62:63], v[126:127]
    v_pk_fma_f32 v[200:201], v[56:57], v[168:169], v[200:201]
    v_pk_fma_f32 v[202:203], v[58:59], v[170:171], v[202:203]
    v_pk_fma_f32 v[204:205], v[60:61], v[172:173], v[204:205]
    v_pk_fma_f32 v[206:207], v[62:63], v[174:175], v[206:207]
    v_cvt_pk_bf16_f32 v160, v200, v201
    v_cvt_pk_bf16_f32 v161, v202, v203
    v_cvt_pk_bf16_f32 v162, v204, v205
    v_cvt_pk_bf16_f32 v163, v206, v207
    s_nop 0
    v_permlane16_swap_b32 v160, v162
    v_permlane16_swap_b32 v161, v163
    buffer_store_dwordx4 v[160:163], v184, s[40:43], s75 offen offset:0
    v_lshlrev_b32 v208, 16, v164
    v_and_b32 v209, 0xffff0000, v164
    v_lshlrev_b32 v210, 16, v165
    v_and_b32 v211, 0xffff0000, v165
    v_lshlrev_b32 v212, 16, v166
    v_and_b32 v213, 0xffff0000, v166
    v_lshlrev_b32 v214, 16, v167
    v_and_b32 v215, 0xffff0000, v167
    s_waitcnt vmcnt(7)
    v_lshlrev_b32 v128, 16, v100
    v_and_b32 v129, 0xffff0000, v100
    v_lshlrev_b32 v130, 16, v101
    v_and_b32 v131, 0xffff0000, v101
    v_lshlrev_b32 v132, 16, v102
    v_and_b32 v133, 0xffff0000, v102
    v_lshlrev_b32 v134, 16, v103
    v_and_b32 v135, 0xffff0000, v103
    v_pk_add_f32 v[64:65], v[64:65], v[128:129]
    v_pk_add_f32 v[66:67], v[66:67], v[130:131]
    v_pk_add_f32 v[68:69], v[68:69], v[132:133]
    v_pk_add_f32 v[70:71], v[70:71], v[134:135]
    v_pk_fma_f32 v[208:209], v[64:65], v[176:177], v[208:209]
    v_pk_fma_f32 v[210:211], v[66:67], v[178:179], v[210:211]
    v_pk_fma_f32 v[212:213], v[68:69], v[180:181], v[212:213]
    v_pk_fma_f32 v[214:215], v[70:71], v[182:183], v[214:215]
    v_cvt_pk_bf16_f32 v164, v208, v209
    v_cvt_pk_bf16_f32 v165, v210, v211
    v_cvt_pk_bf16_f32 v166, v212, v213
    v_cvt_pk_bf16_f32 v167, v214, v215
    s_nop 0
    v_permlane16_swap_b32 v164, v166
    v_permlane16_swap_b32 v165, v167
    buffer_store_dwordx4 v[164:167], v184, s[40:43], s75 offen offset:64
    s_branch M_fin
M_Pidle:
    s_nop 7
    s_barrier
    s_lshl_b32 s70, s48, 12
    s_lshl_b32 s64, s47, 3
    s_lshl_b32 s65, s45, 2
    s_add_u32 s64, s64, s65
    s_mul_i32 s64, s64, 114688
    s_add_u32 s64, s64, s70
    s_lshl_b32 s65, s46, 11
    s_add_u32 s64, s64, s65
    s_add_u32 s64, s64, 0x1500000
    v_lshl_add_u32 v198, v1, 4, s64
    v_mul_f32 v24, v8, v24
    v_exp_f32 v216, -v8
    v_mul_f32 v25, v9, v25
    v_exp_f32 v217, -v9
    v_mul_f32 v26, v10, v26
    v_exp_f32 v218, -v10
    v_mul_f32 v27, v11, v27
    v_exp_f32 v219, -v11
    v_mul_f32 v28, v12, v28
    v_exp_f32 v220, -v12
    v_mul_f32 v29, v13, v29
    v_exp_f32 v221, -v13
    v_mul_f32 v30, v14, v30
    v_exp_f32 v222, -v14
    v_mul_f32 v31, v15, v31
    v_exp_f32 v223, -v15
    v_fma_f32 v216, v216, s67, s67
    v_fma_f32 v217, v217, s67, s67
    v_rcp_f32 v216, v216
    v_fma_f32 v218, v218, s67, s67
    v_rcp_f32 v217, v217
    v_fma_f32 v219, v219, s67, s67
    v_rcp_f32 v218, v218
    v_fma_f32 v220, v220, s67, s67
    v_rcp_f32 v219, v219
    v_fma_f32 v221, v221, s67, s67
    v_rcp_f32 v220, v220
    v_fma_f32 v222, v222, s67, s67
    v_rcp_f32 v221, v221
    v_fma_f32 v223, v223, s67, s67
    v_rcp_f32 v222, v222
    v_rcp_f32 v223, v223
    v_mul_f32 v24, v24, v216
    v_mul_f32 v25, v25, v217
    v_mul_f32 v26, v26, v218
    v_mul_f32 v27, v27, v219
    v_mul_f32 v28, v28, v220
    v_mul_f32 v29, v29, v221
    v_mul_f32 v30, v30, v222
    v_mul_f32 v31, v31, v223
    v_cvt_pk_bf16_f32 v200, v24, v25
    v_cvt_pk_bf16_f32 v201, v26, v27
    v_cvt_pk_bf16_f32 v202, v28, v29
    v_cvt_pk_bf16_f32 v203, v30, v31
    buffer_store_dwordx4 v[200:203], v198, s[28:31], 0 offen offset:0 sc1
    v_mul_f32 v32, v16, v32
    v_exp_f32 v224, -v16
    v_mul_f32 v33, v17, v33
    v_exp_f32 v225, -v17
    v_mul_f32 v34, v18, v34
    v_exp_f32 v226, -v18
    v_mul_f32 v35, v19, v35
    v_exp_f32 v227, -v19
    v_mul_f32 v36, v20, v36
    v_exp_f32 v228, -v20
    v_mul_f32 v37, v21, v37
    v_exp_f32 v229, -v21
    v_mul_f32 v38, v22, v38
    v_exp_f32 v230, -v22
    v_mul_f32 v39, v23, v39
    v_exp_f32 v231, -v23
    v_fma_f32 v224, v224, s67, s67
    v_fma_f32 v225, v225, s67, s67
    v_rcp_f32 v224, v224
    v_fma_f32 v226, v226, s67, s67
    v_rcp_f32 v225, v225
    v_fma_f32 v227, v227, s67, s67
    v_rcp_f32 v226, v226
    v_fma_f32 v228, v228, s67, s67
    v_rcp_f32 v227, v227
    v_fma_f32 v229, v229, s67, s67
    v_rcp_f32 v228, v228
    v_fma_f32 v230, v230, s67, s67
    v_rcp_f32 v229, v229
    v_fma_f32 v231, v231, s67, s67
    v_rcp_f32 v230, v230
    v_rcp_f32 v231, v231
    v_mul_f32 v32, v32, v224
    v_mul_f32 v33, v33, v225
    v_mul_f32 v34, v34, v226
    v_mul_f32 v35, v35, v227
    v_mul_f32 v36, v36, v228
    v_mul_f32 v37, v37, v229
    v_mul_f32 v38, v38, v230
    v_mul_f32 v39, v39, v231
    v_cvt_pk_bf16_f32 v204, v32, v33
    v_cvt_pk_bf16_f32 v205, v34, v35
    v_cvt_pk_bf16_f32 v206, v36, v37
    v_cvt_pk_bf16_f32 v207, v38, v39
    buffer_store_dwordx4 v[204:207], v198, s[28:31], 0 offen offset:1024 sc1
    v_add_u32 v198, 114688, v198
    v_mul_f32 v56, v40, v56
    v_exp_f32 v216, -v40
    v_mul_f32 v57, v41, v57
    v_exp_f32 v217, -v41
    v_mul_f32 v58, v42, v58
    v_exp_f32 v218, -v42
    v_mul_f32 v59, v43, v59
    v_exp_f32 v219, -v43
    v_mul_f32 v60, v44, v60
    v_exp_f32 v220, -v44
    v_mul_f32 v61, v45, v61
    v_exp_f32 v221, -v45
    v_mul_f32 v62, v46, v62
    v_exp_f32 v222, -v46
    v_mul_f32 v63, v47, v63
    v_exp_f32 v223, -v47
    v_fma_f32 v216, v216, s67, s67
    v_fma_f32 v217, v217, s67, s67
    v_rcp_f32 v216, v216
    v_fma_f32 v218, v218, s67, s67
    v_rcp_f32 v217, v217
    v_fma_f32 v219, v219, s67, s67
    v_rcp_f32 v218, v218
    v_fma_f32 v220, v220, s67, s67
    v_rcp_f32 v219, v219
    v_fma_f32 v221, v221, s67, s67
    v_rcp_f32 v220, v220
    v_fma_f32 v222, v222, s67, s67
    v_rcp_f32 v221, v221
    v_fma_f32 v223, v223, s67, s67
    v_rcp_f32 v222, v222
    v_rcp_f32 v223, v223
    v_mul_f32 v56, v56, v216
    v_mul_f32 v57, v57, v217
    v_mul_f32 v58, v58, v218
    v_mul_f32 v59, v59, v219
    v_mul_f32 v60, v60, v220
    v_mul_f32 v61, v61, v221
    v_mul_f32 v62, v62, v222
    v_mul_f32 v63, v63, v223
    v_cvt_pk_bf16_f32 v208, v56, v57
    v_cvt_pk_bf16_f32 v209, v58, v59
    v_cvt_pk_bf16_f32 v210, v60, v61
    v_cvt_pk_bf16_f32 v211, v62, v63
    buffer_store_dwordx4 v[208:211], v198, s[28:31], 0 offen offset:0 sc1
    v_mul_f32 v64, v48, v64
    v_exp_f32 v224, -v48
    v_mul_f32 v65, v49, v65
    v_exp_f32 v225, -v49
    v_mul_f32 v66, v50, v66
    v_exp_f32 v226, -v50
    v_mul_f32 v67, v51, v67
    v_exp_f32 v227, -v51
    v_mul_f32 v68, v52, v68
    v_exp_f32 v228, -v52
    v_mul_f32 v69, v53, v69
    v_exp_f32 v229, -v53
    v_mul_f32 v70, v54, v70
    v_exp_f32 v230, -v54
    v_mul_f32 v71, v55, v71
    v_exp_f32 v231, -v55
    v_fma_f32 v224, v224, s67, s67
    v_fma_f32 v225, v225, s67, s67
    v_rcp_f32 v224, v224
    v_fma_f32 v226, v226, s67, s67
    v_rcp_f32 v225, v225
    v_fma_f32 v227, v227, s67, s67
    v_rcp_f32 v226, v226
    v_fma_f32 v228, v228, s67, s67
    v_rcp_f32 v227, v227
    v_fma_f32 v229, v229, s67, s67
    v_rcp_f32 v228, v228
    v_fma_f32 v230, v230, s67, s67
    v_rcp_f32 v229, v229
    v_fma_f32 v231, v231, s67, s67
    v_rcp_f32 v230, v230
    v_rcp_f32 v231, v231
    v_mul_f32 v64, v64, v224
    v_mul_f32 v65, v65, v225
    v_mul_f32 v66, v66, v226
    v_mul_f32 v67, v67, v227
    v_mul_f32 v68, v68, v228
    v_mul_f32 v69, v69, v229
    v_mul_f32 v70, v70, v230
    v_mul_f32 v71, v71, v231
    v_cvt_pk_bf16_f32 v212, v64, v65
    v_cvt_pk_bf16_f32 v213, v66, v67
    v_cvt_pk_bf16_f32 v214, v68, v69
    v_cvt_pk_bf16_f32 v215, v70, v71
    buffer_store_dwordx4 v[212:215], v198, s[28:31], 0 offen offset:1024 sc1
    v_add_u32 v198, 114688, v198
    v_mul_f32 v88, v72, v88
    v_exp_f32 v216, -v72
    v_mul_f32 v89, v73, v89
    v_exp_f32 v217, -v73
    v_mul_f32 v90, v74, v90
    v_exp_f32 v218, -v74
    v_mul_f32 v91, v75, v91
    v_exp_f32 v219, -v75
    v_mul_f32 v92, v76, v92
    v_exp_f32 v220, -v76
    v_mul_f32 v93, v77, v93
    v_exp_f32 v221, -v77
    v_mul_f32 v94, v78, v94
    v_exp_f32 v222, -v78
    v_mul_f32 v95, v79, v95
    v_exp_f32 v223, -v79
    v_fma_f32 v216, v216, s67, s67
    v_fma_f32 v217, v217, s67, s67
    v_rcp_f32 v216, v216
    v_fma_f32 v218, v218, s67, s67
    v_rcp_f32 v217, v217
    v_fma_f32 v219, v219, s67, s67
    v_rcp_f32 v218, v218
    v_fma_f32 v220, v220, s67, s67
    v_rcp_f32 v219, v219
    v_fma_f32 v221, v221, s67, s67
    v_rcp_f32 v220, v220
    v_fma_f32 v222, v222, s67, s67
    v_rcp_f32 v221, v221
    v_fma_f32 v223, v223, s67, s67
    v_rcp_f32 v222, v222
    v_rcp_f32 v223, v223
    v_mul_f32 v88, v88, v216
    v_mul_f32 v89, v89, v217
    v_mul_f32 v90, v90, v218
    v_mul_f32 v91, v91, v219
    v_mul_f32 v92, v92, v220
    v_mul_f32 v93, v93, v221
    v_mul_f32 v94, v94, v222
    v_mul_f32 v95, v95, v223
    v_cvt_pk_bf16_f32 v200, v88, v89
    v_cvt_pk_bf16_f32 v201, v90, v91
    v_cvt_pk_bf16_f32 v202, v92, v93
    v_cvt_pk_bf16_f32 v203, v94, v95
    buffer_store_dwordx4 v[200:203], v198, s[28:31], 0 offen offset:0 sc1
    v_mul_f32 v96, v80, v96
    v_exp_f32 v224, -v80
    v_mul_f32 v97, v81, v97
    v_exp_f32 v225, -v81
    v_mul_f32 v98, v82, v98
    v_exp_f32 v226, -v82
    v_mul_f32 v99, v83, v99
    v_exp_f32 v227, -v83
    v_mul_f32 v100, v84, v100
    v_exp_f32 v228, -v84
    v_mul_f32 v101, v85, v101
    v_exp_f32 v229, -v85
    v_mul_f32 v102, v86, v102
    v_exp_f32 v230, -v86
    v_mul_f32 v103, v87, v103
    v_exp_f32 v231, -v87
    v_fma_f32 v224, v224, s67, s67
    v_fma_f32 v225, v225, s67, s67
    v_rcp_f32 v224, v224
    v_fma_f32 v226, v226, s67, s67
    v_rcp_f32 v225, v225
    v_fma_f32 v227, v227, s67, s67
    v_rcp_f32 v226, v226
    v_fma_f32 v228, v228, s67, s67
    v_rcp_f32 v227, v227
    v_fma_f32 v229, v229, s67, s67
    v_rcp_f32 v228, v228
    v_fma_f32 v230, v230, s67, s67
    v_rcp_f32 v229, v229
    v_fma_f32 v231, v231, s67, s67
    v_rcp_f32 v230, v230
    v_rcp_f32 v231, v231
    v_mul_f32 v96, v96, v224
    v_mul_f32 v97, v97, v225
    v_mul_f32 v98, v98, v226
    v_mul_f32 v99, v99, v227
    v_mul_f32 v100, v100, v228
    v_mul_f32 v101, v101, v229
    v_mul_f32 v102, v102, v230
    v_mul_f32 v103, v103, v231
    v_cvt_pk_bf16_f32 v204, v96, v97
    v_cvt_pk_bf16_f32 v205, v98, v99
    v_cvt_pk_bf16_f32 v206, v100, v101
    v_cvt_pk_bf16_f32 v207, v102, v103
    buffer_store_dwordx4 v[204:207], v198, s[28:31], 0 offen offset:1024 sc1
    v_add_u32 v198, 114688, v198
    v_mul_f32 v120, v104, v120
    v_exp_f32 v216, -v104
    v_mul_f32 v121, v105, v121
    v_exp_f32 v217, -v105
    v_mul_f32 v122, v106, v122
    v_exp_f32 v218, -v106
    v_mul_f32 v123, v107, v123
    v_exp_f32 v219, -v107
    v_mul_f32 v124, v108, v124
    v_exp_f32 v220, -v108
    v_mul_f32 v125, v109, v125
    v_exp_f32 v221, -v109
    v_mul_f32 v126, v110, v126
    v_exp_f32 v222, -v110
    v_mul_f32 v127, v111, v127
    v_exp_f32 v223, -v111
    v_fma_f32 v216, v216, s67, s67
    v_fma_f32 v217, v217, s67, s67
    v_rcp_f32 v216, v216
    v_fma_f32 v218, v218, s67, s67
    v_rcp_f32 v217, v217
    v_fma_f32 v219, v219, s67, s67
    v_rcp_f32 v218, v218
    v_fma_f32 v220, v220, s67, s67
    v_rcp_f32 v219, v219
    v_fma_f32 v221, v221, s67, s67
    v_rcp_f32 v220, v220
    v_fma_f32 v222, v222, s67, s67
    v_rcp_f32 v221, v221
    v_fma_f32 v223, v223, s67, s67
    v_rcp_f32 v222, v222
    v_rcp_f32 v223, v223
    v_mul_f32 v120, v120, v216
    v_mul_f32 v121, v121, v217
    v_mul_f32 v122, v122, v218
    v_mul_f32 v123, v123, v219
    v_mul_f32 v124, v124, v220
    v_mul_f32 v125, v125, v221
    v_mul_f32 v126, v126, v222
    v_mul_f32 v127, v127, v223
    v_cvt_pk_bf16_f32 v208, v120, v121
    v_cvt_pk_bf16_f32 v209, v122, v123
    v_cvt_pk_bf16_f32 v210, v124, v125
    v_cvt_pk_bf16_f32 v211, v126, v127
    buffer_store_dwordx4 v[208:211], v198, s[28:31], 0 offen offset:0 sc1
    v_mul_f32 v128, v112, v128
    v_exp_f32 v224, -v112
    v_mul_f32 v129, v113, v129
    v_exp_f32 v225, -v113
    v_mul_f32 v130, v114, v130
    v_exp_f32 v226, -v114
    v_mul_f32 v131, v115, v131
    v_exp_f32 v227, -v115
    v_mul_f32 v132, v116, v132
    v_exp_f32 v228, -v116
    v_mul_f32 v133, v117, v133
    v_exp_f32 v229, -v117
    v_mul_f32 v134, v118, v134
    v_exp_f32 v230, -v118
    v_mul_f32 v135, v119, v135
    v_exp_f32 v231, -v119
    v_fma_f32 v224, v224, s67, s67
    v_fma_f32 v225, v225, s67, s67
    v_rcp_f32 v224, v224
    v_fma_f32 v226, v226, s67, s67
    v_rcp_f32 v225, v225
    v_fma_f32 v227, v227, s67, s67
    v_rcp_f32 v226, v226
    v_fma_f32 v228, v228, s67, s67
    v_rcp_f32 v227, v227
    v_fma_f32 v229, v229, s67, s67
    v_rcp_f32 v228, v228
    v_fma_f32 v230, v230, s67, s67
    v_rcp_f32 v229, v229
    v_fma_f32 v231, v231, s67, s67
    v_rcp_f32 v230, v230
    v_rcp_f32 v231, v231
    v_mul_f32 v128, v128, v224
    v_mul_f32 v129, v129, v225
    v_mul_f32 v130, v130, v226
    v_mul_f32 v131, v131, v227
    v_mul_f32 v132, v132, v228
    v_mul_f32 v133, v133, v229
    v_mul_f32 v134, v134, v230
    v_mul_f32 v135, v135, v231
    v_cvt_pk_bf16_f32 v212, v128, v129
    v_cvt_pk_bf16_f32 v213, v130, v131
    v_cvt_pk_bf16_f32 v214, v132, v133
    v_cvt_pk_bf16_f32 v215, v134, v135
    buffer_store_dwordx4 v[212:215], v198, s[28:31], 0 offen offset:1024 sc1
    s_lshl_b32 s64, s50, 3
    s_lshl_b32 s65, s44, 1
    s_add_u32 s64, s64, s65
    s_mul_i32 s64, s64, 114688
    s_add_u32 s64, s64, 0x1500000
    v_lshl_add_u32 v192, v1, 4, s64
    v_add_u32 v193, 112640, v192
    s_lshl_b32 s65, s51, 8
    v_lshrrev_b32 v3, 4, v1
    s_lshl_b32 s64, s44, 4
    v_add_u32 v2, s64, v3
    s_movk_i32 s64, 2048
    v_mul_u32_u24 v2, s64, v2
    v_add_u32 v2, s65, v2
    v_lshlrev_b32 v3, 1, v3
    v_and_b32 v4, 15, v1
    v_xor_b32 v3, v3, v4
    v_lshl_add_u32 v194, v3, 4, v2
    v_add_u32 v196, 14336, v194
    v_xor_b32 v3, 8, v3
    v_lshl_add_u32 v195, v3, 4, v2
    v_add_u32 v195, 7168, v195
    v_add_u32 v197, 14336, v195
    s_lshl_b32 s64, s47, 8
    s_lshl_b32 s65, s48, 4
    s_add_u32 s64, s64, s65
    s_lshl_b32 s65, s44, 2
    s_add_u32 s64, s64, s65
    s_add_u32 s64, s64, 0x51000
    v_mov_b32 v2, s0
    s_waitcnt vmcnt(0)
    s_mov_b64 exec, 1
    buffer_store_dword v2, v234, s[28:31], s64 offen sc1
    s_mov_b64 exec, -1
    s_barrier
    s_lshl_b32 s68, s50, 8
    s_add_u32 s68, s68, 0x51000
    buffer_load_dword v245, v234, s[28:31], s68 offen sc1
    s_waitcnt vmcnt(0)
    s_branch M_Pjoin
M_Q:
    s_setprio 0
    s_sub_u32 s44, s44, 4
    s_lshl_b32 s62, s47, 4
    s_add_u32 s62, s62, s48
    s_lshl_b32 s62, s62, 2
    s_add_u32 s62, s62, s44
    s_lshl_b32 s64, s62, 12
    v_lshl_add_u32 v2, v1, 4, s64
    s_waitcnt lgkmcnt(0)
    s_load_dword s0, s[26:27], 0
    s_mov_b32 s40, s4
    s_mov_b32 s41, s5
    s_mov_b32 s42, 0x400000
    s_mov_b32 s43, 0x20000
    buffer_load_dwordx4 v[104:107], v2, s[40:43], 0 offen offset:0
    buffer_load_dwordx4 v[108:111], v2, s[40:43], 0 offen offset:1024
    buffer_load_dwordx4 v[112:115], v2, s[40:43], 0 offen offset:2048
    buffer_load_dwordx4 v[116:119], v2, s[40:43], 0 offen offset:3072
    s_barrier
    s_or_b32 s65, s48, s44
    s_cmp_lg_u32 s65, 0
    s_cbranch_scc1 M_noclr
    s_lshl_b32 s64, s47, 9
    s_add_u32 s64, s64, 0x54000
    s_add_u32 s56, s26, s64
    s_addc_u32 s57, s27, 0
    s_mov_b32 s84, 0
    s_mov_b32 s85, 0
    s_mov_b32 s86, 0
    s_mov_b32 s87, 0
    s_mov_b32 s88, 0
    s_mov_b32 s89, 0
    s_mov_b32 s90, 0
    s_mov_b32 s91, 0
    s_mov_b32 s92, 0
    s_mov_b32 s93, 0
    s_mov_b32 s94, 0
    s_mov_b32 s95, 0
    s_atomic_swap s84, s[56:57], 0 glc
    s_atomic_swap s85, s[56:57], 128 glc
    s_atomic_swap s86, s[56:57], 256 glc
    s_atomic_swap s87, s[56:57], 384 glc
    s_atomic_swap s88, s[56:57], 8192 glc
    s_atomic_swap s89, s[56:57], 8320 glc
    s_atomic_swap s90, s[56:57], 8448 glc
    s_atomic_swap s91, s[56:57], 8576 glc
    s_atomic_swap s92, s[56:57], 16384 glc
    s_atomic_swap s93, s[56:57], 16512 glc
    s_atomic_swap s94, s[56:57], 16640 glc
    s_atomic_swap s95, s[56:57], 16768 glc
M_noclr:
    v_bfe_u32 v2, v0, 3, 5
    v_and_b32 v3, 7, v0
    v_lshlrev_b32 v14, 5, v3
    v_add_u32 v14, 149504, v14
    s_lshl_b32 s64, s48, 7
    v_lshl_add_u32 v4, v3, 4, s64
    s_lshl_b32 s70, s47, 7
    v_add_u32 v12, s70, v2
    v_lshl_add_u32 v8, v12, 11, v4
    s_max_u32 s70, s70, 16
    s_sub_u32 s70, s70, 16
    v_and_b32 v5, 15, v2
    v_add_u32 v13, s70, v5
    v_lshl_add_u32 v9, v13, 11, v4
    v_and_b32 v4, 7, v2
    v_lshlrev_b32 v4, 3, v4
    v_add_u32 v4, 0x10000, v4
    v_lshrrev_b32 v12, 3, v12
    v_lshl_add_u32 v12, v12, 7, v4
    v_lshrrev_b32 v13, 3, v13
    v_lshl_add_u32 v13, v13, 7, v4
    v_lshlrev_b32 v3, 8, v3
    v_lshl_add_u32 v3, v5, 4, v3
    s_mul_i32 s64, s47, 294912
    s_lshl_b32 s65, s48, 11
    s_add_u32 s64, s64, s65
    s_add_u32 s64, s64, 0x100000
    s_cmp_ge_u32 s44, 2
    s_cselect_b32 s65, 0x80000000, s64
    v_add_u32 v11, s65, v3
    s_cselect_b32 s65, 32768, 0
    s_add_u32 s64, s64, s65
    s_add_u32 s64, s64, 32768
    v_add_u32 v10, s64, v3
    v_mov_b32 v19, v3
    s_lshr_b32 s64, s44, 1
    s_lshl_b32 s64, s64, 11
    s_add_u32 s64, s64, 2048
    v_add_u32 v15, s64, v3
    s_mov_b32 s53, 0
    s_lshl_b32 s72, s44, 12
    s_add_u32 s72, s72, 2048
    s_lshl_b32 s73, s44, 9
    s_mul_i32 s74, s44, 6144
    s_add_u32 s74, s74, 18432
    s_add_u32 s75, s74, 4096
    s_bfe_u32 s66, s2, 0x30003
    s_lshr_b32 s55, s2, 6
    s_add_u32 s66, s66, s55
    s_and_b32 s66, s66, 3
    s_mov_b32 s58, 0x76453210
    s_mov_b32 s59, 0xfecdba89
    s_cmp_eq_u32 s66, 1
    s_cselect_b32 s58, 0x75643120, s58
    s_cselect_b32 s59, 0xfdecb9a8, s59
    s_cmp_eq_u32 s66, 2
    s_cselect_b32 s58, 0x67542310, s58
    s_cselect_b32 s59, 0xefdcab98, s59
    s_cmp_eq_u32 s66, 3
    s_cselect_b32 s58, 0x86534210, s58
    s_cselect_b32 s59, 0xfedbca97, s59
    s_lshl_b32 s55, s48, 2
    s_lshr_b64 s[56:57], s[58:59], s55
    s_and_b32 s55, s56, 15
    s_lshl_b32 s55, s55, 2
    s_lshl_b64 s[56:57], 15, s55
    s_andn2_b64 s[58:59], s[58:59], s[56:57]
    s_or_b32 s58, s58, s48
    s_lshl_b32 s65, s48, 7
    s_mul_i32 s64, s44, 98304
    s_add_u32 s65, s65, s64
    s_movk_i32 s64, 6144
    v_add_u32 v2, 0, v1
    v_mul_u32_u24 v3, 0xab, v2
    v_lshrrev_b32 v3, 12, v3
    v_mul_u32_u24 v4, 24, v3
    v_sub_u32 v2, v2, v4
    v_and_b32 v4, 2, v3
    v_lshrrev_b32 v5, 3, v3
    v_lshl_or_b32 v4, v5, 2, v4
    v_xor_b32 v2, v2, v4
    v_mul_u32_u24 v3, s64, v3
    v_lshrrev_b32 v4, 3, v2
    v_lshl_add_u32 v3, v4, 11, v3
    v_and_b32 v2, 7, v2
    v_lshl_add_u32 v3, v2, 4, v3
    v_add_u32 v187, s65, v3
    v_add_u32 v2, 64, v1
    v_mul_u32_u24 v3, 0xab, v2
    v_lshrrev_b32 v3, 12, v3
    v_mul_u32_u24 v4, 24, v3
    v_sub_u32 v2, v2, v4
    v_and_b32 v4, 2, v3
    v_lshrrev_b32 v5, 3, v3
    v_lshl_or_b32 v4, v5, 2, v4
    v_xor_b32 v2, v2, v4
    v_mul_u32_u24 v3, s64, v3
    v_lshrrev_b32 v4, 3, v2
    v_lshl_add_u32 v3, v4, 11, v3
    v_and_b32 v2, 7, v2
    v_lshl_add_u32 v3, v2, 4, v3
    v_subrev_u32 v3, 1024, v3
    v_add_u32 v188, s65, v3
    v_add_u32 v2, 128, v1
    v_mul_u32_u24 v3, 0xab, v2
    v_lshrrev_b32 v3, 12, v3
    v_mul_u32_u24 v4, 24, v3
    v_sub_u32 v2, v2, v4
    v_and_b32 v4, 2, v3
    v_lshrrev_b32 v5, 3, v3
    v_lshl_or_b32 v4, v5, 2, v4
    v_xor_b32 v2, v2, v4
    v_mul_u32_u24 v3, s64, v3
    v_lshrrev_b32 v4, 3, v2
    v_lshl_add_u32 v3, v4, 11, v3
    v_and_b32 v2, 7, v2
    v_lshl_add_u32 v3, v2, 4, v3
    v_subrev_u32 v3, 2048, v3
    v_add_u32 v189, s65, v3
    v_add_u32 v2, 192, v1
    v_mul_u32_u24 v3, 0xab, v2
    v_lshrrev_b32 v3, 12, v3
    v_mul_u32_u24 v4, 24, v3
    v_sub_u32 v2, v2, v4
    v_and_b32 v4, 2, v3
    v_lshrrev_b32 v5, 3, v3
    v_lshl_or_b32 v4, v5, 2, v4
    v_xor_b32 v2, v2, v4
    v_mul_u32_u24 v3, s64, v3
    v_lshrrev_b32 v4, 3, v2
    v_lshl_add_u32 v3, v4, 11, v3
    v_and_b32 v2, 7, v2
    v_lshl_add_u32 v3, v2, 4, v3
    v_subrev_u32 v3, 3072, v3
    v_add_u32 v190, s65, v3
    v_add_u32 v2, 256, v1
    v_mul_u32_u24 v3, 0xab, v2
    v_lshrrev_b32 v3, 12, v3
    v_mul_u32_u24 v4, 24, v3
    v_sub_u32 v2, v2, v4
    v_and_b32 v4, 2, v3
    v_lshrrev_b32 v5, 3, v3
    v_lshl_or_b32 v4, v5, 2, v4
    v_xor_b32 v2, v2, v4
    v_mul_u32_u24 v3, s64, v3
    v_lshrrev_b32 v4, 3, v2
    v_lshl_add_u32 v3, v4, 11, v3
    v_and_b32 v2, 7, v2
    v_lshl_add_u32 v3, v2, 4, v3
    v_add_u32 v191, s65, v3
    v_add_u32 v2, 320, v1
    v_mul_u32_u24 v3, 0xab, v2
    v_lshrrev_b32 v3, 12, v3
    v_mul_u32_u24 v4, 24, v3
    v_sub_u32 v2, v2, v4
    v_and_b32 v4, 2, v3
    v_lshrrev_b32 v5, 3, v3
    v_lshl_or_b32 v4, v5, 2, v4
    v_xor_b32 v2, v2, v4
    v_mul_u32_u24 v3, s64, v3
    v_lshrrev_b32 v4, 3, v2
    v_lshl_add_u32 v3, v4, 11, v3
    v_and_b32 v2, 7, v2
    v_lshl_add_u32 v3, v2, 4, v3
    v_subrev_u32 v3, 1024, v3
    v_add_u32 v192, s65, v3
    s_mul_i32 s64, s47, 294912
    s_add_u32 s64, s64, 0x100000
    s_add_u32 s65, s64, s73
    v_lshl_add_u32 v186, v1, 4, s65
    s_mul_i32 s65, s44, 65536
    s_add_u32 s64, s64, s65
    s_add_u32 s64, s64, 32768
    v_lshl_add_u32 v184, v1, 4, s64
    v_add_u32 v185, 30720, v184
    s_mov_b32 s32, s6
    s_mov_b32 s33, s7
    s_mov_b32 s34, 0x600000
    s_mov_b32 s35, 0x20000
    s_mov_b32 s28, s26
    s_mov_b32 s29, s27
    s_mov_b32 s30, 0x3000000
    s_mov_b32 s31, 0x20000
    s_lshr_b32 s45, s44, 1
    s_and_b32 s46, s44, 1
    s_bfe_u32 s49, s2, 0x10003
    s_and_b32 s50, s2, 3
    s_lshl_b32 s50, s50, 2
    s_bfe_u32 s64, s2, 0x20004
    s_add_u32 s50, s50, s64
    s_and_b32 s51, s2, 4
    s_lshr_b32 s64, s2, 6
    s_add_u32 s51, s51, s64
    s_cmp_ge_u32 s2, 192
    s_cselect_b32 s69, 0x80000000, 0
    s_mov_b32 s67, 0x40053526
    v_lshlrev_b32 v234, 2, v1
    v_lshrrev_b32 v3, 3, v1
    s_lshl_b32 s64, s44, 4
    v_add_lshl_u32 v2, v3, s64, 11
    s_lshl_b32 s64, s48, 7
    v_add_u32 v2, s64, v2
    v_and_b32 v3, 6, v3
    v_and_b32 v4, 7, v1
    v_xor_b32 v3, v3, v4
    v_lshl_add_u32 v193, v3, 4, v2
    v_add_u32 v194, 15360, v193
    s_lshl_b32 s64, s47, 3
    s_lshl_b32 s65, s44, 1
    s_add_u32 s64, s64, s65
    s_mul_i32 s64, s64, 32768
    s_add_u32 s64, s64, 0x1000000
    v_lshl_add_u32 v206, v1, 4, s64
    v_add_u32 v207, 30720, v206
    s_lshl_b32 s65, s48, 8
    v_lshrrev_b32 v3, 4, v1
    s_lshl_b32 s64, s44, 4
    v_add_u32 v2, s64, v3
    s_movk_i32 s64, 7168
    v_mul_u32_u24 v2, s64, v2
    v_add_u32 v2, s65, v2
    v_lshlrev_b32 v3, 1, v3
    v_and_b32 v4, 15, v1
    v_xor_b32 v3, v3, v4
    v_lshl_add_u32 v208, v3, 4, v2
    v_add_u32 v210, 55296, v208
    v_xor_b32 v3, 8, v3
    v_lshl_add_u32 v209, v3, 4, v2
    v_add_u32 v209, 27648, v209
    v_add_u32 v211, 55296, v209
    s_lshr_b32 s65, s48, 2
    s_sub_u32 s65, s48, s65
    s_add_u32 s65, s65, 16
    s_lshl_b32 s65, s65, 8
    s_or_b32 s65, s65, s69
    v_lshrrev_b32 v3, 4, v1
    s_lshl_b32 s64, s44, 4
    v_add_u32 v2, s64, v3
    s_movk_i32 s64, 7168
    v_mul_u32_u24 v2, s64, v2
    v_add_u32 v2, s65, v2
    v_lshlrev_b32 v3, 1, v3
    v_and_b32 v4, 15, v1
    v_xor_b32 v3, v3, v4
    v_lshl_add_u32 v212, v3, 4, v2
    v_add_u32 v214, 55296, v212
    v_xor_b32 v3, 8, v3
    v_lshl_add_u32 v213, v3, 4, v2
    v_add_u32 v213, 27648, v213
    v_add_u32 v215, 55296, v213
    s_lshl_b32 s64, s50, 3
    s_lshl_b32 s65, s44, 1
    s_add_u32 s64, s64, s65
    s_mul_i32 s64, s64, 114688
    s_add_u32 s64, s64, 0x1500000
    v_lshl_add_u32 v246, v1, 4, s64
    v_add_u32 v247, 112640, v246
    s_lshl_b32 s65, s51, 8
    v_lshrrev_b32 v3, 4, v1
    s_lshl_b32 s64, s44, 4
    v_add_u32 v2, s64, v3
    s_movk_i32 s64, 2048
    v_mul_u32_u24 v2, s64, v2
    v_add_u32 v2, s65, v2
    v_lshlrev_b32 v3, 1, v3
    v_and_b32 v4, 15, v1
    v_xor_b32 v3, v3, v4
    v_lshl_add_u32 v248, v3, 4, v2
    v_add_u32 v250, 14336, v248
    v_xor_b32 v3, 8, v3
    v_lshl_add_u32 v249, v3, 4, v2
    v_add_u32 v249, 7168, v249
    v_add_u32 v251, 14336, v249
    s_lshl_b32 s64, s44, 12
    v_lshl_add_u32 v233, v1, 4, s64
    v_lshrrev_b32 v2, 2, v1
    v_lshlrev_b32 v4, 7, v2
    v_and_b32 v5, 3, v1
    v_lshl_add_u32 v4, v5, 3, v4
    v_add_u32 v4, 16384, v4
    v_bfe_u32 v2, v1, 3, 2
    v_xor_b32 v3, 0, v2
    v_lshl_add_u32 v239, v3, 5, v4
    v_xor_b32 v3, 1, v2
    v_lshl_add_u32 v240, v3, 5, v4
    v_xor_b32 v3, 2, v2
    v_lshl_add_u32 v241, v3, 5, v4
    v_xor_b32 v3, 3, v2
    v_lshl_add_u32 v242, v3, 5, v4
    s_mov_b32 s52, 49152
    v_add_u32 v232, s52, v233
    v_add_u32 v235, s52, v239
    v_add_u32 v236, s52, v240
    v_add_u32 v237, s52, v241
    v_add_u32 v238, s52, v242
    s_lshl_b32 s70, s47, 2
    s_add_u32 s70, s70, s44
    s_lshl_b32 s64, s70, 16
    s_lshl_b32 s65, s48, 7
    s_add_u32 s64, s64, s65
    v_and_b32 v2, 15, v1
    v_lshl_add_u32 v2, v2, 11, s64
    v_bfe_u32 v3, v1, 4, 1
    v_lshl_add_u32 v2, v3, 5, v2
    v_lshrrev_b32 v3, 5, v1
    v_lshl_add_u32 v196, v3, 4, v2
    s_mul_i32 s64, s70, 65536
    s_lshl_b32 s65, s48, 11
    s_add_u32 s64, s64, s65
    v_lshl_add_u32 v197, v1, 4, s64
    s_lshl_b32 s64, s70, 12
    s_add_u32 s64, s64, 0x60000
    v_lshl_add_u32 v198, v1, 3, s64
    v_and_b32 v2, 48, v1
    v_add_u32 v199, 149504, v2
    v_mov_b32 v72, 148480
    v_mov_b32 v73, 0
    ds_write_b32 v72, v73 offset:0
    ds_write_b32 v72, v73 offset:4
    ds_write_b32 v72, v73 offset:8
    ds_write_b32 v72, v73 offset:12
    ds_write_b32 v72, v73 offset:16
    ds_write_b32 v72, v73 offset:20
    v_and_b32 v16, 255, v0
    s_lshr_b32 s80, s2, 6
    s_lshl_b32 s81, s80, 8
    s_and_b32 s82, s2, 63
    s_lshl_b32 s83, s82, 7
    s_add_u32 s83, s83, 4096
    s_lshl_b32 s80, s80, 15
    s_lshl_b32 s82, s82, 9
    s_add_u32 s80, s80, s82
    s_add_u32 s80, s80, 0xa0000
    v_lshrrev_b32 v72, 3, v16
    v_add_u32 v72, s81, v72
    v_lshlrev_b32 v18, 1, v72
    s_movk_i32 s64, 12288
    v_mul_lo_u32 v72, s64, v72
    v_and_b32 v17, 7, v0
    v_lshl_add_u32 v72, v17, 4, v72
    v_add_u32 v17, s83, v72
    s_lshl_b32 s64, s2, 8
    v_add_lshl_u32 v243, v16, s64, 5
    s_mov_b32 s36, s20
    s_mov_b32 s37, s21
    s_mov_b32 s38, 0xc00000
    s_mov_b32 s39, 0x20000
    s_lshl_b32 s64, s2, 2
    s_add_u32 s64, s64, s44
    s_mul_i32 s64, s64, 7168
    s_add_u32 s64, s64, 4096
    s_add_u32 s10, s12, s64
    s_addc_u32 s11, s13, 0
    s_add_u32 s24, s14, s64
    s_addc_u32 s25, s15, 0
    s_waitcnt lgkmcnt(0)
    s_add_u32 s0, s0, 1
    s_barrier
    s_waitcnt vmcnt(0)
    v_lshlrev_b32 v120, 16, v104
    v_and_b32 v121, 0xffff0000, v104
    v_lshlrev_b32 v122, 16, v105
    v_and_b32 v123, 0xffff0000, v105
    v_lshlrev_b32 v124, 16, v106
    v_and_b32 v125, 0xffff0000, v106
    v_lshlrev_b32 v126, 16, v107
    v_and_b32 v127, 0xffff0000, v107
    v_lshlrev_b32 v128, 16, v108
    v_and_b32 v129, 0xffff0000, v108
    v_lshlrev_b32 v130, 16, v109
    v_and_b32 v131, 0xffff0000, v109
    v_lshlrev_b32 v132, 16, v110
    v_and_b32 v133, 0xffff0000, v110
    v_lshlrev_b32 v134, 16, v111
    v_and_b32 v135, 0xffff0000, v111
    v_lshlrev_b32 v136, 16, v112
    v_and_b32 v137, 0xffff0000, v112
    v_lshlrev_b32 v138, 16, v113
    v_and_b32 v139, 0xffff0000, v113
    v_lshlrev_b32 v140, 16, v114
    v_and_b32 v141, 0xffff0000, v114
    v_lshlrev_b32 v142, 16, v115
    v_and_b32 v143, 0xffff0000, v115
    v_lshlrev_b32 v144, 16, v116
    v_and_b32 v145, 0xffff0000, v116
    v_lshlrev_b32 v146, 16, v117
    v_and_b32 v147, 0xffff0000, v117
    v_lshlrev_b32 v148, 16, v118
    v_and_b32 v149, 0xffff0000, v118
    v_lshlrev_b32 v150, 16, v119
    v_and_b32 v151, 0xffff0000, v119
    v_pk_add_f32 v[104:105], v[120:121], v[122:123]
    v_pk_mul_f32 v[108:109], v[120:121], v[120:121]
    v_pk_add_f32 v[106:107], v[136:137], v[138:139]
    v_pk_mul_f32 v[110:111], v[136:137], v[136:137]
    v_pk_fma_f32 v[108:109], v[122:123], v[122:123], v[108:109]
    v_pk_fma_f32 v[110:111], v[138:139], v[138:139], v[110:111]
    v_pk_add_f32 v[104:105], v[104:105], v[124:125]
    v_pk_fma_f32 v[108:109], v[124:125], v[124:125], v[108:109]
    v_pk_add_f32 v[106:107], v[106:107], v[140:141]
    v_pk_fma_f32 v[110:111], v[140:141], v[140:141], v[110:111]
    v_pk_add_f32 v[104:105], v[104:105], v[126:127]
    v_pk_fma_f32 v[108:109], v[126:127], v[126:127], v[108:109]
    v_pk_add_f32 v[106:107], v[106:107], v[142:143]
    v_pk_fma_f32 v[110:111], v[142:143], v[142:143], v[110:111]
    v_pk_add_f32 v[104:105], v[104:105], v[128:129]
    v_pk_fma_f32 v[108:109], v[128:129], v[128:129], v[108:109]
    v_pk_add_f32 v[106:107], v[106:107], v[144:145]
    v_pk_fma_f32 v[110:111], v[144:145], v[144:145], v[110:111]
    v_pk_add_f32 v[104:105], v[104:105], v[130:131]
    v_pk_fma_f32 v[108:109], v[130:131], v[130:131], v[108:109]
    v_pk_add_f32 v[106:107], v[106:107], v[146:147]
    v_pk_fma_f32 v[110:111], v[146:147], v[146:147], v[110:111]
    v_pk_add_f32 v[104:105], v[104:105], v[132:133]
    v_pk_fma_f32 v[108:109], v[132:133], v[132:133], v[108:109]
    v_pk_add_f32 v[106:107], v[106:107], v[148:149]
    v_pk_fma_f32 v[110:111], v[148:149], v[148:149], v[110:111]
    v_pk_add_f32 v[104:105], v[104:105], v[134:135]
    v_pk_fma_f32 v[108:109], v[134:135], v[134:135], v[108:109]
    v_pk_add_f32 v[106:107], v[106:107], v[150:151]
    v_pk_fma_f32 v[110:111], v[150:151], v[150:151], v[110:111]
    v_add_f32 v152, v104, v105
    v_add_f32 v153, v108, v109
    v_add_f32 v156, v106, v107
    v_add_f32 v157, v110, v111
    v_add_f32_dpp v152, v152, v152 quad_perm:[1,0,3,2] row_mask:0xf bank_mask:0xf
    v_add_f32_dpp v153, v153, v153 quad_perm:[1,0,3,2] row_mask:0xf bank_mask:0xf
    v_add_f32_dpp v156, v156, v156 quad_perm:[1,0,3,2] row_mask:0xf bank_mask:0xf
    v_add_f32_dpp v157, v157, v157 quad_perm:[1,0,3,2] row_mask:0xf bank_mask:0xf
    v_add_f32_dpp v152, v152, v152 quad_perm:[2,3,0,1] row_mask:0xf bank_mask:0xf
    v_add_f32_dpp v153, v153, v153 quad_perm:[2,3,0,1] row_mask:0xf bank_mask:0xf
    v_add_f32_dpp v156, v156, v156 quad_perm:[2,3,0,1] row_mask:0xf bank_mask:0xf
    v_add_f32_dpp v157, v157, v157 quad_perm:[2,3,0,1] row_mask:0xf bank_mask:0xf
    v_add_f32_dpp v152, v152, v152 row_half_mirror row_mask:0xf bank_mask:0xf
    v_add_f32_dpp v153, v153, v153 row_half_mirror row_mask:0xf bank_mask:0xf
    v_add_f32_dpp v156, v156, v156 row_half_mirror row_mask:0xf bank_mask:0xf
    v_add_f32_dpp v157, v157, v157 row_half_mirror row_mask:0xf bank_mask:0xf
    v_add_f32_dpp v152, v152, v152 row_mirror row_mask:0xf bank_mask:0xf
    v_add_f32_dpp v153, v153, v153 row_mirror row_mask:0xf bank_mask:0xf
    v_add_f32_dpp v156, v156, v156 row_mirror row_mask:0xf bank_mask:0xf
    v_add_f32_dpp v157, v157, v157 row_mirror row_mask:0xf bank_mask:0xf
    v_mov_b32 v154, v152
    v_mov_b32 v155, v153
    v_mov_b32 v158, v156
    v_mov_b32 v159, v157
    v_permlane32_swap_b32 v152, v154
    v_permlane32_swap_b32 v153, v155
    v_permlane32_swap_b32 v156, v158
    v_permlane32_swap_b32 v157, v159
    v_add_f32 v152, v152, v154
    v_add_f32 v153, v153, v155
    v_add_f32 v156, v156, v158
    v_add_f32 v157, v157, v159
    v_mov_b32 v154, v152
    v_mov_b32 v155, v153
    v_mov_b32 v158, v156
    v_mov_b32 v159, v157
    v_permlane16_swap_b32 v152, v154
    v_permlane16_swap_b32 v153, v155
    v_permlane16_swap_b32 v156, v158
    v_permlane16_swap_b32 v157, v159
    v_add_f32 v152, v152, v154
    v_add_f32 v153, v153, v155
    v_add_f32 v156, v156, v158
    v_add_f32 v157, v157, v159
    v_mul_f32 v152, 0x3a800000, v152
    v_mul_f32 v153, 0x3a800000, v153
    v_mul_f32 v156, 0x3a800000, v156
    v_mul_f32 v157, 0x3a800000, v157
    v_fma_f32 v153, -v152, v152, v153
    v_fma_f32 v157, -v156, v156, v157
    v_max_f32 v153, 0, v153
    v_max_f32 v157, 0, v157
    v_cvt_pk_bf16_f32 v154, v152, v153
    v_lshlrev_b32 v152, 16, v154
    v_and_b32 v153, 0xffff0000, v154
    v_cvt_pk_bf16_f32 v158, v156, v157
    v_lshlrev_b32 v156, 16, v158
    v_and_b32 v157, 0xffff0000, v158
    v_add_f32 v153, 0x3727c5ac, v153
    v_add_f32 v157, 0x3727c5ac, v157
    v_cvt_pk_bf16_f32 v154, v153, v153
    v_lshlrev_b32 v153, 16, v154
    v_cvt_pk_bf16_f32 v158, v157, v157
    v_lshlrev_b32 v157, 16, v158
    v_sqrt_f32 v153, v153
    v_sqrt_f32 v157, v157
    v_cvt_pk_bf16_f32 v154, v153, v153
    v_lshlrev_b32 v153, 16, v154
    v_cvt_pk_bf16_f32 v158, v157, v157
    v_lshlrev_b32 v157, 16, v158
    v_lshrrev_b32 v153, 16, v153
    v_or_b32 v160, v152, v153
    v_mov_b32 v161, s0
    v_lshrrev_b32 v157, 16, v157
    v_or_b32 v162, v156, v157
    v_mov_b32 v163, s0
    s_lshl_b32 s64, s44, 4
    s_add_u32 s64, s64, 150528
    v_mov_b32 v2, s64
    v_mov_b32 v3, 148500
    v_mov_b32 v4, 1
    s_mov_b64 exec, 1
    ds_write_b128 v2, v[160:163]
    ds_add_rtn_u32 v5, v3, v4
    s_mov_b64 exec, 15
    v_lshlrev_b32 v2, 4, v1
    v_add_u32 v3, 150528, v2
    ds_read_b128 v[164:167], v3
    s_lshr_b32 s64, s62, 2
    s_lshl_b32 s64, s64, 7
    s_add_u32 s64, s64, 0x10000
    s_waitcnt lgkmcnt(0)
    v_readfirstlane_b32 s65, v5
    s_nop 3
    s_cmp_eq_u32 s65, 3
    s_cselect_b32 s64, s64, 0x80000000
    v_add_u32 v2, s64, v2
    buffer_store_dwordx4 v[164:167], v2, s[28:31], 0 offen sc1
    s_mov_b64 exec, -1
    s_mov_b32 s64, 0x0
    buffer_load_dwordx4 v[80:83], v8, s[40:43], s64 offen
    s_mov_b32 s64, 0x10000
    buffer_load_dwordx4 v[84:87], v8, s[40:43], s64 offen
    s_mov_b32 s64, 0x20000
    buffer_load_dwordx4 v[88:91], v8, s[40:43], s64 offen
    s_mov_b32 s64, 0x30000
    buffer_load_dwordx4 v[92:95], v8, s[40:43], s64 offen
    buffer_load_dwordx4 v[96:99], v9, s[40:43], 0 offen
    v_mov_b32 v74, -1
    v_mov_b32 v75, -1
    s_lshl_b32 s64, s48, 8
    s_mov_b32 exec_hi, 0
    buffer_store_dwordx2 v[74:75], v198, s[28:31], s64 offen sc1
    s_mov_b32 exec_hi, -1
    s_mov_b32 s40, s18
    s_mov_b32 s41, s19
    s_mov_b32 s42, 0x800
    s_mov_b32 s43, 0x20000
    buffer_load_ushort v24, v18, s[40:43], 0 offen offset:0
    buffer_load_ushort v25, v18, s[40:43], 0 offen offset:64
    buffer_load_ushort v26, v18, s[40:43], 0 offen offset:128
    buffer_load_ushort v27, v18, s[40:43], 0 offen offset:192
    buffer_load_ushort v28, v18, s[40:43], 0 offen offset:256
    buffer_load_ushort v29, v18, s[40:43], 0 offen offset:320
    buffer_load_ushort v30, v18, s[40:43], 0 offen offset:384
    buffer_load_ushort v31, v18, s[40:43], 0 offen offset:448
    buffer_load_dwordx2 v[168:169], v12, s[28:31], 0 offen offset:0 sc1
    buffer_load_dwordx2 v[170:171], v12, s[28:31], 0 offen offset:512 sc1
    buffer_load_dwordx2 v[172:173], v12, s[28:31], 0 offen offset:1024 sc1
    buffer_load_dwordx2 v[174:175], v12, s[28:31], 0 offen offset:1536 sc1
    buffer_load_dwordx2 v[176:177], v13, s[28:31], 0 offen sc1
    s_waitcnt vmcnt(14)
    v_lshlrev_b32 v120, 16, v80
    v_and_b32 v121, 0xffff0000, v80
    v_lshlrev_b32 v122, 16, v81
    v_and_b32 v123, 0xffff0000, v81
    v_lshlrev_b32 v124, 16, v82
    v_and_b32 v125, 0xffff0000, v82
    v_lshlrev_b32 v126, 16, v83
    v_and_b32 v127, 0xffff0000, v83
    v_lshlrev_b32 v128, 16, v84
    v_and_b32 v129, 0xffff0000, v84
    v_lshlrev_b32 v130, 16, v85
    v_and_b32 v131, 0xffff0000, v85
    v_lshlrev_b32 v132, 16, v86
    v_and_b32 v133, 0xffff0000, v86
    v_lshlrev_b32 v134, 16, v87
    v_and_b32 v135, 0xffff0000, v87
    v_lshlrev_b32 v136, 16, v88
    v_and_b32 v137, 0xffff0000, v88
    v_lshlrev_b32 v138, 16, v89
    v_and_b32 v139, 0xffff0000, v89
    v_lshlrev_b32 v140, 16, v90
    v_and_b32 v141, 0xffff0000, v90
    v_lshlrev_b32 v142, 16, v91
    v_and_b32 v143, 0xffff0000, v91
    v_lshlrev_b32 v144, 16, v92
    v_and_b32 v145, 0xffff0000, v92
    v_lshlrev_b32 v146, 16, v93
    v_and_b32 v147, 0xffff0000, v93
    v_lshlrev_b32 v148, 16, v94
    v_and_b32 v149, 0xffff0000, v94
    v_lshlrev_b32 v150, 16, v95
    v_and_b32 v151, 0xffff0000, v95
    v_lshlrev_b32 v152, 16, v96
    v_and_b32 v153, 0xffff0000, v96
    v_lshlrev_b32 v154, 16, v97
    v_and_b32 v155, 0xffff0000, v97
    v_lshlrev_b32 v156, 16, v98
    v_and_b32 v157, 0xffff0000, v98
    v_lshlrev_b32 v158, 16, v99
    v_and_b32 v159, 0xffff0000, v99
    s_waitcnt vmcnt(0)
    s_mov_b32 s3, 0x40000
M_s1_chk:
    v_xor_b32 v72, s0, v169
    v_xor_b32 v73, s0, v171
    v_xor_b32 v74, s0, v173
    v_xor_b32 v75, s0, v175
    v_xor_b32 v76, s0, v177
    v_or3_b32 v72, v72, v73, v74
    v_or3_b32 v72, v72, v75, v76
    v_cmp_ne_u32 vcc, 0, v72
    s_nop 4
    s_cbranch_vccz M_s1_ok
    s_sub_u32 s3, s3, 1
    s_cbranch_scc1 M_s1_ok
    s_sleep 2
    v_cmp_ne_u32 vcc, s0, v169
    s_nop 4
    s_mov_b64 exec, vcc
    buffer_load_dwordx2 v[168:169], v12, s[28:31], 0 offen offset:0 sc1
    s_mov_b64 exec, -1
    v_cmp_ne_u32 vcc, s0, v171
    s_nop 4
    s_mov_b64 exec, vcc
    buffer_load_dwordx2 v[170:171], v12, s[28:31], 0 offen offset:512 sc1
    s_mov_b64 exec, -1
    v_cmp_ne_u32 vcc, s0, v173
    s_nop 4
    s_mov_b64 exec, vcc
    buffer_load_dwordx2 v[172:173], v12, s[28:31], 0 offen offset:1024 sc1
    s_mov_b64 exec, -1
    v_cmp_ne_u32 vcc, s0, v175
    s_nop 4
    s_mov_b64 exec, vcc
    buffer_load_dwordx2 v[174:175], v12, s[28:31], 0 offen offset:1536 sc1
    s_mov_b64 exec, -1
    v_cmp_ne_u32 vcc, s0, v177
    s_nop 4
    s_mov_b64 exec, vcc
    buffer_load_dwordx2 v[176:177], v13, s[28:31], 0 offen sc1
    s_mov_b64 exec, -1
    s_waitcnt vmcnt(0)
    s_branch M_s1_chk
M_s1_ok:
    v_lshlrev_b32 v169, 16, v168
    v_and_b32 v168, 0xffff0000, v168
    v_lshlrev_b32 v171, 16, v170
    v_and_b32 v170, 0xffff0000, v170
    v_lshlrev_b32 v173, 16, v172
    v_and_b32 v172, 0xffff0000, v172
    v_lshlrev_b32 v175, 16, v174
    v_and_b32 v174, 0xffff0000, v174
    v_lshlrev_b32 v177, 16, v176
    v_and_b32 v176, 0xffff0000, v176
    v_rcp_f32 v169, v169
    v_rcp_f32 v171, v171
    v_rcp_f32 v173, v173
    v_rcp_f32 v175, v175
    v_rcp_f32 v177, v177
    v_pk_add_f32 v[120:121], v[120:121], v[168:169] op_sel_hi:[1,0] neg_lo:[0,1] neg_hi:[0,1]
    v_pk_add_f32 v[122:123], v[122:123], v[168:169] op_sel_hi:[1,0] neg_lo:[0,1] neg_hi:[0,1]
    v_pk_add_f32 v[124:125], v[124:125], v[168:169] op_sel_hi:[1,0] neg_lo:[0,1] neg_hi:[0,1]
    v_pk_add_f32 v[126:127], v[126:127], v[168:169] op_sel_hi:[1,0] neg_lo:[0,1] neg_hi:[0,1]
    v_cvt_pk_bf16_f32 v72, v120, v121
    v_lshlrev_b32 v120, 16, v72
    v_and_b32 v121, 0xffff0000, v72
    v_cvt_pk_bf16_f32 v73, v122, v123
    v_lshlrev_b32 v122, 16, v73
    v_and_b32 v123, 0xffff0000, v73
    v_cvt_pk_bf16_f32 v74, v124, v125
    v_lshlrev_b32 v124, 16, v74
    v_and_b32 v125, 0xffff0000, v74
    v_cvt_pk_bf16_f32 v75, v126, v127
    v_lshlrev_b32 v126, 16, v75
    v_and_b32 v127, 0xffff0000, v75
    v_pk_mul_f32 v[120:121], v[120:121], v[168:169] op_sel:[0,1] op_sel_hi:[1,1]
    v_pk_mul_f32 v[122:123], v[122:123], v[168:169] op_sel:[0,1] op_sel_hi:[1,1]
    v_pk_mul_f32 v[124:125], v[124:125], v[168:169] op_sel:[0,1] op_sel_hi:[1,1]
    v_pk_mul_f32 v[126:127], v[126:127], v[168:169] op_sel:[0,1] op_sel_hi:[1,1]
    v_cvt_pk_bf16_f32 v72, v120, v121
    v_lshlrev_b32 v120, 16, v72
    v_and_b32 v121, 0xffff0000, v72
    v_cvt_pk_bf16_f32 v73, v122, v123
    v_lshlrev_b32 v122, 16, v73
    v_and_b32 v123, 0xffff0000, v73
    v_cvt_pk_bf16_f32 v74, v124, v125
    v_lshlrev_b32 v124, 16, v74
    v_and_b32 v125, 0xffff0000, v74
    v_cvt_pk_bf16_f32 v75, v126, v127
    v_lshlrev_b32 v126, 16, v75
    v_and_b32 v127, 0xffff0000, v75
    v_pk_add_f32 v[128:129], v[128:129], v[170:171] op_sel_hi:[1,0] neg_lo:[0,1] neg_hi:[0,1]
    v_pk_add_f32 v[130:131], v[130:131], v[170:171] op_sel_hi:[1,0] neg_lo:[0,1] neg_hi:[0,1]
    v_pk_add_f32 v[132:133], v[132:133], v[170:171] op_sel_hi:[1,0] neg_lo:[0,1] neg_hi:[0,1]
    v_pk_add_f32 v[134:135], v[134:135], v[170:171] op_sel_hi:[1,0] neg_lo:[0,1] neg_hi:[0,1]
    v_cvt_pk_bf16_f32 v72, v128, v129
    v_lshlrev_b32 v128, 16, v72
    v_and_b32 v129, 0xffff0000, v72
    v_cvt_pk_bf16_f32 v73, v130, v131
    v_lshlrev_b32 v130, 16, v73
    v_and_b32 v131, 0xffff0000, v73
    v_cvt_pk_bf16_f32 v74, v132, v133
    v_lshlrev_b32 v132, 16, v74
    v_and_b32 v133, 0xffff0000, v74
    v_cvt_pk_bf16_f32 v75, v134, v135
    v_lshlrev_b32 v134, 16, v75
    v_and_b32 v135, 0xffff0000, v75
    v_pk_mul_f32 v[128:129], v[128:129], v[170:171] op_sel:[0,1] op_sel_hi:[1,1]
    v_pk_mul_f32 v[130:131], v[130:131], v[170:171] op_sel:[0,1] op_sel_hi:[1,1]
    v_pk_mul_f32 v[132:133], v[132:133], v[170:171] op_sel:[0,1] op_sel_hi:[1,1]
    v_pk_mul_f32 v[134:135], v[134:135], v[170:171] op_sel:[0,1] op_sel_hi:[1,1]
    v_cvt_pk_bf16_f32 v72, v128, v129
    v_lshlrev_b32 v128, 16, v72
    v_and_b32 v129, 0xffff0000, v72
    v_cvt_pk_bf16_f32 v73, v130, v131
    v_lshlrev_b32 v130, 16, v73
    v_and_b32 v131, 0xffff0000, v73
    v_cvt_pk_bf16_f32 v74, v132, v133
    v_lshlrev_b32 v132, 16, v74
    v_and_b32 v133, 0xffff0000, v74
    v_cvt_pk_bf16_f32 v75, v134, v135
    v_lshlrev_b32 v134, 16, v75
    v_and_b32 v135, 0xffff0000, v75
    v_pk_add_f32 v[136:137], v[136:137], v[172:173] op_sel_hi:[1,0] neg_lo:[0,1] neg_hi:[0,1]
    v_pk_add_f32 v[138:139], v[138:139], v[172:173] op_sel_hi:[1,0] neg_lo:[0,1] neg_hi:[0,1]
    v_pk_add_f32 v[140:141], v[140:141], v[172:173] op_sel_hi:[1,0] neg_lo:[0,1] neg_hi:[0,1]
    v_pk_add_f32 v[142:143], v[142:143], v[172:173] op_sel_hi:[1,0] neg_lo:[0,1] neg_hi:[0,1]
    v_cvt_pk_bf16_f32 v72, v136, v137
    v_lshlrev_b32 v136, 16, v72
    v_and_b32 v137, 0xffff0000, v72
    v_cvt_pk_bf16_f32 v73, v138, v139
    v_lshlrev_b32 v138, 16, v73
    v_and_b32 v139, 0xffff0000, v73
    v_cvt_pk_bf16_f32 v74, v140, v141
    v_lshlrev_b32 v140, 16, v74
    v_and_b32 v141, 0xffff0000, v74
    v_cvt_pk_bf16_f32 v75, v142, v143
    v_lshlrev_b32 v142, 16, v75
    v_and_b32 v143, 0xffff0000, v75
    v_pk_mul_f32 v[136:137], v[136:137], v[172:173] op_sel:[0,1] op_sel_hi:[1,1]
    v_pk_mul_f32 v[138:139], v[138:139], v[172:173] op_sel:[0,1] op_sel_hi:[1,1]
    v_pk_mul_f32 v[140:141], v[140:141], v[172:173] op_sel:[0,1] op_sel_hi:[1,1]
    v_pk_mul_f32 v[142:143], v[142:143], v[172:173] op_sel:[0,1] op_sel_hi:[1,1]
    v_cvt_pk_bf16_f32 v72, v136, v137
    v_lshlrev_b32 v136, 16, v72
    v_and_b32 v137, 0xffff0000, v72
    v_cvt_pk_bf16_f32 v73, v138, v139
    v_lshlrev_b32 v138, 16, v73
    v_and_b32 v139, 0xffff0000, v73
    v_cvt_pk_bf16_f32 v74, v140, v141
    v_lshlrev_b32 v140, 16, v74
    v_and_b32 v141, 0xffff0000, v74
    v_cvt_pk_bf16_f32 v75, v142, v143
    v_lshlrev_b32 v142, 16, v75
    v_and_b32 v143, 0xffff0000, v75
    v_pk_add_f32 v[144:145], v[144:145], v[174:175] op_sel_hi:[1,0] neg_lo:[0,1] neg_hi:[0,1]
    v_pk_add_f32 v[146:147], v[146:147], v[174:175] op_sel_hi:[1,0] neg_lo:[0,1] neg_hi:[0,1]
    v_pk_add_f32 v[148:149], v[148:149], v[174:175] op_sel_hi:[1,0] neg_lo:[0,1] neg_hi:[0,1]
    v_pk_add_f32 v[150:151], v[150:151], v[174:175] op_sel_hi:[1,0] neg_lo:[0,1] neg_hi:[0,1]
    v_cvt_pk_bf16_f32 v72, v144, v145
    v_lshlrev_b32 v144, 16, v72
    v_and_b32 v145, 0xffff0000, v72
    v_cvt_pk_bf16_f32 v73, v146, v147
    v_lshlrev_b32 v146, 16, v73
    v_and_b32 v147, 0xffff0000, v73
    v_cvt_pk_bf16_f32 v74, v148, v149
    v_lshlrev_b32 v148, 16, v74
    v_and_b32 v149, 0xffff0000, v74
    v_cvt_pk_bf16_f32 v75, v150, v151
    v_lshlrev_b32 v150, 16, v75
    v_and_b32 v151, 0xffff0000, v75
    v_pk_mul_f32 v[144:145], v[144:145], v[174:175] op_sel:[0,1] op_sel_hi:[1,1]
    v_pk_mul_f32 v[146:147], v[146:147], v[174:175] op_sel:[0,1] op_sel_hi:[1,1]
    v_pk_mul_f32 v[148:149], v[148:149], v[174:175] op_sel:[0,1] op_sel_hi:[1,1]
    v_pk_mul_f32 v[150:151], v[150:151], v[174:175] op_sel:[0,1] op_sel_hi:[1,1]
    v_cvt_pk_bf16_f32 v72, v144, v145
    v_lshlrev_b32 v144, 16, v72
    v_and_b32 v145, 0xffff0000, v72
    v_cvt_pk_bf16_f32 v73, v146, v147
    v_lshlrev_b32 v146, 16, v73
    v_and_b32 v147, 0xffff0000, v73
    v_cvt_pk_bf16_f32 v74, v148, v149
    v_lshlrev_b32 v148, 16, v74
    v_and_b32 v149, 0xffff0000, v74
    v_cvt_pk_bf16_f32 v75, v150, v151
    v_lshlrev_b32 v150, 16, v75
    v_and_b32 v151, 0xffff0000, v75
    v_pk_add_f32 v[152:153], v[152:153], v[176:177] op_sel_hi:[1,0] neg_lo:[0,1] neg_hi:[0,1]
    v_pk_add_f32 v[154:155], v[154:155], v[176:177] op_sel_hi:[1,0] neg_lo:[0,1] neg_hi:[0,1]
    v_pk_add_f32 v[156:157], v[156:157], v[176:177] op_sel_hi:[1,0] neg_lo:[0,1] neg_hi:[0,1]
    v_pk_add_f32 v[158:159], v[158:159], v[176:177] op_sel_hi:[1,0] neg_lo:[0,1] neg_hi:[0,1]
    v_cvt_pk_bf16_f32 v72, v152, v153
    v_lshlrev_b32 v152, 16, v72
    v_and_b32 v153, 0xffff0000, v72
    v_cvt_pk_bf16_f32 v73, v154, v155
    v_lshlrev_b32 v154, 16, v73
    v_and_b32 v155, 0xffff0000, v73
    v_cvt_pk_bf16_f32 v74, v156, v157
    v_lshlrev_b32 v156, 16, v74
    v_and_b32 v157, 0xffff0000, v74
    v_cvt_pk_bf16_f32 v75, v158, v159
    v_lshlrev_b32 v158, 16, v75
    v_and_b32 v159, 0xffff0000, v75
    v_pk_mul_f32 v[152:153], v[152:153], v[176:177] op_sel:[0,1] op_sel_hi:[1,1]
    v_pk_mul_f32 v[154:155], v[154:155], v[176:177] op_sel:[0,1] op_sel_hi:[1,1]
    v_pk_mul_f32 v[156:157], v[156:157], v[176:177] op_sel:[0,1] op_sel_hi:[1,1]
    v_pk_mul_f32 v[158:159], v[158:159], v[176:177] op_sel:[0,1] op_sel_hi:[1,1]
    v_cvt_pk_bf16_f32 v72, v152, v153
    v_lshlrev_b32 v152, 16, v72
    v_and_b32 v153, 0xffff0000, v72
    v_cvt_pk_bf16_f32 v73, v154, v155
    v_lshlrev_b32 v154, 16, v73
    v_and_b32 v155, 0xffff0000, v73
    v_cvt_pk_bf16_f32 v74, v156, v157
    v_lshlrev_b32 v156, 16, v74
    v_and_b32 v157, 0xffff0000, v74
    v_cvt_pk_bf16_f32 v75, v158, v159
    v_lshlrev_b32 v158, 16, v75
    v_and_b32 v159, 0xffff0000, v75
    s_lshl_b32 s68, s47, 9
    s_add_u32 s68, s68, 0x58000
    s_add_u32 s62, s26, s68
    s_addc_u32 s63, s27, 0
    s_lshr_b32 s68, s48, 2
    s_lshl_b32 s68, s68, 7
    v_mov_b32 v2, 1
    v_mov_b32 v5, 148496
    s_and_b32 s57, s58, 15
    s_lshr_b64 s[58:59], s[58:59], 4
    s_lshl_b32 s56, s57, 11
    s_mul_i32 s57, s57, 0x60000
    s_add_u32 m0, s53, s74
    s_nop 0
    buffer_load_dwordx4 v187, s[32:35], s57 offen offset:0 lds
    buffer_load_dwordx4 v188, s[32:35], s57 offen offset:1024 lds
    buffer_load_dwordx4 v189, s[32:35], s57 offen offset:2048 lds
    buffer_load_dwordx4 v190, s[32:35], s57 offen offset:3072 lds
    s_add_u32 m0, s53, s75
    s_nop 0
    buffer_load_dwordx4 v191, s[32:35], s57 offen offset:0 lds
    buffer_load_dwordx4 v192, s[32:35], s57 offen offset:1024 lds
    s_add_u32 s53, s53, 49152
    s_cmp_ge_u32 s53, 147456
    s_cselect_b32 s53, 0, s53
    s_barrier
    ds_read_b128 v[32:35], v14 offset:0
    ds_read_b128 v[36:39], v14 offset:16
    ds_read_b128 v[40:43], v14 offset:256
    ds_read_b128 v[44:47], v14 offset:272
    s_waitcnt lgkmcnt(0)
    v_pk_mul_f32 v[120:121], v[120:121], v[40:41]
    v_pk_mul_f32 v[122:123], v[122:123], v[42:43]
    v_pk_mul_f32 v[124:125], v[124:125], v[44:45]
    v_pk_mul_f32 v[126:127], v[126:127], v[46:47]
    v_cvt_pk_bf16_f32 v72, v120, v121
    v_lshlrev_b32 v120, 16, v72
    v_and_b32 v121, 0xffff0000, v72
    v_cvt_pk_bf16_f32 v73, v122, v123
    v_lshlrev_b32 v122, 16, v73
    v_and_b32 v123, 0xffff0000, v73
    v_cvt_pk_bf16_f32 v74, v124, v125
    v_lshlrev_b32 v124, 16, v74
    v_and_b32 v125, 0xffff0000, v74
    v_cvt_pk_bf16_f32 v75, v126, v127
    v_lshlrev_b32 v126, 16, v75
    v_and_b32 v127, 0xffff0000, v75
    v_pk_add_f32 v[120:121], v[120:121], v[32:33]
    v_pk_add_f32 v[122:123], v[122:123], v[34:35]
    v_pk_add_f32 v[124:125], v[124:125], v[36:37]
    v_pk_add_f32 v[126:127], v[126:127], v[38:39]
    v_cvt_pk_bf16_f32 v80, v120, v121
    v_cvt_pk_bf16_f32 v81, v122, v123
    v_cvt_pk_bf16_f32 v82, v124, v125
    v_cvt_pk_bf16_f32 v83, v126, v127
    s_mov_b32 s64, 0x0
    buffer_store_dwordx4 v[80:83], v10, s[28:31], s64 offen sc1
    ds_write_b128 v15, v[80:83] offset:0
    v_pk_mul_f32 v[128:129], v[128:129], v[40:41]
    v_pk_mul_f32 v[130:131], v[130:131], v[42:43]
    v_pk_mul_f32 v[132:133], v[132:133], v[44:45]
    v_pk_mul_f32 v[134:135], v[134:135], v[46:47]
    v_cvt_pk_bf16_f32 v72, v128, v129
    v_lshlrev_b32 v128, 16, v72
    v_and_b32 v129, 0xffff0000, v72
    v_cvt_pk_bf16_f32 v73, v130, v131
    v_lshlrev_b32 v130, 16, v73
    v_and_b32 v131, 0xffff0000, v73
    v_cvt_pk_bf16_f32 v74, v132, v133
    v_lshlrev_b32 v132, 16, v74
    v_and_b32 v133, 0xffff0000, v74
    v_cvt_pk_bf16_f32 v75, v134, v135
    v_lshlrev_b32 v134, 16, v75
    v_and_b32 v135, 0xffff0000, v75
    v_pk_add_f32 v[128:129], v[128:129], v[32:33]
    v_pk_add_f32 v[130:131], v[130:131], v[34:35]
    v_pk_add_f32 v[132:133], v[132:133], v[36:37]
    v_pk_add_f32 v[134:135], v[134:135], v[38:39]
    v_cvt_pk_bf16_f32 v84, v128, v129
    v_cvt_pk_bf16_f32 v85, v130, v131
    v_cvt_pk_bf16_f32 v86, v132, v133
    v_cvt_pk_bf16_f32 v87, v134, v135
    s_mov_b32 s64, 0x10000
    buffer_store_dwordx4 v[84:87], v10, s[28:31], s64 offen sc1
    ds_write_b128 v15, v[84:87] offset:4096
    v_pk_mul_f32 v[136:137], v[136:137], v[40:41]
    v_pk_mul_f32 v[138:139], v[138:139], v[42:43]
    v_pk_mul_f32 v[140:141], v[140:141], v[44:45]
    v_pk_mul_f32 v[142:143], v[142:143], v[46:47]
    v_cvt_pk_bf16_f32 v72, v136, v137
    v_lshlrev_b32 v136, 16, v72
    v_and_b32 v137, 0xffff0000, v72
    v_cvt_pk_bf16_f32 v73, v138, v139
    v_lshlrev_b32 v138, 16, v73
    v_and_b32 v139, 0xffff0000, v73
    v_cvt_pk_bf16_f32 v74, v140, v141
    v_lshlrev_b32 v140, 16, v74
    v_and_b32 v141, 0xffff0000, v74
    v_cvt_pk_bf16_f32 v75, v142, v143
    v_lshlrev_b32 v142, 16, v75
    v_and_b32 v143, 0xffff0000, v75
    v_pk_add_f32 v[136:137], v[136:137], v[32:33]
    v_pk_add_f32 v[138:139], v[138:139], v[34:35]
    v_pk_add_f32 v[140:141], v[140:141], v[36:37]
    v_pk_add_f32 v[142:143], v[142:143], v[38:39]
    v_cvt_pk_bf16_f32 v88, v136, v137
    v_cvt_pk_bf16_f32 v89, v138, v139
    v_cvt_pk_bf16_f32 v90, v140, v141
    v_cvt_pk_bf16_f32 v91, v142, v143
    s_mov_b32 s64, 0x20000
    buffer_store_dwordx4 v[88:91], v10, s[28:31], s64 offen sc1
    ds_write_b128 v15, v[88:91] offset:8192
    v_pk_mul_f32 v[144:145], v[144:145], v[40:41]
    v_pk_mul_f32 v[146:147], v[146:147], v[42:43]
    v_pk_mul_f32 v[148:149], v[148:149], v[44:45]
    v_pk_mul_f32 v[150:151], v[150:151], v[46:47]
    v_cvt_pk_bf16_f32 v72, v144, v145
    v_lshlrev_b32 v144, 16, v72
    v_and_b32 v145, 0xffff0000, v72
    v_cvt_pk_bf16_f32 v73, v146, v147
    v_lshlrev_b32 v146, 16, v73
    v_and_b32 v147, 0xffff0000, v73
    v_cvt_pk_bf16_f32 v74, v148, v149
    v_lshlrev_b32 v148, 16, v74
    v_and_b32 v149, 0xffff0000, v74
    v_cvt_pk_bf16_f32 v75, v150, v151
    v_lshlrev_b32 v150, 16, v75
    v_and_b32 v151, 0xffff0000, v75
    v_pk_add_f32 v[144:145], v[144:145], v[32:33]
    v_pk_add_f32 v[146:147], v[146:147], v[34:35]
    v_pk_add_f32 v[148:149], v[148:149], v[36:37]
    v_pk_add_f32 v[150:151], v[150:151], v[38:39]
    v_cvt_pk_bf16_f32 v92, v144, v145
    v_cvt_pk_bf16_f32 v93, v146, v147
    v_cvt_pk_bf16_f32 v94, v148, v149
    v_cvt_pk_bf16_f32 v95, v150, v151
    s_mov_b32 s64, 0x30000
    buffer_store_dwordx4 v[92:95], v10, s[28:31], s64 offen sc1
    ds_write_b128 v15, v[92:95] offset:12288
    v_pk_mul_f32 v[152:153], v[152:153], v[40:41]
    v_pk_mul_f32 v[154:155], v[154:155], v[42:43]
    v_pk_mul_f32 v[156:157], v[156:157], v[44:45]
    v_pk_mul_f32 v[158:159], v[158:159], v[46:47]
    v_cvt_pk_bf16_f32 v72, v152, v153
    v_lshlrev_b32 v152, 16, v72
    v_and_b32 v153, 0xffff0000, v72
    v_cvt_pk_bf16_f32 v73, v154, v155
    v_lshlrev_b32 v154, 16, v73
    v_and_b32 v155, 0xffff0000, v73
    v_cvt_pk_bf16_f32 v74, v156, v157
    v_lshlrev_b32 v156, 16, v74
    v_and_b32 v157, 0xffff0000, v74
    v_cvt_pk_bf16_f32 v75, v158, v159
    v_lshlrev_b32 v158, 16, v75
    v_and_b32 v159, 0xffff0000, v75
    v_pk_add_f32 v[152:153], v[152:153], v[32:33]
    v_pk_add_f32 v[154:155], v[154:155], v[34:35]
    v_pk_add_f32 v[156:157], v[156:157], v[36:37]
    v_pk_add_f32 v[158:159], v[158:159], v[38:39]
    v_cvt_pk_bf16_f32 v96, v152, v153
    v_cvt_pk_bf16_f32 v97, v154, v155
    v_cvt_pk_bf16_f32 v98, v156, v157
    v_cvt_pk_bf16_f32 v99, v158, v159
    buffer_store_dwordx4 v[96:99], v11, s[28:31], 0 offen sc1
    ds_write_b128 v19, v[96:99] offset:0
    s_waitcnt lgkmcnt(0)
    s_waitcnt vmcnt(5)
    s_barrier
    s_and_b32 s57, s58, 15
    s_lshr_b64 s[58:59], s[58:59], 4
    s_lshl_b32 s56, s57, 11
    s_mul_i32 s57, s57, 0x60000
    s_add_u32 m0, s53, s74
    s_nop 0
    buffer_load_dwordx4 v187, s[32:35], s57 offen offset:0 lds
    buffer_load_dwordx4 v188, s[32:35], s57 offen offset:1024 lds
    buffer_load_dwordx4 v189, s[32:35], s57 offen offset:2048 lds
    buffer_load_dwordx4 v190, s[32:35], s57 offen offset:3072 lds
    s_add_u32 m0, s53, s75
    s_nop 0
    buffer_load_dwordx4 v191, s[32:35], s57 offen offset:0 lds
    buffer_load_dwordx4 v192, s[32:35], s57 offen offset:1024 lds
    s_add_u32 s53, s53, 49152
    s_cmp_ge_u32 s53, 147456
    s_cselect_b32 s53, 0, s53
    s_mov_b32 s64, 0x0
    buffer_load_dwordx4 v[32:35], v17, s[36:39], s64 offen
    s_mov_b32 s64, 0x60000
    buffer_load_dwordx4 v[36:39], v17, s[36:39], s64 offen
    s_mov_b32 s64, 0xc0000
    buffer_load_dwordx4 v[40:43], v17, s[36:39], s64 offen
    s_mov_b32 s53, 0
    s_bfe_u32 s66, s2, 0x30003
    s_lshr_b32 s55, s2, 6
    s_add_u32 s66, s66, s55
    s_and_b32 s66, s66, 3
    s_mov_b32 s58, 0x76453210
    s_mov_b32 s59, 0xfecdba89
    s_cmp_eq_u32 s66, 1
    s_cselect_b32 s58, 0x75643120, s58
    s_cselect_b32 s59, 0xfdecb9a8, s59
    s_cmp_eq_u32 s66, 2
    s_cselect_b32 s58, 0x67542310, s58
    s_cselect_b32 s59, 0xefdcab98, s59
    s_cmp_eq_u32 s66, 3
    s_cselect_b32 s58, 0x86534210, s58
    s_cselect_b32 s59, 0xfedbca97, s59
    s_lshl_b32 s55, s48, 2
    s_lshr_b64 s[56:57], s[58:59], s55
    s_and_b32 s55, s56, 15
    s_lshl_b32 s55, s55, 2
    s_lshl_b64 s[56:57], 15, s55
    s_andn2_b64 s[58:59], s[58:59], s[56:57]
    s_or_b32 s58, s58, s48
    s_waitcnt vmcnt(9)
    s_mov_b64 exec, 1
    ds_add_rtn_u32 v245, v5, v2
    s_mov_b64 exec, -1
    s_mov_b32 s1, 1
    s_mov_b32 s3, 0x40000
    s_waitcnt lgkmcnt(0)
    v_readfirstlane_b32 s64, v245
    s_nop 3
    s_cmp_lg_u32 s64, 3
    s_cbranch_scc1 M_p1_ok
    s_atomic_add s1, s[62:63], 0
    s_atomic_add s1, s[62:63], 128
    s_atomic_add s1, s[62:63], 256
    s_atomic_add s1, s[62:63], 384
M_p1_chk:
    s_load_dword s64, s[62:63], s68 glc
    s_sub_u32 s3, s3, 1
    s_cselect_b32 s65, 0, 16
    s_waitcnt lgkmcnt(0)
    s_cmp_lt_u32 s64, s65
    s_cbranch_scc1 M_p1_chk
M_p1_ok:
    s_barrier
    s_and_b32 s57, s58, 15
    s_lshr_b64 s[58:59], s[58:59], 4
    s_lshl_b32 s56, s57, 11
    s_mul_i32 s57, s57, 0x60000
    s_add_u32 s53, s53, 49152
    s_cmp_ge_u32 s53, 147456
    s_cselect_b32 s53, 0, s53
    s_and_b32 s57, s58, 15
    s_lshr_b64 s[58:59], s[58:59], 4
    s_lshl_b32 s56, s57, 11
    s_mul_i32 s57, s57, 0x60000
    s_add_u32 m0, s53, s72
    s_nop 0
    buffer_load_dwordx4 v184, s[28:31], s56 offen offset:0 lds
    buffer_load_dwordx4 v184, s[28:31], s56 offen offset:1024 lds
    buffer_load_dwordx4 v185, s[28:31], s56 offen offset:2048 lds
    buffer_load_dwordx4 v185, s[28:31], s56 offen offset:3072 lds
    s_add_u32 m0, s53, s73
    s_mov_b32 exec_hi, 0
    buffer_load_dwordx4 v186, s[28:31], s56 offen offset:0 lds
    s_mov_b32 exec_hi, -1
    s_add_u32 s53, s53, 49152
    s_cmp_ge_u32 s53, 147456
    s_cselect_b32 s53, 0, s53
    s_and_b32 s57, s58, 15
    s_lshr_b64 s[58:59], s[58:59], 4
    s_lshl_b32 s56, s57, 11
    s_mul_i32 s57, s57, 0x60000
    s_add_u32 m0, s53, s74
    s_nop 0
    buffer_load_dwordx4 v187, s[32:35], s57 offen offset:0 lds
    buffer_load_dwordx4 v188, s[32:35], s57 offen offset:1024 lds
    buffer_load_dwordx4 v189, s[32:35], s57 offen offset:2048 lds
    buffer_load_dwordx4 v190, s[32:35], s57 offen offset:3072 lds
    s_add_u32 m0, s53, s75
    s_nop 0
    buffer_load_dwordx4 v191, s[32:35], s57 offen offset:0 lds
    buffer_load_dwordx4 v192, s[32:35], s57 offen offset:1024 lds
    s_add_u32 m0, s53, s72
    s_nop 0
    buffer_load_dwordx4 v184, s[28:31], s56 offen offset:0 lds
    buffer_load_dwordx4 v184, s[28:31], s56 offen offset:1024 lds
    buffer_load_dwordx4 v185, s[28:31], s56 offen offset:2048 lds
    buffer_load_dwordx4 v185, s[28:31], s56 offen offset:3072 lds
    s_add_u32 m0, s53, s73
    s_mov_b32 exec_hi, 0
    buffer_load_dwordx4 v186, s[28:31], s56 offen offset:0 lds
    s_mov_b32 exec_hi, -1
    s_add_u32 s53, s53, 49152
    s_cmp_ge_u32 s53, 147456
    s_cselect_b32 s53, 0, s53
    s_waitcnt vmcnt(11)
    s_barrier
    s_and_b32 s57, s58, 15
    s_lshr_b64 s[58:59], s[58:59], 4
    s_lshl_b32 s56, s57, 11
    s_mul_i32 s57, s57, 0x60000
    s_add_u32 m0, s53, s74
    s_nop 0
    buffer_load_dwordx4 v187, s[32:35], s57 offen offset:0 lds
    buffer_load_dwordx4 v188, s[32:35], s57 offen offset:1024 lds
    s_load_dword s99, s[10:11], -3712
    buffer_load_dwordx4 v189, s[32:35], s57 offen offset:2048 lds
    buffer_load_dwordx4 v190, s[32:35], s57 offen offset:3072 lds
    s_load_dword s99, s[24:25], -3712
    s_add_u32 m0, s53, s75
    s_nop 0
    buffer_load_dwordx4 v191, s[32:35], s57 offen offset:0 lds
    buffer_load_dwordx4 v192, s[32:35], s57 offen offset:1024 lds
    s_load_dword s99, s[10:11], -3648
    s_add_u32 m0, s53, s72
    s_nop 0
    buffer_load_dwordx4 v184, s[28:31], s56 offen offset:0 lds
    buffer_load_dwordx4 v184, s[28:31], s56 offen offset:1024 lds
    s_load_dword s99, s[24:25], -3648
    buffer_load_dwordx4 v185, s[28:31], s56 offen offset:2048 lds
    buffer_load_dwordx4 v185, s[28:31], s56 offen offset:3072 lds
    s_load_dword s99, s[10:11], -2688
    s_add_u32 m0, s53, s73
    s_mov_b32 exec_hi, 0
    buffer_load_dwordx4 v186, s[28:31], s56 offen offset:0 lds
    s_mov_b32 exec_hi, -1
    s_add_u32 s53, s53, 49152
    s_cmp_ge_u32 s53, 147456
    s_cselect_b32 s53, 0, s53
    s_load_dword s99, s[24:25], -2688
    s_waitcnt vmcnt(11)
    s_barrier
    s_and_b32 s57, s58, 15
    s_lshr_b64 s[58:59], s[58:59], 4
    s_lshl_b32 s56, s57, 11
    s_mul_i32 s57, s57, 0x60000
    s_add_u32 m0, s53, s74
    s_nop 0
    buffer_load_dwordx4 v187, s[32:35], s57 offen offset:0 lds
    buffer_load_dwordx4 v188, s[32:35], s57 offen offset:1024 lds
    s_load_dword s99, s[10:11], -2624
    buffer_load_dwordx4 v189, s[32:35], s57 offen offset:2048 lds
    buffer_load_dwordx4 v190, s[32:35], s57 offen offset:3072 lds
    s_load_dword s99, s[24:25], -2624
    s_add_u32 m0, s53, s75
    s_nop 0
    buffer_load_dwordx4 v191, s[32:35], s57 offen offset:0 lds
    buffer_load_dwordx4 v192, s[32:35], s57 offen offset:1024 lds
    s_load_dword s99, s[10:11], -1664
    s_add_u32 m0, s53, s72
    s_nop 0
    buffer_load_dwordx4 v184, s[28:31], s56 offen offset:0 lds
    buffer_load_dwordx4 v184, s[28:31], s56 offen offset:1024 lds
    s_load_dword s99, s[24:25], -1664
    buffer_load_dwordx4 v185, s[28:31], s56 offen offset:2048 lds
    buffer_load_dwordx4 v185, s[28:31], s56 offen offset:3072 lds
    s_load_dword s99, s[10:11], -1600
    s_add_u32 m0, s53, s73
    s_mov_b32 exec_hi, 0
    buffer_load_dwordx4 v186, s[28:31], s56 offen offset:0 lds
    s_mov_b32 exec_hi, -1
    s_add_u32 s53, s53, 49152
    s_cmp_ge_u32 s53, 147456
    s_cselect_b32 s53, 0, s53
    s_load_dword s99, s[24:25], -1600
    s_waitcnt vmcnt(11)
    s_barrier
    s_and_b32 s57, s58, 15
    s_lshr_b64 s[58:59], s[58:59], 4
    s_lshl_b32 s56, s57, 11
    s_mul_i32 s57, s57, 0x60000
    s_add_u32 m0, s53, s74
    s_nop 0
    buffer_load_dwordx4 v187, s[32:35], s57 offen offset:0 lds
    buffer_load_dwordx4 v188, s[32:35], s57 offen offset:1024 lds
    buffer_load_dwordx4 v189, s[32:35], s57 offen offset:2048 lds
    s_load_dword s99, s[10:11], -640
    buffer_load_dwordx4 v190, s[32:35], s57 offen offset:3072 lds
    s_add_u32 m0, s53, s75
    s_nop 0
    buffer_load_dwordx4 v191, s[32:35], s57 offen offset:0 lds
    buffer_load_dwordx4 v192, s[32:35], s57 offen offset:1024 lds
    s_load_dword s99, s[24:25], -640
    s_add_u32 m0, s53, s72
    s_nop 0
    buffer_load_dwordx4 v184, s[28:31], s56 offen offset:0 lds
    buffer_load_dwordx4 v184, s[28:31], s56 offen offset:1024 lds
    buffer_load_dwordx4 v185, s[28:31], s56 offen offset:2048 lds
    s_load_dword s99, s[10:11], -576
    buffer_load_dwordx4 v185, s[28:31], s56 offen offset:3072 lds
    s_add_u32 m0, s53, s73
    s_mov_b32 exec_hi, 0
    buffer_load_dwordx4 v186, s[28:31], s56 offen offset:0 lds
    s_mov_b32 exec_hi, -1
    s_add_u32 s53, s53, 49152
    s_cmp_ge_u32 s53, 147456
    s_cselect_b32 s53, 0, s53
    s_load_dword s99, s[24:25], -576
    s_movk_i32 s54, 8
M_Q_loop0:
    s_waitcnt vmcnt(11)
    s_barrier
    s_and_b32 s57, s58, 15
    s_lshr_b64 s[58:59], s[58:59], 4
    s_lshl_b32 s56, s57, 11
    s_mul_i32 s57, s57, 0x60000
    s_add_u32 m0, s53, s74
    s_nop 0
    buffer_load_dwordx4 v187, s[32:35], s57 offen offset:0 lds
    buffer_load_dwordx4 v188, s[32:35], s57 offen offset:1024 lds
    s_load_dword s99, s[10:11], 0
    buffer_load_dwordx4 v189, s[32:35], s57 offen offset:2048 lds
    buffer_load_dwordx4 v190, s[32:35], s57 offen offset:3072 lds
    s_add_u32 m0, s53, s75
    s_nop 0
    buffer_load_dwordx4 v191, s[32:35], s57 offen offset:0 lds
    s_load_dword s99, s[24:25], 0
    buffer_load_dwordx4 v192, s[32:35], s57 offen offset:1024 lds
    s_add_u32 m0, s53, s72
    s_nop 0
    buffer_load_dwordx4 v184, s[28:31], s56 offen offset:0 lds
    s_load_dword s99, s[10:11], 64
    buffer_load_dwordx4 v184, s[28:31], s56 offen offset:1024 lds
    buffer_load_dwordx4 v185, s[28:31], s56 offen offset:2048 lds
    buffer_load_dwordx4 v185, s[28:31], s56 offen offset:3072 lds
    s_load_dword s99, s[24:25], 64
    s_add_u32 m0, s53, s73
    s_mov_b32 exec_hi, 0
    buffer_load_dwordx4 v186, s[28:31], s56 offen offset:0 lds
    s_mov_b32 exec_hi, -1
    s_add_u32 s53, s53, 49152
    s_cmp_ge_u32 s53, 147456
    s_cselect_b32 s53, 0, s53
    s_add_u32 s10, s10, 128
    s_addc_u32 s11, s11, 0
    s_add_u32 s24, s24, 128
    s_addc_u32 s25, s25, 0
    s_sub_u32 s54, s54, 1
    s_cbranch_scc0 M_Q_loop0
    s_waitcnt vmcnt(11)
    s_barrier
    s_and_b32 s57, s58, 15
    s_lshr_b64 s[58:59], s[58:59], 4
    s_lshl_b32 s56, s57, 11
    s_mul_i32 s57, s57, 0x60000
    s_add_u32 m0, s53, s74
    s_nop 0
    buffer_load_dwordx4 v187, s[32:35], s57 offen offset:0 lds
    buffer_load_dwordx4 v188, s[32:35], s57 offen offset:1024 lds
    buffer_load_dwordx4 v189, s[32:35], s57 offen offset:2048 lds
    buffer_load_dwordx4 v190, s[32:35], s57 offen offset:3072 lds
    s_add_u32 m0, s53, s75
    s_nop 0
    buffer_load_dwordx4 v191, s[32:35], s57 offen offset:0 lds
    buffer_load_dwordx4 v192, s[32:35], s57 offen offset:1024 lds
    s_add_u32 m0, s53, s72
    s_nop 0
    buffer_load_dwordx4 v184, s[28:31], s56 offen offset:0 lds
    buffer_load_dwordx4 v184, s[28:31], s56 offen offset:1024 lds
    buffer_load_dwordx4 v185, s[28:31], s56 offen offset:2048 lds
    buffer_load_dwordx4 v185, s[28:31], s56 offen offset:3072 lds
    s_add_u32 m0, s53, s73
    s_mov_b32 exec_hi, 0
    buffer_load_dwordx4 v186, s[28:31], s56 offen offset:0 lds
    s_mov_b32 exec_hi, -1
    s_add_u32 s53, s53, 49152
    s_cmp_ge_u32 s53, 147456
    s_cselect_b32 s53, 0, s53
    s_mov_b32 s64, 0x120000
    buffer_load_dwordx4 v[44:47], v17, s[36:39], s64 offen
    s_mov_b32 s64, 0x180000
    buffer_load_dwordx4 v[48:51], v17, s[36:39], s64 offen
    s_mov_b32 s64, 0x1e0000
    buffer_load_dwordx4 v[52:55], v17, s[36:39], s64 offen
    s_mov_b32 s64, 0x240000
    buffer_load_dwordx4 v[56:59], v17, s[36:39], s64 offen
    s_mov_b32 s64, 0x2a0000
    buffer_load_dwordx4 v[60:63], v17, s[36:39], s64 offen
    s_lshl_b32 s60, s44, 12
    s_add_u32 s61, s60, 147456
    s_add_u32 s53, s60, 49152
    s_lshl_b32 s70, s44, 11
    s_sub_u32 s70, 16384, s70
    s_bfe_u32 s66, s2, 0x30003
    s_lshr_b32 s55, s2, 6
    s_add_u32 s66, s66, s55
    s_and_b32 s66, s66, 3
    s_mov_b32 s58, 0x76453210
    s_mov_b32 s59, 0xfecdba89
    s_cmp_eq_u32 s66, 1
    s_cselect_b32 s58, 0x75643120, s58
    s_cselect_b32 s59, 0xfdecb9a8, s59
    s_cmp_eq_u32 s66, 2
    s_cselect_b32 s58, 0x67542310, s58
    s_cselect_b32 s59, 0xefdcab98, s59
    s_cmp_eq_u32 s66, 3
    s_cselect_b32 s58, 0x86534210, s58
    s_cselect_b32 s59, 0xfedbca97, s59
    s_mov_b32 s32, s8
    s_mov_b32 s33, s9
    s_mov_b32 s34, 0x200000
    s_mov_b32 s35, 0x20000
    s_waitcnt vmcnt(16)
    s_barrier
    s_waitcnt vmcnt(5)
    s_barrier
    s_barrier
    s_and_b32 s57, s58, 15
    s_lshr_b64 s[58:59], s[58:59], 4
    s_lshl_b32 s56, s57, 11
    s_mul_i32 s57, s57, 0x20000
    s_add_u32 m0, s53, s70
    s_nop 0
    buffer_load_dwordx4 v193, s[32:35], s57 offen offset:0 lds
    buffer_load_dwordx4 v194, s[32:35], s57 offen offset:1024 lds
    s_add_u32 s53, s53, 24576
    s_cmp_ge_u32 s53, s61
    s_cselect_b32 s53, s60, s53
    s_and_b32 s57, s58, 15
    s_lshr_b64 s[58:59], s[58:59], 4
    s_lshl_b32 s56, s57, 11
    s_mul_i32 s57, s57, 0x20000
    s_add_u32 m0, s53, s70
    s_nop 0
    buffer_load_dwordx4 v193, s[32:35], s57 offen offset:0 lds
    buffer_load_dwordx4 v194, s[32:35], s57 offen offset:1024 lds
    s_add_u32 s53, s53, 24576
    s_cmp_ge_u32 s53, s61
    s_cselect_b32 s53, s60, s53
    s_and_b32 s57, s58, 15
    s_lshr_b64 s[58:59], s[58:59], 4
    s_lshl_b32 s56, s57, 11
    s_mul_i32 s57, s57, 0x20000
    s_add_u32 m0, s53, s70
    s_nop 0
    buffer_load_dwordx4 v193, s[32:35], s57 offen offset:0 lds
    buffer_load_dwordx4 v194, s[32:35], s57 offen offset:1024 lds
    s_add_u32 s53, s53, 24576
    s_cmp_ge_u32 s53, s61
    s_cselect_b32 s53, s60, s53
    s_and_b32 s57, s58, 15
    s_lshr_b64 s[58:59], s[58:59], 4
    s_lshl_b32 s56, s57, 11
    s_mul_i32 s57, s57, 0x20000
    s_add_u32 m0, s53, s70
    s_nop 0
    buffer_load_dwordx4 v193, s[32:35], s57 offen offset:0 lds
    buffer_load_dwordx4 v194, s[32:35], s57 offen offset:1024 lds
    s_add_u32 s53, s53, 24576
    s_cmp_ge_u32 s53, s61
    s_cselect_b32 s53, s60, s53
    s_and_b32 s57, s58, 15
    s_lshr_b64 s[58:59], s[58:59], 4
    s_lshl_b32 s56, s57, 11
    s_mul_i32 s57, s57, 0x20000
    s_add_u32 m0, s53, s70
    s_nop 0
    buffer_load_dwordx4 v193, s[32:35], s57 offen offset:0 lds
    buffer_load_dwordx4 v194, s[32:35], s57 offen offset:1024 lds
    s_add_u32 s53, s53, 24576
    s_cmp_ge_u32 s53, s61
    s_cselect_b32 s53, s60, s53
    s_and_b32 s57, s58, 15
    s_lshr_b64 s[58:59], s[58:59], 4
    s_lshl_b32 s56, s57, 11
    s_mul_i32 s57, s57, 0x20000
    s_add_u32 m0, s53, s70
    s_nop 0
    buffer_load_dwordx4 v193, s[32:35], s57 offen offset:0 lds
    buffer_load_dwordx4 v194, s[32:35], s57 offen offset:1024 lds
    s_add_u32 s53, s53, 24576
    s_cmp_ge_u32 s53, s61
    s_cselect_b32 s53, s60, s53
    s_mov_b32 s40, s8
    s_mov_b32 s41, s9
    s_mov_b32 s42, 0x200000
    s_mov_b32 s43, 0x20000
    s_mov_b32 s64, 0x0
    buffer_load_dword v244, v243, s[40:43], s64 offen
    v_lshlrev_b32 v24, 16, v24
    v_lshlrev_b32 v25, 16, v25
    v_lshlrev_b32 v26, 16, v26
    v_lshlrev_b32 v27, 16, v27
    v_lshlrev_b32 v28, 16, v28
    v_lshlrev_b32 v29, 16, v29
    v_lshlrev_b32 v30, 16, v30
    v_lshlrev_b32 v31, 16, v31
    v_mul_f32 v72, 0xbfb8aa3b, v24
    v_mul_f32 v73, 0xbfb8aa3b, v25
    v_mul_f32 v74, 0xbfb8aa3b, v26
    v_mul_f32 v75, 0xbfb8aa3b, v27
    v_mul_f32 v76, 0xbfb8aa3b, v28
    v_mul_f32 v77, 0xbfb8aa3b, v29
    v_mul_f32 v78, 0xbfb8aa3b, v30
    v_mul_f32 v79, 0xbfb8aa3b, v31
    v_exp_f32 v72, v72
    v_exp_f32 v73, v73
    v_exp_f32 v74, v74
    v_exp_f32 v75, v75
    v_exp_f32 v76, v76
    v_exp_f32 v77, v77
    v_exp_f32 v78, v78
    v_exp_f32 v79, v79
    v_add_f32 v72, 1.0, v72
    v_add_f32 v73, 1.0, v73
    v_add_f32 v74, 1.0, v74
    v_add_f32 v75, 1.0, v75
    v_add_f32 v76, 1.0, v76
    v_add_f32 v77, 1.0, v77
    v_add_f32 v78, 1.0, v78
    v_add_f32 v79, 1.0, v79
    v_rcp_f32 v72, v72
    v_rcp_f32 v73, v73
    v_rcp_f32 v74, v74
    v_rcp_f32 v75, v75
    v_rcp_f32 v76, v76
    v_rcp_f32 v77, v77
    v_rcp_f32 v78, v78
    v_rcp_f32 v79, v79
    v_mul_f32 v24, v24, v72
    v_mul_f32 v25, v25, v73
    v_mul_f32 v26, v26, v74
    v_mul_f32 v27, v27, v75
    v_mul_f32 v28, v28, v76
    v_mul_f32 v29, v29, v77
    v_mul_f32 v30, v30, v78
    v_mul_f32 v31, v31, v79
    v_cvt_pk_bf16_f32 v72, v24, v24
    v_lshlrev_b32 v24, 16, v72
    v_cvt_pk_bf16_f32 v73, v25, v25
    v_lshlrev_b32 v25, 16, v73
    v_cvt_pk_bf16_f32 v74, v26, v26
    v_lshlrev_b32 v26, 16, v74
    v_cvt_pk_bf16_f32 v75, v27, v27
    v_lshlrev_b32 v27, 16, v75
    v_cvt_pk_bf16_f32 v76, v28, v28
    v_lshlrev_b32 v28, 16, v76
    v_cvt_pk_bf16_f32 v77, v29, v29
    v_lshlrev_b32 v29, 16, v77
    v_cvt_pk_bf16_f32 v78, v30, v30
    v_lshlrev_b32 v30, 16, v78
    v_cvt_pk_bf16_f32 v79, v31, v31
    v_lshlrev_b32 v31, 16, v79
    v_lshlrev_b32 v72, 16, v32
    v_and_b32 v73, 0xffff0000, v32
    v_lshlrev_b32 v74, 16, v33
    v_and_b32 v75, 0xffff0000, v33
    v_lshlrev_b32 v76, 16, v34
    v_and_b32 v77, 0xffff0000, v34
    v_lshlrev_b32 v78, 16, v35
    v_and_b32 v79, 0xffff0000, v35
    v_mul_f32 v64, v24, v72
    v_mul_f32 v65, v24, v73
    v_mul_f32 v66, v24, v74
    v_mul_f32 v67, v24, v75
    v_mul_f32 v68, v24, v76
    v_mul_f32 v69, v24, v77
    v_mul_f32 v70, v24, v78
    v_mul_f32 v71, v24, v79
    v_lshlrev_b32 v72, 16, v36
    v_and_b32 v73, 0xffff0000, v36
    v_lshlrev_b32 v74, 16, v37
    v_and_b32 v75, 0xffff0000, v37
    v_lshlrev_b32 v76, 16, v38
    v_and_b32 v77, 0xffff0000, v38
    v_lshlrev_b32 v78, 16, v39
    v_and_b32 v79, 0xffff0000, v39
    v_fmac_f32 v64, v25, v72
    v_fmac_f32 v65, v25, v73
    v_fmac_f32 v66, v25, v74
    v_fmac_f32 v67, v25, v75
    v_fmac_f32 v68, v25, v76
    v_fmac_f32 v69, v25, v77
    v_fmac_f32 v70, v25, v78
    v_fmac_f32 v71, v25, v79
    v_lshlrev_b32 v72, 16, v40
    v_and_b32 v73, 0xffff0000, v40
    v_lshlrev_b32 v74, 16, v41
    v_and_b32 v75, 0xffff0000, v41
    v_lshlrev_b32 v76, 16, v42
    v_and_b32 v77, 0xffff0000, v42
    v_lshlrev_b32 v78, 16, v43
    v_and_b32 v79, 0xffff0000, v43
    v_fmac_f32 v64, v26, v72
    v_fmac_f32 v65, v26, v73
    v_fmac_f32 v66, v26, v74
    v_fmac_f32 v67, v26, v75
    v_fmac_f32 v68, v26, v76
    v_fmac_f32 v69, v26, v77
    v_fmac_f32 v70, v26, v78
    v_fmac_f32 v71, v26, v79
    s_waitcnt vmcnt(17)
    v_lshlrev_b32 v72, 16, v44
    v_and_b32 v73, 0xffff0000, v44
    v_lshlrev_b32 v74, 16, v45
    v_and_b32 v75, 0xffff0000, v45
    v_lshlrev_b32 v76, 16, v46
    v_and_b32 v77, 0xffff0000, v46
    v_lshlrev_b32 v78, 16, v47
    v_and_b32 v79, 0xffff0000, v47
    v_fmac_f32 v64, v27, v72
    v_fmac_f32 v65, v27, v73
    v_fmac_f32 v66, v27, v74
    v_fmac_f32 v67, v27, v75
    v_fmac_f32 v68, v27, v76
    v_fmac_f32 v69, v27, v77
    v_fmac_f32 v70, v27, v78
    v_fmac_f32 v71, v27, v79
    s_waitcnt vmcnt(16)
    v_lshlrev_b32 v72, 16, v48
    v_and_b32 v73, 0xffff0000, v48
    v_lshlrev_b32 v74, 16, v49
    v_and_b32 v75, 0xffff0000, v49
    v_lshlrev_b32 v76, 16, v50
    v_and_b32 v77, 0xffff0000, v50
    v_lshlrev_b32 v78, 16, v51
    v_and_b32 v79, 0xffff0000, v51
    v_fmac_f32 v64, v28, v72
    v_fmac_f32 v65, v28, v73
    v_fmac_f32 v66, v28, v74
    v_fmac_f32 v67, v28, v75
    v_fmac_f32 v68, v28, v76
    v_fmac_f32 v69, v28, v77
    v_fmac_f32 v70, v28, v78
    v_fmac_f32 v71, v28, v79
    s_waitcnt vmcnt(15)
    v_lshlrev_b32 v72, 16, v52
    v_and_b32 v73, 0xffff0000, v52
    v_lshlrev_b32 v74, 16, v53
    v_and_b32 v75, 0xffff0000, v53
    v_lshlrev_b32 v76, 16, v54
    v_and_b32 v77, 0xffff0000, v54
    v_lshlrev_b32 v78, 16, v55
    v_and_b32 v79, 0xffff0000, v55
    v_fmac_f32 v64, v29, v72
    v_fmac_f32 v65, v29, v73
    v_fmac_f32 v66, v29, v74
    v_fmac_f32 v67, v29, v75
    v_fmac_f32 v68, v29, v76
    v_fmac_f32 v69, v29, v77
    v_fmac_f32 v70, v29, v78
    v_fmac_f32 v71, v29, v79
    s_waitcnt vmcnt(14)
    v_lshlrev_b32 v72, 16, v56
    v_and_b32 v73, 0xffff0000, v56
    v_lshlrev_b32 v74, 16, v57
    v_and_b32 v75, 0xffff0000, v57
    v_lshlrev_b32 v76, 16, v58
    v_and_b32 v77, 0xffff0000, v58
    v_lshlrev_b32 v78, 16, v59
    v_and_b32 v79, 0xffff0000, v59
    v_fmac_f32 v64, v30, v72
    v_fmac_f32 v65, v30, v73
    v_fmac_f32 v66, v30, v74
    v_fmac_f32 v67, v30, v75
    v_fmac_f32 v68, v30, v76
    v_fmac_f32 v69, v30, v77
    v_fmac_f32 v70, v30, v78
    v_fmac_f32 v71, v30, v79
    s_waitcnt vmcnt(13)
    v_lshlrev_b32 v72, 16, v60
    v_and_b32 v73, 0xffff0000, v60
    v_lshlrev_b32 v74, 16, v61
    v_and_b32 v75, 0xffff0000, v61
    v_lshlrev_b32 v76, 16, v62
    v_and_b32 v77, 0xffff0000, v62
    v_lshlrev_b32 v78, 16, v63
    v_and_b32 v79, 0xffff0000, v63
    v_fmac_f32 v64, v31, v72
    v_fmac_f32 v65, v31, v73
    v_fmac_f32 v66, v31, v74
    v_fmac_f32 v67, v31, v75
    v_fmac_f32 v68, v31, v76
    v_fmac_f32 v69, v31, v77
    v_fmac_f32 v70, v31, v78
    v_fmac_f32 v71, v31, v79
    v_add_f32_dpp v64, v64, v64 row_ror:8 row_mask:0xf bank_mask:0xf
    v_add_f32_dpp v65, v65, v65 row_ror:8 row_mask:0xf bank_mask:0xf
    v_add_f32_dpp v66, v66, v66 row_ror:8 row_mask:0xf bank_mask:0xf
    v_add_f32_dpp v67, v67, v67 row_ror:8 row_mask:0xf bank_mask:0xf
    v_add_f32_dpp v68, v68, v68 row_ror:8 row_mask:0xf bank_mask:0xf
    v_add_f32_dpp v69, v69, v69 row_ror:8 row_mask:0xf bank_mask:0xf
    v_add_f32_dpp v70, v70, v70 row_ror:8 row_mask:0xf bank_mask:0xf
    v_add_f32_dpp v71, v71, v71 row_ror:8 row_mask:0xf bank_mask:0xf
    v_mov_b32 v72, v64
    v_mov_b32 v73, v65
    v_mov_b32 v74, v66
    v_mov_b32 v75, v67
    v_mov_b32 v76, v68
    v_mov_b32 v77, v69
    v_mov_b32 v78, v70
    v_mov_b32 v79, v71
    v_permlane32_swap_b32 v64, v72
    v_permlane32_swap_b32 v65, v73
    v_permlane32_swap_b32 v66, v74
    v_permlane32_swap_b32 v67, v75
    v_permlane32_swap_b32 v68, v76
    v_permlane32_swap_b32 v69, v77
    v_permlane32_swap_b32 v70, v78
    v_permlane32_swap_b32 v71, v79
    v_add_f32 v64, v64, v72
    v_add_f32 v65, v65, v73
    v_add_f32 v66, v66, v74
    v_add_f32 v67, v67, v75
    v_add_f32 v68, v68, v76
    v_add_f32 v69, v69, v77
    v_add_f32 v70, v70, v78
    v_add_f32 v71, v71, v79
    v_mov_b32 v72, v64
    v_mov_b32 v73, v65
    v_mov_b32 v74, v66
    v_mov_b32 v75, v67
    v_mov_b32 v76, v68
    v_mov_b32 v77, v69
    v_mov_b32 v78, v70
    v_mov_b32 v79, v71
    v_permlane16_swap_b32 v64, v72
    v_permlane16_swap_b32 v65, v73
    v_permlane16_swap_b32 v66, v74
    v_permlane16_swap_b32 v67, v75
    v_permlane16_swap_b32 v68, v76
    v_permlane16_swap_b32 v69, v77
    v_permlane16_swap_b32 v70, v78
    v_permlane16_swap_b32 v71, v79
    v_add_f32 v64, v64, v72
    v_add_f32 v65, v65, v73
    v_add_f32 v66, v66, v74
    v_add_f32 v67, v67, v75
    v_add_f32 v68, v68, v76
    v_add_f32 v69, v69, v77
    v_add_f32 v70, v70, v78
    v_add_f32 v71, v71, v79
    s_lshl_b32 s64, s44, 8
    s_add_u32 s64, s64, 147456
    v_and_b32 v72, 7, v0
    v_lshl_add_u32 v72, v72, 5, s64
    ds_write_b128 v72, v[64:67]
    ds_write_b128 v72, v[68:71] offset:16
    v_mov_b32 v73, 148480
    v_mov_b32 v74, 1
    s_waitcnt lgkmcnt(0)
    s_mov_b64 exec, 1
    ds_add_rtn_u32 v75, v73, v74
    s_mov_b64 exec, -1
    v_add_u32 v73, 147456, v234
    s_waitcnt lgkmcnt(0)
    ds_read_b32 v64, v73 offset:0
    ds_read_b32 v65, v73 offset:256
    ds_read_b32 v66, v73 offset:512
    ds_read_b32 v67, v73 offset:768
    v_readfirstlane_b32 s64, v75
    s_nop 3
    s_cmp_eq_u32 s64, 3
    s_cselect_b32 s80, s80, 0x80000000
    v_lshl_add_u32 v72, v1, 3, s80
    s_waitcnt lgkmcnt(0)
    v_add_f32 v64, v64, v65
    v_add_f32 v66, v66, v67
    v_add_f32 v64, v64, v66
    v_mov_b32 v65, s0
    buffer_store_dwordx2 v[64:65], v72, s[28:31], 0 offen sc1
    s_mov_b32 s40, s4
    s_mov_b32 s41, s5
    s_mov_b32 s42, 0x400000
    s_mov_b32 s43, 0x20000
    s_mov_b32 s64, 0x8000
    buffer_load_dwordx4 v[88:91], v196, s[40:43], 0 offen offset:0
    buffer_load_dwordx4 v[92:95], v196, s[40:43], 0 offen offset:64
    buffer_load_dwordx4 v[96:99], v196, s[40:43], s64 offen offset:0
    buffer_load_dwordx4 v[100:103], v196, s[40:43], s64 offen offset:64
    s_lshl_b32 s60, s44, 12
    s_add_u32 s61, s60, 147456
    s_add_u32 s53, s60, 0
    s_bfe_u32 s66, s2, 0x30003
    s_lshr_b32 s55, s2, 6
    s_add_u32 s66, s66, s55
    s_and_b32 s66, s66, 3
    s_mov_b32 s58, 0x76453210
    s_mov_b32 s59, 0xfecdba89
    s_cmp_eq_u32 s66, 1
    s_cselect_b32 s58, 0x75643120, s58
    s_cselect_b32 s59, 0xfdecb9a8, s59
    s_cmp_eq_u32 s66, 2
    s_cselect_b32 s58, 0x67542310, s58
    s_cselect_b32 s59, 0xefdcab98, s59
    s_cmp_eq_u32 s66, 3
    s_cselect_b32 s58, 0x86534210, s58
    s_cselect_b32 s59, 0xfedbca97, s59
    s_lshl_b32 s55, s48, 2
    s_lshr_b64 s[56:57], s[58:59], s55
    s_and_b32 s55, s56, 15
    s_lshl_b32 s55, s55, 2
    s_lshl_b64 s[56:57], 15, s55
    s_andn2_b64 s[58:59], s[58:59], s[56:57]
    s_or_b32 s58, s58, s48
    s_mov_b32 s32, s12
    s_mov_b32 s33, s13
    s_mov_b32 s34, 0x700000
    s_mov_b32 s35, 0x20000
    s_mov_b32 s36, s14
    s_mov_b32 s37, s15
    s_mov_b32 s38, 0x700000
    s_mov_b32 s39, 0x20000
    s_mov_b32 s72, 0xb00000
    s_mov_b32 s74, 0x1000000
    s_mov_b32 s73, 0xb08000
    s_mov_b32 s75, 0x1008000
    s_lshl_b32 s76, s48, 8
    s_waitcnt vmcnt(0)
    v_permlane16_swap_b32 v88, v90
    v_permlane16_swap_b32 v89, v91
    v_permlane16_swap_b32 v92, v94
    v_permlane16_swap_b32 v93, v95
    v_permlane16_swap_b32 v96, v98
    v_permlane16_swap_b32 v97, v99
    v_permlane16_swap_b32 v100, v102
    v_permlane16_swap_b32 v101, v103
    v_lshlrev_b32 v104, 16, v88
    v_and_b32 v105, 0xffff0000, v88
    v_lshlrev_b32 v106, 16, v89
    v_and_b32 v107, 0xffff0000, v89
    v_lshlrev_b32 v108, 16, v90
    v_and_b32 v109, 0xffff0000, v90
    v_lshlrev_b32 v110, 16, v91
    v_and_b32 v111, 0xffff0000, v91
    v_lshlrev_b32 v112, 16, v92
    v_and_b32 v113, 0xffff0000, v92
    v_lshlrev_b32 v114, 16, v93
    v_and_b32 v115, 0xffff0000, v93
    v_lshlrev_b32 v116, 16, v94
    v_and_b32 v117, 0xffff0000, v94
    v_lshlrev_b32 v118, 16, v95
    v_and_b32 v119, 0xffff0000, v95
    v_lshlrev_b32 v120, 16, v96
    v_and_b32 v121, 0xffff0000, v96
    v_lshlrev_b32 v122, 16, v97
    v_and_b32 v123, 0xffff0000, v97
    v_lshlrev_b32 v124, 16, v98
    v_and_b32 v125, 0xffff0000, v98
    v_lshlrev_b32 v126, 16, v99
    v_and_b32 v127, 0xffff0000, v99
    v_lshlrev_b32 v128, 16, v100
    v_and_b32 v129, 0xffff0000, v100
    v_lshlrev_b32 v130, 16, v101
    v_and_b32 v131, 0xffff0000, v101
    v_lshlrev_b32 v132, 16, v102
    v_and_b32 v133, 0xffff0000, v102
    v_lshlrev_b32 v134, 16, v103
    v_and_b32 v135, 0xffff0000, v103
    s_setprio 2
    s_barrier
    s_barrier
    ds_read_b128 v[40:43], v232 offset:0
    ds_read_b64_tr_b16 v[48:49], v235 offset:0
    ds_read_b64_tr_b16 v[50:51], v235 offset:2048
    ds_read_b64_tr_b16 v[52:53], v236 offset:0
    ds_read_b64_tr_b16 v[54:55], v236 offset:2048
    ds_read_b64_tr_b16 v[56:57], v237 offset:0
    ds_read_b64_tr_b16 v[58:59], v237 offset:2048
    ds_read_b64_tr_b16 v[60:61], v238 offset:0
    ds_read_b64_tr_b16 v[62:63], v238 offset:2048
    ds_read_b128 v[44:47], v232 offset:2048
    s_add_u32 s52, s52, 24576
    s_cmp_ge_u32 s52, 147456
    s_cselect_b32 s52, 0, s52
    s_waitcnt lgkmcnt(0)
    v_mfma_f32_16x16x32_bf16 v[8:11], v[48:51], v[40:43], 0
    ds_read_b128 v[64:67], v232 offset:1024
    ds_read_b64_tr_b16 v[72:73], v235 offset:4096
    v_mfma_f32_16x16x32_bf16 v[12:15], v[52:55], v[40:43], 0
    ds_read_b64_tr_b16 v[74:75], v235 offset:6144
    ds_read_b64_tr_b16 v[76:77], v236 offset:4096
    v_mfma_f32_16x16x32_bf16 v[16:19], v[56:59], v[40:43], 0
    ds_read_b64_tr_b16 v[78:79], v236 offset:6144
    ds_read_b64_tr_b16 v[80:81], v237 offset:4096
    v_mfma_f32_16x16x32_bf16 v[20:23], v[60:63], v[40:43], 0
    ds_read_b64_tr_b16 v[82:83], v237 offset:6144
    ds_read_b64_tr_b16 v[84:85], v238 offset:4096
    v_mfma_f32_16x16x32_bf16 v[24:27], v[48:51], v[44:47], 0
    ds_read_b64_tr_b16 v[86:87], v238 offset:6144
    ds_read_b128 v[68:71], v232 offset:3072
    v_mfma_f32_16x16x32_bf16 v[28:31], v[52:55], v[44:47], 0
    v_add_u32 v232, s52, v233
    v_add_u32 v235, s52, v239
    v_mfma_f32_16x16x32_bf16 v[32:35], v[56:59], v[44:47], 0
    v_add_u32 v236, s52, v240
    v_add_u32 v237, s52, v241
    v_mfma_f32_16x16x32_bf16 v[36:39], v[60:63], v[44:47], 0
    v_add_u32 v238, s52, v242
    s_waitcnt lgkmcnt(0)
    v_mfma_f32_16x16x32_bf16 v[8:11], v[72:75], v[64:67], v[8:11]
    s_barrier
    v_mfma_f32_16x16x32_bf16 v[12:15], v[76:79], v[64:67], v[12:15]
    ds_read_b128 v[40:43], v232 offset:0
    ds_read_b64_tr_b16 v[48:49], v235 offset:0
    ds_read_b64_tr_b16 v[50:51], v235 offset:2048
    v_mfma_f32_16x16x32_bf16 v[16:19], v[80:83], v[64:67], v[16:19]
    ds_read_b64_tr_b16 v[52:53], v236 offset:0
    ds_read_b64_tr_b16 v[54:55], v236 offset:2048
    v_mfma_f32_16x16x32_bf16 v[20:23], v[84:87], v[64:67], v[20:23]
    ds_read_b64_tr_b16 v[56:57], v237 offset:0
    ds_read_b64_tr_b16 v[58:59], v237 offset:2048
    ds_read_b64_tr_b16 v[60:61], v238 offset:0
    v_mfma_f32_16x16x32_bf16 v[24:27], v[72:75], v[68:71], v[24:27]
    ds_read_b64_tr_b16 v[62:63], v238 offset:2048
    ds_read_b128 v[44:47], v232 offset:2048
    v_mfma_f32_16x16x32_bf16 v[28:31], v[76:79], v[68:71], v[28:31]
    v_mfma_f32_16x16x32_bf16 v[32:35], v[80:83], v[68:71], v[32:35]
    s_add_u32 s52, s52, 24576
    s_cmp_ge_u32 s52, 147456
    s_cselect_b32 s52, 0, s52
    v_mfma_f32_16x16x32_bf16 v[36:39], v[84:87], v[68:71], v[36:39]
    s_waitcnt lgkmcnt(0)
    v_mfma_f32_16x16x32_bf16 v[8:11], v[48:51], v[40:43], v[8:11]
    ds_read_b128 v[64:67], v232 offset:1024
    ds_read_b64_tr_b16 v[72:73], v235 offset:4096
    v_mfma_f32_16x16x32_bf16 v[12:15], v[52:55], v[40:43], v[12:15]
    ds_read_b64_tr_b16 v[74:75], v235 offset:6144
    ds_read_b64_tr_b16 v[76:77], v236 offset:4096
    v_mfma_f32_16x16x32_bf16 v[16:19], v[56:59], v[40:43], v[16:19]
    ds_read_b64_tr_b16 v[78:79], v236 offset:6144
    ds_read_b64_tr_b16 v[80:81], v237 offset:4096
    v_mfma_f32_16x16x32_bf16 v[20:23], v[60:63], v[40:43], v[20:23]
    ds_read_b64_tr_b16 v[82:83], v237 offset:6144
    ds_read_b64_tr_b16 v[84:85], v238 offset:4096
    v_mfma_f32_16x16x32_bf16 v[24:27], v[48:51], v[44:47], v[24:27]
    s_movk_i32 s54, 10
M_Q_loop1:
    ds_read_b64_tr_b16 v[86:87], v238 offset:6144
    ds_read_b128 v[68:71], v232 offset:3072
    v_mfma_f32_16x16x32_bf16 v[28:31], v[52:55], v[44:47], v[28:31]
    v_add_u32 v232, s52, v233
    v_add_u32 v235, s52, v239
    v_mfma_f32_16x16x32_bf16 v[32:35], v[56:59], v[44:47], v[32:35]
    v_add_u32 v236, s52, v240
    v_add_u32 v237, s52, v241
    v_mfma_f32_16x16x32_bf16 v[36:39], v[60:63], v[44:47], v[36:39]
    v_add_u32 v238, s52, v242
    s_waitcnt lgkmcnt(0)
    v_mfma_f32_16x16x32_bf16 v[8:11], v[72:75], v[64:67], v[8:11]
    s_barrier
    v_mfma_f32_16x16x32_bf16 v[12:15], v[76:79], v[64:67], v[12:15]
    ds_read_b128 v[40:43], v232 offset:0
    ds_read_b64_tr_b16 v[48:49], v235 offset:0
    ds_read_b64_tr_b16 v[50:51], v235 offset:2048
    v_mfma_f32_16x16x32_bf16 v[16:19], v[80:83], v[64:67], v[16:19]
    ds_read_b64_tr_b16 v[52:53], v236 offset:0
    ds_read_b64_tr_b16 v[54:55], v236 offset:2048
    v_mfma_f32_16x16x32_bf16 v[20:23], v[84:87], v[64:67], v[20:23]
    ds_read_b64_tr_b16 v[56:57], v237 offset:0
    ds_read_b64_tr_b16 v[58:59], v237 offset:2048
    ds_read_b64_tr_b16 v[60:61], v238 offset:0
    v_mfma_f32_16x16x32_bf16 v[24:27], v[72:75], v[68:71], v[24:27]
    ds_read_b64_tr_b16 v[62:63], v238 offset:2048
    ds_read_b128 v[44:47], v232 offset:2048
    v_mfma_f32_16x16x32_bf16 v[28:31], v[76:79], v[68:71], v[28:31]
    v_mfma_f32_16x16x32_bf16 v[32:35], v[80:83], v[68:71], v[32:35]
    s_add_u32 s52, s52, 24576
    s_cmp_ge_u32 s52, 147456
    s_cselect_b32 s52, 0, s52
    v_mfma_f32_16x16x32_bf16 v[36:39], v[84:87], v[68:71], v[36:39]
    s_waitcnt lgkmcnt(0)
    v_mfma_f32_16x16x32_bf16 v[8:11], v[48:51], v[40:43], v[8:11]
    ds_read_b128 v[64:67], v232 offset:1024
    ds_read_b64_tr_b16 v[72:73], v235 offset:4096
    v_mfma_f32_16x16x32_bf16 v[12:15], v[52:55], v[40:43], v[12:15]
    ds_read_b64_tr_b16 v[74:75], v235 offset:6144
    ds_read_b64_tr_b16 v[76:77], v236 offset:4096
    v_mfma_f32_16x16x32_bf16 v[16:19], v[56:59], v[40:43], v[16:19]
    ds_read_b64_tr_b16 v[78:79], v236 offset:6144
    ds_read_b64_tr_b16 v[80:81], v237 offset:4096
    v_mfma_f32_16x16x32_bf16 v[20:23], v[60:63], v[40:43], v[20:23]
    s_sub_u32 s54, s54, 1
    ds_read_b64_tr_b16 v[82:83], v237 offset:6144
    ds_read_b64_tr_b16 v[84:85], v238 offset:4096
    v_mfma_f32_16x16x32_bf16 v[24:27], v[48:51], v[44:47], v[24:27]
    s_cbranch_scc0 M_Q_loop1
    ds_read_b64_tr_b16 v[86:87], v238 offset:6144
    ds_read_b128 v[68:71], v232 offset:3072
    v_mfma_f32_16x16x32_bf16 v[28:31], v[52:55], v[44:47], v[28:31]
    v_add_u32 v232, s52, v233
    v_add_u32 v235, s52, v239
    v_mfma_f32_16x16x32_bf16 v[32:35], v[56:59], v[44:47], v[32:35]
    v_add_u32 v236, s52, v240
    v_add_u32 v237, s52, v241
    v_mfma_f32_16x16x32_bf16 v[36:39], v[60:63], v[44:47], v[36:39]
    v_add_u32 v238, s52, v242
    s_waitcnt lgkmcnt(0)
    v_mfma_f32_16x16x32_bf16 v[8:11], v[72:75], v[64:67], v[8:11]
    s_barrier
    v_mfma_f32_16x16x32_bf16 v[12:15], v[76:79], v[64:67], v[12:15]
    ds_read_b128 v[40:43], v232 offset:0
    ds_read_b64_tr_b16 v[48:49], v235 offset:0
    ds_read_b64_tr_b16 v[50:51], v235 offset:2048
    v_mfma_f32_16x16x32_bf16 v[16:19], v[80:83], v[64:67], v[16:19]
    ds_read_b64_tr_b16 v[52:53], v236 offset:0
    ds_read_b64_tr_b16 v[54:55], v236 offset:2048
    v_mfma_f32_16x16x32_bf16 v[20:23], v[84:87], v[64:67], v[20:23]
    ds_read_b64_tr_b16 v[56:57], v237 offset:0
    ds_read_b64_tr_b16 v[58:59], v237 offset:2048
    ds_read_b64_tr_b16 v[60:61], v238 offset:0
    v_mfma_f32_16x16x32_bf16 v[24:27], v[72:75], v[68:71], v[24:27]
    ds_read_b64_tr_b16 v[62:63], v238 offset:2048
    ds_read_b128 v[44:47], v232 offset:2048
    v_mfma_f32_16x16x32_bf16 v[28:31], v[76:79], v[68:71], v[28:31]
    v_mfma_f32_16x16x32_bf16 v[32:35], v[80:83], v[68:71], v[32:35]
    s_add_u32 s52, s52, 24576
    s_cmp_ge_u32 s52, 147456
    s_cselect_b32 s52, 0, s52
    v_mfma_f32_16x16x32_bf16 v[36:39], v[84:87], v[68:71], v[36:39]
    s_waitcnt lgkmcnt(0)
    v_mfma_f32_16x16x32_bf16 v[8:11], v[48:51], v[40:43], v[8:11]
    ds_read_b128 v[64:67], v232 offset:1024
    ds_read_b64_tr_b16 v[72:73], v235 offset:4096
    v_mfma_f32_16x16x32_bf16 v[12:15], v[52:55], v[40:43], v[12:15]
    ds_read_b64_tr_b16 v[74:75], v235 offset:6144
    ds_read_b64_tr_b16 v[76:77], v236 offset:4096
    ds_read_b128 v[136:139], v199 offset:0
    v_mfma_f32_16x16x32_bf16 v[16:19], v[56:59], v[40:43], v[16:19]
    ds_read_b64_tr_b16 v[78:79], v236 offset:6144
    ds_read_b64_tr_b16 v[80:81], v237 offset:4096
    ds_read_b128 v[140:143], v199 offset:64
    v_mfma_f32_16x16x32_bf16 v[20:23], v[60:63], v[40:43], v[20:23]
    ds_read_b64_tr_b16 v[82:83], v237 offset:6144
    ds_read_b64_tr_b16 v[84:85], v238 offset:4096
    v_mfma_f32_16x16x32_bf16 v[24:27], v[48:51], v[44:47], v[24:27]
    ds_read_b64_tr_b16 v[86:87], v238 offset:6144
    ds_read_b128 v[68:71], v232 offset:3072
    ds_read_b128 v[144:147], v199 offset:128
    v_mfma_f32_16x16x32_bf16 v[28:31], v[52:55], v[44:47], v[28:31]
    v_add_u32 v232, s52, v233
    v_add_u32 v235, s52, v239
    v_mfma_f32_16x16x32_bf16 v[32:35], v[56:59], v[44:47], v[32:35]
    v_add_u32 v236, s52, v240
    v_add_u32 v237, s52, v241
    ds_read_b128 v[148:151], v199 offset:192
    v_mfma_f32_16x16x32_bf16 v[36:39], v[60:63], v[44:47], v[36:39]
    v_add_u32 v238, s52, v242
    s_waitcnt lgkmcnt(0)
    v_mfma_f32_16x16x32_bf16 v[8:11], v[72:75], v[64:67], v[8:11]
    s_barrier
    v_mfma_f32_16x16x32_bf16 v[12:15], v[76:79], v[64:67], v[12:15]
    ds_read_b128 v[40:43], v232 offset:0
    ds_read_b64_tr_b16 v[48:49], v235 offset:0
    ds_read_b64_tr_b16 v[50:51], v235 offset:2048
    ds_read_b128 v[152:155], v199 offset:256
    v_mfma_f32_16x16x32_bf16 v[16:19], v[80:83], v[64:67], v[16:19]
    ds_read_b64_tr_b16 v[52:53], v236 offset:0
    ds_read_b64_tr_b16 v[54:55], v236 offset:2048
    ds_read_b128 v[156:159], v199 offset:320
    v_mfma_f32_16x16x32_bf16 v[20:23], v[84:87], v[64:67], v[20:23]
    ds_read_b64_tr_b16 v[56:57], v237 offset:0
    ds_read_b64_tr_b16 v[58:59], v237 offset:2048
    ds_read_b64_tr_b16 v[60:61], v238 offset:0
    v_mfma_f32_16x16x32_bf16 v[24:27], v[72:75], v[68:71], v[24:27]
    ds_read_b64_tr_b16 v[62:63], v238 offset:2048
    ds_read_b128 v[44:47], v232 offset:2048
    ds_read_b128 v[160:163], v199 offset:384
    v_mfma_f32_16x16x32_bf16 v[28:31], v[76:79], v[68:71], v[28:31]
    v_mfma_f32_16x16x32_bf16 v[32:35], v[80:83], v[68:71], v[32:35]
    s_add_u32 s52, s52, 24576
    s_cmp_ge_u32 s52, 147456
    s_cselect_b32 s52, 0, s52
    ds_read_b128 v[164:167], v199 offset:448
    v_mfma_f32_16x16x32_bf16 v[36:39], v[84:87], v[68:71], v[36:39]
    s_waitcnt lgkmcnt(0)
    v_mfma_f32_16x16x32_bf16 v[8:11], v[48:51], v[40:43], v[8:11]
    ds_read_b128 v[64:67], v232 offset:1024
    ds_read_b64_tr_b16 v[72:73], v235 offset:4096
    v_mfma_f32_16x16x32_bf16 v[12:15], v[52:55], v[40:43], v[12:15]
    ds_read_b64_tr_b16 v[74:75], v235 offset:6144
    ds_read_b64_tr_b16 v[76:77], v236 offset:4096
    ds_read_b128 v[168:171], v199 offset:512
    v_mfma_f32_16x16x32_bf16 v[16:19], v[56:59], v[40:43], v[16:19]
    ds_read_b64_tr_b16 v[78:79], v236 offset:6144
    ds_read_b64_tr_b16 v[80:81], v237 offset:4096
    ds_read_b128 v[172:175], v199 offset:576
    v_mfma_f32_16x16x32_bf16 v[20:23], v[60:63], v[40:43], v[20:23]
    ds_read_b64_tr_b16 v[82:83], v237 offset:6144
    ds_read_b64_tr_b16 v[84:85], v238 offset:4096
    v_mfma_f32_16x16x32_bf16 v[24:27], v[48:51], v[44:47], v[24:27]
    ds_read_b64_tr_b16 v[86:87], v238 offset:6144
    ds_read_b128 v[68:71], v232 offset:3072
    ds_read_b128 v[176:179], v199 offset:640
    v_mfma_f32_16x16x32_bf16 v[28:31], v[52:55], v[44:47], v[28:31]
    v_add_u32 v232, s52, v233
    v_add_u32 v235, s52, v239
    v_mfma_f32_16x16x32_bf16 v[32:35], v[56:59], v[44:47], v[32:35]
    v_add_u32 v236, s52, v240
    v_add_u32 v237, s52, v241
    ds_read_b128 v[180:183], v199 offset:704
    v_mfma_f32_16x16x32_bf16 v[36:39], v[60:63], v[44:47], v[36:39]
    v_add_u32 v238, s52, v242
    s_waitcnt lgkmcnt(0)
    v_mfma_f32_16x16x32_bf16 v[8:11], v[72:75], v[64:67], v[8:11]
    s_barrier
    v_mfma_f32_16x16x32_bf16 v[12:15], v[76:79], v[64:67], v[12:15]
    ds_read_b128 v[40:43], v232 offset:0
    ds_read_b64_tr_b16 v[48:49], v235 offset:0
    ds_read_b64_tr_b16 v[50:51], v235 offset:2048
    v_mfma_f32_16x16x32_bf16 v[16:19], v[80:83], v[64:67], v[16:19]
    ds_read_b64_tr_b16 v[52:53], v236 offset:0
    ds_read_b64_tr_b16 v[54:55], v236 offset:2048
    v_mfma_f32_16x16x32_bf16 v[20:23], v[84:87], v[64:67], v[20:23]
    ds_read_b64_tr_b16 v[56:57], v237 offset:0
    ds_read_b64_tr_b16 v[58:59], v237 offset:2048
    ds_read_b64_tr_b16 v[60:61], v238 offset:0
    v_mfma_f32_16x16x32_bf16 v[24:27], v[72:75], v[68:71], v[24:27]
    ds_read_b64_tr_b16 v[62:63], v238 offset:2048
    ds_read_b128 v[44:47], v232 offset:2048
    v_mfma_f32_16x16x32_bf16 v[28:31], v[76:79], v[68:71], v[28:31]
    v_mfma_f32_16x16x32_bf16 v[32:35], v[80:83], v[68:71], v[32:35]
    s_add_u32 s52, s52, 24576
    s_cmp_ge_u32 s52, 147456
    s_cselect_b32 s52, 0, s52
    v_mfma_f32_16x16x32_bf16 v[36:39], v[84:87], v[68:71], v[36:39]
    s_waitcnt lgkmcnt(0)
    v_mfma_f32_16x16x32_bf16 v[8:11], v[48:51], v[40:43], v[8:11]
    ds_read_b128 v[64:67], v232 offset:1024
    ds_read_b64_tr_b16 v[72:73], v235 offset:4096
    v_mfma_f32_16x16x32_bf16 v[12:15], v[52:55], v[40:43], v[12:15]
    ds_read_b64_tr_b16 v[74:75], v235 offset:6144
    ds_read_b64_tr_b16 v[76:77], v236 offset:4096
    v_mfma_f32_16x16x32_bf16 v[16:19], v[56:59], v[40:43], v[16:19]
    ds_read_b64_tr_b16 v[78:79], v236 offset:6144
    ds_read_b64_tr_b16 v[80:81], v237 offset:4096
    v_mfma_f32_16x16x32_bf16 v[20:23], v[60:63], v[40:43], v[20:23]
    ds_read_b64_tr_b16 v[82:83], v237 offset:6144
    ds_read_b64_tr_b16 v[84:85], v238 offset:4096
    v_mfma_f32_16x16x32_bf16 v[24:27], v[48:51], v[44:47], v[24:27]
    ds_read_b64_tr_b16 v[86:87], v238 offset:6144
    ds_read_b128 v[68:71], v232 offset:3072
    v_mfma_f32_16x16x32_bf16 v[28:31], v[52:55], v[44:47], v[28:31]
    v_mfma_f32_16x16x32_bf16 v[32:35], v[56:59], v[44:47], v[32:35]
    v_mfma_f32_16x16x32_bf16 v[36:39], v[60:63], v[44:47], v[36:39]
    s_waitcnt lgkmcnt(0)
    v_mfma_f32_16x16x32_bf16 v[8:11], v[72:75], v[64:67], v[8:11]
    s_barrier
    v_mfma_f32_16x16x32_bf16 v[12:15], v[76:79], v[64:67], v[12:15]
    v_mfma_f32_16x16x32_bf16 v[16:19], v[80:83], v[64:67], v[16:19]
    v_mfma_f32_16x16x32_bf16 v[20:23], v[84:87], v[64:67], v[20:23]
    v_mfma_f32_16x16x32_bf16 v[24:27], v[72:75], v[68:71], v[24:27]
    v_mfma_f32_16x16x32_bf16 v[28:31], v[76:79], v[68:71], v[28:31]
    v_mfma_f32_16x16x32_bf16 v[32:35], v[80:83], v[68:71], v[32:35]
    v_mfma_f32_16x16x32_bf16 v[36:39], v[84:87], v[68:71], v[36:39]
    v_pk_fma_f32 v[104:105], v[8:9], v[136:137], v[104:105]
    v_pk_fma_f32 v[106:107], v[10:11], v[138:139], v[106:107]
    v_pk_fma_f32 v[108:109], v[12:13], v[140:141], v[108:109]
    v_pk_fma_f32 v[110:111], v[14:15], v[142:143], v[110:111]
    v_pk_fma_f32 v[112:113], v[16:17], v[144:145], v[112:113]
    v_pk_fma_f32 v[114:115], v[18:19], v[146:147], v[114:115]
    v_pk_fma_f32 v[116:117], v[20:21], v[148:149], v[116:117]
    v_pk_fma_f32 v[118:119], v[22:23], v[150:151], v[118:119]
    v_pk_fma_f32 v[120:121], v[24:25], v[136:137], v[120:121]
    v_pk_fma_f32 v[122:123], v[26:27], v[138:139], v[122:123]
    v_pk_fma_f32 v[124:125], v[28:29], v[140:141], v[124:125]
    v_pk_fma_f32 v[126:127], v[30:31], v[142:143], v[126:127]
    v_pk_fma_f32 v[128:129], v[32:33], v[144:145], v[128:129]
    v_pk_fma_f32 v[130:131], v[34:35], v[146:147], v[130:131]
    v_pk_fma_f32 v[132:133], v[36:37], v[148:149], v[132:133]
    v_pk_fma_f32 v[134:135], v[38:39], v[150:151], v[134:135]
    v_cvt_pk_bf16_f32 v88, v104, v105
    v_cvt_pk_bf16_f32 v89, v106, v107
    v_cvt_pk_bf16_f32 v90, v108, v109
    v_cvt_pk_bf16_f32 v91, v110, v111
    v_cvt_pk_bf16_f32 v92, v112, v113
    v_cvt_pk_bf16_f32 v93, v114, v115
    v_cvt_pk_bf16_f32 v94, v116, v117
    v_cvt_pk_bf16_f32 v95, v118, v119
    v_cvt_pk_bf16_f32 v96, v120, v121
    v_cvt_pk_bf16_f32 v97, v122, v123
    v_cvt_pk_bf16_f32 v98, v124, v125
    v_cvt_pk_bf16_f32 v99, v126, v127
    v_cvt_pk_bf16_f32 v100, v128, v129
    v_cvt_pk_bf16_f32 v101, v130, v131
    v_cvt_pk_bf16_f32 v102, v132, v133
    v_cvt_pk_bf16_f32 v103, v134, v135
    v_lshlrev_b32 v104, 16, v88
    v_and_b32 v105, 0xffff0000, v88
    v_lshlrev_b32 v106, 16, v89
    v_and_b32 v107, 0xffff0000, v89
    v_lshlrev_b32 v108, 16, v90
    v_and_b32 v109, 0xffff0000, v90
    v_lshlrev_b32 v110, 16, v91
    v_and_b32 v111, 0xffff0000, v91
    v_lshlrev_b32 v112, 16, v92
    v_and_b32 v113, 0xffff0000, v92
    v_lshlrev_b32 v114, 16, v93
    v_and_b32 v115, 0xffff0000, v93
    v_lshlrev_b32 v116, 16, v94
    v_and_b32 v117, 0xffff0000, v94
    v_lshlrev_b32 v118, 16, v95
    v_and_b32 v119, 0xffff0000, v95
    v_lshlrev_b32 v120, 16, v96
    v_and_b32 v121, 0xffff0000, v96
    v_lshlrev_b32 v122, 16, v97
    v_and_b32 v123, 0xffff0000, v97
    v_lshlrev_b32 v124, 16, v98
    v_and_b32 v125, 0xffff0000, v98
    v_lshlrev_b32 v126, 16, v99
    v_and_b32 v127, 0xffff0000, v99
    v_lshlrev_b32 v128, 16, v100
    v_and_b32 v129, 0xffff0000, v100
    v_lshlrev_b32 v130, 16, v101
    v_and_b32 v131, 0xffff0000, v101
    v_lshlrev_b32 v132, 16, v102
    v_and_b32 v133, 0xffff0000, v102
    v_lshlrev_b32 v134, 16, v103
    v_and_b32 v135, 0xffff0000, v103
    v_pk_add_f32 v[40:41], v[104:105], v[106:107]
    v_pk_mul_f32 v[44:45], v[104:105], v[104:105]
    v_pk_add_f32 v[42:43], v[120:121], v[122:123]
    v_pk_mul_f32 v[46:47], v[120:121], v[120:121]
    v_pk_fma_f32 v[44:45], v[106:107], v[106:107], v[44:45]
    v_pk_fma_f32 v[46:47], v[122:123], v[122:123], v[46:47]
    v_pk_add_f32 v[40:41], v[40:41], v[108:109]
    v_pk_fma_f32 v[44:45], v[108:109], v[108:109], v[44:45]
    v_pk_add_f32 v[42:43], v[42:43], v[124:125]
    v_pk_fma_f32 v[46:47], v[124:125], v[124:125], v[46:47]
    v_pk_add_f32 v[40:41], v[40:41], v[110:111]
    v_pk_fma_f32 v[44:45], v[110:111], v[110:111], v[44:45]
    v_pk_add_f32 v[42:43], v[42:43], v[126:127]
    v_pk_fma_f32 v[46:47], v[126:127], v[126:127], v[46:47]
    v_pk_add_f32 v[40:41], v[40:41], v[112:113]
    v_pk_fma_f32 v[44:45], v[112:113], v[112:113], v[44:45]
    v_pk_add_f32 v[42:43], v[42:43], v[128:129]
    v_pk_fma_f32 v[46:47], v[128:129], v[128:129], v[46:47]
    v_pk_add_f32 v[40:41], v[40:41], v[114:115]
    v_pk_fma_f32 v[44:45], v[114:115], v[114:115], v[44:45]
    v_pk_add_f32 v[42:43], v[42:43], v[130:131]
    v_pk_fma_f32 v[46:47], v[130:131], v[130:131], v[46:47]
    v_pk_add_f32 v[40:41], v[40:41], v[116:117]
    v_pk_fma_f32 v[44:45], v[116:117], v[116:117], v[44:45]
    v_pk_add_f32 v[42:43], v[42:43], v[132:133]
    v_pk_fma_f32 v[46:47], v[132:133], v[132:133], v[46:47]
    v_pk_add_f32 v[40:41], v[40:41], v[118:119]
    v_pk_fma_f32 v[44:45], v[118:119], v[118:119], v[44:45]
    v_pk_add_f32 v[42:43], v[42:43], v[134:135]
    v_pk_fma_f32 v[46:47], v[134:135], v[134:135], v[46:47]
    v_add_f32 v40, v40, v41
    v_add_f32 v42, v42, v43
    v_add_f32 v44, v44, v45
    v_add_f32 v46, v46, v47
    v_permlane16_swap_b32 v40, v42
    s_nop 0
    v_permlane16_swap_b32 v44, v46
    v_add_f32 v48, v40, v42
    v_add_f32 v49, v44, v46
    v_mov_b32 v50, v48
    v_mov_b32 v51, v49
    s_nop 0
    v_permlane32_swap_b32 v48, v50
    v_permlane32_swap_b32 v49, v51
    v_add_f32 v48, v48, v50
    v_add_f32 v49, v49, v51
    s_mov_b32 exec_hi, 0
    buffer_store_dwordx2 v[48:49], v198, s[28:31], s76 offen sc1
    s_mov_b32 exec_hi, -1
    buffer_load_dwordx2 v[56:57], v198, s[28:31], 0 offen offset:0 sc1
    buffer_load_dwordx2 v[58:59], v198, s[28:31], 0 offen offset:512 sc1
    buffer_load_dwordx2 v[60:61], v198, s[28:31], 0 offen offset:1024 sc1
    buffer_load_dwordx2 v[62:63], v198, s[28:31], 0 offen offset:1536 sc1
    buffer_load_dwordx2 v[64:65], v198, s[28:31], 0 offen offset:2048 sc1
    buffer_load_dwordx2 v[66:67], v198, s[28:31], 0 offen offset:2560 sc1
    buffer_load_dwordx2 v[68:69], v198, s[28:31], 0 offen offset:3072 sc1
    buffer_load_dwordx2 v[70:71], v198, s[28:31], 0 offen offset:3584 sc1
    s_waitcnt vmcnt(0)
    s_mov_b32 s3, 0x40000
M_sp_chk:
    v_cmp_eq_u32 s[80:81], -1, v57
    v_cmp_eq_u32 s[82:83], -1, v59
    v_cmp_eq_u32 s[84:85], -1, v61
    v_cmp_eq_u32 s[86:87], -1, v63
    v_cmp_eq_u32 s[88:89], -1, v65
    v_cmp_eq_u32 s[90:91], -1, v67
    v_cmp_eq_u32 s[92:93], -1, v69
    v_cmp_eq_u32 s[94:95], -1, v71
    v_max3_u32 v52, v57, v59, v61
    v_max3_u32 v53, v63, v65, v67
    v_max3_u32 v52, v52, v69, v71
    v_max_u32 v52, v52, v53
    v_cmp_eq_u32 vcc, -1, v52
    s_nop 4
    s_cbranch_vccz M_sp_ok
    s_sub_u32 s3, s3, 1
    s_cbranch_scc1 M_sp_ok
    s_mov_b64 exec, s[80:81]
    buffer_load_dwordx2 v[56:57], v198, s[28:31], 0 offen offset:0 sc1
    s_mov_b64 exec, s[82:83]
    buffer_load_dwordx2 v[58:59], v198, s[28:31], 0 offen offset:512 sc1
    s_mov_b64 exec, s[84:85]
    buffer_load_dwordx2 v[60:61], v198, s[28:31], 0 offen offset:1024 sc1
    s_mov_b64 exec, s[86:87]
    buffer_load_dwordx2 v[62:63], v198, s[28:31], 0 offen offset:1536 sc1
    s_mov_b64 exec, s[88:89]
    buffer_load_dwordx2 v[64:65], v198, s[28:31], 0 offen offset:2048 sc1
    s_mov_b64 exec, s[90:91]
    buffer_load_dwordx2 v[66:67], v198, s[28:31], 0 offen offset:2560 sc1
    s_mov_b64 exec, s[92:93]
    buffer_load_dwordx2 v[68:69], v198, s[28:31], 0 offen offset:3072 sc1
    s_mov_b64 exec, s[94:95]
    buffer_load_dwordx2 v[70:71], v198, s[28:31], 0 offen offset:3584 sc1
    s_mov_b64 exec, -1
    s_waitcnt vmcnt(0)
    s_branch M_sp_chk
M_sp_ok:
    buffer_store_dwordx4 v[88:91], v197, s[28:31], s72 offen offset:0 sc1
    buffer_store_dwordx4 v[92:95], v197, s[28:31], s72 offen offset:1024 sc1
    buffer_store_dwordx4 v[96:99], v197, s[28:31], s73 offen offset:0 sc1
    buffer_store_dwordx4 v[100:103], v197, s[28:31], s73 offen offset:1024 sc1
    v_pk_add_f32 v[56:57], v[56:57], v[58:59]
    v_pk_add_f32 v[60:61], v[60:61], v[62:63]
    v_pk_add_f32 v[64:65], v[64:65], v[66:67]
    v_pk_add_f32 v[68:69], v[68:69], v[70:71]
    v_pk_add_f32 v[56:57], v[56:57], v[60:61]
    v_pk_add_f32 v[64:65], v[64:65], v[68:69]
    v_pk_add_f32 v[56:57], v[56:57], v[64:65]
    v_mov_b32 v50, v56
    v_mov_b32 v51, v57
    s_nop 0
    v_permlane32_swap_b32 v56, v50
    v_permlane32_swap_b32 v57, v51
    v_add_f32 v56, v56, v50
    v_add_f32 v57, v57, v51
    v_mul_f32 v56, 0x3a800000, v56
    v_mul_f32 v57, 0x3a800000, v57
    v_fma_f32 v57, -v56, v56, v57
    v_max_f32 v57, 0, v57
    v_cvt_pk_bf16_f32 v50, v56, v57
    v_lshlrev_b32 v56, 16, v50
    v_and_b32 v57, 0xffff0000, v50
    v_add_f32 v57, 0x3727c5ac, v57
    v_cvt_pk_bf16_f32 v50, v57, v57
    v_lshlrev_b32 v57, 16, v50
    v_sqrt_f32 v57, v57
    s_nop 0
    v_cvt_pk_bf16_f32 v50, v57, v57
    v_lshlrev_b32 v57, 16, v50
    v_rcp_f32 v40, v57
    s_nop 0
    v_mul_f32 v44, -v56, v40
    v_mov_b32 v42, v40
    v_mov_b32 v46, v44
    s_nop 0
    v_permlane16_swap_b32 v40, v42
    v_permlane16_swap_b32 v44, v46
    v_pk_fma_f32 v[104:105], v[104:105], v[40:41], v[44:45] op_sel_hi:[1,0,0]
    v_pk_fma_f32 v[106:107], v[106:107], v[40:41], v[44:45] op_sel_hi:[1,0,0]
    v_pk_fma_f32 v[108:109], v[108:109], v[40:41], v[44:45] op_sel_hi:[1,0,0]
    v_pk_fma_f32 v[110:111], v[110:111], v[40:41], v[44:45] op_sel_hi:[1,0,0]
    v_pk_fma_f32 v[112:113], v[112:113], v[40:41], v[44:45] op_sel_hi:[1,0,0]
    v_pk_fma_f32 v[114:115], v[114:115], v[40:41], v[44:45] op_sel_hi:[1,0,0]
    v_pk_fma_f32 v[116:117], v[116:117], v[40:41], v[44:45] op_sel_hi:[1,0,0]
    v_pk_fma_f32 v[118:119], v[118:119], v[40:41], v[44:45] op_sel_hi:[1,0,0]
    v_pk_fma_f32 v[104:105], v[104:105], v[168:169], v[152:153]
    v_pk_fma_f32 v[106:107], v[106:107], v[170:171], v[154:155]
    v_pk_fma_f32 v[108:109], v[108:109], v[172:173], v[156:157]
    v_pk_fma_f32 v[110:111], v[110:111], v[174:175], v[158:159]
    v_pk_fma_f32 v[112:113], v[112:113], v[176:177], v[160:161]
    v_pk_fma_f32 v[114:115], v[114:115], v[178:179], v[162:163]
    v_pk_fma_f32 v[116:117], v[116:117], v[180:181], v[164:165]
    v_pk_fma_f32 v[118:119], v[118:119], v[182:183], v[166:167]
    v_cvt_pk_bf16_f32 v72, v104, v105
    v_cvt_pk_bf16_f32 v73, v106, v107
    v_cvt_pk_bf16_f32 v74, v108, v109
    v_cvt_pk_bf16_f32 v75, v110, v111
    buffer_store_dwordx4 v[72:75], v197, s[28:31], s74 offen offset:0 sc1
    ds_write_b128 v233, v[72:75] offset:0
    v_cvt_pk_bf16_f32 v76, v112, v113
    v_cvt_pk_bf16_f32 v77, v114, v115
    v_cvt_pk_bf16_f32 v78, v116, v117
    v_cvt_pk_bf16_f32 v79, v118, v119
    buffer_store_dwordx4 v[76:79], v197, s[28:31], s74 offen offset:1024 sc1
    ds_write_b128 v233, v[76:79] offset:1024
    v_pk_fma_f32 v[120:121], v[120:121], v[42:43], v[46:47] op_sel_hi:[1,0,0]
    v_pk_fma_f32 v[122:123], v[122:123], v[42:43], v[46:47] op_sel_hi:[1,0,0]
    v_pk_fma_f32 v[124:125], v[124:125], v[42:43], v[46:47] op_sel_hi:[1,0,0]
    v_pk_fma_f32 v[126:127], v[126:127], v[42:43], v[46:47] op_sel_hi:[1,0,0]
    v_pk_fma_f32 v[128:129], v[128:129], v[42:43], v[46:47] op_sel_hi:[1,0,0]
    v_pk_fma_f32 v[130:131], v[130:131], v[42:43], v[46:47] op_sel_hi:[1,0,0]
    v_pk_fma_f32 v[132:133], v[132:133], v[42:43], v[46:47] op_sel_hi:[1,0,0]
    v_pk_fma_f32 v[134:135], v[134:135], v[42:43], v[46:47] op_sel_hi:[1,0,0]
    v_pk_fma_f32 v[120:121], v[120:121], v[168:169], v[152:153]
    v_pk_fma_f32 v[122:123], v[122:123], v[170:171], v[154:155]
    v_pk_fma_f32 v[124:125], v[124:125], v[172:173], v[156:157]
    v_pk_fma_f32 v[126:127], v[126:127], v[174:175], v[158:159]
    v_pk_fma_f32 v[128:129], v[128:129], v[176:177], v[160:161]
    v_pk_fma_f32 v[130:131], v[130:131], v[178:179], v[162:163]
    v_pk_fma_f32 v[132:133], v[132:133], v[180:181], v[164:165]
    v_pk_fma_f32 v[134:135], v[134:135], v[182:183], v[166:167]
    v_cvt_pk_bf16_f32 v80, v120, v121
    v_cvt_pk_bf16_f32 v81, v122, v123
    v_cvt_pk_bf16_f32 v82, v124, v125
    v_cvt_pk_bf16_f32 v83, v126, v127
    buffer_store_dwordx4 v[80:83], v197, s[28:31], s75 offen offset:0 sc1
    ds_write_b128 v233, v[80:83] offset:2048
    v_cvt_pk_bf16_f32 v84, v128, v129
    v_cvt_pk_bf16_f32 v85, v130, v131
    v_cvt_pk_bf16_f32 v86, v132, v133
    v_cvt_pk_bf16_f32 v87, v134, v135
    buffer_store_dwordx4 v[84:87], v197, s[28:31], s75 offen offset:1024 sc1
    ds_write_b128 v233, v[84:87] offset:3072
    s_waitcnt lgkmcnt(0)
    s_barrier
    s_and_b32 s57, s58, 15
    s_lshr_b64 s[58:59], s[58:59], 4
    s_lshl_b32 s56, s57, 11
    s_mul_i32 s57, s57, 0x70000
    s_add_u32 s53, s53, 49152
    s_cmp_ge_u32 s53, s61
    s_cselect_b32 s53, s60, s53
    s_and_b32 s57, s58, 15
    s_lshr_b64 s[58:59], s[58:59], 4
    s_lshl_b32 s56, s57, 11
    s_mul_i32 s57, s57, 0x70000
    s_add_u32 m0, s53, 16384
    s_nop 0
    buffer_load_dwordx4 v208, s[32:35], s57 offen offset:0 lds
    buffer_load_dwordx4 v209, s[32:35], s57 offen offset:1024 lds
    buffer_load_dwordx4 v210, s[32:35], s57 offen offset:2048 lds
    buffer_load_dwordx4 v211, s[32:35], s57 offen offset:3072 lds
    s_add_u32 m0, s53, 32768
    s_nop 0
    buffer_load_dwordx4 v208, s[36:39], s57 offen offset:0 lds
    buffer_load_dwordx4 v209, s[36:39], s57 offen offset:1024 lds
    buffer_load_dwordx4 v210, s[36:39], s57 offen offset:2048 lds
    buffer_load_dwordx4 v211, s[36:39], s57 offen offset:3072 lds
    s_add_u32 s53, s53, 49152
    s_cmp_ge_u32 s53, s61
    s_cselect_b32 s53, s60, s53
    s_lshl_b32 s60, s44, 12
    s_add_u32 s61, s60, 147456
    s_add_u32 s53, s60, 0
    s_bfe_u32 s66, s2, 0x30003
    s_lshr_b32 s55, s2, 6
    s_add_u32 s66, s66, s55
    s_and_b32 s66, s66, 3
    s_mov_b32 s58, 0x76453210
    s_mov_b32 s59, 0xfecdba89
    s_cmp_eq_u32 s66, 1
    s_cselect_b32 s58, 0x75643120, s58
    s_cselect_b32 s59, 0xfdecb9a8, s59
    s_cmp_eq_u32 s66, 2
    s_cselect_b32 s58, 0x67542310, s58
    s_cselect_b32 s59, 0xefdcab98, s59
    s_cmp_eq_u32 s66, 3
    s_cselect_b32 s58, 0x86534210, s58
    s_cselect_b32 s59, 0xfedbca97, s59
    s_lshl_b32 s55, s48, 2
    s_lshr_b64 s[56:57], s[58:59], s55
    s_and_b32 s55, s56, 15
    s_lshl_b32 s55, s55, 2
    s_lshl_b64 s[56:57], 15, s55
    s_andn2_b64 s[58:59], s[58:59], s[56:57]
    s_or_b32 s58, s58, s48
    s_mov_b32 s32, s12
    s_mov_b32 s33, s13
    s_mov_b32 s34, 0x700000
    s_mov_b32 s35, 0x20000
    s_mov_b32 s36, s14
    s_mov_b32 s37, s15
    s_mov_b32 s38, 0x700000
    s_mov_b32 s39, 0x20000
    s_lshl_b32 s68, s47, 9
    s_add_u32 s68, s68, 0x56000
    s_add_u32 s62, s26, s68
    s_addc_u32 s63, s27, 0
    s_lshr_b32 s68, s48, 2
    s_lshl_b32 s68, s68, 7
    v_mov_b32 v2, 1
    v_mov_b32 v5, 148488
    s_waitcnt vmcnt(8)
    s_mov_b64 exec, 1
    ds_add_rtn_u32 v245, v5, v2
    s_mov_b64 exec, -1
    s_mov_b32 s1, 1
    s_mov_b32 s3, 0x40000
    s_waitcnt lgkmcnt(0)
    v_readfirstlane_b32 s64, v245
    s_nop 3
    s_cmp_lg_u32 s64, 3
    s_cbranch_scc1 M_ph_ok
    s_atomic_add s1, s[62:63], 0
    s_atomic_add s1, s[62:63], 128
    s_atomic_add s1, s[62:63], 256
    s_atomic_add s1, s[62:63], 384
M_ph_chk:
    s_load_dword s64, s[62:63], s68 glc
    s_sub_u32 s3, s3, 1
    s_cselect_b32 s65, 0, 16
    s_waitcnt lgkmcnt(0)
    s_cmp_lt_u32 s64, s65
    s_cbranch_scc1 M_ph_chk
M_ph_ok:
    s_barrier
    s_setprio 0
    s_and_b32 s57, s58, 15
    s_lshr_b64 s[58:59], s[58:59], 4
    s_lshl_b32 s56, s57, 11
    s_mul_i32 s57, s57, 0x70000
    s_add_u32 s53, s53, 49152
    s_cmp_ge_u32 s53, s61
    s_cselect_b32 s53, s60, s53
    s_and_b32 s57, s58, 15
    s_lshr_b64 s[58:59], s[58:59], 4
    s_lshl_b32 s56, s57, 11
    s_mul_i32 s57, s57, 0x70000
    s_mov_b32 m0, s53
    s_nop 0
    buffer_load_dwordx4 v206, s[28:31], s56 offen offset:0 lds
    buffer_load_dwordx4 v206, s[28:31], s56 offen offset:1024 lds
    buffer_load_dwordx4 v207, s[28:31], s56 offen offset:2048 lds
    buffer_load_dwordx4 v207, s[28:31], s56 offen offset:3072 lds
    s_add_u32 s53, s53, 49152
    s_cmp_ge_u32 s53, s61
    s_cselect_b32 s53, s60, s53
    s_and_b32 s57, s58, 15
    s_lshr_b64 s[58:59], s[58:59], 4
    s_lshl_b32 s56, s57, 11
    s_mul_i32 s57, s57, 0x70000
    s_add_u32 m0, s53, 16384
    s_nop 0
    buffer_load_dwordx4 v208, s[32:35], s57 offen offset:0 lds
    buffer_load_dwordx4 v209, s[32:35], s57 offen offset:1024 lds
    buffer_load_dwordx4 v210, s[32:35], s57 offen offset:2048 lds
    buffer_load_dwordx4 v211, s[32:35], s57 offen offset:3072 lds
    s_add_u32 m0, s53, 32768
    s_nop 0
    buffer_load_dwordx4 v208, s[36:39], s57 offen offset:0 lds
    buffer_load_dwordx4 v209, s[36:39], s57 offen offset:1024 lds
    buffer_load_dwordx4 v210, s[36:39], s57 offen offset:2048 lds
    buffer_load_dwordx4 v211, s[36:39], s57 offen offset:3072 lds
    s_mov_b32 m0, s53
    s_nop 0
    buffer_load_dwordx4 v206, s[28:31], s56 offen offset:0 lds
    buffer_load_dwordx4 v206, s[28:31], s56 offen offset:1024 lds
    buffer_load_dwordx4 v207, s[28:31], s56 offen offset:2048 lds
    buffer_load_dwordx4 v207, s[28:31], s56 offen offset:3072 lds
    s_add_u32 s53, s53, 49152
    s_cmp_ge_u32 s53, s61
    s_cselect_b32 s53, s60, s53
    s_lshl_b32 s64, s45, 13
    v_lshl_add_u32 v233, v1, 4, s64
    v_lshrrev_b32 v2, 2, v1
    v_lshlrev_b32 v4, 8, v2
    v_and_b32 v5, 3, v1
    v_lshl_add_u32 v4, v5, 3, v4
    v_add_u32 v4, 16384, v4
    v_and_b32 v2, 7, v2
    s_lshl_b32 s64, s46, 2
    v_xor_b32 v2, s64, v2
    v_xor_b32 v3, 0, v2
    v_lshl_add_u32 v239, v3, 5, v4
    v_xor_b32 v3, 1, v2
    v_lshl_add_u32 v240, v3, 5, v4
    v_xor_b32 v3, 2, v2
    v_lshl_add_u32 v241, v3, 5, v4
    v_xor_b32 v3, 3, v2
    v_lshl_add_u32 v242, v3, 5, v4
    s_mov_b32 s52, 49152
    v_add_u32 v232, s52, v233
    v_add_u32 v235, s52, v239
    v_add_u32 v236, s52, v240
    v_add_u32 v237, s52, v241
    v_add_u32 v238, s52, v242
    s_lshl_b32 s64, s2, 2
    s_add_u32 s64, s64, s44
    s_mul_i32 s64, s64, 7168
    s_add_u32 s64, s64, 5248
    s_add_u32 s10, s12, s64
    s_addc_u32 s11, s13, 0
    s_add_u32 s24, s14, s64
    s_addc_u32 s25, s15, 0
    s_movk_i32 s54, 9
M_Q_loop2:
    s_waitcnt vmcnt(12)
    s_barrier
    s_and_b32 s57, s58, 15
    s_lshr_b64 s[58:59], s[58:59], 4
    s_lshl_b32 s56, s57, 11
    s_mul_i32 s57, s57, 0x70000
    s_add_u32 m0, s53, 16384
    s_nop 0
    buffer_load_dwordx4 v208, s[32:35], s57 offen offset:0 lds
    s_load_dword s99, s[10:11], 0
    buffer_load_dwordx4 v209, s[32:35], s57 offen offset:1024 lds
    buffer_load_dwordx4 v210, s[32:35], s57 offen offset:2048 lds
    s_load_dword s99, s[24:25], 0
    buffer_load_dwordx4 v211, s[32:35], s57 offen offset:3072 lds
    s_add_u32 m0, s53, 32768
    s_nop 0
    buffer_load_dwordx4 v208, s[36:39], s57 offen offset:0 lds
    s_load_dword s99, s[10:11], 64
    buffer_load_dwordx4 v209, s[36:39], s57 offen offset:1024 lds
    buffer_load_dwordx4 v210, s[36:39], s57 offen offset:2048 lds
    s_load_dword s99, s[24:25], 64
    buffer_load_dwordx4 v211, s[36:39], s57 offen offset:3072 lds
    s_mov_b32 m0, s53
    s_nop 0
    buffer_load_dwordx4 v206, s[28:31], s56 offen offset:0 lds
    s_load_dword s99, s[10:11], 128
    buffer_load_dwordx4 v206, s[28:31], s56 offen offset:1024 lds
    buffer_load_dwordx4 v207, s[28:31], s56 offen offset:2048 lds
    s_load_dword s99, s[24:25], 128
    buffer_load_dwordx4 v207, s[28:31], s56 offen offset:3072 lds
    s_add_u32 s53, s53, 49152
    s_cmp_ge_u32 s53, s61
    s_cselect_b32 s53, s60, s53
    s_add_u32 s10, s10, 192
    s_addc_u32 s11, s11, 0
    s_add_u32 s24, s24, 192
    s_addc_u32 s25, s25, 0
    s_sub_u32 s54, s54, 1
    s_cbranch_scc0 M_Q_loop2
    s_movk_i32 s54, 2
M_Q_loop3:
    s_waitcnt vmcnt(12)
    s_barrier
    s_and_b32 s57, s58, 15
    s_lshr_b64 s[58:59], s[58:59], 4
    s_lshl_b32 s56, s57, 11
    s_mul_i32 s57, s57, 0x70000
    s_add_u32 m0, s53, 16384
    s_nop 0
    buffer_load_dwordx4 v208, s[32:35], s57 offen offset:0 lds
    buffer_load_dwordx4 v209, s[32:35], s57 offen offset:1024 lds
    buffer_load_dwordx4 v210, s[32:35], s57 offen offset:2048 lds
    buffer_load_dwordx4 v211, s[32:35], s57 offen offset:3072 lds
    s_add_u32 m0, s53, 32768
    s_nop 0
    buffer_load_dwordx4 v208, s[36:39], s57 offen offset:0 lds
    buffer_load_dwordx4 v209, s[36:39], s57 offen offset:1024 lds
    buffer_load_dwordx4 v210, s[36:39], s57 offen offset:2048 lds
    buffer_load_dwordx4 v211, s[36:39], s57 offen offset:3072 lds
    s_mov_b32 m0, s53
    s_nop 0
    buffer_load_dwordx4 v206, s[28:31], s56 offen offset:0 lds
    buffer_load_dwordx4 v206, s[28:31], s56 offen offset:1024 lds
    buffer_load_dwordx4 v207, s[28:31], s56 offen offset:2048 lds
    buffer_load_dwordx4 v207, s[28:31], s56 offen offset:3072 lds
    s_add_u32 s53, s53, 49152
    s_cmp_ge_u32 s53, s61
    s_cselect_b32 s53, s60, s53
    s_sub_u32 s54, s54, 1
    s_cbranch_scc0 M_Q_loop3
    s_waitcnt vmcnt(12)
    s_barrier
    s_bfe_u32 s66, s2, 0x30003
    s_lshr_b32 s55, s2, 6
    s_add_u32 s66, s66, s55
    s_mul_i32 s55, s66, 11
    s_lshr_b32 s55, s55, 5
    s_mul_i32 s55, s55, 3
    s_sub_u32 s66, s66, s55
    s_mov_b32 s58, 0x67534201
    s_mov_b32 s59, 0xfecdb9a8
    s_cmp_eq_u32 s66, 1
    s_cselect_b32 s58, 0x86453120, s58
    s_cselect_b32 s59, 0xfdecab97, s59
    s_cmp_eq_u32 s66, 2
    s_cselect_b32 s58, 0x75642310, s58
    s_cselect_b32 s59, 0xefdbca89, s59
    v_or_b32 v206, s69, v206
    v_or_b32 v207, s69, v207
    s_and_b32 s57, s58, 15
    s_lshr_b64 s[58:59], s[58:59], 4
    s_lshl_b32 s56, s57, 11
    s_mul_i32 s57, s57, 0x70000
    s_add_u32 m0, s53, 16384
    s_nop 0
    buffer_load_dwordx4 v212, s[32:35], s57 offen offset:0 lds
    buffer_load_dwordx4 v213, s[32:35], s57 offen offset:1024 lds
    buffer_load_dwordx4 v214, s[32:35], s57 offen offset:2048 lds
    buffer_load_dwordx4 v215, s[32:35], s57 offen offset:3072 lds
    s_add_u32 m0, s53, 32768
    s_nop 0
    buffer_load_dwordx4 v212, s[36:39], s57 offen offset:0 lds
    buffer_load_dwordx4 v213, s[36:39], s57 offen offset:1024 lds
    buffer_load_dwordx4 v214, s[36:39], s57 offen offset:2048 lds
    buffer_load_dwordx4 v215, s[36:39], s57 offen offset:3072 lds
    s_mov_b32 m0, s53
    s_nop 0
    buffer_load_dwordx4 v206, s[28:31], s56 offen offset:0 lds
    buffer_load_dwordx4 v206, s[28:31], s56 offen offset:1024 lds
    buffer_load_dwordx4 v207, s[28:31], s56 offen offset:2048 lds
    buffer_load_dwordx4 v207, s[28:31], s56 offen offset:3072 lds
    s_add_u32 s53, s53, 49152
    s_cmp_ge_u32 s53, s61
    s_cselect_b32 s53, s60, s53
    s_waitcnt vmcnt(12)
    s_barrier
    s_and_b32 s57, s58, 15
    s_lshr_b64 s[58:59], s[58:59], 4
    s_lshl_b32 s56, s57, 11
    s_mul_i32 s57, s57, 0x70000
    s_add_u32 m0, s53, 16384
    s_nop 0
    buffer_load_dwordx4 v212, s[32:35], s57 offen offset:0 lds
    buffer_load_dwordx4 v213, s[32:35], s57 offen offset:1024 lds
    buffer_load_dwordx4 v214, s[32:35], s57 offen offset:2048 lds
    buffer_load_dwordx4 v215, s[32:35], s57 offen offset:3072 lds
    s_add_u32 m0, s53, 32768
    s_nop 0
    buffer_load_dwordx4 v212, s[36:39], s57 offen offset:0 lds
    buffer_load_dwordx4 v213, s[36:39], s57 offen offset:1024 lds
    buffer_load_dwordx4 v214, s[36:39], s57 offen offset:2048 lds
    buffer_load_dwordx4 v215, s[36:39], s57 offen offset:3072 lds
    s_mov_b32 m0, s53
    s_nop 0
    buffer_load_dwordx4 v206, s[28:31], s56 offen offset:0 lds
    buffer_load_dwordx4 v206, s[28:31], s56 offen offset:1024 lds
    buffer_load_dwordx4 v207, s[28:31], s56 offen offset:2048 lds
    buffer_load_dwordx4 v207, s[28:31], s56 offen offset:3072 lds
    s_add_u32 s53, s53, 49152
    s_cmp_ge_u32 s53, s61
    s_cselect_b32 s53, s60, s53
    s_waitcnt vmcnt(12)
    s_barrier
    s_cmp_lg_u32 s69, 0
    s_cbranch_scc1 M_Qidle
    ds_read_b128 v[136:139], v232 offset:0
    ds_read_b64_tr_b16 v[152:153], v235 offset:0
    ds_read_b64_tr_b16 v[154:155], v235 offset:4096
    ds_read_b64_tr_b16 v[156:157], v236 offset:0
    ds_read_b64_tr_b16 v[158:159], v236 offset:4096
    ds_read_b64_tr_b16 v[160:161], v237 offset:0
    ds_read_b64_tr_b16 v[162:163], v237 offset:4096
    ds_read_b64_tr_b16 v[164:165], v238 offset:0
    ds_read_b64_tr_b16 v[166:167], v238 offset:4096
    ds_read_b64_tr_b16 v[168:169], v235 offset:16384
    ds_read_b64_tr_b16 v[170:171], v235 offset:20480
    ds_read_b64_tr_b16 v[172:173], v236 offset:16384
    ds_read_b64_tr_b16 v[174:175], v236 offset:20480
    ds_read_b64_tr_b16 v[176:177], v237 offset:16384
    ds_read_b64_tr_b16 v[178:179], v237 offset:20480
    ds_read_b64_tr_b16 v[180:181], v238 offset:16384
    ds_read_b64_tr_b16 v[182:183], v238 offset:20480
    ds_read_b128 v[140:143], v232 offset:2048
    ds_read_b128 v[144:147], v232 offset:4096
    ds_read_b128 v[148:151], v232 offset:6144
    s_and_b32 s57, s58, 15
    s_lshr_b64 s[58:59], s[58:59], 4
    s_lshl_b32 s56, s57, 11
    s_mul_i32 s57, s57, 0x70000
    s_add_u32 m0, s53, 16384
    s_nop 0
    buffer_load_dwordx4 v212, s[32:35], s57 offen offset:0 lds
    buffer_load_dwordx4 v213, s[32:35], s57 offen offset:1024 lds
    buffer_load_dwordx4 v214, s[32:35], s57 offen offset:2048 lds
    buffer_load_dwordx4 v215, s[32:35], s57 offen offset:3072 lds
    s_add_u32 m0, s53, 32768
    s_nop 0
    buffer_load_dwordx4 v212, s[36:39], s57 offen offset:0 lds
    buffer_load_dwordx4 v213, s[36:39], s57 offen offset:1024 lds
    buffer_load_dwordx4 v214, s[36:39], s57 offen offset:2048 lds
    buffer_load_dwordx4 v215, s[36:39], s57 offen offset:3072 lds
    s_mov_b32 m0, s53
    s_nop 0
    buffer_load_dwordx4 v206, s[28:31], s56 offen offset:0 lds
    buffer_load_dwordx4 v206, s[28:31], s56 offen offset:1024 lds
    buffer_load_dwordx4 v207, s[28:31], s56 offen offset:2048 lds
    buffer_load_dwordx4 v207, s[28:31], s56 offen offset:3072 lds
    s_add_u32 s53, s53, 49152
    s_cmp_ge_u32 s53, s61
    s_cselect_b32 s53, s60, s53
    s_setprio 2
    s_add_u32 s52, s52, 49152
    s_cmp_ge_u32 s52, 147456
    s_cselect_b32 s52, 0, s52
    s_waitcnt lgkmcnt(0)
    v_mfma_f32_16x16x32_bf16 v[8:11], v[152:155], v[136:139], 0
    ds_read_b128 v[184:187], v232 offset:1024
    v_mfma_f32_16x16x32_bf16 v[12:15], v[156:159], v[136:139], 0
    ds_read_b64_tr_b16 v[200:201], v235 offset:8192
    v_mfma_f32_16x16x32_bf16 v[16:19], v[160:163], v[136:139], 0
    ds_read_b64_tr_b16 v[202:203], v235 offset:12288
    v_mfma_f32_16x16x32_bf16 v[20:23], v[164:167], v[136:139], 0
    ds_read_b64_tr_b16 v[204:205], v236 offset:8192
    v_mfma_f32_16x16x32_bf16 v[24:27], v[168:171], v[136:139], 0
    v_mfma_f32_16x16x32_bf16 v[28:31], v[172:175], v[136:139], 0
    ds_read_b64_tr_b16 v[206:207], v236 offset:12288
    v_mfma_f32_16x16x32_bf16 v[32:35], v[176:179], v[136:139], 0
    ds_read_b64_tr_b16 v[208:209], v237 offset:8192
    v_mfma_f32_16x16x32_bf16 v[36:39], v[180:183], v[136:139], 0
    ds_read_b64_tr_b16 v[210:211], v237 offset:12288
    v_mfma_f32_16x16x32_bf16 v[40:43], v[152:155], v[140:143], 0
    ds_read_b64_tr_b16 v[212:213], v238 offset:8192
    v_mfma_f32_16x16x32_bf16 v[44:47], v[156:159], v[140:143], 0
    v_mfma_f32_16x16x32_bf16 v[48:51], v[160:163], v[140:143], 0
    ds_read_b64_tr_b16 v[214:215], v238 offset:12288
    v_mfma_f32_16x16x32_bf16 v[52:55], v[164:167], v[140:143], 0
    ds_read_b64_tr_b16 v[216:217], v235 offset:24576
    v_mfma_f32_16x16x32_bf16 v[56:59], v[168:171], v[140:143], 0
    ds_read_b64_tr_b16 v[218:219], v235 offset:28672
    v_mfma_f32_16x16x32_bf16 v[60:63], v[172:175], v[140:143], 0
    ds_read_b64_tr_b16 v[220:221], v236 offset:24576
    v_mfma_f32_16x16x32_bf16 v[64:67], v[176:179], v[140:143], 0
    v_mfma_f32_16x16x32_bf16 v[68:71], v[180:183], v[140:143], 0
    ds_read_b64_tr_b16 v[222:223], v236 offset:28672
    v_mfma_f32_16x16x32_bf16 v[72:75], v[152:155], v[144:147], 0
    ds_read_b64_tr_b16 v[224:225], v237 offset:24576
    v_mfma_f32_16x16x32_bf16 v[76:79], v[156:159], v[144:147], 0
    ds_read_b64_tr_b16 v[226:227], v237 offset:28672
    v_mfma_f32_16x16x32_bf16 v[80:83], v[160:163], v[144:147], 0
    ds_read_b64_tr_b16 v[228:229], v238 offset:24576
    v_mfma_f32_16x16x32_bf16 v[84:87], v[164:167], v[144:147], 0
    v_mfma_f32_16x16x32_bf16 v[88:91], v[168:171], v[144:147], 0
    ds_read_b64_tr_b16 v[230:231], v238 offset:28672
    v_mfma_f32_16x16x32_bf16 v[92:95], v[172:175], v[144:147], 0
    ds_read_b128 v[188:191], v232 offset:3072
    v_mfma_f32_16x16x32_bf16 v[96:99], v[176:179], v[144:147], 0
    ds_read_b128 v[192:195], v232 offset:5120
    v_mfma_f32_16x16x32_bf16 v[100:103], v[180:183], v[144:147], 0
    ds_read_b128 v[196:199], v232 offset:7168
    v_mfma_f32_16x16x32_bf16 v[104:107], v[152:155], v[148:151], 0
    v_mfma_f32_16x16x32_bf16 v[108:111], v[156:159], v[148:151], 0
    v_add_u32 v232, s52, v233
    v_mfma_f32_16x16x32_bf16 v[112:115], v[160:163], v[148:151], 0
    v_add_u32 v235, s52, v239
    v_mfma_f32_16x16x32_bf16 v[116:119], v[164:167], v[148:151], 0
    v_add_u32 v236, s52, v240
    v_mfma_f32_16x16x32_bf16 v[120:123], v[168:171], v[148:151], 0
    v_mfma_f32_16x16x32_bf16 v[124:127], v[172:175], v[148:151], 0
    v_add_u32 v237, s52, v241
    v_mfma_f32_16x16x32_bf16 v[128:131], v[176:179], v[148:151], 0
    v_add_u32 v238, s52, v242
    v_mfma_f32_16x16x32_bf16 v[132:135], v[180:183], v[148:151], 0
    s_waitcnt lgkmcnt(0)
    v_mfma_f32_16x16x32_bf16 v[8:11], v[200:203], v[184:187], v[8:11]
    s_waitcnt vmcnt(12)
    s_barrier
    v_mfma_f32_16x16x32_bf16 v[12:15], v[204:207], v[184:187], v[12:15]
    ds_read_b128 v[136:139], v232 offset:0
    v_mfma_f32_16x16x32_bf16 v[16:19], v[208:211], v[184:187], v[16:19]
    ds_read_b64_tr_b16 v[152:153], v235 offset:0
    v_mfma_f32_16x16x32_bf16 v[20:23], v[212:215], v[184:187], v[20:23]
    ds_read_b64_tr_b16 v[154:155], v235 offset:4096
    v_mfma_f32_16x16x32_bf16 v[24:27], v[216:219], v[184:187], v[24:27]
    ds_read_b64_tr_b16 v[156:157], v236 offset:0
    v_mfma_f32_16x16x32_bf16 v[28:31], v[220:223], v[184:187], v[28:31]
    ds_read_b64_tr_b16 v[158:159], v236 offset:4096
    v_mfma_f32_16x16x32_bf16 v[32:35], v[224:227], v[184:187], v[32:35]
    v_mfma_f32_16x16x32_bf16 v[36:39], v[228:231], v[184:187], v[36:39]
    ds_read_b64_tr_b16 v[160:161], v237 offset:0
    v_mfma_f32_16x16x32_bf16 v[40:43], v[200:203], v[188:191], v[40:43]
    ds_read_b64_tr_b16 v[162:163], v237 offset:4096
    v_mfma_f32_16x16x32_bf16 v[44:47], v[204:207], v[188:191], v[44:47]
    ds_read_b64_tr_b16 v[164:165], v238 offset:0
    v_mfma_f32_16x16x32_bf16 v[48:51], v[208:211], v[188:191], v[48:51]
    ds_read_b64_tr_b16 v[166:167], v238 offset:4096
    v_mfma_f32_16x16x32_bf16 v[52:55], v[212:215], v[188:191], v[52:55]
    ds_read_b64_tr_b16 v[168:169], v235 offset:16384
    v_mfma_f32_16x16x32_bf16 v[56:59], v[216:219], v[188:191], v[56:59]
    v_mfma_f32_16x16x32_bf16 v[60:63], v[220:223], v[188:191], v[60:63]
    ds_read_b64_tr_b16 v[170:171], v235 offset:20480
    v_mfma_f32_16x16x32_bf16 v[64:67], v[224:227], v[188:191], v[64:67]
    ds_read_b64_tr_b16 v[172:173], v236 offset:16384
    v_mfma_f32_16x16x32_bf16 v[68:71], v[228:231], v[188:191], v[68:71]
    ds_read_b64_tr_b16 v[174:175], v236 offset:20480
    v_mfma_f32_16x16x32_bf16 v[72:75], v[200:203], v[192:195], v[72:75]
    ds_read_b64_tr_b16 v[176:177], v237 offset:16384
    v_mfma_f32_16x16x32_bf16 v[76:79], v[204:207], v[192:195], v[76:79]
    ds_read_b64_tr_b16 v[178:179], v237 offset:20480
    v_mfma_f32_16x16x32_bf16 v[80:83], v[208:211], v[192:195], v[80:83]
    v_mfma_f32_16x16x32_bf16 v[84:87], v[212:215], v[192:195], v[84:87]
    ds_read_b64_tr_b16 v[180:181], v238 offset:16384
    v_mfma_f32_16x16x32_bf16 v[88:91], v[216:219], v[192:195], v[88:91]
    ds_read_b64_tr_b16 v[182:183], v238 offset:20480
    v_mfma_f32_16x16x32_bf16 v[92:95], v[220:223], v[192:195], v[92:95]
    ds_read_b128 v[140:143], v232 offset:2048
    v_mfma_f32_16x16x32_bf16 v[96:99], v[224:227], v[192:195], v[96:99]
    ds_read_b128 v[144:147], v232 offset:4096
    v_mfma_f32_16x16x32_bf16 v[100:103], v[228:231], v[192:195], v[100:103]
    ds_read_b128 v[148:151], v232 offset:6144
    v_mfma_f32_16x16x32_bf16 v[104:107], v[200:203], v[196:199], v[104:107]
    v_mfma_f32_16x16x32_bf16 v[108:111], v[204:207], v[196:199], v[108:111]
    v_mfma_f32_16x16x32_bf16 v[112:115], v[208:211], v[196:199], v[112:115]
    v_mfma_f32_16x16x32_bf16 v[116:119], v[212:215], v[196:199], v[116:119]
    v_mfma_f32_16x16x32_bf16 v[120:123], v[216:219], v[196:199], v[120:123]
    v_mfma_f32_16x16x32_bf16 v[124:127], v[220:223], v[196:199], v[124:127]
    v_mfma_f32_16x16x32_bf16 v[128:131], v[224:227], v[196:199], v[128:131]
    s_add_u32 s52, s52, 49152
    s_cmp_ge_u32 s52, 147456
    s_cselect_b32 s52, 0, s52
    v_mfma_f32_16x16x32_bf16 v[132:135], v[228:231], v[196:199], v[132:135]
    s_waitcnt lgkmcnt(0)
    v_mfma_f32_16x16x32_bf16 v[8:11], v[152:155], v[136:139], v[8:11]
    ds_read_b128 v[184:187], v232 offset:1024
    v_mfma_f32_16x16x32_bf16 v[12:15], v[156:159], v[136:139], v[12:15]
    ds_read_b64_tr_b16 v[200:201], v235 offset:8192
    v_mfma_f32_16x16x32_bf16 v[16:19], v[160:163], v[136:139], v[16:19]
    ds_read_b64_tr_b16 v[202:203], v235 offset:12288
    v_mfma_f32_16x16x32_bf16 v[20:23], v[164:167], v[136:139], v[20:23]
    ds_read_b64_tr_b16 v[204:205], v236 offset:8192
    v_mfma_f32_16x16x32_bf16 v[24:27], v[168:171], v[136:139], v[24:27]
    v_mfma_f32_16x16x32_bf16 v[28:31], v[172:175], v[136:139], v[28:31]
    ds_read_b64_tr_b16 v[206:207], v236 offset:12288
    v_mfma_f32_16x16x32_bf16 v[32:35], v[176:179], v[136:139], v[32:35]
    ds_read_b64_tr_b16 v[208:209], v237 offset:8192
    v_mfma_f32_16x16x32_bf16 v[36:39], v[180:183], v[136:139], v[36:39]
    ds_read_b64_tr_b16 v[210:211], v237 offset:12288
    v_mfma_f32_16x16x32_bf16 v[40:43], v[152:155], v[140:143], v[40:43]
    ds_read_b64_tr_b16 v[212:213], v238 offset:8192
    v_mfma_f32_16x16x32_bf16 v[44:47], v[156:159], v[140:143], v[44:47]
    v_mfma_f32_16x16x32_bf16 v[48:51], v[160:163], v[140:143], v[48:51]
    ds_read_b64_tr_b16 v[214:215], v238 offset:12288
    v_mfma_f32_16x16x32_bf16 v[52:55], v[164:167], v[140:143], v[52:55]
    ds_read_b64_tr_b16 v[216:217], v235 offset:24576
    v_mfma_f32_16x16x32_bf16 v[56:59], v[168:171], v[140:143], v[56:59]
    ds_read_b64_tr_b16 v[218:219], v235 offset:28672
    v_mfma_f32_16x16x32_bf16 v[60:63], v[172:175], v[140:143], v[60:63]
    ds_read_b64_tr_b16 v[220:221], v236 offset:24576
    v_mfma_f32_16x16x32_bf16 v[64:67], v[176:179], v[140:143], v[64:67]
    v_mfma_f32_16x16x32_bf16 v[68:71], v[180:183], v[140:143], v[68:71]
    ds_read_b64_tr_b16 v[222:223], v236 offset:28672
    v_mfma_f32_16x16x32_bf16 v[72:75], v[152:155], v[144:147], v[72:75]
    ds_read_b64_tr_b16 v[224:225], v237 offset:24576
    v_mfma_f32_16x16x32_bf16 v[76:79], v[156:159], v[144:147], v[76:79]
    ds_read_b64_tr_b16 v[226:227], v237 offset:28672
    v_mfma_f32_16x16x32_bf16 v[80:83], v[160:163], v[144:147], v[80:83]
    ds_read_b64_tr_b16 v[228:229], v238 offset:24576
    v_mfma_f32_16x16x32_bf16 v[84:87], v[164:167], v[144:147], v[84:87]
    v_mfma_f32_16x16x32_bf16 v[88:91], v[168:171], v[144:147], v[88:91]
    ds_read_b64_tr_b16 v[230:231], v238 offset:28672
    v_mfma_f32_16x16x32_bf16 v[92:95], v[172:175], v[144:147], v[92:95]
    ds_read_b128 v[188:191], v232 offset:3072
    v_mfma_f32_16x16x32_bf16 v[96:99], v[176:179], v[144:147], v[96:99]
    ds_read_b128 v[192:195], v232 offset:5120
    v_mfma_f32_16x16x32_bf16 v[100:103], v[180:183], v[144:147], v[100:103]
    ds_read_b128 v[196:199], v232 offset:7168
    v_mfma_f32_16x16x32_bf16 v[104:107], v[152:155], v[148:151], v[104:107]
    v_mfma_f32_16x16x32_bf16 v[108:111], v[156:159], v[148:151], v[108:111]
    v_add_u32 v232, s52, v233
    v_mfma_f32_16x16x32_bf16 v[112:115], v[160:163], v[148:151], v[112:115]
    v_add_u32 v235, s52, v239
    v_mfma_f32_16x16x32_bf16 v[116:119], v[164:167], v[148:151], v[116:119]
    v_add_u32 v236, s52, v240
    v_mfma_f32_16x16x32_bf16 v[120:123], v[168:171], v[148:151], v[120:123]
    v_mfma_f32_16x16x32_bf16 v[124:127], v[172:175], v[148:151], v[124:127]
    v_add_u32 v237, s52, v241
    v_mfma_f32_16x16x32_bf16 v[128:131], v[176:179], v[148:151], v[128:131]
    v_add_u32 v238, s52, v242
    v_mfma_f32_16x16x32_bf16 v[132:135], v[180:183], v[148:151], v[132:135]
    s_waitcnt lgkmcnt(0)
    v_mfma_f32_16x16x32_bf16 v[8:11], v[200:203], v[184:187], v[8:11]
    s_waitcnt vmcnt(0)
    s_barrier
    v_mfma_f32_16x16x32_bf16 v[12:15], v[204:207], v[184:187], v[12:15]
    ds_read_b128 v[136:139], v232 offset:0
    v_mfma_f32_16x16x32_bf16 v[16:19], v[208:211], v[184:187], v[16:19]
    ds_read_b64_tr_b16 v[152:153], v235 offset:0
    v_mfma_f32_16x16x32_bf16 v[20:23], v[212:215], v[184:187], v[20:23]
    ds_read_b64_tr_b16 v[154:155], v235 offset:4096
    v_mfma_f32_16x16x32_bf16 v[24:27], v[216:219], v[184:187], v[24:27]
    ds_read_b64_tr_b16 v[156:157], v236 offset:0
    v_mfma_f32_16x16x32_bf16 v[28:31], v[220:223], v[184:187], v[28:31]
    ds_read_b64_tr_b16 v[158:159], v236 offset:4096
    v_mfma_f32_16x16x32_bf16 v[32:35], v[224:227], v[184:187], v[32:35]
    v_mfma_f32_16x16x32_bf16 v[36:39], v[228:231], v[184:187], v[36:39]
    ds_read_b64_tr_b16 v[160:161], v237 offset:0
    v_mfma_f32_16x16x32_bf16 v[40:43], v[200:203], v[188:191], v[40:43]
    ds_read_b64_tr_b16 v[162:163], v237 offset:4096
    v_mfma_f32_16x16x32_bf16 v[44:47], v[204:207], v[188:191], v[44:47]
    ds_read_b64_tr_b16 v[164:165], v238 offset:0
    v_mfma_f32_16x16x32_bf16 v[48:51], v[208:211], v[188:191], v[48:51]
    ds_read_b64_tr_b16 v[166:167], v238 offset:4096
    v_mfma_f32_16x16x32_bf16 v[52:55], v[212:215], v[188:191], v[52:55]
    ds_read_b64_tr_b16 v[168:169], v235 offset:16384
    v_mfma_f32_16x16x32_bf16 v[56:59], v[216:219], v[188:191], v[56:59]
    v_mfma_f32_16x16x32_bf16 v[60:63], v[220:223], v[188:191], v[60:63]
    ds_read_b64_tr_b16 v[170:171], v235 offset:20480
    v_mfma_f32_16x16x32_bf16 v[64:67], v[224:227], v[188:191], v[64:67]
    ds_read_b64_tr_b16 v[172:173], v236 offset:16384
    v_mfma_f32_16x16x32_bf16 v[68:71], v[228:231], v[188:191], v[68:71]
    ds_read_b64_tr_b16 v[174:175], v236 offset:20480
    v_mfma_f32_16x16x32_bf16 v[72:75], v[200:203], v[192:195], v[72:75]
    ds_read_b64_tr_b16 v[176:177], v237 offset:16384
    v_mfma_f32_16x16x32_bf16 v[76:79], v[204:207], v[192:195], v[76:79]
    ds_read_b64_tr_b16 v[178:179], v237 offset:20480
    v_mfma_f32_16x16x32_bf16 v[80:83], v[208:211], v[192:195], v[80:83]
    v_mfma_f32_16x16x32_bf16 v[84:87], v[212:215], v[192:195], v[84:87]
    ds_read_b64_tr_b16 v[180:181], v238 offset:16384
    v_mfma_f32_16x16x32_bf16 v[88:91], v[216:219], v[192:195], v[88:91]
    ds_read_b64_tr_b16 v[182:183], v238 offset:20480
    v_mfma_f32_16x16x32_bf16 v[92:95], v[220:223], v[192:195], v[92:95]
    ds_read_b128 v[140:143], v232 offset:2048
    v_mfma_f32_16x16x32_bf16 v[96:99], v[224:227], v[192:195], v[96:99]
    ds_read_b128 v[144:147], v232 offset:4096
    v_mfma_f32_16x16x32_bf16 v[100:103], v[228:231], v[192:195], v[100:103]
    ds_read_b128 v[148:151], v232 offset:6144
    v_mfma_f32_16x16x32_bf16 v[104:107], v[200:203], v[196:199], v[104:107]
    v_mfma_f32_16x16x32_bf16 v[108:111], v[204:207], v[196:199], v[108:111]
    v_mfma_f32_16x16x32_bf16 v[112:115], v[208:211], v[196:199], v[112:115]
    v_mfma_f32_16x16x32_bf16 v[116:119], v[212:215], v[196:199], v[116:119]
    v_mfma_f32_16x16x32_bf16 v[120:123], v[216:219], v[196:199], v[120:123]
    v_mfma_f32_16x16x32_bf16 v[124:127], v[220:223], v[196:199], v[124:127]
    v_mfma_f32_16x16x32_bf16 v[128:131], v[224:227], v[196:199], v[128:131]
    s_add_u32 s52, s52, 49152
    s_cmp_ge_u32 s52, 147456
    s_cselect_b32 s52, 0, s52
    v_mfma_f32_16x16x32_bf16 v[132:135], v[228:231], v[196:199], v[132:135]
    s_waitcnt lgkmcnt(0)
    v_mfma_f32_16x16x32_bf16 v[8:11], v[152:155], v[136:139], v[8:11]
    ds_read_b128 v[184:187], v232 offset:1024
    v_mfma_f32_16x16x32_bf16 v[12:15], v[156:159], v[136:139], v[12:15]
    ds_read_b64_tr_b16 v[200:201], v235 offset:8192
    v_mfma_f32_16x16x32_bf16 v[16:19], v[160:163], v[136:139], v[16:19]
    ds_read_b64_tr_b16 v[202:203], v235 offset:12288
    v_mfma_f32_16x16x32_bf16 v[20:23], v[164:167], v[136:139], v[20:23]
    ds_read_b64_tr_b16 v[204:205], v236 offset:8192
    v_mfma_f32_16x16x32_bf16 v[24:27], v[168:171], v[136:139], v[24:27]
    v_mfma_f32_16x16x32_bf16 v[28:31], v[172:175], v[136:139], v[28:31]
    ds_read_b64_tr_b16 v[206:207], v236 offset:12288
    v_mfma_f32_16x16x32_bf16 v[32:35], v[176:179], v[136:139], v[32:35]
    ds_read_b64_tr_b16 v[208:209], v237 offset:8192
    v_mfma_f32_16x16x32_bf16 v[36:39], v[180:183], v[136:139], v[36:39]
    ds_read_b64_tr_b16 v[210:211], v237 offset:12288
    v_mfma_f32_16x16x32_bf16 v[40:43], v[152:155], v[140:143], v[40:43]
    ds_read_b64_tr_b16 v[212:213], v238 offset:8192
    v_mfma_f32_16x16x32_bf16 v[44:47], v[156:159], v[140:143], v[44:47]
    v_mfma_f32_16x16x32_bf16 v[48:51], v[160:163], v[140:143], v[48:51]
    ds_read_b64_tr_b16 v[214:215], v238 offset:12288
    v_mfma_f32_16x16x32_bf16 v[52:55], v[164:167], v[140:143], v[52:55]
    ds_read_b64_tr_b16 v[216:217], v235 offset:24576
    v_mfma_f32_16x16x32_bf16 v[56:59], v[168:171], v[140:143], v[56:59]
    ds_read_b64_tr_b16 v[218:219], v235 offset:28672
    v_mfma_f32_16x16x32_bf16 v[60:63], v[172:175], v[140:143], v[60:63]
    ds_read_b64_tr_b16 v[220:221], v236 offset:24576
    v_mfma_f32_16x16x32_bf16 v[64:67], v[176:179], v[140:143], v[64:67]
    v_mfma_f32_16x16x32_bf16 v[68:71], v[180:183], v[140:143], v[68:71]
    ds_read_b64_tr_b16 v[222:223], v236 offset:28672
    v_mfma_f32_16x16x32_bf16 v[72:75], v[152:155], v[144:147], v[72:75]
    s_movk_i32 s54, 12
M_Q_loop4:
    ds_read_b64_tr_b16 v[224:225], v237 offset:24576
    v_mfma_f32_16x16x32_bf16 v[76:79], v[156:159], v[144:147], v[76:79]
    ds_read_b64_tr_b16 v[226:227], v237 offset:28672
    v_mfma_f32_16x16x32_bf16 v[80:83], v[160:163], v[144:147], v[80:83]
    ds_read_b64_tr_b16 v[228:229], v238 offset:24576
    v_mfma_f32_16x16x32_bf16 v[84:87], v[164:167], v[144:147], v[84:87]
    v_mfma_f32_16x16x32_bf16 v[88:91], v[168:171], v[144:147], v[88:91]
    ds_read_b64_tr_b16 v[230:231], v238 offset:28672
    v_mfma_f32_16x16x32_bf16 v[92:95], v[172:175], v[144:147], v[92:95]
    ds_read_b128 v[188:191], v232 offset:3072
    v_mfma_f32_16x16x32_bf16 v[96:99], v[176:179], v[144:147], v[96:99]
    ds_read_b128 v[192:195], v232 offset:5120
    v_mfma_f32_16x16x32_bf16 v[100:103], v[180:183], v[144:147], v[100:103]
    ds_read_b128 v[196:199], v232 offset:7168
    v_mfma_f32_16x16x32_bf16 v[104:107], v[152:155], v[148:151], v[104:107]
    v_mfma_f32_16x16x32_bf16 v[108:111], v[156:159], v[148:151], v[108:111]
    v_add_u32 v232, s52, v233
    v_mfma_f32_16x16x32_bf16 v[112:115], v[160:163], v[148:151], v[112:115]
    v_add_u32 v235, s52, v239
    v_mfma_f32_16x16x32_bf16 v[116:119], v[164:167], v[148:151], v[116:119]
    v_add_u32 v236, s52, v240
    v_mfma_f32_16x16x32_bf16 v[120:123], v[168:171], v[148:151], v[120:123]
    v_mfma_f32_16x16x32_bf16 v[124:127], v[172:175], v[148:151], v[124:127]
    v_add_u32 v237, s52, v241
    v_mfma_f32_16x16x32_bf16 v[128:131], v[176:179], v[148:151], v[128:131]
    v_add_u32 v238, s52, v242
    v_mfma_f32_16x16x32_bf16 v[132:135], v[180:183], v[148:151], v[132:135]
    s_waitcnt lgkmcnt(0)
    v_mfma_f32_16x16x32_bf16 v[8:11], v[200:203], v[184:187], v[8:11]
    s_barrier
    v_mfma_f32_16x16x32_bf16 v[12:15], v[204:207], v[184:187], v[12:15]
    ds_read_b128 v[136:139], v232 offset:0
    v_mfma_f32_16x16x32_bf16 v[16:19], v[208:211], v[184:187], v[16:19]
    ds_read_b64_tr_b16 v[152:153], v235 offset:0
    v_mfma_f32_16x16x32_bf16 v[20:23], v[212:215], v[184:187], v[20:23]
    ds_read_b64_tr_b16 v[154:155], v235 offset:4096
    v_mfma_f32_16x16x32_bf16 v[24:27], v[216:219], v[184:187], v[24:27]
    ds_read_b64_tr_b16 v[156:157], v236 offset:0
    v_mfma_f32_16x16x32_bf16 v[28:31], v[220:223], v[184:187], v[28:31]
    ds_read_b64_tr_b16 v[158:159], v236 offset:4096
    v_mfma_f32_16x16x32_bf16 v[32:35], v[224:227], v[184:187], v[32:35]
    v_mfma_f32_16x16x32_bf16 v[36:39], v[228:231], v[184:187], v[36:39]
    ds_read_b64_tr_b16 v[160:161], v237 offset:0
    v_mfma_f32_16x16x32_bf16 v[40:43], v[200:203], v[188:191], v[40:43]
    ds_read_b64_tr_b16 v[162:163], v237 offset:4096
    v_mfma_f32_16x16x32_bf16 v[44:47], v[204:207], v[188:191], v[44:47]
    ds_read_b64_tr_b16 v[164:165], v238 offset:0
    v_mfma_f32_16x16x32_bf16 v[48:51], v[208:211], v[188:191], v[48:51]
    ds_read_b64_tr_b16 v[166:167], v238 offset:4096
    v_mfma_f32_16x16x32_bf16 v[52:55], v[212:215], v[188:191], v[52:55]
    ds_read_b64_tr_b16 v[168:169], v235 offset:16384
    v_mfma_f32_16x16x32_bf16 v[56:59], v[216:219], v[188:191], v[56:59]
    v_mfma_f32_16x16x32_bf16 v[60:63], v[220:223], v[188:191], v[60:63]
    ds_read_b64_tr_b16 v[170:171], v235 offset:20480
    v_mfma_f32_16x16x32_bf16 v[64:67], v[224:227], v[188:191], v[64:67]
    ds_read_b64_tr_b16 v[172:173], v236 offset:16384
    v_mfma_f32_16x16x32_bf16 v[68:71], v[228:231], v[188:191], v[68:71]
    ds_read_b64_tr_b16 v[174:175], v236 offset:20480
    v_mfma_f32_16x16x32_bf16 v[72:75], v[200:203], v[192:195], v[72:75]
    ds_read_b64_tr_b16 v[176:177], v237 offset:16384
    v_mfma_f32_16x16x32_bf16 v[76:79], v[204:207], v[192:195], v[76:79]
    ds_read_b64_tr_b16 v[178:179], v237 offset:20480
    v_mfma_f32_16x16x32_bf16 v[80:83], v[208:211], v[192:195], v[80:83]
    v_mfma_f32_16x16x32_bf16 v[84:87], v[212:215], v[192:195], v[84:87]
    ds_read_b64_tr_b16 v[180:181], v238 offset:16384
    v_mfma_f32_16x16x32_bf16 v[88:91], v[216:219], v[192:195], v[88:91]
    ds_read_b64_tr_b16 v[182:183], v238 offset:20480
    v_mfma_f32_16x16x32_bf16 v[92:95], v[220:223], v[192:195], v[92:95]
    ds_read_b128 v[140:143], v232 offset:2048
    v_mfma_f32_16x16x32_bf16 v[96:99], v[224:227], v[192:195], v[96:99]
    ds_read_b128 v[144:147], v232 offset:4096
    v_mfma_f32_16x16x32_bf16 v[100:103], v[228:231], v[192:195], v[100:103]
    ds_read_b128 v[148:151], v232 offset:6144
    v_mfma_f32_16x16x32_bf16 v[104:107], v[200:203], v[196:199], v[104:107]
    v_mfma_f32_16x16x32_bf16 v[108:111], v[204:207], v[196:199], v[108:111]
    v_mfma_f32_16x16x32_bf16 v[112:115], v[208:211], v[196:199], v[112:115]
    v_mfma_f32_16x16x32_bf16 v[116:119], v[212:215], v[196:199], v[116:119]
    v_mfma_f32_16x16x32_bf16 v[120:123], v[216:219], v[196:199], v[120:123]
    v_mfma_f32_16x16x32_bf16 v[124:127], v[220:223], v[196:199], v[124:127]
    v_mfma_f32_16x16x32_bf16 v[128:131], v[224:227], v[196:199], v[128:131]
    s_add_u32 s52, s52, 49152
    s_cmp_ge_u32 s52, 147456
    s_cselect_b32 s52, 0, s52
    v_mfma_f32_16x16x32_bf16 v[132:135], v[228:231], v[196:199], v[132:135]
    s_waitcnt lgkmcnt(0)
    v_mfma_f32_16x16x32_bf16 v[8:11], v[152:155], v[136:139], v[8:11]
    ds_read_b128 v[184:187], v232 offset:1024
    v_mfma_f32_16x16x32_bf16 v[12:15], v[156:159], v[136:139], v[12:15]
    ds_read_b64_tr_b16 v[200:201], v235 offset:8192
    v_mfma_f32_16x16x32_bf16 v[16:19], v[160:163], v[136:139], v[16:19]
    ds_read_b64_tr_b16 v[202:203], v235 offset:12288
    v_mfma_f32_16x16x32_bf16 v[20:23], v[164:167], v[136:139], v[20:23]
    ds_read_b64_tr_b16 v[204:205], v236 offset:8192
    v_mfma_f32_16x16x32_bf16 v[24:27], v[168:171], v[136:139], v[24:27]
    v_mfma_f32_16x16x32_bf16 v[28:31], v[172:175], v[136:139], v[28:31]
    ds_read_b64_tr_b16 v[206:207], v236 offset:12288
    v_mfma_f32_16x16x32_bf16 v[32:35], v[176:179], v[136:139], v[32:35]
    ds_read_b64_tr_b16 v[208:209], v237 offset:8192
    v_mfma_f32_16x16x32_bf16 v[36:39], v[180:183], v[136:139], v[36:39]
    ds_read_b64_tr_b16 v[210:211], v237 offset:12288
    v_mfma_f32_16x16x32_bf16 v[40:43], v[152:155], v[140:143], v[40:43]
    ds_read_b64_tr_b16 v[212:213], v238 offset:8192
    v_mfma_f32_16x16x32_bf16 v[44:47], v[156:159], v[140:143], v[44:47]
    v_mfma_f32_16x16x32_bf16 v[48:51], v[160:163], v[140:143], v[48:51]
    ds_read_b64_tr_b16 v[214:215], v238 offset:12288
    v_mfma_f32_16x16x32_bf16 v[52:55], v[164:167], v[140:143], v[52:55]
    ds_read_b64_tr_b16 v[216:217], v235 offset:24576
    v_mfma_f32_16x16x32_bf16 v[56:59], v[168:171], v[140:143], v[56:59]
    ds_read_b64_tr_b16 v[218:219], v235 offset:28672
    v_mfma_f32_16x16x32_bf16 v[60:63], v[172:175], v[140:143], v[60:63]
    ds_read_b64_tr_b16 v[220:221], v236 offset:24576
    v_mfma_f32_16x16x32_bf16 v[64:67], v[176:179], v[140:143], v[64:67]
    v_mfma_f32_16x16x32_bf16 v[68:71], v[180:183], v[140:143], v[68:71]
    s_sub_u32 s54, s54, 1
    ds_read_b64_tr_b16 v[222:223], v236 offset:28672
    v_mfma_f32_16x16x32_bf16 v[72:75], v[152:155], v[144:147], v[72:75]
    s_cbranch_scc0 M_Q_loop4
    ds_read_b64_tr_b16 v[224:225], v237 offset:24576
    v_mfma_f32_16x16x32_bf16 v[76:79], v[156:159], v[144:147], v[76:79]
    ds_read_b64_tr_b16 v[226:227], v237 offset:28672
    v_mfma_f32_16x16x32_bf16 v[80:83], v[160:163], v[144:147], v[80:83]
    ds_read_b64_tr_b16 v[228:229], v238 offset:24576
    v_mfma_f32_16x16x32_bf16 v[84:87], v[164:167], v[144:147], v[84:87]
    v_mfma_f32_16x16x32_bf16 v[88:91], v[168:171], v[144:147], v[88:91]
    ds_read_b64_tr_b16 v[230:231], v238 offset:28672
    v_mfma_f32_16x16x32_bf16 v[92:95], v[172:175], v[144:147], v[92:95]
    ds_read_b128 v[188:191], v232 offset:3072
    v_mfma_f32_16x16x32_bf16 v[96:99], v[176:179], v[144:147], v[96:99]
    ds_read_b128 v[192:195], v232 offset:5120
    v_mfma_f32_16x16x32_bf16 v[100:103], v[180:183], v[144:147], v[100:103]
    ds_read_b128 v[196:199], v232 offset:7168
    v_mfma_f32_16x16x32_bf16 v[104:107], v[152:155], v[148:151], v[104:107]
    v_mfma_f32_16x16x32_bf16 v[108:111], v[156:159], v[148:151], v[108:111]
    v_mfma_f32_16x16x32_bf16 v[112:115], v[160:163], v[148:151], v[112:115]
    v_mfma_f32_16x16x32_bf16 v[116:119], v[164:167], v[148:151], v[116:119]
    v_mfma_f32_16x16x32_bf16 v[120:123], v[168:171], v[148:151], v[120:123]
    v_mfma_f32_16x16x32_bf16 v[124:127], v[172:175], v[148:151], v[124:127]
    v_mfma_f32_16x16x32_bf16 v[128:131], v[176:179], v[148:151], v[128:131]
    v_mfma_f32_16x16x32_bf16 v[132:135], v[180:183], v[148:151], v[132:135]
    s_waitcnt lgkmcnt(0)
    v_mfma_f32_16x16x32_bf16 v[8:11], v[200:203], v[184:187], v[8:11]
    s_barrier
    v_mfma_f32_16x16x32_bf16 v[12:15], v[204:207], v[184:187], v[12:15]
    v_mfma_f32_16x16x32_bf16 v[16:19], v[208:211], v[184:187], v[16:19]
    v_mfma_f32_16x16x32_bf16 v[20:23], v[212:215], v[184:187], v[20:23]
    v_mfma_f32_16x16x32_bf16 v[24:27], v[216:219], v[184:187], v[24:27]
    v_mfma_f32_16x16x32_bf16 v[28:31], v[220:223], v[184:187], v[28:31]
    v_mfma_f32_16x16x32_bf16 v[32:35], v[224:227], v[184:187], v[32:35]
    v_mfma_f32_16x16x32_bf16 v[36:39], v[228:231], v[184:187], v[36:39]
    v_mfma_f32_16x16x32_bf16 v[40:43], v[200:203], v[188:191], v[40:43]
    v_mfma_f32_16x16x32_bf16 v[44:47], v[204:207], v[188:191], v[44:47]
    v_mfma_f32_16x16x32_bf16 v[48:51], v[208:211], v[188:191], v[48:51]
    v_mfma_f32_16x16x32_bf16 v[52:55], v[212:215], v[188:191], v[52:55]
    v_mfma_f32_16x16x32_bf16 v[56:59], v[216:219], v[188:191], v[56:59]
    v_mfma_f32_16x16x32_bf16 v[60:63], v[220:223], v[188:191], v[60:63]
    v_mfma_f32_16x16x32_bf16 v[64:67], v[224:227], v[188:191], v[64:67]
    v_mfma_f32_16x16x32_bf16 v[68:71], v[228:231], v[188:191], v[68:71]
    v_mfma_f32_16x16x32_bf16 v[72:75], v[200:203], v[192:195], v[72:75]
    v_mfma_f32_16x16x32_bf16 v[76:79], v[204:207], v[192:195], v[76:79]
    v_mfma_f32_16x16x32_bf16 v[80:83], v[208:211], v[192:195], v[80:83]
    v_mfma_f32_16x16x32_bf16 v[84:87], v[212:215], v[192:195], v[84:87]
    v_mfma_f32_16x16x32_bf16 v[88:91], v[216:219], v[192:195], v[88:91]
    v_mfma_f32_16x16x32_bf16 v[92:95], v[220:223], v[192:195], v[92:95]
    v_mfma_f32_16x16x32_bf16 v[96:99], v[224:227], v[192:195], v[96:99]
    v_mfma_f32_16x16x32_bf16 v[100:103], v[228:231], v[192:195], v[100:103]
    v_mfma_f32_16x16x32_bf16 v[104:107], v[200:203], v[196:199], v[104:107]
    v_mfma_f32_16x16x32_bf16 v[108:111], v[204:207], v[196:199], v[108:111]
    v_mfma_f32_16x16x32_bf16 v[112:115], v[208:211], v[196:199], v[112:115]
    v_mfma_f32_16x16x32_bf16 v[116:119], v[212:215], v[196:199], v[116:119]
    v_mfma_f32_16x16x32_bf16 v[120:123], v[216:219], v[196:199], v[120:123]
    v_mfma_f32_16x16x32_bf16 v[124:127], v[220:223], v[196:199], v[124:127]
    v_mfma_f32_16x16x32_bf16 v[128:131], v[224:227], v[196:199], v[128:131]
    v_mfma_f32_16x16x32_bf16 v[132:135], v[228:231], v[196:199], v[132:135]
M_Qjoin:
    s_setprio 0
    s_lshl_b32 s60, s44, 12
    s_add_u32 s61, s60, 163840
    s_add_u32 s53, s60, 65536
    s_add_u32 s66, s50, s51
    s_and_b32 s66, s66, 3
    s_mov_b32 s58, 0xba897645
    s_mov_b32 s59, 0xfecd
    s_cmp_eq_u32 s66, 1
    s_cselect_b32 s58, 0xb9a87564, s58
    s_cselect_b32 s59, 0xfdec, s59
    s_cmp_eq_u32 s66, 2
    s_cselect_b32 s58, 0xab986754, s58
    s_cselect_b32 s59, 0xefdc, s59
    s_cmp_eq_u32 s66, 3
    s_cselect_b32 s58, 0xca978653, s58
    s_cselect_b32 s59, 0xfedb, s59
    s_cmp_eq_u32 s49, 0
    s_cselect_b32 s55, 16, 0
    s_mov_b32 s32, s16
    s_mov_b32 s33, s17
    s_mov_b32 s34, 0x700000
    s_mov_b32 s35, 0x20000
    s_lshr_b32 s62, s48, 2
    s_sub_u32 s62, s48, s62
    s_add_u32 s62, s62, 16
    s_lshl_b32 s70, s62, 12
    s_lshl_b32 s64, s47, 3
    s_lshl_b32 s65, s45, 2
    s_add_u32 s64, s64, s65
    s_mul_i32 s64, s64, 114688
    s_add_u32 s64, s64, s70
    s_lshl_b32 s65, s46, 11
    s_add_u32 s64, s64, s65
    s_add_u32 s64, s64, 0x1500000
    s_or_b32 s64, s64, s69
    v_lshl_add_u32 v198, v1, 4, s64
    v_mul_f32 v24, v8, v24
    v_exp_f32 v216, -v8
    v_mul_f32 v25, v9, v25
    v_exp_f32 v217, -v9
    v_mul_f32 v26, v10, v26
    v_exp_f32 v218, -v10
    v_mul_f32 v27, v11, v27
    v_exp_f32 v219, -v11
    v_mul_f32 v28, v12, v28
    v_exp_f32 v220, -v12
    v_mul_f32 v29, v13, v29
    v_exp_f32 v221, -v13
    v_mul_f32 v30, v14, v30
    v_exp_f32 v222, -v14
    v_mul_f32 v31, v15, v31
    v_exp_f32 v223, -v15
    v_fma_f32 v216, v216, s67, s67
    v_fma_f32 v217, v217, s67, s67
    v_rcp_f32 v216, v216
    v_fma_f32 v218, v218, s67, s67
    v_rcp_f32 v217, v217
    v_fma_f32 v219, v219, s67, s67
    v_rcp_f32 v218, v218
    v_fma_f32 v220, v220, s67, s67
    v_rcp_f32 v219, v219
    v_fma_f32 v221, v221, s67, s67
    v_rcp_f32 v220, v220
    v_fma_f32 v222, v222, s67, s67
    v_rcp_f32 v221, v221
    v_fma_f32 v223, v223, s67, s67
    s_mul_i32 s62, s49, 0
    s_mul_i32 s63, s49, 6
    s_barrier
    s_and_b32 s57, s58, 15
    s_lshr_b64 s[58:59], s[58:59], 4
    s_add_u32 s57, s57, s55
    s_lshl_b32 s56, s57, 11
    s_mul_i32 s57, s57, 0x20000
    s_add_u32 m0, s53, 16384
    s_nop 0
    buffer_load_dwordx4 v248, s[32:35], s57 offen offset:0 lds
    v_rcp_f32 v222, v222
    v_rcp_f32 v223, v223
    v_mul_f32 v24, v24, v216
    v_mul_f32 v25, v25, v217
    v_mul_f32 v26, v26, v218
    v_mul_f32 v27, v27, v219
    v_mul_f32 v28, v28, v220
    v_mul_f32 v29, v29, v221
    buffer_load_dwordx4 v249, s[32:35], s57 offen offset:1024 lds
    v_mul_f32 v30, v30, v222
    v_mul_f32 v31, v31, v223
    v_cvt_pk_bf16_f32 v200, v24, v25
    v_cvt_pk_bf16_f32 v201, v26, v27
    v_cvt_pk_bf16_f32 v202, v28, v29
    v_cvt_pk_bf16_f32 v203, v30, v31
    v_mul_f32 v32, v16, v32
    buffer_load_dwordx4 v250, s[32:35], s57 offen offset:2048 lds
    v_exp_f32 v224, -v16
    v_mul_f32 v33, v17, v33
    v_exp_f32 v225, -v17
    v_mul_f32 v34, v18, v34
    v_exp_f32 v226, -v18
    v_mul_f32 v35, v19, v35
    v_exp_f32 v227, -v19
    v_mul_f32 v36, v20, v36
    buffer_load_dwordx4 v251, s[32:35], s57 offen offset:3072 lds
    v_exp_f32 v228, -v20
    v_mul_f32 v37, v21, v37
    v_exp_f32 v229, -v21
    v_mul_f32 v38, v22, v38
    v_exp_f32 v230, -v22
    v_mul_f32 v39, v23, v39
    v_exp_f32 v231, -v23
    v_fma_f32 v224, v224, s67, s67
    s_mov_b32 m0, s53
    s_nop 0
    buffer_load_dwordx4 v246, s[28:31], s56 offen offset:0 lds
    v_fma_f32 v225, v225, s67, s67
    v_rcp_f32 v224, v224
    v_fma_f32 v226, v226, s67, s67
    v_rcp_f32 v225, v225
    v_fma_f32 v227, v227, s67, s67
    v_rcp_f32 v226, v226
    v_fma_f32 v228, v228, s67, s67
    v_rcp_f32 v227, v227
    buffer_load_dwordx4 v246, s[28:31], s56 offen offset:1024 lds
    v_fma_f32 v229, v229, s67, s67
    v_rcp_f32 v228, v228
    v_fma_f32 v230, v230, s67, s67
    v_rcp_f32 v229, v229
    v_fma_f32 v231, v231, s67, s67
    v_rcp_f32 v230, v230
    v_rcp_f32 v231, v231
    v_mul_f32 v32, v32, v224
    buffer_load_dwordx4 v247, s[28:31], s56 offen offset:2048 lds
    v_mul_f32 v33, v33, v225
    v_mul_f32 v34, v34, v226
    v_mul_f32 v35, v35, v227
    v_mul_f32 v36, v36, v228
    v_mul_f32 v37, v37, v229
    v_mul_f32 v38, v38, v230
    v_mul_f32 v39, v39, v231
    v_cvt_pk_bf16_f32 v204, v32, v33
    buffer_load_dwordx4 v247, s[28:31], s56 offen offset:3072 lds
    v_cvt_pk_bf16_f32 v205, v34, v35
    v_cvt_pk_bf16_f32 v206, v36, v37
    v_cvt_pk_bf16_f32 v207, v38, v39
    v_mul_f32 v56, v40, v56
    v_exp_f32 v216, -v40
    v_mul_f32 v57, v41, v57
    s_add_u32 s53, s53, 32768
    s_cmp_ge_u32 s53, s61
    s_cselect_b32 s53, s60, s53
    buffer_store_dwordx4 v[200:203], v198, s[28:31], 0 offen offset:0 sc1
    buffer_store_dwordx4 v[204:207], v198, s[28:31], 0 offen offset:1024 sc1
    v_add_u32 v198, 114688, v198
    s_barrier
    s_and_b32 s57, s58, 15
    s_lshr_b64 s[58:59], s[58:59], 4
    s_add_u32 s57, s57, s55
    s_lshl_b32 s56, s57, 11
    s_mul_i32 s57, s57, 0x20000
    s_add_u32 m0, s53, 16384
    s_nop 0
    buffer_load_dwordx4 v248, s[32:35], s57 offen offset:0 lds
    v_exp_f32 v217, -v41
    v_mul_f32 v58, v42, v58
    v_exp_f32 v218, -v42
    v_mul_f32 v59, v43, v59
    v_exp_f32 v219, -v43
    v_mul_f32 v60, v44, v60
    v_exp_f32 v220, -v44
    v_mul_f32 v61, v45, v61
    buffer_load_dwordx4 v249, s[32:35], s57 offen offset:1024 lds
    v_exp_f32 v221, -v45
    v_mul_f32 v62, v46, v62
    v_exp_f32 v222, -v46
    v_mul_f32 v63, v47, v63
    v_exp_f32 v223, -v47
    v_fma_f32 v216, v216, s67, s67
    v_fma_f32 v217, v217, s67, s67
    v_rcp_f32 v216, v216
    buffer_load_dwordx4 v250, s[32:35], s57 offen offset:2048 lds
    v_fma_f32 v218, v218, s67, s67
    v_rcp_f32 v217, v217
    v_fma_f32 v219, v219, s67, s67
    v_rcp_f32 v218, v218
    v_fma_f32 v220, v220, s67, s67
    v_rcp_f32 v219, v219
    v_fma_f32 v221, v221, s67, s67
    v_rcp_f32 v220, v220
    buffer_load_dwordx4 v251, s[32:35], s57 offen offset:3072 lds
    v_fma_f32 v222, v222, s67, s67
    v_rcp_f32 v221, v221
    v_fma_f32 v223, v223, s67, s67
    v_rcp_f32 v222, v222
    v_rcp_f32 v223, v223
    v_mul_f32 v56, v56, v216
    v_mul_f32 v57, v57, v217
    v_mul_f32 v58, v58, v218
    s_mov_b32 m0, s53
    s_nop 0
    buffer_load_dwordx4 v246, s[28:31], s56 offen offset:0 lds
    v_mul_f32 v59, v59, v219
    v_mul_f32 v60, v60, v220
    v_mul_f32 v61, v61, v221
    v_mul_f32 v62, v62, v222
    v_mul_f32 v63, v63, v223
    v_cvt_pk_bf16_f32 v208, v56, v57
    v_cvt_pk_bf16_f32 v209, v58, v59
    v_cvt_pk_bf16_f32 v210, v60, v61
    buffer_load_dwordx4 v246, s[28:31], s56 offen offset:1024 lds
    v_cvt_pk_bf16_f32 v211, v62, v63
    v_mul_f32 v64, v48, v64
    v_exp_f32 v224, -v48
    v_mul_f32 v65, v49, v65
    v_exp_f32 v225, -v49
    v_mul_f32 v66, v50, v66
    v_exp_f32 v226, -v50
    buffer_load_dwordx4 v247, s[28:31], s56 offen offset:2048 lds
    v_mul_f32 v67, v51, v67
    v_exp_f32 v227, -v51
    v_mul_f32 v68, v52, v68
    v_exp_f32 v228, -v52
    v_mul_f32 v69, v53, v69
    v_exp_f32 v229, -v53
    v_mul_f32 v70, v54, v70
    v_exp_f32 v230, -v54
    buffer_load_dwordx4 v247, s[28:31], s56 offen offset:3072 lds
    v_mul_f32 v71, v55, v71
    v_exp_f32 v231, -v55
    v_fma_f32 v224, v224, s67, s67
    v_fma_f32 v225, v225, s67, s67
    v_rcp_f32 v224, v224
    v_fma_f32 v226, v226, s67, s67
    v_rcp_f32 v225, v225
    v_fma_f32 v227, v227, s67, s67
    s_add_u32 s53, s53, 32768
    s_cmp_ge_u32 s53, s61
    s_cselect_b32 s53, s60, s53
    buffer_store_dwordx4 v[208:211], v198, s[28:31], 0 offen offset:0 sc1
    s_barrier
    s_and_b32 s57, s58, 15
    s_lshr_b64 s[58:59], s[58:59], 4
    s_add_u32 s57, s57, s55
    s_lshl_b32 s56, s57, 11
    s_mul_i32 s57, s57, 0x20000
    s_add_u32 m0, s53, 16384
    s_nop 0
    buffer_load_dwordx4 v248, s[32:35], s57 offen offset:0 lds
    v_rcp_f32 v226, v226
    v_fma_f32 v228, v228, s67, s67
    v_rcp_f32 v227, v227
    v_fma_f32 v229, v229, s67, s67
    v_rcp_f32 v228, v228
    v_fma_f32 v230, v230, s67, s67
    v_rcp_f32 v229, v229
    v_fma_f32 v231, v231, s67, s67
    buffer_load_dwordx4 v249, s[32:35], s57 offen offset:1024 lds
    v_rcp_f32 v230, v230
    v_rcp_f32 v231, v231
    v_mul_f32 v64, v64, v224
    v_mul_f32 v65, v65, v225
    v_mul_f32 v66, v66, v226
    v_mul_f32 v67, v67, v227
    v_mul_f32 v68, v68, v228
    v_mul_f32 v69, v69, v229
    buffer_load_dwordx4 v250, s[32:35], s57 offen offset:2048 lds
    v_mul_f32 v70, v70, v230
    v_mul_f32 v71, v71, v231
    v_cvt_pk_bf16_f32 v212, v64, v65
    v_cvt_pk_bf16_f32 v213, v66, v67
    v_cvt_pk_bf16_f32 v214, v68, v69
    v_cvt_pk_bf16_f32 v215, v70, v71
    buffer_load_dwordx4 v251, s[32:35], s57 offen offset:3072 lds
    v_mul_f32 v88, v72, v88
    v_exp_f32 v216, -v72
    v_mul_f32 v89, v73, v89
    v_exp_f32 v217, -v73
    v_mul_f32 v90, v74, v90
    v_exp_f32 v218, -v74
    v_mul_f32 v91, v75, v91
    v_exp_f32 v219, -v75
    s_mov_b32 m0, s53
    s_nop 0
    buffer_load_dwordx4 v246, s[28:31], s56 offen offset:0 lds
    v_mul_f32 v92, v76, v92
    v_exp_f32 v220, -v76
    v_mul_f32 v93, v77, v93
    v_exp_f32 v221, -v77
    v_mul_f32 v94, v78, v94
    v_exp_f32 v222, -v78
    v_mul_f32 v95, v79, v95
    v_exp_f32 v223, -v79
    buffer_load_dwordx4 v246, s[28:31], s56 offen offset:1024 lds
    v_fma_f32 v216, v216, s67, s67
    v_fma_f32 v217, v217, s67, s67
    v_rcp_f32 v216, v216
    v_fma_f32 v218, v218, s67, s67
    v_rcp_f32 v217, v217
    v_fma_f32 v219, v219, s67, s67
    v_rcp_f32 v218, v218
    v_fma_f32 v220, v220, s67, s67
    buffer_load_dwordx4 v247, s[28:31], s56 offen offset:2048 lds
    v_rcp_f32 v219, v219
    v_fma_f32 v221, v221, s67, s67
    v_rcp_f32 v220, v220
    v_fma_f32 v222, v222, s67, s67
    v_rcp_f32 v221, v221
    v_fma_f32 v223, v223, s67, s67
    v_rcp_f32 v222, v222
    v_rcp_f32 v223, v223
    buffer_load_dwordx4 v247, s[28:31], s56 offen offset:3072 lds
    v_mul_f32 v88, v88, v216
    v_mul_f32 v89, v89, v217
    v_mul_f32 v90, v90, v218
    v_mul_f32 v91, v91, v219
    v_mul_f32 v92, v92, v220
    v_mul_f32 v93, v93, v221
    v_mul_f32 v94, v94, v222
    v_mul_f32 v95, v95, v223
    s_add_u32 s53, s53, 32768
    s_cmp_ge_u32 s53, s61
    s_cselect_b32 s53, s60, s53
    buffer_store_dwordx4 v[212:215], v198, s[28:31], 0 offen offset:1024 sc1
    v_add_u32 v198, 114688, v198
    s_waitcnt vmcnt(20)
    s_barrier
    s_and_b32 s57, s58, 15
    s_lshr_b64 s[58:59], s[58:59], 4
    s_add_u32 s57, s57, s55
    s_lshl_b32 s56, s57, 11
    s_mul_i32 s57, s57, 0x20000
    s_add_u32 m0, s53, 16384
    s_nop 0
    buffer_load_dwordx4 v248, s[32:35], s57 offen offset:0 lds
    v_cvt_pk_bf16_f32 v200, v88, v89
    v_cvt_pk_bf16_f32 v201, v90, v91
    v_cvt_pk_bf16_f32 v202, v92, v93
    v_cvt_pk_bf16_f32 v203, v94, v95
    v_mul_f32 v96, v80, v96
    v_exp_f32 v224, -v80
    v_mul_f32 v97, v81, v97
    buffer_load_dwordx4 v249, s[32:35], s57 offen offset:1024 lds
    v_exp_f32 v225, -v81
    v_mul_f32 v98, v82, v98
    v_exp_f32 v226, -v82
    v_mul_f32 v99, v83, v99
    v_exp_f32 v227, -v83
    v_mul_f32 v100, v84, v100
    v_exp_f32 v228, -v84
    v_mul_f32 v101, v85, v101
    buffer_load_dwordx4 v250, s[32:35], s57 offen offset:2048 lds
    v_exp_f32 v229, -v85
    v_mul_f32 v102, v86, v102
    v_exp_f32 v230, -v86
    v_mul_f32 v103, v87, v103
    v_exp_f32 v231, -v87
    v_fma_f32 v224, v224, s67, s67
    v_fma_f32 v225, v225, s67, s67
    v_rcp_f32 v224, v224
    buffer_load_dwordx4 v251, s[32:35], s57 offen offset:3072 lds
    v_fma_f32 v226, v226, s67, s67
    v_rcp_f32 v225, v225
    v_fma_f32 v227, v227, s67, s67
    v_rcp_f32 v226, v226
    v_fma_f32 v228, v228, s67, s67
    v_rcp_f32 v227, v227
    v_fma_f32 v229, v229, s67, s67
    v_rcp_f32 v228, v228
    s_mov_b32 m0, s53
    s_nop 0
    buffer_load_dwordx4 v246, s[28:31], s56 offen offset:0 lds
    v_fma_f32 v230, v230, s67, s67
    v_rcp_f32 v229, v229
    v_fma_f32 v231, v231, s67, s67
    v_rcp_f32 v230, v230
    v_rcp_f32 v231, v231
    v_mul_f32 v96, v96, v224
    v_mul_f32 v97, v97, v225
    v_mul_f32 v98, v98, v226
    buffer_load_dwordx4 v246, s[28:31], s56 offen offset:1024 lds
    v_mul_f32 v99, v99, v227
    v_mul_f32 v100, v100, v228
    v_mul_f32 v101, v101, v229
    v_mul_f32 v102, v102, v230
    v_mul_f32 v103, v103, v231
    v_cvt_pk_bf16_f32 v204, v96, v97
    v_cvt_pk_bf16_f32 v205, v98, v99
    v_cvt_pk_bf16_f32 v206, v100, v101
    buffer_load_dwordx4 v247, s[28:31], s56 offen offset:2048 lds
    v_cvt_pk_bf16_f32 v207, v102, v103
    v_mul_f32 v120, v104, v120
    v_exp_f32 v216, -v104
    v_mul_f32 v121, v105, v121
    v_exp_f32 v217, -v105
    v_mul_f32 v122, v106, v122
    buffer_load_dwordx4 v247, s[28:31], s56 offen offset:3072 lds
    v_exp_f32 v218, -v106
    v_mul_f32 v123, v107, v123
    v_exp_f32 v219, -v107
    v_mul_f32 v124, v108, v124
    v_exp_f32 v220, -v108
    v_mul_f32 v125, v109, v125
    v_exp_f32 v221, -v109
    v_mul_f32 v126, v110, v126
    s_add_u32 s53, s53, 32768
    s_cmp_ge_u32 s53, s61
    s_cselect_b32 s53, s60, s53
    buffer_store_dwordx4 v[200:203], v198, s[28:31], 0 offen offset:0 sc1
    buffer_store_dwordx4 v[204:207], v198, s[28:31], 0 offen offset:1024 sc1
    v_add_u32 v198, 114688, v198
    s_waitcnt vmcnt(20)
    s_barrier
    s_and_b32 s57, s58, 15
    s_lshr_b64 s[58:59], s[58:59], 4
    s_add_u32 s57, s57, s55
    s_lshl_b32 s56, s57, 11
    s_mul_i32 s57, s57, 0x20000
    s_add_u32 m0, s53, 16384
    s_nop 0
    buffer_load_dwordx4 v248, s[32:35], s57 offen offset:0 lds
    v_exp_f32 v222, -v110
    v_mul_f32 v127, v111, v127
    v_exp_f32 v223, -v111
    v_fma_f32 v216, v216, s67, s67
    v_fma_f32 v217, v217, s67, s67
    v_rcp_f32 v216, v216
    v_fma_f32 v218, v218, s67, s67
    v_rcp_f32 v217, v217
    buffer_load_dwordx4 v249, s[32:35], s57 offen offset:1024 lds
    v_fma_f32 v219, v219, s67, s67
    v_rcp_f32 v218, v218
    v_fma_f32 v220, v220, s67, s67
    v_rcp_f32 v219, v219
    v_fma_f32 v221, v221, s67, s67
    v_rcp_f32 v220, v220
    v_fma_f32 v222, v222, s67, s67
    v_rcp_f32 v221, v221
    buffer_load_dwordx4 v250, s[32:35], s57 offen offset:2048 lds
    v_fma_f32 v223, v223, s67, s67
    v_rcp_f32 v222, v222
    v_rcp_f32 v223, v223
    v_mul_f32 v120, v120, v216
    v_mul_f32 v121, v121, v217
    v_mul_f32 v122, v122, v218
    v_mul_f32 v123, v123, v219
    v_mul_f32 v124, v124, v220
    buffer_load_dwordx4 v251, s[32:35], s57 offen offset:3072 lds
    v_mul_f32 v125, v125, v221
    v_mul_f32 v126, v126, v222
    v_mul_f32 v127, v127, v223
    v_cvt_pk_bf16_f32 v208, v120, v121
    v_cvt_pk_bf16_f32 v209, v122, v123
    v_cvt_pk_bf16_f32 v210, v124, v125
    v_cvt_pk_bf16_f32 v211, v126, v127
    s_mov_b32 m0, s53
    s_nop 0
    buffer_load_dwordx4 v246, s[28:31], s56 offen offset:0 lds
    v_mul_f32 v128, v112, v128
    v_exp_f32 v224, -v112
    v_mul_f32 v129, v113, v129
    v_exp_f32 v225, -v113
    v_mul_f32 v130, v114, v130
    v_exp_f32 v226, -v114
    v_mul_f32 v131, v115, v131
    v_exp_f32 v227, -v115
    buffer_load_dwordx4 v246, s[28:31], s56 offen offset:1024 lds
    v_mul_f32 v132, v116, v132
    v_exp_f32 v228, -v116
    v_mul_f32 v133, v117, v133
    v_exp_f32 v229, -v117
    v_mul_f32 v134, v118, v134
    v_exp_f32 v230, -v118
    v_mul_f32 v135, v119, v135
    v_exp_f32 v231, -v119
    buffer_load_dwordx4 v247, s[28:31], s56 offen offset:2048 lds
    v_fma_f32 v224, v224, s67, s67
    v_fma_f32 v225, v225, s67, s67
    v_rcp_f32 v224, v224
    v_fma_f32 v226, v226, s67, s67
    v_rcp_f32 v225, v225
    v_fma_f32 v227, v227, s67, s67
    v_rcp_f32 v226, v226
    v_fma_f32 v228, v228, s67, s67
    buffer_load_dwordx4 v247, s[28:31], s56 offen offset:3072 lds
    v_rcp_f32 v227, v227
    v_fma_f32 v229, v229, s67, s67
    v_rcp_f32 v228, v228
    v_fma_f32 v230, v230, s67, s67
    v_rcp_f32 v229, v229
    v_fma_f32 v231, v231, s67, s67
    v_rcp_f32 v230, v230
    v_rcp_f32 v231, v231
    s_add_u32 s53, s53, 32768
    s_cmp_ge_u32 s53, s61
    s_cselect_b32 s53, s60, s53
    buffer_store_dwordx4 v[208:211], v198, s[28:31], 0 offen offset:0 sc1
    s_waitcnt vmcnt(20)
    s_barrier
    s_and_b32 s57, s58, 15
    s_lshr_b64 s[58:59], s[58:59], 4
    s_add_u32 s57, s57, s55
    s_lshl_b32 s56, s57, 11
    s_mul_i32 s57, s57, 0x20000
    s_add_u32 m0, s53, 16384
    s_nop 0
    buffer_load_dwordx4 v248, s[32:35], s57 offen offset:0 lds
    v_mul_f32 v128, v128, v224
    v_mul_f32 v129, v129, v225
    v_mul_f32 v130, v130, v226
    v_mul_f32 v131, v131, v227
    v_mul_f32 v132, v132, v228
    v_mul_f32 v133, v133, v229
    v_mul_f32 v134, v134, v230
    v_mul_f32 v135, v135, v231
    buffer_load_dwordx4 v249, s[32:35], s57 offen offset:1024 lds
    v_cvt_pk_bf16_f32 v212, v128, v129
    v_cvt_pk_bf16_f32 v213, v130, v131
    v_cvt_pk_bf16_f32 v214, v132, v133
    v_cvt_pk_bf16_f32 v215, v134, v135
    buffer_load_dwordx4 v250, s[32:35], s57 offen offset:2048 lds
    buffer_load_dwordx4 v251, s[32:35], s57 offen offset:3072 lds
    s_mov_b32 m0, s53
    s_nop 0
    buffer_load_dwordx4 v246, s[28:31], s56 offen offset:0 lds
    buffer_load_dwordx4 v246, s[28:31], s56 offen offset:1024 lds
    buffer_load_dwordx4 v247, s[28:31], s56 offen offset:2048 lds
    buffer_load_dwordx4 v247, s[28:31], s56 offen offset:3072 lds
    s_add_u32 s53, s53, 32768
    s_cmp_ge_u32 s53, s61
    s_cselect_b32 s53, s60, s53
    buffer_store_dwordx4 v[212:215], v198, s[28:31], 0 offen offset:1024 sc1
    s_waitcnt vmcnt(20)
    s_barrier
    s_and_b32 s57, s58, 15
    s_lshr_b64 s[58:59], s[58:59], 4
    s_add_u32 s57, s57, s55
    s_lshl_b32 s56, s57, 11
    s_mul_i32 s57, s57, 0x20000
    s_add_u32 m0, s53, 16384
    s_nop 0
    buffer_load_dwordx4 v248, s[32:35], s57 offen offset:0 lds
    buffer_load_dwordx4 v249, s[32:35], s57 offen offset:1024 lds
    buffer_load_dwordx4 v250, s[32:35], s57 offen offset:2048 lds
    buffer_load_dwordx4 v251, s[32:35], s57 offen offset:3072 lds
    s_mov_b32 m0, s53
    s_nop 0
    buffer_load_dwordx4 v246, s[28:31], s56 offen offset:0 lds
    buffer_load_dwordx4 v246, s[28:31], s56 offen offset:1024 lds
    buffer_load_dwordx4 v247, s[28:31], s56 offen offset:2048 lds
    buffer_load_dwordx4 v247, s[28:31], s56 offen offset:3072 lds
    s_add_u32 s53, s53, 32768
    s_cmp_ge_u32 s53, s61
    s_cselect_b32 s53, s60, s53
    s_lshl_b32 s64, s47, 8
    s_lshl_b32 s65, s48, 4
    s_add_u32 s64, s64, s65
    s_lshl_b32 s65, s44, 2
    s_add_u32 s64, s64, s65
    s_add_u32 s64, s64, 0x52000
    v_mov_b32 v2, s0
    s_waitcnt vmcnt(8)
    s_mov_b64 exec, 1
    buffer_store_dword v2, v234, s[28:31], s64 offen sc1
    s_mov_b64 exec, -1
    s_movk_i32 s54, 1
M_Q_loop5:
    s_barrier
    s_and_b32 s57, s58, 15
    s_lshr_b64 s[58:59], s[58:59], 4
    s_add_u32 s57, s57, s55
    s_lshl_b32 s56, s57, 11
    s_mul_i32 s57, s57, 0x20000
    s_add_u32 m0, s53, 16384
    s_nop 0
    buffer_load_dwordx4 v248, s[32:35], s57 offen offset:0 lds
    buffer_load_dwordx4 v249, s[32:35], s57 offen offset:1024 lds
    buffer_load_dwordx4 v250, s[32:35], s57 offen offset:2048 lds
    buffer_load_dwordx4 v251, s[32:35], s57 offen offset:3072 lds
    s_mov_b32 m0, s53
    s_nop 0
    buffer_load_dwordx4 v246, s[28:31], s56 offen offset:0 lds
    buffer_load_dwordx4 v246, s[28:31], s56 offen offset:1024 lds
    buffer_load_dwordx4 v247, s[28:31], s56 offen offset:2048 lds
    buffer_load_dwordx4 v247, s[28:31], s56 offen offset:3072 lds
    s_add_u32 s53, s53, 32768
    s_cmp_ge_u32 s53, s61
    s_cselect_b32 s53, s60, s53
    s_sub_u32 s54, s54, 1
    s_cbranch_scc0 M_Q_loop5
    s_waitcnt vmcnt(17)
    s_barrier
    s_and_b32 s57, s58, 15
    s_lshr_b64 s[58:59], s[58:59], 4
    s_add_u32 s57, s57, s55
    s_lshl_b32 s56, s57, 11
    s_mul_i32 s57, s57, 0x20000
    s_add_u32 m0, s53, 16384
    s_nop 0
    buffer_load_dwordx4 v248, s[32:35], s57 offen offset:0 lds
    buffer_load_dwordx4 v249, s[32:35], s57 offen offset:1024 lds
    buffer_load_dwordx4 v250, s[32:35], s57 offen offset:2048 lds
    buffer_load_dwordx4 v251, s[32:35], s57 offen offset:3072 lds
    s_mov_b32 m0, s53
    s_nop 0
    buffer_load_dwordx4 v246, s[28:31], s56 offen offset:0 lds
    buffer_load_dwordx4 v246, s[28:31], s56 offen offset:1024 lds
    buffer_load_dwordx4 v247, s[28:31], s56 offen offset:2048 lds
    buffer_load_dwordx4 v247, s[28:31], s56 offen offset:3072 lds
    s_add_u32 s53, s53, 32768
    s_cmp_ge_u32 s53, s61
    s_cselect_b32 s53, s60, s53
    s_waitcnt vmcnt(16)
    s_barrier
    s_and_b32 s57, s58, 15
    s_lshr_b64 s[58:59], s[58:59], 4
    s_add_u32 s57, s57, s55
    s_lshl_b32 s56, s57, 11
    s_mul_i32 s57, s57, 0x20000
    s_add_u32 m0, s53, 16384
    s_nop 0
    buffer_load_dwordx4 v248, s[32:35], s57 offen offset:0 lds
    buffer_load_dwordx4 v249, s[32:35], s57 offen offset:1024 lds
    buffer_load_dwordx4 v250, s[32:35], s57 offen offset:2048 lds
    buffer_load_dwordx4 v251, s[32:35], s57 offen offset:3072 lds
    s_mov_b32 m0, s53
    s_nop 0
    buffer_load_dwordx4 v246, s[28:31], s56 offen offset:0 lds
    buffer_load_dwordx4 v246, s[28:31], s56 offen offset:1024 lds
    buffer_load_dwordx4 v247, s[28:31], s56 offen offset:2048 lds
    buffer_load_dwordx4 v247, s[28:31], s56 offen offset:3072 lds
    s_add_u32 s53, s53, 32768
    s_cmp_ge_u32 s53, s61
    s_cselect_b32 s53, s60, s53
    s_waitcnt vmcnt(16)
    s_barrier
    s_lshl_b32 s68, s50, 8
    s_add_u32 s68, s68, 0x52000
    buffer_load_dword v245, v234, s[28:31], s68 offen sc1
    s_and_b32 s57, s58, 15
    s_lshr_b64 s[58:59], s[58:59], 4
    s_add_u32 s57, s57, s55
    s_lshl_b32 s56, s57, 11
    s_mul_i32 s57, s57, 0x20000
    s_add_u32 m0, s53, 16384
    s_nop 0
    buffer_load_dwordx4 v248, s[32:35], s57 offen offset:0 lds
    buffer_load_dwordx4 v249, s[32:35], s57 offen offset:1024 lds
    buffer_load_dwordx4 v250, s[32:35], s57 offen offset:2048 lds
    buffer_load_dwordx4 v251, s[32:35], s57 offen offset:3072 lds
    s_mov_b32 m0, s53
    s_nop 0
    buffer_load_dwordx4 v246, s[28:31], s56 offen offset:0 lds
    buffer_load_dwordx4 v246, s[28:31], s56 offen offset:1024 lds
    buffer_load_dwordx4 v247, s[28:31], s56 offen offset:2048 lds
    buffer_load_dwordx4 v247, s[28:31], s56 offen offset:3072 lds
    s_add_u32 s53, s53, 32768
    s_cmp_ge_u32 s53, s61
    s_cselect_b32 s53, s60, s53
    s_waitcnt vmcnt(17)
    s_barrier
    s_waitcnt vmcnt(8)
    s_mov_b32 s3, 0x40000
M_pb_chk:
    v_cmp_ne_u32 vcc, s0, v245
    s_nop 4
    s_cbranch_vccz M_pb_ok
    s_sub_u32 s3, s3, 1
    s_cbranch_scc1 M_pb_ok
    s_sleep 4
    s_cmp_eq_u32 s69, 0
    s_cbranch_scc1 M_pb_rl
    s_sleep 48
M_pb_rl:
    buffer_load_dword v245, v234, s[28:31], s68 offen sc1
    s_waitcnt vmcnt(0)
    s_branch M_pb_chk
M_pb_ok:
    s_add_u32 s66, s50, s51
    s_and_b32 s66, s66, 3
    s_mov_b32 s58, 0x76453201
    s_mov_b32 s59, 0xecdba89
    s_cmp_eq_u32 s66, 1
    s_cselect_b32 s58, 0x75643120, s58
    s_cselect_b32 s59, 0xdecb9a8, s59
    s_cmp_eq_u32 s66, 2
    s_cselect_b32 s58, 0x67542310, s58
    s_cselect_b32 s59, 0xedcab98, s59
    s_cmp_eq_u32 s66, 3
    s_cselect_b32 s58, 0x86534210, s58
    s_cselect_b32 s59, 0xedbca97, s59
    s_mov_b32 s56, 0x76453201
    s_mov_b32 s57, 0x8
    s_cmp_eq_u32 s66, 1
    s_cselect_b32 s56, 0x75643120, s56
    s_cselect_b32 s57, 0x8, s57
    s_cmp_eq_u32 s66, 2
    s_cselect_b32 s56, 0x67542310, s56
    s_cselect_b32 s57, 0x8, s57
    s_cmp_eq_u32 s66, 3
    s_cselect_b32 s56, 0x86534210, s56
    s_cselect_b32 s57, 0x7, s57
    s_cmp_eq_u32 s49, 0
    s_cselect_b64 s[58:59], s[56:57], s[58:59]
    s_cselect_b32 s55, 47, 32
    s_and_b32 s57, s58, 15
    s_lshr_b64 s[58:59], s[58:59], 4
    s_add_u32 s57, s57, s55
    s_lshl_b32 s56, s57, 11
    s_mul_i32 s57, s57, 0x20000
    s_add_u32 m0, s53, 16384
    s_nop 0
    buffer_load_dwordx4 v248, s[32:35], s57 offen offset:0 lds
    buffer_load_dwordx4 v249, s[32:35], s57 offen offset:1024 lds
    buffer_load_dwordx4 v250, s[32:35], s57 offen offset:2048 lds
    buffer_load_dwordx4 v251, s[32:35], s57 offen offset:3072 lds
    s_mov_b32 m0, s53
    s_nop 0
    buffer_load_dwordx4 v246, s[28:31], s56 offen offset:0 lds
    buffer_load_dwordx4 v246, s[28:31], s56 offen offset:1024 lds
    buffer_load_dwordx4 v247, s[28:31], s56 offen offset:2048 lds
    buffer_load_dwordx4 v247, s[28:31], s56 offen offset:3072 lds
    s_add_u32 s53, s53, 32768
    s_cmp_ge_u32 s53, s61
    s_cselect_b32 s53, s60, s53
    s_barrier
    s_and_b32 s57, s58, 15
    s_lshr_b64 s[58:59], s[58:59], 4
    s_add_u32 s57, s57, s55
    s_lshl_b32 s56, s57, 11
    s_mul_i32 s57, s57, 0x20000
    s_add_u32 m0, s53, 16384
    s_nop 0
    buffer_load_dwordx4 v248, s[32:35], s57 offen offset:0 lds
    buffer_load_dwordx4 v249, s[32:35], s57 offen offset:1024 lds
    buffer_load_dwordx4 v250, s[32:35], s57 offen offset:2048 lds
    buffer_load_dwordx4 v251, s[32:35], s57 offen offset:3072 lds
    s_mov_b32 m0, s53
    s_nop 0
    buffer_load_dwordx4 v246, s[28:31], s56 offen offset:0 lds
    buffer_load_dwordx4 v246, s[28:31], s56 offen offset:1024 lds
    buffer_load_dwordx4 v247, s[28:31], s56 offen offset:2048 lds
    buffer_load_dwordx4 v247, s[28:31], s56 offen offset:3072 lds
    s_add_u32 s53, s53, 32768
    s_cmp_ge_u32 s53, s61
    s_cselect_b32 s53, s60, s53
    s_add_u32 s54, s63, 6
M_Q_loop6:
    s_waitcnt vmcnt(16)
    s_barrier
    s_and_b32 s57, s58, 15
    s_lshr_b64 s[58:59], s[58:59], 4
    s_add_u32 s57, s57, s55
    s_lshl_b32 s56, s57, 11
    s_mul_i32 s57, s57, 0x20000
    s_add_u32 m0, s53, 16384
    s_nop 0
    buffer_load_dwordx4 v248, s[32:35], s57 offen offset:0 lds
    buffer_load_dwordx4 v249, s[32:35], s57 offen offset:1024 lds
    buffer_load_dwordx4 v250, s[32:35], s57 offen offset:2048 lds
    buffer_load_dwordx4 v251, s[32:35], s57 offen offset:3072 lds
    s_mov_b32 m0, s53
    s_nop 0
    buffer_load_dwordx4 v246, s[28:31], s56 offen offset:0 lds
    buffer_load_dwordx4 v246, s[28:31], s56 offen offset:1024 lds
    buffer_load_dwordx4 v247, s[28:31], s56 offen offset:2048 lds
    buffer_load_dwordx4 v247, s[28:31], s56 offen offset:3072 lds
    s_add_u32 s53, s53, 32768
    s_cmp_ge_u32 s53, s61
    s_cselect_b32 s53, s60, s53
    s_sub_u32 s54, s54, 1
    s_cbranch_scc0 M_Q_loop6
    s_waitcnt vmcnt(16)
    s_barrier
    s_waitcnt vmcnt(8)
    s_barrier
    s_waitcnt vmcnt(0)
    s_barrier
    s_branch M_fin
M_Qidle:
    s_waitcnt vmcnt(0)
    s_barrier
    v_and_b32 v2, 255, v0
    s_and_b32 s64, s2, 63
    s_lshl_b32 s64, s64, 8
    v_add_lshl_u32 v243, v2, s64, 6
    s_mov_b32 s40, s16
    s_mov_b32 s41, s17
    s_mov_b32 s42, 0x100000
    s_mov_b32 s43, 0x20000
    s_mov_b32 s64, 0x0
    buffer_load_dword v244, v243, s[40:43], s64 offen
    s_waitcnt vmcnt(0)
    s_mov_b32 s40, s16
    s_mov_b32 s41, s17
    s_mov_b32 s42, 0x200000
    s_mov_b32 s43, 0x20000
    s_mov_b32 s64, 0x100000
    buffer_load_dword v244, v243, s[40:43], s64 offen
    s_waitcnt vmcnt(0)
    s_mov_b32 s40, s16
    s_mov_b32 s41, s17
    s_mov_b32 s42, 0x300000
    s_mov_b32 s43, 0x20000
    s_mov_b32 s64, 0x200000
    buffer_load_dword v244, v243, s[40:43], s64 offen
    s_waitcnt vmcnt(0)
    s_mov_b32 s40, s16
    s_mov_b32 s41, s17
    s_mov_b32 s42, 0x400000
    s_mov_b32 s43, 0x20000
    s_mov_b32 s64, 0x300000
    buffer_load_dword v244, v243, s[40:43], s64 offen
    s_waitcnt vmcnt(0)
    s_mov_b32 s40, s16
    s_mov_b32 s41, s17
    s_mov_b32 s42, 0x500000
    s_mov_b32 s43, 0x20000
    s_mov_b32 s64, 0x400000
    buffer_load_dword v244, v243, s[40:43], s64 offen
    s_waitcnt vmcnt(0)
    s_mov_b32 s40, s16
    s_mov_b32 s41, s17
    s_mov_b32 s42, 0x600000
    s_mov_b32 s43, 0x20000
    s_mov_b32 s64, 0x500000
    buffer_load_dword v244, v243, s[40:43], s64 offen
    s_waitcnt vmcnt(0)
    s_mov_b32 s40, s16
    s_mov_b32 s41, s17
    s_mov_b32 s42, 0x700000
    s_mov_b32 s43, 0x20000
    s_mov_b32 s64, 0x600000
    buffer_load_dword v244, v243, s[40:43], s64 offen
    s_waitcnt vmcnt(0)
    s_waitcnt vmcnt(0)
    s_barrier
    s_barrier
    s_barrier
    s_branch M_Qjoin
M_fin:
M_end:
    s_endpgm

.section .rodata,"a"
.p2align 6
.amdhsa_kernel adaLN_cond__sliding_local_dilated__glu_gated_swiglu__prompt_kernel
  .amdhsa_next_free_vgpr 252
  .amdhsa_next_free_sgpr 102
  .amdhsa_accum_offset 252
  .amdhsa_group_segment_fixed_size 0
  .amdhsa_kernarg_size 96
  .amdhsa_user_sgpr_count 2
  .amdhsa_user_sgpr_kernarg_segment_ptr 1
  .amdhsa_system_sgpr_workgroup_id_x 1
  .amdhsa_float_denorm_mode_32 3
.end_amdhsa_kernel
```

```asm
; @launch grid=(256,1,1) block=(512,1,1) lds=163840
.amdgcn_target "amdgcn-amd-amdhsa--gfx950"
.text
.globl adaLN_cond__sliding_local_dilated__glu_gated_swiglu__prompt_kernel
.p2align 8
.type adaLN_cond__sliding_local_dilated__glu_gated_swiglu__prompt_kernel,@function
adaLN_cond__sliding_local_dilated__glu_gated_swiglu__prompt_kernel:
    s_cmp_ge_u32 s2, 256
    s_cbranch_scc1 M_end
    s_load_dwordx16 s[4:19], s[0:1], 0
    s_load_dwordx8 s[20:27], s[0:1], 64
    v_lshrrev_b32 v2, 6, v0
    v_and_b32 v1, 63, v0
    v_readfirstlane_b32 s44, v2
    s_and_b32 s47, s2, 1
    s_lshl_b32 s47, s47, 3
    s_bfe_u32 s64, s2, 0x30003
    s_add_u32 s47, s47, s64
    s_and_b32 s48, s2, 6
    s_lshl_b32 s48, s48, 1
    s_lshr_b32 s64, s2, 6
    s_add_u32 s48, s48, s64
    s_getpc_b64 s[28:29]
M_pc:
    s_lshr_b32 s64, s2, 3
    s_lshl_b32 s64, s64, 3
    s_add_u32 s64, s64, s44
    s_lshl_b32 s64, s64, 8
    v_lshl_add_u32 v2, v1, 7, s64
    v_min_u32 v2, M_end-M_pc, v2
    s_mov_b64 exec, 3
    global_load_dword v244, v2, s[28:29]
    s_mov_b64 exec, -1
    s_cmp_ge_u32 s44, 4
    s_cbranch_scc1 M_Q
    s_lshr_b32 s70, s47, 1
    s_lshl_b32 s70, s70, 7
    s_and_b32 s71, s47, 1
    s_lshl_b32 s71, s71, 4
    s_add_u32 s71, s71, s48
    s_lshl_b32 s71, s71, 7
    v_lshrrev_b32 v48, 3, v0
    v_add_u32 v48, s70, v48
    v_lshlrev_b32 v9, 1, v48
    s_movk_i32 s64, 12288
    v_mul_lo_u32 v48, s64, v48
    v_and_b32 v8, 7, v0
    v_lshl_add_u32 v48, v8, 4, v48
    v_add_u32 v8, s71, v48
    s_waitcnt lgkmcnt(0)
    s_load_dword s0, s[26:27], 0
    s_mov_b32 s40, s18
    s_mov_b32 s41, s19
    s_mov_b32 s42, 0x800
    s_mov_b32 s43, 0x20000
    s_mov_b32 s36, s20
    s_mov_b32 s37, s21
    s_mov_b32 s38, 0xc00000
    s_mov_b32 s39, 0x20000
    s_barrier
    buffer_load_ushort v20, v9, s[40:43], 0 offen offset:0
    buffer_load_ushort v21, v9, s[40:43], 0 offen offset:64
    buffer_load_ushort v22, v9, s[40:43], 0 offen offset:128
    buffer_load_ushort v23, v9, s[40:43], 0 offen offset:192
    s_mov_b32 s64, 0x0
    buffer_load_dwordx4 v[24:27], v8, s[36:39], s64 offen
    s_mov_b32 s64, 0x60000
    buffer_load_dwordx4 v[28:31], v8, s[36:39], s64 offen
    s_mov_b32 s64, 0xc0000
    buffer_load_dwordx4 v[32:35], v8, s[36:39], s64 offen
    s_mov_b32 s64, 0x120000
    buffer_load_dwordx4 v[36:39], v8, s[36:39], s64 offen
    s_mov_b32 s28, s26
    s_mov_b32 s29, s27
    s_mov_b32 s30, 0x3100000
    s_mov_b32 s31, 0x20000
    s_lshl_b32 s64, s48, 13
    s_add_u32 s64, s64, 0x20000
    s_lshl_b32 s65, s47, 9
    s_add_u32 s62, s64, s65
    s_lshl_b32 s65, s44, 9
    s_add_u32 s64, s64, s65
    v_lshl_add_u32 v16, v1, 3, s64
    s_lshr_b32 s45, s44, 1
    s_and_b32 s46, s44, 1
    s_lshr_b32 s49, s48, 2
    s_and_b32 s51, s48, 3
    s_cmp_ge_u32 s2, 192
    s_cselect_b32 s69, 0x80000000, 0
    s_mov_b32 s67, 0x40053526
    v_lshlrev_b32 v234, 2, v1
    s_mov_b32 s52, 0
    s_lshl_b32 s64, s45, 13
    v_lshl_add_u32 v233, v1, 4, s64
    v_lshrrev_b32 v3, 4, v1
    v_bfe_u32 v2, v1, 2, 2
    v_lshl_add_u32 v4, v3, 3, v2
    v_mul_u32_u24 v4, 384, v4
    v_and_b32 v5, 3, v1
    v_lshl_add_u32 v4, v5, 3, v4
    v_add_u32 v4, 18432, v4
    v_bfe_u32 v2, v1, 3, 2
    s_lshl_b32 s64, s46, 1
    v_xor_b32 v2, s64, v2
    v_lshl_add_u32 v239, v2, 5, v4
    v_xor_b32 v2, 1, v2
    v_lshl_add_u32 v240, v2, 5, v4
    v_and_b32 v2, 15, v1
    v_lshlrev_b32 v3, 2, v3
    v_sub_u32 v3, v2, v3
    s_mov_b32 s64, 0x80000001
    v_sub_u32 v4, -2, v3
    v_and_b32 v4, s64, v4
    v_cmp_eq_u32 s[72:73], 0, v4
    v_subrev_u32 v4, 0, v3
    v_and_b32 v4, s64, v4
    v_cmp_eq_u32 s[80:81], 0, v4
    v_sub_u32 v4, -1, v3
    v_and_b32 v4, s64, v4
    v_cmp_eq_u32 s[74:75], 0, v4
    v_subrev_u32 v4, 1, v3
    v_and_b32 v4, s64, v4
    v_cmp_eq_u32 s[82:83], 0, v4
    v_sub_u32 v4, 0, v3
    v_and_b32 v4, s64, v4
    v_cmp_eq_u32 s[76:77], 0, v4
    v_subrev_u32 v4, 2, v3
    v_and_b32 v4, s64, v4
    v_cmp_eq_u32 s[84:85], 0, v4
    v_sub_u32 v4, 1, v3
    v_and_b32 v4, s64, v4
    v_cmp_eq_u32 s[78:79], 0, v4
    v_subrev_u32 v4, 3, v3
    v_and_b32 v4, s64, v4
    v_cmp_eq_u32 s[86:87], 0, v4
    s_lshl_b32 s64, s47, 1
    s_add_u32 s64, s64, s45
    s_cmp_eq_u32 s64, 0
    s_cselect_b64 s[88:89], 0, s[72:73]
    s_cselect_b64 s[90:91], 0, s[74:75]
    s_cselect_b64 s[92:93], 0, s[76:77]
    s_cselect_b64 s[94:95], 0, s[78:79]
    s_mul_i32 s64, s64, 131072
    s_lshl_b32 s65, s48, 11
    s_add_u32 s64, s64, s65
    s_lshl_b32 s65, s46, 10
    s_add_u32 s64, s64, s65
    s_add_u32 s64, s64, 0x600000
    v_lshl_add_u32 v237, v1, 4, s64
    s_lshl_b32 s64, s2, 8
    v_add_lshl_u32 v243, v0, s64, 5
    s_lshl_b32 s64, s47, 3
    s_lshl_b32 s65, s44, 1
    s_add_u32 s64, s64, s65
    s_mul_i32 s64, s64, 32768
    s_add_u32 s64, s64, 0x600000
    v_lshl_add_u32 v208, v1, 4, s64
    v_add_u32 v209, 30720, v208
    v_lshrrev_b32 v3, 3, v1
    s_lshl_b32 s64, s44, 4
    v_add_lshl_u32 v2, v3, s64, 11
    s_lshl_b32 s64, s48, 7
    v_add_u32 v2, s64, v2
    v_and_b32 v3, 6, v3
    v_and_b32 v4, 7, v1
    v_xor_b32 v3, v3, v4
    v_lshl_add_u32 v210, v3, 4, v2
    v_add_u32 v211, 15360, v210
    s_lshl_b32 s65, s48, 8
    v_lshrrev_b32 v3, 4, v1
    s_lshl_b32 s64, s44, 4
    v_add_u32 v2, s64, v3
    s_movk_i32 s64, 7168
    v_mul_u32_u24 v2, s64, v2
    v_add_u32 v2, s65, v2
    v_lshlrev_b32 v3, 1, v3
    v_and_b32 v4, 15, v1
    v_xor_b32 v3, v3, v4
    v_lshl_add_u32 v212, v3, 4, v2
    v_add_u32 v214, 55296, v212
    v_xor_b32 v3, 8, v3
    v_lshl_add_u32 v213, v3, 4, v2
    v_add_u32 v213, 27648, v213
    v_add_u32 v215, 55296, v213
    v_add_u32 v232, s52, v233
    v_add_u32 v235, s52, v239
    v_add_u32 v236, s52, v240
    s_lshl_b32 s60, s44, 12
    s_add_u32 s61, s60, 147456
    s_add_u32 s53, s60, 49152
    s_lshl_b32 s70, s44, 11
    s_sub_u32 s70, 16384, s70
    s_bfe_u32 s66, s2, 0x30003
    s_lshr_b32 s55, s2, 6
    s_add_u32 s66, s66, s55
    s_and_b32 s66, s66, 3
    s_mov_b32 s58, 0x76453210
    s_mov_b32 s59, 0xfecdba89
    s_cmp_eq_u32 s66, 1
    s_cselect_b32 s58, 0x75643120, s58
    s_cselect_b32 s59, 0xfdecb9a8, s59
    s_cmp_eq_u32 s66, 2
    s_cselect_b32 s58, 0x67542310, s58
    s_cselect_b32 s59, 0xefdcab98, s59
    s_cmp_eq_u32 s66, 3
    s_cselect_b32 s58, 0x86534210, s58
    s_cselect_b32 s59, 0xfedbca97, s59
    s_mov_b32 s32, s8
    s_mov_b32 s33, s9
    s_mov_b32 s34, 0x200000
    s_mov_b32 s35, 0x20000
    s_waitcnt lgkmcnt(0)
    s_add_u32 s0, s0, 1
    s_setprio 2
    s_barrier
    s_waitcnt vmcnt(4)
    v_lshlrev_b32 v20, 16, v20
    v_lshlrev_b32 v21, 16, v21
    v_lshlrev_b32 v22, 16, v22
    v_lshlrev_b32 v23, 16, v23
    v_mul_f32 v48, 0xbfb8aa3b, v20
    v_mul_f32 v49, 0xbfb8aa3b, v21
    v_mul_f32 v50, 0xbfb8aa3b, v22
    v_mul_f32 v51, 0xbfb8aa3b, v23
    v_exp_f32 v48, v48
    v_exp_f32 v49, v49
    v_exp_f32 v50, v50
    v_exp_f32 v51, v51
    v_add_f32 v48, 1.0, v48
    v_add_f32 v49, 1.0, v49
    v_add_f32 v50, 1.0, v50
    v_add_f32 v51, 1.0, v51
    v_rcp_f32 v48, v48
    v_rcp_f32 v49, v49
    v_rcp_f32 v50, v50
    v_rcp_f32 v51, v51
    v_mul_f32 v20, v20, v48
    v_mul_f32 v21, v21, v49
    v_mul_f32 v22, v22, v50
    v_mul_f32 v23, v23, v51
    v_cvt_pk_bf16_f32 v48, v20, v20
    v_lshlrev_b32 v20, 16, v48
    v_cvt_pk_bf16_f32 v49, v21, v21
    v_lshlrev_b32 v21, 16, v49
    v_cvt_pk_bf16_f32 v50, v22, v22
    v_lshlrev_b32 v22, 16, v50
    v_cvt_pk_bf16_f32 v51, v23, v23
    v_lshlrev_b32 v23, 16, v51
    s_waitcnt vmcnt(3)
    v_lshlrev_b32 v48, 16, v24
    v_and_b32 v49, 0xffff0000, v24
    v_lshlrev_b32 v50, 16, v25
    v_and_b32 v51, 0xffff0000, v25
    v_lshlrev_b32 v52, 16, v26
    v_and_b32 v53, 0xffff0000, v26
    v_lshlrev_b32 v54, 16, v27
    v_and_b32 v55, 0xffff0000, v27
    v_mul_f32 v40, v20, v48
    v_mul_f32 v41, v20, v49
    v_mul_f32 v42, v20, v50
    v_mul_f32 v43, v20, v51
    v_mul_f32 v44, v20, v52
    v_mul_f32 v45, v20, v53
    v_mul_f32 v46, v20, v54
    v_mul_f32 v47, v20, v55
    s_waitcnt vmcnt(2)
    v_lshlrev_b32 v48, 16, v28
    v_and_b32 v49, 0xffff0000, v28
    v_lshlrev_b32 v50, 16, v29
    v_and_b32 v51, 0xffff0000, v29
    v_lshlrev_b32 v52, 16, v30
    v_and_b32 v53, 0xffff0000, v30
    v_lshlrev_b32 v54, 16, v31
    v_and_b32 v55, 0xffff0000, v31
    v_fmac_f32 v40, v21, v48
    v_fmac_f32 v41, v21, v49
    v_fmac_f32 v42, v21, v50
    v_fmac_f32 v43, v21, v51
    v_fmac_f32 v44, v21, v52
    v_fmac_f32 v45, v21, v53
    v_fmac_f32 v46, v21, v54
    v_fmac_f32 v47, v21, v55
    s_waitcnt vmcnt(1)
    v_lshlrev_b32 v48, 16, v32
    v_and_b32 v49, 0xffff0000, v32
    v_lshlrev_b32 v50, 16, v33
    v_and_b32 v51, 0xffff0000, v33
    v_lshlrev_b32 v52, 16, v34
    v_and_b32 v53, 0xffff0000, v34
    v_lshlrev_b32 v54, 16, v35
    v_and_b32 v55, 0xffff0000, v35
    v_fmac_f32 v40, v22, v48
    v_fmac_f32 v41, v22, v49
    v_fmac_f32 v42, v22, v50
    v_fmac_f32 v43, v22, v51
    v_fmac_f32 v44, v22, v52
    v_fmac_f32 v45, v22, v53
    v_fmac_f32 v46, v22, v54
    v_fmac_f32 v47, v22, v55
    s_waitcnt vmcnt(0)
    v_lshlrev_b32 v48, 16, v36
    v_and_b32 v49, 0xffff0000, v36
    v_lshlrev_b32 v50, 16, v37
    v_and_b32 v51, 0xffff0000, v37
    v_lshlrev_b32 v52, 16, v38
    v_and_b32 v53, 0xffff0000, v38
    v_lshlrev_b32 v54, 16, v39
    v_and_b32 v55, 0xffff0000, v39
    v_fmac_f32 v40, v23, v48
    v_fmac_f32 v41, v23, v49
    v_fmac_f32 v42, v23, v50
    v_fmac_f32 v43, v23, v51
    v_fmac_f32 v44, v23, v52
    v_fmac_f32 v45, v23, v53
    v_fmac_f32 v46, v23, v54
    v_fmac_f32 v47, v23, v55
    v_add_f32_dpp v40, v40, v40 row_ror:8 row_mask:0xf bank_mask:0xf
    v_add_f32_dpp v41, v41, v41 row_ror:8 row_mask:0xf bank_mask:0xf
    v_add_f32_dpp v42, v42, v42 row_ror:8 row_mask:0xf bank_mask:0xf
    v_add_f32_dpp v43, v43, v43 row_ror:8 row_mask:0xf bank_mask:0xf
    v_add_f32_dpp v44, v44, v44 row_ror:8 row_mask:0xf bank_mask:0xf
    v_add_f32_dpp v45, v45, v45 row_ror:8 row_mask:0xf bank_mask:0xf
    v_add_f32_dpp v46, v46, v46 row_ror:8 row_mask:0xf bank_mask:0xf
    v_add_f32_dpp v47, v47, v47 row_ror:8 row_mask:0xf bank_mask:0xf
    v_mov_b32 v48, v40
    v_mov_b32 v49, v41
    v_mov_b32 v50, v42
    v_mov_b32 v51, v43
    v_mov_b32 v52, v44
    v_mov_b32 v53, v45
    v_mov_b32 v54, v46
    v_mov_b32 v55, v47
    v_permlane32_swap_b32 v40, v48
    v_permlane32_swap_b32 v41, v49
    v_permlane32_swap_b32 v42, v50
    v_permlane32_swap_b32 v43, v51
    v_permlane32_swap_b32 v44, v52
    v_permlane32_swap_b32 v45, v53
    v_permlane32_swap_b32 v46, v54
    v_permlane32_swap_b32 v47, v55
    v_add_f32 v40, v40, v48
    v_add_f32 v41, v41, v49
    v_add_f32 v42, v42, v50
    v_add_f32 v43, v43, v51
    v_add_f32 v44, v44, v52
    v_add_f32 v45, v45, v53
    v_add_f32 v46, v46, v54
    v_add_f32 v47, v47, v55
    v_mov_b32 v48, v40
    v_mov_b32 v49, v41
    v_mov_b32 v50, v42
    v_mov_b32 v51, v43
    v_mov_b32 v52, v44
    v_mov_b32 v53, v45
    v_mov_b32 v54, v46
    v_mov_b32 v55, v47
    v_permlane16_swap_b32 v40, v48
    v_permlane16_swap_b32 v41, v49
    v_permlane16_swap_b32 v42, v50
    v_permlane16_swap_b32 v43, v51
    v_permlane16_swap_b32 v44, v52
    v_permlane16_swap_b32 v45, v53
    v_permlane16_swap_b32 v46, v54
    v_permlane16_swap_b32 v47, v55
    v_add_f32 v40, v40, v48
    v_add_f32 v41, v41, v49
    v_add_f32 v42, v42, v50
    v_add_f32 v43, v43, v51
    v_add_f32 v44, v44, v52
    v_add_f32 v45, v45, v53
    v_add_f32 v46, v46, v54
    v_add_f32 v47, v47, v55
    s_lshl_b32 s64, s44, 8
    s_add_u32 s64, s64, 147456
    v_and_b32 v48, 7, v0
    v_lshl_add_u32 v48, v48, 5, s64
    ds_write_b128 v48, v[40:43]
    ds_write_b128 v48, v[44:47] offset:16
    v_mov_b32 v49, 148492
    v_mov_b32 v50, 1
    s_waitcnt lgkmcnt(0)
    s_mov_b64 exec, 1
    ds_add_rtn_u32 v51, v49, v50
    s_mov_b64 exec, -1
    v_add_u32 v49, 147456, v234
    s_waitcnt lgkmcnt(0)
    ds_read_b32 v40, v49 offset:0
    ds_read_b32 v41, v49 offset:256
    ds_read_b32 v42, v49 offset:512
    ds_read_b32 v43, v49 offset:768
    v_readfirstlane_b32 s64, v51
    s_nop 3
    s_cmp_eq_u32 s64, 3
    s_cselect_b32 s62, s62, 0x80000000
    v_lshl_add_u32 v48, v1, 3, s62
    s_waitcnt lgkmcnt(0)
    v_add_f32 v40, v40, v41
    v_add_f32 v42, v42, v43
    v_add_f32 v40, v40, v42
    v_mov_b32 v41, s0
    buffer_store_dwordx2 v[40:41], v48, s[28:31], 0 offen sc1
    s_cmp_ge_u32 s44, 2
    s_cbranch_scc1 M_spf
    s_movk_i32 s63, 4096
    buffer_load_dwordx2 v[88:89], v16, s[28:31], 0 offen offset:0 sc1
    buffer_load_dwordx2 v[90:91], v16, s[28:31], 0 offen offset:1024 sc1
    buffer_load_dwordx2 v[92:93], v16, s[28:31], 0 offen offset:2048 sc1
    buffer_load_dwordx2 v[94:95], v16, s[28:31], 0 offen offset:3072 sc1
    buffer_load_dwordx2 v[96:97], v16, s[28:31], s63 offen offset:0 sc1
    buffer_load_dwordx2 v[98:99], v16, s[28:31], s63 offen offset:1024 sc1
    buffer_load_dwordx2 v[100:101], v16, s[28:31], s63 offen offset:2048 sc1
    buffer_load_dwordx2 v[102:103], v16, s[28:31], s63 offen offset:3072 sc1
    s_waitcnt vmcnt(0)
    s_mov_b32 s3, 0x40000
M_pt_chk:
    v_xor_b32 v48, s0, v89
    v_xor_b32 v49, s0, v91
    v_xor_b32 v50, s0, v93
    v_xor_b32 v51, s0, v95
    v_xor_b32 v52, s0, v97
    v_xor_b32 v53, s0, v99
    v_xor_b32 v54, s0, v101
    v_xor_b32 v55, s0, v103
    v_or3_b32 v48, v48, v49, v50
    v_or3_b32 v48, v48, v51, v52
    v_or3_b32 v48, v48, v53, v54
    v_or_b32 v48, v48, v55
    v_cmp_ne_u32 vcc, 0, v48
    s_nop 4
    s_cbranch_vccz M_pt_ok
    s_sub_u32 s3, s3, 1
    s_cbranch_scc1 M_pt_ok
    v_cmp_ne_u32 vcc, s0, v89
    s_nop 4
    s_mov_b64 exec, vcc
    buffer_load_dwordx2 v[88:89], v16, s[28:31], 0 offen offset:0 sc1
    s_mov_b64 exec, -1
    v_cmp_ne_u32 vcc, s0, v91
    s_nop 4
    s_mov_b64 exec, vcc
    buffer_load_dwordx2 v[90:91], v16, s[28:31], 0 offen offset:1024 sc1
    s_mov_b64 exec, -1
    v_cmp_ne_u32 vcc, s0, v93
    s_nop 4
    s_mov_b64 exec, vcc
    buffer_load_dwordx2 v[92:93], v16, s[28:31], 0 offen offset:2048 sc1
    s_mov_b64 exec, -1
    v_cmp_ne_u32 vcc, s0, v95
    s_nop 4
    s_mov_b64 exec, vcc
    buffer_load_dwordx2 v[94:95], v16, s[28:31], 0 offen offset:3072 sc1
    s_mov_b64 exec, -1
    v_cmp_ne_u32 vcc, s0, v97
    s_nop 4
    s_mov_b64 exec, vcc
    buffer_load_dwordx2 v[96:97], v16, s[28:31], s63 offen offset:0 sc1
    s_mov_b64 exec, -1
    v_cmp_ne_u32 vcc, s0, v99
    s_nop 4
    s_mov_b64 exec, vcc
    buffer_load_dwordx2 v[98:99], v16, s[28:31], s63 offen offset:1024 sc1
    s_mov_b64 exec, -1
    v_cmp_ne_u32 vcc, s0, v101
    s_nop 4
    s_mov_b64 exec, vcc
    buffer_load_dwordx2 v[100:101], v16, s[28:31], s63 offen offset:2048 sc1
    s_mov_b64 exec, -1
    v_cmp_ne_u32 vcc, s0, v103
    s_nop 4
    s_mov_b64 exec, vcc
    buffer_load_dwordx2 v[102:103], v16, s[28:31], s63 offen offset:3072 sc1
    s_mov_b64 exec, -1
    s_waitcnt vmcnt(0)
    s_branch M_pt_chk
M_pt_ok:
    v_add_f32 v88, v88, v90
    v_add_f32 v92, v92, v94
    v_add_f32 v96, v96, v98
    v_add_f32 v100, v100, v102
    v_add_f32 v88, v88, v92
    v_add_f32 v96, v96, v100
    v_add_f32 v88, v88, v96
    v_cvt_pk_bf16_f32 v89, v88, v88
    v_lshlrev_b32 v88, 16, v89
    s_cmp_eq_u32 s44, 1
    s_cselect_b32 s64, 1.0, 0
    v_add_f32 v88, s64, v88
    v_cvt_pk_bf16_f32 v89, v88, v88
    v_lshlrev_b32 v88, 16, v89
    s_lshl_b32 s64, s44, 8
    s_add_u32 s64, s64, 149504
    v_add_u32 v2, s64, v234
    ds_write_b32 v2, v88
    s_waitcnt lgkmcnt(0)
    s_branch M_tbl
M_spf:
    s_lshl_b32 s64, s2, 1
    s_add_u32 s64, s64, s46
    s_mul_i32 s65, s64, 12288
    s_add_u32 s56, s6, s65
    s_addc_u32 s57, s7, 0
    s_load_dword s99, s[56:57], 384
    s_load_dword s99, s[56:57], 448
    s_load_dword s99, s[56:57], 1408
    s_load_dword s99, s[56:57], 1472
    s_load_dword s99, s[56:57], 2432
    s_load_dword s99, s[56:57], 2496
    s_load_dword s99, s[56:57], 3456
    s_load_dword s99, s[56:57], 3520
    s_load_dword s99, s[56:57], 4480
    s_load_dword s99, s[56:57], 4544
    s_load_dword s99, s[56:57], 5504
    s_load_dword s99, s[56:57], 5568
    s_load_dword s99, s[56:57], 6528
    s_load_dword s99, s[56:57], 6592
    s_load_dword s99, s[56:57], 7552
    s_load_dword s99, s[56:57], 7616
    s_load_dword s99, s[56:57], 8576
    s_load_dword s99, s[56:57], 8640
    s_load_dword s99, s[56:57], 9600
    s_load_dword s99, s[56:57], 9664
    s_load_dword s99, s[56:57], 10624
    s_load_dword s99, s[56:57], 10688
    s_load_dword s99, s[56:57], 11648
    s_load_dword s99, s[56:57], 11712
M_tbl:
    s_barrier
    s_or_b32 s64, s2, s44
    s_cmp_eq_u32 s64, 0
    s_cselect_b32 s64, 0, 0x80000000
    v_mov_b32 v2, s64
    v_mov_b32 v3, s0
    s_barrier
    ds_read_b128 v[120:123], v232 offset:0
    ds_read_b64_tr_b16 v[148:149], v235 offset:128
    ds_read_b64_tr_b16 v[150:151], v235 offset:1664
    ds_read_b64_tr_b16 v[152:153], v236 offset:128
    ds_read_b64_tr_b16 v[154:155], v236 offset:1664
    ds_read_b64_tr_b16 v[156:157], v235 offset:256
    ds_read_b64_tr_b16 v[158:159], v235 offset:1792
    ds_read_b64_tr_b16 v[160:161], v236 offset:256
    ds_read_b64_tr_b16 v[162:163], v236 offset:1792
    ds_read_b128 v[124:127], v232 offset:2048
    ds_read_b64_tr_b16 v[140:141], v235 offset:0
    ds_read_b64_tr_b16 v[142:143], v235 offset:1536
    ds_read_b64_tr_b16 v[144:145], v236 offset:0
    ds_read_b64_tr_b16 v[146:147], v236 offset:1536
    ds_read_b128 v[128:131], v232 offset:4096
    ds_read_b128 v[132:135], v232 offset:6144
    ds_read_b128 v[136:139], v232 offset:8192
    s_add_u32 s52, s52, 49152
    s_cmp_ge_u32 s52, 147456
    s_cselect_b32 s52, 0, s52
    s_waitcnt lgkmcnt(0)
    v_mfma_f32_16x16x32_bf16 v[40:43], v[148:151], v[120:123], 0
    ds_read_b128 v[164:167], v232 offset:1024
    v_mfma_f32_16x16x32_bf16 v[44:47], v[152:155], v[120:123], 0
    ds_read_b64_tr_b16 v[192:193], v235 offset:12416
    v_mfma_f32_16x16x32_bf16 v[80:83], v[120:123], v[156:159], 0
    ds_read_b64_tr_b16 v[194:195], v235 offset:13952
    v_mfma_f32_16x16x32_bf16 v[84:87], v[120:123], v[160:163], 0
    ds_read_b64_tr_b16 v[196:197], v236 offset:12416
    v_mfma_f32_16x16x32_bf16 v[48:51], v[148:151], v[124:127], 0
    ds_read_b64_tr_b16 v[198:199], v236 offset:13952
    v_mfma_f32_16x16x32_bf16 v[52:55], v[152:155], v[124:127], 0
    v_mfma_f32_16x16x32_bf16 v[88:91], v[124:127], v[156:159], 0
    ds_read_b64_tr_b16 v[200:201], v235 offset:12544
    v_mfma_f32_16x16x32_bf16 v[92:95], v[124:127], v[160:163], 0
    ds_read_b64_tr_b16 v[202:203], v235 offset:14080
    v_mfma_f32_16x16x32_bf16 v[8:11], v[140:143], v[124:127], 0
    ds_read_b64_tr_b16 v[204:205], v236 offset:12544
    v_mfma_f32_16x16x32_bf16 v[12:15], v[144:147], v[124:127], 0
    ds_read_b64_tr_b16 v[206:207], v236 offset:14080
    v_mfma_f32_16x16x32_bf16 v[56:59], v[148:151], v[128:131], 0
    v_mfma_f32_16x16x32_bf16 v[60:63], v[152:155], v[128:131], 0
    ds_read_b128 v[168:171], v232 offset:3072
    v_mfma_f32_16x16x32_bf16 v[96:99], v[128:131], v[156:159], 0
    ds_read_b64_tr_b16 v[184:185], v235 offset:12288
    v_mfma_f32_16x16x32_bf16 v[100:103], v[128:131], v[160:163], 0
    ds_read_b64_tr_b16 v[186:187], v235 offset:13824
    v_mfma_f32_16x16x32_bf16 v[16:19], v[140:143], v[128:131], 0
    ds_read_b64_tr_b16 v[188:189], v236 offset:12288
    v_mfma_f32_16x16x32_bf16 v[20:23], v[144:147], v[128:131], 0
    v_mfma_f32_16x16x32_bf16 v[64:67], v[148:151], v[132:135], 0
    ds_read_b64_tr_b16 v[190:191], v236 offset:13824
    v_mfma_f32_16x16x32_bf16 v[68:71], v[152:155], v[132:135], 0
    ds_read_b128 v[172:175], v232 offset:5120
    v_mfma_f32_16x16x32_bf16 v[104:107], v[132:135], v[156:159], 0
    ds_read_b128 v[176:179], v232 offset:7168
    v_mfma_f32_16x16x32_bf16 v[108:111], v[132:135], v[160:163], 0
    ds_read_b128 v[180:183], v232 offset:9216
    v_mfma_f32_16x16x32_bf16 v[24:27], v[140:143], v[132:135], 0
    v_mfma_f32_16x16x32_bf16 v[28:31], v[144:147], v[132:135], 0
    v_add_u32 v232, s52, v233
    v_mfma_f32_16x16x32_bf16 v[72:75], v[148:151], v[136:139], 0
    v_mfma_f32_16x16x32_bf16 v[76:79], v[152:155], v[136:139], 0
    v_add_u32 v235, s52, v239
    v_mfma_f32_16x16x32_bf16 v[112:115], v[136:139], v[156:159], 0
    v_mfma_f32_16x16x32_bf16 v[116:119], v[136:139], v[160:163], 0
    v_add_u32 v236, s52, v240
    v_mfma_f32_16x16x32_bf16 v[32:35], v[140:143], v[136:139], 0
    v_mfma_f32_16x16x32_bf16 v[36:39], v[144:147], v[136:139], 0
    s_waitcnt lgkmcnt(0)
    v_mfma_f32_16x16x32_bf16 v[40:43], v[192:195], v[164:167], v[40:43]
    v_mfma_f32_16x16x32_bf16 v[44:47], v[196:199], v[164:167], v[44:47]
    v_mfma_f32_16x16x32_bf16 v[80:83], v[164:167], v[200:203], v[80:83]
    v_mfma_f32_16x16x32_bf16 v[84:87], v[164:167], v[204:207], v[84:87]
    v_mfma_f32_16x16x32_bf16 v[48:51], v[192:195], v[168:171], v[48:51]
    v_mfma_f32_16x16x32_bf16 v[52:55], v[196:199], v[168:171], v[52:55]
    v_mfma_f32_16x16x32_bf16 v[88:91], v[168:171], v[200:203], v[88:91]
    v_mfma_f32_16x16x32_bf16 v[92:95], v[168:171], v[204:207], v[92:95]
    v_mfma_f32_16x16x32_bf16 v[8:11], v[184:187], v[168:171], v[8:11]
    v_mfma_f32_16x16x32_bf16 v[12:15], v[188:191], v[168:171], v[12:15]
    v_mfma_f32_16x16x32_bf16 v[56:59], v[192:195], v[172:175], v[56:59]
    v_mfma_f32_16x16x32_bf16 v[60:63], v[196:199], v[172:175], v[60:63]
    v_mfma_f32_16x16x32_bf16 v[96:99], v[172:175], v[200:203], v[96:99]
    v_mfma_f32_16x16x32_bf16 v[100:103], v[172:175], v[204:207], v[100:103]
    v_mfma_f32_16x16x32_bf16 v[16:19], v[184:187], v[172:175], v[16:19]
    v_mfma_f32_16x16x32_bf16 v[20:23], v[188:191], v[172:175], v[20:23]
    v_mfma_f32_16x16x32_bf16 v[64:67], v[192:195], v[176:179], v[64:67]
    v_mfma_f32_16x16x32_bf16 v[68:71], v[196:199], v[176:179], v[68:71]
    v_mfma_f32_16x16x32_bf16 v[104:107], v[176:179], v[200:203], v[104:107]
    v_mfma_f32_16x16x32_bf16 v[108:111], v[176:179], v[204:207], v[108:111]
    v_mfma_f32_16x16x32_bf16 v[24:27], v[184:187], v[176:179], v[24:27]
    v_mfma_f32_16x16x32_bf16 v[28:31], v[188:191], v[176:179], v[28:31]
    v_mfma_f32_16x16x32_bf16 v[72:75], v[192:195], v[180:183], v[72:75]
    v_mfma_f32_16x16x32_bf16 v[76:79], v[196:199], v[180:183], v[76:79]
    v_mfma_f32_16x16x32_bf16 v[112:115], v[180:183], v[200:203], v[112:115]
    v_mfma_f32_16x16x32_bf16 v[116:119], v[180:183], v[204:207], v[116:119]
    v_mfma_f32_16x16x32_bf16 v[32:35], v[184:187], v[180:183], v[32:35]
    v_mfma_f32_16x16x32_bf16 v[36:39], v[188:191], v[180:183], v[36:39]
    s_barrier
    s_mov_b64 exec, 1
    buffer_store_dword v3, v2, s[28:31], 0 offen sc1
    s_mov_b64 exec, -1
    s_barrier
    ds_read_b128 v[120:123], v232 offset:0
    ds_read_b64_tr_b16 v[148:149], v235 offset:128
    ds_read_b64_tr_b16 v[150:151], v235 offset:1664
    ds_read_b64_tr_b16 v[152:153], v236 offset:128
    ds_read_b64_tr_b16 v[154:155], v236 offset:1664
    ds_read_b64_tr_b16 v[156:157], v235 offset:256
    ds_read_b64_tr_b16 v[158:159], v235 offset:1792
    ds_read_b64_tr_b16 v[160:161], v236 offset:256
    ds_read_b64_tr_b16 v[162:163], v236 offset:1792
    ds_read_b128 v[124:127], v232 offset:2048
    ds_read_b64_tr_b16 v[140:141], v235 offset:0
    ds_read_b64_tr_b16 v[142:143], v235 offset:1536
    ds_read_b64_tr_b16 v[144:145], v236 offset:0
    ds_read_b64_tr_b16 v[146:147], v236 offset:1536
    ds_read_b128 v[128:131], v232 offset:4096
    ds_read_b128 v[132:135], v232 offset:6144
    ds_read_b128 v[136:139], v232 offset:8192
    s_add_u32 s52, s52, 49152
    s_cmp_ge_u32 s52, 147456
    s_cselect_b32 s52, 0, s52
    s_waitcnt lgkmcnt(0)
    v_mfma_f32_16x16x32_bf16 v[40:43], v[148:151], v[120:123], v[40:43]
    ds_read_b128 v[164:167], v232 offset:1024
    v_mfma_f32_16x16x32_bf16 v[44:47], v[152:155], v[120:123], v[44:47]
    ds_read_b64_tr_b16 v[192:193], v235 offset:12416
    v_mfma_f32_16x16x32_bf16 v[80:83], v[120:123], v[156:159], v[80:83]
    ds_read_b64_tr_b16 v[194:195], v235 offset:13952
    v_mfma_f32_16x16x32_bf16 v[84:87], v[120:123], v[160:163], v[84:87]
    ds_read_b64_tr_b16 v[196:197], v236 offset:12416
    v_mfma_f32_16x16x32_bf16 v[48:51], v[148:151], v[124:127], v[48:51]
    ds_read_b64_tr_b16 v[198:199], v236 offset:13952
    v_mfma_f32_16x16x32_bf16 v[52:55], v[152:155], v[124:127], v[52:55]
    v_mfma_f32_16x16x32_bf16 v[88:91], v[124:127], v[156:159], v[88:91]
    ds_read_b64_tr_b16 v[200:201], v235 offset:12544
    v_mfma_f32_16x16x32_bf16 v[92:95], v[124:127], v[160:163], v[92:95]
    ds_read_b64_tr_b16 v[202:203], v235 offset:14080
    v_mfma_f32_16x16x32_bf16 v[8:11], v[140:143], v[124:127], v[8:11]
    ds_read_b64_tr_b16 v[204:205], v236 offset:12544
    v_mfma_f32_16x16x32_bf16 v[12:15], v[144:147], v[124:127], v[12:15]
    ds_read_b64_tr_b16 v[206:207], v236 offset:14080
    v_mfma_f32_16x16x32_bf16 v[56:59], v[148:151], v[128:131], v[56:59]
    v_mfma_f32_16x16x32_bf16 v[60:63], v[152:155], v[128:131], v[60:63]
    ds_read_b128 v[168:171], v232 offset:3072
    v_mfma_f32_16x16x32_bf16 v[96:99], v[128:131], v[156:159], v[96:99]
    ds_read_b64_tr_b16 v[184:185], v235 offset:12288
    v_mfma_f32_16x16x32_bf16 v[100:103], v[128:131], v[160:163], v[100:103]
    ds_read_b64_tr_b16 v[186:187], v235 offset:13824
    v_mfma_f32_16x16x32_bf16 v[16:19], v[140:143], v[128:131], v[16:19]
    s_movk_i32 s54, 13
M_P_loop0:
    ds_read_b64_tr_b16 v[188:189], v236 offset:12288
    v_mfma_f32_16x16x32_bf16 v[20:23], v[144:147], v[128:131], v[20:23]
    v_mfma_f32_16x16x32_bf16 v[64:67], v[148:151], v[132:135], v[64:67]
    ds_read_b64_tr_b16 v[190:191], v236 offset:13824
    v_mfma_f32_16x16x32_bf16 v[68:71], v[152:155], v[132:135], v[68:71]
    ds_read_b128 v[172:175], v232 offset:5120
    v_mfma_f32_16x16x32_bf16 v[104:107], v[132:135], v[156:159], v[104:107]
    ds_read_b128 v[176:179], v232 offset:7168
    v_mfma_f32_16x16x32_bf16 v[108:111], v[132:135], v[160:163], v[108:111]
    ds_read_b128 v[180:183], v232 offset:9216
    v_mfma_f32_16x16x32_bf16 v[24:27], v[140:143], v[132:135], v[24:27]
    v_mfma_f32_16x16x32_bf16 v[28:31], v[144:147], v[132:135], v[28:31]
    v_add_u32 v232, s52, v233
    v_mfma_f32_16x16x32_bf16 v[72:75], v[148:151], v[136:139], v[72:75]
    v_mfma_f32_16x16x32_bf16 v[76:79], v[152:155], v[136:139], v[76:79]
    v_add_u32 v235, s52, v239
    v_mfma_f32_16x16x32_bf16 v[112:115], v[136:139], v[156:159], v[112:115]
    v_mfma_f32_16x16x32_bf16 v[116:119], v[136:139], v[160:163], v[116:119]
    v_add_u32 v236, s52, v240
    v_mfma_f32_16x16x32_bf16 v[32:35], v[140:143], v[136:139], v[32:35]
    v_mfma_f32_16x16x32_bf16 v[36:39], v[144:147], v[136:139], v[36:39]
    s_waitcnt lgkmcnt(0)
    v_mfma_f32_16x16x32_bf16 v[40:43], v[192:195], v[164:167], v[40:43]
    s_barrier
    v_mfma_f32_16x16x32_bf16 v[44:47], v[196:199], v[164:167], v[44:47]
    ds_read_b128 v[120:123], v232 offset:0
    v_mfma_f32_16x16x32_bf16 v[80:83], v[164:167], v[200:203], v[80:83]
    ds_read_b64_tr_b16 v[148:149], v235 offset:128
    v_mfma_f32_16x16x32_bf16 v[84:87], v[164:167], v[204:207], v[84:87]
    ds_read_b64_tr_b16 v[150:151], v235 offset:1664
    v_mfma_f32_16x16x32_bf16 v[48:51], v[192:195], v[168:171], v[48:51]
    ds_read_b64_tr_b16 v[152:153], v236 offset:128
    v_mfma_f32_16x16x32_bf16 v[52:55], v[196:199], v[168:171], v[52:55]
    ds_read_b64_tr_b16 v[154:155], v236 offset:1664
    v_mfma_f32_16x16x32_bf16 v[88:91], v[168:171], v[200:203], v[88:91]
    ds_read_b64_tr_b16 v[156:157], v235 offset:256
    v_mfma_f32_16x16x32_bf16 v[92:95], v[168:171], v[204:207], v[92:95]
    v_mfma_f32_16x16x32_bf16 v[8:11], v[184:187], v[168:171], v[8:11]
    ds_read_b64_tr_b16 v[158:159], v235 offset:1792
    v_mfma_f32_16x16x32_bf16 v[12:15], v[188:191], v[168:171], v[12:15]
    ds_read_b64_tr_b16 v[160:161], v236 offset:256
    v_mfma_f32_16x16x32_bf16 v[56:59], v[192:195], v[172:175], v[56:59]
    ds_read_b64_tr_b16 v[162:163], v236 offset:1792
    v_mfma_f32_16x16x32_bf16 v[60:63], v[196:199], v[172:175], v[60:63]
    ds_read_b128 v[124:127], v232 offset:2048
    v_mfma_f32_16x16x32_bf16 v[96:99], v[172:175], v[200:203], v[96:99]
    ds_read_b64_tr_b16 v[140:141], v235 offset:0
    v_mfma_f32_16x16x32_bf16 v[100:103], v[172:175], v[204:207], v[100:103]
    ds_read_b64_tr_b16 v[142:143], v235 offset:1536
    v_mfma_f32_16x16x32_bf16 v[16:19], v[184:187], v[172:175], v[16:19]
    v_mfma_f32_16x16x32_bf16 v[20:23], v[188:191], v[172:175], v[20:23]
    ds_read_b64_tr_b16 v[144:145], v236 offset:0
    v_mfma_f32_16x16x32_bf16 v[64:67], v[192:195], v[176:179], v[64:67]
    ds_read_b64_tr_b16 v[146:147], v236 offset:1536
    v_mfma_f32_16x16x32_bf16 v[68:71], v[196:199], v[176:179], v[68:71]
    ds_read_b128 v[128:131], v232 offset:4096
    v_mfma_f32_16x16x32_bf16 v[104:107], v[176:179], v[200:203], v[104:107]
    ds_read_b128 v[132:135], v232 offset:6144
    v_mfma_f32_16x16x32_bf16 v[108:111], v[176:179], v[204:207], v[108:111]
    ds_read_b128 v[136:139], v232 offset:8192
    v_mfma_f32_16x16x32_bf16 v[24:27], v[184:187], v[176:179], v[24:27]
    v_mfma_f32_16x16x32_bf16 v[28:31], v[188:191], v[176:179], v[28:31]
    v_mfma_f32_16x16x32_bf16 v[72:75], v[192:195], v[180:183], v[72:75]
    v_mfma_f32_16x16x32_bf16 v[76:79], v[196:199], v[180:183], v[76:79]
    v_mfma_f32_16x16x32_bf16 v[112:115], v[180:183], v[200:203], v[112:115]
    v_mfma_f32_16x16x32_bf16 v[116:119], v[180:183], v[204:207], v[116:119]
    v_mfma_f32_16x16x32_bf16 v[32:35], v[184:187], v[180:183], v[32:35]
    s_add_u32 s52, s52, 49152
    s_cmp_ge_u32 s52, 147456
    s_cselect_b32 s52, 0, s52
    v_mfma_f32_16x16x32_bf16 v[36:39], v[188:191], v[180:183], v[36:39]
    s_waitcnt lgkmcnt(0)
    v_mfma_f32_16x16x32_bf16 v[40:43], v[148:151], v[120:123], v[40:43]
    ds_read_b128 v[164:167], v232 offset:1024
    v_mfma_f32_16x16x32_bf16 v[44:47], v[152:155], v[120:123], v[44:47]
    ds_read_b64_tr_b16 v[192:193], v235 offset:12416
    v_mfma_f32_16x16x32_bf16 v[80:83], v[120:123], v[156:159], v[80:83]
    ds_read_b64_tr_b16 v[194:195], v235 offset:13952
    v_mfma_f32_16x16x32_bf16 v[84:87], v[120:123], v[160:163], v[84:87]
    ds_read_b64_tr_b16 v[196:197], v236 offset:12416
    v_mfma_f32_16x16x32_bf16 v[48:51], v[148:151], v[124:127], v[48:51]
    ds_read_b64_tr_b16 v[198:199], v236 offset:13952
    v_mfma_f32_16x16x32_bf16 v[52:55], v[152:155], v[124:127], v[52:55]
    v_mfma_f32_16x16x32_bf16 v[88:91], v[124:127], v[156:159], v[88:91]
    ds_read_b64_tr_b16 v[200:201], v235 offset:12544
    v_mfma_f32_16x16x32_bf16 v[92:95], v[124:127], v[160:163], v[92:95]
    ds_read_b64_tr_b16 v[202:203], v235 offset:14080
    v_mfma_f32_16x16x32_bf16 v[8:11], v[140:143], v[124:127], v[8:11]
    ds_read_b64_tr_b16 v[204:205], v236 offset:12544
    v_mfma_f32_16x16x32_bf16 v[12:15], v[144:147], v[124:127], v[12:15]
    ds_read_b64_tr_b16 v[206:207], v236 offset:14080
    v_mfma_f32_16x16x32_bf16 v[56:59], v[148:151], v[128:131], v[56:59]
    v_mfma_f32_16x16x32_bf16 v[60:63], v[152:155], v[128:131], v[60:63]
    ds_read_b128 v[168:171], v232 offset:3072
    v_mfma_f32_16x16x32_bf16 v[96:99], v[128:131], v[156:159], v[96:99]
    ds_read_b64_tr_b16 v[184:185], v235 offset:12288
    v_mfma_f32_16x16x32_bf16 v[100:103], v[128:131], v[160:163], v[100:103]
    s_sub_u32 s54, s54, 1
    ds_read_b64_tr_b16 v[186:187], v235 offset:13824
    v_mfma_f32_16x16x32_bf16 v[16:19], v[140:143], v[128:131], v[16:19]
    s_cbranch_scc0 M_P_loop0
    ds_read_b64_tr_b16 v[188:189], v236 offset:12288
    v_mfma_f32_16x16x32_bf16 v[20:23], v[144:147], v[128:131], v[20:23]
    v_mfma_f32_16x16x32_bf16 v[64:67], v[148:151], v[132:135], v[64:67]
    ds_read_b64_tr_b16 v[190:191], v236 offset:13824
    v_mfma_f32_16x16x32_bf16 v[68:71], v[152:155], v[132:135], v[68:71]
    ds_read_b128 v[172:175], v232 offset:5120
    v_mfma_f32_16x16x32_bf16 v[104:107], v[132:135], v[156:159], v[104:107]
    ds_read_b128 v[176:179], v232 offset:7168
    v_mfma_f32_16x16x32_bf16 v[108:111], v[132:135], v[160:163], v[108:111]
    ds_read_b128 v[180:183], v232 offset:9216
    v_mfma_f32_16x16x32_bf16 v[24:27], v[140:143], v[132:135], v[24:27]
    v_mfma_f32_16x16x32_bf16 v[28:31], v[144:147], v[132:135], v[28:31]
    v_mfma_f32_16x16x32_bf16 v[72:75], v[148:151], v[136:139], v[72:75]
    v_mfma_f32_16x16x32_bf16 v[76:79], v[152:155], v[136:139], v[76:79]
    v_mfma_f32_16x16x32_bf16 v[112:115], v[136:139], v[156:159], v[112:115]
    v_mfma_f32_16x16x32_bf16 v[116:119], v[136:139], v[160:163], v[116:119]
    v_mfma_f32_16x16x32_bf16 v[32:35], v[140:143], v[136:139], v[32:35]
    v_mfma_f32_16x16x32_bf16 v[36:39], v[144:147], v[136:139], v[36:39]
    s_waitcnt lgkmcnt(0)
    v_mfma_f32_16x16x32_bf16 v[40:43], v[192:195], v[164:167], v[40:43]
    s_barrier
    v_mfma_f32_16x16x32_bf16 v[44:47], v[196:199], v[164:167], v[44:47]
    v_mfma_f32_16x16x32_bf16 v[80:83], v[164:167], v[200:203], v[80:83]
    v_mfma_f32_16x16x32_bf16 v[84:87], v[164:167], v[204:207], v[84:87]
    v_mfma_f32_16x16x32_bf16 v[48:51], v[192:195], v[168:171], v[48:51]
    v_mfma_f32_16x16x32_bf16 v[52:55], v[196:199], v[168:171], v[52:55]
    v_mfma_f32_16x16x32_bf16 v[88:91], v[168:171], v[200:203], v[88:91]
    v_mfma_f32_16x16x32_bf16 v[92:95], v[168:171], v[204:207], v[92:95]
    v_mfma_f32_16x16x32_bf16 v[8:11], v[184:187], v[168:171], v[8:11]
    v_mfma_f32_16x16x32_bf16 v[12:15], v[188:191], v[168:171], v[12:15]
    v_mfma_f32_16x16x32_bf16 v[56:59], v[192:195], v[172:175], v[56:59]
    v_mfma_f32_16x16x32_bf16 v[60:63], v[196:199], v[172:175], v[60:63]
    v_mfma_f32_16x16x32_bf16 v[96:99], v[172:175], v[200:203], v[96:99]
    v_mfma_f32_16x16x32_bf16 v[100:103], v[172:175], v[204:207], v[100:103]
    v_mfma_f32_16x16x32_bf16 v[16:19], v[184:187], v[172:175], v[16:19]
    v_mfma_f32_16x16x32_bf16 v[20:23], v[188:191], v[172:175], v[20:23]
    v_mfma_f32_16x16x32_bf16 v[64:67], v[192:195], v[176:179], v[64:67]
    v_mfma_f32_16x16x32_bf16 v[68:71], v[196:199], v[176:179], v[68:71]
    v_mfma_f32_16x16x32_bf16 v[104:107], v[176:179], v[200:203], v[104:107]
    v_mfma_f32_16x16x32_bf16 v[108:111], v[176:179], v[204:207], v[108:111]
    v_mfma_f32_16x16x32_bf16 v[24:27], v[184:187], v[176:179], v[24:27]
    v_mfma_f32_16x16x32_bf16 v[28:31], v[188:191], v[176:179], v[28:31]
    v_mfma_f32_16x16x32_bf16 v[72:75], v[192:195], v[180:183], v[72:75]
    v_mfma_f32_16x16x32_bf16 v[76:79], v[196:199], v[180:183], v[76:79]
    v_mfma_f32_16x16x32_bf16 v[112:115], v[180:183], v[200:203], v[112:115]
    v_mfma_f32_16x16x32_bf16 v[116:119], v[180:183], v[204:207], v[116:119]
    v_mfma_f32_16x16x32_bf16 v[32:35], v[184:187], v[180:183], v[32:35]
    v_mfma_f32_16x16x32_bf16 v[36:39], v[188:191], v[180:183], v[36:39]
    v_cvt_pk_bf16_f32 v120, v40, v41
    v_cvt_pk_bf16_f32 v121, v42, v43
    v_cvt_pk_bf16_f32 v122, v44, v45
    v_cvt_pk_bf16_f32 v123, v46, v47
    v_cvt_pk_bf16_f32 v124, v48, v49
    v_cvt_pk_bf16_f32 v125, v50, v51
    v_cvt_pk_bf16_f32 v126, v52, v53
    v_cvt_pk_bf16_f32 v127, v54, v55
    v_cvt_pk_bf16_f32 v140, v8, v9
    v_cvt_pk_bf16_f32 v141, v10, v11
    v_cvt_pk_bf16_f32 v142, v12, v13
    v_cvt_pk_bf16_f32 v143, v14, v15
    v_cvt_pk_bf16_f32 v128, v56, v57
    v_cvt_pk_bf16_f32 v129, v58, v59
    v_cvt_pk_bf16_f32 v130, v60, v61
    v_cvt_pk_bf16_f32 v131, v62, v63
    v_cvt_pk_bf16_f32 v144, v16, v17
    v_cvt_pk_bf16_f32 v145, v18, v19
    v_cvt_pk_bf16_f32 v146, v20, v21
    v_cvt_pk_bf16_f32 v147, v22, v23
    v_cvt_pk_bf16_f32 v132, v64, v65
    v_cvt_pk_bf16_f32 v133, v66, v67
    v_cvt_pk_bf16_f32 v134, v68, v69
    v_cvt_pk_bf16_f32 v135, v70, v71
    v_cvt_pk_bf16_f32 v148, v24, v25
    v_cvt_pk_bf16_f32 v149, v26, v27
    v_cvt_pk_bf16_f32 v150, v28, v29
    v_cvt_pk_bf16_f32 v151, v30, v31
    v_cvt_pk_bf16_f32 v136, v72, v73
    v_cvt_pk_bf16_f32 v137, v74, v75
    v_cvt_pk_bf16_f32 v138, v76, v77
    v_cvt_pk_bf16_f32 v139, v78, v79
    v_cvt_pk_bf16_f32 v152, v32, v33
    v_cvt_pk_bf16_f32 v153, v34, v35
    v_cvt_pk_bf16_f32 v154, v36, v37
    v_cvt_pk_bf16_f32 v155, v38, v39
    v_mfma_f32_16x16x32_bf16 v[8:11], v[120:123], v[140:143], 0
    v_mfma_f32_16x16x32_bf16 v[12:15], v[124:127], v[140:143], 0
    v_mfma_f32_16x16x32_bf16 v[16:19], v[124:127], v[144:147], 0
    v_mfma_f32_16x16x32_bf16 v[20:23], v[128:131], v[144:147], 0
    v_mfma_f32_16x16x32_bf16 v[24:27], v[128:131], v[148:151], 0
    v_mfma_f32_16x16x32_bf16 v[28:31], v[132:135], v[148:151], 0
    v_mfma_f32_16x16x32_bf16 v[32:35], v[132:135], v[152:155], 0
    v_mfma_f32_16x16x32_bf16 v[36:39], v[136:139], v[152:155], 0
    v_cvt_pk_bf16_f32 v156, v80, v81
    v_cvt_pk_bf16_f32 v157, v82, v83
    v_cvt_pk_bf16_f32 v166, v84, v85
    v_cvt_pk_bf16_f32 v167, v86, v87
    v_cvt_pk_bf16_f32 v158, v88, v89
    v_cvt_pk_bf16_f32 v159, v90, v91
    v_cvt_pk_bf16_f32 v168, v92, v93
    v_cvt_pk_bf16_f32 v169, v94, v95
    v_cvt_pk_bf16_f32 v160, v96, v97
    v_cvt_pk_bf16_f32 v161, v98, v99
    v_cvt_pk_bf16_f32 v170, v100, v101
    v_cvt_pk_bf16_f32 v171, v102, v103
    v_cvt_pk_bf16_f32 v162, v104, v105
    v_cvt_pk_bf16_f32 v163, v106, v107
    v_cvt_pk_bf16_f32 v172, v108, v109
    v_cvt_pk_bf16_f32 v173, v110, v111
    v_cvt_pk_bf16_f32 v164, v112, v113
    v_cvt_pk_bf16_f32 v165, v114, v115
    v_cvt_pk_bf16_f32 v174, v116, v117
    v_cvt_pk_bf16_f32 v175, v118, v119
    s_mov_b32 s64, 0x3e8293ee
    v_mov_b32 v5, 0xf149f2ca
    v_cndmask_b32 v8, v5, v8, s[88:89]
    v_cndmask_b32 v12, v5, v12, s[80:81]
    v_cndmask_b32 v9, v5, v9, s[90:91]
    v_cndmask_b32 v13, v5, v13, s[82:83]
    v_cndmask_b32 v10, v5, v10, s[92:93]
    v_cndmask_b32 v14, v5, v14, s[84:85]
    v_cndmask_b32 v11, v5, v11, s[94:95]
    v_cndmask_b32 v15, v5, v15, s[86:87]
    v_cndmask_b32 v16, v5, v16, s[72:73]
    v_cndmask_b32 v20, v5, v20, s[80:81]
    v_cndmask_b32 v17, v5, v17, s[74:75]
    v_cndmask_b32 v21, v5, v21, s[82:83]
    v_cndmask_b32 v18, v5, v18, s[76:77]
    v_cndmask_b32 v22, v5, v22, s[84:85]
    v_cndmask_b32 v19, v5, v19, s[78:79]
    v_cndmask_b32 v23, v5, v23, s[86:87]
    v_cndmask_b32 v24, v5, v24, s[72:73]
    v_cndmask_b32 v28, v5, v28, s[80:81]
    v_cndmask_b32 v25, v5, v25, s[74:75]
    v_cndmask_b32 v29, v5, v29, s[82:83]
    v_cndmask_b32 v26, v5, v26, s[76:77]
    v_cndmask_b32 v30, v5, v30, s[84:85]
    v_cndmask_b32 v27, v5, v27, s[78:79]
    v_cndmask_b32 v31, v5, v31, s[86:87]
    v_cndmask_b32 v32, v5, v32, s[72:73]
    v_cndmask_b32 v36, v5, v36, s[80:81]
    v_cndmask_b32 v33, v5, v33, s[74:75]
    v_cndmask_b32 v37, v5, v37, s[82:83]
    v_cndmask_b32 v34, v5, v34, s[76:77]
    v_cndmask_b32 v38, v5, v38, s[84:85]
    v_cndmask_b32 v35, v5, v35, s[78:79]
    v_cndmask_b32 v39, v5, v39, s[86:87]
    v_max3_f32 v192, v8, v9, v10
    v_max3_f32 v196, v11, v12, v13
    v_max3_f32 v193, v16, v17, v18
    v_max3_f32 v197, v19, v20, v21
    v_max3_f32 v194, v24, v25, v26
    v_max3_f32 v198, v27, v28, v29
    v_max3_f32 v195, v32, v33, v34
    v_max3_f32 v199, v35, v36, v37
    v_max3_f32 v192, v192, v14, v15
    v_max3_f32 v193, v193, v22, v23
    v_max3_f32 v194, v194, v30, v31
    v_max3_f32 v195, v195, v38, v39
    v_max_f32 v192, v192, v196
    v_max_f32 v193, v193, v197
    v_max_f32 v194, v194, v198
    v_max_f32 v195, v195, v199
    v_mov_b32 v196, v192
    v_mov_b32 v197, v193
    v_mov_b32 v198, v194
    v_mov_b32 v199, v195
    v_permlane32_swap_b32 v192, v196
    v_permlane32_swap_b32 v193, v197
    v_permlane32_swap_b32 v194, v198
    v_permlane32_swap_b32 v195, v199
    v_max_f32 v192, v192, v196
    v_max_f32 v193, v193, v197
    v_max_f32 v194, v194, v198
    v_max_f32 v195, v195, v199
    v_mov_b32 v196, v192
    v_mov_b32 v197, v193
    v_mov_b32 v198, v194
    v_mov_b32 v199, v195
    v_permlane16_swap_b32 v192, v196
    v_permlane16_swap_b32 v193, v197
    v_permlane16_swap_b32 v194, v198
    v_permlane16_swap_b32 v195, v199
    v_max_f32 v192, v192, v196
    v_max_f32 v193, v193, v197
    v_max_f32 v194, v194, v198
    v_max_f32 v195, v195, v199
    v_mul_f32 v192, s64, v192
    v_mul_f32 v193, s64, v193
    v_mul_f32 v194, s64, v194
    v_mul_f32 v195, s64, v195
    v_fma_f32 v8, v8, s64, -v192
    v_fma_f32 v9, v9, s64, -v192
    v_fma_f32 v10, v10, s64, -v192
    v_fma_f32 v11, v11, s64, -v192
    v_fma_f32 v12, v12, s64, -v192
    v_fma_f32 v13, v13, s64, -v192
    v_fma_f32 v14, v14, s64, -v192
    v_fma_f32 v15, v15, s64, -v192
    v_fma_f32 v16, v16, s64, -v193
    v_fma_f32 v17, v17, s64, -v193
    v_fma_f32 v18, v18, s64, -v193
    v_fma_f32 v19, v19, s64, -v193
    v_fma_f32 v20, v20, s64, -v193
    v_fma_f32 v21, v21, s64, -v193
    v_fma_f32 v22, v22, s64, -v193
    v_fma_f32 v23, v23, s64, -v193
    v_fma_f32 v24, v24, s64, -v194
    v_fma_f32 v25, v25, s64, -v194
    v_fma_f32 v26, v26, s64, -v194
    v_fma_f32 v27, v27, s64, -v194
    v_fma_f32 v28, v28, s64, -v194
    v_fma_f32 v29, v29, s64, -v194
    v_fma_f32 v30, v30, s64, -v194
    v_fma_f32 v31, v31, s64, -v194
    v_fma_f32 v32, v32, s64, -v195
    v_fma_f32 v33, v33, s64, -v195
    v_fma_f32 v34, v34, s64, -v195
    v_fma_f32 v35, v35, s64, -v195
    v_fma_f32 v36, v36, s64, -v195
    v_fma_f32 v37, v37, s64, -v195
    v_fma_f32 v38, v38, s64, -v195
    v_fma_f32 v39, v39, s64, -v195
    v_exp_f32 v8, v8
    v_exp_f32 v9, v9
    v_exp_f32 v10, v10
    v_exp_f32 v11, v11
    v_exp_f32 v12, v12
    v_exp_f32 v13, v13
    v_exp_f32 v14, v14
    v_exp_f32 v15, v15
    v_exp_f32 v16, v16
    v_exp_f32 v17, v17
    v_exp_f32 v18, v18
    v_exp_f32 v19, v19
    v_exp_f32 v20, v20
    v_exp_f32 v21, v21
    v_exp_f32 v22, v22
    v_exp_f32 v23, v23
    v_exp_f32 v24, v24
    v_exp_f32 v25, v25
    v_exp_f32 v26, v26
    v_exp_f32 v27, v27
    v_exp_f32 v28, v28
    v_exp_f32 v29, v29
    v_exp_f32 v30, v30
    v_exp_f32 v31, v31
    v_exp_f32 v32, v32
    v_exp_f32 v33, v33
    v_exp_f32 v34, v34
    v_exp_f32 v35, v35
    v_exp_f32 v36, v36
    v_exp_f32 v37, v37
    v_exp_f32 v38, v38
    v_exp_f32 v39, v39
    v_pk_add_f32 v[200:201], v[8:9], v[10:11]
    v_pk_add_f32 v[202:203], v[16:17], v[18:19]
    v_pk_add_f32 v[204:205], v[24:25], v[26:27]
    v_pk_add_f32 v[206:207], v[32:33], v[34:35]
    v_pk_add_f32 v[200:201], v[200:201], v[12:13]
    v_pk_add_f32 v[202:203], v[202:203], v[20:21]
    v_pk_add_f32 v[204:205], v[204:205], v[28:29]
    v_pk_add_f32 v[206:207], v[206:207], v[36:37]
    v_pk_add_f32 v[200:201], v[200:201], v[14:15]
    v_pk_add_f32 v[202:203], v[202:203], v[22:23]
    v_pk_add_f32 v[204:205], v[204:205], v[30:31]
    v_pk_add_f32 v[206:207], v[206:207], v[38:39]
    v_add_f32 v200, v200, v201
    v_add_f32 v202, v202, v203
    v_add_f32 v204, v204, v205
    v_add_f32 v206, v206, v207
    v_mov_b32 v196, v200
    v_mov_b32 v197, v202
    v_mov_b32 v198, v204
    v_mov_b32 v199, v206
    v_permlane32_swap_b32 v200, v196
    v_permlane32_swap_b32 v202, v197
    v_permlane32_swap_b32 v204, v198
    v_permlane32_swap_b32 v206, v199
    v_add_f32 v200, v200, v196
    v_add_f32 v202, v202, v197
    v_add_f32 v204, v204, v198
    v_add_f32 v206, v206, v199
    v_mov_b32 v196, v200
    v_mov_b32 v197, v202
    v_mov_b32 v198, v204
    v_mov_b32 v199, v206
    v_permlane16_swap_b32 v200, v196
    v_permlane16_swap_b32 v202, v197
    v_permlane16_swap_b32 v204, v198
    v_permlane16_swap_b32 v206, v199
    v_add_f32 v200, v200, v196
    v_add_f32 v202, v202, v197
    v_add_f32 v204, v204, v198
    v_add_f32 v206, v206, v199
    v_rcp_f32 v200, v200
    v_rcp_f32 v202, v202
    v_rcp_f32 v204, v204
    v_rcp_f32 v206, v206
    v_pk_mul_f32 v[8:9], v[8:9], v[200:201] op_sel_hi:[1,0]
    v_pk_mul_f32 v[10:11], v[10:11], v[200:201] op_sel_hi:[1,0]
    v_pk_mul_f32 v[12:13], v[12:13], v[200:201] op_sel_hi:[1,0]
    v_pk_mul_f32 v[14:15], v[14:15], v[200:201] op_sel_hi:[1,0]
    v_pk_mul_f32 v[16:17], v[16:17], v[202:203] op_sel_hi:[1,0]
    v_pk_mul_f32 v[18:19], v[18:19], v[202:203] op_sel_hi:[1,0]
    v_pk_mul_f32 v[20:21], v[20:21], v[202:203] op_sel_hi:[1,0]
    v_pk_mul_f32 v[22:23], v[22:23], v[202:203] op_sel_hi:[1,0]
    v_pk_mul_f32 v[24:25], v[24:25], v[204:205] op_sel_hi:[1,0]
    v_pk_mul_f32 v[26:27], v[26:27], v[204:205] op_sel_hi:[1,0]
    v_pk_mul_f32 v[28:29], v[28:29], v[204:205] op_sel_hi:[1,0]
    v_pk_mul_f32 v[30:31], v[30:31], v[204:205] op_sel_hi:[1,0]
    v_pk_mul_f32 v[32:33], v[32:33], v[206:207] op_sel_hi:[1,0]
    v_pk_mul_f32 v[34:35], v[34:35], v[206:207] op_sel_hi:[1,0]
    v_pk_mul_f32 v[36:37], v[36:37], v[206:207] op_sel_hi:[1,0]
    v_pk_mul_f32 v[38:39], v[38:39], v[206:207] op_sel_hi:[1,0]
    v_cvt_pk_bf16_f32 v176, v8, v9
    v_cvt_pk_bf16_f32 v177, v10, v11
    v_cvt_pk_bf16_f32 v178, v12, v13
    v_cvt_pk_bf16_f32 v179, v14, v15
    v_cvt_pk_bf16_f32 v180, v16, v17
    v_cvt_pk_bf16_f32 v181, v18, v19
    v_cvt_pk_bf16_f32 v182, v20, v21
    v_cvt_pk_bf16_f32 v183, v22, v23
    v_cvt_pk_bf16_f32 v184, v24, v25
    v_cvt_pk_bf16_f32 v185, v26, v27
    v_cvt_pk_bf16_f32 v186, v28, v29
    v_cvt_pk_bf16_f32 v187, v30, v31
    v_cvt_pk_bf16_f32 v188, v32, v33
    v_cvt_pk_bf16_f32 v189, v34, v35
    v_cvt_pk_bf16_f32 v190, v36, v37
    v_cvt_pk_bf16_f32 v191, v38, v39
    v_mfma_f32_16x16x32_bf16 v[40:43], v[156:159], v[176:179], 0
    v_mfma_f32_16x16x32_bf16 v[44:47], v[166:169], v[176:179], 0
    v_mfma_f32_16x16x32_bf16 v[48:51], v[158:161], v[180:183], 0
    v_mfma_f32_16x16x32_bf16 v[52:55], v[168:171], v[180:183], 0
    v_mfma_f32_16x16x32_bf16 v[56:59], v[160:163], v[184:187], 0
    v_mfma_f32_16x16x32_bf16 v[60:63], v[170:173], v[184:187], 0
    v_mfma_f32_16x16x32_bf16 v[64:67], v[162:165], v[188:191], 0
    v_mfma_f32_16x16x32_bf16 v[68:71], v[172:175], v[188:191], 0
    s_mov_b32 s72, 0x0
    s_mov_b32 s73, 0x8000
    s_mov_b32 s74, 0x10000
    s_mov_b32 s75, 0x18000
    v_cvt_pk_bf16_f32 v120, v40, v41
    v_cvt_pk_bf16_f32 v121, v42, v43
    v_cvt_pk_bf16_f32 v122, v44, v45
    v_cvt_pk_bf16_f32 v123, v46, v47
    buffer_store_dwordx4 v[120:123], v237, s[28:31], s72 offen sc1
    v_cvt_pk_bf16_f32 v124, v48, v49
    v_cvt_pk_bf16_f32 v125, v50, v51
    v_cvt_pk_bf16_f32 v126, v52, v53
    v_cvt_pk_bf16_f32 v127, v54, v55
    buffer_store_dwordx4 v[124:127], v237, s[28:31], s73 offen sc1
    v_cvt_pk_bf16_f32 v128, v56, v57
    v_cvt_pk_bf16_f32 v129, v58, v59
    v_cvt_pk_bf16_f32 v130, v60, v61
    v_cvt_pk_bf16_f32 v131, v62, v63
    buffer_store_dwordx4 v[128:131], v237, s[28:31], s74 offen sc1
    v_cvt_pk_bf16_f32 v132, v64, v65
    v_cvt_pk_bf16_f32 v133, v66, v67
    v_cvt_pk_bf16_f32 v134, v68, v69
    v_cvt_pk_bf16_f32 v135, v70, v71
    buffer_store_dwordx4 v[132:135], v237, s[28:31], s75 offen sc1
    s_lshl_b32 s64, s44, 13
    s_lshl_b32 s65, s48, 9
    s_add_u32 s64, s64, s65
    s_add_u32 s64, s64, 0xa0000
    v_lshl_add_u32 v200, v1, 3, s64
    s_mov_b32 s76, 0
    s_mov_b32 s77, 32768
    s_mov_b32 s78, 65536
    s_mov_b32 s79, 98304
    s_lshl_b32 s68, s47, 9
    s_add_u32 s68, s68, 0x54000
    s_add_u32 s62, s26, s68
    s_addc_u32 s63, s27, 0
    s_lshr_b32 s68, s48, 2
    s_lshl_b32 s68, s68, 7
    v_mov_b32 v2, 1
    v_mov_b32 v5, 148484
    s_waitcnt vmcnt(0)
    s_mov_b64 exec, 1
    ds_add_rtn_u32 v245, v5, v2
    s_mov_b64 exec, -1
    s_mov_b32 s1, 1
    s_mov_b32 s3, 0x40000
    s_waitcnt lgkmcnt(0)
    v_readfirstlane_b32 s64, v245
    s_nop 3
    s_cmp_lg_u32 s64, 3
    s_cbranch_scc1 M_po_ok
    s_atomic_add s1, s[62:63], 0
    s_atomic_add s1, s[62:63], 128
    s_atomic_add s1, s[62:63], 256
    s_atomic_add s1, s[62:63], 384
M_po_chk:
    s_load_dword s64, s[62:63], s68 glc
    s_sub_u32 s3, s3, 1
    s_cselect_b32 s65, 0, 16
    s_waitcnt lgkmcnt(0)
    s_cmp_lt_u32 s64, s65
    s_cbranch_scc1 M_po_chk
M_po_ok:
    s_barrier
    s_setprio 0
    s_and_b32 s57, s58, 15
    s_lshr_b64 s[58:59], s[58:59], 4
    s_lshl_b32 s56, s57, 11
    s_mul_i32 s57, s57, 0x20000
    s_mov_b32 m0, s53
    s_nop 0
    buffer_load_dwordx4 v208, s[28:31], s56 offen offset:0 sc1 lds
    buffer_load_dwordx4 v208, s[28:31], s56 offen offset:1024 sc1 lds
    buffer_load_dwordx4 v209, s[28:31], s56 offen offset:2048 sc1 lds
    buffer_load_dwordx4 v209, s[28:31], s56 offen offset:3072 sc1 lds
    s_add_u32 s53, s53, 24576
    s_cmp_ge_u32 s53, s61
    s_cselect_b32 s53, s60, s53
    s_and_b32 s57, s58, 15
    s_lshr_b64 s[58:59], s[58:59], 4
    s_lshl_b32 s56, s57, 11
    s_mul_i32 s57, s57, 0x20000
    s_mov_b32 m0, s53
    s_nop 0
    buffer_load_dwordx4 v208, s[28:31], s56 offen offset:0 sc1 lds
    buffer_load_dwordx4 v208, s[28:31], s56 offen offset:1024 sc1 lds
    buffer_load_dwordx4 v209, s[28:31], s56 offen offset:2048 sc1 lds
    buffer_load_dwordx4 v209, s[28:31], s56 offen offset:3072 sc1 lds
    s_add_u32 s53, s53, 24576
    s_cmp_ge_u32 s53, s61
    s_cselect_b32 s53, s60, s53
    s_and_b32 s57, s58, 15
    s_lshr_b64 s[58:59], s[58:59], 4
    s_lshl_b32 s56, s57, 11
    s_mul_i32 s57, s57, 0x20000
    s_mov_b32 m0, s53
    s_nop 0
    buffer_load_dwordx4 v208, s[28:31], s56 offen offset:0 sc1 lds
    buffer_load_dwordx4 v208, s[28:31], s56 offen offset:1024 sc1 lds
    buffer_load_dwordx4 v209, s[28:31], s56 offen offset:2048 sc1 lds
    buffer_load_dwordx4 v209, s[28:31], s56 offen offset:3072 sc1 lds
    s_add_u32 s53, s53, 24576
    s_cmp_ge_u32 s53, s61
    s_cselect_b32 s53, s60, s53
    buffer_load_dwordx2 v[192:193], v200, s[28:31], s76 offen sc1
    buffer_load_dwordx2 v[194:195], v200, s[28:31], s77 offen sc1
    buffer_load_dwordx2 v[196:197], v200, s[28:31], s78 offen sc1
    buffer_load_dwordx2 v[198:199], v200, s[28:31], s79 offen sc1
    s_lshl_b32 s64, s45, 13
    v_lshl_add_u32 v233, v1, 4, s64
    v_lshrrev_b32 v2, 2, v1
    v_lshlrev_b32 v4, 8, v2
    v_and_b32 v5, 3, v1
    v_lshl_add_u32 v4, v5, 3, v4
    v_add_u32 v4, 16384, v4
    v_and_b32 v2, 7, v2
    s_lshl_b32 s64, s46, 2
    v_xor_b32 v2, s64, v2
    v_xor_b32 v3, 0, v2
    v_lshl_add_u32 v239, v3, 5, v4
    v_xor_b32 v3, 1, v2
    v_lshl_add_u32 v240, v3, 5, v4
    v_xor_b32 v3, 2, v2
    v_lshl_add_u32 v241, v3, 5, v4
    v_xor_b32 v3, 3, v2
    v_lshl_add_u32 v242, v3, 5, v4
    s_lshl_b32 s64, s2, 2
    s_add_u32 s64, s64, s44
    s_mul_i32 s64, s64, 7168
    s_add_u32 s64, s64, 5248
    s_add_u32 s10, s12, s64
    s_addc_u32 s11, s13, 0
    s_add_u32 s24, s14, s64
    s_addc_u32 s25, s15, 0
    s_mov_b32 s52, 0
    v_add_u32 v232, s52, v233
    v_add_u32 v235, s52, v239
    v_add_u32 v236, s52, v240
    v_add_u32 v237, s52, v241
    v_add_u32 v238, s52, v242
    s_movk_i32 s54, 2
M_P_loop1:
    s_waitcnt vmcnt(12)
    s_barrier
    s_and_b32 s57, s58, 15
    s_lshr_b64 s[58:59], s[58:59], 4
    s_lshl_b32 s56, s57, 11
    s_mul_i32 s57, s57, 0x20000
    s_mov_b32 m0, s53
    s_nop 0
    buffer_load_dwordx4 v208, s[28:31], s56 offen offset:0 sc1 lds
    buffer_load_dwordx4 v208, s[28:31], s56 offen offset:1024 sc1 lds
    buffer_load_dwordx4 v209, s[28:31], s56 offen offset:2048 sc1 lds
    buffer_load_dwordx4 v209, s[28:31], s56 offen offset:3072 sc1 lds
    s_add_u32 s53, s53, 24576
    s_cmp_ge_u32 s53, s61
    s_cselect_b32 s53, s60, s53
    s_sub_u32 s54, s54, 1
    s_cbranch_scc0 M_P_loop1
    s_waitcnt vmcnt(8)
    s_barrier
    s_and_b32 s57, s58, 15
    s_lshr_b64 s[58:59], s[58:59], 4
    s_lshl_b32 s56, s57, 11
    s_mul_i32 s57, s57, 0x20000
    s_add_u32 m0, s53, s70
    s_nop 0
    buffer_load_dwordx4 v210, s[32:35], s57 offen offset:0 lds
    buffer_load_dwordx4 v211, s[32:35], s57 offen offset:1024 lds
    s_mov_b32 m0, s53
    s_nop 0
    buffer_load_dwordx4 v208, s[28:31], s56 offen offset:0 sc1 lds
    buffer_load_dwordx4 v208, s[28:31], s56 offen offset:1024 sc1 lds
    buffer_load_dwordx4 v209, s[28:31], s56 offen offset:2048 sc1 lds
    buffer_load_dwordx4 v209, s[28:31], s56 offen offset:3072 sc1 lds
    s_add_u32 s53, s53, 24576
    s_cmp_ge_u32 s53, s61
    s_cselect_b32 s53, s60, s53
    s_mov_b32 s3, 0x40000
M_tb_chk:
    v_xor_b32 v2, s0, v193
    v_xor_b32 v3, s0, v195
    v_xor_b32 v4, s0, v197
    v_xor_b32 v5, s0, v199
    v_or3_b32 v2, v2, v3, v4
    v_or_b32 v2, v2, v5
    v_cmp_ne_u32 vcc, 0, v2
    s_nop 4
    s_cbranch_vccz M_tb_ok
    s_sub_u32 s3, s3, 1
    s_cbranch_scc1 M_tb_ok
    s_sleep 1
    buffer_load_dwordx2 v[192:193], v200, s[28:31], s76 offen sc1
    buffer_load_dwordx2 v[194:195], v200, s[28:31], s77 offen sc1
    buffer_load_dwordx2 v[196:197], v200, s[28:31], s78 offen sc1
    buffer_load_dwordx2 v[198:199], v200, s[28:31], s79 offen sc1
    s_waitcnt vmcnt(0)
    s_branch M_tb_chk
M_tb_ok:
    v_add_f32 v192, v192, v194
    v_add_f32 v196, v196, v198
    v_add_f32 v192, v192, v196
    v_cvt_pk_bf16_f32 v193, v192, v192
    v_lshlrev_b32 v192, 16, v193
    s_cmp_eq_u32 s44, 2
    s_cselect_b32 s64, 1.0, 0
    v_add_f32 v192, s64, v192
    v_cvt_pk_bf16_f32 v193, v192, v192
    v_lshlrev_b32 v192, 16, v193
    s_cmp_lg_u32 s45, s46
    s_cselect_b32 s64, 0x3fb8aa3b, 1.0
    v_mul_f32 v192, s64, v192
    s_lshl_b32 s64, s44, 8
    s_add_u32 s64, s64, 149504
    v_add_u32 v2, s64, v234
    ds_write_b32 v2, v192
    s_lshl_b32 s64, s47, 12
    s_lshl_b32 s65, s48, 8
    s_add_u32 s64, s64, s65
    s_add_u32 s64, s64, 0xc0000
    s_cmp_eq_u32 s44, 3
    s_cselect_b32 s64, s64, 0x80000000
    v_add_u32 v2, s64, v234
    buffer_store_dword v192, v2, s[28:31], 0 offen sc1
    s_waitcnt lgkmcnt(0)
    s_waitcnt vmcnt(11)
    s_barrier
    s_and_b32 s57, s58, 15
    s_lshr_b64 s[58:59], s[58:59], 4
    s_lshl_b32 s56, s57, 11
    s_mul_i32 s57, s57, 0x20000
    s_add_u32 m0, s53, s70
    s_nop 0
    buffer_load_dwordx4 v210, s[32:35], s57 offen offset:0 lds
    buffer_load_dwordx4 v211, s[32:35], s57 offen offset:1024 lds
    s_mov_b32 m0, s53
    s_nop 0
    buffer_load_dwordx4 v208, s[28:31], s56 offen offset:0 sc1 lds
    buffer_load_dwordx4 v208, s[28:31], s56 offen offset:1024 sc1 lds
    buffer_load_dwordx4 v209, s[28:31], s56 offen offset:2048 sc1 lds
    buffer_load_dwordx4 v209, s[28:31], s56 offen offset:3072 sc1 lds
    s_add_u32 s53, s53, 24576
    s_cmp_ge_u32 s53, s61
    s_cselect_b32 s53, s60, s53
    s_movk_i32 s54, 1
M_P_loop2:
    s_waitcnt vmcnt(13)
    s_barrier
    s_and_b32 s57, s58, 15
    s_lshr_b64 s[58:59], s[58:59], 4
    s_lshl_b32 s56, s57, 11
    s_mul_i32 s57, s57, 0x20000
    s_add_u32 m0, s53, s70
    s_nop 0
    buffer_load_dwordx4 v210, s[32:35], s57 offen offset:0 lds
    buffer_load_dwordx4 v211, s[32:35], s57 offen offset:1024 lds
    s_mov_b32 m0, s53
    s_nop 0
    buffer_load_dwordx4 v208, s[28:31], s56 offen offset:0 sc1 lds
    buffer_load_dwordx4 v208, s[28:31], s56 offen offset:1024 sc1 lds
    buffer_load_dwordx4 v209, s[28:31], s56 offen offset:2048 sc1 lds
    buffer_load_dwordx4 v209, s[28:31], s56 offen offset:3072 sc1 lds
    s_add_u32 s53, s53, 24576
    s_cmp_ge_u32 s53, s61
    s_cselect_b32 s53, s60, s53
    s_sub_u32 s54, s54, 1
    s_cbranch_scc0 M_P_loop2
    s_movk_i32 s54, 4
M_P_loop3:
    s_waitcnt vmcnt(12)
    s_barrier
    s_and_b32 s57, s58, 15
    s_lshr_b64 s[58:59], s[58:59], 4
    s_lshl_b32 s56, s57, 11
    s_mul_i32 s57, s57, 0x20000
    s_add_u32 m0, s53, s70
    s_nop 0
    buffer_load_dwordx4 v210, s[32:35], s57 offen offset:0 lds
    buffer_load_dwordx4 v211, s[32:35], s57 offen offset:1024 lds
    s_mov_b32 m0, s53
    s_nop 0
    buffer_load_dwordx4 v208, s[28:31], s56 offen offset:0 sc1 lds
    buffer_load_dwordx4 v208, s[28:31], s56 offen offset:1024 sc1 lds
    buffer_load_dwordx4 v209, s[28:31], s56 offen offset:2048 sc1 lds
    buffer_load_dwordx4 v209, s[28:31], s56 offen offset:3072 sc1 lds
    s_add_u32 s53, s53, 24576
    s_cmp_ge_u32 s53, s61
    s_cselect_b32 s53, s60, s53
    s_sub_u32 s54, s54, 1
    s_cbranch_scc0 M_P_loop3
    s_waitcnt vmcnt(12)
    s_barrier
    s_and_b32 s57, s58, 15
    s_lshr_b64 s[58:59], s[58:59], 4
    s_lshl_b32 s56, s57, 11
    s_mul_i32 s57, s57, 0x20000
    s_add_u32 m0, s53, s70
    s_nop 0
    buffer_load_dwordx4 v210, s[32:35], s57 offen offset:0 lds
    buffer_load_dwordx4 v211, s[32:35], s57 offen offset:1024 lds
    s_mov_b32 m0, s53
    s_nop 0
    buffer_load_dwordx4 v208, s[28:31], s56 offen offset:0 sc1 lds
    buffer_load_dwordx4 v208, s[28:31], s56 offen offset:1024 sc1 lds
    buffer_load_dwordx4 v209, s[28:31], s56 offen offset:2048 sc1 lds
    buffer_load_dwordx4 v209, s[28:31], s56 offen offset:3072 sc1 lds
    s_add_u32 s53, s53, 24576
    s_cmp_ge_u32 s53, s61
    s_cselect_b32 s53, s60, s53
    s_lshl_b32 s60, s44, 12
    s_add_u32 s61, s60, 147456
    s_add_u32 s53, s60, 0
    s_bfe_u32 s66, s2, 0x30003
    s_lshr_b32 s55, s2, 6
    s_add_u32 s66, s66, s55
    s_and_b32 s66, s66, 3
    s_mov_b32 s58, 0x76453210
    s_mov_b32 s59, 0xfecdba89
    s_cmp_eq_u32 s66, 1
    s_cselect_b32 s58, 0x75643120, s58
    s_cselect_b32 s59, 0xfdecb9a8, s59
    s_cmp_eq_u32 s66, 2
    s_cselect_b32 s58, 0x67542310, s58
    s_cselect_b32 s59, 0xefdcab98, s59
    s_cmp_eq_u32 s66, 3
    s_cselect_b32 s58, 0x86534210, s58
    s_cselect_b32 s59, 0xfedbca97, s59
    s_and_b32 s66, s48, 15
    s_lshl_b32 s55, s66, 2
    s_lshr_b64 s[56:57], s[58:59], s55
    s_and_b32 s55, s56, 15
    s_lshl_b32 s55, s55, 2
    s_lshl_b64 s[56:57], 15, s55
    s_andn2_b64 s[58:59], s[58:59], s[56:57]
    s_or_b32 s58, s58, s66
    s_mov_b32 s32, s12
    s_mov_b32 s33, s13
    s_mov_b32 s34, 0x700000
    s_mov_b32 s35, 0x20000
    s_mov_b32 s36, s14
    s_mov_b32 s37, s15
    s_mov_b32 s38, 0x700000
    s_mov_b32 s39, 0x20000
    s_and_b32 s57, s58, 15
    s_lshr_b64 s[58:59], s[58:59], 4
    s_lshl_b32 s56, s57, 11
    s_mul_i32 s57, s57, 0x70000
    s_add_u32 m0, s53, 16384
    s_nop 0
    buffer_load_dwordx4 v212, s[32:35], s57 offen offset:0 lds
    buffer_load_dwordx4 v213, s[32:35], s57 offen offset:1024 lds
    s_waitcnt vmcnt(14)
    s_barrier
    buffer_load_dwordx4 v214, s[32:35], s57 offen offset:2048 lds
    buffer_load_dwordx4 v215, s[32:35], s57 offen offset:3072 lds
    s_add_u32 m0, s53, 32768
    s_nop 0
    buffer_load_dwordx4 v212, s[36:39], s57 offen offset:0 lds
    s_waitcnt vmcnt(11)
    s_barrier
    buffer_load_dwordx4 v213, s[36:39], s57 offen offset:1024 lds
    buffer_load_dwordx4 v214, s[36:39], s57 offen offset:2048 lds
    buffer_load_dwordx4 v215, s[36:39], s57 offen offset:3072 lds
    s_waitcnt vmcnt(8)
    s_barrier
    s_add_u32 s53, s53, 49152
    s_cmp_ge_u32 s53, s61
    s_cselect_b32 s53, s60, s53
    s_barrier
    s_setprio 2
    s_waitcnt vmcnt(0)
    s_barrier
    ds_read_b128 v[136:139], v232 offset:0
    ds_read_b64_tr_b16 v[152:153], v235 offset:0
    ds_read_b64_tr_b16 v[154:155], v235 offset:4096
    ds_read_b64_tr_b16 v[156:157], v236 offset:0
    ds_read_b64_tr_b16 v[158:159], v236 offset:4096
    ds_read_b64_tr_b16 v[160:161], v237 offset:0
    ds_read_b64_tr_b16 v[162:163], v237 offset:4096
    ds_read_b64_tr_b16 v[164:165], v238 offset:0
    ds_read_b64_tr_b16 v[166:167], v238 offset:4096
    ds_read_b64_tr_b16 v[168:169], v235 offset:16384
    ds_read_b64_tr_b16 v[170:171], v235 offset:20480
    ds_read_b64_tr_b16 v[172:173], v236 offset:16384
    ds_read_b64_tr_b16 v[174:175], v236 offset:20480
    ds_read_b64_tr_b16 v[176:177], v237 offset:16384
    ds_read_b64_tr_b16 v[178:179], v237 offset:20480
    ds_read_b64_tr_b16 v[180:181], v238 offset:16384
    ds_read_b64_tr_b16 v[182:183], v238 offset:20480
    ds_read_b128 v[140:143], v232 offset:2048
    ds_read_b128 v[144:147], v232 offset:4096
    ds_read_b128 v[148:151], v232 offset:6144
    s_add_u32 s52, s52, 49152
    s_cmp_ge_u32 s52, 147456
    s_cselect_b32 s52, 0, s52
    s_waitcnt lgkmcnt(0)
    v_mfma_f32_16x16x32_bf16 v[8:11], v[152:155], v[136:139], 0
    ds_read_b128 v[184:187], v232 offset:1024
    v_mfma_f32_16x16x32_bf16 v[12:15], v[156:159], v[136:139], 0
    ds_read_b64_tr_b16 v[200:201], v235 offset:8192
    v_mfma_f32_16x16x32_bf16 v[16:19], v[160:163], v[136:139], 0
    ds_read_b64_tr_b16 v[202:203], v235 offset:12288
    v_mfma_f32_16x16x32_bf16 v[20:23], v[164:167], v[136:139], 0
    ds_read_b64_tr_b16 v[204:205], v236 offset:8192
    v_mfma_f32_16x16x32_bf16 v[24:27], v[168:171], v[136:139], 0
    v_mfma_f32_16x16x32_bf16 v[28:31], v[172:175], v[136:139], 0
    ds_read_b64_tr_b16 v[206:207], v236 offset:12288
    v_mfma_f32_16x16x32_bf16 v[32:35], v[176:179], v[136:139], 0
    ds_read_b64_tr_b16 v[208:209], v237 offset:8192
    v_mfma_f32_16x16x32_bf16 v[36:39], v[180:183], v[136:139], 0
    ds_read_b64_tr_b16 v[210:211], v237 offset:12288
    v_mfma_f32_16x16x32_bf16 v[40:43], v[152:155], v[140:143], 0
    ds_read_b64_tr_b16 v[212:213], v238 offset:8192
    v_mfma_f32_16x16x32_bf16 v[44:47], v[156:159], v[140:143], 0
    v_mfma_f32_16x16x32_bf16 v[48:51], v[160:163], v[140:143], 0
    ds_read_b64_tr_b16 v[214:215], v238 offset:12288
    v_mfma_f32_16x16x32_bf16 v[52:55], v[164:167], v[140:143], 0
    ds_read_b64_tr_b16 v[216:217], v235 offset:24576
    v_mfma_f32_16x16x32_bf16 v[56:59], v[168:171], v[140:143], 0
    ds_read_b64_tr_b16 v[218:219], v235 offset:28672
    v_mfma_f32_16x16x32_bf16 v[60:63], v[172:175], v[140:143], 0
    ds_read_b64_tr_b16 v[220:221], v236 offset:24576
    v_mfma_f32_16x16x32_bf16 v[64:67], v[176:179], v[140:143], 0
    v_mfma_f32_16x16x32_bf16 v[68:71], v[180:183], v[140:143], 0
    ds_read_b64_tr_b16 v[222:223], v236 offset:28672
    v_mfma_f32_16x16x32_bf16 v[72:75], v[152:155], v[144:147], 0
    ds_read_b64_tr_b16 v[224:225], v237 offset:24576
    v_mfma_f32_16x16x32_bf16 v[76:79], v[156:159], v[144:147], 0
    ds_read_b64_tr_b16 v[226:227], v237 offset:28672
    v_mfma_f32_16x16x32_bf16 v[80:83], v[160:163], v[144:147], 0
    ds_read_b64_tr_b16 v[228:229], v238 offset:24576
    v_mfma_f32_16x16x32_bf16 v[84:87], v[164:167], v[144:147], 0
    v_mfma_f32_16x16x32_bf16 v[88:91], v[168:171], v[144:147], 0
    ds_read_b64_tr_b16 v[230:231], v238 offset:28672
    v_mfma_f32_16x16x32_bf16 v[92:95], v[172:175], v[144:147], 0
    ds_read_b128 v[188:191], v232 offset:3072
    v_mfma_f32_16x16x32_bf16 v[96:99], v[176:179], v[144:147], 0
    ds_read_b128 v[192:195], v232 offset:5120
    v_mfma_f32_16x16x32_bf16 v[100:103], v[180:183], v[144:147], 0
    ds_read_b128 v[196:199], v232 offset:7168
    v_mfma_f32_16x16x32_bf16 v[104:107], v[152:155], v[148:151], 0
    v_mfma_f32_16x16x32_bf16 v[108:111], v[156:159], v[148:151], 0
    v_add_u32 v232, s52, v233
    v_mfma_f32_16x16x32_bf16 v[112:115], v[160:163], v[148:151], 0
    v_add_u32 v235, s52, v239
    v_mfma_f32_16x16x32_bf16 v[116:119], v[164:167], v[148:151], 0
    v_add_u32 v236, s52, v240
    v_mfma_f32_16x16x32_bf16 v[120:123], v[168:171], v[148:151], 0
    v_mfma_f32_16x16x32_bf16 v[124:127], v[172:175], v[148:151], 0
    v_add_u32 v237, s52, v241
    v_mfma_f32_16x16x32_bf16 v[128:131], v[176:179], v[148:151], 0
    v_add_u32 v238, s52, v242
    v_mfma_f32_16x16x32_bf16 v[132:135], v[180:183], v[148:151], 0
    s_waitcnt lgkmcnt(0)
    v_mfma_f32_16x16x32_bf16 v[8:11], v[200:203], v[184:187], v[8:11]
    v_mfma_f32_16x16x32_bf16 v[12:15], v[204:207], v[184:187], v[12:15]
    v_mfma_f32_16x16x32_bf16 v[16:19], v[208:211], v[184:187], v[16:19]
    v_mfma_f32_16x16x32_bf16 v[20:23], v[212:215], v[184:187], v[20:23]
    v_mfma_f32_16x16x32_bf16 v[24:27], v[216:219], v[184:187], v[24:27]
    v_mfma_f32_16x16x32_bf16 v[28:31], v[220:223], v[184:187], v[28:31]
    v_mfma_f32_16x16x32_bf16 v[32:35], v[224:227], v[184:187], v[32:35]
    v_mfma_f32_16x16x32_bf16 v[36:39], v[228:231], v[184:187], v[36:39]
    v_mfma_f32_16x16x32_bf16 v[40:43], v[200:203], v[188:191], v[40:43]
    v_mfma_f32_16x16x32_bf16 v[44:47], v[204:207], v[188:191], v[44:47]
    v_mfma_f32_16x16x32_bf16 v[48:51], v[208:211], v[188:191], v[48:51]
    v_mfma_f32_16x16x32_bf16 v[52:55], v[212:215], v[188:191], v[52:55]
    v_mfma_f32_16x16x32_bf16 v[56:59], v[216:219], v[188:191], v[56:59]
    v_mfma_f32_16x16x32_bf16 v[60:63], v[220:223], v[188:191], v[60:63]
    v_mfma_f32_16x16x32_bf16 v[64:67], v[224:227], v[188:191], v[64:67]
    v_mfma_f32_16x16x32_bf16 v[68:71], v[228:231], v[188:191], v[68:71]
    v_mfma_f32_16x16x32_bf16 v[72:75], v[200:203], v[192:195], v[72:75]
    v_mfma_f32_16x16x32_bf16 v[76:79], v[204:207], v[192:195], v[76:79]
    v_mfma_f32_16x16x32_bf16 v[80:83], v[208:211], v[192:195], v[80:83]
    v_mfma_f32_16x16x32_bf16 v[84:87], v[212:215], v[192:195], v[84:87]
    v_mfma_f32_16x16x32_bf16 v[88:91], v[216:219], v[192:195], v[88:91]
    v_mfma_f32_16x16x32_bf16 v[92:95], v[220:223], v[192:195], v[92:95]
    v_mfma_f32_16x16x32_bf16 v[96:99], v[224:227], v[192:195], v[96:99]
    v_mfma_f32_16x16x32_bf16 v[100:103], v[228:231], v[192:195], v[100:103]
    v_mfma_f32_16x16x32_bf16 v[104:107], v[200:203], v[196:199], v[104:107]
    v_mfma_f32_16x16x32_bf16 v[108:111], v[204:207], v[196:199], v[108:111]
    v_mfma_f32_16x16x32_bf16 v[112:115], v[208:211], v[196:199], v[112:115]
    v_mfma_f32_16x16x32_bf16 v[116:119], v[212:215], v[196:199], v[116:119]
    v_mfma_f32_16x16x32_bf16 v[120:123], v[216:219], v[196:199], v[120:123]
    v_mfma_f32_16x16x32_bf16 v[124:127], v[220:223], v[196:199], v[124:127]
    v_mfma_f32_16x16x32_bf16 v[128:131], v[224:227], v[196:199], v[128:131]
    v_mfma_f32_16x16x32_bf16 v[132:135], v[228:231], v[196:199], v[132:135]
    s_barrier
    s_barrier
    ds_read_b128 v[136:139], v232 offset:0
    ds_read_b64_tr_b16 v[152:153], v235 offset:0
    ds_read_b64_tr_b16 v[154:155], v235 offset:4096
    ds_read_b64_tr_b16 v[156:157], v236 offset:0
    ds_read_b64_tr_b16 v[158:159], v236 offset:4096
    ds_read_b64_tr_b16 v[160:161], v237 offset:0
    ds_read_b64_tr_b16 v[162:163], v237 offset:4096
    ds_read_b64_tr_b16 v[164:165], v238 offset:0
    ds_read_b64_tr_b16 v[166:167], v238 offset:4096
    ds_read_b64_tr_b16 v[168:169], v235 offset:16384
    ds_read_b64_tr_b16 v[170:171], v235 offset:20480
    ds_read_b64_tr_b16 v[172:173], v236 offset:16384
    ds_read_b64_tr_b16 v[174:175], v236 offset:20480
    ds_read_b64_tr_b16 v[176:177], v237 offset:16384
    ds_read_b64_tr_b16 v[178:179], v237 offset:20480
    ds_read_b64_tr_b16 v[180:181], v238 offset:16384
    ds_read_b64_tr_b16 v[182:183], v238 offset:20480
    ds_read_b128 v[140:143], v232 offset:2048
    ds_read_b128 v[144:147], v232 offset:4096
    ds_read_b128 v[148:151], v232 offset:6144
    s_add_u32 s52, s52, 49152
    s_cmp_ge_u32 s52, 147456
    s_cselect_b32 s52, 0, s52
    s_waitcnt lgkmcnt(0)
    v_mfma_f32_16x16x32_bf16 v[8:11], v[152:155], v[136:139], v[8:11]
    ds_read_b128 v[184:187], v232 offset:1024
    v_mfma_f32_16x16x32_bf16 v[12:15], v[156:159], v[136:139], v[12:15]
    ds_read_b64_tr_b16 v[200:201], v235 offset:8192
    v_mfma_f32_16x16x32_bf16 v[16:19], v[160:163], v[136:139], v[16:19]
    ds_read_b64_tr_b16 v[202:203], v235 offset:12288
    v_mfma_f32_16x16x32_bf16 v[20:23], v[164:167], v[136:139], v[20:23]
    ds_read_b64_tr_b16 v[204:205], v236 offset:8192
    v_mfma_f32_16x16x32_bf16 v[24:27], v[168:171], v[136:139], v[24:27]
    v_mfma_f32_16x16x32_bf16 v[28:31], v[172:175], v[136:139], v[28:31]
    ds_read_b64_tr_b16 v[206:207], v236 offset:12288
    v_mfma_f32_16x16x32_bf16 v[32:35], v[176:179], v[136:139], v[32:35]
    ds_read_b64_tr_b16 v[208:209], v237 offset:8192
    v_mfma_f32_16x16x32_bf16 v[36:39], v[180:183], v[136:139], v[36:39]
    ds_read_b64_tr_b16 v[210:211], v237 offset:12288
    v_mfma_f32_16x16x32_bf16 v[40:43], v[152:155], v[140:143], v[40:43]
    ds_read_b64_tr_b16 v[212:213], v238 offset:8192
    v_mfma_f32_16x16x32_bf16 v[44:47], v[156:159], v[140:143], v[44:47]
    v_mfma_f32_16x16x32_bf16 v[48:51], v[160:163], v[140:143], v[48:51]
    ds_read_b64_tr_b16 v[214:215], v238 offset:12288
    v_mfma_f32_16x16x32_bf16 v[52:55], v[164:167], v[140:143], v[52:55]
    ds_read_b64_tr_b16 v[216:217], v235 offset:24576
    v_mfma_f32_16x16x32_bf16 v[56:59], v[168:171], v[140:143], v[56:59]
    ds_read_b64_tr_b16 v[218:219], v235 offset:28672
    v_mfma_f32_16x16x32_bf16 v[60:63], v[172:175], v[140:143], v[60:63]
    ds_read_b64_tr_b16 v[220:221], v236 offset:24576
    v_mfma_f32_16x16x32_bf16 v[64:67], v[176:179], v[140:143], v[64:67]
    v_mfma_f32_16x16x32_bf16 v[68:71], v[180:183], v[140:143], v[68:71]
    ds_read_b64_tr_b16 v[222:223], v236 offset:28672
    v_mfma_f32_16x16x32_bf16 v[72:75], v[152:155], v[144:147], v[72:75]
    s_movk_i32 s54, 13
M_P_loop4:
    ds_read_b64_tr_b16 v[224:225], v237 offset:24576
    v_mfma_f32_16x16x32_bf16 v[76:79], v[156:159], v[144:147], v[76:79]
    ds_read_b64_tr_b16 v[226:227], v237 offset:28672
    v_mfma_f32_16x16x32_bf16 v[80:83], v[160:163], v[144:147], v[80:83]
    ds_read_b64_tr_b16 v[228:229], v238 offset:24576
    v_mfma_f32_16x16x32_bf16 v[84:87], v[164:167], v[144:147], v[84:87]
    v_mfma_f32_16x16x32_bf16 v[88:91], v[168:171], v[144:147], v[88:91]
    ds_read_b64_tr_b16 v[230:231], v238 offset:28672
    v_mfma_f32_16x16x32_bf16 v[92:95], v[172:175], v[144:147], v[92:95]
    ds_read_b128 v[188:191], v232 offset:3072
    v_mfma_f32_16x16x32_bf16 v[96:99], v[176:179], v[144:147], v[96:99]
    ds_read_b128 v[192:195], v232 offset:5120
    v_mfma_f32_16x16x32_bf16 v[100:103], v[180:183], v[144:147], v[100:103]
    ds_read_b128 v[196:199], v232 offset:7168
    v_mfma_f32_16x16x32_bf16 v[104:107], v[152:155], v[148:151], v[104:107]
    v_mfma_f32_16x16x32_bf16 v[108:111], v[156:159], v[148:151], v[108:111]
    v_add_u32 v232, s52, v233
    v_mfma_f32_16x16x32_bf16 v[112:115], v[160:163], v[148:151], v[112:115]
    v_add_u32 v235, s52, v239
    v_mfma_f32_16x16x32_bf16 v[116:119], v[164:167], v[148:151], v[116:119]
    v_add_u32 v236, s52, v240
    v_mfma_f32_16x16x32_bf16 v[120:123], v[168:171], v[148:151], v[120:123]
    v_mfma_f32_16x16x32_bf16 v[124:127], v[172:175], v[148:151], v[124:127]
    v_add_u32 v237, s52, v241
    v_mfma_f32_16x16x32_bf16 v[128:131], v[176:179], v[148:151], v[128:131]
    v_add_u32 v238, s52, v242
    v_mfma_f32_16x16x32_bf16 v[132:135], v[180:183], v[148:151], v[132:135]
    s_waitcnt lgkmcnt(0)
    v_mfma_f32_16x16x32_bf16 v[8:11], v[200:203], v[184:187], v[8:11]
    s_barrier
    v_mfma_f32_16x16x32_bf16 v[12:15], v[204:207], v[184:187], v[12:15]
    ds_read_b128 v[136:139], v232 offset:0
    v_mfma_f32_16x16x32_bf16 v[16:19], v[208:211], v[184:187], v[16:19]
    ds_read_b64_tr_b16 v[152:153], v235 offset:0
    v_mfma_f32_16x16x32_bf16 v[20:23], v[212:215], v[184:187], v[20:23]
    ds_read_b64_tr_b16 v[154:155], v235 offset:4096
    v_mfma_f32_16x16x32_bf16 v[24:27], v[216:219], v[184:187], v[24:27]
    ds_read_b64_tr_b16 v[156:157], v236 offset:0
    v_mfma_f32_16x16x32_bf16 v[28:31], v[220:223], v[184:187], v[28:31]
    ds_read_b64_tr_b16 v[158:159], v236 offset:4096
    v_mfma_f32_16x16x32_bf16 v[32:35], v[224:227], v[184:187], v[32:35]
    v_mfma_f32_16x16x32_bf16 v[36:39], v[228:231], v[184:187], v[36:39]
    ds_read_b64_tr_b16 v[160:161], v237 offset:0
    v_mfma_f32_16x16x32_bf16 v[40:43], v[200:203], v[188:191], v[40:43]
    ds_read_b64_tr_b16 v[162:163], v237 offset:4096
    v_mfma_f32_16x16x32_bf16 v[44:47], v[204:207], v[188:191], v[44:47]
    ds_read_b64_tr_b16 v[164:165], v238 offset:0
    v_mfma_f32_16x16x32_bf16 v[48:51], v[208:211], v[188:191], v[48:51]
    ds_read_b64_tr_b16 v[166:167], v238 offset:4096
    v_mfma_f32_16x16x32_bf16 v[52:55], v[212:215], v[188:191], v[52:55]
    ds_read_b64_tr_b16 v[168:169], v235 offset:16384
    v_mfma_f32_16x16x32_bf16 v[56:59], v[216:219], v[188:191], v[56:59]
    v_mfma_f32_16x16x32_bf16 v[60:63], v[220:223], v[188:191], v[60:63]
    ds_read_b64_tr_b16 v[170:171], v235 offset:20480
    v_mfma_f32_16x16x32_bf16 v[64:67], v[224:227], v[188:191], v[64:67]
    ds_read_b64_tr_b16 v[172:173], v236 offset:16384
    v_mfma_f32_16x16x32_bf16 v[68:71], v[228:231], v[188:191], v[68:71]
    ds_read_b64_tr_b16 v[174:175], v236 offset:20480
    v_mfma_f32_16x16x32_bf16 v[72:75], v[200:203], v[192:195], v[72:75]
    ds_read_b64_tr_b16 v[176:177], v237 offset:16384
    v_mfma_f32_16x16x32_bf16 v[76:79], v[204:207], v[192:195], v[76:79]
    ds_read_b64_tr_b16 v[178:179], v237 offset:20480
    v_mfma_f32_16x16x32_bf16 v[80:83], v[208:211], v[192:195], v[80:83]
    v_mfma_f32_16x16x32_bf16 v[84:87], v[212:215], v[192:195], v[84:87]
    ds_read_b64_tr_b16 v[180:181], v238 offset:16384
    v_mfma_f32_16x16x32_bf16 v[88:91], v[216:219], v[192:195], v[88:91]
    ds_read_b64_tr_b16 v[182:183], v238 offset:20480
    v_mfma_f32_16x16x32_bf16 v[92:95], v[220:223], v[192:195], v[92:95]
    ds_read_b128 v[140:143], v232 offset:2048
    v_mfma_f32_16x16x32_bf16 v[96:99], v[224:227], v[192:195], v[96:99]
    ds_read_b128 v[144:147], v232 offset:4096
    v_mfma_f32_16x16x32_bf16 v[100:103], v[228:231], v[192:195], v[100:103]
    ds_read_b128 v[148:151], v232 offset:6144
    v_mfma_f32_16x16x32_bf16 v[104:107], v[200:203], v[196:199], v[104:107]
    v_mfma_f32_16x16x32_bf16 v[108:111], v[204:207], v[196:199], v[108:111]
    v_mfma_f32_16x16x32_bf16 v[112:115], v[208:211], v[196:199], v[112:115]
    v_mfma_f32_16x16x32_bf16 v[116:119], v[212:215], v[196:199], v[116:119]
    v_mfma_f32_16x16x32_bf16 v[120:123], v[216:219], v[196:199], v[120:123]
    v_mfma_f32_16x16x32_bf16 v[124:127], v[220:223], v[196:199], v[124:127]
    v_mfma_f32_16x16x32_bf16 v[128:131], v[224:227], v[196:199], v[128:131]
    s_add_u32 s52, s52, 49152
    s_cmp_ge_u32 s52, 147456
    s_cselect_b32 s52, 0, s52
    v_mfma_f32_16x16x32_bf16 v[132:135], v[228:231], v[196:199], v[132:135]
    s_waitcnt lgkmcnt(0)
    v_mfma_f32_16x16x32_bf16 v[8:11], v[152:155], v[136:139], v[8:11]
    ds_read_b128 v[184:187], v232 offset:1024
    v_mfma_f32_16x16x32_bf16 v[12:15], v[156:159], v[136:139], v[12:15]
    ds_read_b64_tr_b16 v[200:201], v235 offset:8192
    v_mfma_f32_16x16x32_bf16 v[16:19], v[160:163], v[136:139], v[16:19]
    ds_read_b64_tr_b16 v[202:203], v235 offset:12288
    v_mfma_f32_16x16x32_bf16 v[20:23], v[164:167], v[136:139], v[20:23]
    ds_read_b64_tr_b16 v[204:205], v236 offset:8192
    v_mfma_f32_16x16x32_bf16 v[24:27], v[168:171], v[136:139], v[24:27]
    v_mfma_f32_16x16x32_bf16 v[28:31], v[172:175], v[136:139], v[28:31]
    ds_read_b64_tr_b16 v[206:207], v236 offset:12288
    v_mfma_f32_16x16x32_bf16 v[32:35], v[176:179], v[136:139], v[32:35]
    ds_read_b64_tr_b16 v[208:209], v237 offset:8192
    v_mfma_f32_16x16x32_bf16 v[36:39], v[180:183], v[136:139], v[36:39]
    ds_read_b64_tr_b16 v[210:211], v237 offset:12288
    v_mfma_f32_16x16x32_bf16 v[40:43], v[152:155], v[140:143], v[40:43]
    ds_read_b64_tr_b16 v[212:213], v238 offset:8192
    v_mfma_f32_16x16x32_bf16 v[44:47], v[156:159], v[140:143], v[44:47]
    v_mfma_f32_16x16x32_bf16 v[48:51], v[160:163], v[140:143], v[48:51]
    ds_read_b64_tr_b16 v[214:215], v238 offset:12288
    v_mfma_f32_16x16x32_bf16 v[52:55], v[164:167], v[140:143], v[52:55]
    ds_read_b64_tr_b16 v[216:217], v235 offset:24576
    v_mfma_f32_16x16x32_bf16 v[56:59], v[168:171], v[140:143], v[56:59]
    ds_read_b64_tr_b16 v[218:219], v235 offset:28672
    v_mfma_f32_16x16x32_bf16 v[60:63], v[172:175], v[140:143], v[60:63]
    ds_read_b64_tr_b16 v[220:221], v236 offset:24576
    v_mfma_f32_16x16x32_bf16 v[64:67], v[176:179], v[140:143], v[64:67]
    v_mfma_f32_16x16x32_bf16 v[68:71], v[180:183], v[140:143], v[68:71]
    s_sub_u32 s54, s54, 1
    ds_read_b64_tr_b16 v[222:223], v236 offset:28672
    v_mfma_f32_16x16x32_bf16 v[72:75], v[152:155], v[144:147], v[72:75]
    s_cbranch_scc0 M_P_loop4
    ds_read_b64_tr_b16 v[224:225], v237 offset:24576
    v_mfma_f32_16x16x32_bf16 v[76:79], v[156:159], v[144:147], v[76:79]
    ds_read_b64_tr_b16 v[226:227], v237 offset:28672
    v_mfma_f32_16x16x32_bf16 v[80:83], v[160:163], v[144:147], v[80:83]
    ds_read_b64_tr_b16 v[228:229], v238 offset:24576
    v_mfma_f32_16x16x32_bf16 v[84:87], v[164:167], v[144:147], v[84:87]
    v_mfma_f32_16x16x32_bf16 v[88:91], v[168:171], v[144:147], v[88:91]
    ds_read_b64_tr_b16 v[230:231], v238 offset:28672
    v_mfma_f32_16x16x32_bf16 v[92:95], v[172:175], v[144:147], v[92:95]
    ds_read_b128 v[188:191], v232 offset:3072
    v_mfma_f32_16x16x32_bf16 v[96:99], v[176:179], v[144:147], v[96:99]
    ds_read_b128 v[192:195], v232 offset:5120
    v_mfma_f32_16x16x32_bf16 v[100:103], v[180:183], v[144:147], v[100:103]
    ds_read_b128 v[196:199], v232 offset:7168
    v_mfma_f32_16x16x32_bf16 v[104:107], v[152:155], v[148:151], v[104:107]
    v_mfma_f32_16x16x32_bf16 v[108:111], v[156:159], v[148:151], v[108:111]
    v_mfma_f32_16x16x32_bf16 v[112:115], v[160:163], v[148:151], v[112:115]
    v_mfma_f32_16x16x32_bf16 v[116:119], v[164:167], v[148:151], v[116:119]
    v_mfma_f32_16x16x32_bf16 v[120:123], v[168:171], v[148:151], v[120:123]
    v_mfma_f32_16x16x32_bf16 v[124:127], v[172:175], v[148:151], v[124:127]
    v_mfma_f32_16x16x32_bf16 v[128:131], v[176:179], v[148:151], v[128:131]
    v_mfma_f32_16x16x32_bf16 v[132:135], v[180:183], v[148:151], v[132:135]
    s_waitcnt lgkmcnt(0)
    v_mfma_f32_16x16x32_bf16 v[8:11], v[200:203], v[184:187], v[8:11]
    s_barrier
    v_mfma_f32_16x16x32_bf16 v[12:15], v[204:207], v[184:187], v[12:15]
    v_mfma_f32_16x16x32_bf16 v[16:19], v[208:211], v[184:187], v[16:19]
    v_mfma_f32_16x16x32_bf16 v[20:23], v[212:215], v[184:187], v[20:23]
    v_mfma_f32_16x16x32_bf16 v[24:27], v[216:219], v[184:187], v[24:27]
    v_mfma_f32_16x16x32_bf16 v[28:31], v[220:223], v[184:187], v[28:31]
    v_mfma_f32_16x16x32_bf16 v[32:35], v[224:227], v[184:187], v[32:35]
    v_mfma_f32_16x16x32_bf16 v[36:39], v[228:231], v[184:187], v[36:39]
    v_mfma_f32_16x16x32_bf16 v[40:43], v[200:203], v[188:191], v[40:43]
    v_mfma_f32_16x16x32_bf16 v[44:47], v[204:207], v[188:191], v[44:47]
    v_mfma_f32_16x16x32_bf16 v[48:51], v[208:211], v[188:191], v[48:51]
    v_mfma_f32_16x16x32_bf16 v[52:55], v[212:215], v[188:191], v[52:55]
    v_mfma_f32_16x16x32_bf16 v[56:59], v[216:219], v[188:191], v[56:59]
    v_mfma_f32_16x16x32_bf16 v[60:63], v[220:223], v[188:191], v[60:63]
    v_mfma_f32_16x16x32_bf16 v[64:67], v[224:227], v[188:191], v[64:67]
    v_mfma_f32_16x16x32_bf16 v[68:71], v[228:231], v[188:191], v[68:71]
    v_mfma_f32_16x16x32_bf16 v[72:75], v[200:203], v[192:195], v[72:75]
    v_mfma_f32_16x16x32_bf16 v[76:79], v[204:207], v[192:195], v[76:79]
    v_mfma_f32_16x16x32_bf16 v[80:83], v[208:211], v[192:195], v[80:83]
    v_mfma_f32_16x16x32_bf16 v[84:87], v[212:215], v[192:195], v[84:87]
    v_mfma_f32_16x16x32_bf16 v[88:91], v[216:219], v[192:195], v[88:91]
    v_mfma_f32_16x16x32_bf16 v[92:95], v[220:223], v[192:195], v[92:95]
    v_mfma_f32_16x16x32_bf16 v[96:99], v[224:227], v[192:195], v[96:99]
    v_mfma_f32_16x16x32_bf16 v[100:103], v[228:231], v[192:195], v[100:103]
    v_mfma_f32_16x16x32_bf16 v[104:107], v[200:203], v[196:199], v[104:107]
    v_mfma_f32_16x16x32_bf16 v[108:111], v[204:207], v[196:199], v[108:111]
    v_mfma_f32_16x16x32_bf16 v[112:115], v[208:211], v[196:199], v[112:115]
    v_mfma_f32_16x16x32_bf16 v[116:119], v[212:215], v[196:199], v[116:119]
    v_mfma_f32_16x16x32_bf16 v[120:123], v[216:219], v[196:199], v[120:123]
    v_mfma_f32_16x16x32_bf16 v[124:127], v[220:223], v[196:199], v[124:127]
    v_mfma_f32_16x16x32_bf16 v[128:131], v[224:227], v[196:199], v[128:131]
    v_mfma_f32_16x16x32_bf16 v[132:135], v[228:231], v[196:199], v[132:135]
    s_setprio 0
    s_cmp_lg_u32 s69, 0
    s_cbranch_scc1 M_Pidle
    s_lshl_b32 s64, s47, 3
    s_lshl_b32 s65, s44, 1
    s_add_u32 s64, s64, s65
    s_mul_i32 s64, s64, 32768
    s_add_u32 s64, s64, 0x1000000
    v_lshl_add_u32 v184, v1, 4, s64
    v_add_u32 v185, 30720, v184
    s_lshr_b32 s65, s48, 2
    s_sub_u32 s65, s48, s65
    s_add_u32 s65, s65, 16
    s_lshl_b32 s65, s65, 8
    s_or_b32 s65, s65, s69
    v_lshrrev_b32 v3, 4, v1
    s_lshl_b32 s64, s44, 4
    v_add_u32 v2, s64, v3
    s_movk_i32 s64, 7168
    v_mul_u32_u24 v2, s64, v2
    v_add_u32 v2, s65, v2
    v_lshlrev_b32 v3, 1, v3
    v_and_b32 v4, 15, v1
    v_xor_b32 v3, v3, v4
    v_lshl_add_u32 v188, v3, 4, v2
    v_add_u32 v190, 55296, v188
    v_xor_b32 v3, 8, v3
    v_lshl_add_u32 v189, v3, 4, v2
    v_add_u32 v189, 27648, v189
    v_add_u32 v191, 55296, v189
    s_lshl_b32 s60, s44, 12
    s_add_u32 s61, s60, 147456
    s_add_u32 s53, s60, 49152
    s_bfe_u32 s66, s2, 0x30003
    s_lshr_b32 s55, s2, 6
    s_add_u32 s66, s66, s55
    s_mul_i32 s55, s66, 11
    s_lshr_b32 s55, s55, 5
    s_mul_i32 s55, s55, 3
    s_sub_u32 s66, s66, s55
    s_mov_b32 s58, 0x9a867534
    s_mov_b32 s59, 0xfecdb
    s_cmp_eq_u32 s66, 1
    s_cselect_b32 s58, 0xb9786453, s58
    s_cselect_b32 s59, 0xfdeca, s59
    s_cmp_eq_u32 s66, 2
    s_cselect_b32 s58, 0xa8975642, s58
    s_cselect_b32 s59, 0xefdbc, s59
    s_mov_b32 s32, s12
    s_mov_b32 s33, s13
    s_mov_b32 s34, 0x700000
    s_mov_b32 s35, 0x20000
    s_mov_b32 s36, s14
    s_mov_b32 s37, s15
    s_mov_b32 s38, 0x700000
    s_mov_b32 s39, 0x20000
    s_lshl_b32 s70, s48, 12
    s_lshl_b32 s64, s47, 3
    s_lshl_b32 s65, s45, 2
    s_add_u32 s64, s64, s65
    s_mul_i32 s64, s64, 114688
    s_add_u32 s64, s64, s70
    s_lshl_b32 s65, s46, 11
    s_add_u32 s64, s64, s65
    s_add_u32 s64, s64, 0x1500000
    v_lshl_add_u32 v198, v1, 4, s64
    v_mul_f32 v24, v8, v24
    v_exp_f32 v216, -v8
    v_mul_f32 v25, v9, v25
    v_exp_f32 v217, -v9
    v_mul_f32 v26, v10, v26
    v_exp_f32 v218, -v10
    v_mul_f32 v27, v11, v27
    v_exp_f32 v219, -v11
    v_mul_f32 v28, v12, v28
    v_exp_f32 v220, -v12
    v_mul_f32 v29, v13, v29
    v_exp_f32 v221, -v13
    v_mul_f32 v30, v14, v30
    v_exp_f32 v222, -v14
    v_mul_f32 v31, v15, v31
    v_exp_f32 v223, -v15
    s_barrier
    s_and_b32 s57, s58, 15
    s_lshr_b64 s[58:59], s[58:59], 4
    s_lshl_b32 s56, s57, 11
    s_mul_i32 s57, s57, 0x70000
    s_add_u32 m0, s53, 16384
    s_nop 0
    buffer_load_dwordx4 v188, s[32:35], s57 offen offset:0 lds
    v_fma_f32 v216, v216, s67, s67
    v_fma_f32 v217, v217, s67, s67
    v_rcp_f32 v216, v216
    v_fma_f32 v218, v218, s67, s67
    buffer_load_dwordx4 v189, s[32:35], s57 offen offset:1024 lds
    v_rcp_f32 v217, v217
    v_fma_f32 v219, v219, s67, s67
    v_rcp_f32 v218, v218
    v_fma_f32 v220, v220, s67, s67
    buffer_load_dwordx4 v190, s[32:35], s57 offen offset:2048 lds
    v_rcp_f32 v219, v219
    v_fma_f32 v221, v221, s67, s67
    v_rcp_f32 v220, v220
    v_fma_f32 v222, v222, s67, s67
    buffer_load_dwordx4 v191, s[32:35], s57 offen offset:3072 lds
    v_rcp_f32 v221, v221
    v_fma_f32 v223, v223, s67, s67
    v_rcp_f32 v222, v222
    v_rcp_f32 v223, v223
    s_add_u32 m0, s53, 32768
    s_nop 0
    buffer_load_dwordx4 v188, s[36:39], s57 offen offset:0 lds
    v_mul_f32 v24, v24, v216
    v_mul_f32 v25, v25, v217
    v_mul_f32 v26, v26, v218
    v_mul_f32 v27, v27, v219
    buffer_load_dwordx4 v189, s[36:39], s57 offen offset:1024 lds
    v_mul_f32 v28, v28, v220
    v_mul_f32 v29, v29, v221
    v_mul_f32 v30, v30, v222
    v_mul_f32 v31, v31, v223
    buffer_load_dwordx4 v190, s[36:39], s57 offen offset:2048 lds
    v_cvt_pk_bf16_f32 v200, v24, v25
    v_cvt_pk_bf16_f32 v201, v26, v27
    v_cvt_pk_bf16_f32 v202, v28, v29
    v_cvt_pk_bf16_f32 v203, v30, v31
    buffer_load_dwordx4 v191, s[36:39], s57 offen offset:3072 lds
    v_mul_f32 v32, v16, v32
    v_exp_f32 v224, -v16
    v_mul_f32 v33, v17, v33
    s_mov_b32 m0, s53
    s_nop 0
    buffer_load_dwordx4 v184, s[28:31], s56 offen offset:0 sc1 lds
    v_exp_f32 v225, -v17
    v_mul_f32 v34, v18, v34
    v_exp_f32 v226, -v18
    v_mul_f32 v35, v19, v35
    buffer_load_dwordx4 v184, s[28:31], s56 offen offset:1024 sc1 lds
    v_exp_f32 v227, -v19
    v_mul_f32 v36, v20, v36
    v_exp_f32 v228, -v20
    v_mul_f32 v37, v21, v37
    buffer_load_dwordx4 v185, s[28:31], s56 offen offset:2048 sc1 lds
    v_exp_f32 v229, -v21
    v_mul_f32 v38, v22, v38
    v_exp_f32 v230, -v22
    v_mul_f32 v39, v23, v39
    buffer_load_dwordx4 v185, s[28:31], s56 offen offset:3072 sc1 lds
    v_exp_f32 v231, -v23
    v_fma_f32 v224, v224, s67, s67
    v_fma_f32 v225, v225, s67, s67
    v_rcp_f32 v224, v224
    s_add_u32 s53, s53, 49152
    s_cmp_ge_u32 s53, s61
    s_cselect_b32 s53, s60, s53
    buffer_store_dwordx4 v[200:203], v198, s[28:31], 0 offen offset:0 sc1
    s_barrier
    s_and_b32 s57, s58, 15
    s_lshr_b64 s[58:59], s[58:59], 4
    s_lshl_b32 s56, s57, 11
    s_mul_i32 s57, s57, 0x70000
    s_add_u32 m0, s53, 16384
    s_nop 0
    buffer_load_dwordx4 v188, s[32:35], s57 offen offset:0 lds
    v_fma_f32 v226, v226, s67, s67
    v_rcp_f32 v225, v225
    v_fma_f32 v227, v227, s67, s67
    v_rcp_f32 v226, v226
    buffer_load_dwordx4 v189, s[32:35], s57 offen offset:1024 lds
    v_fma_f32 v228, v228, s67, s67
    v_rcp_f32 v227, v227
    v_fma_f32 v229, v229, s67, s67
    v_rcp_f32 v228, v228
    buffer_load_dwordx4 v190, s[32:35], s57 offen offset:2048 lds
    v_fma_f32 v230, v230, s67, s67
    v_rcp_f32 v229, v229
    v_fma_f32 v231, v231, s67, s67
    v_rcp_f32 v230, v230
    buffer_load_dwordx4 v191, s[32:35], s57 offen offset:3072 lds
    v_rcp_f32 v231, v231
    v_mul_f32 v32, v32, v224
    v_mul_f32 v33, v33, v225
    v_mul_f32 v34, v34, v226
    s_add_u32 m0, s53, 32768
    s_nop 0
    buffer_load_dwordx4 v188, s[36:39], s57 offen offset:0 lds
    v_mul_f32 v35, v35, v227
    v_mul_f32 v36, v36, v228
    v_mul_f32 v37, v37, v229
    v_mul_f32 v38, v38, v230
    buffer_load_dwordx4 v189, s[36:39], s57 offen offset:1024 lds
    v_mul_f32 v39, v39, v231
    v_cvt_pk_bf16_f32 v204, v32, v33
    v_cvt_pk_bf16_f32 v205, v34, v35
    v_cvt_pk_bf16_f32 v206, v36, v37
    buffer_load_dwordx4 v190, s[36:39], s57 offen offset:2048 lds
    v_cvt_pk_bf16_f32 v207, v38, v39
    v_mul_f32 v56, v40, v56
    buffer_load_dwordx4 v191, s[36:39], s57 offen offset:3072 lds
    v_exp_f32 v216, -v40
    v_mul_f32 v57, v41, v57
    v_exp_f32 v217, -v41
    v_mul_f32 v58, v42, v58
    s_mov_b32 m0, s53
    s_nop 0
    buffer_load_dwordx4 v184, s[28:31], s56 offen offset:0 sc1 lds
    v_exp_f32 v218, -v42
    v_mul_f32 v59, v43, v59
    v_exp_f32 v219, -v43
    v_mul_f32 v60, v44, v60
    buffer_load_dwordx4 v184, s[28:31], s56 offen offset:1024 sc1 lds
    v_exp_f32 v220, -v44
    v_mul_f32 v61, v45, v61
    v_exp_f32 v221, -v45
    v_mul_f32 v62, v46, v62
    buffer_load_dwordx4 v185, s[28:31], s56 offen offset:2048 sc1 lds
    v_exp_f32 v222, -v46
    v_mul_f32 v63, v47, v63
    v_exp_f32 v223, -v47
    v_fma_f32 v216, v216, s67, s67
    buffer_load_dwordx4 v185, s[28:31], s56 offen offset:3072 sc1 lds
    v_fma_f32 v217, v217, s67, s67
    v_rcp_f32 v216, v216
    v_fma_f32 v218, v218, s67, s67
    v_rcp_f32 v217, v217
    s_add_u32 s53, s53, 49152
    s_cmp_ge_u32 s53, s61
    s_cselect_b32 s53, s60, s53
    buffer_store_dwordx4 v[204:207], v198, s[28:31], 0 offen offset:1024 sc1
    v_add_u32 v198, 114688, v198
    s_waitcnt vmcnt(14)
    s_barrier
    s_and_b32 s57, s58, 15
    s_lshr_b64 s[58:59], s[58:59], 4
    s_lshl_b32 s56, s57, 11
    s_mul_i32 s57, s57, 0x70000
    s_add_u32 m0, s53, 16384
    s_nop 0
    buffer_load_dwordx4 v188, s[32:35], s57 offen offset:0 lds
    v_fma_f32 v219, v219, s67, s67
    v_rcp_f32 v218, v218
    v_fma_f32 v220, v220, s67, s67
    v_rcp_f32 v219, v219
    buffer_load_dwordx4 v189, s[32:35], s57 offen offset:1024 lds
    v_fma_f32 v221, v221, s67, s67
    v_rcp_f32 v220, v220
    v_fma_f32 v222, v222, s67, s67
    v_rcp_f32 v221, v221
    buffer_load_dwordx4 v190, s[32:35], s57 offen offset:2048 lds
    v_fma_f32 v223, v223, s67, s67
    v_rcp_f32 v222, v222
    v_rcp_f32 v223, v223
    v_mul_f32 v56, v56, v216
    buffer_load_dwordx4 v191, s[32:35], s57 offen offset:3072 lds
    v_mul_f32 v57, v57, v217
    v_mul_f32 v58, v58, v218
    v_mul_f32 v59, v59, v219
    v_mul_f32 v60, v60, v220
    s_add_u32 m0, s53, 32768
    s_nop 0
    buffer_load_dwordx4 v188, s[36:39], s57 offen offset:0 lds
    v_mul_f32 v61, v61, v221
    v_mul_f32 v62, v62, v222
    v_mul_f32 v63, v63, v223
    v_cvt_pk_bf16_f32 v208, v56, v57
    buffer_load_dwordx4 v189, s[36:39], s57 offen offset:1024 lds
    v_cvt_pk_bf16_f32 v209, v58, v59
    v_cvt_pk_bf16_f32 v210, v60, v61
    v_cvt_pk_bf16_f32 v211, v62, v63
    buffer_load_dwordx4 v190, s[36:39], s57 offen offset:2048 lds
    v_mul_f32 v64, v48, v64
    v_exp_f32 v224, -v48
    v_mul_f32 v65, v49, v65
    v_exp_f32 v225, -v49
    buffer_load_dwordx4 v191, s[36:39], s57 offen offset:3072 lds
    v_mul_f32 v66, v50, v66
    v_exp_f32 v226, -v50
    v_mul_f32 v67, v51, v67
    v_exp_f32 v227, -v51
    s_mov_b32 m0, s53
    s_nop 0
    buffer_load_dwordx4 v184, s[28:31], s56 offen offset:0 sc1 lds
    v_mul_f32 v68, v52, v68
    v_exp_f32 v228, -v52
    v_mul_f32 v69, v53, v69
    v_exp_f32 v229, -v53
    buffer_load_dwordx4 v184, s[28:31], s56 offen offset:1024 sc1 lds
    v_mul_f32 v70, v54, v70
    v_exp_f32 v230, -v54
    v_mul_f32 v71, v55, v71
    v_exp_f32 v231, -v55
    buffer_load_dwordx4 v185, s[28:31], s56 offen offset:2048 sc1 lds
    v_fma_f32 v224, v224, s67, s67
    v_fma_f32 v225, v225, s67, s67
    v_rcp_f32 v224, v224
    v_fma_f32 v226, v226, s67, s67
    buffer_load_dwordx4 v185, s[28:31], s56 offen offset:3072 sc1 lds
    v_rcp_f32 v225, v225
    v_fma_f32 v227, v227, s67, s67
    v_rcp_f32 v226, v226
    v_fma_f32 v228, v228, s67, s67
    s_add_u32 s53, s53, 49152
    s_cmp_ge_u32 s53, s61
    s_cselect_b32 s53, s60, s53
    buffer_store_dwordx4 v[208:211], v198, s[28:31], 0 offen offset:0 sc1
    s_waitcnt vmcnt(14)
    s_barrier
    s_and_b32 s57, s58, 15
    s_lshr_b64 s[58:59], s[58:59], 4
    s_lshl_b32 s56, s57, 11
    s_mul_i32 s57, s57, 0x70000
    s_add_u32 m0, s53, 16384
    s_nop 0
    buffer_load_dwordx4 v188, s[32:35], s57 offen offset:0 lds
    v_rcp_f32 v227, v227
    v_fma_f32 v229, v229, s67, s67
    v_rcp_f32 v228, v228
    v_fma_f32 v230, v230, s67, s67
    buffer_load_dwordx4 v189, s[32:35], s57 offen offset:1024 lds
    v_rcp_f32 v229, v229
    v_fma_f32 v231, v231, s67, s67
    v_rcp_f32 v230, v230
    v_rcp_f32 v231, v231
    buffer_load_dwordx4 v190, s[32:35], s57 offen offset:2048 lds
    v_mul_f32 v64, v64, v224
    v_mul_f32 v65, v65, v225
    v_mul_f32 v66, v66, v226
    v_mul_f32 v67, v67, v227
    buffer_load_dwordx4 v191, s[32:35], s57 offen offset:3072 lds
    v_mul_f32 v68, v68, v228
    v_mul_f32 v69, v69, v229
    v_mul_f32 v70, v70, v230
    v_mul_f32 v71, v71, v231
    s_add_u32 m0, s53, 32768
    s_nop 0
    buffer_load_dwordx4 v188, s[36:39], s57 offen offset:0 lds
    v_cvt_pk_bf16_f32 v212, v64, v65
    v_cvt_pk_bf16_f32 v213, v66, v67
    v_cvt_pk_bf16_f32 v214, v68, v69
    v_cvt_pk_bf16_f32 v215, v70, v71
    buffer_load_dwordx4 v189, s[36:39], s57 offen offset:1024 lds
    v_mul_f32 v88, v72, v88
    v_exp_f32 v216, -v72
    buffer_load_dwordx4 v190, s[36:39], s57 offen offset:2048 lds
    v_mul_f32 v89, v73, v89
    v_exp_f32 v217, -v73
    v_mul_f32 v90, v74, v90
    v_exp_f32 v218, -v74
    buffer_load_dwordx4 v191, s[36:39], s57 offen offset:3072 lds
    v_mul_f32 v91, v75, v91
    v_exp_f32 v219, -v75
    v_mul_f32 v92, v76, v92
    v_exp_f32 v220, -v76
    s_mov_b32 m0, s53
    s_nop 0
    buffer_load_dwordx4 v184, s[28:31], s56 offen offset:0 sc1 lds
    v_mul_f32 v93, v77, v93
    v_exp_f32 v221, -v77
    v_mul_f32 v94, v78, v94
    v_exp_f32 v222, -v78
    buffer_load_dwordx4 v184, s[28:31], s56 offen offset:1024 sc1 lds
    v_mul_f32 v95, v79, v95
    v_exp_f32 v223, -v79
    v_fma_f32 v216, v216, s67, s67
    v_fma_f32 v217, v217, s67, s67
    buffer_load_dwordx4 v185, s[28:31], s56 offen offset:2048 sc1 lds
    v_rcp_f32 v216, v216
    v_fma_f32 v218, v218, s67, s67
    v_rcp_f32 v217, v217
    v_fma_f32 v219, v219, s67, s67
    buffer_load_dwordx4 v185, s[28:31], s56 offen offset:3072 sc1 lds
    v_rcp_f32 v218, v218
    v_fma_f32 v220, v220, s67, s67
    v_rcp_f32 v219, v219
    v_fma_f32 v221, v221, s67, s67
    s_add_u32 s53, s53, 49152
    s_cmp_ge_u32 s53, s61
    s_cselect_b32 s53, s60, s53
    buffer_store_dwordx4 v[212:215], v198, s[28:31], 0 offen offset:1024 sc1
    v_add_u32 v198, 114688, v198
    s_waitcnt vmcnt(14)
    s_barrier
    s_and_b32 s57, s58, 15
    s_lshr_b64 s[58:59], s[58:59], 4
    s_lshl_b32 s56, s57, 11
    s_mul_i32 s57, s57, 0x70000
    s_add_u32 m0, s53, 16384
    s_nop 0
    buffer_load_dwordx4 v188, s[32:35], s57 offen offset:0 lds
    v_rcp_f32 v220, v220
    v_fma_f32 v222, v222, s67, s67
    v_rcp_f32 v221, v221
    v_fma_f32 v223, v223, s67, s67
    buffer_load_dwordx4 v189, s[32:35], s57 offen offset:1024 lds
    v_rcp_f32 v222, v222
    v_rcp_f32 v223, v223
    v_mul_f32 v88, v88, v216
    v_mul_f32 v89, v89, v217
    buffer_load_dwordx4 v190, s[32:35], s57 offen offset:2048 lds
    v_mul_f32 v90, v90, v218
    v_mul_f32 v91, v91, v219
    v_mul_f32 v92, v92, v220
    v_mul_f32 v93, v93, v221
    buffer_load_dwordx4 v191, s[32:35], s57 offen offset:3072 lds
    v_mul_f32 v94, v94, v222
    v_mul_f32 v95, v95, v223
    v_cvt_pk_bf16_f32 v200, v88, v89
    v_cvt_pk_bf16_f32 v201, v90, v91
    s_add_u32 m0, s53, 32768
    s_nop 0
    buffer_load_dwordx4 v188, s[36:39], s57 offen offset:0 lds
    v_cvt_pk_bf16_f32 v202, v92, v93
    v_cvt_pk_bf16_f32 v203, v94, v95
    v_mul_f32 v96, v80, v96
    buffer_load_dwordx4 v189, s[36:39], s57 offen offset:1024 lds
    v_exp_f32 v224, -v80
    v_mul_f32 v97, v81, v97
    v_exp_f32 v225, -v81
    v_mul_f32 v98, v82, v98
    buffer_load_dwordx4 v190, s[36:39], s57 offen offset:2048 lds
    v_exp_f32 v226, -v82
    v_mul_f32 v99, v83, v99
    v_exp_f32 v227, -v83
    v_mul_f32 v100, v84, v100
    buffer_load_dwordx4 v191, s[36:39], s57 offen offset:3072 lds
    v_exp_f32 v228, -v84
    v_mul_f32 v101, v85, v101
    v_exp_f32 v229, -v85
    v_mul_f32 v102, v86, v102
    s_mov_b32 m0, s53
    s_nop 0
    buffer_load_dwordx4 v184, s[28:31], s56 offen offset:0 sc1 lds
    v_exp_f32 v230, -v86
    v_mul_f32 v103, v87, v103
    v_exp_f32 v231, -v87
    v_fma_f32 v224, v224, s67, s67
    buffer_load_dwordx4 v184, s[28:31], s56 offen offset:1024 sc1 lds
    v_fma_f32 v225, v225, s67, s67
    v_rcp_f32 v224, v224
    v_fma_f32 v226, v226, s67, s67
    v_rcp_f32 v225, v225
    buffer_load_dwordx4 v185, s[28:31], s56 offen offset:2048 sc1 lds
    v_fma_f32 v227, v227, s67, s67
    v_rcp_f32 v226, v226
    v_fma_f32 v228, v228, s67, s67
    v_rcp_f32 v227, v227
    buffer_load_dwordx4 v185, s[28:31], s56 offen offset:3072 sc1 lds
    v_fma_f32 v229, v229, s67, s67
    v_rcp_f32 v228, v228
    v_fma_f32 v230, v230, s67, s67
    v_rcp_f32 v229, v229
    s_add_u32 s53, s53, 49152
    s_cmp_ge_u32 s53, s61
    s_cselect_b32 s53, s60, s53
    buffer_store_dwordx4 v[200:203], v198, s[28:31], 0 offen offset:0 sc1
    s_waitcnt vmcnt(14)
    s_barrier
    s_and_b32 s57, s58, 15
    s_lshr_b64 s[58:59], s[58:59], 4
    s_lshl_b32 s56, s57, 11
    s_mul_i32 s57, s57, 0x70000
    s_add_u32 m0, s53, 16384
    s_nop 0
    buffer_load_dwordx4 v188, s[32:35], s57 offen offset:0 lds
    v_fma_f32 v231, v231, s67, s67
    v_rcp_f32 v230, v230
    v_rcp_f32 v231, v231
    v_mul_f32 v96, v96, v224
    buffer_load_dwordx4 v189, s[32:35], s57 offen offset:1024 lds
    v_mul_f32 v97, v97, v225
    v_mul_f32 v98, v98, v226
    v_mul_f32 v99, v99, v227
    v_mul_f32 v100, v100, v228
    buffer_load_dwordx4 v190, s[32:35], s57 offen offset:2048 lds
    v_mul_f32 v101, v101, v229
    v_mul_f32 v102, v102, v230
    v_mul_f32 v103, v103, v231
    v_cvt_pk_bf16_f32 v204, v96, v97
    buffer_load_dwordx4 v191, s[32:35], s57 offen offset:3072 lds
    v_cvt_pk_bf16_f32 v205, v98, v99
    v_cvt_pk_bf16_f32 v206, v100, v101
    v_cvt_pk_bf16_f32 v207, v102, v103
    s_add_u32 m0, s53, 32768
    s_nop 0
    buffer_load_dwordx4 v188, s[36:39], s57 offen offset:0 lds
    v_mul_f32 v120, v104, v120
    v_exp_f32 v216, -v104
    v_mul_f32 v121, v105, v121
    buffer_load_dwordx4 v189, s[36:39], s57 offen offset:1024 lds
    v_exp_f32 v217, -v105
    v_mul_f32 v122, v106, v122
    v_exp_f32 v218, -v106
    v_mul_f32 v123, v107, v123
    buffer_load_dwordx4 v190, s[36:39], s57 offen offset:2048 lds
    v_exp_f32 v219, -v107
    v_mul_f32 v124, v108, v124
    v_exp_f32 v220, -v108
    v_mul_f32 v125, v109, v125
    buffer_load_dwordx4 v191, s[36:39], s57 offen offset:3072 lds
    v_exp_f32 v221, -v109
    v_mul_f32 v126, v110, v126
    v_exp_f32 v222, -v110
    v_mul_f32 v127, v111, v127
    s_mov_b32 m0, s53
    s_nop 0
    buffer_load_dwordx4 v184, s[28:31], s56 offen offset:0 sc1 lds
    v_exp_f32 v223, -v111
    v_fma_f32 v216, v216, s67, s67
    v_fma_f32 v217, v217, s67, s67
    v_rcp_f32 v216, v216
    buffer_load_dwordx4 v184, s[28:31], s56 offen offset:1024 sc1 lds
    v_fma_f32 v218, v218, s67, s67
    v_rcp_f32 v217, v217
    v_fma_f32 v219, v219, s67, s67
    v_rcp_f32 v218, v218
    buffer_load_dwordx4 v185, s[28:31], s56 offen offset:2048 sc1 lds
    v_fma_f32 v220, v220, s67, s67
    v_rcp_f32 v219, v219
    v_fma_f32 v221, v221, s67, s67
    v_rcp_f32 v220, v220
    buffer_load_dwordx4 v185, s[28:31], s56 offen offset:3072 sc1 lds
    v_fma_f32 v222, v222, s67, s67
    v_rcp_f32 v221, v221
    v_fma_f32 v223, v223, s67, s67
    v_rcp_f32 v222, v222
    s_add_u32 s53, s53, 49152
    s_cmp_ge_u32 s53, s61
    s_cselect_b32 s53, s60, s53
    buffer_store_dwordx4 v[204:207], v198, s[28:31], 0 offen offset:1024 sc1
    v_add_u32 v198, 114688, v198
    s_waitcnt vmcnt(14)
    s_barrier
    s_and_b32 s57, s58, 15
    s_lshr_b64 s[58:59], s[58:59], 4
    s_lshl_b32 s56, s57, 11
    s_mul_i32 s57, s57, 0x70000
    s_add_u32 m0, s53, 16384
    s_nop 0
    buffer_load_dwordx4 v188, s[32:35], s57 offen offset:0 lds
    v_rcp_f32 v223, v223
    v_mul_f32 v120, v120, v216
    v_mul_f32 v121, v121, v217
    v_mul_f32 v122, v122, v218
    buffer_load_dwordx4 v189, s[32:35], s57 offen offset:1024 lds
    v_mul_f32 v123, v123, v219
    v_mul_f32 v124, v124, v220
    v_mul_f32 v125, v125, v221
    v_mul_f32 v126, v126, v222
    buffer_load_dwordx4 v190, s[32:35], s57 offen offset:2048 lds
    v_mul_f32 v127, v127, v223
    v_cvt_pk_bf16_f32 v208, v120, v121
    v_cvt_pk_bf16_f32 v209, v122, v123
    v_cvt_pk_bf16_f32 v210, v124, v125
    buffer_load_dwordx4 v191, s[32:35], s57 offen offset:3072 lds
    v_cvt_pk_bf16_f32 v211, v126, v127
    v_mul_f32 v128, v112, v128
    v_exp_f32 v224, -v112
    s_add_u32 m0, s53, 32768
    s_nop 0
    buffer_load_dwordx4 v188, s[36:39], s57 offen offset:0 lds
    v_mul_f32 v129, v113, v129
    v_exp_f32 v225, -v113
    v_mul_f32 v130, v114, v130
    v_exp_f32 v226, -v114
    buffer_load_dwordx4 v189, s[36:39], s57 offen offset:1024 lds
    v_mul_f32 v131, v115, v131
    v_exp_f32 v227, -v115
    v_mul_f32 v132, v116, v132
    v_exp_f32 v228, -v116
    buffer_load_dwordx4 v190, s[36:39], s57 offen offset:2048 lds
    v_mul_f32 v133, v117, v133
    v_exp_f32 v229, -v117
    v_mul_f32 v134, v118, v134
    v_exp_f32 v230, -v118
    buffer_load_dwordx4 v191, s[36:39], s57 offen offset:3072 lds
    v_mul_f32 v135, v119, v135
    v_exp_f32 v231, -v119
    v_fma_f32 v224, v224, s67, s67
    v_fma_f32 v225, v225, s67, s67
    s_mov_b32 m0, s53
    s_nop 0
    buffer_load_dwordx4 v184, s[28:31], s56 offen offset:0 sc1 lds
    v_rcp_f32 v224, v224
    v_fma_f32 v226, v226, s67, s67
    v_rcp_f32 v225, v225
    v_fma_f32 v227, v227, s67, s67
    buffer_load_dwordx4 v184, s[28:31], s56 offen offset:1024 sc1 lds
    v_rcp_f32 v226, v226
    v_fma_f32 v228, v228, s67, s67
    v_rcp_f32 v227, v227
    v_fma_f32 v229, v229, s67, s67
    buffer_load_dwordx4 v185, s[28:31], s56 offen offset:2048 sc1 lds
    v_rcp_f32 v228, v228
    v_fma_f32 v230, v230, s67, s67
    v_rcp_f32 v229, v229
    v_fma_f32 v231, v231, s67, s67
    buffer_load_dwordx4 v185, s[28:31], s56 offen offset:3072 sc1 lds
    v_rcp_f32 v230, v230
    v_rcp_f32 v231, v231
    v_mul_f32 v128, v128, v224
    v_mul_f32 v129, v129, v225
    s_add_u32 s53, s53, 49152
    s_cmp_ge_u32 s53, s61
    s_cselect_b32 s53, s60, s53
    buffer_store_dwordx4 v[208:211], v198, s[28:31], 0 offen offset:0 sc1
    s_waitcnt vmcnt(14)
    s_barrier
    s_and_b32 s57, s58, 15
    s_lshr_b64 s[58:59], s[58:59], 4
    s_lshl_b32 s56, s57, 11
    s_mul_i32 s57, s57, 0x70000
    s_add_u32 m0, s53, 16384
    s_nop 0
    buffer_load_dwordx4 v188, s[32:35], s57 offen offset:0 lds
    v_mul_f32 v130, v130, v226
    v_mul_f32 v131, v131, v227
    v_mul_f32 v132, v132, v228
    v_mul_f32 v133, v133, v229
    buffer_load_dwordx4 v189, s[32:35], s57 offen offset:1024 lds
    v_mul_f32 v134, v134, v230
    v_mul_f32 v135, v135, v231
    v_cvt_pk_bf16_f32 v212, v128, v129
    v_cvt_pk_bf16_f32 v213, v130, v131
    buffer_load_dwordx4 v190, s[32:35], s57 offen offset:2048 lds
    v_cvt_pk_bf16_f32 v214, v132, v133
    v_cvt_pk_bf16_f32 v215, v134, v135
    buffer_load_dwordx4 v191, s[32:35], s57 offen offset:3072 lds
    s_add_u32 m0, s53, 32768
    s_nop 0
    buffer_load_dwordx4 v188, s[36:39], s57 offen offset:0 lds
    buffer_load_dwordx4 v189, s[36:39], s57 offen offset:1024 lds
    buffer_load_dwordx4 v190, s[36:39], s57 offen offset:2048 lds
    buffer_load_dwordx4 v191, s[36:39], s57 offen offset:3072 lds
    s_mov_b32 m0, s53
    s_nop 0
    buffer_load_dwordx4 v184, s[28:31], s56 offen offset:0 sc1 lds
    buffer_load_dwordx4 v184, s[28:31], s56 offen offset:1024 sc1 lds
    buffer_load_dwordx4 v185, s[28:31], s56 offen offset:2048 sc1 lds
    buffer_load_dwordx4 v185, s[28:31], s56 offen offset:3072 sc1 lds
    s_add_u32 s53, s53, 49152
    s_cmp_ge_u32 s53, s61
    s_cselect_b32 s53, s60, s53
    buffer_store_dwordx4 v[212:215], v198, s[28:31], 0 offen offset:1024 sc1
    s_waitcnt vmcnt(14)
    s_barrier
    s_and_b32 s57, s58, 15
    s_lshr_b64 s[58:59], s[58:59], 4
    s_lshl_b32 s56, s57, 11
    s_mul_i32 s57, s57, 0x70000
    s_add_u32 m0, s53, 16384
    s_nop 0
    buffer_load_dwordx4 v188, s[32:35], s57 offen offset:0 lds
    buffer_load_dwordx4 v189, s[32:35], s57 offen offset:1024 lds
    buffer_load_dwordx4 v190, s[32:35], s57 offen offset:2048 lds
    buffer_load_dwordx4 v191, s[32:35], s57 offen offset:3072 lds
    s_add_u32 m0, s53, 32768
    s_nop 0
    buffer_load_dwordx4 v188, s[36:39], s57 offen offset:0 lds
    buffer_load_dwordx4 v189, s[36:39], s57 offen offset:1024 lds
    buffer_load_dwordx4 v190, s[36:39], s57 offen offset:2048 lds
    buffer_load_dwordx4 v191, s[36:39], s57 offen offset:3072 lds
    s_mov_b32 m0, s53
    s_nop 0
    buffer_load_dwordx4 v184, s[28:31], s56 offen offset:0 sc1 lds
    buffer_load_dwordx4 v184, s[28:31], s56 offen offset:1024 sc1 lds
    buffer_load_dwordx4 v185, s[28:31], s56 offen offset:2048 sc1 lds
    buffer_load_dwordx4 v185, s[28:31], s56 offen offset:3072 sc1 lds
    s_add_u32 s53, s53, 49152
    s_cmp_ge_u32 s53, s61
    s_cselect_b32 s53, s60, s53
    s_lshl_b32 s64, s47, 9
    s_lshl_b32 s65, s49, 7
    s_add_u32 s64, s64, s65
    s_lshl_b32 s65, s51, 4
    s_add_u32 s64, s64, s65
    s_lshl_b32 s65, s44, 2
    s_add_u32 s64, s64, s65
    s_add_u32 s64, s64, 0x50000
    v_mov_b32 v2, s0
    s_waitcnt vmcnt(12)
    s_mov_b64 exec, 1
    buffer_store_dword v2, v234, s[28:31], s64 offen sc1
    s_mov_b64 exec, -1
    s_lshl_b32 s65, s44, 1
    s_xor_b32 s65, s65, s49
    s_lshl_b32 s64, s47, 3
    s_add_u32 s64, s64, s65
    s_mul_i32 s64, s64, 114688
    s_add_u32 s64, s64, 0x1500000
    v_lshl_add_u32 v192, v1, 4, s64
    s_lshl_b32 s65, s44, 1
    s_or_b32 s65, s65, 1
    s_xor_b32 s65, s65, s49
    s_lshl_b32 s64, s47, 3
    s_add_u32 s64, s64, s65
    s_mul_i32 s64, s64, 114688
    s_add_u32 s64, s64, 0x14ff800
    v_lshl_add_u32 v193, v1, 4, s64
    s_lshl_b32 s65, s51, 9
    v_lshrrev_b32 v3, 4, v1
    s_lshl_b32 s64, s44, 4
    v_add_u32 v2, s64, v3
    s_movk_i32 s64, 2048
    v_mul_u32_u24 v2, s64, v2
    v_add_u32 v2, s65, v2
    v_lshlrev_b32 v3, 1, v3
    v_and_b32 v4, 15, v1
    v_xor_b32 v3, v3, v4
    v_lshl_add_u32 v194, v3, 4, v2
    v_add_u32 v196, 14336, v194
    v_xor_b32 v3, 8, v3
    v_lshl_add_u32 v195, v3, 4, v2
    v_add_u32 v195, 7168, v195
    v_add_u32 v197, 14336, v195
    s_barrier
    s_and_b32 s57, s58, 15
    s_lshr_b64 s[58:59], s[58:59], 4
    s_lshl_b32 s56, s57, 11
    s_mul_i32 s57, s57, 0x70000
    s_add_u32 m0, s53, 16384
    s_nop 0
    buffer_load_dwordx4 v188, s[32:35], s57 offen offset:0 lds
    buffer_load_dwordx4 v189, s[32:35], s57 offen offset:1024 lds
    buffer_load_dwordx4 v190, s[32:35], s57 offen offset:2048 lds
    buffer_load_dwordx4 v191, s[32:35], s57 offen offset:3072 lds
    s_add_u32 m0, s53, 32768
    s_nop 0
    buffer_load_dwordx4 v188, s[36:39], s57 offen offset:0 lds
    buffer_load_dwordx4 v189, s[36:39], s57 offen offset:1024 lds
    buffer_load_dwordx4 v190, s[36:39], s57 offen offset:2048 lds
    buffer_load_dwordx4 v191, s[36:39], s57 offen offset:3072 lds
    s_mov_b32 m0, s53
    s_nop 0
    buffer_load_dwordx4 v184, s[28:31], s56 offen offset:0 sc1 lds
    buffer_load_dwordx4 v184, s[28:31], s56 offen offset:1024 sc1 lds
    buffer_load_dwordx4 v185, s[28:31], s56 offen offset:2048 sc1 lds
    buffer_load_dwordx4 v185, s[28:31], s56 offen offset:3072 sc1 lds
    s_add_u32 s53, s53, 49152
    s_cmp_ge_u32 s53, s61
    s_cselect_b32 s53, s60, s53
    s_waitcnt vmcnt(13)
    s_barrier
    s_and_b32 s57, s58, 15
    s_lshr_b64 s[58:59], s[58:59], 4
    s_lshl_b32 s56, s57, 11
    s_mul_i32 s57, s57, 0x70000
    s_add_u32 m0, s53, 16384
    s_nop 0
    buffer_load_dwordx4 v188, s[32:35], s57 offen offset:0 lds
    buffer_load_dwordx4 v189, s[32:35], s57 offen offset:1024 lds
    buffer_load_dwordx4 v190, s[32:35], s57 offen offset:2048 lds
    buffer_load_dwordx4 v191, s[32:35], s57 offen offset:3072 lds
    s_add_u32 m0, s53, 32768
    s_nop 0
    buffer_load_dwordx4 v188, s[36:39], s57 offen offset:0 lds
    buffer_load_dwordx4 v189, s[36:39], s57 offen offset:1024 lds
    buffer_load_dwordx4 v190, s[36:39], s57 offen offset:2048 lds
    buffer_load_dwordx4 v191, s[36:39], s57 offen offset:3072 lds
    s_mov_b32 m0, s53
    s_nop 0
    buffer_load_dwordx4 v184, s[28:31], s56 offen offset:0 sc1 lds
    buffer_load_dwordx4 v184, s[28:31], s56 offen offset:1024 sc1 lds
    buffer_load_dwordx4 v185, s[28:31], s56 offen offset:2048 sc1 lds
    buffer_load_dwordx4 v185, s[28:31], s56 offen offset:3072 sc1 lds
    s_add_u32 s53, s53, 49152
    s_cmp_ge_u32 s53, s61
    s_cselect_b32 s53, s60, s53
    s_waitcnt vmcnt(12)
    s_barrier
    s_and_b32 s57, s58, 15
    s_lshr_b64 s[58:59], s[58:59], 4
    s_lshl_b32 s56, s57, 11
    s_mul_i32 s57, s57, 0x70000
    s_add_u32 m0, s53, 16384
    s_nop 0
    buffer_load_dwordx4 v188, s[32:35], s57 offen offset:0 lds
    buffer_load_dwordx4 v189, s[32:35], s57 offen offset:1024 lds
    buffer_load_dwordx4 v190, s[32:35], s57 offen offset:2048 lds
    buffer_load_dwordx4 v191, s[32:35], s57 offen offset:3072 lds
    s_add_u32 m0, s53, 32768
    s_nop 0
    buffer_load_dwordx4 v188, s[36:39], s57 offen offset:0 lds
    buffer_load_dwordx4 v189, s[36:39], s57 offen offset:1024 lds
    buffer_load_dwordx4 v190, s[36:39], s57 offen offset:2048 lds
    buffer_load_dwordx4 v191, s[36:39], s57 offen offset:3072 lds
    s_mov_b32 m0, s53
    s_nop 0
    buffer_load_dwordx4 v184, s[28:31], s56 offen offset:0 sc1 lds
    buffer_load_dwordx4 v184, s[28:31], s56 offen offset:1024 sc1 lds
    buffer_load_dwordx4 v185, s[28:31], s56 offen offset:2048 sc1 lds
    buffer_load_dwordx4 v185, s[28:31], s56 offen offset:3072 sc1 lds
    s_add_u32 s53, s53, 49152
    s_cmp_ge_u32 s53, s61
    s_cselect_b32 s53, s60, s53
    s_waitcnt vmcnt(12)
    s_barrier
    s_lshl_b32 s68, s47, 2
    s_add_u32 s68, s68, s49
    s_lshl_b32 s68, s68, 7
    s_add_u32 s68, s68, 0x50000
    v_min_u32 v234, 60, v234
    buffer_load_dword v245, v234, s[28:31], s68 offen sc1
    s_and_b32 s57, s58, 15
    s_lshr_b64 s[58:59], s[58:59], 4
    s_lshl_b32 s56, s57, 11
    s_mul_i32 s57, s57, 0x70000
    s_add_u32 m0, s53, 16384
    s_nop 0
    buffer_load_dwordx4 v188, s[32:35], s57 offen offset:0 lds
    buffer_load_dwordx4 v189, s[32:35], s57 offen offset:1024 lds
    buffer_load_dwordx4 v190, s[32:35], s57 offen offset:2048 lds
    buffer_load_dwordx4 v191, s[32:35], s57 offen offset:3072 lds
    s_add_u32 m0, s53, 32768
    s_nop 0
    buffer_load_dwordx4 v188, s[36:39], s57 offen offset:0 lds
    buffer_load_dwordx4 v189, s[36:39], s57 offen offset:1024 lds
    buffer_load_dwordx4 v190, s[36:39], s57 offen offset:2048 lds
    buffer_load_dwordx4 v191, s[36:39], s57 offen offset:3072 lds
    s_mov_b32 m0, s53
    s_nop 0
    buffer_load_dwordx4 v184, s[28:31], s56 offen offset:0 sc1 lds
    buffer_load_dwordx4 v184, s[28:31], s56 offen offset:1024 sc1 lds
    buffer_load_dwordx4 v185, s[28:31], s56 offen offset:2048 sc1 lds
    buffer_load_dwordx4 v185, s[28:31], s56 offen offset:3072 sc1 lds
    s_add_u32 s53, s53, 49152
    s_cmp_ge_u32 s53, s61
    s_cselect_b32 s53, s60, s53
    s_waitcnt vmcnt(13)
    s_barrier
M_Pjoin:
    s_waitcnt vmcnt(12)
    s_mov_b32 s3, 0x40000
M_pa_chk:
    v_cmp_ne_u32 vcc, s0, v245
    s_nop 4
    s_cbranch_vccz M_pa_ok
    s_sub_u32 s3, s3, 1
    s_cbranch_scc1 M_pa_ok
    s_sleep 4
    s_cmp_eq_u32 s69, 0
    s_cbranch_scc1 M_pa_rl
    s_sleep 48
M_pa_rl:
    buffer_load_dword v245, v234, s[28:31], s68 offen sc1
    s_waitcnt vmcnt(0)
    s_branch M_pa_chk
M_pa_ok:
    s_lshl_b32 s60, s44, 12
    s_add_u32 s61, s60, 147456
    s_add_u32 s53, s60, 98304
    s_bfe_u32 s66, s2, 0x30003
    s_lshr_b32 s55, s2, 6
    s_add_u32 s66, s66, s55
    s_and_b32 s66, s66, 3
    s_mov_b32 s58, 0x76453201
    s_mov_b32 s59, 0x542310
    s_cmp_eq_u32 s66, 1
    s_cselect_b32 s58, 0x75643120, s58
    s_cselect_b32 s59, 0x534201, s59
    s_cmp_eq_u32 s66, 2
    s_cselect_b32 s58, 0x67542310, s58
    s_cselect_b32 s59, 0x453210, s59
    s_cmp_eq_u32 s66, 3
    s_cselect_b32 s58, 0x76534210, s58
    s_cselect_b32 s59, 0x543201, s59
    s_lshl_b32 s55, s49, 3
    s_mov_b32 s32, s16
    s_mov_b32 s33, s17
    s_mov_b32 s34, 0x700000
    s_mov_b32 s35, 0x20000
    s_add_u32 s36, s16, 0x100
    s_addc_u32 s37, s17, 0
    s_mov_b32 s38, 0x6fff00
    s_mov_b32 s39, 0x20000
    s_and_b32 s57, s58, 15
    s_lshr_b64 s[58:59], s[58:59], 4
    s_add_u32 s57, s57, s55
    s_lshl_b32 s56, s57, 11
    s_mul_i32 s57, s57, 0x20000
    s_add_u32 m0, s53, 16384
    s_nop 0
    buffer_load_dwordx4 v194, s[32:35], s57 offen offset:0 lds
    buffer_load_dwordx4 v195, s[32:35], s57 offen offset:1024 lds
    buffer_load_dwordx4 v196, s[32:35], s57 offen offset:2048 lds
    buffer_load_dwordx4 v197, s[32:35], s57 offen offset:3072 lds
    s_add_u32 m0, s53, 32768
    s_nop 0
    buffer_load_dwordx4 v194, s[36:39], s57 offen offset:0 lds
    buffer_load_dwordx4 v195, s[36:39], s57 offen offset:1024 lds
    buffer_load_dwordx4 v196, s[36:39], s57 offen offset:2048 lds
    buffer_load_dwordx4 v197, s[36:39], s57 offen offset:3072 lds
    s_mov_b32 m0, s53
    s_nop 0
    buffer_load_dwordx4 v192, s[28:31], s56 offen offset:0 sc1 lds
    buffer_load_dwordx4 v192, s[28:31], s56 offen offset:1024 sc1 lds
    buffer_load_dwordx4 v193, s[28:31], s56 offen offset:2048 sc1 lds
    buffer_load_dwordx4 v193, s[28:31], s56 offen offset:3072 sc1 lds
    s_add_u32 s53, s53, 49152
    s_cmp_ge_u32 s53, s61
    s_cselect_b32 s53, s60, s53
    s_lshl_b32 s70, s47, 1
    s_add_u32 s70, s70, s45
    s_lshl_b32 s70, s70, 2
    s_add_u32 s70, s70, s49
    s_lshl_b32 s71, s51, 2
    s_add_u32 s71, s71, s46
    s_lshl_b32 s64, s70, 15
    s_lshl_b32 s65, s71, 7
    s_add_u32 s64, s64, s65
    v_and_b32 v2, 15, v1
    v_lshl_add_u32 v2, v2, 11, s64
    v_bfe_u32 v3, v1, 4, 1
    v_lshl_add_u32 v2, v3, 5, v2
    v_lshrrev_b32 v3, 5, v1
    v_lshl_add_u32 v246, v3, 4, v2
    s_mul_i32 s64, s70, 32768
    s_lshl_b32 s65, s71, 11
    s_add_u32 s64, s64, s65
    s_add_u32 s64, s64, 0xb00000
    v_lshl_add_u32 v248, v1, 4, s64
    s_lshl_b32 s64, s47, 12
    s_lshl_b32 s65, s71, 8
    s_add_u32 s64, s64, s65
    s_add_u32 s64, s64, 0xc0000
    v_and_b32 v2, 48, v1
    v_add_u32 v247, s64, v2
    v_lshlrev_b32 v249, 4, v1
    s_xor_b32 s64, s48, 0
    s_lshl_b32 s65, s47, 4
    s_add_u32 s64, s64, s65
    s_lshl_b32 s64, s64, 2
    s_add_u32 s64, s64, s44
    s_lshl_b32 s72, s64, 12
    s_lshl_b32 s76, s64, 9
    s_add_u32 s76, s76, 0x3000000
    s_xor_b32 s64, s48, 4
    s_lshl_b32 s65, s47, 4
    s_add_u32 s64, s64, s65
    s_lshl_b32 s64, s64, 2
    s_add_u32 s64, s64, s44
    s_lshl_b32 s73, s64, 12
    s_add_u32 s73, s73, 0x2400000
    s_lshl_b32 s77, s64, 9
    s_add_u32 s77, s77, 0x3000000
    s_xor_b32 s64, s48, 8
    s_lshl_b32 s65, s47, 4
    s_add_u32 s64, s64, s65
    s_lshl_b32 s64, s64, 2
    s_add_u32 s64, s64, s44
    s_lshl_b32 s74, s64, 12
    s_add_u32 s74, s74, 0x2800000
    s_lshl_b32 s78, s64, 9
    s_add_u32 s78, s78, 0x3000080
    s_xor_b32 s64, s48, 12
    s_lshl_b32 s65, s47, 4
    s_add_u32 s64, s64, s65
    s_lshl_b32 s64, s64, 2
    s_add_u32 s64, s64, s44
    s_lshl_b32 s75, s64, 12
    s_add_u32 s75, s75, 0x2c00000
    s_lshl_b32 s79, s64, 9
    s_add_u32 s79, s79, 0x3000100
    s_add_u32 s80, s72, 0x2400000
    s_add_u32 s81, s72, 0x2800000
    s_add_u32 s82, s72, 0x2c00000
    s_movk_i32 s83, 4096
    s_add_u32 s62, s26, s76
    s_addc_u32 s63, s27, 0
    s_load_dword s99, s[62:63], 0 glc
    s_load_dword s99, s[62:63], 128 glc
    s_load_dword s99, s[62:63], 256 glc
    s_mov_b32 s52, 98304
    s_waitcnt vmcnt(12)
    s_barrier
    s_and_b32 s57, s58, 15
    s_lshr_b64 s[58:59], s[58:59], 4
    s_add_u32 s57, s57, s55
    s_lshl_b32 s56, s57, 11
    s_mul_i32 s57, s57, 0x20000
    s_add_u32 m0, s53, 16384
    s_nop 0
    buffer_load_dwordx4 v194, s[32:35], s57 offen offset:0 lds
    buffer_load_dwordx4 v195, s[32:35], s57 offen offset:1024 lds
    buffer_load_dwordx4 v196, s[32:35], s57 offen offset:2048 lds
    buffer_load_dwordx4 v197, s[32:35], s57 offen offset:3072 lds
    s_add_u32 m0, s53, 32768
    s_nop 0
    buffer_load_dwordx4 v194, s[36:39], s57 offen offset:0 lds
    buffer_load_dwordx4 v195, s[36:39], s57 offen offset:1024 lds
    buffer_load_dwordx4 v196, s[36:39], s57 offen offset:2048 lds
    buffer_load_dwordx4 v197, s[36:39], s57 offen offset:3072 lds
    s_mov_b32 m0, s53
    s_nop 0
    buffer_load_dwordx4 v192, s[28:31], s56 offen offset:0 sc1 lds
    buffer_load_dwordx4 v192, s[28:31], s56 offen offset:1024 sc1 lds
    buffer_load_dwordx4 v193, s[28:31], s56 offen offset:2048 sc1 lds
    buffer_load_dwordx4 v193, s[28:31], s56 offen offset:3072 sc1 lds
    s_add_u32 s53, s53, 49152
    s_cmp_ge_u32 s53, s61
    s_cselect_b32 s53, s60, s53
    v_add_u32 v232, s52, v233
    v_add_u32 v235, s52, v239
    v_add_u32 v236, s52, v240
    v_add_u32 v237, s52, v241
    v_add_u32 v238, s52, v242
    s_mov_b32 s40, s22
    s_mov_b32 s41, s23
    s_mov_b32 s42, 0x400000
    s_mov_b32 s43, 0x20000
    s_waitcnt vmcnt(12)
    s_barrier
    ds_read_b128 v[140:143], v232 offset:2048
    ds_read_b64_tr_b16 v[152:153], v235 offset:0
    ds_read_b64_tr_b16 v[154:155], v235 offset:4096
    ds_read_b64_tr_b16 v[156:157], v236 offset:0
    ds_read_b64_tr_b16 v[158:159], v236 offset:4096
    ds_read_b64_tr_b16 v[160:161], v237 offset:0
    ds_read_b64_tr_b16 v[162:163], v237 offset:4096
    ds_read_b64_tr_b16 v[164:165], v238 offset:0
    ds_read_b64_tr_b16 v[166:167], v238 offset:4096
    ds_read_b64_tr_b16 v[168:169], v235 offset:16384
    ds_read_b64_tr_b16 v[170:171], v235 offset:20480
    ds_read_b64_tr_b16 v[172:173], v236 offset:16384
    ds_read_b64_tr_b16 v[174:175], v236 offset:20480
    ds_read_b64_tr_b16 v[176:177], v237 offset:16384
    ds_read_b64_tr_b16 v[178:179], v237 offset:20480
    ds_read_b64_tr_b16 v[180:181], v238 offset:16384
    ds_read_b64_tr_b16 v[182:183], v238 offset:20480
    ds_read_b128 v[144:147], v232 offset:4096
    ds_read_b128 v[148:151], v232 offset:6144
    ds_read_b128 v[136:139], v232 offset:0
    s_and_b32 s57, s58, 15
    s_lshr_b64 s[58:59], s[58:59], 4
    s_add_u32 s57, s57, s55
    s_lshl_b32 s56, s57, 11
    s_mul_i32 s57, s57, 0x20000
    s_add_u32 m0, s53, 16384
    s_nop 0
    buffer_load_dwordx4 v194, s[32:35], s57 offen offset:0 lds
    buffer_load_dwordx4 v195, s[32:35], s57 offen offset:1024 lds
    buffer_load_dwordx4 v196, s[32:35], s57 offen offset:2048 lds
    buffer_load_dwordx4 v197, s[32:35], s57 offen offset:3072 lds
    s_add_u32 m0, s53, 32768
    s_nop 0
    buffer_load_dwordx4 v194, s[36:39], s57 offen offset:0 lds
    buffer_load_dwordx4 v195, s[36:39], s57 offen offset:1024 lds
    buffer_load_dwordx4 v196, s[36:39], s57 offen offset:2048 lds
    buffer_load_dwordx4 v197, s[36:39], s57 offen offset:3072 lds
    s_mov_b32 m0, s53
    s_nop 0
    buffer_load_dwordx4 v192, s[28:31], s56 offen offset:0 sc1 lds
    buffer_load_dwordx4 v192, s[28:31], s56 offen offset:1024 sc1 lds
    buffer_load_dwordx4 v193, s[28:31], s56 offen offset:2048 sc1 lds
    buffer_load_dwordx4 v193, s[28:31], s56 offen offset:3072 sc1 lds
    s_add_u32 s53, s53, 49152
    s_cmp_ge_u32 s53, s61
    s_cselect_b32 s53, s60, s53
    s_setprio 2
    s_add_u32 s52, s52, 49152
    s_cmp_ge_u32 s52, 147456
    s_cselect_b32 s52, 0, s52
    s_waitcnt lgkmcnt(0)
    v_mfma_f32_16x16x32_bf16 v[40:43], v[152:155], v[140:143], 0
    ds_read_b128 v[188:191], v232 offset:3072
    v_mfma_f32_16x16x32_bf16 v[44:47], v[156:159], v[140:143], 0
    ds_read_b64_tr_b16 v[200:201], v235 offset:8192
    v_mfma_f32_16x16x32_bf16 v[48:51], v[160:163], v[140:143], 0
    ds_read_b64_tr_b16 v[202:203], v235 offset:12288
    v_mfma_f32_16x16x32_bf16 v[52:55], v[164:167], v[140:143], 0
    ds_read_b64_tr_b16 v[204:205], v236 offset:8192
    v_mfma_f32_16x16x32_bf16 v[56:59], v[168:171], v[140:143], 0
    v_mfma_f32_16x16x32_bf16 v[60:63], v[172:175], v[140:143], 0
    ds_read_b64_tr_b16 v[206:207], v236 offset:12288
    v_mfma_f32_16x16x32_bf16 v[64:67], v[176:179], v[140:143], 0
    ds_read_b64_tr_b16 v[208:209], v237 offset:8192
    v_mfma_f32_16x16x32_bf16 v[68:71], v[180:183], v[140:143], 0
    ds_read_b64_tr_b16 v[210:211], v237 offset:12288
    v_mfma_f32_16x16x32_bf16 v[72:75], v[152:155], v[144:147], 0
    ds_read_b64_tr_b16 v[212:213], v238 offset:8192
    v_mfma_f32_16x16x32_bf16 v[76:79], v[156:159], v[144:147], 0
    v_mfma_f32_16x16x32_bf16 v[80:83], v[160:163], v[144:147], 0
    ds_read_b64_tr_b16 v[214:215], v238 offset:12288
    v_mfma_f32_16x16x32_bf16 v[84:87], v[164:167], v[144:147], 0
    ds_read_b64_tr_b16 v[216:217], v235 offset:24576
    v_mfma_f32_16x16x32_bf16 v[88:91], v[168:171], v[144:147], 0
    ds_read_b64_tr_b16 v[218:219], v235 offset:28672
    v_mfma_f32_16x16x32_bf16 v[92:95], v[172:175], v[144:147], 0
    ds_read_b64_tr_b16 v[220:221], v236 offset:24576
    v_mfma_f32_16x16x32_bf16 v[96:99], v[176:179], v[144:147], 0
    v_mfma_f32_16x16x32_bf16 v[100:103], v[180:183], v[144:147], 0
    ds_read_b64_tr_b16 v[222:223], v236 offset:28672
    v_mfma_f32_16x16x32_bf16 v[104:107], v[152:155], v[148:151], 0
    ds_read_b64_tr_b16 v[224:225], v237 offset:24576
    v_mfma_f32_16x16x32_bf16 v[108:111], v[156:159], v[148:151], 0
    ds_read_b64_tr_b16 v[226:227], v237 offset:28672
    v_mfma_f32_16x16x32_bf16 v[112:115], v[160:163], v[148:151], 0
    ds_read_b64_tr_b16 v[228:229], v238 offset:24576
    v_mfma_f32_16x16x32_bf16 v[116:119], v[164:167], v[148:151], 0
    v_mfma_f32_16x16x32_bf16 v[120:123], v[168:171], v[148:151], 0
    ds_read_b64_tr_b16 v[230:231], v238 offset:28672
    v_mfma_f32_16x16x32_bf16 v[124:127], v[172:175], v[148:151], 0
    ds_read_b128 v[192:195], v232 offset:5120
    v_mfma_f32_16x16x32_bf16 v[128:131], v[176:179], v[148:151], 0
    ds_read_b128 v[196:199], v232 offset:7168
    v_mfma_f32_16x16x32_bf16 v[132:135], v[180:183], v[148:151], 0
    ds_read_b128 v[184:187], v232 offset:1024
    v_mfma_f32_16x16x32_bf16 v[8:11], v[152:155], v[136:139], 0
    v_mfma_f32_16x16x32_bf16 v[12:15], v[156:159], v[136:139], 0
    v_add_u32 v232, s52, v233
    v_mfma_f32_16x16x32_bf16 v[16:19], v[160:163], v[136:139], 0
    v_add_u32 v235, s52, v239
    v_mfma_f32_16x16x32_bf16 v[20:23], v[164:167], v[136:139], 0
    v_add_u32 v236, s52, v240
    v_mfma_f32_16x16x32_bf16 v[24:27], v[168:171], v[136:139], 0
    v_mfma_f32_16x16x32_bf16 v[28:31], v[172:175], v[136:139], 0
    v_add_u32 v237, s52, v241
    v_mfma_f32_16x16x32_bf16 v[32:35], v[176:179], v[136:139], 0
    v_add_u32 v238, s52, v242
    v_mfma_f32_16x16x32_bf16 v[36:39], v[180:183], v[136:139], 0
    s_waitcnt lgkmcnt(0)
    v_mfma_f32_16x16x32_bf16 v[40:43], v[200:203], v[188:191], v[40:43]
    s_waitcnt vmcnt(12)
    s_barrier
    v_mfma_f32_16x16x32_bf16 v[44:47], v[204:207], v[188:191], v[44:47]
    ds_read_b128 v[140:143], v232 offset:2048
    v_mfma_f32_16x16x32_bf16 v[48:51], v[208:211], v[188:191], v[48:51]
    ds_read_b64_tr_b16 v[152:153], v235 offset:0
    v_mfma_f32_16x16x32_bf16 v[52:55], v[212:215], v[188:191], v[52:55]
    ds_read_b64_tr_b16 v[154:155], v235 offset:4096
    v_mfma_f32_16x16x32_bf16 v[56:59], v[216:219], v[188:191], v[56:59]
    ds_read_b64_tr_b16 v[156:157], v236 offset:0
    v_mfma_f32_16x16x32_bf16 v[60:63], v[220:223], v[188:191], v[60:63]
    ds_read_b64_tr_b16 v[158:159], v236 offset:4096
    v_mfma_f32_16x16x32_bf16 v[64:67], v[224:227], v[188:191], v[64:67]
    v_mfma_f32_16x16x32_bf16 v[68:71], v[228:231], v[188:191], v[68:71]
    ds_read_b64_tr_b16 v[160:161], v237 offset:0
    v_mfma_f32_16x16x32_bf16 v[72:75], v[200:203], v[192:195], v[72:75]
    ds_read_b64_tr_b16 v[162:163], v237 offset:4096
    v_mfma_f32_16x16x32_bf16 v[76:79], v[204:207], v[192:195], v[76:79]
    ds_read_b64_tr_b16 v[164:165], v238 offset:0
    v_mfma_f32_16x16x32_bf16 v[80:83], v[208:211], v[192:195], v[80:83]
    ds_read_b64_tr_b16 v[166:167], v238 offset:4096
    v_mfma_f32_16x16x32_bf16 v[84:87], v[212:215], v[192:195], v[84:87]
    ds_read_b64_tr_b16 v[168:169], v235 offset:16384
    v_mfma_f32_16x16x32_bf16 v[88:91], v[216:219], v[192:195], v[88:91]
    v_mfma_f32_16x16x32_bf16 v[92:95], v[220:223], v[192:195], v[92:95]
    ds_read_b64_tr_b16 v[170:171], v235 offset:20480
    v_mfma_f32_16x16x32_bf16 v[96:99], v[224:227], v[192:195], v[96:99]
    ds_read_b64_tr_b16 v[172:173], v236 offset:16384
    v_mfma_f32_16x16x32_bf16 v[100:103], v[228:231], v[192:195], v[100:103]
    ds_read_b64_tr_b16 v[174:175], v236 offset:20480
    v_mfma_f32_16x16x32_bf16 v[104:107], v[200:203], v[196:199], v[104:107]
    ds_read_b64_tr_b16 v[176:177], v237 offset:16384
    v_mfma_f32_16x16x32_bf16 v[108:111], v[204:207], v[196:199], v[108:111]
    ds_read_b64_tr_b16 v[178:179], v237 offset:20480
    v_mfma_f32_16x16x32_bf16 v[112:115], v[208:211], v[196:199], v[112:115]
    v_mfma_f32_16x16x32_bf16 v[116:119], v[212:215], v[196:199], v[116:119]
    ds_read_b64_tr_b16 v[180:181], v238 offset:16384
    v_mfma_f32_16x16x32_bf16 v[120:123], v[216:219], v[196:199], v[120:123]
    ds_read_b64_tr_b16 v[182:183], v238 offset:20480
    v_mfma_f32_16x16x32_bf16 v[124:127], v[220:223], v[196:199], v[124:127]
    ds_read_b128 v[144:147], v232 offset:4096
    v_mfma_f32_16x16x32_bf16 v[128:131], v[224:227], v[196:199], v[128:131]
    ds_read_b128 v[148:151], v232 offset:6144
    v_mfma_f32_16x16x32_bf16 v[132:135], v[228:231], v[196:199], v[132:135]
    ds_read_b128 v[136:139], v232 offset:0
    v_mfma_f32_16x16x32_bf16 v[8:11], v[200:203], v[184:187], v[8:11]
    v_mfma_f32_16x16x32_bf16 v[12:15], v[204:207], v[184:187], v[12:15]
    v_mfma_f32_16x16x32_bf16 v[16:19], v[208:211], v[184:187], v[16:19]
    v_mfma_f32_16x16x32_bf16 v[20:23], v[212:215], v[184:187], v[20:23]
    v_mfma_f32_16x16x32_bf16 v[24:27], v[216:219], v[184:187], v[24:27]
    v_mfma_f32_16x16x32_bf16 v[28:31], v[220:223], v[184:187], v[28:31]
    v_mfma_f32_16x16x32_bf16 v[32:35], v[224:227], v[184:187], v[32:35]
    s_add_u32 s52, s52, 49152
    s_cmp_ge_u32 s52, 147456
    s_cselect_b32 s52, 0, s52
    v_mfma_f32_16x16x32_bf16 v[36:39], v[228:231], v[184:187], v[36:39]
    s_waitcnt lgkmcnt(0)
    v_mfma_f32_16x16x32_bf16 v[40:43], v[152:155], v[140:143], v[40:43]
    ds_read_b128 v[188:191], v232 offset:3072
    v_mfma_f32_16x16x32_bf16 v[44:47], v[156:159], v[140:143], v[44:47]
    ds_read_b64_tr_b16 v[200:201], v235 offset:8192
    v_mfma_f32_16x16x32_bf16 v[48:51], v[160:163], v[140:143], v[48:51]
    ds_read_b64_tr_b16 v[202:203], v235 offset:12288
    v_mfma_f32_16x16x32_bf16 v[52:55], v[164:167], v[140:143], v[52:55]
    ds_read_b64_tr_b16 v[204:205], v236 offset:8192
    v_mfma_f32_16x16x32_bf16 v[56:59], v[168:171], v[140:143], v[56:59]
    v_mfma_f32_16x16x32_bf16 v[60:63], v[172:175], v[140:143], v[60:63]
    ds_read_b64_tr_b16 v[206:207], v236 offset:12288
    v_mfma_f32_16x16x32_bf16 v[64:67], v[176:179], v[140:143], v[64:67]
    ds_read_b64_tr_b16 v[208:209], v237 offset:8192
    v_mfma_f32_16x16x32_bf16 v[68:71], v[180:183], v[140:143], v[68:71]
    ds_read_b64_tr_b16 v[210:211], v237 offset:12288
    v_mfma_f32_16x16x32_bf16 v[72:75], v[152:155], v[144:147], v[72:75]
    ds_read_b64_tr_b16 v[212:213], v238 offset:8192
    v_mfma_f32_16x16x32_bf16 v[76:79], v[156:159], v[144:147], v[76:79]
    v_mfma_f32_16x16x32_bf16 v[80:83], v[160:163], v[144:147], v[80:83]
    ds_read_b64_tr_b16 v[214:215], v238 offset:12288
    v_mfma_f32_16x16x32_bf16 v[84:87], v[164:167], v[144:147], v[84:87]
    ds_read_b64_tr_b16 v[216:217], v235 offset:24576
    v_mfma_f32_16x16x32_bf16 v[88:91], v[168:171], v[144:147], v[88:91]
    ds_read_b64_tr_b16 v[218:219], v235 offset:28672
    v_mfma_f32_16x16x32_bf16 v[92:95], v[172:175], v[144:147], v[92:95]
    ds_read_b64_tr_b16 v[220:221], v236 offset:24576
    v_mfma_f32_16x16x32_bf16 v[96:99], v[176:179], v[144:147], v[96:99]
    v_mfma_f32_16x16x32_bf16 v[100:103], v[180:183], v[144:147], v[100:103]
    ds_read_b64_tr_b16 v[222:223], v236 offset:28672
    v_mfma_f32_16x16x32_bf16 v[104:107], v[152:155], v[148:151], v[104:107]
    ds_read_b64_tr_b16 v[224:225], v237 offset:24576
    v_mfma_f32_16x16x32_bf16 v[108:111], v[156:159], v[148:151], v[108:111]
    ds_read_b64_tr_b16 v[226:227], v237 offset:28672
    v_mfma_f32_16x16x32_bf16 v[112:115], v[160:163], v[148:151], v[112:115]
    ds_read_b64_tr_b16 v[228:229], v238 offset:24576
    v_mfma_f32_16x16x32_bf16 v[116:119], v[164:167], v[148:151], v[116:119]
    v_mfma_f32_16x16x32_bf16 v[120:123], v[168:171], v[148:151], v[120:123]
    ds_read_b64_tr_b16 v[230:231], v238 offset:28672
    v_mfma_f32_16x16x32_bf16 v[124:127], v[172:175], v[148:151], v[124:127]
    ds_read_b128 v[192:195], v232 offset:5120
    v_mfma_f32_16x16x32_bf16 v[128:131], v[176:179], v[148:151], v[128:131]
    ds_read_b128 v[196:199], v232 offset:7168
    v_mfma_f32_16x16x32_bf16 v[132:135], v[180:183], v[148:151], v[132:135]
    ds_read_b128 v[184:187], v232 offset:1024
    v_mfma_f32_16x16x32_bf16 v[8:11], v[152:155], v[136:139], v[8:11]
    v_mfma_f32_16x16x32_bf16 v[12:15], v[156:159], v[136:139], v[12:15]
    v_add_u32 v232, s52, v233
    v_mfma_f32_16x16x32_bf16 v[16:19], v[160:163], v[136:139], v[16:19]
    v_add_u32 v235, s52, v239
    v_mfma_f32_16x16x32_bf16 v[20:23], v[164:167], v[136:139], v[20:23]
    v_add_u32 v236, s52, v240
    v_mfma_f32_16x16x32_bf16 v[24:27], v[168:171], v[136:139], v[24:27]
    v_mfma_f32_16x16x32_bf16 v[28:31], v[172:175], v[136:139], v[28:31]
    v_add_u32 v237, s52, v241
    v_mfma_f32_16x16x32_bf16 v[32:35], v[176:179], v[136:139], v[32:35]
    v_add_u32 v238, s52, v242
    v_mfma_f32_16x16x32_bf16 v[36:39], v[180:183], v[136:139], v[36:39]
    s_waitcnt lgkmcnt(0)
    v_mfma_f32_16x16x32_bf16 v[40:43], v[200:203], v[188:191], v[40:43]
    s_waitcnt vmcnt(0)
    s_barrier
    v_mfma_f32_16x16x32_bf16 v[44:47], v[204:207], v[188:191], v[44:47]
    ds_read_b128 v[140:143], v232 offset:2048
    v_mfma_f32_16x16x32_bf16 v[48:51], v[208:211], v[188:191], v[48:51]
    ds_read_b64_tr_b16 v[152:153], v235 offset:0
    v_mfma_f32_16x16x32_bf16 v[52:55], v[212:215], v[188:191], v[52:55]
    ds_read_b64_tr_b16 v[154:155], v235 offset:4096
    v_mfma_f32_16x16x32_bf16 v[56:59], v[216:219], v[188:191], v[56:59]
    ds_read_b64_tr_b16 v[156:157], v236 offset:0
    v_mfma_f32_16x16x32_bf16 v[60:63], v[220:223], v[188:191], v[60:63]
    ds_read_b64_tr_b16 v[158:159], v236 offset:4096
    v_mfma_f32_16x16x32_bf16 v[64:67], v[224:227], v[188:191], v[64:67]
    v_mfma_f32_16x16x32_bf16 v[68:71], v[228:231], v[188:191], v[68:71]
    ds_read_b64_tr_b16 v[160:161], v237 offset:0
    v_mfma_f32_16x16x32_bf16 v[72:75], v[200:203], v[192:195], v[72:75]
    ds_read_b64_tr_b16 v[162:163], v237 offset:4096
    v_mfma_f32_16x16x32_bf16 v[76:79], v[204:207], v[192:195], v[76:79]
    ds_read_b64_tr_b16 v[164:165], v238 offset:0
    v_mfma_f32_16x16x32_bf16 v[80:83], v[208:211], v[192:195], v[80:83]
    ds_read_b64_tr_b16 v[166:167], v238 offset:4096
    v_mfma_f32_16x16x32_bf16 v[84:87], v[212:215], v[192:195], v[84:87]
    ds_read_b64_tr_b16 v[168:169], v235 offset:16384
    v_mfma_f32_16x16x32_bf16 v[88:91], v[216:219], v[192:195], v[88:91]
    v_mfma_f32_16x16x32_bf16 v[92:95], v[220:223], v[192:195], v[92:95]
    ds_read_b64_tr_b16 v[170:171], v235 offset:20480
    v_mfma_f32_16x16x32_bf16 v[96:99], v[224:227], v[192:195], v[96:99]
    ds_read_b64_tr_b16 v[172:173], v236 offset:16384
    v_mfma_f32_16x16x32_bf16 v[100:103], v[228:231], v[192:195], v[100:103]
    ds_read_b64_tr_b16 v[174:175], v236 offset:20480
    v_mfma_f32_16x16x32_bf16 v[104:107], v[200:203], v[196:199], v[104:107]
    ds_read_b64_tr_b16 v[176:177], v237 offset:16384
    v_mfma_f32_16x16x32_bf16 v[108:111], v[204:207], v[196:199], v[108:111]
    ds_read_b64_tr_b16 v[178:179], v237 offset:20480
    v_mfma_f32_16x16x32_bf16 v[112:115], v[208:211], v[196:199], v[112:115]
    v_mfma_f32_16x16x32_bf16 v[116:119], v[212:215], v[196:199], v[116:119]
    ds_read_b64_tr_b16 v[180:181], v238 offset:16384
    v_mfma_f32_16x16x32_bf16 v[120:123], v[216:219], v[196:199], v[120:123]
    ds_read_b64_tr_b16 v[182:183], v238 offset:20480
    v_mfma_f32_16x16x32_bf16 v[124:127], v[220:223], v[196:199], v[124:127]
    ds_read_b128 v[144:147], v232 offset:4096
    v_mfma_f32_16x16x32_bf16 v[128:131], v[224:227], v[196:199], v[128:131]
    ds_read_b128 v[148:151], v232 offset:6144
    v_mfma_f32_16x16x32_bf16 v[132:135], v[228:231], v[196:199], v[132:135]
    ds_read_b128 v[136:139], v232 offset:0
    v_mfma_f32_16x16x32_bf16 v[8:11], v[200:203], v[184:187], v[8:11]
    v_mfma_f32_16x16x32_bf16 v[12:15], v[204:207], v[184:187], v[12:15]
    v_mfma_f32_16x16x32_bf16 v[16:19], v[208:211], v[184:187], v[16:19]
    v_mfma_f32_16x16x32_bf16 v[20:23], v[212:215], v[184:187], v[20:23]
    v_mfma_f32_16x16x32_bf16 v[24:27], v[216:219], v[184:187], v[24:27]
    v_mfma_f32_16x16x32_bf16 v[28:31], v[220:223], v[184:187], v[28:31]
    v_mfma_f32_16x16x32_bf16 v[32:35], v[224:227], v[184:187], v[32:35]
    s_add_u32 s52, s52, 49152
    s_cmp_ge_u32 s52, 147456
    s_cselect_b32 s52, 0, s52
    v_mfma_f32_16x16x32_bf16 v[36:39], v[228:231], v[184:187], v[36:39]
    s_waitcnt lgkmcnt(0)
    v_mfma_f32_16x16x32_bf16 v[40:43], v[152:155], v[140:143], v[40:43]
    ds_read_b128 v[188:191], v232 offset:3072
    v_mfma_f32_16x16x32_bf16 v[44:47], v[156:159], v[140:143], v[44:47]
    ds_read_b64_tr_b16 v[200:201], v235 offset:8192
    v_mfma_f32_16x16x32_bf16 v[48:51], v[160:163], v[140:143], v[48:51]
    ds_read_b64_tr_b16 v[202:203], v235 offset:12288
    v_mfma_f32_16x16x32_bf16 v[52:55], v[164:167], v[140:143], v[52:55]
    ds_read_b64_tr_b16 v[204:205], v236 offset:8192
    v_mfma_f32_16x16x32_bf16 v[56:59], v[168:171], v[140:143], v[56:59]
    v_mfma_f32_16x16x32_bf16 v[60:63], v[172:175], v[140:143], v[60:63]
    ds_read_b64_tr_b16 v[206:207], v236 offset:12288
    v_mfma_f32_16x16x32_bf16 v[64:67], v[176:179], v[140:143], v[64:67]
    ds_read_b64_tr_b16 v[208:209], v237 offset:8192
    v_mfma_f32_16x16x32_bf16 v[68:71], v[180:183], v[140:143], v[68:71]
    ds_read_b64_tr_b16 v[210:211], v237 offset:12288
    v_mfma_f32_16x16x32_bf16 v[72:75], v[152:155], v[144:147], v[72:75]
    ds_read_b64_tr_b16 v[212:213], v238 offset:8192
    v_mfma_f32_16x16x32_bf16 v[76:79], v[156:159], v[144:147], v[76:79]
    v_mfma_f32_16x16x32_bf16 v[80:83], v[160:163], v[144:147], v[80:83]
    ds_read_b64_tr_b16 v[214:215], v238 offset:12288
    v_mfma_f32_16x16x32_bf16 v[84:87], v[164:167], v[144:147], v[84:87]
    ds_read_b64_tr_b16 v[216:217], v235 offset:24576
    v_mfma_f32_16x16x32_bf16 v[88:91], v[168:171], v[144:147], v[88:91]
    ds_read_b64_tr_b16 v[218:219], v235 offset:28672
    v_mfma_f32_16x16x32_bf16 v[92:95], v[172:175], v[144:147], v[92:95]
    ds_read_b64_tr_b16 v[220:221], v236 offset:24576
    v_mfma_f32_16x16x32_bf16 v[96:99], v[176:179], v[144:147], v[96:99]
    v_mfma_f32_16x16x32_bf16 v[100:103], v[180:183], v[144:147], v[100:103]
    ds_read_b64_tr_b16 v[222:223], v236 offset:28672
    v_mfma_f32_16x16x32_bf16 v[104:107], v[152:155], v[148:151], v[104:107]
    s_movk_i32 s54, 7
M_P_loop5:
    ds_read_b64_tr_b16 v[224:225], v237 offset:24576
    v_mfma_f32_16x16x32_bf16 v[108:111], v[156:159], v[148:151], v[108:111]
    ds_read_b64_tr_b16 v[226:227], v237 offset:28672
    v_mfma_f32_16x16x32_bf16 v[112:115], v[160:163], v[148:151], v[112:115]
    ds_read_b64_tr_b16 v[228:229], v238 offset:24576
    v_mfma_f32_16x16x32_bf16 v[116:119], v[164:167], v[148:151], v[116:119]
    v_mfma_f32_16x16x32_bf16 v[120:123], v[168:171], v[148:151], v[120:123]
    ds_read_b64_tr_b16 v[230:231], v238 offset:28672
    v_mfma_f32_16x16x32_bf16 v[124:127], v[172:175], v[148:151], v[124:127]
    ds_read_b128 v[192:195], v232 offset:5120
    v_mfma_f32_16x16x32_bf16 v[128:131], v[176:179], v[148:151], v[128:131]
    ds_read_b128 v[196:199], v232 offset:7168
    v_mfma_f32_16x16x32_bf16 v[132:135], v[180:183], v[148:151], v[132:135]
    ds_read_b128 v[184:187], v232 offset:1024
    v_mfma_f32_16x16x32_bf16 v[8:11], v[152:155], v[136:139], v[8:11]
    v_mfma_f32_16x16x32_bf16 v[12:15], v[156:159], v[136:139], v[12:15]
    v_add_u32 v232, s52, v233
    v_mfma_f32_16x16x32_bf16 v[16:19], v[160:163], v[136:139], v[16:19]
    v_add_u32 v235, s52, v239
    v_mfma_f32_16x16x32_bf16 v[20:23], v[164:167], v[136:139], v[20:23]
    v_add_u32 v236, s52, v240
    v_mfma_f32_16x16x32_bf16 v[24:27], v[168:171], v[136:139], v[24:27]
    v_mfma_f32_16x16x32_bf16 v[28:31], v[172:175], v[136:139], v[28:31]
    v_add_u32 v237, s52, v241
    v_mfma_f32_16x16x32_bf16 v[32:35], v[176:179], v[136:139], v[32:35]
    v_add_u32 v238, s52, v242
    v_mfma_f32_16x16x32_bf16 v[36:39], v[180:183], v[136:139], v[36:39]
    s_waitcnt lgkmcnt(0)
    v_mfma_f32_16x16x32_bf16 v[40:43], v[200:203], v[188:191], v[40:43]
    s_barrier
    v_mfma_f32_16x16x32_bf16 v[44:47], v[204:207], v[188:191], v[44:47]
    ds_read_b128 v[140:143], v232 offset:2048
    v_mfma_f32_16x16x32_bf16 v[48:51], v[208:211], v[188:191], v[48:51]
    ds_read_b64_tr_b16 v[152:153], v235 offset:0
    v_mfma_f32_16x16x32_bf16 v[52:55], v[212:215], v[188:191], v[52:55]
    ds_read_b64_tr_b16 v[154:155], v235 offset:4096
    v_mfma_f32_16x16x32_bf16 v[56:59], v[216:219], v[188:191], v[56:59]
    ds_read_b64_tr_b16 v[156:157], v236 offset:0
    v_mfma_f32_16x16x32_bf16 v[60:63], v[220:223], v[188:191], v[60:63]
    ds_read_b64_tr_b16 v[158:159], v236 offset:4096
    v_mfma_f32_16x16x32_bf16 v[64:67], v[224:227], v[188:191], v[64:67]
    v_mfma_f32_16x16x32_bf16 v[68:71], v[228:231], v[188:191], v[68:71]
    ds_read_b64_tr_b16 v[160:161], v237 offset:0
    v_mfma_f32_16x16x32_bf16 v[72:75], v[200:203], v[192:195], v[72:75]
    ds_read_b64_tr_b16 v[162:163], v237 offset:4096
    v_mfma_f32_16x16x32_bf16 v[76:79], v[204:207], v[192:195], v[76:79]
    ds_read_b64_tr_b16 v[164:165], v238 offset:0
    v_mfma_f32_16x16x32_bf16 v[80:83], v[208:211], v[192:195], v[80:83]
    ds_read_b64_tr_b16 v[166:167], v238 offset:4096
    v_mfma_f32_16x16x32_bf16 v[84:87], v[212:215], v[192:195], v[84:87]
    ds_read_b64_tr_b16 v[168:169], v235 offset:16384
    v_mfma_f32_16x16x32_bf16 v[88:91], v[216:219], v[192:195], v[88:91]
    v_mfma_f32_16x16x32_bf16 v[92:95], v[220:223], v[192:195], v[92:95]
    ds_read_b64_tr_b16 v[170:171], v235 offset:20480
    v_mfma_f32_16x16x32_bf16 v[96:99], v[224:227], v[192:195], v[96:99]
    ds_read_b64_tr_b16 v[172:173], v236 offset:16384
    v_mfma_f32_16x16x32_bf16 v[100:103], v[228:231], v[192:195], v[100:103]
    ds_read_b64_tr_b16 v[174:175], v236 offset:20480
    v_mfma_f32_16x16x32_bf16 v[104:107], v[200:203], v[196:199], v[104:107]
    ds_read_b64_tr_b16 v[176:177], v237 offset:16384
    v_mfma_f32_16x16x32_bf16 v[108:111], v[204:207], v[196:199], v[108:111]
    ds_read_b64_tr_b16 v[178:179], v237 offset:20480
    v_mfma_f32_16x16x32_bf16 v[112:115], v[208:211], v[196:199], v[112:115]
    v_mfma_f32_16x16x32_bf16 v[116:119], v[212:215], v[196:199], v[116:119]
    ds_read_b64_tr_b16 v[180:181], v238 offset:16384
    v_mfma_f32_16x16x32_bf16 v[120:123], v[216:219], v[196:199], v[120:123]
    ds_read_b64_tr_b16 v[182:183], v238 offset:20480
    v_mfma_f32_16x16x32_bf16 v[124:127], v[220:223], v[196:199], v[124:127]
    ds_read_b128 v[144:147], v232 offset:4096
    v_mfma_f32_16x16x32_bf16 v[128:131], v[224:227], v[196:199], v[128:131]
    ds_read_b128 v[148:151], v232 offset:6144
    v_mfma_f32_16x16x32_bf16 v[132:135], v[228:231], v[196:199], v[132:135]
    ds_read_b128 v[136:139], v232 offset:0
    v_mfma_f32_16x16x32_bf16 v[8:11], v[200:203], v[184:187], v[8:11]
    v_mfma_f32_16x16x32_bf16 v[12:15], v[204:207], v[184:187], v[12:15]
    v_mfma_f32_16x16x32_bf16 v[16:19], v[208:211], v[184:187], v[16:19]
    v_mfma_f32_16x16x32_bf16 v[20:23], v[212:215], v[184:187], v[20:23]
    v_mfma_f32_16x16x32_bf16 v[24:27], v[216:219], v[184:187], v[24:27]
    v_mfma_f32_16x16x32_bf16 v[28:31], v[220:223], v[184:187], v[28:31]
    v_mfma_f32_16x16x32_bf16 v[32:35], v[224:227], v[184:187], v[32:35]
    s_add_u32 s52, s52, 49152
    s_cmp_ge_u32 s52, 147456
    s_cselect_b32 s52, 0, s52
    v_mfma_f32_16x16x32_bf16 v[36:39], v[228:231], v[184:187], v[36:39]
    s_waitcnt lgkmcnt(0)
    v_mfma_f32_16x16x32_bf16 v[40:43], v[152:155], v[140:143], v[40:43]
    ds_read_b128 v[188:191], v232 offset:3072
    v_mfma_f32_16x16x32_bf16 v[44:47], v[156:159], v[140:143], v[44:47]
    ds_read_b64_tr_b16 v[200:201], v235 offset:8192
    v_mfma_f32_16x16x32_bf16 v[48:51], v[160:163], v[140:143], v[48:51]
    ds_read_b64_tr_b16 v[202:203], v235 offset:12288
    v_mfma_f32_16x16x32_bf16 v[52:55], v[164:167], v[140:143], v[52:55]
    ds_read_b64_tr_b16 v[204:205], v236 offset:8192
    v_mfma_f32_16x16x32_bf16 v[56:59], v[168:171], v[140:143], v[56:59]
    v_mfma_f32_16x16x32_bf16 v[60:63], v[172:175], v[140:143], v[60:63]
    ds_read_b64_tr_b16 v[206:207], v236 offset:12288
    v_mfma_f32_16x16x32_bf16 v[64:67], v[176:179], v[140:143], v[64:67]
    ds_read_b64_tr_b16 v[208:209], v237 offset:8192
    v_mfma_f32_16x16x32_bf16 v[68:71], v[180:183], v[140:143], v[68:71]
    ds_read_b64_tr_b16 v[210:211], v237 offset:12288
    v_mfma_f32_16x16x32_bf16 v[72:75], v[152:155], v[144:147], v[72:75]
    ds_read_b64_tr_b16 v[212:213], v238 offset:8192
    v_mfma_f32_16x16x32_bf16 v[76:79], v[156:159], v[144:147], v[76:79]
    v_mfma_f32_16x16x32_bf16 v[80:83], v[160:163], v[144:147], v[80:83]
    ds_read_b64_tr_b16 v[214:215], v238 offset:12288
    v_mfma_f32_16x16x32_bf16 v[84:87], v[164:167], v[144:147], v[84:87]
    ds_read_b64_tr_b16 v[216:217], v235 offset:24576
    v_mfma_f32_16x16x32_bf16 v[88:91], v[168:171], v[144:147], v[88:91]
    ds_read_b64_tr_b16 v[218:219], v235 offset:28672
    v_mfma_f32_16x16x32_bf16 v[92:95], v[172:175], v[144:147], v[92:95]
    ds_read_b64_tr_b16 v[220:221], v236 offset:24576
    v_mfma_f32_16x16x32_bf16 v[96:99], v[176:179], v[144:147], v[96:99]
    v_mfma_f32_16x16x32_bf16 v[100:103], v[180:183], v[144:147], v[100:103]
    s_sub_u32 s54, s54, 1
    ds_read_b64_tr_b16 v[222:223], v236 offset:28672
    v_mfma_f32_16x16x32_bf16 v[104:107], v[152:155], v[148:151], v[104:107]
    s_cbranch_scc0 M_P_loop5
    ds_read_b64_tr_b16 v[224:225], v237 offset:24576
    v_mfma_f32_16x16x32_bf16 v[108:111], v[156:159], v[148:151], v[108:111]
    ds_read_b64_tr_b16 v[226:227], v237 offset:28672
    v_mfma_f32_16x16x32_bf16 v[112:115], v[160:163], v[148:151], v[112:115]
    ds_read_b64_tr_b16 v[228:229], v238 offset:24576
    v_mfma_f32_16x16x32_bf16 v[116:119], v[164:167], v[148:151], v[116:119]
    v_mfma_f32_16x16x32_bf16 v[120:123], v[168:171], v[148:151], v[120:123]
    ds_read_b64_tr_b16 v[230:231], v238 offset:28672
    v_mfma_f32_16x16x32_bf16 v[124:127], v[172:175], v[148:151], v[124:127]
    ds_read_b128 v[192:195], v232 offset:5120
    v_mfma_f32_16x16x32_bf16 v[128:131], v[176:179], v[148:151], v[128:131]
    ds_read_b128 v[196:199], v232 offset:7168
    v_mfma_f32_16x16x32_bf16 v[132:135], v[180:183], v[148:151], v[132:135]
    ds_read_b128 v[184:187], v232 offset:1024
    v_mfma_f32_16x16x32_bf16 v[8:11], v[152:155], v[136:139], v[8:11]
    v_mfma_f32_16x16x32_bf16 v[12:15], v[156:159], v[136:139], v[12:15]
    v_add_u32 v232, s52, v233
    v_mfma_f32_16x16x32_bf16 v[16:19], v[160:163], v[136:139], v[16:19]
    v_add_u32 v235, s52, v239
    v_mfma_f32_16x16x32_bf16 v[20:23], v[164:167], v[136:139], v[20:23]
    v_add_u32 v236, s52, v240
    v_mfma_f32_16x16x32_bf16 v[24:27], v[168:171], v[136:139], v[24:27]
    v_mfma_f32_16x16x32_bf16 v[28:31], v[172:175], v[136:139], v[28:31]
    v_add_u32 v237, s52, v241
    v_mfma_f32_16x16x32_bf16 v[32:35], v[176:179], v[136:139], v[32:35]
    v_add_u32 v238, s52, v242
    v_mfma_f32_16x16x32_bf16 v[36:39], v[180:183], v[136:139], v[36:39]
    s_waitcnt lgkmcnt(0)
    v_mfma_f32_16x16x32_bf16 v[40:43], v[200:203], v[188:191], v[40:43]
    s_barrier
    v_mfma_f32_16x16x32_bf16 v[44:47], v[204:207], v[188:191], v[44:47]
    ds_read_b128 v[140:143], v232 offset:2048
    v_mfma_f32_16x16x32_bf16 v[48:51], v[208:211], v[188:191], v[48:51]
    ds_read_b64_tr_b16 v[152:153], v235 offset:0
    v_mfma_f32_16x16x32_bf16 v[52:55], v[212:215], v[188:191], v[52:55]
    ds_read_b64_tr_b16 v[154:155], v235 offset:4096
    v_mfma_f32_16x16x32_bf16 v[56:59], v[216:219], v[188:191], v[56:59]
    v_mfma_f32_16x16x32_bf16 v[60:63], v[220:223], v[188:191], v[60:63]
    ds_read_b64_tr_b16 v[156:157], v236 offset:0
    v_mfma_f32_16x16x32_bf16 v[64:67], v[224:227], v[188:191], v[64:67]
    ds_read_b64_tr_b16 v[158:159], v236 offset:4096
    v_mfma_f32_16x16x32_bf16 v[68:71], v[228:231], v[188:191], v[68:71]
    ds_read_b64_tr_b16 v[160:161], v237 offset:0
    v_mfma_f32_16x16x32_bf16 v[72:75], v[200:203], v[192:195], v[72:75]
    v_mfma_f32_16x16x32_bf16 v[76:79], v[204:207], v[192:195], v[76:79]
    ds_read_b64_tr_b16 v[162:163], v237 offset:4096
    v_mfma_f32_16x16x32_bf16 v[80:83], v[208:211], v[192:195], v[80:83]
    ds_read_b64_tr_b16 v[164:165], v238 offset:0
    v_mfma_f32_16x16x32_bf16 v[84:87], v[212:215], v[192:195], v[84:87]
    ds_read_b64_tr_b16 v[166:167], v238 offset:4096
    v_mfma_f32_16x16x32_bf16 v[88:91], v[216:219], v[192:195], v[88:91]
    v_mfma_f32_16x16x32_bf16 v[92:95], v[220:223], v[192:195], v[92:95]
    ds_read_b64_tr_b16 v[168:169], v235 offset:16384
    v_mfma_f32_16x16x32_bf16 v[96:99], v[224:227], v[192:195], v[96:99]
    ds_read_b64_tr_b16 v[170:171], v235 offset:20480
    v_mfma_f32_16x16x32_bf16 v[100:103], v[228:231], v[192:195], v[100:103]
    ds_read_b64_tr_b16 v[172:173], v236 offset:16384
    v_mfma_f32_16x16x32_bf16 v[104:107], v[200:203], v[196:199], v[104:107]
    v_mfma_f32_16x16x32_bf16 v[108:111], v[204:207], v[196:199], v[108:111]
    ds_read_b64_tr_b16 v[174:175], v236 offset:20480
    v_mfma_f32_16x16x32_bf16 v[112:115], v[208:211], v[196:199], v[112:115]
    ds_read_b64_tr_b16 v[176:177], v237 offset:16384
    v_mfma_f32_16x16x32_bf16 v[116:119], v[212:215], v[196:199], v[116:119]
    ds_read_b64_tr_b16 v[178:179], v237 offset:20480
    v_mfma_f32_16x16x32_bf16 v[120:123], v[216:219], v[196:199], v[120:123]
    v_mfma_f32_16x16x32_bf16 v[124:127], v[220:223], v[196:199], v[124:127]
    ds_read_b64_tr_b16 v[180:181], v238 offset:16384
    v_mfma_f32_16x16x32_bf16 v[128:131], v[224:227], v[196:199], v[128:131]
    ds_read_b64_tr_b16 v[182:183], v238 offset:20480
    v_mfma_f32_16x16x32_bf16 v[132:135], v[228:231], v[196:199], v[132:135]
    ds_read_b128 v[144:147], v232 offset:4096
    v_mfma_f32_16x16x32_bf16 v[8:11], v[200:203], v[184:187], v[8:11]
    v_mfma_f32_16x16x32_bf16 v[12:15], v[204:207], v[184:187], v[12:15]
    v_mfma_f32_16x16x32_bf16 v[16:19], v[208:211], v[184:187], v[16:19]
    v_mfma_f32_16x16x32_bf16 v[20:23], v[212:215], v[184:187], v[20:23]
    v_mfma_f32_16x16x32_bf16 v[24:27], v[216:219], v[184:187], v[24:27]
    v_mfma_f32_16x16x32_bf16 v[28:31], v[220:223], v[184:187], v[28:31]
    v_mfma_f32_16x16x32_bf16 v[32:35], v[224:227], v[184:187], v[32:35]
    s_add_u32 s52, s52, 49152
    s_cmp_ge_u32 s52, 147456
    s_cselect_b32 s52, 0, s52
    v_mfma_f32_16x16x32_bf16 v[36:39], v[228:231], v[184:187], v[36:39]
    s_waitcnt lgkmcnt(0)
    v_mfma_f32_16x16x32_bf16 v[40:43], v[152:155], v[140:143], v[40:43]
    ds_read_b128 v[188:191], v232 offset:3072
    ds_read_b64_tr_b16 v[200:201], v235 offset:8192
    v_mfma_f32_16x16x32_bf16 v[44:47], v[156:159], v[140:143], v[44:47]
    ds_read_b64_tr_b16 v[202:203], v235 offset:12288
    v_mfma_f32_16x16x32_bf16 v[48:51], v[160:163], v[140:143], v[48:51]
    ds_read_b64_tr_b16 v[204:205], v236 offset:8192
    ds_read_b64_tr_b16 v[206:207], v236 offset:12288
    v_mfma_f32_16x16x32_bf16 v[52:55], v[164:167], v[140:143], v[52:55]
    ds_read_b64_tr_b16 v[208:209], v237 offset:8192
    v_mfma_f32_16x16x32_bf16 v[56:59], v[168:171], v[140:143], v[56:59]
    ds_read_b64_tr_b16 v[210:211], v237 offset:12288
    ds_read_b64_tr_b16 v[212:213], v238 offset:8192
    v_mfma_f32_16x16x32_bf16 v[60:63], v[172:175], v[140:143], v[60:63]
    ds_read_b64_tr_b16 v[214:215], v238 offset:12288
    v_mfma_f32_16x16x32_bf16 v[64:67], v[176:179], v[140:143], v[64:67]
    ds_read_b64_tr_b16 v[216:217], v235 offset:24576
    ds_read_b64_tr_b16 v[218:219], v235 offset:28672
    v_mfma_f32_16x16x32_bf16 v[68:71], v[180:183], v[140:143], v[68:71]
    ds_read_b64_tr_b16 v[220:221], v236 offset:24576
    v_mfma_f32_16x16x32_bf16 v[72:75], v[152:155], v[144:147], v[72:75]
    s_movk_i32 s54, 1
M_P_loop6:
    ds_read_b64_tr_b16 v[222:223], v236 offset:28672
    ds_read_b64_tr_b16 v[224:225], v237 offset:24576
    v_mfma_f32_16x16x32_bf16 v[76:79], v[156:159], v[144:147], v[76:79]
    ds_read_b64_tr_b16 v[226:227], v237 offset:28672
    v_mfma_f32_16x16x32_bf16 v[80:83], v[160:163], v[144:147], v[80:83]
    ds_read_b64_tr_b16 v[228:229], v238 offset:24576
    ds_read_b64_tr_b16 v[230:231], v238 offset:28672
    v_mfma_f32_16x16x32_bf16 v[84:87], v[164:167], v[144:147], v[84:87]
    ds_read_b128 v[192:195], v232 offset:5120
    v_mfma_f32_16x16x32_bf16 v[88:91], v[168:171], v[144:147], v[88:91]
    v_add_u32 v232, s52, v233
    v_add_u32 v235, s52, v239
    v_mfma_f32_16x16x32_bf16 v[92:95], v[172:175], v[144:147], v[92:95]
    v_add_u32 v236, s52, v240
    v_mfma_f32_16x16x32_bf16 v[96:99], v[176:179], v[144:147], v[96:99]
    v_add_u32 v237, s52, v241
    v_mfma_f32_16x16x32_bf16 v[100:103], v[180:183], v[144:147], v[100:103]
    v_add_u32 v238, s52, v242
    s_waitcnt lgkmcnt(0)
    v_mfma_f32_16x16x32_bf16 v[40:43], v[200:203], v[188:191], v[40:43]
    s_barrier
    v_mfma_f32_16x16x32_bf16 v[44:47], v[204:207], v[188:191], v[44:47]
    ds_read_b128 v[140:143], v232 offset:2048
    ds_read_b64_tr_b16 v[152:153], v235 offset:0
    v_mfma_f32_16x16x32_bf16 v[48:51], v[208:211], v[188:191], v[48:51]
    ds_read_b64_tr_b16 v[154:155], v235 offset:4096
    ds_read_b64_tr_b16 v[156:157], v236 offset:0
    v_mfma_f32_16x16x32_bf16 v[52:55], v[212:215], v[188:191], v[52:55]
    ds_read_b64_tr_b16 v[158:159], v236 offset:4096
    v_mfma_f32_16x16x32_bf16 v[56:59], v[216:219], v[188:191], v[56:59]
    ds_read_b64_tr_b16 v[160:161], v237 offset:0
    ds_read_b64_tr_b16 v[162:163], v237 offset:4096
    v_mfma_f32_16x16x32_bf16 v[60:63], v[220:223], v[188:191], v[60:63]
    ds_read_b64_tr_b16 v[164:165], v238 offset:0
    ds_read_b64_tr_b16 v[166:167], v238 offset:4096
    v_mfma_f32_16x16x32_bf16 v[64:67], v[224:227], v[188:191], v[64:67]
    ds_read_b64_tr_b16 v[168:169], v235 offset:16384
    v_mfma_f32_16x16x32_bf16 v[68:71], v[228:231], v[188:191], v[68:71]
    ds_read_b64_tr_b16 v[170:171], v235 offset:20480
    ds_read_b64_tr_b16 v[172:173], v236 offset:16384
    v_mfma_f32_16x16x32_bf16 v[72:75], v[200:203], v[192:195], v[72:75]
    ds_read_b64_tr_b16 v[174:175], v236 offset:20480
    ds_read_b64_tr_b16 v[176:177], v237 offset:16384
    v_mfma_f32_16x16x32_bf16 v[76:79], v[204:207], v[192:195], v[76:79]
    ds_read_b64_tr_b16 v[178:179], v237 offset:20480
    v_mfma_f32_16x16x32_bf16 v[80:83], v[208:211], v[192:195], v[80:83]
    ds_read_b64_tr_b16 v[180:181], v238 offset:16384
    ds_read_b64_tr_b16 v[182:183], v238 offset:20480
    v_mfma_f32_16x16x32_bf16 v[84:87], v[212:215], v[192:195], v[84:87]
    ds_read_b128 v[144:147], v232 offset:4096
    v_mfma_f32_16x16x32_bf16 v[88:91], v[216:219], v[192:195], v[88:91]
    v_mfma_f32_16x16x32_bf16 v[92:95], v[220:223], v[192:195], v[92:95]
    v_mfma_f32_16x16x32_bf16 v[96:99], v[224:227], v[192:195], v[96:99]
    s_add_u32 s52, s52, 49152
    s_cmp_ge_u32 s52, 147456
    s_cselect_b32 s52, 0, s52
    v_mfma_f32_16x16x32_bf16 v[100:103], v[228:231], v[192:195], v[100:103]
    s_waitcnt lgkmcnt(0)
    v_mfma_f32_16x16x32_bf16 v[40:43], v[152:155], v[140:143], v[40:43]
    ds_read_b128 v[188:191], v232 offset:3072
    ds_read_b64_tr_b16 v[200:201], v235 offset:8192
    v_mfma_f32_16x16x32_bf16 v[44:47], v[156:159], v[140:143], v[44:47]
    ds_read_b64_tr_b16 v[202:203], v235 offset:12288
    v_mfma_f32_16x16x32_bf16 v[48:51], v[160:163], v[140:143], v[48:51]
    ds_read_b64_tr_b16 v[204:205], v236 offset:8192
    ds_read_b64_tr_b16 v[206:207], v236 offset:12288
    v_mfma_f32_16x16x32_bf16 v[52:55], v[164:167], v[140:143], v[52:55]
    ds_read_b64_tr_b16 v[208:209], v237 offset:8192
    v_mfma_f32_16x16x32_bf16 v[56:59], v[168:171], v[140:143], v[56:59]
    ds_read_b64_tr_b16 v[210:211], v237 offset:12288
    ds_read_b64_tr_b16 v[212:213], v238 offset:8192
    v_mfma_f32_16x16x32_bf16 v[60:63], v[172:175], v[140:143], v[60:63]
    ds_read_b64_tr_b16 v[214:215], v238 offset:12288
    v_mfma_f32_16x16x32_bf16 v[64:67], v[176:179], v[140:143], v[64:67]
    ds_read_b64_tr_b16 v[216:217], v235 offset:24576
    ds_read_b64_tr_b16 v[218:219], v235 offset:28672
    v_mfma_f32_16x16x32_bf16 v[68:71], v[180:183], v[140:143], v[68:71]
    s_sub_u32 s54, s54, 1
    ds_read_b64_tr_b16 v[220:221], v236 offset:24576
    v_mfma_f32_16x16x32_bf16 v[72:75], v[152:155], v[144:147], v[72:75]
    s_cbranch_scc0 M_P_loop6
    ds_read_b64_tr_b16 v[222:223], v236 offset:28672
    ds_read_b64_tr_b16 v[224:225], v237 offset:24576
    v_mfma_f32_16x16x32_bf16 v[76:79], v[156:159], v[144:147], v[76:79]
    ds_read_b64_tr_b16 v[226:227], v237 offset:28672
    v_mfma_f32_16x16x32_bf16 v[80:83], v[160:163], v[144:147], v[80:83]
    ds_read_b64_tr_b16 v[228:229], v238 offset:24576
    ds_read_b64_tr_b16 v[230:231], v238 offset:28672
    v_mfma_f32_16x16x32_bf16 v[84:87], v[164:167], v[144:147], v[84:87]
    ds_read_b128 v[192:195], v232 offset:5120
    v_mfma_f32_16x16x32_bf16 v[88:91], v[168:171], v[144:147], v[88:91]
    v_mfma_f32_16x16x32_bf16 v[92:95], v[172:175], v[144:147], v[92:95]
    v_mfma_f32_16x16x32_bf16 v[96:99], v[176:179], v[144:147], v[96:99]
    v_mfma_f32_16x16x32_bf16 v[100:103], v[180:183], v[144:147], v[100:103]
    s_waitcnt lgkmcnt(0)
    v_mfma_f32_16x16x32_bf16 v[40:43], v[200:203], v[188:191], v[40:43]
    v_add_u32 v232, 49152, v233
    v_add_u32 v235, 49152, v239
    v_mfma_f32_16x16x32_bf16 v[44:47], v[204:207], v[188:191], v[44:47]
    v_add_u32 v236, 49152, v240
    v_add_u32 v237, 49152, v241
    v_mfma_f32_16x16x32_bf16 v[48:51], v[208:211], v[188:191], v[48:51]
    v_add_u32 v238, 49152, v242
    v_mfma_f32_16x16x32_bf16 v[52:55], v[212:215], v[188:191], v[52:55]
    ds_read_b128 v[148:151], v232 offset:6144
    ds_read_b64_tr_b16 v[152:153], v235 offset:0
    v_mfma_f32_16x16x32_bf16 v[56:59], v[216:219], v[188:191], v[56:59]
    ds_read_b64_tr_b16 v[154:155], v235 offset:4096
    v_mfma_f32_16x16x32_bf16 v[60:63], v[220:223], v[188:191], v[60:63]
    ds_read_b64_tr_b16 v[156:157], v236 offset:0
    ds_read_b64_tr_b16 v[158:159], v236 offset:4096
    v_mfma_f32_16x16x32_bf16 v[64:67], v[224:227], v[188:191], v[64:67]
    ds_read_b64_tr_b16 v[160:161], v237 offset:0
    v_mfma_f32_16x16x32_bf16 v[68:71], v[228:231], v[188:191], v[68:71]
    ds_read_b64_tr_b16 v[162:163], v237 offset:4096
    ds_read_b64_tr_b16 v[164:165], v238 offset:0
    v_mfma_f32_16x16x32_bf16 v[72:75], v[200:203], v[192:195], v[72:75]
    ds_read_b64_tr_b16 v[166:167], v238 offset:4096
    ds_read_b64_tr_b16 v[168:169], v235 offset:16384
    v_mfma_f32_16x16x32_bf16 v[76:79], v[204:207], v[192:195], v[76:79]
    ds_read_b64_tr_b16 v[170:171], v235 offset:20480
    v_mfma_f32_16x16x32_bf16 v[80:83], v[208:211], v[192:195], v[80:83]
    ds_read_b64_tr_b16 v[172:173], v236 offset:16384
    ds_read_b64_tr_b16 v[174:175], v236 offset:20480
    v_mfma_f32_16x16x32_bf16 v[84:87], v[212:215], v[192:195], v[84:87]
    ds_read_b64_tr_b16 v[176:177], v237 offset:16384
    v_cvt_pk_bf16_f32 v40, v40, v41
    v_cvt_pk_bf16_f32 v41, v42, v43
    v_mfma_f32_16x16x32_bf16 v[88:91], v[216:219], v[192:195], v[88:91]
    ds_read_b64_tr_b16 v[178:179], v237 offset:20480
    ds_read_b64_tr_b16 v[180:181], v238 offset:16384
    v_cvt_pk_bf16_f32 v42, v44, v45
    v_cvt_pk_bf16_f32 v43, v46, v47
    v_mfma_f32_16x16x32_bf16 v[92:95], v[220:223], v[192:195], v[92:95]
    ds_read_b64_tr_b16 v[182:183], v238 offset:20480
    buffer_store_dwordx4 v[40:43], v249, s[28:31], s73 offen offset:0 sc1
    v_cvt_pk_bf16_f32 v48, v48, v49
    v_mfma_f32_16x16x32_bf16 v[96:99], v[224:227], v[192:195], v[96:99]
    v_cvt_pk_bf16_f32 v49, v50, v51
    v_cvt_pk_bf16_f32 v50, v52, v53
    v_mfma_f32_16x16x32_bf16 v[100:103], v[228:231], v[192:195], v[100:103]
    v_cvt_pk_bf16_f32 v51, v54, v55
    buffer_store_dwordx4 v[48:51], v249, s[28:31], s73 offen offset:1024 sc1
    s_waitcnt lgkmcnt(14)
    v_mfma_f32_16x16x32_bf16 v[104:107], v[152:155], v[148:151], v[104:107]
    ds_read_b128 v[196:199], v232 offset:7168
    ds_read_b64_tr_b16 v[200:201], v235 offset:8192
    v_cvt_pk_bf16_f32 v56, v56, v57
    s_waitcnt lgkmcnt(14)
    v_mfma_f32_16x16x32_bf16 v[108:111], v[156:159], v[148:151], v[108:111]
    ds_read_b64_tr_b16 v[202:203], v235 offset:12288
    ds_read_b64_tr_b16 v[204:205], v236 offset:8192
    v_cvt_pk_bf16_f32 v57, v58, v59
    s_waitcnt lgkmcnt(14)
    v_mfma_f32_16x16x32_bf16 v[112:115], v[160:163], v[148:151], v[112:115]
    ds_read_b64_tr_b16 v[206:207], v236 offset:12288
    ds_read_b64_tr_b16 v[208:209], v237 offset:8192
    v_cvt_pk_bf16_f32 v58, v60, v61
    s_waitcnt lgkmcnt(14)
    v_mfma_f32_16x16x32_bf16 v[116:119], v[164:167], v[148:151], v[116:119]
    ds_read_b64_tr_b16 v[210:211], v237 offset:12288
    ds_read_b64_tr_b16 v[212:213], v238 offset:8192
    v_cvt_pk_bf16_f32 v59, v62, v63
    s_waitcnt lgkmcnt(14)
    v_mfma_f32_16x16x32_bf16 v[120:123], v[168:171], v[148:151], v[120:123]
    ds_read_b64_tr_b16 v[214:215], v238 offset:12288
    ds_read_b64_tr_b16 v[216:217], v235 offset:24576
    buffer_store_dwordx4 v[56:59], v249, s[28:31], s73 offen offset:2048 sc1
    s_waitcnt lgkmcnt(14)
    v_mfma_f32_16x16x32_bf16 v[124:127], v[172:175], v[148:151], v[124:127]
    ds_read_b64_tr_b16 v[218:219], v235 offset:28672
    ds_read_b64_tr_b16 v[220:221], v236 offset:24576
    v_cvt_pk_bf16_f32 v64, v64, v65
    s_waitcnt lgkmcnt(14)
    v_mfma_f32_16x16x32_bf16 v[128:131], v[176:179], v[148:151], v[128:131]
    ds_read_b64_tr_b16 v[222:223], v236 offset:28672
    ds_read_b64_tr_b16 v[224:225], v237 offset:24576
    v_cvt_pk_bf16_f32 v65, v66, v67
    s_waitcnt lgkmcnt(14)
    v_mfma_f32_16x16x32_bf16 v[132:135], v[180:183], v[148:151], v[132:135]
    ds_read_b64_tr_b16 v[226:227], v237 offset:28672
    ds_read_b64_tr_b16 v[228:229], v238 offset:24576
    ds_read_b64_tr_b16 v[230:231], v238 offset:28672
    v_cvt_pk_bf16_f32 v66, v68, v69
    s_waitcnt lgkmcnt(14)
    v_mfma_f32_16x16x32_bf16 v[104:107], v[200:203], v[196:199], v[104:107]
    v_add_u32 v232, 98304, v233
    v_add_u32 v235, 98304, v239
    v_cvt_pk_bf16_f32 v67, v70, v71
    s_waitcnt lgkmcnt(12)
    v_mfma_f32_16x16x32_bf16 v[108:111], v[204:207], v[196:199], v[108:111]
    v_add_u32 v236, 98304, v240
    v_add_u32 v237, 98304, v241
    v_add_u32 v238, 98304, v242
    buffer_store_dwordx4 v[64:67], v249, s[28:31], s73 offen offset:3072 sc1
    s_waitcnt lgkmcnt(10)
    v_mfma_f32_16x16x32_bf16 v[112:115], v[208:211], v[196:199], v[112:115]
    ds_read_b128 v[148:151], v232 offset:6144
    ds_read_b64_tr_b16 v[152:153], v235 offset:0
    ds_read_b64_tr_b16 v[154:155], v235 offset:4096
    v_cvt_pk_bf16_f32 v72, v72, v73
    s_waitcnt lgkmcnt(11)
    v_mfma_f32_16x16x32_bf16 v[116:119], v[212:215], v[196:199], v[116:119]
    ds_read_b64_tr_b16 v[156:157], v236 offset:0
    ds_read_b64_tr_b16 v[158:159], v236 offset:4096
    ds_read_b64_tr_b16 v[160:161], v237 offset:0
    v_cvt_pk_bf16_f32 v73, v74, v75
    s_waitcnt lgkmcnt(12)
    v_mfma_f32_16x16x32_bf16 v[120:123], v[216:219], v[196:199], v[120:123]
    ds_read_b64_tr_b16 v[162:163], v237 offset:4096
    ds_read_b64_tr_b16 v[164:165], v238 offset:0
    v_cvt_pk_bf16_f32 v74, v76, v77
    s_waitcnt lgkmcnt(12)
    v_mfma_f32_16x16x32_bf16 v[124:127], v[220:223], v[196:199], v[124:127]
    ds_read_b64_tr_b16 v[166:167], v238 offset:4096
    ds_read_b64_tr_b16 v[168:169], v235 offset:16384
    ds_read_b64_tr_b16 v[170:171], v235 offset:20480
    v_cvt_pk_bf16_f32 v75, v78, v79
    s_waitcnt lgkmcnt(13)
    v_mfma_f32_16x16x32_bf16 v[128:131], v[224:227], v[196:199], v[128:131]
    ds_read_b64_tr_b16 v[172:173], v236 offset:16384
    ds_read_b64_tr_b16 v[174:175], v236 offset:20480
    ds_read_b64_tr_b16 v[176:177], v237 offset:16384
    buffer_store_dwordx4 v[72:75], v249, s[28:31], s74 offen offset:0 sc1
    s_waitcnt lgkmcnt(14)
    v_mfma_f32_16x16x32_bf16 v[132:135], v[228:231], v[196:199], v[132:135]
    ds_read_b64_tr_b16 v[178:179], v237 offset:20480
    ds_read_b64_tr_b16 v[180:181], v238 offset:16384
    ds_read_b64_tr_b16 v[182:183], v238 offset:20480
    v_cvt_pk_bf16_f32 v80, v80, v81
    s_waitcnt lgkmcnt(14)
    v_mfma_f32_16x16x32_bf16 v[104:107], v[152:155], v[148:151], v[104:107]
    ds_read_b128 v[196:199], v232 offset:7168
    ds_read_b64_tr_b16 v[200:201], v235 offset:8192
    v_cvt_pk_bf16_f32 v81, v82, v83
    s_waitcnt lgkmcnt(14)
    v_mfma_f32_16x16x32_bf16 v[108:111], v[156:159], v[148:151], v[108:111]
    ds_read_b64_tr_b16 v[202:203], v235 offset:12288
    ds_read_b64_tr_b16 v[204:205], v236 offset:8192
    v_cvt_pk_bf16_f32 v82, v84, v85
    s_waitcnt lgkmcnt(14)
    v_mfma_f32_16x16x32_bf16 v[112:115], v[160:163], v[148:151], v[112:115]
    ds_read_b64_tr_b16 v[206:207], v236 offset:12288
    ds_read_b64_tr_b16 v[208:209], v237 offset:8192
    v_cvt_pk_bf16_f32 v83, v86, v87
    s_waitcnt lgkmcnt(14)
    v_mfma_f32_16x16x32_bf16 v[116:119], v[164:167], v[148:151], v[116:119]
    ds_read_b64_tr_b16 v[210:211], v237 offset:12288
    ds_read_b64_tr_b16 v[212:213], v238 offset:8192
    buffer_store_dwordx4 v[80:83], v249, s[28:31], s74 offen offset:1024 sc1
    s_waitcnt lgkmcnt(14)
    v_mfma_f32_16x16x32_bf16 v[120:123], v[168:171], v[148:151], v[120:123]
    ds_read_b64_tr_b16 v[214:215], v238 offset:12288
    ds_read_b64_tr_b16 v[216:217], v235 offset:24576
    v_cvt_pk_bf16_f32 v88, v88, v89
    s_waitcnt lgkmcnt(14)
    v_mfma_f32_16x16x32_bf16 v[124:127], v[172:175], v[148:151], v[124:127]
    ds_read_b64_tr_b16 v[218:219], v235 offset:28672
    ds_read_b64_tr_b16 v[220:221], v236 offset:24576
    v_cvt_pk_bf16_f32 v89, v90, v91
    s_waitcnt lgkmcnt(14)
    v_mfma_f32_16x16x32_bf16 v[128:131], v[176:179], v[148:151], v[128:131]
    ds_read_b64_tr_b16 v[222:223], v236 offset:28672
    ds_read_b64_tr_b16 v[224:225], v237 offset:24576
    v_cvt_pk_bf16_f32 v90, v92, v93
    s_waitcnt lgkmcnt(14)
    v_mfma_f32_16x16x32_bf16 v[132:135], v[180:183], v[148:151], v[132:135]
    ds_read_b64_tr_b16 v[226:227], v237 offset:28672
    ds_read_b64_tr_b16 v[228:229], v238 offset:24576
    ds_read_b64_tr_b16 v[230:231], v238 offset:28672
    v_cvt_pk_bf16_f32 v91, v94, v95
    s_waitcnt lgkmcnt(14)
    v_mfma_f32_16x16x32_bf16 v[104:107], v[200:203], v[196:199], v[104:107]
    v_add_u32 v232, 0, v233
    v_add_u32 v235, 0, v239
    buffer_store_dwordx4 v[88:91], v249, s[28:31], s74 offen offset:2048 sc1
    s_waitcnt lgkmcnt(12)
    v_mfma_f32_16x16x32_bf16 v[108:111], v[204:207], v[196:199], v[108:111]
    v_add_u32 v236, 0, v240
    v_add_u32 v237, 0, v241
    v_add_u32 v238, 0, v242
    v_cvt_pk_bf16_f32 v96, v96, v97
    s_waitcnt lgkmcnt(10)
    v_mfma_f32_16x16x32_bf16 v[112:115], v[208:211], v[196:199], v[112:115]
    ds_read_b128 v[148:151], v232 offset:6144
    ds_read_b64_tr_b16 v[152:153], v235 offset:0
    ds_read_b64_tr_b16 v[154:155], v235 offset:4096
    v_cvt_pk_bf16_f32 v97, v98, v99
    s_waitcnt lgkmcnt(11)
    v_mfma_f32_16x16x32_bf16 v[116:119], v[212:215], v[196:199], v[116:119]
    ds_read_b64_tr_b16 v[156:157], v236 offset:0
    ds_read_b64_tr_b16 v[158:159], v236 offset:4096
    ds_read_b64_tr_b16 v[160:161], v237 offset:0
    v_cvt_pk_bf16_f32 v98, v100, v101
    s_waitcnt lgkmcnt(12)
    v_mfma_f32_16x16x32_bf16 v[120:123], v[216:219], v[196:199], v[120:123]
    ds_read_b64_tr_b16 v[162:163], v237 offset:4096
    ds_read_b64_tr_b16 v[164:165], v238 offset:0
    v_cvt_pk_bf16_f32 v99, v102, v103
    s_waitcnt lgkmcnt(12)
    v_mfma_f32_16x16x32_bf16 v[124:127], v[220:223], v[196:199], v[124:127]
    ds_read_b64_tr_b16 v[166:167], v238 offset:4096
    ds_read_b64_tr_b16 v[168:169], v235 offset:16384
    ds_read_b64_tr_b16 v[170:171], v235 offset:20480
    buffer_store_dwordx4 v[96:99], v249, s[28:31], s74 offen offset:3072 sc1
    s_waitcnt lgkmcnt(13)
    v_mfma_f32_16x16x32_bf16 v[128:131], v[224:227], v[196:199], v[128:131]
    ds_read_b64_tr_b16 v[172:173], v236 offset:16384
    ds_read_b64_tr_b16 v[174:175], v236 offset:20480
    ds_read_b64_tr_b16 v[176:177], v237 offset:16384
    s_waitcnt lgkmcnt(14)
    v_mfma_f32_16x16x32_bf16 v[132:135], v[228:231], v[196:199], v[132:135]
    ds_read_b64_tr_b16 v[178:179], v237 offset:20480
    ds_read_b64_tr_b16 v[180:181], v238 offset:16384
    ds_read_b64_tr_b16 v[182:183], v238 offset:20480
    s_waitcnt lgkmcnt(14)
    v_mfma_f32_16x16x32_bf16 v[104:107], v[152:155], v[148:151], v[104:107]
    ds_read_b128 v[196:199], v232 offset:7168
    ds_read_b64_tr_b16 v[200:201], v235 offset:8192
    s_waitcnt lgkmcnt(14)
    v_mfma_f32_16x16x32_bf16 v[108:111], v[156:159], v[148:151], v[108:111]
    ds_read_b64_tr_b16 v[202:203], v235 offset:12288
    ds_read_b64_tr_b16 v[204:205], v236 offset:8192
    s_waitcnt lgkmcnt(14)
    v_mfma_f32_16x16x32_bf16 v[112:115], v[160:163], v[148:151], v[112:115]
    ds_read_b64_tr_b16 v[206:207], v236 offset:12288
    ds_read_b64_tr_b16 v[208:209], v237 offset:8192
    s_waitcnt lgkmcnt(14)
    v_mfma_f32_16x16x32_bf16 v[116:119], v[164:167], v[148:151], v[116:119]
    ds_read_b64_tr_b16 v[210:211], v237 offset:12288
    ds_read_b64_tr_b16 v[212:213], v238 offset:8192
    s_waitcnt lgkmcnt(14)
    v_mfma_f32_16x16x32_bf16 v[120:123], v[168:171], v[148:151], v[120:123]
    ds_read_b64_tr_b16 v[214:215], v238 offset:12288
    ds_read_b64_tr_b16 v[216:217], v235 offset:24576
    s_waitcnt lgkmcnt(14)
    v_mfma_f32_16x16x32_bf16 v[124:127], v[172:175], v[148:151], v[124:127]
    ds_read_b64_tr_b16 v[218:219], v235 offset:28672
    ds_read_b64_tr_b16 v[220:221], v236 offset:24576
    s_waitcnt lgkmcnt(14)
    v_mfma_f32_16x16x32_bf16 v[128:131], v[176:179], v[148:151], v[128:131]
    ds_read_b64_tr_b16 v[222:223], v236 offset:28672
    ds_read_b64_tr_b16 v[224:225], v237 offset:24576
    s_waitcnt lgkmcnt(14)
    v_mfma_f32_16x16x32_bf16 v[132:135], v[180:183], v[148:151], v[132:135]
    ds_read_b64_tr_b16 v[226:227], v237 offset:28672
    ds_read_b64_tr_b16 v[228:229], v238 offset:24576
    ds_read_b64_tr_b16 v[230:231], v238 offset:28672
    s_waitcnt lgkmcnt(14)
    v_mfma_f32_16x16x32_bf16 v[104:107], v[200:203], v[196:199], v[104:107]
    v_add_u32 v232, 49152, v233
    v_add_u32 v235, 49152, v239
    s_waitcnt lgkmcnt(12)
    v_mfma_f32_16x16x32_bf16 v[108:111], v[204:207], v[196:199], v[108:111]
    v_add_u32 v236, 49152, v240
    v_add_u32 v237, 49152, v241
    v_add_u32 v238, 49152, v242
    s_waitcnt lgkmcnt(10)
    v_mfma_f32_16x16x32_bf16 v[112:115], v[208:211], v[196:199], v[112:115]
    ds_read_b128 v[136:139], v232 offset:0
    ds_read_b64_tr_b16 v[152:153], v235 offset:0
    ds_read_b64_tr_b16 v[154:155], v235 offset:4096
    s_waitcnt lgkmcnt(11)
    v_mfma_f32_16x16x32_bf16 v[116:119], v[212:215], v[196:199], v[116:119]
    ds_read_b64_tr_b16 v[156:157], v236 offset:0
    ds_read_b64_tr_b16 v[158:159], v236 offset:4096
    ds_read_b64_tr_b16 v[160:161], v237 offset:0
    s_waitcnt lgkmcnt(12)
    v_mfma_f32_16x16x32_bf16 v[120:123], v[216:219], v[196:199], v[120:123]
    ds_read_b64_tr_b16 v[162:163], v237 offset:4096
    ds_read_b64_tr_b16 v[164:165], v238 offset:0
    s_waitcnt lgkmcnt(12)
    v_mfma_f32_16x16x32_bf16 v[124:127], v[220:223], v[196:199], v[124:127]
    ds_read_b64_tr_b16 v[166:167], v238 offset:4096
    ds_read_b64_tr_b16 v[168:169], v235 offset:16384
    ds_read_b64_tr_b16 v[170:171], v235 offset:20480
    s_waitcnt lgkmcnt(13)
    v_mfma_f32_16x16x32_bf16 v[128:131], v[224:227], v[196:199], v[128:131]
    ds_read_b64_tr_b16 v[172:173], v236 offset:16384
    ds_read_b64_tr_b16 v[174:175], v236 offset:20480
    ds_read_b64_tr_b16 v[176:177], v237 offset:16384
    s_waitcnt lgkmcnt(14)
    v_mfma_f32_16x16x32_bf16 v[132:135], v[228:231], v[196:199], v[132:135]
    ds_read_b64_tr_b16 v[178:179], v237 offset:20480
    ds_read_b64_tr_b16 v[180:181], v238 offset:16384
    ds_read_b64_tr_b16 v[182:183], v238 offset:20480
    s_waitcnt lgkmcnt(14)
    v_mfma_f32_16x16x32_bf16 v[8:11], v[152:155], v[136:139], v[8:11]
    ds_read_b128 v[184:187], v232 offset:1024
    ds_read_b64_tr_b16 v[200:201], v235 offset:8192
    v_cvt_pk_bf16_f32 v104, v104, v105
    v_cvt_pk_bf16_f32 v105, v106, v107
    s_waitcnt lgkmcnt(14)
    v_mfma_f32_16x16x32_bf16 v[12:15], v[156:159], v[136:139], v[12:15]
    ds_read_b64_tr_b16 v[202:203], v235 offset:12288
    ds_read_b64_tr_b16 v[204:205], v236 offset:8192
    v_cvt_pk_bf16_f32 v106, v108, v109
    v_cvt_pk_bf16_f32 v107, v110, v111
    s_waitcnt lgkmcnt(14)
    v_mfma_f32_16x16x32_bf16 v[16:19], v[160:163], v[136:139], v[16:19]
    ds_read_b64_tr_b16 v[206:207], v236 offset:12288
    ds_read_b64_tr_b16 v[208:209], v237 offset:8192
    buffer_store_dwordx4 v[104:107], v249, s[28:31], s75 offen offset:0 sc1
    v_cvt_pk_bf16_f32 v112, v112, v113
    s_waitcnt lgkmcnt(14)
    v_mfma_f32_16x16x32_bf16 v[20:23], v[164:167], v[136:139], v[20:23]
    ds_read_b64_tr_b16 v[210:211], v237 offset:12288
    ds_read_b64_tr_b16 v[212:213], v238 offset:8192
    v_cvt_pk_bf16_f32 v113, v114, v115
    v_cvt_pk_bf16_f32 v114, v116, v117
    s_waitcnt lgkmcnt(14)
    v_mfma_f32_16x16x32_bf16 v[24:27], v[168:171], v[136:139], v[24:27]
    ds_read_b64_tr_b16 v[214:215], v238 offset:12288
    ds_read_b64_tr_b16 v[216:217], v235 offset:24576
    v_cvt_pk_bf16_f32 v115, v118, v119
    buffer_store_dwordx4 v[112:115], v249, s[28:31], s75 offen offset:1024 sc1
    s_waitcnt lgkmcnt(14)
    v_mfma_f32_16x16x32_bf16 v[28:31], v[172:175], v[136:139], v[28:31]
    ds_read_b64_tr_b16 v[218:219], v235 offset:28672
    ds_read_b64_tr_b16 v[220:221], v236 offset:24576
    v_cvt_pk_bf16_f32 v120, v120, v121
    v_cvt_pk_bf16_f32 v121, v122, v123
    s_waitcnt lgkmcnt(14)
    v_mfma_f32_16x16x32_bf16 v[32:35], v[176:179], v[136:139], v[32:35]
    ds_read_b64_tr_b16 v[222:223], v236 offset:28672
    ds_read_b64_tr_b16 v[224:225], v237 offset:24576
    v_cvt_pk_bf16_f32 v122, v124, v125
    v_cvt_pk_bf16_f32 v123, v126, v127
    s_waitcnt lgkmcnt(14)
    v_mfma_f32_16x16x32_bf16 v[36:39], v[180:183], v[136:139], v[36:39]
    ds_read_b64_tr_b16 v[226:227], v237 offset:28672
    ds_read_b64_tr_b16 v[228:229], v238 offset:24576
    ds_read_b64_tr_b16 v[230:231], v238 offset:28672
    buffer_store_dwordx4 v[120:123], v249, s[28:31], s75 offen offset:2048 sc1
    v_cvt_pk_bf16_f32 v128, v128, v129
    s_waitcnt lgkmcnt(14)
    v_mfma_f32_16x16x32_bf16 v[8:11], v[200:203], v[184:187], v[8:11]
    v_add_u32 v232, 98304, v233
    v_add_u32 v235, 98304, v239
    v_cvt_pk_bf16_f32 v129, v130, v131
    v_cvt_pk_bf16_f32 v130, v132, v133
    s_waitcnt lgkmcnt(12)
    v_mfma_f32_16x16x32_bf16 v[12:15], v[204:207], v[184:187], v[12:15]
    v_add_u32 v236, 98304, v240
    v_add_u32 v237, 98304, v241
    v_add_u32 v238, 98304, v242
    v_cvt_pk_bf16_f32 v131, v134, v135
    buffer_store_dwordx4 v[128:131], v249, s[28:31], s75 offen offset:3072 sc1
    s_waitcnt lgkmcnt(10)
    v_mfma_f32_16x16x32_bf16 v[16:19], v[208:211], v[184:187], v[16:19]
    ds_read_b128 v[136:139], v232 offset:0
    ds_read_b64_tr_b16 v[152:153], v235 offset:0
    ds_read_b64_tr_b16 v[154:155], v235 offset:4096
    buffer_load_dwordx4 v[44:47], v248, s[28:31], 0 offen offset:0 sc1
    buffer_load_dwordx4 v[52:55], v248, s[28:31], 0 offen offset:1024 sc1
    s_waitcnt lgkmcnt(11)
    v_mfma_f32_16x16x32_bf16 v[20:23], v[212:215], v[184:187], v[20:23]
    ds_read_b64_tr_b16 v[156:157], v236 offset:0
    ds_read_b64_tr_b16 v[158:159], v236 offset:4096
    ds_read_b64_tr_b16 v[160:161], v237 offset:0
    buffer_load_dwordx4 v[60:63], v248, s[28:31], s83 offen offset:0 sc1
    buffer_load_dwordx4 v[68:71], v248, s[28:31], s83 offen offset:1024 sc1
    s_waitcnt lgkmcnt(12)
    v_mfma_f32_16x16x32_bf16 v[24:27], v[216:219], v[184:187], v[24:27]
    ds_read_b64_tr_b16 v[162:163], v237 offset:4096
    ds_read_b64_tr_b16 v[164:165], v238 offset:0
    buffer_load_dwordx4 v[76:79], v247, s[28:31], 0 offen offset:0 sc1
    buffer_load_dwordx4 v[84:87], v247, s[28:31], 0 offen offset:64 sc1
    s_waitcnt lgkmcnt(12)
    v_mfma_f32_16x16x32_bf16 v[28:31], v[220:223], v[184:187], v[28:31]
    ds_read_b64_tr_b16 v[166:167], v238 offset:4096
    ds_read_b64_tr_b16 v[168:169], v235 offset:16384
    ds_read_b64_tr_b16 v[170:171], v235 offset:20480
    buffer_load_dwordx4 v[92:95], v247, s[28:31], 0 offen offset:128 sc1
    buffer_load_dwordx4 v[100:103], v247, s[28:31], 0 offen offset:192 sc1
    s_waitcnt lgkmcnt(13)
    v_mfma_f32_16x16x32_bf16 v[32:35], v[224:227], v[184:187], v[32:35]
    ds_read_b64_tr_b16 v[172:173], v236 offset:16384
    ds_read_b64_tr_b16 v[174:175], v236 offset:20480
    ds_read_b64_tr_b16 v[176:177], v237 offset:16384
    buffer_load_dwordx4 v[108:111], v247, s[28:31], 0 offen offset:512 sc1
    buffer_load_dwordx4 v[116:119], v247, s[28:31], 0 offen offset:576 sc1
    s_waitcnt lgkmcnt(14)
    v_mfma_f32_16x16x32_bf16 v[36:39], v[228:231], v[184:187], v[36:39]
    ds_read_b64_tr_b16 v[178:179], v237 offset:20480
    ds_read_b64_tr_b16 v[180:181], v238 offset:16384
    ds_read_b64_tr_b16 v[182:183], v238 offset:20480
    buffer_load_dwordx4 v[124:127], v247, s[28:31], 0 offen offset:640 sc1
    buffer_load_dwordx4 v[132:135], v247, s[28:31], 0 offen offset:704 sc1
    s_waitcnt lgkmcnt(14)
    v_mfma_f32_16x16x32_bf16 v[8:11], v[152:155], v[136:139], v[8:11]
    ds_read_b128 v[184:187], v232 offset:1024
    ds_read_b64_tr_b16 v[200:201], v235 offset:8192
    s_waitcnt lgkmcnt(14)
    v_mfma_f32_16x16x32_bf16 v[12:15], v[156:159], v[136:139], v[12:15]
    ds_read_b64_tr_b16 v[202:203], v235 offset:12288
    ds_read_b64_tr_b16 v[204:205], v236 offset:8192
    s_waitcnt lgkmcnt(14)
    v_mfma_f32_16x16x32_bf16 v[16:19], v[160:163], v[136:139], v[16:19]
    ds_read_b64_tr_b16 v[206:207], v236 offset:12288
    ds_read_b64_tr_b16 v[208:209], v237 offset:8192
    s_waitcnt lgkmcnt(14)
    v_mfma_f32_16x16x32_bf16 v[20:23], v[164:167], v[136:139], v[20:23]
    ds_read_b64_tr_b16 v[210:211], v237 offset:12288
    ds_read_b64_tr_b16 v[212:213], v238 offset:8192
    s_waitcnt lgkmcnt(14)
    v_mfma_f32_16x16x32_bf16 v[24:27], v[168:171], v[136:139], v[24:27]
    ds_read_b64_tr_b16 v[214:215], v238 offset:12288
    ds_read_b64_tr_b16 v[216:217], v235 offset:24576
    s_waitcnt lgkmcnt(14)
    v_mfma_f32_16x16x32_bf16 v[28:31], v[172:175], v[136:139], v[28:31]
    ds_read_b64_tr_b16 v[218:219], v235 offset:28672
    ds_read_b64_tr_b16 v[220:221], v236 offset:24576
    s_waitcnt lgkmcnt(14)
    v_mfma_f32_16x16x32_bf16 v[32:35], v[176:179], v[136:139], v[32:35]
    ds_read_b64_tr_b16 v[222:223], v236 offset:28672
    ds_read_b64_tr_b16 v[224:225], v237 offset:24576
    s_waitcnt lgkmcnt(14)
    v_mfma_f32_16x16x32_bf16 v[36:39], v[180:183], v[136:139], v[36:39]
    ds_read_b64_tr_b16 v[226:227], v237 offset:28672
    ds_read_b64_tr_b16 v[228:229], v238 offset:24576
    ds_read_b64_tr_b16 v[230:231], v238 offset:28672
    s_waitcnt lgkmcnt(14)
    v_mfma_f32_16x16x32_bf16 v[8:11], v[200:203], v[184:187], v[8:11]
    v_add_u32 v232, 0, v233
    v_add_u32 v235, 0, v239
    s_waitcnt lgkmcnt(12)
    v_mfma_f32_16x16x32_bf16 v[12:15], v[204:207], v[184:187], v[12:15]
    v_add_u32 v236, 0, v240
    v_add_u32 v237, 0, v241
    v_add_u32 v238, 0, v242
    s_waitcnt lgkmcnt(10)
    v_mfma_f32_16x16x32_bf16 v[16:19], v[208:211], v[184:187], v[16:19]
    ds_read_b128 v[136:139], v232 offset:0
    ds_read_b64_tr_b16 v[152:153], v235 offset:0
    ds_read_b64_tr_b16 v[154:155], v235 offset:4096
    s_waitcnt lgkmcnt(11)
    v_mfma_f32_16x16x32_bf16 v[20:23], v[212:215], v[184:187], v[20:23]
    ds_read_b64_tr_b16 v[156:157], v236 offset:0
    ds_read_b64_tr_b16 v[158:159], v236 offset:4096
    ds_read_b64_tr_b16 v[160:161], v237 offset:0
    s_waitcnt lgkmcnt(12)
    v_mfma_f32_16x16x32_bf16 v[24:27], v[216:219], v[184:187], v[24:27]
    ds_read_b64_tr_b16 v[162:163], v237 offset:4096
    ds_read_b64_tr_b16 v[164:165], v238 offset:0
    s_waitcnt lgkmcnt(12)
    v_mfma_f32_16x16x32_bf16 v[28:31], v[220:223], v[184:187], v[28:31]
    ds_read_b64_tr_b16 v[166:167], v238 offset:4096
    ds_read_b64_tr_b16 v[168:169], v235 offset:16384
    ds_read_b64_tr_b16 v[170:171], v235 offset:20480
    s_waitcnt lgkmcnt(13)
    v_mfma_f32_16x16x32_bf16 v[32:35], v[224:227], v[184:187], v[32:35]
    ds_read_b64_tr_b16 v[172:173], v236 offset:16384
    ds_read_b64_tr_b16 v[174:175], v236 offset:20480
    ds_read_b64_tr_b16 v[176:177], v237 offset:16384
    s_waitcnt lgkmcnt(14)
    v_mfma_f32_16x16x32_bf16 v[36:39], v[228:231], v[184:187], v[36:39]
    ds_read_b64_tr_b16 v[178:179], v237 offset:20480
    ds_read_b64_tr_b16 v[180:181], v238 offset:16384
    ds_read_b64_tr_b16 v[182:183], v238 offset:20480
    s_waitcnt lgkmcnt(14)
    v_mfma_f32_16x16x32_bf16 v[8:11], v[152:155], v[136:139], v[8:11]
    ds_read_b128 v[184:187], v232 offset:1024
    ds_read_b64_tr_b16 v[200:201], v235 offset:8192
    s_waitcnt lgkmcnt(14)
    v_mfma_f32_16x16x32_bf16 v[12:15], v[156:159], v[136:139], v[12:15]
    ds_read_b64_tr_b16 v[202:203], v235 offset:12288
    ds_read_b64_tr_b16 v[204:205], v236 offset:8192
    s_waitcnt lgkmcnt(14)
    v_mfma_f32_16x16x32_bf16 v[16:19], v[160:163], v[136:139], v[16:19]
    ds_read_b64_tr_b16 v[206:207], v236 offset:12288
    ds_read_b64_tr_b16 v[208:209], v237 offset:8192
    s_waitcnt lgkmcnt(14)
    v_mfma_f32_16x16x32_bf16 v[20:23], v[164:167], v[136:139], v[20:23]
    ds_read_b64_tr_b16 v[210:211], v237 offset:12288
    ds_read_b64_tr_b16 v[212:213], v238 offset:8192
    s_waitcnt lgkmcnt(14)
    v_mfma_f32_16x16x32_bf16 v[24:27], v[168:171], v[136:139], v[24:27]
    ds_read_b64_tr_b16 v[214:215], v238 offset:12288
    ds_read_b64_tr_b16 v[216:217], v235 offset:24576
    s_waitcnt lgkmcnt(14)
    v_mfma_f32_16x16x32_bf16 v[28:31], v[172:175], v[136:139], v[28:31]
    ds_read_b64_tr_b16 v[218:219], v235 offset:28672
    ds_read_b64_tr_b16 v[220:221], v236 offset:24576
    s_waitcnt lgkmcnt(14)
    v_mfma_f32_16x16x32_bf16 v[32:35], v[176:179], v[136:139], v[32:35]
    ds_read_b64_tr_b16 v[222:223], v236 offset:28672
    ds_read_b64_tr_b16 v[224:225], v237 offset:24576
    s_waitcnt lgkmcnt(14)
    v_mfma_f32_16x16x32_bf16 v[36:39], v[180:183], v[136:139], v[36:39]
    ds_read_b64_tr_b16 v[226:227], v237 offset:28672
    ds_read_b64_tr_b16 v[228:229], v238 offset:24576
    ds_read_b64_tr_b16 v[230:231], v238 offset:28672
    s_waitcnt lgkmcnt(14)
    v_mfma_f32_16x16x32_bf16 v[8:11], v[200:203], v[184:187], v[8:11]
    s_waitcnt lgkmcnt(12)
    v_mfma_f32_16x16x32_bf16 v[12:15], v[204:207], v[184:187], v[12:15]
    s_waitcnt lgkmcnt(10)
    v_mfma_f32_16x16x32_bf16 v[16:19], v[208:211], v[184:187], v[16:19]
    s_waitcnt lgkmcnt(8)
    v_mfma_f32_16x16x32_bf16 v[20:23], v[212:215], v[184:187], v[20:23]
    s_waitcnt lgkmcnt(6)
    v_mfma_f32_16x16x32_bf16 v[24:27], v[216:219], v[184:187], v[24:27]
    s_waitcnt lgkmcnt(4)
    v_mfma_f32_16x16x32_bf16 v[28:31], v[220:223], v[184:187], v[28:31]
    s_waitcnt lgkmcnt(2)
    v_mfma_f32_16x16x32_bf16 v[32:35], v[224:227], v[184:187], v[32:35]
    s_waitcnt lgkmcnt(0)
    v_mfma_f32_16x16x32_bf16 v[36:39], v[228:231], v[184:187], v[36:39]
    s_waitcnt vmcnt(20)
    s_atomic_swap s0, s[26:27], s77
    s_waitcnt vmcnt(16)
    s_atomic_swap s0, s[26:27], s78
    s_waitcnt vmcnt(12)
    s_atomic_swap s0, s[26:27], s79
    s_mov_b32 s3, 0x40000
    s_mov_b32 s88, 0
M_fchk:
    s_load_dword s84, s[62:63], 0 glc
    s_load_dword s85, s[62:63], 128 glc
    s_load_dword s86, s[62:63], 256 glc
    s_sub_u32 s3, s3, 1
    s_cbranch_scc1 M_fgo
    s_waitcnt lgkmcnt(0)
    s_cmp_lg_u32 s84, s0
    s_cbranch_scc1 M_fn0
    s_bitcmp1_b32 s88, 0
    s_cbranch_scc1 M_fn0
    s_bitset1_b32 s88, 0
    buffer_load_dwordx4 v[184:187], v249, s[28:31], s80 offen offset:0 sc1
    buffer_load_dwordx4 v[196:199], v249, s[28:31], s80 offen offset:1024 sc1
    buffer_load_dwordx4 v[208:211], v249, s[28:31], s80 offen offset:2048 sc1
    buffer_load_dwordx4 v[220:223], v249, s[28:31], s80 offen offset:3072 sc1
M_fn0:
    s_cmp_lg_u32 s85, s0
    s_cbranch_scc1 M_fn1
    s_bitcmp1_b32 s88, 1
    s_cbranch_scc1 M_fn1
    s_bitset1_b32 s88, 1
    buffer_load_dwordx4 v[188:191], v249, s[28:31], s81 offen offset:0 sc1
    buffer_load_dwordx4 v[200:203], v249, s[28:31], s81 offen offset:1024 sc1
    buffer_load_dwordx4 v[212:215], v249, s[28:31], s81 offen offset:2048 sc1
    buffer_load_dwordx4 v[224:227], v249, s[28:31], s81 offen offset:3072 sc1
M_fn1:
    s_cmp_lg_u32 s86, s0
    s_cbranch_scc1 M_fn2
    s_bitcmp1_b32 s88, 2
    s_cbranch_scc1 M_fn2
    s_bitset1_b32 s88, 2
    buffer_load_dwordx4 v[192:195], v249, s[28:31], s82 offen offset:0 sc1
    buffer_load_dwordx4 v[204:207], v249, s[28:31], s82 offen offset:1024 sc1
    buffer_load_dwordx4 v[216:219], v249, s[28:31], s82 offen offset:2048 sc1
    buffer_load_dwordx4 v[228:231], v249, s[28:31], s82 offen offset:3072 sc1
M_fn2:
    s_cmp_lg_u32 s88, 7
    s_cbranch_scc1 M_fchk
M_fgo:
    s_movk_i32 s88, 16384
    s_waitcnt vmcnt(3)
    v_lshlrev_b32 v160, 16, v44
    v_and_b32 v161, 0xffff0000, v44
    v_lshlrev_b32 v162, 16, v45
    v_and_b32 v163, 0xffff0000, v45
    v_lshlrev_b32 v164, 16, v46
    v_and_b32 v165, 0xffff0000, v46
    v_lshlrev_b32 v166, 16, v47
    v_and_b32 v167, 0xffff0000, v47
    v_lshlrev_b32 v136, 16, v184
    v_and_b32 v137, 0xffff0000, v184
    v_lshlrev_b32 v138, 16, v185
    v_and_b32 v139, 0xffff0000, v185
    v_lshlrev_b32 v140, 16, v186
    v_and_b32 v141, 0xffff0000, v186
    v_lshlrev_b32 v142, 16, v187
    v_and_b32 v143, 0xffff0000, v187
    v_lshlrev_b32 v144, 16, v188
    v_and_b32 v145, 0xffff0000, v188
    v_lshlrev_b32 v146, 16, v189
    v_and_b32 v147, 0xffff0000, v189
    v_lshlrev_b32 v148, 16, v190
    v_and_b32 v149, 0xffff0000, v190
    v_lshlrev_b32 v150, 16, v191
    v_and_b32 v151, 0xffff0000, v191
    v_lshlrev_b32 v152, 16, v192
    v_and_b32 v153, 0xffff0000, v192
    v_lshlrev_b32 v154, 16, v193
    v_and_b32 v155, 0xffff0000, v193
    v_lshlrev_b32 v156, 16, v194
    v_and_b32 v157, 0xffff0000, v194
    v_lshlrev_b32 v158, 16, v195
    v_and_b32 v159, 0xffff0000, v195
    v_pk_add_f32 v[8:9], v[8:9], v[136:137]
    v_pk_add_f32 v[144:145], v[144:145], v[152:153]
    v_pk_add_f32 v[10:11], v[10:11], v[138:139]
    v_pk_add_f32 v[146:147], v[146:147], v[154:155]
    v_pk_add_f32 v[12:13], v[12:13], v[140:141]
    v_pk_add_f32 v[148:149], v[148:149], v[156:157]
    v_pk_add_f32 v[14:15], v[14:15], v[142:143]
    v_pk_add_f32 v[150:151], v[150:151], v[158:159]
    v_pk_add_f32 v[8:9], v[8:9], v[144:145]
    v_pk_add_f32 v[10:11], v[10:11], v[146:147]
    v_pk_add_f32 v[12:13], v[12:13], v[148:149]
    v_pk_add_f32 v[14:15], v[14:15], v[150:151]
    v_pk_fma_f32 v[8:9], v[8:9], v[76:77], v[160:161]
    v_pk_fma_f32 v[10:11], v[10:11], v[78:79], v[162:163]
    v_pk_fma_f32 v[12:13], v[12:13], v[84:85], v[164:165]
    v_pk_fma_f32 v[14:15], v[14:15], v[86:87], v[166:167]
    v_cvt_pk_bf16_f32 v44, v8, v9
    v_cvt_pk_bf16_f32 v45, v10, v11
    v_cvt_pk_bf16_f32 v46, v12, v13
    v_cvt_pk_bf16_f32 v47, v14, v15
    s_nop 0
    v_permlane16_swap_b32 v44, v46
    v_permlane16_swap_b32 v45, v47
    buffer_store_dwordx4 v[44:47], v246, s[40:43], 0 offen offset:0
    s_waitcnt vmcnt(3)
    v_lshlrev_b32 v160, 16, v52
    v_and_b32 v161, 0xffff0000, v52
    v_lshlrev_b32 v162, 16, v53
    v_and_b32 v163, 0xffff0000, v53
    v_lshlrev_b32 v164, 16, v54
    v_and_b32 v165, 0xffff0000, v54
    v_lshlrev_b32 v166, 16, v55
    v_and_b32 v167, 0xffff0000, v55
    v_lshlrev_b32 v136, 16, v196
    v_and_b32 v137, 0xffff0000, v196
    v_lshlrev_b32 v138, 16, v197
    v_and_b32 v139, 0xffff0000, v197
    v_lshlrev_b32 v140, 16, v198
    v_and_b32 v141, 0xffff0000, v198
    v_lshlrev_b32 v142, 16, v199
    v_and_b32 v143, 0xffff0000, v199
    v_lshlrev_b32 v144, 16, v200
    v_and_b32 v145, 0xffff0000, v200
    v_lshlrev_b32 v146, 16, v201
    v_and_b32 v147, 0xffff0000, v201
    v_lshlrev_b32 v148, 16, v202
    v_and_b32 v149, 0xffff0000, v202
    v_lshlrev_b32 v150, 16, v203
    v_and_b32 v151, 0xffff0000, v203
    v_lshlrev_b32 v152, 16, v204
    v_and_b32 v153, 0xffff0000, v204
    v_lshlrev_b32 v154, 16, v205
    v_and_b32 v155, 0xffff0000, v205
    v_lshlrev_b32 v156, 16, v206
    v_and_b32 v157, 0xffff0000, v206
    v_lshlrev_b32 v158, 16, v207
    v_and_b32 v159, 0xffff0000, v207
    v_pk_add_f32 v[16:17], v[16:17], v[136:137]
    v_pk_add_f32 v[144:145], v[144:145], v[152:153]
    v_pk_add_f32 v[18:19], v[18:19], v[138:139]
    v_pk_add_f32 v[146:147], v[146:147], v[154:155]
    v_pk_add_f32 v[20:21], v[20:21], v[140:141]
    v_pk_add_f32 v[148:149], v[148:149], v[156:157]
    v_pk_add_f32 v[22:23], v[22:23], v[142:143]
    v_pk_add_f32 v[150:151], v[150:151], v[158:159]
    v_pk_add_f32 v[16:17], v[16:17], v[144:145]
    v_pk_add_f32 v[18:19], v[18:19], v[146:147]
    v_pk_add_f32 v[20:21], v[20:21], v[148:149]
    v_pk_add_f32 v[22:23], v[22:23], v[150:151]
    v_pk_fma_f32 v[16:17], v[16:17], v[92:93], v[160:161]
    v_pk_fma_f32 v[18:19], v[18:19], v[94:95], v[162:163]
    v_pk_fma_f32 v[20:21], v[20:21], v[100:101], v[164:165]
    v_pk_fma_f32 v[22:23], v[22:23], v[102:103], v[166:167]
    v_cvt_pk_bf16_f32 v52, v16, v17
    v_cvt_pk_bf16_f32 v53, v18, v19
    v_cvt_pk_bf16_f32 v54, v20, v21
    v_cvt_pk_bf16_f32 v55, v22, v23
    s_nop 0
    v_permlane16_swap_b32 v52, v54
    v_permlane16_swap_b32 v53, v55
    buffer_store_dwordx4 v[52:55], v246, s[40:43], 0 offen offset:64
    s_waitcnt vmcnt(3)
    v_lshlrev_b32 v160, 16, v60
    v_and_b32 v161, 0xffff0000, v60
    v_lshlrev_b32 v162, 16, v61
    v_and_b32 v163, 0xffff0000, v61
    v_lshlrev_b32 v164, 16, v62
    v_and_b32 v165, 0xffff0000, v62
    v_lshlrev_b32 v166, 16, v63
    v_and_b32 v167, 0xffff0000, v63
    v_lshlrev_b32 v136, 16, v208
    v_and_b32 v137, 0xffff0000, v208
    v_lshlrev_b32 v138, 16, v209
    v_and_b32 v139, 0xffff0000, v209
    v_lshlrev_b32 v140, 16, v210
    v_and_b32 v141, 0xffff0000, v210
    v_lshlrev_b32 v142, 16, v211
    v_and_b32 v143, 0xffff0000, v211
    v_lshlrev_b32 v144, 16, v212
    v_and_b32 v145, 0xffff0000, v212
    v_lshlrev_b32 v146, 16, v213
    v_and_b32 v147, 0xffff0000, v213
    v_lshlrev_b32 v148, 16, v214
    v_and_b32 v149, 0xffff0000, v214
    v_lshlrev_b32 v150, 16, v215
    v_and_b32 v151, 0xffff0000, v215
    v_lshlrev_b32 v152, 16, v216
    v_and_b32 v153, 0xffff0000, v216
    v_lshlrev_b32 v154, 16, v217
    v_and_b32 v155, 0xffff0000, v217
    v_lshlrev_b32 v156, 16, v218
    v_and_b32 v157, 0xffff0000, v218
    v_lshlrev_b32 v158, 16, v219
    v_and_b32 v159, 0xffff0000, v219
    v_pk_add_f32 v[24:25], v[24:25], v[136:137]
    v_pk_add_f32 v[144:145], v[144:145], v[152:153]
    v_pk_add_f32 v[26:27], v[26:27], v[138:139]
    v_pk_add_f32 v[146:147], v[146:147], v[154:155]
    v_pk_add_f32 v[28:29], v[28:29], v[140:141]
    v_pk_add_f32 v[148:149], v[148:149], v[156:157]
    v_pk_add_f32 v[30:31], v[30:31], v[142:143]
    v_pk_add_f32 v[150:151], v[150:151], v[158:159]
    v_pk_add_f32 v[24:25], v[24:25], v[144:145]
    v_pk_add_f32 v[26:27], v[26:27], v[146:147]
    v_pk_add_f32 v[28:29], v[28:29], v[148:149]
    v_pk_add_f32 v[30:31], v[30:31], v[150:151]
    v_pk_fma_f32 v[24:25], v[24:25], v[108:109], v[160:161]
    v_pk_fma_f32 v[26:27], v[26:27], v[110:111], v[162:163]
    v_pk_fma_f32 v[28:29], v[28:29], v[116:117], v[164:165]
    v_pk_fma_f32 v[30:31], v[30:31], v[118:119], v[166:167]
    v_cvt_pk_bf16_f32 v60, v24, v25
    v_cvt_pk_bf16_f32 v61, v26, v27
    v_cvt_pk_bf16_f32 v62, v28, v29
    v_cvt_pk_bf16_f32 v63, v30, v31
    s_nop 0
    v_permlane16_swap_b32 v60, v62
    v_permlane16_swap_b32 v61, v63
    buffer_store_dwordx4 v[60:63], v246, s[40:43], 0 offen offset:256
    s_waitcnt vmcnt(3)
    v_lshlrev_b32 v160, 16, v68
    v_and_b32 v161, 0xffff0000, v68
    v_lshlrev_b32 v162, 16, v69
    v_and_b32 v163, 0xffff0000, v69
    v_lshlrev_b32 v164, 16, v70
    v_and_b32 v165, 0xffff0000, v70
    v_lshlrev_b32 v166, 16, v71
    v_and_b32 v167, 0xffff0000, v71
    v_lshlrev_b32 v136, 16, v220
    v_and_b32 v137, 0xffff0000, v220
    v_lshlrev_b32 v138, 16, v221
    v_and_b32 v139, 0xffff0000, v221
    v_lshlrev_b32 v140, 16, v222
    v_and_b32 v141, 0xffff0000, v222
    v_lshlrev_b32 v142, 16, v223
    v_and_b32 v143, 0xffff0000, v223
    v_lshlrev_b32 v144, 16, v224
    v_and_b32 v145, 0xffff0000, v224
    v_lshlrev_b32 v146, 16, v225
    v_and_b32 v147, 0xffff0000, v225
    v_lshlrev_b32 v148, 16, v226
    v_and_b32 v149, 0xffff0000, v226
    v_lshlrev_b32 v150, 16, v227
    v_and_b32 v151, 0xffff0000, v227
    v_lshlrev_b32 v152, 16, v228
    v_and_b32 v153, 0xffff0000, v228
    v_lshlrev_b32 v154, 16, v229
    v_and_b32 v155, 0xffff0000, v229
    v_lshlrev_b32 v156, 16, v230
    v_and_b32 v157, 0xffff0000, v230
    v_lshlrev_b32 v158, 16, v231
    v_and_b32 v159, 0xffff0000, v231
    v_pk_add_f32 v[32:33], v[32:33], v[136:137]
    v_pk_add_f32 v[144:145], v[144:145], v[152:153]
    v_pk_add_f32 v[34:35], v[34:35], v[138:139]
    v_pk_add_f32 v[146:147], v[146:147], v[154:155]
    v_pk_add_f32 v[36:37], v[36:37], v[140:141]
    v_pk_add_f32 v[148:149], v[148:149], v[156:157]
    v_pk_add_f32 v[38:39], v[38:39], v[142:143]
    v_pk_add_f32 v[150:151], v[150:151], v[158:159]
    v_pk_add_f32 v[32:33], v[32:33], v[144:145]
    v_pk_add_f32 v[34:35], v[34:35], v[146:147]
    v_pk_add_f32 v[36:37], v[36:37], v[148:149]
    v_pk_add_f32 v[38:39], v[38:39], v[150:151]
    v_pk_fma_f32 v[32:33], v[32:33], v[124:125], v[160:161]
    v_pk_fma_f32 v[34:35], v[34:35], v[126:127], v[162:163]
    v_pk_fma_f32 v[36:37], v[36:37], v[132:133], v[164:165]
    v_pk_fma_f32 v[38:39], v[38:39], v[134:135], v[166:167]
    v_cvt_pk_bf16_f32 v68, v32, v33
    v_cvt_pk_bf16_f32 v69, v34, v35
    v_cvt_pk_bf16_f32 v70, v36, v37
    v_cvt_pk_bf16_f32 v71, v38, v39
    s_nop 0
    v_permlane16_swap_b32 v68, v70
    v_permlane16_swap_b32 v69, v71
    buffer_store_dwordx4 v[68:71], v246, s[40:43], 0 offen offset:320
    s_branch M_fin
M_Pidle:
    s_nop 7
    s_barrier
    s_lshl_b32 s70, s48, 12
    s_lshl_b32 s64, s47, 3
    s_lshl_b32 s65, s45, 2
    s_add_u32 s64, s64, s65
    s_mul_i32 s64, s64, 114688
    s_add_u32 s64, s64, s70
    s_lshl_b32 s65, s46, 11
    s_add_u32 s64, s64, s65
    s_add_u32 s64, s64, 0x1500000
    v_lshl_add_u32 v198, v1, 4, s64
    v_mul_f32 v24, v8, v24
    v_exp_f32 v216, -v8
    v_mul_f32 v25, v9, v25
    v_exp_f32 v217, -v9
    v_mul_f32 v26, v10, v26
    v_exp_f32 v218, -v10
    v_mul_f32 v27, v11, v27
    v_exp_f32 v219, -v11
    v_mul_f32 v28, v12, v28
    v_exp_f32 v220, -v12
    v_mul_f32 v29, v13, v29
    v_exp_f32 v221, -v13
    v_mul_f32 v30, v14, v30
    v_exp_f32 v222, -v14
    v_mul_f32 v31, v15, v31
    v_exp_f32 v223, -v15
    v_fma_f32 v216, v216, s67, s67
    v_fma_f32 v217, v217, s67, s67
    v_rcp_f32 v216, v216
    v_fma_f32 v218, v218, s67, s67
    v_rcp_f32 v217, v217
    v_fma_f32 v219, v219, s67, s67
    v_rcp_f32 v218, v218
    v_fma_f32 v220, v220, s67, s67
    v_rcp_f32 v219, v219
    v_fma_f32 v221, v221, s67, s67
    v_rcp_f32 v220, v220
    v_fma_f32 v222, v222, s67, s67
    v_rcp_f32 v221, v221
    v_fma_f32 v223, v223, s67, s67
    v_rcp_f32 v222, v222
    v_rcp_f32 v223, v223
    v_mul_f32 v24, v24, v216
    v_mul_f32 v25, v25, v217
    v_mul_f32 v26, v26, v218
    v_mul_f32 v27, v27, v219
    v_mul_f32 v28, v28, v220
    v_mul_f32 v29, v29, v221
    v_mul_f32 v30, v30, v222
    v_mul_f32 v31, v31, v223
    v_cvt_pk_bf16_f32 v200, v24, v25
    v_cvt_pk_bf16_f32 v201, v26, v27
    v_cvt_pk_bf16_f32 v202, v28, v29
    v_cvt_pk_bf16_f32 v203, v30, v31
    buffer_store_dwordx4 v[200:203], v198, s[28:31], 0 offen offset:0 sc1
    v_mul_f32 v32, v16, v32
    v_exp_f32 v224, -v16
    v_mul_f32 v33, v17, v33
    v_exp_f32 v225, -v17
    v_mul_f32 v34, v18, v34
    v_exp_f32 v226, -v18
    v_mul_f32 v35, v19, v35
    v_exp_f32 v227, -v19
    v_mul_f32 v36, v20, v36
    v_exp_f32 v228, -v20
    v_mul_f32 v37, v21, v37
    v_exp_f32 v229, -v21
    v_mul_f32 v38, v22, v38
    v_exp_f32 v230, -v22
    v_mul_f32 v39, v23, v39
    v_exp_f32 v231, -v23
    v_fma_f32 v224, v224, s67, s67
    v_fma_f32 v225, v225, s67, s67
    v_rcp_f32 v224, v224
    v_fma_f32 v226, v226, s67, s67
    v_rcp_f32 v225, v225
    v_fma_f32 v227, v227, s67, s67
    v_rcp_f32 v226, v226
    v_fma_f32 v228, v228, s67, s67
    v_rcp_f32 v227, v227
    v_fma_f32 v229, v229, s67, s67
    v_rcp_f32 v228, v228
    v_fma_f32 v230, v230, s67, s67
    v_rcp_f32 v229, v229
    v_fma_f32 v231, v231, s67, s67
    v_rcp_f32 v230, v230
    v_rcp_f32 v231, v231
    v_mul_f32 v32, v32, v224
    v_mul_f32 v33, v33, v225
    v_mul_f32 v34, v34, v226
    v_mul_f32 v35, v35, v227
    v_mul_f32 v36, v36, v228
    v_mul_f32 v37, v37, v229
    v_mul_f32 v38, v38, v230
    v_mul_f32 v39, v39, v231
    v_cvt_pk_bf16_f32 v204, v32, v33
    v_cvt_pk_bf16_f32 v205, v34, v35
    v_cvt_pk_bf16_f32 v206, v36, v37
    v_cvt_pk_bf16_f32 v207, v38, v39
    buffer_store_dwordx4 v[204:207], v198, s[28:31], 0 offen offset:1024 sc1
    v_add_u32 v198, 114688, v198
    v_mul_f32 v56, v40, v56
    v_exp_f32 v216, -v40
    v_mul_f32 v57, v41, v57
    v_exp_f32 v217, -v41
    v_mul_f32 v58, v42, v58
    v_exp_f32 v218, -v42
    v_mul_f32 v59, v43, v59
    v_exp_f32 v219, -v43
    v_mul_f32 v60, v44, v60
    v_exp_f32 v220, -v44
    v_mul_f32 v61, v45, v61
    v_exp_f32 v221, -v45
    v_mul_f32 v62, v46, v62
    v_exp_f32 v222, -v46
    v_mul_f32 v63, v47, v63
    v_exp_f32 v223, -v47
    v_fma_f32 v216, v216, s67, s67
    v_fma_f32 v217, v217, s67, s67
    v_rcp_f32 v216, v216
    v_fma_f32 v218, v218, s67, s67
    v_rcp_f32 v217, v217
    v_fma_f32 v219, v219, s67, s67
    v_rcp_f32 v218, v218
    v_fma_f32 v220, v220, s67, s67
    v_rcp_f32 v219, v219
    v_fma_f32 v221, v221, s67, s67
    v_rcp_f32 v220, v220
    v_fma_f32 v222, v222, s67, s67
    v_rcp_f32 v221, v221
    v_fma_f32 v223, v223, s67, s67
    v_rcp_f32 v222, v222
    v_rcp_f32 v223, v223
    v_mul_f32 v56, v56, v216
    v_mul_f32 v57, v57, v217
    v_mul_f32 v58, v58, v218
    v_mul_f32 v59, v59, v219
    v_mul_f32 v60, v60, v220
    v_mul_f32 v61, v61, v221
    v_mul_f32 v62, v62, v222
    v_mul_f32 v63, v63, v223
    v_cvt_pk_bf16_f32 v208, v56, v57
    v_cvt_pk_bf16_f32 v209, v58, v59
    v_cvt_pk_bf16_f32 v210, v60, v61
    v_cvt_pk_bf16_f32 v211, v62, v63
    buffer_store_dwordx4 v[208:211], v198, s[28:31], 0 offen offset:0 sc1
    v_mul_f32 v64, v48, v64
    v_exp_f32 v224, -v48
    v_mul_f32 v65, v49, v65
    v_exp_f32 v225, -v49
    v_mul_f32 v66, v50, v66
    v_exp_f32 v226, -v50
    v_mul_f32 v67, v51, v67
    v_exp_f32 v227, -v51
    v_mul_f32 v68, v52, v68
    v_exp_f32 v228, -v52
    v_mul_f32 v69, v53, v69
    v_exp_f32 v229, -v53
    v_mul_f32 v70, v54, v70
    v_exp_f32 v230, -v54
    v_mul_f32 v71, v55, v71
    v_exp_f32 v231, -v55
    v_fma_f32 v224, v224, s67, s67
    v_fma_f32 v225, v225, s67, s67
    v_rcp_f32 v224, v224
    v_fma_f32 v226, v226, s67, s67
    v_rcp_f32 v225, v225
    v_fma_f32 v227, v227, s67, s67
    v_rcp_f32 v226, v226
    v_fma_f32 v228, v228, s67, s67
    v_rcp_f32 v227, v227
    v_fma_f32 v229, v229, s67, s67
    v_rcp_f32 v228, v228
    v_fma_f32 v230, v230, s67, s67
    v_rcp_f32 v229, v229
    v_fma_f32 v231, v231, s67, s67
    v_rcp_f32 v230, v230
    v_rcp_f32 v231, v231
    v_mul_f32 v64, v64, v224
    v_mul_f32 v65, v65, v225
    v_mul_f32 v66, v66, v226
    v_mul_f32 v67, v67, v227
    v_mul_f32 v68, v68, v228
    v_mul_f32 v69, v69, v229
    v_mul_f32 v70, v70, v230
    v_mul_f32 v71, v71, v231
    v_cvt_pk_bf16_f32 v212, v64, v65
    v_cvt_pk_bf16_f32 v213, v66, v67
    v_cvt_pk_bf16_f32 v214, v68, v69
    v_cvt_pk_bf16_f32 v215, v70, v71
    buffer_store_dwordx4 v[212:215], v198, s[28:31], 0 offen offset:1024 sc1
    v_add_u32 v198, 114688, v198
    v_mul_f32 v88, v72, v88
    v_exp_f32 v216, -v72
    v_mul_f32 v89, v73, v89
    v_exp_f32 v217, -v73
    v_mul_f32 v90, v74, v90
    v_exp_f32 v218, -v74
    v_mul_f32 v91, v75, v91
    v_exp_f32 v219, -v75
    v_mul_f32 v92, v76, v92
    v_exp_f32 v220, -v76
    v_mul_f32 v93, v77, v93
    v_exp_f32 v221, -v77
    v_mul_f32 v94, v78, v94
    v_exp_f32 v222, -v78
    v_mul_f32 v95, v79, v95
    v_exp_f32 v223, -v79
    v_fma_f32 v216, v216, s67, s67
    v_fma_f32 v217, v217, s67, s67
    v_rcp_f32 v216, v216
    v_fma_f32 v218, v218, s67, s67
    v_rcp_f32 v217, v217
    v_fma_f32 v219, v219, s67, s67
    v_rcp_f32 v218, v218
    v_fma_f32 v220, v220, s67, s67
    v_rcp_f32 v219, v219
    v_fma_f32 v221, v221, s67, s67
    v_rcp_f32 v220, v220
    v_fma_f32 v222, v222, s67, s67
    v_rcp_f32 v221, v221
    v_fma_f32 v223, v223, s67, s67
    v_rcp_f32 v222, v222
    v_rcp_f32 v223, v223
    v_mul_f32 v88, v88, v216
    v_mul_f32 v89, v89, v217
    v_mul_f32 v90, v90, v218
    v_mul_f32 v91, v91, v219
    v_mul_f32 v92, v92, v220
    v_mul_f32 v93, v93, v221
    v_mul_f32 v94, v94, v222
    v_mul_f32 v95, v95, v223
    v_cvt_pk_bf16_f32 v200, v88, v89
    v_cvt_pk_bf16_f32 v201, v90, v91
    v_cvt_pk_bf16_f32 v202, v92, v93
    v_cvt_pk_bf16_f32 v203, v94, v95
    buffer_store_dwordx4 v[200:203], v198, s[28:31], 0 offen offset:0 sc1
    v_mul_f32 v96, v80, v96
    v_exp_f32 v224, -v80
    v_mul_f32 v97, v81, v97
    v_exp_f32 v225, -v81
    v_mul_f32 v98, v82, v98
    v_exp_f32 v226, -v82
    v_mul_f32 v99, v83, v99
    v_exp_f32 v227, -v83
    v_mul_f32 v100, v84, v100
    v_exp_f32 v228, -v84
    v_mul_f32 v101, v85, v101
    v_exp_f32 v229, -v85
    v_mul_f32 v102, v86, v102
    v_exp_f32 v230, -v86
    v_mul_f32 v103, v87, v103
    v_exp_f32 v231, -v87
    v_fma_f32 v224, v224, s67, s67
    v_fma_f32 v225, v225, s67, s67
    v_rcp_f32 v224, v224
    v_fma_f32 v226, v226, s67, s67
    v_rcp_f32 v225, v225
    v_fma_f32 v227, v227, s67, s67
    v_rcp_f32 v226, v226
    v_fma_f32 v228, v228, s67, s67
    v_rcp_f32 v227, v227
    v_fma_f32 v229, v229, s67, s67
    v_rcp_f32 v228, v228
    v_fma_f32 v230, v230, s67, s67
    v_rcp_f32 v229, v229
    v_fma_f32 v231, v231, s67, s67
    v_rcp_f32 v230, v230
    v_rcp_f32 v231, v231
    v_mul_f32 v96, v96, v224
    v_mul_f32 v97, v97, v225
    v_mul_f32 v98, v98, v226
    v_mul_f32 v99, v99, v227
    v_mul_f32 v100, v100, v228
    v_mul_f32 v101, v101, v229
    v_mul_f32 v102, v102, v230
    v_mul_f32 v103, v103, v231
    v_cvt_pk_bf16_f32 v204, v96, v97
    v_cvt_pk_bf16_f32 v205, v98, v99
    v_cvt_pk_bf16_f32 v206, v100, v101
    v_cvt_pk_bf16_f32 v207, v102, v103
    buffer_store_dwordx4 v[204:207], v198, s[28:31], 0 offen offset:1024 sc1
    v_add_u32 v198, 114688, v198
    v_mul_f32 v120, v104, v120
    v_exp_f32 v216, -v104
    v_mul_f32 v121, v105, v121
    v_exp_f32 v217, -v105
    v_mul_f32 v122, v106, v122
    v_exp_f32 v218, -v106
    v_mul_f32 v123, v107, v123
    v_exp_f32 v219, -v107
    v_mul_f32 v124, v108, v124
    v_exp_f32 v220, -v108
    v_mul_f32 v125, v109, v125
    v_exp_f32 v221, -v109
    v_mul_f32 v126, v110, v126
    v_exp_f32 v222, -v110
    v_mul_f32 v127, v111, v127
    v_exp_f32 v223, -v111
    v_fma_f32 v216, v216, s67, s67
    v_fma_f32 v217, v217, s67, s67
    v_rcp_f32 v216, v216
    v_fma_f32 v218, v218, s67, s67
    v_rcp_f32 v217, v217
    v_fma_f32 v219, v219, s67, s67
    v_rcp_f32 v218, v218
    v_fma_f32 v220, v220, s67, s67
    v_rcp_f32 v219, v219
    v_fma_f32 v221, v221, s67, s67
    v_rcp_f32 v220, v220
    v_fma_f32 v222, v222, s67, s67
    v_rcp_f32 v221, v221
    v_fma_f32 v223, v223, s67, s67
    v_rcp_f32 v222, v222
    v_rcp_f32 v223, v223
    v_mul_f32 v120, v120, v216
    v_mul_f32 v121, v121, v217
    v_mul_f32 v122, v122, v218
    v_mul_f32 v123, v123, v219
    v_mul_f32 v124, v124, v220
    v_mul_f32 v125, v125, v221
    v_mul_f32 v126, v126, v222
    v_mul_f32 v127, v127, v223
    v_cvt_pk_bf16_f32 v208, v120, v121
    v_cvt_pk_bf16_f32 v209, v122, v123
    v_cvt_pk_bf16_f32 v210, v124, v125
    v_cvt_pk_bf16_f32 v211, v126, v127
    buffer_store_dwordx4 v[208:211], v198, s[28:31], 0 offen offset:0 sc1
    v_mul_f32 v128, v112, v128
    v_exp_f32 v224, -v112
    v_mul_f32 v129, v113, v129
    v_exp_f32 v225, -v113
    v_mul_f32 v130, v114, v130
    v_exp_f32 v226, -v114
    v_mul_f32 v131, v115, v131
    v_exp_f32 v227, -v115
    v_mul_f32 v132, v116, v132
    v_exp_f32 v228, -v116
    v_mul_f32 v133, v117, v133
    v_exp_f32 v229, -v117
    v_mul_f32 v134, v118, v134
    v_exp_f32 v230, -v118
    v_mul_f32 v135, v119, v135
    v_exp_f32 v231, -v119
    v_fma_f32 v224, v224, s67, s67
    v_fma_f32 v225, v225, s67, s67
    v_rcp_f32 v224, v224
    v_fma_f32 v226, v226, s67, s67
    v_rcp_f32 v225, v225
    v_fma_f32 v227, v227, s67, s67
    v_rcp_f32 v226, v226
    v_fma_f32 v228, v228, s67, s67
    v_rcp_f32 v227, v227
    v_fma_f32 v229, v229, s67, s67
    v_rcp_f32 v228, v228
    v_fma_f32 v230, v230, s67, s67
    v_rcp_f32 v229, v229
    v_fma_f32 v231, v231, s67, s67
    v_rcp_f32 v230, v230
    v_rcp_f32 v231, v231
    v_mul_f32 v128, v128, v224
    v_mul_f32 v129, v129, v225
    v_mul_f32 v130, v130, v226
    v_mul_f32 v131, v131, v227
    v_mul_f32 v132, v132, v228
    v_mul_f32 v133, v133, v229
    v_mul_f32 v134, v134, v230
    v_mul_f32 v135, v135, v231
    v_cvt_pk_bf16_f32 v212, v128, v129
    v_cvt_pk_bf16_f32 v213, v130, v131
    v_cvt_pk_bf16_f32 v214, v132, v133
    v_cvt_pk_bf16_f32 v215, v134, v135
    buffer_store_dwordx4 v[212:215], v198, s[28:31], 0 offen offset:1024 sc1
    s_lshl_b32 s65, s44, 1
    s_xor_b32 s65, s65, s49
    s_lshl_b32 s64, s47, 3
    s_add_u32 s64, s64, s65
    s_mul_i32 s64, s64, 114688
    s_add_u32 s64, s64, 0x1500000
    v_lshl_add_u32 v192, v1, 4, s64
    s_lshl_b32 s65, s44, 1
    s_or_b32 s65, s65, 1
    s_xor_b32 s65, s65, s49
    s_lshl_b32 s64, s47, 3
    s_add_u32 s64, s64, s65
    s_mul_i32 s64, s64, 114688
    s_add_u32 s64, s64, 0x14ff800
    v_lshl_add_u32 v193, v1, 4, s64
    s_lshl_b32 s65, s51, 9
    v_lshrrev_b32 v3, 4, v1
    s_lshl_b32 s64, s44, 4
    v_add_u32 v2, s64, v3
    s_movk_i32 s64, 2048
    v_mul_u32_u24 v2, s64, v2
    v_add_u32 v2, s65, v2
    v_lshlrev_b32 v3, 1, v3
    v_and_b32 v4, 15, v1
    v_xor_b32 v3, v3, v4
    v_lshl_add_u32 v194, v3, 4, v2
    v_add_u32 v196, 14336, v194
    v_xor_b32 v3, 8, v3
    v_lshl_add_u32 v195, v3, 4, v2
    v_add_u32 v195, 7168, v195
    v_add_u32 v197, 14336, v195
    s_lshl_b32 s64, s47, 9
    s_lshl_b32 s65, s49, 7
    s_add_u32 s64, s64, s65
    s_lshl_b32 s65, s51, 4
    s_add_u32 s64, s64, s65
    s_lshl_b32 s65, s44, 2
    s_add_u32 s64, s64, s65
    s_add_u32 s64, s64, 0x50000
    v_mov_b32 v2, s0
    s_waitcnt vmcnt(0)
    s_mov_b64 exec, 1
    buffer_store_dword v2, v234, s[28:31], s64 offen sc1
    s_mov_b64 exec, -1
    s_barrier
    s_lshl_b32 s68, s47, 2
    s_add_u32 s68, s68, s49
    s_lshl_b32 s68, s68, 7
    s_add_u32 s68, s68, 0x50000
    v_min_u32 v234, 60, v234
    buffer_load_dword v245, v234, s[28:31], s68 offen sc1
    s_waitcnt vmcnt(0)
    s_branch M_Pjoin
M_Q:
    s_setprio 0
    s_sub_u32 s44, s44, 4
    s_lshl_b32 s62, s47, 4
    s_add_u32 s62, s62, s48
    s_lshl_b32 s62, s62, 2
    s_add_u32 s62, s62, s44
    s_lshl_b32 s64, s62, 12
    v_lshl_add_u32 v2, v1, 4, s64
    s_waitcnt lgkmcnt(0)
    s_load_dword s0, s[26:27], 0
    s_mov_b32 s40, s4
    s_mov_b32 s41, s5
    s_mov_b32 s42, 0x400000
    s_mov_b32 s43, 0x20000
    buffer_load_dwordx4 v[104:107], v2, s[40:43], 0 offen offset:0
    buffer_load_dwordx4 v[108:111], v2, s[40:43], 0 offen offset:1024
    buffer_load_dwordx4 v[112:115], v2, s[40:43], 0 offen offset:2048
    buffer_load_dwordx4 v[116:119], v2, s[40:43], 0 offen offset:3072
    s_barrier
    s_or_b32 s65, s48, s44
    s_cmp_lg_u32 s65, 0
    s_cbranch_scc1 M_noclr
    s_lshl_b32 s64, s47, 9
    s_add_u32 s64, s64, 0x54000
    s_add_u32 s56, s26, s64
    s_addc_u32 s57, s27, 0
    s_mov_b32 s84, 0
    s_mov_b32 s85, 0
    s_mov_b32 s86, 0
    s_mov_b32 s87, 0
    s_mov_b32 s88, 0
    s_mov_b32 s89, 0
    s_mov_b32 s90, 0
    s_mov_b32 s91, 0
    s_mov_b32 s92, 0
    s_mov_b32 s93, 0
    s_mov_b32 s94, 0
    s_mov_b32 s95, 0
    s_atomic_swap s84, s[56:57], 0 glc
    s_atomic_swap s85, s[56:57], 128 glc
    s_atomic_swap s86, s[56:57], 256 glc
    s_atomic_swap s87, s[56:57], 384 glc
    s_atomic_swap s88, s[56:57], 8192 glc
    s_atomic_swap s89, s[56:57], 8320 glc
    s_atomic_swap s90, s[56:57], 8448 glc
    s_atomic_swap s91, s[56:57], 8576 glc
    s_atomic_swap s92, s[56:57], 16384 glc
    s_atomic_swap s93, s[56:57], 16512 glc
    s_atomic_swap s94, s[56:57], 16640 glc
    s_atomic_swap s95, s[56:57], 16768 glc
M_noclr:
    v_and_b32 v2, 7, v1
    s_lshl_b32 s64, s44, 3
    v_add_u32 v2, s64, v2
    v_lshrrev_b32 v3, 3, v1
    v_lshlrev_b32 v14, 5, v3
    v_add_u32 v14, 149504, v14
    s_lshl_b32 s64, s48, 7
    v_lshl_add_u32 v4, v3, 4, s64
    s_lshl_b32 s70, s47, 7
    v_add_u32 v12, s70, v2
    v_lshl_add_u32 v8, v12, 11, v4
    s_max_u32 s70, s70, 16
    s_sub_u32 s70, s70, 16
    v_and_b32 v5, 15, v2
    v_add_u32 v13, s70, v5
    v_lshl_add_u32 v9, v13, 11, v4
    v_and_b32 v4, 7, v2
    v_lshlrev_b32 v4, 3, v4
    v_add_u32 v4, 0x10000, v4
    v_lshrrev_b32 v12, 3, v12
    v_lshl_add_u32 v12, v12, 7, v4
    v_lshrrev_b32 v13, 3, v13
    v_lshl_add_u32 v13, v13, 7, v4
    v_lshlrev_b32 v3, 8, v3
    v_lshl_add_u32 v3, v5, 4, v3
    s_mul_i32 s64, s47, 294912
    s_lshl_b32 s65, s48, 11
    s_add_u32 s64, s64, s65
    s_add_u32 s64, s64, 0x100000
    s_cmp_ge_u32 s44, 2
    s_cselect_b32 s65, 0x80000000, s64
    v_add_u32 v11, s65, v3
    s_cselect_b32 s65, 32768, 0
    s_add_u32 s64, s64, s65
    s_add_u32 s64, s64, 32768
    v_add_u32 v10, s64, v3
    v_mov_b32 v19, v3
    s_lshr_b32 s64, s44, 1
    s_lshl_b32 s64, s64, 11
    s_add_u32 s64, s64, 2048
    v_add_u32 v15, s64, v3
    s_mov_b32 s53, 0
    s_lshl_b32 s72, s44, 12
    s_add_u32 s72, s72, 2048
    s_lshl_b32 s73, s44, 9
    s_mul_i32 s74, s44, 6144
    s_add_u32 s74, s74, 18432
    s_add_u32 s75, s74, 4096
    s_bfe_u32 s66, s2, 0x30003
    s_lshr_b32 s55, s2, 6
    s_add_u32 s66, s66, s55
    s_and_b32 s66, s66, 3
    s_mov_b32 s58, 0x76453210
    s_mov_b32 s59, 0xfecdba89
    s_cmp_eq_u32 s66, 1
    s_cselect_b32 s58, 0x75643120, s58
    s_cselect_b32 s59, 0xfdecb9a8, s59
    s_cmp_eq_u32 s66, 2
    s_cselect_b32 s58, 0x67542310, s58
    s_cselect_b32 s59, 0xefdcab98, s59
    s_cmp_eq_u32 s66, 3
    s_cselect_b32 s58, 0x86534210, s58
    s_cselect_b32 s59, 0xfedbca97, s59
    s_and_b32 s66, s48, 15
    s_lshl_b32 s55, s66, 2
    s_lshr_b64 s[56:57], s[58:59], s55
    s_and_b32 s55, s56, 15
    s_lshl_b32 s55, s55, 2
    s_lshl_b64 s[56:57], 15, s55
    s_andn2_b64 s[58:59], s[58:59], s[56:57]
    s_or_b32 s58, s58, s66
    s_lshl_b32 s65, s48, 7
    s_mul_i32 s64, s44, 98304
    s_add_u32 s65, s65, s64
    s_movk_i32 s64, 6144
    v_add_u32 v2, 0, v1
    v_mul_u32_u24 v3, 0xab, v2
    v_lshrrev_b32 v3, 12, v3
    v_mul_u32_u24 v4, 24, v3
    v_sub_u32 v2, v2, v4
    v_and_b32 v4, 2, v3
    v_lshrrev_b32 v5, 3, v3
    v_lshl_or_b32 v4, v5, 2, v4
    v_xor_b32 v2, v2, v4
    v_mul_u32_u24 v3, s64, v3
    v_lshrrev_b32 v4, 3, v2
    v_lshl_add_u32 v3, v4, 11, v3
    v_and_b32 v2, 7, v2
    v_lshl_add_u32 v3, v2, 4, v3
    v_add_u32 v187, s65, v3
    v_add_u32 v2, 64, v1
    v_mul_u32_u24 v3, 0xab, v2
    v_lshrrev_b32 v3, 12, v3
    v_mul_u32_u24 v4, 24, v3
    v_sub_u32 v2, v2, v4
    v_and_b32 v4, 2, v3
    v_lshrrev_b32 v5, 3, v3
    v_lshl_or_b32 v4, v5, 2, v4
    v_xor_b32 v2, v2, v4
    v_mul_u32_u24 v3, s64, v3
    v_lshrrev_b32 v4, 3, v2
    v_lshl_add_u32 v3, v4, 11, v3
    v_and_b32 v2, 7, v2
    v_lshl_add_u32 v3, v2, 4, v3
    v_subrev_u32 v3, 1024, v3
    v_add_u32 v188, s65, v3
    v_add_u32 v2, 128, v1
    v_mul_u32_u24 v3, 0xab, v2
    v_lshrrev_b32 v3, 12, v3
    v_mul_u32_u24 v4, 24, v3
    v_sub_u32 v2, v2, v4
    v_and_b32 v4, 2, v3
    v_lshrrev_b32 v5, 3, v3
    v_lshl_or_b32 v4, v5, 2, v4
    v_xor_b32 v2, v2, v4
    v_mul_u32_u24 v3, s64, v3
    v_lshrrev_b32 v4, 3, v2
    v_lshl_add_u32 v3, v4, 11, v3
    v_and_b32 v2, 7, v2
    v_lshl_add_u32 v3, v2, 4, v3
    v_subrev_u32 v3, 2048, v3
    v_add_u32 v189, s65, v3
    v_add_u32 v2, 192, v1
    v_mul_u32_u24 v3, 0xab, v2
    v_lshrrev_b32 v3, 12, v3
    v_mul_u32_u24 v4, 24, v3
    v_sub_u32 v2, v2, v4
    v_and_b32 v4, 2, v3
    v_lshrrev_b32 v5, 3, v3
    v_lshl_or_b32 v4, v5, 2, v4
    v_xor_b32 v2, v2, v4
    v_mul_u32_u24 v3, s64, v3
    v_lshrrev_b32 v4, 3, v2
    v_lshl_add_u32 v3, v4, 11, v3
    v_and_b32 v2, 7, v2
    v_lshl_add_u32 v3, v2, 4, v3
    v_subrev_u32 v3, 3072, v3
    v_add_u32 v190, s65, v3
    v_add_u32 v2, 256, v1
    v_mul_u32_u24 v3, 0xab, v2
    v_lshrrev_b32 v3, 12, v3
    v_mul_u32_u24 v4, 24, v3
    v_sub_u32 v2, v2, v4
    v_and_b32 v4, 2, v3
    v_lshrrev_b32 v5, 3, v3
    v_lshl_or_b32 v4, v5, 2, v4
    v_xor_b32 v2, v2, v4
    v_mul_u32_u24 v3, s64, v3
    v_lshrrev_b32 v4, 3, v2
    v_lshl_add_u32 v3, v4, 11, v3
    v_and_b32 v2, 7, v2
    v_lshl_add_u32 v3, v2, 4, v3
    v_add_u32 v191, s65, v3
    v_add_u32 v2, 320, v1
    v_mul_u32_u24 v3, 0xab, v2
    v_lshrrev_b32 v3, 12, v3
    v_mul_u32_u24 v4, 24, v3
    v_sub_u32 v2, v2, v4
    v_and_b32 v4, 2, v3
    v_lshrrev_b32 v5, 3, v3
    v_lshl_or_b32 v4, v5, 2, v4
    v_xor_b32 v2, v2, v4
    v_mul_u32_u24 v3, s64, v3
    v_lshrrev_b32 v4, 3, v2
    v_lshl_add_u32 v3, v4, 11, v3
    v_and_b32 v2, 7, v2
    v_lshl_add_u32 v3, v2, 4, v3
    v_subrev_u32 v3, 1024, v3
    v_add_u32 v192, s65, v3
    s_mul_i32 s64, s47, 294912
    s_add_u32 s64, s64, 0x100000
    s_add_u32 s65, s64, s73
    v_lshl_add_u32 v186, v1, 4, s65
    s_mul_i32 s65, s44, 65536
    s_add_u32 s64, s64, s65
    s_add_u32 s64, s64, 32768
    v_lshl_add_u32 v184, v1, 4, s64
    v_add_u32 v185, 30720, v184
    s_mov_b32 s32, s6
    s_mov_b32 s33, s7
    s_mov_b32 s34, 0x600000
    s_mov_b32 s35, 0x20000
    s_mov_b32 s28, s26
    s_mov_b32 s29, s27
    s_mov_b32 s30, 0x3100000
    s_mov_b32 s31, 0x20000
    s_lshr_b32 s45, s44, 1
    s_and_b32 s46, s44, 1
    s_lshr_b32 s49, s48, 2
    s_and_b32 s51, s48, 3
    s_cmp_ge_u32 s2, 192
    s_cselect_b32 s69, 0x80000000, 0
    s_mov_b32 s67, 0x40053526
    v_lshlrev_b32 v234, 2, v1
    v_lshrrev_b32 v3, 3, v1
    s_lshl_b32 s64, s44, 4
    v_add_lshl_u32 v2, v3, s64, 11
    s_lshl_b32 s64, s48, 7
    v_add_u32 v2, s64, v2
    v_and_b32 v3, 6, v3
    v_and_b32 v4, 7, v1
    v_xor_b32 v3, v3, v4
    v_lshl_add_u32 v193, v3, 4, v2
    v_add_u32 v194, 15360, v193
    s_lshl_b32 s64, s47, 3
    s_lshl_b32 s65, s44, 1
    s_add_u32 s64, s64, s65
    s_mul_i32 s64, s64, 32768
    s_add_u32 s64, s64, 0x1000000
    v_lshl_add_u32 v206, v1, 4, s64
    v_add_u32 v207, 30720, v206
    s_lshl_b32 s65, s48, 8
    v_lshrrev_b32 v3, 4, v1
    s_lshl_b32 s64, s44, 4
    v_add_u32 v2, s64, v3
    s_movk_i32 s64, 7168
    v_mul_u32_u24 v2, s64, v2
    v_add_u32 v2, s65, v2
    v_lshlrev_b32 v3, 1, v3
    v_and_b32 v4, 15, v1
    v_xor_b32 v3, v3, v4
    v_lshl_add_u32 v208, v3, 4, v2
    v_add_u32 v210, 55296, v208
    v_xor_b32 v3, 8, v3
    v_lshl_add_u32 v209, v3, 4, v2
    v_add_u32 v209, 27648, v209
    v_add_u32 v211, 55296, v209
    s_lshr_b32 s65, s48, 2
    s_sub_u32 s65, s48, s65
    s_add_u32 s65, s65, 16
    s_lshl_b32 s65, s65, 8
    s_or_b32 s65, s65, s69
    v_lshrrev_b32 v3, 4, v1
    s_lshl_b32 s64, s44, 4
    v_add_u32 v2, s64, v3
    s_movk_i32 s64, 7168
    v_mul_u32_u24 v2, s64, v2
    v_add_u32 v2, s65, v2
    v_lshlrev_b32 v3, 1, v3
    v_and_b32 v4, 15, v1
    v_xor_b32 v3, v3, v4
    v_lshl_add_u32 v212, v3, 4, v2
    v_add_u32 v214, 55296, v212
    v_xor_b32 v3, 8, v3
    v_lshl_add_u32 v213, v3, 4, v2
    v_add_u32 v213, 27648, v213
    v_add_u32 v215, 55296, v213
    s_lshl_b32 s65, s44, 1
    s_xor_b32 s65, s65, s49
    s_lshl_b32 s64, s47, 3
    s_add_u32 s64, s64, s65
    s_mul_i32 s64, s64, 114688
    s_add_u32 s64, s64, 0x1500000
    v_lshl_add_u32 v246, v1, 4, s64
    s_lshl_b32 s65, s44, 1
    s_or_b32 s65, s65, 1
    s_xor_b32 s65, s65, s49
    s_lshl_b32 s64, s47, 3
    s_add_u32 s64, s64, s65
    s_mul_i32 s64, s64, 114688
    s_add_u32 s64, s64, 0x14ff800
    v_lshl_add_u32 v247, v1, 4, s64
    s_lshl_b32 s65, s51, 9
    v_lshrrev_b32 v3, 4, v1
    s_lshl_b32 s64, s44, 4
    v_add_u32 v2, s64, v3
    s_movk_i32 s64, 2048
    v_mul_u32_u24 v2, s64, v2
    v_add_u32 v2, s65, v2
    v_lshlrev_b32 v3, 1, v3
    v_and_b32 v4, 15, v1
    v_xor_b32 v3, v3, v4
    v_lshl_add_u32 v248, v3, 4, v2
    v_add_u32 v250, 14336, v248
    v_xor_b32 v3, 8, v3
    v_lshl_add_u32 v249, v3, 4, v2
    v_add_u32 v249, 7168, v249
    v_add_u32 v251, 14336, v249
    s_lshl_b32 s64, s44, 12
    v_lshl_add_u32 v233, v1, 4, s64
    v_lshrrev_b32 v2, 2, v1
    v_lshlrev_b32 v4, 7, v2
    v_and_b32 v5, 3, v1
    v_lshl_add_u32 v4, v5, 3, v4
    v_add_u32 v4, 16384, v4
    v_bfe_u32 v2, v1, 3, 2
    v_xor_b32 v3, 0, v2
    v_lshl_add_u32 v239, v3, 5, v4
    v_xor_b32 v3, 1, v2
    v_lshl_add_u32 v240, v3, 5, v4
    v_xor_b32 v3, 2, v2
    v_lshl_add_u32 v241, v3, 5, v4
    v_xor_b32 v3, 3, v2
    v_lshl_add_u32 v242, v3, 5, v4
    s_mov_b32 s52, 49152
    v_add_u32 v232, s52, v233
    v_add_u32 v235, s52, v239
    v_add_u32 v236, s52, v240
    v_add_u32 v237, s52, v241
    v_add_u32 v238, s52, v242
    s_lshl_b32 s70, s47, 2
    s_add_u32 s70, s70, s44
    s_lshl_b32 s64, s70, 16
    s_lshl_b32 s65, s48, 7
    s_add_u32 s64, s64, s65
    v_and_b32 v2, 15, v1
    v_lshl_add_u32 v2, v2, 11, s64
    v_bfe_u32 v3, v1, 4, 1
    v_lshl_add_u32 v2, v3, 5, v2
    v_lshrrev_b32 v3, 5, v1
    v_lshl_add_u32 v196, v3, 4, v2
    s_mul_i32 s64, s70, 65536
    s_lshl_b32 s65, s48, 11
    s_add_u32 s64, s64, s65
    v_lshl_add_u32 v197, v1, 4, s64
    s_lshl_b32 s64, s70, 12
    s_add_u32 s64, s64, 0x60000
    v_lshl_add_u32 v198, v1, 3, s64
    v_and_b32 v2, 48, v1
    v_add_u32 v199, 149504, v2
    v_mov_b32 v72, 148480
    v_mov_b32 v73, 0
    ds_write_b32 v72, v73 offset:0
    ds_write_b32 v72, v73 offset:4
    ds_write_b32 v72, v73 offset:8
    ds_write_b32 v72, v73 offset:12
    ds_write_b32 v72, v73 offset:16
    ds_write_b32 v72, v73 offset:20
    v_and_b32 v16, 255, v0
    s_lshr_b32 s80, s2, 6
    s_lshl_b32 s81, s80, 8
    s_and_b32 s82, s2, 63
    s_lshl_b32 s83, s82, 7
    s_add_u32 s83, s83, 4096
    s_lshl_b32 s80, s80, 15
    s_lshl_b32 s82, s82, 9
    s_add_u32 s80, s80, s82
    s_add_u32 s80, s80, 0xa0000
    v_lshrrev_b32 v72, 3, v16
    v_add_u32 v72, s81, v72
    v_lshlrev_b32 v18, 1, v72
    s_movk_i32 s64, 12288
    v_mul_lo_u32 v72, s64, v72
    v_and_b32 v17, 7, v0
    v_lshl_add_u32 v72, v17, 4, v72
    v_add_u32 v17, s83, v72
    s_lshl_b32 s64, s2, 8
    v_add_lshl_u32 v243, v16, s64, 5
    s_mov_b32 s36, s20
    s_mov_b32 s37, s21
    s_mov_b32 s38, 0xc00000
    s_mov_b32 s39, 0x20000
    s_lshl_b32 s64, s2, 2
    s_add_u32 s64, s64, s44
    s_mul_i32 s64, s64, 7168
    s_add_u32 s64, s64, 4096
    s_add_u32 s10, s12, s64
    s_addc_u32 s11, s13, 0
    s_add_u32 s24, s14, s64
    s_addc_u32 s25, s15, 0
    s_waitcnt lgkmcnt(0)
    s_add_u32 s0, s0, 1
    s_barrier
    s_waitcnt vmcnt(0)
    v_lshlrev_b32 v120, 16, v104
    v_and_b32 v121, 0xffff0000, v104
    v_lshlrev_b32 v122, 16, v105
    v_and_b32 v123, 0xffff0000, v105
    v_lshlrev_b32 v124, 16, v106
    v_and_b32 v125, 0xffff0000, v106
    v_lshlrev_b32 v126, 16, v107
    v_and_b32 v127, 0xffff0000, v107
    v_lshlrev_b32 v128, 16, v108
    v_and_b32 v129, 0xffff0000, v108
    v_lshlrev_b32 v130, 16, v109
    v_and_b32 v131, 0xffff0000, v109
    v_lshlrev_b32 v132, 16, v110
    v_and_b32 v133, 0xffff0000, v110
    v_lshlrev_b32 v134, 16, v111
    v_and_b32 v135, 0xffff0000, v111
    v_lshlrev_b32 v136, 16, v112
    v_and_b32 v137, 0xffff0000, v112
    v_lshlrev_b32 v138, 16, v113
    v_and_b32 v139, 0xffff0000, v113
    v_lshlrev_b32 v140, 16, v114
    v_and_b32 v141, 0xffff0000, v114
    v_lshlrev_b32 v142, 16, v115
    v_and_b32 v143, 0xffff0000, v115
    v_lshlrev_b32 v144, 16, v116
    v_and_b32 v145, 0xffff0000, v116
    v_lshlrev_b32 v146, 16, v117
    v_and_b32 v147, 0xffff0000, v117
    v_lshlrev_b32 v148, 16, v118
    v_and_b32 v149, 0xffff0000, v118
    v_lshlrev_b32 v150, 16, v119
    v_and_b32 v151, 0xffff0000, v119
    v_pk_add_f32 v[104:105], v[120:121], v[122:123]
    v_pk_mul_f32 v[108:109], v[120:121], v[120:121]
    v_pk_add_f32 v[106:107], v[136:137], v[138:139]
    v_pk_mul_f32 v[110:111], v[136:137], v[136:137]
    v_pk_fma_f32 v[108:109], v[122:123], v[122:123], v[108:109]
    v_pk_fma_f32 v[110:111], v[138:139], v[138:139], v[110:111]
    v_pk_add_f32 v[104:105], v[104:105], v[124:125]
    v_pk_fma_f32 v[108:109], v[124:125], v[124:125], v[108:109]
    v_pk_add_f32 v[106:107], v[106:107], v[140:141]
    v_pk_fma_f32 v[110:111], v[140:141], v[140:141], v[110:111]
    v_pk_add_f32 v[104:105], v[104:105], v[126:127]
    v_pk_fma_f32 v[108:109], v[126:127], v[126:127], v[108:109]
    v_pk_add_f32 v[106:107], v[106:107], v[142:143]
    v_pk_fma_f32 v[110:111], v[142:143], v[142:143], v[110:111]
    v_pk_add_f32 v[104:105], v[104:105], v[128:129]
    v_pk_fma_f32 v[108:109], v[128:129], v[128:129], v[108:109]
    v_pk_add_f32 v[106:107], v[106:107], v[144:145]
    v_pk_fma_f32 v[110:111], v[144:145], v[144:145], v[110:111]
    v_pk_add_f32 v[104:105], v[104:105], v[130:131]
    v_pk_fma_f32 v[108:109], v[130:131], v[130:131], v[108:109]
    v_pk_add_f32 v[106:107], v[106:107], v[146:147]
    v_pk_fma_f32 v[110:111], v[146:147], v[146:147], v[110:111]
    v_pk_add_f32 v[104:105], v[104:105], v[132:133]
    v_pk_fma_f32 v[108:109], v[132:133], v[132:133], v[108:109]
    v_pk_add_f32 v[106:107], v[106:107], v[148:149]
    v_pk_fma_f32 v[110:111], v[148:149], v[148:149], v[110:111]
    v_pk_add_f32 v[104:105], v[104:105], v[134:135]
    v_pk_fma_f32 v[108:109], v[134:135], v[134:135], v[108:109]
    v_pk_add_f32 v[106:107], v[106:107], v[150:151]
    v_pk_fma_f32 v[110:111], v[150:151], v[150:151], v[110:111]
    v_add_f32 v152, v104, v105
    v_add_f32 v153, v108, v109
    v_add_f32 v156, v106, v107
    v_add_f32 v157, v110, v111
    v_add_f32_dpp v152, v152, v152 quad_perm:[1,0,3,2] row_mask:0xf bank_mask:0xf
    v_add_f32_dpp v153, v153, v153 quad_perm:[1,0,3,2] row_mask:0xf bank_mask:0xf
    v_add_f32_dpp v156, v156, v156 quad_perm:[1,0,3,2] row_mask:0xf bank_mask:0xf
    v_add_f32_dpp v157, v157, v157 quad_perm:[1,0,3,2] row_mask:0xf bank_mask:0xf
    v_add_f32_dpp v152, v152, v152 quad_perm:[2,3,0,1] row_mask:0xf bank_mask:0xf
    v_add_f32_dpp v153, v153, v153 quad_perm:[2,3,0,1] row_mask:0xf bank_mask:0xf
    v_add_f32_dpp v156, v156, v156 quad_perm:[2,3,0,1] row_mask:0xf bank_mask:0xf
    v_add_f32_dpp v157, v157, v157 quad_perm:[2,3,0,1] row_mask:0xf bank_mask:0xf
    v_add_f32_dpp v152, v152, v152 row_half_mirror row_mask:0xf bank_mask:0xf
    v_add_f32_dpp v153, v153, v153 row_half_mirror row_mask:0xf bank_mask:0xf
    v_add_f32_dpp v156, v156, v156 row_half_mirror row_mask:0xf bank_mask:0xf
    v_add_f32_dpp v157, v157, v157 row_half_mirror row_mask:0xf bank_mask:0xf
    v_add_f32_dpp v152, v152, v152 row_mirror row_mask:0xf bank_mask:0xf
    v_add_f32_dpp v153, v153, v153 row_mirror row_mask:0xf bank_mask:0xf
    v_add_f32_dpp v156, v156, v156 row_mirror row_mask:0xf bank_mask:0xf
    v_add_f32_dpp v157, v157, v157 row_mirror row_mask:0xf bank_mask:0xf
    v_mov_b32 v154, v152
    v_mov_b32 v155, v153
    v_mov_b32 v158, v156
    v_mov_b32 v159, v157
    v_permlane32_swap_b32 v152, v154
    v_permlane32_swap_b32 v153, v155
    v_permlane32_swap_b32 v156, v158
    v_permlane32_swap_b32 v157, v159
    v_add_f32 v152, v152, v154
    v_add_f32 v153, v153, v155
    v_add_f32 v156, v156, v158
    v_add_f32 v157, v157, v159
    v_mov_b32 v154, v152
    v_mov_b32 v155, v153
    v_mov_b32 v158, v156
    v_mov_b32 v159, v157
    v_permlane16_swap_b32 v152, v154
    v_permlane16_swap_b32 v153, v155
    v_permlane16_swap_b32 v156, v158
    v_permlane16_swap_b32 v157, v159
    v_add_f32 v152, v152, v154
    v_add_f32 v153, v153, v155
    v_add_f32 v156, v156, v158
    v_add_f32 v157, v157, v159
    v_mul_f32 v152, 0x3a800000, v152
    v_mul_f32 v153, 0x3a800000, v153
    v_mul_f32 v156, 0x3a800000, v156
    v_mul_f32 v157, 0x3a800000, v157
    v_fma_f32 v153, -v152, v152, v153
    v_fma_f32 v157, -v156, v156, v157
    v_max_f32 v153, 0, v153
    v_max_f32 v157, 0, v157
    v_cvt_pk_bf16_f32 v154, v152, v153
    v_lshlrev_b32 v152, 16, v154
    v_and_b32 v153, 0xffff0000, v154
    v_cvt_pk_bf16_f32 v158, v156, v157
    v_lshlrev_b32 v156, 16, v158
    v_and_b32 v157, 0xffff0000, v158
    v_add_f32 v153, 0x3727c5ac, v153
    v_add_f32 v157, 0x3727c5ac, v157
    v_cvt_pk_bf16_f32 v154, v153, v153
    v_lshlrev_b32 v153, 16, v154
    v_cvt_pk_bf16_f32 v158, v157, v157
    v_lshlrev_b32 v157, 16, v158
    v_sqrt_f32 v153, v153
    v_sqrt_f32 v157, v157
    v_cvt_pk_bf16_f32 v154, v153, v153
    v_lshlrev_b32 v153, 16, v154
    v_cvt_pk_bf16_f32 v158, v157, v157
    v_lshlrev_b32 v157, 16, v158
    v_lshrrev_b32 v153, 16, v153
    v_or_b32 v160, v152, v153
    v_mov_b32 v161, s0
    v_lshrrev_b32 v157, 16, v157
    v_or_b32 v162, v156, v157
    v_mov_b32 v163, s0
    s_lshl_b32 s64, s44, 4
    s_add_u32 s64, s64, 150528
    v_mov_b32 v2, s64
    v_mov_b32 v3, 148500
    v_mov_b32 v4, 1
    s_mov_b64 exec, 1
    ds_write_b128 v2, v[160:163]
    ds_add_rtn_u32 v5, v3, v4
    s_mov_b64 exec, 15
    v_lshlrev_b32 v2, 4, v1
    v_add_u32 v3, 150528, v2
    ds_read_b128 v[164:167], v3
    s_lshr_b32 s64, s62, 2
    s_lshl_b32 s64, s64, 7
    s_add_u32 s64, s64, 0x10000
    s_waitcnt lgkmcnt(0)
    v_readfirstlane_b32 s65, v5
    s_nop 3
    s_cmp_eq_u32 s65, 3
    s_cselect_b32 s64, s64, 0x80000000
    v_add_u32 v2, s64, v2
    buffer_store_dwordx4 v[164:167], v2, s[28:31], 0 offen sc1
    s_mov_b64 exec, -1
    s_mov_b32 s64, 0x0
    buffer_load_dwordx4 v[80:83], v8, s[40:43], s64 offen
    s_mov_b32 s64, 0x10000
    buffer_load_dwordx4 v[84:87], v8, s[40:43], s64 offen
    s_mov_b32 s64, 0x20000
    buffer_load_dwordx4 v[88:91], v8, s[40:43], s64 offen
    s_mov_b32 s64, 0x30000
    buffer_load_dwordx4 v[92:95], v8, s[40:43], s64 offen
    buffer_load_dwordx4 v[96:99], v9, s[40:43], 0 offen
    v_mov_b32 v74, -1
    v_mov_b32 v75, -1
    s_lshl_b32 s64, s48, 8
    s_mov_b32 exec_hi, 0
    buffer_store_dwordx2 v[74:75], v198, s[28:31], s64 offen sc1
    s_mov_b32 exec_hi, -1
    s_mov_b32 s40, s18
    s_mov_b32 s41, s19
    s_mov_b32 s42, 0x800
    s_mov_b32 s43, 0x20000
    buffer_load_ushort v24, v18, s[40:43], 0 offen offset:0
    buffer_load_ushort v25, v18, s[40:43], 0 offen offset:64
    buffer_load_ushort v26, v18, s[40:43], 0 offen offset:128
    buffer_load_ushort v27, v18, s[40:43], 0 offen offset:192
    buffer_load_ushort v28, v18, s[40:43], 0 offen offset:256
    buffer_load_ushort v29, v18, s[40:43], 0 offen offset:320
    buffer_load_ushort v30, v18, s[40:43], 0 offen offset:384
    buffer_load_ushort v31, v18, s[40:43], 0 offen offset:448
    buffer_load_dwordx2 v[168:169], v12, s[28:31], 0 offen offset:0 sc1
    buffer_load_dwordx2 v[170:171], v12, s[28:31], 0 offen offset:512 sc1
    buffer_load_dwordx2 v[172:173], v12, s[28:31], 0 offen offset:1024 sc1
    buffer_load_dwordx2 v[174:175], v12, s[28:31], 0 offen offset:1536 sc1
    buffer_load_dwordx2 v[176:177], v13, s[28:31], 0 offen sc1
    s_waitcnt vmcnt(14)
    v_lshlrev_b32 v120, 16, v80
    v_and_b32 v121, 0xffff0000, v80
    v_lshlrev_b32 v122, 16, v81
    v_and_b32 v123, 0xffff0000, v81
    v_lshlrev_b32 v124, 16, v82
    v_and_b32 v125, 0xffff0000, v82
    v_lshlrev_b32 v126, 16, v83
    v_and_b32 v127, 0xffff0000, v83
    v_lshlrev_b32 v128, 16, v84
    v_and_b32 v129, 0xffff0000, v84
    v_lshlrev_b32 v130, 16, v85
    v_and_b32 v131, 0xffff0000, v85
    v_lshlrev_b32 v132, 16, v86
    v_and_b32 v133, 0xffff0000, v86
    v_lshlrev_b32 v134, 16, v87
    v_and_b32 v135, 0xffff0000, v87
    v_lshlrev_b32 v136, 16, v88
    v_and_b32 v137, 0xffff0000, v88
    v_lshlrev_b32 v138, 16, v89
    v_and_b32 v139, 0xffff0000, v89
    v_lshlrev_b32 v140, 16, v90
    v_and_b32 v141, 0xffff0000, v90
    v_lshlrev_b32 v142, 16, v91
    v_and_b32 v143, 0xffff0000, v91
    v_lshlrev_b32 v144, 16, v92
    v_and_b32 v145, 0xffff0000, v92
    v_lshlrev_b32 v146, 16, v93
    v_and_b32 v147, 0xffff0000, v93
    v_lshlrev_b32 v148, 16, v94
    v_and_b32 v149, 0xffff0000, v94
    v_lshlrev_b32 v150, 16, v95
    v_and_b32 v151, 0xffff0000, v95
    v_lshlrev_b32 v152, 16, v96
    v_and_b32 v153, 0xffff0000, v96
    v_lshlrev_b32 v154, 16, v97
    v_and_b32 v155, 0xffff0000, v97
    v_lshlrev_b32 v156, 16, v98
    v_and_b32 v157, 0xffff0000, v98
    v_lshlrev_b32 v158, 16, v99
    v_and_b32 v159, 0xffff0000, v99
    s_waitcnt vmcnt(0)
    s_mov_b32 s3, 0x40000
M_s1_chk:
    v_xor_b32 v72, s0, v169
    v_xor_b32 v73, s0, v171
    v_xor_b32 v74, s0, v173
    v_xor_b32 v75, s0, v175
    v_xor_b32 v76, s0, v177
    v_or3_b32 v72, v72, v73, v74
    v_or3_b32 v72, v72, v75, v76
    v_cmp_ne_u32 vcc, 0, v72
    s_nop 4
    s_cbranch_vccz M_s1_ok
    s_sub_u32 s3, s3, 1
    s_cbranch_scc1 M_s1_ok
    s_sleep 2
    v_cmp_ne_u32 vcc, s0, v169
    s_nop 4
    s_mov_b64 exec, vcc
    buffer_load_dwordx2 v[168:169], v12, s[28:31], 0 offen offset:0 sc1
    s_mov_b64 exec, -1
    v_cmp_ne_u32 vcc, s0, v171
    s_nop 4
    s_mov_b64 exec, vcc
    buffer_load_dwordx2 v[170:171], v12, s[28:31], 0 offen offset:512 sc1
    s_mov_b64 exec, -1
    v_cmp_ne_u32 vcc, s0, v173
    s_nop 4
    s_mov_b64 exec, vcc
    buffer_load_dwordx2 v[172:173], v12, s[28:31], 0 offen offset:1024 sc1
    s_mov_b64 exec, -1
    v_cmp_ne_u32 vcc, s0, v175
    s_nop 4
    s_mov_b64 exec, vcc
    buffer_load_dwordx2 v[174:175], v12, s[28:31], 0 offen offset:1536 sc1
    s_mov_b64 exec, -1
    v_cmp_ne_u32 vcc, s0, v177
    s_nop 4
    s_mov_b64 exec, vcc
    buffer_load_dwordx2 v[176:177], v13, s[28:31], 0 offen sc1
    s_mov_b64 exec, -1
    s_waitcnt vmcnt(0)
    s_branch M_s1_chk
M_s1_ok:
    v_lshlrev_b32 v169, 16, v168
    v_and_b32 v168, 0xffff0000, v168
    v_lshlrev_b32 v171, 16, v170
    v_and_b32 v170, 0xffff0000, v170
    v_lshlrev_b32 v173, 16, v172
    v_and_b32 v172, 0xffff0000, v172
    v_lshlrev_b32 v175, 16, v174
    v_and_b32 v174, 0xffff0000, v174
    v_lshlrev_b32 v177, 16, v176
    v_and_b32 v176, 0xffff0000, v176
    v_rcp_f32 v169, v169
    v_rcp_f32 v171, v171
    v_rcp_f32 v173, v173
    v_rcp_f32 v175, v175
    v_rcp_f32 v177, v177
    v_pk_add_f32 v[120:121], v[120:121], v[168:169] op_sel_hi:[1,0] neg_lo:[0,1] neg_hi:[0,1]
    v_pk_add_f32 v[122:123], v[122:123], v[168:169] op_sel_hi:[1,0] neg_lo:[0,1] neg_hi:[0,1]
    v_pk_add_f32 v[124:125], v[124:125], v[168:169] op_sel_hi:[1,0] neg_lo:[0,1] neg_hi:[0,1]
    v_pk_add_f32 v[126:127], v[126:127], v[168:169] op_sel_hi:[1,0] neg_lo:[0,1] neg_hi:[0,1]
    v_cvt_pk_bf16_f32 v72, v120, v121
    v_lshlrev_b32 v120, 16, v72
    v_and_b32 v121, 0xffff0000, v72
    v_cvt_pk_bf16_f32 v73, v122, v123
    v_lshlrev_b32 v122, 16, v73
    v_and_b32 v123, 0xffff0000, v73
    v_cvt_pk_bf16_f32 v74, v124, v125
    v_lshlrev_b32 v124, 16, v74
    v_and_b32 v125, 0xffff0000, v74
    v_cvt_pk_bf16_f32 v75, v126, v127
    v_lshlrev_b32 v126, 16, v75
    v_and_b32 v127, 0xffff0000, v75
    v_pk_mul_f32 v[120:121], v[120:121], v[168:169] op_sel:[0,1] op_sel_hi:[1,1]
    v_pk_mul_f32 v[122:123], v[122:123], v[168:169] op_sel:[0,1] op_sel_hi:[1,1]
    v_pk_mul_f32 v[124:125], v[124:125], v[168:169] op_sel:[0,1] op_sel_hi:[1,1]
    v_pk_mul_f32 v[126:127], v[126:127], v[168:169] op_sel:[0,1] op_sel_hi:[1,1]
    v_cvt_pk_bf16_f32 v72, v120, v121
    v_lshlrev_b32 v120, 16, v72
    v_and_b32 v121, 0xffff0000, v72
    v_cvt_pk_bf16_f32 v73, v122, v123
    v_lshlrev_b32 v122, 16, v73
    v_and_b32 v123, 0xffff0000, v73
    v_cvt_pk_bf16_f32 v74, v124, v125
    v_lshlrev_b32 v124, 16, v74
    v_and_b32 v125, 0xffff0000, v74
    v_cvt_pk_bf16_f32 v75, v126, v127
    v_lshlrev_b32 v126, 16, v75
    v_and_b32 v127, 0xffff0000, v75
    v_pk_add_f32 v[128:129], v[128:129], v[170:171] op_sel_hi:[1,0] neg_lo:[0,1] neg_hi:[0,1]
    v_pk_add_f32 v[130:131], v[130:131], v[170:171] op_sel_hi:[1,0] neg_lo:[0,1] neg_hi:[0,1]
    v_pk_add_f32 v[132:133], v[132:133], v[170:171] op_sel_hi:[1,0] neg_lo:[0,1] neg_hi:[0,1]
    v_pk_add_f32 v[134:135], v[134:135], v[170:171] op_sel_hi:[1,0] neg_lo:[0,1] neg_hi:[0,1]
    v_cvt_pk_bf16_f32 v72, v128, v129
    v_lshlrev_b32 v128, 16, v72
    v_and_b32 v129, 0xffff0000, v72
    v_cvt_pk_bf16_f32 v73, v130, v131
    v_lshlrev_b32 v130, 16, v73
    v_and_b32 v131, 0xffff0000, v73
    v_cvt_pk_bf16_f32 v74, v132, v133
    v_lshlrev_b32 v132, 16, v74
    v_and_b32 v133, 0xffff0000, v74
    v_cvt_pk_bf16_f32 v75, v134, v135
    v_lshlrev_b32 v134, 16, v75
    v_and_b32 v135, 0xffff0000, v75
    v_pk_mul_f32 v[128:129], v[128:129], v[170:171] op_sel:[0,1] op_sel_hi:[1,1]
    v_pk_mul_f32 v[130:131], v[130:131], v[170:171] op_sel:[0,1] op_sel_hi:[1,1]
    v_pk_mul_f32 v[132:133], v[132:133], v[170:171] op_sel:[0,1] op_sel_hi:[1,1]
    v_pk_mul_f32 v[134:135], v[134:135], v[170:171] op_sel:[0,1] op_sel_hi:[1,1]
    v_cvt_pk_bf16_f32 v72, v128, v129
    v_lshlrev_b32 v128, 16, v72
    v_and_b32 v129, 0xffff0000, v72
    v_cvt_pk_bf16_f32 v73, v130, v131
    v_lshlrev_b32 v130, 16, v73
    v_and_b32 v131, 0xffff0000, v73
    v_cvt_pk_bf16_f32 v74, v132, v133
    v_lshlrev_b32 v132, 16, v74
    v_and_b32 v133, 0xffff0000, v74
    v_cvt_pk_bf16_f32 v75, v134, v135
    v_lshlrev_b32 v134, 16, v75
    v_and_b32 v135, 0xffff0000, v75
    v_pk_add_f32 v[136:137], v[136:137], v[172:173] op_sel_hi:[1,0] neg_lo:[0,1] neg_hi:[0,1]
    v_pk_add_f32 v[138:139], v[138:139], v[172:173] op_sel_hi:[1,0] neg_lo:[0,1] neg_hi:[0,1]
    v_pk_add_f32 v[140:141], v[140:141], v[172:173] op_sel_hi:[1,0] neg_lo:[0,1] neg_hi:[0,1]
    v_pk_add_f32 v[142:143], v[142:143], v[172:173] op_sel_hi:[1,0] neg_lo:[0,1] neg_hi:[0,1]
    v_cvt_pk_bf16_f32 v72, v136, v137
    v_lshlrev_b32 v136, 16, v72
    v_and_b32 v137, 0xffff0000, v72
    v_cvt_pk_bf16_f32 v73, v138, v139
    v_lshlrev_b32 v138, 16, v73
    v_and_b32 v139, 0xffff0000, v73
    v_cvt_pk_bf16_f32 v74, v140, v141
    v_lshlrev_b32 v140, 16, v74
    v_and_b32 v141, 0xffff0000, v74
    v_cvt_pk_bf16_f32 v75, v142, v143
    v_lshlrev_b32 v142, 16, v75
    v_and_b32 v143, 0xffff0000, v75
    v_pk_mul_f32 v[136:137], v[136:137], v[172:173] op_sel:[0,1] op_sel_hi:[1,1]
    v_pk_mul_f32 v[138:139], v[138:139], v[172:173] op_sel:[0,1] op_sel_hi:[1,1]
    v_pk_mul_f32 v[140:141], v[140:141], v[172:173] op_sel:[0,1] op_sel_hi:[1,1]
    v_pk_mul_f32 v[142:143], v[142:143], v[172:173] op_sel:[0,1] op_sel_hi:[1,1]
    v_cvt_pk_bf16_f32 v72, v136, v137
    v_lshlrev_b32 v136, 16, v72
    v_and_b32 v137, 0xffff0000, v72
    v_cvt_pk_bf16_f32 v73, v138, v139
    v_lshlrev_b32 v138, 16, v73
    v_and_b32 v139, 0xffff0000, v73
    v_cvt_pk_bf16_f32 v74, v140, v141
    v_lshlrev_b32 v140, 16, v74
    v_and_b32 v141, 0xffff0000, v74
    v_cvt_pk_bf16_f32 v75, v142, v143
    v_lshlrev_b32 v142, 16, v75
    v_and_b32 v143, 0xffff0000, v75
    v_pk_add_f32 v[144:145], v[144:145], v[174:175] op_sel_hi:[1,0] neg_lo:[0,1] neg_hi:[0,1]
    v_pk_add_f32 v[146:147], v[146:147], v[174:175] op_sel_hi:[1,0] neg_lo:[0,1] neg_hi:[0,1]
    v_pk_add_f32 v[148:149], v[148:149], v[174:175] op_sel_hi:[1,0] neg_lo:[0,1] neg_hi:[0,1]
    v_pk_add_f32 v[150:151], v[150:151], v[174:175] op_sel_hi:[1,0] neg_lo:[0,1] neg_hi:[0,1]
    v_cvt_pk_bf16_f32 v72, v144, v145
    v_lshlrev_b32 v144, 16, v72
    v_and_b32 v145, 0xffff0000, v72
    v_cvt_pk_bf16_f32 v73, v146, v147
    v_lshlrev_b32 v146, 16, v73
    v_and_b32 v147, 0xffff0000, v73
    v_cvt_pk_bf16_f32 v74, v148, v149
    v_lshlrev_b32 v148, 16, v74
    v_and_b32 v149, 0xffff0000, v74
    v_cvt_pk_bf16_f32 v75, v150, v151
    v_lshlrev_b32 v150, 16, v75
    v_and_b32 v151, 0xffff0000, v75
    v_pk_mul_f32 v[144:145], v[144:145], v[174:175] op_sel:[0,1] op_sel_hi:[1,1]
    v_pk_mul_f32 v[146:147], v[146:147], v[174:175] op_sel:[0,1] op_sel_hi:[1,1]
    v_pk_mul_f32 v[148:149], v[148:149], v[174:175] op_sel:[0,1] op_sel_hi:[1,1]
    v_pk_mul_f32 v[150:151], v[150:151], v[174:175] op_sel:[0,1] op_sel_hi:[1,1]
    v_cvt_pk_bf16_f32 v72, v144, v145
    v_lshlrev_b32 v144, 16, v72
    v_and_b32 v145, 0xffff0000, v72
    v_cvt_pk_bf16_f32 v73, v146, v147
    v_lshlrev_b32 v146, 16, v73
    v_and_b32 v147, 0xffff0000, v73
    v_cvt_pk_bf16_f32 v74, v148, v149
    v_lshlrev_b32 v148, 16, v74
    v_and_b32 v149, 0xffff0000, v74
    v_cvt_pk_bf16_f32 v75, v150, v151
    v_lshlrev_b32 v150, 16, v75
    v_and_b32 v151, 0xffff0000, v75
    v_pk_add_f32 v[152:153], v[152:153], v[176:177] op_sel_hi:[1,0] neg_lo:[0,1] neg_hi:[0,1]
    v_pk_add_f32 v[154:155], v[154:155], v[176:177] op_sel_hi:[1,0] neg_lo:[0,1] neg_hi:[0,1]
    v_pk_add_f32 v[156:157], v[156:157], v[176:177] op_sel_hi:[1,0] neg_lo:[0,1] neg_hi:[0,1]
    v_pk_add_f32 v[158:159], v[158:159], v[176:177] op_sel_hi:[1,0] neg_lo:[0,1] neg_hi:[0,1]
    v_cvt_pk_bf16_f32 v72, v152, v153
    v_lshlrev_b32 v152, 16, v72
    v_and_b32 v153, 0xffff0000, v72
    v_cvt_pk_bf16_f32 v73, v154, v155
    v_lshlrev_b32 v154, 16, v73
    v_and_b32 v155, 0xffff0000, v73
    v_cvt_pk_bf16_f32 v74, v156, v157
    v_lshlrev_b32 v156, 16, v74
    v_and_b32 v157, 0xffff0000, v74
    v_cvt_pk_bf16_f32 v75, v158, v159
    v_lshlrev_b32 v158, 16, v75
    v_and_b32 v159, 0xffff0000, v75
    v_pk_mul_f32 v[152:153], v[152:153], v[176:177] op_sel:[0,1] op_sel_hi:[1,1]
    v_pk_mul_f32 v[154:155], v[154:155], v[176:177] op_sel:[0,1] op_sel_hi:[1,1]
    v_pk_mul_f32 v[156:157], v[156:157], v[176:177] op_sel:[0,1] op_sel_hi:[1,1]
    v_pk_mul_f32 v[158:159], v[158:159], v[176:177] op_sel:[0,1] op_sel_hi:[1,1]
    v_cvt_pk_bf16_f32 v72, v152, v153
    v_lshlrev_b32 v152, 16, v72
    v_and_b32 v153, 0xffff0000, v72
    v_cvt_pk_bf16_f32 v73, v154, v155
    v_lshlrev_b32 v154, 16, v73
    v_and_b32 v155, 0xffff0000, v73
    v_cvt_pk_bf16_f32 v74, v156, v157
    v_lshlrev_b32 v156, 16, v74
    v_and_b32 v157, 0xffff0000, v74
    v_cvt_pk_bf16_f32 v75, v158, v159
    v_lshlrev_b32 v158, 16, v75
    v_and_b32 v159, 0xffff0000, v75
    s_lshl_b32 s68, s47, 9
    s_add_u32 s68, s68, 0x58000
    s_add_u32 s62, s26, s68
    s_addc_u32 s63, s27, 0
    s_lshr_b32 s68, s48, 2
    s_lshl_b32 s68, s68, 7
    v_mov_b32 v2, 1
    v_mov_b32 v5, 148496
    s_and_b32 s57, s58, 15
    s_lshr_b64 s[58:59], s[58:59], 4
    s_lshl_b32 s56, s57, 11
    s_mul_i32 s57, s57, 0x60000
    s_add_u32 m0, s53, s74
    s_nop 0
    buffer_load_dwordx4 v187, s[32:35], s57 offen offset:0 lds
    buffer_load_dwordx4 v188, s[32:35], s57 offen offset:1024 lds
    buffer_load_dwordx4 v189, s[32:35], s57 offen offset:2048 lds
    buffer_load_dwordx4 v190, s[32:35], s57 offen offset:3072 lds
    s_add_u32 m0, s53, s75
    s_nop 0
    buffer_load_dwordx4 v191, s[32:35], s57 offen offset:0 lds
    buffer_load_dwordx4 v192, s[32:35], s57 offen offset:1024 lds
    s_add_u32 s53, s53, 49152
    s_cmp_ge_u32 s53, 147456
    s_cselect_b32 s53, 0, s53
    s_barrier
    ds_read_b128 v[32:35], v14 offset:0
    ds_read_b128 v[36:39], v14 offset:16
    ds_read_b128 v[40:43], v14 offset:256
    ds_read_b128 v[44:47], v14 offset:272
    s_waitcnt lgkmcnt(0)
    v_pk_mul_f32 v[120:121], v[120:121], v[40:41]
    v_pk_mul_f32 v[122:123], v[122:123], v[42:43]
    v_pk_mul_f32 v[124:125], v[124:125], v[44:45]
    v_pk_mul_f32 v[126:127], v[126:127], v[46:47]
    v_cvt_pk_bf16_f32 v72, v120, v121
    v_lshlrev_b32 v120, 16, v72
    v_and_b32 v121, 0xffff0000, v72
    v_cvt_pk_bf16_f32 v73, v122, v123
    v_lshlrev_b32 v122, 16, v73
    v_and_b32 v123, 0xffff0000, v73
    v_cvt_pk_bf16_f32 v74, v124, v125
    v_lshlrev_b32 v124, 16, v74
    v_and_b32 v125, 0xffff0000, v74
    v_cvt_pk_bf16_f32 v75, v126, v127
    v_lshlrev_b32 v126, 16, v75
    v_and_b32 v127, 0xffff0000, v75
    v_pk_add_f32 v[120:121], v[120:121], v[32:33]
    v_pk_add_f32 v[122:123], v[122:123], v[34:35]
    v_pk_add_f32 v[124:125], v[124:125], v[36:37]
    v_pk_add_f32 v[126:127], v[126:127], v[38:39]
    v_cvt_pk_bf16_f32 v80, v120, v121
    v_cvt_pk_bf16_f32 v81, v122, v123
    v_cvt_pk_bf16_f32 v82, v124, v125
    v_cvt_pk_bf16_f32 v83, v126, v127
    s_mov_b32 s64, 0x0
    buffer_store_dwordx4 v[80:83], v10, s[28:31], s64 offen sc1
    ds_write_b128 v15, v[80:83] offset:0
    v_pk_mul_f32 v[128:129], v[128:129], v[40:41]
    v_pk_mul_f32 v[130:131], v[130:131], v[42:43]
    v_pk_mul_f32 v[132:133], v[132:133], v[44:45]
    v_pk_mul_f32 v[134:135], v[134:135], v[46:47]
    v_cvt_pk_bf16_f32 v72, v128, v129
    v_lshlrev_b32 v128, 16, v72
    v_and_b32 v129, 0xffff0000, v72
    v_cvt_pk_bf16_f32 v73, v130, v131
    v_lshlrev_b32 v130, 16, v73
    v_and_b32 v131, 0xffff0000, v73
    v_cvt_pk_bf16_f32 v74, v132, v133
    v_lshlrev_b32 v132, 16, v74
    v_and_b32 v133, 0xffff0000, v74
    v_cvt_pk_bf16_f32 v75, v134, v135
    v_lshlrev_b32 v134, 16, v75
    v_and_b32 v135, 0xffff0000, v75
    v_pk_add_f32 v[128:129], v[128:129], v[32:33]
    v_pk_add_f32 v[130:131], v[130:131], v[34:35]
    v_pk_add_f32 v[132:133], v[132:133], v[36:37]
    v_pk_add_f32 v[134:135], v[134:135], v[38:39]
    v_cvt_pk_bf16_f32 v84, v128, v129
    v_cvt_pk_bf16_f32 v85, v130, v131
    v_cvt_pk_bf16_f32 v86, v132, v133
    v_cvt_pk_bf16_f32 v87, v134, v135
    s_mov_b32 s64, 0x10000
    buffer_store_dwordx4 v[84:87], v10, s[28:31], s64 offen sc1
    ds_write_b128 v15, v[84:87] offset:4096
    v_pk_mul_f32 v[136:137], v[136:137], v[40:41]
    v_pk_mul_f32 v[138:139], v[138:139], v[42:43]
    v_pk_mul_f32 v[140:141], v[140:141], v[44:45]
    v_pk_mul_f32 v[142:143], v[142:143], v[46:47]
    v_cvt_pk_bf16_f32 v72, v136, v137
    v_lshlrev_b32 v136, 16, v72
    v_and_b32 v137, 0xffff0000, v72
    v_cvt_pk_bf16_f32 v73, v138, v139
    v_lshlrev_b32 v138, 16, v73
    v_and_b32 v139, 0xffff0000, v73
    v_cvt_pk_bf16_f32 v74, v140, v141
    v_lshlrev_b32 v140, 16, v74
    v_and_b32 v141, 0xffff0000, v74
    v_cvt_pk_bf16_f32 v75, v142, v143
    v_lshlrev_b32 v142, 16, v75
    v_and_b32 v143, 0xffff0000, v75
    v_pk_add_f32 v[136:137], v[136:137], v[32:33]
    v_pk_add_f32 v[138:139], v[138:139], v[34:35]
    v_pk_add_f32 v[140:141], v[140:141], v[36:37]
    v_pk_add_f32 v[142:143], v[142:143], v[38:39]
    v_cvt_pk_bf16_f32 v88, v136, v137
    v_cvt_pk_bf16_f32 v89, v138, v139
    v_cvt_pk_bf16_f32 v90, v140, v141
    v_cvt_pk_bf16_f32 v91, v142, v143
    s_mov_b32 s64, 0x20000
    buffer_store_dwordx4 v[88:91], v10, s[28:31], s64 offen sc1
    ds_write_b128 v15, v[88:91] offset:8192
    v_pk_mul_f32 v[144:145], v[144:145], v[40:41]
    v_pk_mul_f32 v[146:147], v[146:147], v[42:43]
    v_pk_mul_f32 v[148:149], v[148:149], v[44:45]
    v_pk_mul_f32 v[150:151], v[150:151], v[46:47]
    v_cvt_pk_bf16_f32 v72, v144, v145
    v_lshlrev_b32 v144, 16, v72
    v_and_b32 v145, 0xffff0000, v72
    v_cvt_pk_bf16_f32 v73, v146, v147
    v_lshlrev_b32 v146, 16, v73
    v_and_b32 v147, 0xffff0000, v73
    v_cvt_pk_bf16_f32 v74, v148, v149
    v_lshlrev_b32 v148, 16, v74
    v_and_b32 v149, 0xffff0000, v74
    v_cvt_pk_bf16_f32 v75, v150, v151
    v_lshlrev_b32 v150, 16, v75
    v_and_b32 v151, 0xffff0000, v75
    v_pk_add_f32 v[144:145], v[144:145], v[32:33]
    v_pk_add_f32 v[146:147], v[146:147], v[34:35]
    v_pk_add_f32 v[148:149], v[148:149], v[36:37]
    v_pk_add_f32 v[150:151], v[150:151], v[38:39]
    v_cvt_pk_bf16_f32 v92, v144, v145
    v_cvt_pk_bf16_f32 v93, v146, v147
    v_cvt_pk_bf16_f32 v94, v148, v149
    v_cvt_pk_bf16_f32 v95, v150, v151
    s_mov_b32 s64, 0x30000
    buffer_store_dwordx4 v[92:95], v10, s[28:31], s64 offen sc1
    ds_write_b128 v15, v[92:95] offset:12288
    v_pk_mul_f32 v[152:153], v[152:153], v[40:41]
    v_pk_mul_f32 v[154:155], v[154:155], v[42:43]
    v_pk_mul_f32 v[156:157], v[156:157], v[44:45]
    v_pk_mul_f32 v[158:159], v[158:159], v[46:47]
    v_cvt_pk_bf16_f32 v72, v152, v153
    v_lshlrev_b32 v152, 16, v72
    v_and_b32 v153, 0xffff0000, v72
    v_cvt_pk_bf16_f32 v73, v154, v155
    v_lshlrev_b32 v154, 16, v73
    v_and_b32 v155, 0xffff0000, v73
    v_cvt_pk_bf16_f32 v74, v156, v157
    v_lshlrev_b32 v156, 16, v74
    v_and_b32 v157, 0xffff0000, v74
    v_cvt_pk_bf16_f32 v75, v158, v159
    v_lshlrev_b32 v158, 16, v75
    v_and_b32 v159, 0xffff0000, v75
    v_pk_add_f32 v[152:153], v[152:153], v[32:33]
    v_pk_add_f32 v[154:155], v[154:155], v[34:35]
    v_pk_add_f32 v[156:157], v[156:157], v[36:37]
    v_pk_add_f32 v[158:159], v[158:159], v[38:39]
    v_cvt_pk_bf16_f32 v96, v152, v153
    v_cvt_pk_bf16_f32 v97, v154, v155
    v_cvt_pk_bf16_f32 v98, v156, v157
    v_cvt_pk_bf16_f32 v99, v158, v159
    buffer_store_dwordx4 v[96:99], v11, s[28:31], 0 offen sc1
    ds_write_b128 v19, v[96:99] offset:0
    s_waitcnt lgkmcnt(0)
    s_waitcnt vmcnt(5)
    s_barrier
    s_and_b32 s57, s58, 15
    s_lshr_b64 s[58:59], s[58:59], 4
    s_lshl_b32 s56, s57, 11
    s_mul_i32 s57, s57, 0x60000
    s_add_u32 m0, s53, s74
    s_nop 0
    buffer_load_dwordx4 v187, s[32:35], s57 offen offset:0 lds
    buffer_load_dwordx4 v188, s[32:35], s57 offen offset:1024 lds
    buffer_load_dwordx4 v189, s[32:35], s57 offen offset:2048 lds
    buffer_load_dwordx4 v190, s[32:35], s57 offen offset:3072 lds
    s_add_u32 m0, s53, s75
    s_nop 0
    buffer_load_dwordx4 v191, s[32:35], s57 offen offset:0 lds
    buffer_load_dwordx4 v192, s[32:35], s57 offen offset:1024 lds
    s_add_u32 s53, s53, 49152
    s_cmp_ge_u32 s53, 147456
    s_cselect_b32 s53, 0, s53
    s_mov_b32 s64, 0x0
    buffer_load_dwordx4 v[32:35], v17, s[36:39], s64 offen
    s_mov_b32 s64, 0x60000
    buffer_load_dwordx4 v[36:39], v17, s[36:39], s64 offen
    s_mov_b32 s64, 0xc0000
    buffer_load_dwordx4 v[40:43], v17, s[36:39], s64 offen
    s_mov_b32 s53, 0
    s_bfe_u32 s66, s2, 0x30003
    s_lshr_b32 s55, s2, 6
    s_add_u32 s66, s66, s55
    s_and_b32 s66, s66, 3
    s_mov_b32 s58, 0x76453210
    s_mov_b32 s59, 0xfecdba89
    s_cmp_eq_u32 s66, 1
    s_cselect_b32 s58, 0x75643120, s58
    s_cselect_b32 s59, 0xfdecb9a8, s59
    s_cmp_eq_u32 s66, 2
    s_cselect_b32 s58, 0x67542310, s58
    s_cselect_b32 s59, 0xefdcab98, s59
    s_cmp_eq_u32 s66, 3
    s_cselect_b32 s58, 0x86534210, s58
    s_cselect_b32 s59, 0xfedbca97, s59
    s_and_b32 s66, s48, 15
    s_lshl_b32 s55, s66, 2
    s_lshr_b64 s[56:57], s[58:59], s55
    s_and_b32 s55, s56, 15
    s_lshl_b32 s55, s55, 2
    s_lshl_b64 s[56:57], 15, s55
    s_andn2_b64 s[58:59], s[58:59], s[56:57]
    s_or_b32 s58, s58, s66
    s_waitcnt vmcnt(9)
    s_mov_b64 exec, 1
    ds_add_rtn_u32 v245, v5, v2
    s_mov_b64 exec, -1
    s_mov_b32 s1, 1
    s_mov_b32 s3, 0x40000
    s_waitcnt lgkmcnt(0)
    v_readfirstlane_b32 s64, v245
    s_nop 3
    s_cmp_lg_u32 s64, 3
    s_cbranch_scc1 M_p1_ok
    s_atomic_add s1, s[62:63], 0
    s_atomic_add s1, s[62:63], 128
    s_atomic_add s1, s[62:63], 256
    s_atomic_add s1, s[62:63], 384
M_p1_chk:
    s_load_dword s64, s[62:63], s68 glc
    s_sub_u32 s3, s3, 1
    s_cselect_b32 s65, 0, 16
    s_waitcnt lgkmcnt(0)
    s_cmp_lt_u32 s64, s65
    s_cbranch_scc1 M_p1_chk
M_p1_ok:
    s_barrier
    s_and_b32 s57, s58, 15
    s_lshr_b64 s[58:59], s[58:59], 4
    s_lshl_b32 s56, s57, 11
    s_mul_i32 s57, s57, 0x60000
    s_add_u32 s53, s53, 49152
    s_cmp_ge_u32 s53, 147456
    s_cselect_b32 s53, 0, s53
    s_and_b32 s57, s58, 15
    s_lshr_b64 s[58:59], s[58:59], 4
    s_lshl_b32 s56, s57, 11
    s_mul_i32 s57, s57, 0x60000
    s_add_u32 m0, s53, s72
    s_nop 0
    buffer_load_dwordx4 v184, s[28:31], s56 offen offset:0 sc1 lds
    buffer_load_dwordx4 v184, s[28:31], s56 offen offset:1024 sc1 lds
    buffer_load_dwordx4 v185, s[28:31], s56 offen offset:2048 sc1 lds
    buffer_load_dwordx4 v185, s[28:31], s56 offen offset:3072 sc1 lds
    s_add_u32 m0, s53, s73
    s_mov_b32 exec_hi, 0
    buffer_load_dwordx4 v186, s[28:31], s56 offen offset:0 sc1 lds
    s_mov_b32 exec_hi, -1
    s_add_u32 s53, s53, 49152
    s_cmp_ge_u32 s53, 147456
    s_cselect_b32 s53, 0, s53
    s_and_b32 s57, s58, 15
    s_lshr_b64 s[58:59], s[58:59], 4
    s_lshl_b32 s56, s57, 11
    s_mul_i32 s57, s57, 0x60000
    s_add_u32 m0, s53, s74
    s_nop 0
    buffer_load_dwordx4 v187, s[32:35], s57 offen offset:0 lds
    buffer_load_dwordx4 v188, s[32:35], s57 offen offset:1024 lds
    buffer_load_dwordx4 v189, s[32:35], s57 offen offset:2048 lds
    buffer_load_dwordx4 v190, s[32:35], s57 offen offset:3072 lds
    s_add_u32 m0, s53, s75
    s_nop 0
    buffer_load_dwordx4 v191, s[32:35], s57 offen offset:0 lds
    buffer_load_dwordx4 v192, s[32:35], s57 offen offset:1024 lds
    s_add_u32 m0, s53, s72
    s_nop 0
    buffer_load_dwordx4 v184, s[28:31], s56 offen offset:0 sc1 lds
    buffer_load_dwordx4 v184, s[28:31], s56 offen offset:1024 sc1 lds
    buffer_load_dwordx4 v185, s[28:31], s56 offen offset:2048 sc1 lds
    buffer_load_dwordx4 v185, s[28:31], s56 offen offset:3072 sc1 lds
    s_add_u32 m0, s53, s73
    s_mov_b32 exec_hi, 0
    buffer_load_dwordx4 v186, s[28:31], s56 offen offset:0 sc1 lds
    s_mov_b32 exec_hi, -1
    s_add_u32 s53, s53, 49152
    s_cmp_ge_u32 s53, 147456
    s_cselect_b32 s53, 0, s53
    s_waitcnt vmcnt(11)
    s_barrier
    s_and_b32 s57, s58, 15
    s_lshr_b64 s[58:59], s[58:59], 4
    s_lshl_b32 s56, s57, 11
    s_mul_i32 s57, s57, 0x60000
    s_add_u32 m0, s53, s74
    s_nop 0
    buffer_load_dwordx4 v187, s[32:35], s57 offen offset:0 lds
    buffer_load_dwordx4 v188, s[32:35], s57 offen offset:1024 lds
    s_load_dword s99, s[10:11], -3712
    buffer_load_dwordx4 v189, s[32:35], s57 offen offset:2048 lds
    buffer_load_dwordx4 v190, s[32:35], s57 offen offset:3072 lds
    s_load_dword s99, s[24:25], -3712
    s_add_u32 m0, s53, s75
    s_nop 0
    buffer_load_dwordx4 v191, s[32:35], s57 offen offset:0 lds
    buffer_load_dwordx4 v192, s[32:35], s57 offen offset:1024 lds
    s_load_dword s99, s[10:11], -3648
    s_add_u32 m0, s53, s72
    s_nop 0
    buffer_load_dwordx4 v184, s[28:31], s56 offen offset:0 sc1 lds
    buffer_load_dwordx4 v184, s[28:31], s56 offen offset:1024 sc1 lds
    s_load_dword s99, s[24:25], -3648
    buffer_load_dwordx4 v185, s[28:31], s56 offen offset:2048 sc1 lds
    buffer_load_dwordx4 v185, s[28:31], s56 offen offset:3072 sc1 lds
    s_load_dword s99, s[10:11], -2688
    s_add_u32 m0, s53, s73
    s_mov_b32 exec_hi, 0
    buffer_load_dwordx4 v186, s[28:31], s56 offen offset:0 sc1 lds
    s_mov_b32 exec_hi, -1
    s_add_u32 s53, s53, 49152
    s_cmp_ge_u32 s53, 147456
    s_cselect_b32 s53, 0, s53
    s_load_dword s99, s[24:25], -2688
    s_waitcnt vmcnt(11)
    s_barrier
    s_and_b32 s57, s58, 15
    s_lshr_b64 s[58:59], s[58:59], 4
    s_lshl_b32 s56, s57, 11
    s_mul_i32 s57, s57, 0x60000
    s_add_u32 m0, s53, s74
    s_nop 0
    buffer_load_dwordx4 v187, s[32:35], s57 offen offset:0 lds
    buffer_load_dwordx4 v188, s[32:35], s57 offen offset:1024 lds
    s_load_dword s99, s[10:11], -2624
    buffer_load_dwordx4 v189, s[32:35], s57 offen offset:2048 lds
    buffer_load_dwordx4 v190, s[32:35], s57 offen offset:3072 lds
    s_load_dword s99, s[24:25], -2624
    s_add_u32 m0, s53, s75
    s_nop 0
    buffer_load_dwordx4 v191, s[32:35], s57 offen offset:0 lds
    buffer_load_dwordx4 v192, s[32:35], s57 offen offset:1024 lds
    s_load_dword s99, s[10:11], -1664
    s_add_u32 m0, s53, s72
    s_nop 0
    buffer_load_dwordx4 v184, s[28:31], s56 offen offset:0 sc1 lds
    buffer_load_dwordx4 v184, s[28:31], s56 offen offset:1024 sc1 lds
    s_load_dword s99, s[24:25], -1664
    buffer_load_dwordx4 v185, s[28:31], s56 offen offset:2048 sc1 lds
    buffer_load_dwordx4 v185, s[28:31], s56 offen offset:3072 sc1 lds
    s_load_dword s99, s[10:11], -1600
    s_add_u32 m0, s53, s73
    s_mov_b32 exec_hi, 0
    buffer_load_dwordx4 v186, s[28:31], s56 offen offset:0 sc1 lds
    s_mov_b32 exec_hi, -1
    s_add_u32 s53, s53, 49152
    s_cmp_ge_u32 s53, 147456
    s_cselect_b32 s53, 0, s53
    s_load_dword s99, s[24:25], -1600
    s_waitcnt vmcnt(11)
    s_barrier
    s_and_b32 s57, s58, 15
    s_lshr_b64 s[58:59], s[58:59], 4
    s_lshl_b32 s56, s57, 11
    s_mul_i32 s57, s57, 0x60000
    s_add_u32 m0, s53, s74
    s_nop 0
    buffer_load_dwordx4 v187, s[32:35], s57 offen offset:0 lds
    buffer_load_dwordx4 v188, s[32:35], s57 offen offset:1024 lds
    buffer_load_dwordx4 v189, s[32:35], s57 offen offset:2048 lds
    s_load_dword s99, s[10:11], -640
    buffer_load_dwordx4 v190, s[32:35], s57 offen offset:3072 lds
    s_add_u32 m0, s53, s75
    s_nop 0
    buffer_load_dwordx4 v191, s[32:35], s57 offen offset:0 lds
    buffer_load_dwordx4 v192, s[32:35], s57 offen offset:1024 lds
    s_load_dword s99, s[24:25], -640
    s_add_u32 m0, s53, s72
    s_nop 0
    buffer_load_dwordx4 v184, s[28:31], s56 offen offset:0 sc1 lds
    buffer_load_dwordx4 v184, s[28:31], s56 offen offset:1024 sc1 lds
    buffer_load_dwordx4 v185, s[28:31], s56 offen offset:2048 sc1 lds
    s_load_dword s99, s[10:11], -576
    buffer_load_dwordx4 v185, s[28:31], s56 offen offset:3072 sc1 lds
    s_add_u32 m0, s53, s73
    s_mov_b32 exec_hi, 0
    buffer_load_dwordx4 v186, s[28:31], s56 offen offset:0 sc1 lds
    s_mov_b32 exec_hi, -1
    s_add_u32 s53, s53, 49152
    s_cmp_ge_u32 s53, 147456
    s_cselect_b32 s53, 0, s53
    s_load_dword s99, s[24:25], -576
    s_movk_i32 s54, 8
M_Q_loop0:
    s_waitcnt vmcnt(11)
    s_barrier
    s_and_b32 s57, s58, 15
    s_lshr_b64 s[58:59], s[58:59], 4
    s_lshl_b32 s56, s57, 11
    s_mul_i32 s57, s57, 0x60000
    s_add_u32 m0, s53, s74
    s_nop 0
    buffer_load_dwordx4 v187, s[32:35], s57 offen offset:0 lds
    buffer_load_dwordx4 v188, s[32:35], s57 offen offset:1024 lds
    s_load_dword s99, s[10:11], 0
    buffer_load_dwordx4 v189, s[32:35], s57 offen offset:2048 lds
    buffer_load_dwordx4 v190, s[32:35], s57 offen offset:3072 lds
    s_add_u32 m0, s53, s75
    s_nop 0
    buffer_load_dwordx4 v191, s[32:35], s57 offen offset:0 lds
    s_load_dword s99, s[24:25], 0
    buffer_load_dwordx4 v192, s[32:35], s57 offen offset:1024 lds
    s_add_u32 m0, s53, s72
    s_nop 0
    buffer_load_dwordx4 v184, s[28:31], s56 offen offset:0 sc1 lds
    s_load_dword s99, s[10:11], 64
    buffer_load_dwordx4 v184, s[28:31], s56 offen offset:1024 sc1 lds
    buffer_load_dwordx4 v185, s[28:31], s56 offen offset:2048 sc1 lds
    buffer_load_dwordx4 v185, s[28:31], s56 offen offset:3072 sc1 lds
    s_load_dword s99, s[24:25], 64
    s_add_u32 m0, s53, s73
    s_mov_b32 exec_hi, 0
    buffer_load_dwordx4 v186, s[28:31], s56 offen offset:0 sc1 lds
    s_mov_b32 exec_hi, -1
    s_add_u32 s53, s53, 49152
    s_cmp_ge_u32 s53, 147456
    s_cselect_b32 s53, 0, s53
    s_add_u32 s10, s10, 128
    s_addc_u32 s11, s11, 0
    s_add_u32 s24, s24, 128
    s_addc_u32 s25, s25, 0
    s_sub_u32 s54, s54, 1
    s_cbranch_scc0 M_Q_loop0
    s_waitcnt vmcnt(11)
    s_barrier
    s_and_b32 s57, s58, 15
    s_lshr_b64 s[58:59], s[58:59], 4
    s_lshl_b32 s56, s57, 11
    s_mul_i32 s57, s57, 0x60000
    s_add_u32 m0, s53, s74
    s_nop 0
    buffer_load_dwordx4 v187, s[32:35], s57 offen offset:0 lds
    buffer_load_dwordx4 v188, s[32:35], s57 offen offset:1024 lds
    buffer_load_dwordx4 v189, s[32:35], s57 offen offset:2048 lds
    buffer_load_dwordx4 v190, s[32:35], s57 offen offset:3072 lds
    s_add_u32 m0, s53, s75
    s_nop 0
    buffer_load_dwordx4 v191, s[32:35], s57 offen offset:0 lds
    buffer_load_dwordx4 v192, s[32:35], s57 offen offset:1024 lds
    s_add_u32 m0, s53, s72
    s_nop 0
    buffer_load_dwordx4 v184, s[28:31], s56 offen offset:0 sc1 lds
    buffer_load_dwordx4 v184, s[28:31], s56 offen offset:1024 sc1 lds
    buffer_load_dwordx4 v185, s[28:31], s56 offen offset:2048 sc1 lds
    buffer_load_dwordx4 v185, s[28:31], s56 offen offset:3072 sc1 lds
    s_add_u32 m0, s53, s73
    s_mov_b32 exec_hi, 0
    buffer_load_dwordx4 v186, s[28:31], s56 offen offset:0 sc1 lds
    s_mov_b32 exec_hi, -1
    s_add_u32 s53, s53, 49152
    s_cmp_ge_u32 s53, 147456
    s_cselect_b32 s53, 0, s53
    s_mov_b32 s64, 0x120000
    buffer_load_dwordx4 v[44:47], v17, s[36:39], s64 offen
    s_mov_b32 s64, 0x180000
    buffer_load_dwordx4 v[48:51], v17, s[36:39], s64 offen
    s_mov_b32 s64, 0x1e0000
    buffer_load_dwordx4 v[52:55], v17, s[36:39], s64 offen
    s_mov_b32 s64, 0x240000
    buffer_load_dwordx4 v[56:59], v17, s[36:39], s64 offen
    s_mov_b32 s64, 0x2a0000
    buffer_load_dwordx4 v[60:63], v17, s[36:39], s64 offen
    s_lshl_b32 s60, s44, 12
    s_add_u32 s61, s60, 147456
    s_add_u32 s53, s60, 49152
    s_lshl_b32 s70, s44, 11
    s_sub_u32 s70, 16384, s70
    s_bfe_u32 s66, s2, 0x30003
    s_lshr_b32 s55, s2, 6
    s_add_u32 s66, s66, s55
    s_and_b32 s66, s66, 3
    s_mov_b32 s58, 0x76453210
    s_mov_b32 s59, 0xfecdba89
    s_cmp_eq_u32 s66, 1
    s_cselect_b32 s58, 0x75643120, s58
    s_cselect_b32 s59, 0xfdecb9a8, s59
    s_cmp_eq_u32 s66, 2
    s_cselect_b32 s58, 0x67542310, s58
    s_cselect_b32 s59, 0xefdcab98, s59
    s_cmp_eq_u32 s66, 3
    s_cselect_b32 s58, 0x86534210, s58
    s_cselect_b32 s59, 0xfedbca97, s59
    s_mov_b32 s32, s8
    s_mov_b32 s33, s9
    s_mov_b32 s34, 0x200000
    s_mov_b32 s35, 0x20000
    s_waitcnt vmcnt(16)
    s_barrier
    s_waitcnt vmcnt(5)
    s_barrier
    s_barrier
    s_and_b32 s57, s58, 15
    s_lshr_b64 s[58:59], s[58:59], 4
    s_lshl_b32 s56, s57, 11
    s_mul_i32 s57, s57, 0x20000
    s_add_u32 m0, s53, s70
    s_nop 0
    buffer_load_dwordx4 v193, s[32:35], s57 offen offset:0 lds
    buffer_load_dwordx4 v194, s[32:35], s57 offen offset:1024 lds
    s_add_u32 s53, s53, 24576
    s_cmp_ge_u32 s53, s61
    s_cselect_b32 s53, s60, s53
    s_and_b32 s57, s58, 15
    s_lshr_b64 s[58:59], s[58:59], 4
    s_lshl_b32 s56, s57, 11
    s_mul_i32 s57, s57, 0x20000
    s_add_u32 m0, s53, s70
    s_nop 0
    buffer_load_dwordx4 v193, s[32:35], s57 offen offset:0 lds
    buffer_load_dwordx4 v194, s[32:35], s57 offen offset:1024 lds
    s_add_u32 s53, s53, 24576
    s_cmp_ge_u32 s53, s61
    s_cselect_b32 s53, s60, s53
    s_and_b32 s57, s58, 15
    s_lshr_b64 s[58:59], s[58:59], 4
    s_lshl_b32 s56, s57, 11
    s_mul_i32 s57, s57, 0x20000
    s_add_u32 m0, s53, s70
    s_nop 0
    buffer_load_dwordx4 v193, s[32:35], s57 offen offset:0 lds
    buffer_load_dwordx4 v194, s[32:35], s57 offen offset:1024 lds
    s_add_u32 s53, s53, 24576
    s_cmp_ge_u32 s53, s61
    s_cselect_b32 s53, s60, s53
    s_and_b32 s57, s58, 15
    s_lshr_b64 s[58:59], s[58:59], 4
    s_lshl_b32 s56, s57, 11
    s_mul_i32 s57, s57, 0x20000
    s_add_u32 m0, s53, s70
    s_nop 0
    buffer_load_dwordx4 v193, s[32:35], s57 offen offset:0 lds
    buffer_load_dwordx4 v194, s[32:35], s57 offen offset:1024 lds
    s_add_u32 s53, s53, 24576
    s_cmp_ge_u32 s53, s61
    s_cselect_b32 s53, s60, s53
    s_and_b32 s57, s58, 15
    s_lshr_b64 s[58:59], s[58:59], 4
    s_lshl_b32 s56, s57, 11
    s_mul_i32 s57, s57, 0x20000
    s_add_u32 m0, s53, s70
    s_nop 0
    buffer_load_dwordx4 v193, s[32:35], s57 offen offset:0 lds
    buffer_load_dwordx4 v194, s[32:35], s57 offen offset:1024 lds
    s_add_u32 s53, s53, 24576
    s_cmp_ge_u32 s53, s61
    s_cselect_b32 s53, s60, s53
    s_and_b32 s57, s58, 15
    s_lshr_b64 s[58:59], s[58:59], 4
    s_lshl_b32 s56, s57, 11
    s_mul_i32 s57, s57, 0x20000
    s_add_u32 m0, s53, s70
    s_nop 0
    buffer_load_dwordx4 v193, s[32:35], s57 offen offset:0 lds
    buffer_load_dwordx4 v194, s[32:35], s57 offen offset:1024 lds
    s_add_u32 s53, s53, 24576
    s_cmp_ge_u32 s53, s61
    s_cselect_b32 s53, s60, s53
    s_mov_b32 s40, s8
    s_mov_b32 s41, s9
    s_mov_b32 s42, 0x200000
    s_mov_b32 s43, 0x20000
    s_mov_b32 s64, 0x0
    buffer_load_dword v244, v243, s[40:43], s64 offen
    v_lshlrev_b32 v24, 16, v24
    v_lshlrev_b32 v25, 16, v25
    v_lshlrev_b32 v26, 16, v26
    v_lshlrev_b32 v27, 16, v27
    v_lshlrev_b32 v28, 16, v28
    v_lshlrev_b32 v29, 16, v29
    v_lshlrev_b32 v30, 16, v30
    v_lshlrev_b32 v31, 16, v31
    v_mul_f32 v72, 0xbfb8aa3b, v24
    v_mul_f32 v73, 0xbfb8aa3b, v25
    v_mul_f32 v74, 0xbfb8aa3b, v26
    v_mul_f32 v75, 0xbfb8aa3b, v27
    v_mul_f32 v76, 0xbfb8aa3b, v28
    v_mul_f32 v77, 0xbfb8aa3b, v29
    v_mul_f32 v78, 0xbfb8aa3b, v30
    v_mul_f32 v79, 0xbfb8aa3b, v31
    v_exp_f32 v72, v72
    v_exp_f32 v73, v73
    v_exp_f32 v74, v74
    v_exp_f32 v75, v75
    v_exp_f32 v76, v76
    v_exp_f32 v77, v77
    v_exp_f32 v78, v78
    v_exp_f32 v79, v79
    v_add_f32 v72, 1.0, v72
    v_add_f32 v73, 1.0, v73
    v_add_f32 v74, 1.0, v74
    v_add_f32 v75, 1.0, v75
    v_add_f32 v76, 1.0, v76
    v_add_f32 v77, 1.0, v77
    v_add_f32 v78, 1.0, v78
    v_add_f32 v79, 1.0, v79
    v_rcp_f32 v72, v72
    v_rcp_f32 v73, v73
    v_rcp_f32 v74, v74
    v_rcp_f32 v75, v75
    v_rcp_f32 v76, v76
    v_rcp_f32 v77, v77
    v_rcp_f32 v78, v78
    v_rcp_f32 v79, v79
    v_mul_f32 v24, v24, v72
    v_mul_f32 v25, v25, v73
    v_mul_f32 v26, v26, v74
    v_mul_f32 v27, v27, v75
    v_mul_f32 v28, v28, v76
    v_mul_f32 v29, v29, v77
    v_mul_f32 v30, v30, v78
    v_mul_f32 v31, v31, v79
    v_cvt_pk_bf16_f32 v72, v24, v24
    v_lshlrev_b32 v24, 16, v72
    v_cvt_pk_bf16_f32 v73, v25, v25
    v_lshlrev_b32 v25, 16, v73
    v_cvt_pk_bf16_f32 v74, v26, v26
    v_lshlrev_b32 v26, 16, v74
    v_cvt_pk_bf16_f32 v75, v27, v27
    v_lshlrev_b32 v27, 16, v75
    v_cvt_pk_bf16_f32 v76, v28, v28
    v_lshlrev_b32 v28, 16, v76
    v_cvt_pk_bf16_f32 v77, v29, v29
    v_lshlrev_b32 v29, 16, v77
    v_cvt_pk_bf16_f32 v78, v30, v30
    v_lshlrev_b32 v30, 16, v78
    v_cvt_pk_bf16_f32 v79, v31, v31
    v_lshlrev_b32 v31, 16, v79
    v_lshlrev_b32 v72, 16, v32
    v_and_b32 v73, 0xffff0000, v32
    v_lshlrev_b32 v74, 16, v33
    v_and_b32 v75, 0xffff0000, v33
    v_lshlrev_b32 v76, 16, v34
    v_and_b32 v77, 0xffff0000, v34
    v_lshlrev_b32 v78, 16, v35
    v_and_b32 v79, 0xffff0000, v35
    v_mul_f32 v64, v24, v72
    v_mul_f32 v65, v24, v73
    v_mul_f32 v66, v24, v74
    v_mul_f32 v67, v24, v75
    v_mul_f32 v68, v24, v76
    v_mul_f32 v69, v24, v77
    v_mul_f32 v70, v24, v78
    v_mul_f32 v71, v24, v79
    v_lshlrev_b32 v72, 16, v36
    v_and_b32 v73, 0xffff0000, v36
    v_lshlrev_b32 v74, 16, v37
    v_and_b32 v75, 0xffff0000, v37
    v_lshlrev_b32 v76, 16, v38
    v_and_b32 v77, 0xffff0000, v38
    v_lshlrev_b32 v78, 16, v39
    v_and_b32 v79, 0xffff0000, v39
    v_fmac_f32 v64, v25, v72
    v_fmac_f32 v65, v25, v73
    v_fmac_f32 v66, v25, v74
    v_fmac_f32 v67, v25, v75
    v_fmac_f32 v68, v25, v76
    v_fmac_f32 v69, v25, v77
    v_fmac_f32 v70, v25, v78
    v_fmac_f32 v71, v25, v79
    v_lshlrev_b32 v72, 16, v40
    v_and_b32 v73, 0xffff0000, v40
    v_lshlrev_b32 v74, 16, v41
    v_and_b32 v75, 0xffff0000, v41
    v_lshlrev_b32 v76, 16, v42
    v_and_b32 v77, 0xffff0000, v42
    v_lshlrev_b32 v78, 16, v43
    v_and_b32 v79, 0xffff0000, v43
    v_fmac_f32 v64, v26, v72
    v_fmac_f32 v65, v26, v73
    v_fmac_f32 v66, v26, v74
    v_fmac_f32 v67, v26, v75
    v_fmac_f32 v68, v26, v76
    v_fmac_f32 v69, v26, v77
    v_fmac_f32 v70, v26, v78
    v_fmac_f32 v71, v26, v79
    s_waitcnt vmcnt(17)
    v_lshlrev_b32 v72, 16, v44
    v_and_b32 v73, 0xffff0000, v44
    v_lshlrev_b32 v74, 16, v45
    v_and_b32 v75, 0xffff0000, v45
    v_lshlrev_b32 v76, 16, v46
    v_and_b32 v77, 0xffff0000, v46
    v_lshlrev_b32 v78, 16, v47
    v_and_b32 v79, 0xffff0000, v47
    v_fmac_f32 v64, v27, v72
    v_fmac_f32 v65, v27, v73
    v_fmac_f32 v66, v27, v74
    v_fmac_f32 v67, v27, v75
    v_fmac_f32 v68, v27, v76
    v_fmac_f32 v69, v27, v77
    v_fmac_f32 v70, v27, v78
    v_fmac_f32 v71, v27, v79
    s_waitcnt vmcnt(16)
    v_lshlrev_b32 v72, 16, v48
    v_and_b32 v73, 0xffff0000, v48
    v_lshlrev_b32 v74, 16, v49
    v_and_b32 v75, 0xffff0000, v49
    v_lshlrev_b32 v76, 16, v50
    v_and_b32 v77, 0xffff0000, v50
    v_lshlrev_b32 v78, 16, v51
    v_and_b32 v79, 0xffff0000, v51
    v_fmac_f32 v64, v28, v72
    v_fmac_f32 v65, v28, v73
    v_fmac_f32 v66, v28, v74
    v_fmac_f32 v67, v28, v75
    v_fmac_f32 v68, v28, v76
    v_fmac_f32 v69, v28, v77
    v_fmac_f32 v70, v28, v78
    v_fmac_f32 v71, v28, v79
    s_waitcnt vmcnt(15)
    v_lshlrev_b32 v72, 16, v52
    v_and_b32 v73, 0xffff0000, v52
    v_lshlrev_b32 v74, 16, v53
    v_and_b32 v75, 0xffff0000, v53
    v_lshlrev_b32 v76, 16, v54
    v_and_b32 v77, 0xffff0000, v54
    v_lshlrev_b32 v78, 16, v55
    v_and_b32 v79, 0xffff0000, v55
    v_fmac_f32 v64, v29, v72
    v_fmac_f32 v65, v29, v73
    v_fmac_f32 v66, v29, v74
    v_fmac_f32 v67, v29, v75
    v_fmac_f32 v68, v29, v76
    v_fmac_f32 v69, v29, v77
    v_fmac_f32 v70, v29, v78
    v_fmac_f32 v71, v29, v79
    s_waitcnt vmcnt(14)
    v_lshlrev_b32 v72, 16, v56
    v_and_b32 v73, 0xffff0000, v56
    v_lshlrev_b32 v74, 16, v57
    v_and_b32 v75, 0xffff0000, v57
    v_lshlrev_b32 v76, 16, v58
    v_and_b32 v77, 0xffff0000, v58
    v_lshlrev_b32 v78, 16, v59
    v_and_b32 v79, 0xffff0000, v59
    v_fmac_f32 v64, v30, v72
    v_fmac_f32 v65, v30, v73
    v_fmac_f32 v66, v30, v74
    v_fmac_f32 v67, v30, v75
    v_fmac_f32 v68, v30, v76
    v_fmac_f32 v69, v30, v77
    v_fmac_f32 v70, v30, v78
    v_fmac_f32 v71, v30, v79
    s_waitcnt vmcnt(13)
    v_lshlrev_b32 v72, 16, v60
    v_and_b32 v73, 0xffff0000, v60
    v_lshlrev_b32 v74, 16, v61
    v_and_b32 v75, 0xffff0000, v61
    v_lshlrev_b32 v76, 16, v62
    v_and_b32 v77, 0xffff0000, v62
    v_lshlrev_b32 v78, 16, v63
    v_and_b32 v79, 0xffff0000, v63
    v_fmac_f32 v64, v31, v72
    v_fmac_f32 v65, v31, v73
    v_fmac_f32 v66, v31, v74
    v_fmac_f32 v67, v31, v75
    v_fmac_f32 v68, v31, v76
    v_fmac_f32 v69, v31, v77
    v_fmac_f32 v70, v31, v78
    v_fmac_f32 v71, v31, v79
    v_add_f32_dpp v64, v64, v64 row_ror:8 row_mask:0xf bank_mask:0xf
    v_add_f32_dpp v65, v65, v65 row_ror:8 row_mask:0xf bank_mask:0xf
    v_add_f32_dpp v66, v66, v66 row_ror:8 row_mask:0xf bank_mask:0xf
    v_add_f32_dpp v67, v67, v67 row_ror:8 row_mask:0xf bank_mask:0xf
    v_add_f32_dpp v68, v68, v68 row_ror:8 row_mask:0xf bank_mask:0xf
    v_add_f32_dpp v69, v69, v69 row_ror:8 row_mask:0xf bank_mask:0xf
    v_add_f32_dpp v70, v70, v70 row_ror:8 row_mask:0xf bank_mask:0xf
    v_add_f32_dpp v71, v71, v71 row_ror:8 row_mask:0xf bank_mask:0xf
    v_mov_b32 v72, v64
    v_mov_b32 v73, v65
    v_mov_b32 v74, v66
    v_mov_b32 v75, v67
    v_mov_b32 v76, v68
    v_mov_b32 v77, v69
    v_mov_b32 v78, v70
    v_mov_b32 v79, v71
    v_permlane32_swap_b32 v64, v72
    v_permlane32_swap_b32 v65, v73
    v_permlane32_swap_b32 v66, v74
    v_permlane32_swap_b32 v67, v75
    v_permlane32_swap_b32 v68, v76
    v_permlane32_swap_b32 v69, v77
    v_permlane32_swap_b32 v70, v78
    v_permlane32_swap_b32 v71, v79
    v_add_f32 v64, v64, v72
    v_add_f32 v65, v65, v73
    v_add_f32 v66, v66, v74
    v_add_f32 v67, v67, v75
    v_add_f32 v68, v68, v76
    v_add_f32 v69, v69, v77
    v_add_f32 v70, v70, v78
    v_add_f32 v71, v71, v79
    v_mov_b32 v72, v64
    v_mov_b32 v73, v65
    v_mov_b32 v74, v66
    v_mov_b32 v75, v67
    v_mov_b32 v76, v68
    v_mov_b32 v77, v69
    v_mov_b32 v78, v70
    v_mov_b32 v79, v71
    v_permlane16_swap_b32 v64, v72
    v_permlane16_swap_b32 v65, v73
    v_permlane16_swap_b32 v66, v74
    v_permlane16_swap_b32 v67, v75
    v_permlane16_swap_b32 v68, v76
    v_permlane16_swap_b32 v69, v77
    v_permlane16_swap_b32 v70, v78
    v_permlane16_swap_b32 v71, v79
    v_add_f32 v64, v64, v72
    v_add_f32 v65, v65, v73
    v_add_f32 v66, v66, v74
    v_add_f32 v67, v67, v75
    v_add_f32 v68, v68, v76
    v_add_f32 v69, v69, v77
    v_add_f32 v70, v70, v78
    v_add_f32 v71, v71, v79
    s_lshl_b32 s64, s44, 8
    s_add_u32 s64, s64, 147456
    v_and_b32 v72, 7, v0
    v_lshl_add_u32 v72, v72, 5, s64
    ds_write_b128 v72, v[64:67]
    ds_write_b128 v72, v[68:71] offset:16
    v_mov_b32 v73, 148480
    v_mov_b32 v74, 1
    s_waitcnt lgkmcnt(0)
    s_mov_b64 exec, 1
    ds_add_rtn_u32 v75, v73, v74
    s_mov_b64 exec, -1
    v_add_u32 v73, 147456, v234
    s_waitcnt lgkmcnt(0)
    ds_read_b32 v64, v73 offset:0
    ds_read_b32 v65, v73 offset:256
    ds_read_b32 v66, v73 offset:512
    ds_read_b32 v67, v73 offset:768
    v_readfirstlane_b32 s64, v75
    s_nop 3
    s_cmp_eq_u32 s64, 3
    s_cselect_b32 s80, s80, 0x80000000
    v_lshl_add_u32 v72, v1, 3, s80
    s_waitcnt lgkmcnt(0)
    v_add_f32 v64, v64, v65
    v_add_f32 v66, v66, v67
    v_add_f32 v64, v64, v66
    v_mov_b32 v65, s0
    buffer_store_dwordx2 v[64:65], v72, s[28:31], 0 offen sc1
    s_mov_b32 s40, s4
    s_mov_b32 s41, s5
    s_mov_b32 s42, 0x400000
    s_mov_b32 s43, 0x20000
    s_mov_b32 s64, 0x8000
    buffer_load_dwordx4 v[88:91], v196, s[40:43], 0 offen offset:0
    buffer_load_dwordx4 v[92:95], v196, s[40:43], 0 offen offset:64
    buffer_load_dwordx4 v[96:99], v196, s[40:43], s64 offen offset:0
    buffer_load_dwordx4 v[100:103], v196, s[40:43], s64 offen offset:64
    s_lshl_b32 s60, s44, 12
    s_add_u32 s61, s60, 147456
    s_add_u32 s53, s60, 0
    s_bfe_u32 s66, s2, 0x30003
    s_lshr_b32 s55, s2, 6
    s_add_u32 s66, s66, s55
    s_and_b32 s66, s66, 3
    s_mov_b32 s58, 0x76453210
    s_mov_b32 s59, 0xfecdba89
    s_cmp_eq_u32 s66, 1
    s_cselect_b32 s58, 0x75643120, s58
    s_cselect_b32 s59, 0xfdecb9a8, s59
    s_cmp_eq_u32 s66, 2
    s_cselect_b32 s58, 0x67542310, s58
    s_cselect_b32 s59, 0xefdcab98, s59
    s_cmp_eq_u32 s66, 3
    s_cselect_b32 s58, 0x86534210, s58
    s_cselect_b32 s59, 0xfedbca97, s59
    s_and_b32 s66, s48, 15
    s_lshl_b32 s55, s66, 2
    s_lshr_b64 s[56:57], s[58:59], s55
    s_and_b32 s55, s56, 15
    s_lshl_b32 s55, s55, 2
    s_lshl_b64 s[56:57], 15, s55
    s_andn2_b64 s[58:59], s[58:59], s[56:57]
    s_or_b32 s58, s58, s66
    s_mov_b32 s32, s12
    s_mov_b32 s33, s13
    s_mov_b32 s34, 0x700000
    s_mov_b32 s35, 0x20000
    s_mov_b32 s36, s14
    s_mov_b32 s37, s15
    s_mov_b32 s38, 0x700000
    s_mov_b32 s39, 0x20000
    s_mov_b32 s72, 0xb00000
    s_mov_b32 s74, 0x1000000
    s_mov_b32 s73, 0xb08000
    s_mov_b32 s75, 0x1008000
    s_lshl_b32 s76, s48, 8
    s_waitcnt vmcnt(0)
    v_permlane16_swap_b32 v88, v90
    v_permlane16_swap_b32 v89, v91
    v_permlane16_swap_b32 v92, v94
    v_permlane16_swap_b32 v93, v95
    v_permlane16_swap_b32 v96, v98
    v_permlane16_swap_b32 v97, v99
    v_permlane16_swap_b32 v100, v102
    v_permlane16_swap_b32 v101, v103
    v_lshlrev_b32 v104, 16, v88
    v_and_b32 v105, 0xffff0000, v88
    v_lshlrev_b32 v106, 16, v89
    v_and_b32 v107, 0xffff0000, v89
    v_lshlrev_b32 v108, 16, v90
    v_and_b32 v109, 0xffff0000, v90
    v_lshlrev_b32 v110, 16, v91
    v_and_b32 v111, 0xffff0000, v91
    v_lshlrev_b32 v112, 16, v92
    v_and_b32 v113, 0xffff0000, v92
    v_lshlrev_b32 v114, 16, v93
    v_and_b32 v115, 0xffff0000, v93
    v_lshlrev_b32 v116, 16, v94
    v_and_b32 v117, 0xffff0000, v94
    v_lshlrev_b32 v118, 16, v95
    v_and_b32 v119, 0xffff0000, v95
    v_lshlrev_b32 v120, 16, v96
    v_and_b32 v121, 0xffff0000, v96
    v_lshlrev_b32 v122, 16, v97
    v_and_b32 v123, 0xffff0000, v97
    v_lshlrev_b32 v124, 16, v98
    v_and_b32 v125, 0xffff0000, v98
    v_lshlrev_b32 v126, 16, v99
    v_and_b32 v127, 0xffff0000, v99
    v_lshlrev_b32 v128, 16, v100
    v_and_b32 v129, 0xffff0000, v100
    v_lshlrev_b32 v130, 16, v101
    v_and_b32 v131, 0xffff0000, v101
    v_lshlrev_b32 v132, 16, v102
    v_and_b32 v133, 0xffff0000, v102
    v_lshlrev_b32 v134, 16, v103
    v_and_b32 v135, 0xffff0000, v103
    s_setprio 2
    s_barrier
    s_barrier
    ds_read_b128 v[40:43], v232 offset:0
    ds_read_b64_tr_b16 v[48:49], v235 offset:0
    ds_read_b64_tr_b16 v[50:51], v235 offset:2048
    ds_read_b64_tr_b16 v[52:53], v236 offset:0
    ds_read_b64_tr_b16 v[54:55], v236 offset:2048
    ds_read_b64_tr_b16 v[56:57], v237 offset:0
    ds_read_b64_tr_b16 v[58:59], v237 offset:2048
    ds_read_b64_tr_b16 v[60:61], v238 offset:0
    ds_read_b64_tr_b16 v[62:63], v238 offset:2048
    ds_read_b128 v[44:47], v232 offset:2048
    s_add_u32 s52, s52, 24576
    s_cmp_ge_u32 s52, 147456
    s_cselect_b32 s52, 0, s52
    s_waitcnt lgkmcnt(0)
    v_mfma_f32_16x16x32_bf16 v[8:11], v[48:51], v[40:43], 0
    ds_read_b128 v[64:67], v232 offset:1024
    ds_read_b64_tr_b16 v[72:73], v235 offset:4096
    v_mfma_f32_16x16x32_bf16 v[12:15], v[52:55], v[40:43], 0
    ds_read_b64_tr_b16 v[74:75], v235 offset:6144
    ds_read_b64_tr_b16 v[76:77], v236 offset:4096
    v_mfma_f32_16x16x32_bf16 v[16:19], v[56:59], v[40:43], 0
    ds_read_b64_tr_b16 v[78:79], v236 offset:6144
    ds_read_b64_tr_b16 v[80:81], v237 offset:4096
    v_mfma_f32_16x16x32_bf16 v[20:23], v[60:63], v[40:43], 0
    ds_read_b64_tr_b16 v[82:83], v237 offset:6144
    ds_read_b64_tr_b16 v[84:85], v238 offset:4096
    v_mfma_f32_16x16x32_bf16 v[24:27], v[48:51], v[44:47], 0
    ds_read_b64_tr_b16 v[86:87], v238 offset:6144
    ds_read_b128 v[68:71], v232 offset:3072
    v_mfma_f32_16x16x32_bf16 v[28:31], v[52:55], v[44:47], 0
    v_add_u32 v232, s52, v233
    v_add_u32 v235, s52, v239
    v_mfma_f32_16x16x32_bf16 v[32:35], v[56:59], v[44:47], 0
    v_add_u32 v236, s52, v240
    v_add_u32 v237, s52, v241
    v_mfma_f32_16x16x32_bf16 v[36:39], v[60:63], v[44:47], 0
    v_add_u32 v238, s52, v242
    s_waitcnt lgkmcnt(0)
    v_mfma_f32_16x16x32_bf16 v[8:11], v[72:75], v[64:67], v[8:11]
    s_barrier
    v_mfma_f32_16x16x32_bf16 v[12:15], v[76:79], v[64:67], v[12:15]
    ds_read_b128 v[40:43], v232 offset:0
    ds_read_b64_tr_b16 v[48:49], v235 offset:0
    ds_read_b64_tr_b16 v[50:51], v235 offset:2048
    v_mfma_f32_16x16x32_bf16 v[16:19], v[80:83], v[64:67], v[16:19]
    ds_read_b64_tr_b16 v[52:53], v236 offset:0
    ds_read_b64_tr_b16 v[54:55], v236 offset:2048
    v_mfma_f32_16x16x32_bf16 v[20:23], v[84:87], v[64:67], v[20:23]
    ds_read_b64_tr_b16 v[56:57], v237 offset:0
    ds_read_b64_tr_b16 v[58:59], v237 offset:2048
    ds_read_b64_tr_b16 v[60:61], v238 offset:0
    v_mfma_f32_16x16x32_bf16 v[24:27], v[72:75], v[68:71], v[24:27]
    ds_read_b64_tr_b16 v[62:63], v238 offset:2048
    ds_read_b128 v[44:47], v232 offset:2048
    v_mfma_f32_16x16x32_bf16 v[28:31], v[76:79], v[68:71], v[28:31]
    v_mfma_f32_16x16x32_bf16 v[32:35], v[80:83], v[68:71], v[32:35]
    s_add_u32 s52, s52, 24576
    s_cmp_ge_u32 s52, 147456
    s_cselect_b32 s52, 0, s52
    v_mfma_f32_16x16x32_bf16 v[36:39], v[84:87], v[68:71], v[36:39]
    s_waitcnt lgkmcnt(0)
    v_mfma_f32_16x16x32_bf16 v[8:11], v[48:51], v[40:43], v[8:11]
    ds_read_b128 v[64:67], v232 offset:1024
    ds_read_b64_tr_b16 v[72:73], v235 offset:4096
    v_mfma_f32_16x16x32_bf16 v[12:15], v[52:55], v[40:43], v[12:15]
    ds_read_b64_tr_b16 v[74:75], v235 offset:6144
    ds_read_b64_tr_b16 v[76:77], v236 offset:4096
    v_mfma_f32_16x16x32_bf16 v[16:19], v[56:59], v[40:43], v[16:19]
    ds_read_b64_tr_b16 v[78:79], v236 offset:6144
    ds_read_b64_tr_b16 v[80:81], v237 offset:4096
    v_mfma_f32_16x16x32_bf16 v[20:23], v[60:63], v[40:43], v[20:23]
    ds_read_b64_tr_b16 v[82:83], v237 offset:6144
    ds_read_b64_tr_b16 v[84:85], v238 offset:4096
    v_mfma_f32_16x16x32_bf16 v[24:27], v[48:51], v[44:47], v[24:27]
    s_movk_i32 s54, 10
M_Q_loop1:
    ds_read_b64_tr_b16 v[86:87], v238 offset:6144
    ds_read_b128 v[68:71], v232 offset:3072
    v_mfma_f32_16x16x32_bf16 v[28:31], v[52:55], v[44:47], v[28:31]
    v_add_u32 v232, s52, v233
    v_add_u32 v235, s52, v239
    v_mfma_f32_16x16x32_bf16 v[32:35], v[56:59], v[44:47], v[32:35]
    v_add_u32 v236, s52, v240
    v_add_u32 v237, s52, v241
    v_mfma_f32_16x16x32_bf16 v[36:39], v[60:63], v[44:47], v[36:39]
    v_add_u32 v238, s52, v242
    s_waitcnt lgkmcnt(0)
    v_mfma_f32_16x16x32_bf16 v[8:11], v[72:75], v[64:67], v[8:11]
    s_barrier
    v_mfma_f32_16x16x32_bf16 v[12:15], v[76:79], v[64:67], v[12:15]
    ds_read_b128 v[40:43], v232 offset:0
    ds_read_b64_tr_b16 v[48:49], v235 offset:0
    ds_read_b64_tr_b16 v[50:51], v235 offset:2048
    v_mfma_f32_16x16x32_bf16 v[16:19], v[80:83], v[64:67], v[16:19]
    ds_read_b64_tr_b16 v[52:53], v236 offset:0
    ds_read_b64_tr_b16 v[54:55], v236 offset:2048
    v_mfma_f32_16x16x32_bf16 v[20:23], v[84:87], v[64:67], v[20:23]
    ds_read_b64_tr_b16 v[56:57], v237 offset:0
    ds_read_b64_tr_b16 v[58:59], v237 offset:2048
    ds_read_b64_tr_b16 v[60:61], v238 offset:0
    v_mfma_f32_16x16x32_bf16 v[24:27], v[72:75], v[68:71], v[24:27]
    ds_read_b64_tr_b16 v[62:63], v238 offset:2048
    ds_read_b128 v[44:47], v232 offset:2048
    v_mfma_f32_16x16x32_bf16 v[28:31], v[76:79], v[68:71], v[28:31]
    v_mfma_f32_16x16x32_bf16 v[32:35], v[80:83], v[68:71], v[32:35]
    s_add_u32 s52, s52, 24576
    s_cmp_ge_u32 s52, 147456
    s_cselect_b32 s52, 0, s52
    v_mfma_f32_16x16x32_bf16 v[36:39], v[84:87], v[68:71], v[36:39]
    s_waitcnt lgkmcnt(0)
    v_mfma_f32_16x16x32_bf16 v[8:11], v[48:51], v[40:43], v[8:11]
    ds_read_b128 v[64:67], v232 offset:1024
    ds_read_b64_tr_b16 v[72:73], v235 offset:4096
    v_mfma_f32_16x16x32_bf16 v[12:15], v[52:55], v[40:43], v[12:15]
    ds_read_b64_tr_b16 v[74:75], v235 offset:6144
    ds_read_b64_tr_b16 v[76:77], v236 offset:4096
    v_mfma_f32_16x16x32_bf16 v[16:19], v[56:59], v[40:43], v[16:19]
    ds_read_b64_tr_b16 v[78:79], v236 offset:6144
    ds_read_b64_tr_b16 v[80:81], v237 offset:4096
    v_mfma_f32_16x16x32_bf16 v[20:23], v[60:63], v[40:43], v[20:23]
    s_sub_u32 s54, s54, 1
    ds_read_b64_tr_b16 v[82:83], v237 offset:6144
    ds_read_b64_tr_b16 v[84:85], v238 offset:4096
    v_mfma_f32_16x16x32_bf16 v[24:27], v[48:51], v[44:47], v[24:27]
    s_cbranch_scc0 M_Q_loop1
    ds_read_b64_tr_b16 v[86:87], v238 offset:6144
    ds_read_b128 v[68:71], v232 offset:3072
    v_mfma_f32_16x16x32_bf16 v[28:31], v[52:55], v[44:47], v[28:31]
    v_add_u32 v232, s52, v233
    v_add_u32 v235, s52, v239
    v_mfma_f32_16x16x32_bf16 v[32:35], v[56:59], v[44:47], v[32:35]
    v_add_u32 v236, s52, v240
    v_add_u32 v237, s52, v241
    v_mfma_f32_16x16x32_bf16 v[36:39], v[60:63], v[44:47], v[36:39]
    v_add_u32 v238, s52, v242
    s_waitcnt lgkmcnt(0)
    v_mfma_f32_16x16x32_bf16 v[8:11], v[72:75], v[64:67], v[8:11]
    s_barrier
    v_mfma_f32_16x16x32_bf16 v[12:15], v[76:79], v[64:67], v[12:15]
    ds_read_b128 v[40:43], v232 offset:0
    ds_read_b64_tr_b16 v[48:49], v235 offset:0
    ds_read_b64_tr_b16 v[50:51], v235 offset:2048
    v_mfma_f32_16x16x32_bf16 v[16:19], v[80:83], v[64:67], v[16:19]
    ds_read_b64_tr_b16 v[52:53], v236 offset:0
    ds_read_b64_tr_b16 v[54:55], v236 offset:2048
    v_mfma_f32_16x16x32_bf16 v[20:23], v[84:87], v[64:67], v[20:23]
    ds_read_b64_tr_b16 v[56:57], v237 offset:0
    ds_read_b64_tr_b16 v[58:59], v237 offset:2048
    ds_read_b64_tr_b16 v[60:61], v238 offset:0
    v_mfma_f32_16x16x32_bf16 v[24:27], v[72:75], v[68:71], v[24:27]
    ds_read_b64_tr_b16 v[62:63], v238 offset:2048
    ds_read_b128 v[44:47], v232 offset:2048
    v_mfma_f32_16x16x32_bf16 v[28:31], v[76:79], v[68:71], v[28:31]
    v_mfma_f32_16x16x32_bf16 v[32:35], v[80:83], v[68:71], v[32:35]
    s_add_u32 s52, s52, 24576
    s_cmp_ge_u32 s52, 147456
    s_cselect_b32 s52, 0, s52
    v_mfma_f32_16x16x32_bf16 v[36:39], v[84:87], v[68:71], v[36:39]
    s_waitcnt lgkmcnt(0)
    v_mfma_f32_16x16x32_bf16 v[8:11], v[48:51], v[40:43], v[8:11]
    ds_read_b128 v[64:67], v232 offset:1024
    ds_read_b64_tr_b16 v[72:73], v235 offset:4096
    v_mfma_f32_16x16x32_bf16 v[12:15], v[52:55], v[40:43], v[12:15]
    ds_read_b64_tr_b16 v[74:75], v235 offset:6144
    ds_read_b64_tr_b16 v[76:77], v236 offset:4096
    ds_read_b128 v[136:139], v199 offset:0
    v_mfma_f32_16x16x32_bf16 v[16:19], v[56:59], v[40:43], v[16:19]
    ds_read_b64_tr_b16 v[78:79], v236 offset:6144
    ds_read_b64_tr_b16 v[80:81], v237 offset:4096
    ds_read_b128 v[140:143], v199 offset:64
    v_mfma_f32_16x16x32_bf16 v[20:23], v[60:63], v[40:43], v[20:23]
    ds_read_b64_tr_b16 v[82:83], v237 offset:6144
    ds_read_b64_tr_b16 v[84:85], v238 offset:4096
    v_mfma_f32_16x16x32_bf16 v[24:27], v[48:51], v[44:47], v[24:27]
    ds_read_b64_tr_b16 v[86:87], v238 offset:6144
    ds_read_b128 v[68:71], v232 offset:3072
    ds_read_b128 v[144:147], v199 offset:128
    v_mfma_f32_16x16x32_bf16 v[28:31], v[52:55], v[44:47], v[28:31]
    v_add_u32 v232, s52, v233
    v_add_u32 v235, s52, v239
    v_mfma_f32_16x16x32_bf16 v[32:35], v[56:59], v[44:47], v[32:35]
    v_add_u32 v236, s52, v240
    v_add_u32 v237, s52, v241
    ds_read_b128 v[148:151], v199 offset:192
    v_mfma_f32_16x16x32_bf16 v[36:39], v[60:63], v[44:47], v[36:39]
    v_add_u32 v238, s52, v242
    s_waitcnt lgkmcnt(0)
    v_mfma_f32_16x16x32_bf16 v[8:11], v[72:75], v[64:67], v[8:11]
    s_barrier
    v_mfma_f32_16x16x32_bf16 v[12:15], v[76:79], v[64:67], v[12:15]
    ds_read_b128 v[40:43], v232 offset:0
    ds_read_b64_tr_b16 v[48:49], v235 offset:0
    ds_read_b64_tr_b16 v[50:51], v235 offset:2048
    ds_read_b128 v[152:155], v199 offset:256
    v_mfma_f32_16x16x32_bf16 v[16:19], v[80:83], v[64:67], v[16:19]
    ds_read_b64_tr_b16 v[52:53], v236 offset:0
    ds_read_b64_tr_b16 v[54:55], v236 offset:2048
    ds_read_b128 v[156:159], v199 offset:320
    v_mfma_f32_16x16x32_bf16 v[20:23], v[84:87], v[64:67], v[20:23]
    ds_read_b64_tr_b16 v[56:57], v237 offset:0
    ds_read_b64_tr_b16 v[58:59], v237 offset:2048
    ds_read_b64_tr_b16 v[60:61], v238 offset:0
    v_mfma_f32_16x16x32_bf16 v[24:27], v[72:75], v[68:71], v[24:27]
    ds_read_b64_tr_b16 v[62:63], v238 offset:2048
    ds_read_b128 v[44:47], v232 offset:2048
    ds_read_b128 v[160:163], v199 offset:384
    v_mfma_f32_16x16x32_bf16 v[28:31], v[76:79], v[68:71], v[28:31]
    v_mfma_f32_16x16x32_bf16 v[32:35], v[80:83], v[68:71], v[32:35]
    s_add_u32 s52, s52, 24576
    s_cmp_ge_u32 s52, 147456
    s_cselect_b32 s52, 0, s52
    ds_read_b128 v[164:167], v199 offset:448
    v_mfma_f32_16x16x32_bf16 v[36:39], v[84:87], v[68:71], v[36:39]
    s_waitcnt lgkmcnt(0)
    v_mfma_f32_16x16x32_bf16 v[8:11], v[48:51], v[40:43], v[8:11]
    ds_read_b128 v[64:67], v232 offset:1024
    ds_read_b64_tr_b16 v[72:73], v235 offset:4096
    v_mfma_f32_16x16x32_bf16 v[12:15], v[52:55], v[40:43], v[12:15]
    ds_read_b64_tr_b16 v[74:75], v235 offset:6144
    ds_read_b64_tr_b16 v[76:77], v236 offset:4096
    ds_read_b128 v[168:171], v199 offset:512
    v_mfma_f32_16x16x32_bf16 v[16:19], v[56:59], v[40:43], v[16:19]
    ds_read_b64_tr_b16 v[78:79], v236 offset:6144
    ds_read_b64_tr_b16 v[80:81], v237 offset:4096
    ds_read_b128 v[172:175], v199 offset:576
    v_mfma_f32_16x16x32_bf16 v[20:23], v[60:63], v[40:43], v[20:23]
    ds_read_b64_tr_b16 v[82:83], v237 offset:6144
    ds_read_b64_tr_b16 v[84:85], v238 offset:4096
    v_mfma_f32_16x16x32_bf16 v[24:27], v[48:51], v[44:47], v[24:27]
    ds_read_b64_tr_b16 v[86:87], v238 offset:6144
    ds_read_b128 v[68:71], v232 offset:3072
    ds_read_b128 v[176:179], v199 offset:640
    v_mfma_f32_16x16x32_bf16 v[28:31], v[52:55], v[44:47], v[28:31]
    v_add_u32 v232, s52, v233
    v_add_u32 v235, s52, v239
    v_mfma_f32_16x16x32_bf16 v[32:35], v[56:59], v[44:47], v[32:35]
    v_add_u32 v236, s52, v240
    v_add_u32 v237, s52, v241
    ds_read_b128 v[180:183], v199 offset:704
    v_mfma_f32_16x16x32_bf16 v[36:39], v[60:63], v[44:47], v[36:39]
    v_add_u32 v238, s52, v242
    s_waitcnt lgkmcnt(0)
    v_mfma_f32_16x16x32_bf16 v[8:11], v[72:75], v[64:67], v[8:11]
    s_barrier
    v_mfma_f32_16x16x32_bf16 v[12:15], v[76:79], v[64:67], v[12:15]
    ds_read_b128 v[40:43], v232 offset:0
    ds_read_b64_tr_b16 v[48:49], v235 offset:0
    ds_read_b64_tr_b16 v[50:51], v235 offset:2048
    v_mfma_f32_16x16x32_bf16 v[16:19], v[80:83], v[64:67], v[16:19]
    ds_read_b64_tr_b16 v[52:53], v236 offset:0
    ds_read_b64_tr_b16 v[54:55], v236 offset:2048
    v_mfma_f32_16x16x32_bf16 v[20:23], v[84:87], v[64:67], v[20:23]
    ds_read_b64_tr_b16 v[56:57], v237 offset:0
    ds_read_b64_tr_b16 v[58:59], v237 offset:2048
    ds_read_b64_tr_b16 v[60:61], v238 offset:0
    v_mfma_f32_16x16x32_bf16 v[24:27], v[72:75], v[68:71], v[24:27]
    ds_read_b64_tr_b16 v[62:63], v238 offset:2048
    ds_read_b128 v[44:47], v232 offset:2048
    v_mfma_f32_16x16x32_bf16 v[28:31], v[76:79], v[68:71], v[28:31]
    v_mfma_f32_16x16x32_bf16 v[32:35], v[80:83], v[68:71], v[32:35]
    s_add_u32 s52, s52, 24576
    s_cmp_ge_u32 s52, 147456
    s_cselect_b32 s52, 0, s52
    v_mfma_f32_16x16x32_bf16 v[36:39], v[84:87], v[68:71], v[36:39]
    s_waitcnt lgkmcnt(0)
    v_mfma_f32_16x16x32_bf16 v[8:11], v[48:51], v[40:43], v[8:11]
    ds_read_b128 v[64:67], v232 offset:1024
    ds_read_b64_tr_b16 v[72:73], v235 offset:4096
    v_mfma_f32_16x16x32_bf16 v[12:15], v[52:55], v[40:43], v[12:15]
    ds_read_b64_tr_b16 v[74:75], v235 offset:6144
    ds_read_b64_tr_b16 v[76:77], v236 offset:4096
    v_mfma_f32_16x16x32_bf16 v[16:19], v[56:59], v[40:43], v[16:19]
    ds_read_b64_tr_b16 v[78:79], v236 offset:6144
    ds_read_b64_tr_b16 v[80:81], v237 offset:4096
    v_mfma_f32_16x16x32_bf16 v[20:23], v[60:63], v[40:43], v[20:23]
    ds_read_b64_tr_b16 v[82:83], v237 offset:6144
    ds_read_b64_tr_b16 v[84:85], v238 offset:4096
    v_mfma_f32_16x16x32_bf16 v[24:27], v[48:51], v[44:47], v[24:27]
    ds_read_b64_tr_b16 v[86:87], v238 offset:6144
    ds_read_b128 v[68:71], v232 offset:3072
    v_mfma_f32_16x16x32_bf16 v[28:31], v[52:55], v[44:47], v[28:31]
    v_mfma_f32_16x16x32_bf16 v[32:35], v[56:59], v[44:47], v[32:35]
    v_mfma_f32_16x16x32_bf16 v[36:39], v[60:63], v[44:47], v[36:39]
    s_waitcnt lgkmcnt(0)
    v_mfma_f32_16x16x32_bf16 v[8:11], v[72:75], v[64:67], v[8:11]
    s_barrier
    v_mfma_f32_16x16x32_bf16 v[12:15], v[76:79], v[64:67], v[12:15]
    v_mfma_f32_16x16x32_bf16 v[16:19], v[80:83], v[64:67], v[16:19]
    v_mfma_f32_16x16x32_bf16 v[20:23], v[84:87], v[64:67], v[20:23]
    v_mfma_f32_16x16x32_bf16 v[24:27], v[72:75], v[68:71], v[24:27]
    v_mfma_f32_16x16x32_bf16 v[28:31], v[76:79], v[68:71], v[28:31]
    v_mfma_f32_16x16x32_bf16 v[32:35], v[80:83], v[68:71], v[32:35]
    v_mfma_f32_16x16x32_bf16 v[36:39], v[84:87], v[68:71], v[36:39]
    v_pk_fma_f32 v[104:105], v[8:9], v[136:137], v[104:105]
    v_pk_fma_f32 v[106:107], v[10:11], v[138:139], v[106:107]
    v_pk_fma_f32 v[108:109], v[12:13], v[140:141], v[108:109]
    v_pk_fma_f32 v[110:111], v[14:15], v[142:143], v[110:111]
    v_pk_fma_f32 v[112:113], v[16:17], v[144:145], v[112:113]
    v_pk_fma_f32 v[114:115], v[18:19], v[146:147], v[114:115]
    v_pk_fma_f32 v[116:117], v[20:21], v[148:149], v[116:117]
    v_pk_fma_f32 v[118:119], v[22:23], v[150:151], v[118:119]
    v_pk_fma_f32 v[120:121], v[24:25], v[136:137], v[120:121]
    v_pk_fma_f32 v[122:123], v[26:27], v[138:139], v[122:123]
    v_pk_fma_f32 v[124:125], v[28:29], v[140:141], v[124:125]
    v_pk_fma_f32 v[126:127], v[30:31], v[142:143], v[126:127]
    v_pk_fma_f32 v[128:129], v[32:33], v[144:145], v[128:129]
    v_pk_fma_f32 v[130:131], v[34:35], v[146:147], v[130:131]
    v_pk_fma_f32 v[132:133], v[36:37], v[148:149], v[132:133]
    v_pk_fma_f32 v[134:135], v[38:39], v[150:151], v[134:135]
    v_cvt_pk_bf16_f32 v88, v104, v105
    v_cvt_pk_bf16_f32 v89, v106, v107
    v_cvt_pk_bf16_f32 v90, v108, v109
    v_cvt_pk_bf16_f32 v91, v110, v111
    v_cvt_pk_bf16_f32 v92, v112, v113
    v_cvt_pk_bf16_f32 v93, v114, v115
    v_cvt_pk_bf16_f32 v94, v116, v117
    v_cvt_pk_bf16_f32 v95, v118, v119
    v_cvt_pk_bf16_f32 v96, v120, v121
    v_cvt_pk_bf16_f32 v97, v122, v123
    v_cvt_pk_bf16_f32 v98, v124, v125
    v_cvt_pk_bf16_f32 v99, v126, v127
    v_cvt_pk_bf16_f32 v100, v128, v129
    v_cvt_pk_bf16_f32 v101, v130, v131
    v_cvt_pk_bf16_f32 v102, v132, v133
    v_cvt_pk_bf16_f32 v103, v134, v135
    v_lshlrev_b32 v104, 16, v88
    v_and_b32 v105, 0xffff0000, v88
    v_lshlrev_b32 v106, 16, v89
    v_and_b32 v107, 0xffff0000, v89
    v_lshlrev_b32 v108, 16, v90
    v_and_b32 v109, 0xffff0000, v90
    v_lshlrev_b32 v110, 16, v91
    v_and_b32 v111, 0xffff0000, v91
    v_lshlrev_b32 v112, 16, v92
    v_and_b32 v113, 0xffff0000, v92
    v_lshlrev_b32 v114, 16, v93
    v_and_b32 v115, 0xffff0000, v93
    v_lshlrev_b32 v116, 16, v94
    v_and_b32 v117, 0xffff0000, v94
    v_lshlrev_b32 v118, 16, v95
    v_and_b32 v119, 0xffff0000, v95
    v_lshlrev_b32 v120, 16, v96
    v_and_b32 v121, 0xffff0000, v96
    v_lshlrev_b32 v122, 16, v97
    v_and_b32 v123, 0xffff0000, v97
    v_lshlrev_b32 v124, 16, v98
    v_and_b32 v125, 0xffff0000, v98
    v_lshlrev_b32 v126, 16, v99
    v_and_b32 v127, 0xffff0000, v99
    v_lshlrev_b32 v128, 16, v100
    v_and_b32 v129, 0xffff0000, v100
    v_lshlrev_b32 v130, 16, v101
    v_and_b32 v131, 0xffff0000, v101
    v_lshlrev_b32 v132, 16, v102
    v_and_b32 v133, 0xffff0000, v102
    v_lshlrev_b32 v134, 16, v103
    v_and_b32 v135, 0xffff0000, v103
    v_pk_add_f32 v[40:41], v[104:105], v[106:107]
    v_pk_mul_f32 v[44:45], v[104:105], v[104:105]
    v_pk_add_f32 v[42:43], v[120:121], v[122:123]
    v_pk_mul_f32 v[46:47], v[120:121], v[120:121]
    v_pk_fma_f32 v[44:45], v[106:107], v[106:107], v[44:45]
    v_pk_fma_f32 v[46:47], v[122:123], v[122:123], v[46:47]
    v_pk_add_f32 v[40:41], v[40:41], v[108:109]
    v_pk_fma_f32 v[44:45], v[108:109], v[108:109], v[44:45]
    v_pk_add_f32 v[42:43], v[42:43], v[124:125]
    v_pk_fma_f32 v[46:47], v[124:125], v[124:125], v[46:47]
    v_pk_add_f32 v[40:41], v[40:41], v[110:111]
    v_pk_fma_f32 v[44:45], v[110:111], v[110:111], v[44:45]
    v_pk_add_f32 v[42:43], v[42:43], v[126:127]
    v_pk_fma_f32 v[46:47], v[126:127], v[126:127], v[46:47]
    v_pk_add_f32 v[40:41], v[40:41], v[112:113]
    v_pk_fma_f32 v[44:45], v[112:113], v[112:113], v[44:45]
    v_pk_add_f32 v[42:43], v[42:43], v[128:129]
    v_pk_fma_f32 v[46:47], v[128:129], v[128:129], v[46:47]
    v_pk_add_f32 v[40:41], v[40:41], v[114:115]
    v_pk_fma_f32 v[44:45], v[114:115], v[114:115], v[44:45]
    v_pk_add_f32 v[42:43], v[42:43], v[130:131]
    v_pk_fma_f32 v[46:47], v[130:131], v[130:131], v[46:47]
    v_pk_add_f32 v[40:41], v[40:41], v[116:117]
    v_pk_fma_f32 v[44:45], v[116:117], v[116:117], v[44:45]
    v_pk_add_f32 v[42:43], v[42:43], v[132:133]
    v_pk_fma_f32 v[46:47], v[132:133], v[132:133], v[46:47]
    v_pk_add_f32 v[40:41], v[40:41], v[118:119]
    v_pk_fma_f32 v[44:45], v[118:119], v[118:119], v[44:45]
    v_pk_add_f32 v[42:43], v[42:43], v[134:135]
    v_pk_fma_f32 v[46:47], v[134:135], v[134:135], v[46:47]
    v_add_f32 v40, v40, v41
    v_add_f32 v42, v42, v43
    v_add_f32 v44, v44, v45
    v_add_f32 v46, v46, v47
    v_permlane16_swap_b32 v40, v42
    s_nop 0
    v_permlane16_swap_b32 v44, v46
    v_add_f32 v48, v40, v42
    v_add_f32 v49, v44, v46
    v_mov_b32 v50, v48
    v_mov_b32 v51, v49
    s_nop 0
    v_permlane32_swap_b32 v48, v50
    v_permlane32_swap_b32 v49, v51
    v_add_f32 v48, v48, v50
    v_add_f32 v49, v49, v51
    s_mov_b32 exec_hi, 0
    buffer_store_dwordx2 v[48:49], v198, s[28:31], s76 offen sc1
    s_mov_b32 exec_hi, -1
    buffer_load_dwordx2 v[56:57], v198, s[28:31], 0 offen offset:0 sc1
    buffer_load_dwordx2 v[58:59], v198, s[28:31], 0 offen offset:512 sc1
    buffer_load_dwordx2 v[60:61], v198, s[28:31], 0 offen offset:1024 sc1
    buffer_load_dwordx2 v[62:63], v198, s[28:31], 0 offen offset:1536 sc1
    buffer_load_dwordx2 v[64:65], v198, s[28:31], 0 offen offset:2048 sc1
    buffer_load_dwordx2 v[66:67], v198, s[28:31], 0 offen offset:2560 sc1
    buffer_load_dwordx2 v[68:69], v198, s[28:31], 0 offen offset:3072 sc1
    buffer_load_dwordx2 v[70:71], v198, s[28:31], 0 offen offset:3584 sc1
    s_waitcnt vmcnt(0)
    s_mov_b32 s3, 0x40000
M_sp_chk:
    v_cmp_eq_u32 s[80:81], -1, v57
    v_cmp_eq_u32 s[82:83], -1, v59
    v_cmp_eq_u32 s[84:85], -1, v61
    v_cmp_eq_u32 s[86:87], -1, v63
    v_cmp_eq_u32 s[88:89], -1, v65
    v_cmp_eq_u32 s[90:91], -1, v67
    v_cmp_eq_u32 s[92:93], -1, v69
    v_cmp_eq_u32 s[94:95], -1, v71
    v_max3_u32 v52, v57, v59, v61
    v_max3_u32 v53, v63, v65, v67
    v_max3_u32 v52, v52, v69, v71
    v_max_u32 v52, v52, v53
    v_cmp_eq_u32 vcc, -1, v52
    s_nop 4
    s_cbranch_vccz M_sp_ok
    s_sub_u32 s3, s3, 1
    s_cbranch_scc1 M_sp_ok
    s_mov_b64 exec, s[80:81]
    buffer_load_dwordx2 v[56:57], v198, s[28:31], 0 offen offset:0 sc1
    s_mov_b64 exec, s[82:83]
    buffer_load_dwordx2 v[58:59], v198, s[28:31], 0 offen offset:512 sc1
    s_mov_b64 exec, s[84:85]
    buffer_load_dwordx2 v[60:61], v198, s[28:31], 0 offen offset:1024 sc1
    s_mov_b64 exec, s[86:87]
    buffer_load_dwordx2 v[62:63], v198, s[28:31], 0 offen offset:1536 sc1
    s_mov_b64 exec, s[88:89]
    buffer_load_dwordx2 v[64:65], v198, s[28:31], 0 offen offset:2048 sc1
    s_mov_b64 exec, s[90:91]
    buffer_load_dwordx2 v[66:67], v198, s[28:31], 0 offen offset:2560 sc1
    s_mov_b64 exec, s[92:93]
    buffer_load_dwordx2 v[68:69], v198, s[28:31], 0 offen offset:3072 sc1
    s_mov_b64 exec, s[94:95]
    buffer_load_dwordx2 v[70:71], v198, s[28:31], 0 offen offset:3584 sc1
    s_mov_b64 exec, -1
    s_waitcnt vmcnt(0)
    s_branch M_sp_chk
M_sp_ok:
    buffer_store_dwordx4 v[88:91], v197, s[28:31], s72 offen offset:0 sc1
    buffer_store_dwordx4 v[92:95], v197, s[28:31], s72 offen offset:1024 sc1
    buffer_store_dwordx4 v[96:99], v197, s[28:31], s73 offen offset:0 sc1
    buffer_store_dwordx4 v[100:103], v197, s[28:31], s73 offen offset:1024 sc1
    v_pk_add_f32 v[56:57], v[56:57], v[58:59]
    v_pk_add_f32 v[60:61], v[60:61], v[62:63]
    v_pk_add_f32 v[64:65], v[64:65], v[66:67]
    v_pk_add_f32 v[68:69], v[68:69], v[70:71]
    v_pk_add_f32 v[56:57], v[56:57], v[60:61]
    v_pk_add_f32 v[64:65], v[64:65], v[68:69]
    v_pk_add_f32 v[56:57], v[56:57], v[64:65]
    v_mov_b32 v50, v56
    v_mov_b32 v51, v57
    s_nop 0
    v_permlane32_swap_b32 v56, v50
    v_permlane32_swap_b32 v57, v51
    v_add_f32 v56, v56, v50
    v_add_f32 v57, v57, v51
    v_mul_f32 v56, 0x3a800000, v56
    v_mul_f32 v57, 0x3a800000, v57
    v_fma_f32 v57, -v56, v56, v57
    v_max_f32 v57, 0, v57
    v_cvt_pk_bf16_f32 v50, v56, v57
    v_lshlrev_b32 v56, 16, v50
    v_and_b32 v57, 0xffff0000, v50
    v_add_f32 v57, 0x3727c5ac, v57
    v_cvt_pk_bf16_f32 v50, v57, v57
    v_lshlrev_b32 v57, 16, v50
    v_sqrt_f32 v57, v57
    s_nop 0
    v_cvt_pk_bf16_f32 v50, v57, v57
    v_lshlrev_b32 v57, 16, v50
    v_rcp_f32 v40, v57
    s_nop 0
    v_mul_f32 v44, -v56, v40
    v_mov_b32 v42, v40
    v_mov_b32 v46, v44
    s_nop 0
    v_permlane16_swap_b32 v40, v42
    v_permlane16_swap_b32 v44, v46
    v_pk_fma_f32 v[104:105], v[104:105], v[40:41], v[44:45] op_sel_hi:[1,0,0]
    v_pk_fma_f32 v[106:107], v[106:107], v[40:41], v[44:45] op_sel_hi:[1,0,0]
    v_pk_fma_f32 v[108:109], v[108:109], v[40:41], v[44:45] op_sel_hi:[1,0,0]
    v_pk_fma_f32 v[110:111], v[110:111], v[40:41], v[44:45] op_sel_hi:[1,0,0]
    v_pk_fma_f32 v[112:113], v[112:113], v[40:41], v[44:45] op_sel_hi:[1,0,0]
    v_pk_fma_f32 v[114:115], v[114:115], v[40:41], v[44:45] op_sel_hi:[1,0,0]
    v_pk_fma_f32 v[116:117], v[116:117], v[40:41], v[44:45] op_sel_hi:[1,0,0]
    v_pk_fma_f32 v[118:119], v[118:119], v[40:41], v[44:45] op_sel_hi:[1,0,0]
    v_pk_fma_f32 v[104:105], v[104:105], v[168:169], v[152:153]
    v_pk_fma_f32 v[106:107], v[106:107], v[170:171], v[154:155]
    v_pk_fma_f32 v[108:109], v[108:109], v[172:173], v[156:157]
    v_pk_fma_f32 v[110:111], v[110:111], v[174:175], v[158:159]
    v_pk_fma_f32 v[112:113], v[112:113], v[176:177], v[160:161]
    v_pk_fma_f32 v[114:115], v[114:115], v[178:179], v[162:163]
    v_pk_fma_f32 v[116:117], v[116:117], v[180:181], v[164:165]
    v_pk_fma_f32 v[118:119], v[118:119], v[182:183], v[166:167]
    v_cvt_pk_bf16_f32 v72, v104, v105
    v_cvt_pk_bf16_f32 v73, v106, v107
    v_cvt_pk_bf16_f32 v74, v108, v109
    v_cvt_pk_bf16_f32 v75, v110, v111
    buffer_store_dwordx4 v[72:75], v197, s[28:31], s74 offen offset:0 sc1
    ds_write_b128 v233, v[72:75] offset:0
    v_cvt_pk_bf16_f32 v76, v112, v113
    v_cvt_pk_bf16_f32 v77, v114, v115
    v_cvt_pk_bf16_f32 v78, v116, v117
    v_cvt_pk_bf16_f32 v79, v118, v119
    buffer_store_dwordx4 v[76:79], v197, s[28:31], s74 offen offset:1024 sc1
    ds_write_b128 v233, v[76:79] offset:1024
    v_pk_fma_f32 v[120:121], v[120:121], v[42:43], v[46:47] op_sel_hi:[1,0,0]
    v_pk_fma_f32 v[122:123], v[122:123], v[42:43], v[46:47] op_sel_hi:[1,0,0]
    v_pk_fma_f32 v[124:125], v[124:125], v[42:43], v[46:47] op_sel_hi:[1,0,0]
    v_pk_fma_f32 v[126:127], v[126:127], v[42:43], v[46:47] op_sel_hi:[1,0,0]
    v_pk_fma_f32 v[128:129], v[128:129], v[42:43], v[46:47] op_sel_hi:[1,0,0]
    v_pk_fma_f32 v[130:131], v[130:131], v[42:43], v[46:47] op_sel_hi:[1,0,0]
    v_pk_fma_f32 v[132:133], v[132:133], v[42:43], v[46:47] op_sel_hi:[1,0,0]
    v_pk_fma_f32 v[134:135], v[134:135], v[42:43], v[46:47] op_sel_hi:[1,0,0]
    v_pk_fma_f32 v[120:121], v[120:121], v[168:169], v[152:153]
    v_pk_fma_f32 v[122:123], v[122:123], v[170:171], v[154:155]
    v_pk_fma_f32 v[124:125], v[124:125], v[172:173], v[156:157]
    v_pk_fma_f32 v[126:127], v[126:127], v[174:175], v[158:159]
    v_pk_fma_f32 v[128:129], v[128:129], v[176:177], v[160:161]
    v_pk_fma_f32 v[130:131], v[130:131], v[178:179], v[162:163]
    v_pk_fma_f32 v[132:133], v[132:133], v[180:181], v[164:165]
    v_pk_fma_f32 v[134:135], v[134:135], v[182:183], v[166:167]
    v_cvt_pk_bf16_f32 v80, v120, v121
    v_cvt_pk_bf16_f32 v81, v122, v123
    v_cvt_pk_bf16_f32 v82, v124, v125
    v_cvt_pk_bf16_f32 v83, v126, v127
    buffer_store_dwordx4 v[80:83], v197, s[28:31], s75 offen offset:0 sc1
    ds_write_b128 v233, v[80:83] offset:2048
    v_cvt_pk_bf16_f32 v84, v128, v129
    v_cvt_pk_bf16_f32 v85, v130, v131
    v_cvt_pk_bf16_f32 v86, v132, v133
    v_cvt_pk_bf16_f32 v87, v134, v135
    buffer_store_dwordx4 v[84:87], v197, s[28:31], s75 offen offset:1024 sc1
    ds_write_b128 v233, v[84:87] offset:3072
    s_waitcnt lgkmcnt(0)
    s_barrier
    s_and_b32 s57, s58, 15
    s_lshr_b64 s[58:59], s[58:59], 4
    s_lshl_b32 s56, s57, 11
    s_mul_i32 s57, s57, 0x70000
    s_add_u32 s53, s53, 49152
    s_cmp_ge_u32 s53, s61
    s_cselect_b32 s53, s60, s53
    s_and_b32 s57, s58, 15
    s_lshr_b64 s[58:59], s[58:59], 4
    s_lshl_b32 s56, s57, 11
    s_mul_i32 s57, s57, 0x70000
    s_add_u32 m0, s53, 16384
    s_nop 0
    buffer_load_dwordx4 v208, s[32:35], s57 offen offset:0 lds
    buffer_load_dwordx4 v209, s[32:35], s57 offen offset:1024 lds
    buffer_load_dwordx4 v210, s[32:35], s57 offen offset:2048 lds
    buffer_load_dwordx4 v211, s[32:35], s57 offen offset:3072 lds
    s_add_u32 m0, s53, 32768
    s_nop 0
    buffer_load_dwordx4 v208, s[36:39], s57 offen offset:0 lds
    buffer_load_dwordx4 v209, s[36:39], s57 offen offset:1024 lds
    buffer_load_dwordx4 v210, s[36:39], s57 offen offset:2048 lds
    buffer_load_dwordx4 v211, s[36:39], s57 offen offset:3072 lds
    s_add_u32 s53, s53, 49152
    s_cmp_ge_u32 s53, s61
    s_cselect_b32 s53, s60, s53
    s_lshl_b32 s60, s44, 12
    s_add_u32 s61, s60, 147456
    s_add_u32 s53, s60, 0
    s_bfe_u32 s66, s2, 0x30003
    s_lshr_b32 s55, s2, 6
    s_add_u32 s66, s66, s55
    s_and_b32 s66, s66, 3
    s_mov_b32 s58, 0x76453210
    s_mov_b32 s59, 0xfecdba89
    s_cmp_eq_u32 s66, 1
    s_cselect_b32 s58, 0x75643120, s58
    s_cselect_b32 s59, 0xfdecb9a8, s59
    s_cmp_eq_u32 s66, 2
    s_cselect_b32 s58, 0x67542310, s58
    s_cselect_b32 s59, 0xefdcab98, s59
    s_cmp_eq_u32 s66, 3
    s_cselect_b32 s58, 0x86534210, s58
    s_cselect_b32 s59, 0xfedbca97, s59
    s_and_b32 s66, s48, 15
    s_lshl_b32 s55, s66, 2
    s_lshr_b64 s[56:57], s[58:59], s55
    s_and_b32 s55, s56, 15
    s_lshl_b32 s55, s55, 2
    s_lshl_b64 s[56:57], 15, s55
    s_andn2_b64 s[58:59], s[58:59], s[56:57]
    s_or_b32 s58, s58, s66
    s_mov_b32 s32, s12
    s_mov_b32 s33, s13
    s_mov_b32 s34, 0x700000
    s_mov_b32 s35, 0x20000
    s_mov_b32 s36, s14
    s_mov_b32 s37, s15
    s_mov_b32 s38, 0x700000
    s_mov_b32 s39, 0x20000
    s_lshl_b32 s68, s47, 9
    s_add_u32 s68, s68, 0x56000
    s_add_u32 s62, s26, s68
    s_addc_u32 s63, s27, 0
    s_lshr_b32 s68, s48, 2
    s_lshl_b32 s68, s68, 7
    v_mov_b32 v2, 1
    v_mov_b32 v5, 148488
    s_waitcnt vmcnt(8)
    s_mov_b64 exec, 1
    ds_add_rtn_u32 v245, v5, v2
    s_mov_b64 exec, -1
    s_mov_b32 s1, 1
    s_mov_b32 s3, 0x40000
    s_waitcnt lgkmcnt(0)
    v_readfirstlane_b32 s64, v245
    s_nop 3
    s_cmp_lg_u32 s64, 3
    s_cbranch_scc1 M_ph_ok
    s_atomic_add s1, s[62:63], 0
    s_atomic_add s1, s[62:63], 128
    s_atomic_add s1, s[62:63], 256
    s_atomic_add s1, s[62:63], 384
M_ph_chk:
    s_load_dword s64, s[62:63], s68 glc
    s_sub_u32 s3, s3, 1
    s_cselect_b32 s65, 0, 16
    s_waitcnt lgkmcnt(0)
    s_cmp_lt_u32 s64, s65
    s_cbranch_scc1 M_ph_chk
M_ph_ok:
    s_barrier
    s_setprio 0
    s_and_b32 s57, s58, 15
    s_lshr_b64 s[58:59], s[58:59], 4
    s_lshl_b32 s56, s57, 11
    s_mul_i32 s57, s57, 0x70000
    s_add_u32 s53, s53, 49152
    s_cmp_ge_u32 s53, s61
    s_cselect_b32 s53, s60, s53
    s_and_b32 s57, s58, 15
    s_lshr_b64 s[58:59], s[58:59], 4
    s_lshl_b32 s56, s57, 11
    s_mul_i32 s57, s57, 0x70000
    s_mov_b32 m0, s53
    s_nop 0
    buffer_load_dwordx4 v206, s[28:31], s56 offen offset:0 sc1 lds
    buffer_load_dwordx4 v206, s[28:31], s56 offen offset:1024 sc1 lds
    buffer_load_dwordx4 v207, s[28:31], s56 offen offset:2048 sc1 lds
    buffer_load_dwordx4 v207, s[28:31], s56 offen offset:3072 sc1 lds
    s_add_u32 s53, s53, 49152
    s_cmp_ge_u32 s53, s61
    s_cselect_b32 s53, s60, s53
    s_and_b32 s57, s58, 15
    s_lshr_b64 s[58:59], s[58:59], 4
    s_lshl_b32 s56, s57, 11
    s_mul_i32 s57, s57, 0x70000
    s_add_u32 m0, s53, 16384
    s_nop 0
    buffer_load_dwordx4 v208, s[32:35], s57 offen offset:0 lds
    buffer_load_dwordx4 v209, s[32:35], s57 offen offset:1024 lds
    buffer_load_dwordx4 v210, s[32:35], s57 offen offset:2048 lds
    buffer_load_dwordx4 v211, s[32:35], s57 offen offset:3072 lds
    s_add_u32 m0, s53, 32768
    s_nop 0
    buffer_load_dwordx4 v208, s[36:39], s57 offen offset:0 lds
    buffer_load_dwordx4 v209, s[36:39], s57 offen offset:1024 lds
    buffer_load_dwordx4 v210, s[36:39], s57 offen offset:2048 lds
    buffer_load_dwordx4 v211, s[36:39], s57 offen offset:3072 lds
    s_mov_b32 m0, s53
    s_nop 0
    buffer_load_dwordx4 v206, s[28:31], s56 offen offset:0 sc1 lds
    buffer_load_dwordx4 v206, s[28:31], s56 offen offset:1024 sc1 lds
    buffer_load_dwordx4 v207, s[28:31], s56 offen offset:2048 sc1 lds
    buffer_load_dwordx4 v207, s[28:31], s56 offen offset:3072 sc1 lds
    s_add_u32 s53, s53, 49152
    s_cmp_ge_u32 s53, s61
    s_cselect_b32 s53, s60, s53
    s_lshl_b32 s64, s45, 13
    v_lshl_add_u32 v233, v1, 4, s64
    v_lshrrev_b32 v2, 2, v1
    v_lshlrev_b32 v4, 8, v2
    v_and_b32 v5, 3, v1
    v_lshl_add_u32 v4, v5, 3, v4
    v_add_u32 v4, 16384, v4
    v_and_b32 v2, 7, v2
    s_lshl_b32 s64, s46, 2
    v_xor_b32 v2, s64, v2
    v_xor_b32 v3, 0, v2
    v_lshl_add_u32 v239, v3, 5, v4
    v_xor_b32 v3, 1, v2
    v_lshl_add_u32 v240, v3, 5, v4
    v_xor_b32 v3, 2, v2
    v_lshl_add_u32 v241, v3, 5, v4
    v_xor_b32 v3, 3, v2
    v_lshl_add_u32 v242, v3, 5, v4
    s_mov_b32 s52, 49152
    v_add_u32 v232, s52, v233
    v_add_u32 v235, s52, v239
    v_add_u32 v236, s52, v240
    v_add_u32 v237, s52, v241
    v_add_u32 v238, s52, v242
    s_lshl_b32 s64, s2, 2
    s_add_u32 s64, s64, s44
    s_mul_i32 s64, s64, 7168
    s_add_u32 s64, s64, 5248
    s_add_u32 s10, s12, s64
    s_addc_u32 s11, s13, 0
    s_add_u32 s24, s14, s64
    s_addc_u32 s25, s15, 0
    s_movk_i32 s54, 9
M_Q_loop2:
    s_waitcnt vmcnt(12)
    s_barrier
    s_and_b32 s57, s58, 15
    s_lshr_b64 s[58:59], s[58:59], 4
    s_lshl_b32 s56, s57, 11
    s_mul_i32 s57, s57, 0x70000
    s_add_u32 m0, s53, 16384
    s_nop 0
    buffer_load_dwordx4 v208, s[32:35], s57 offen offset:0 lds
    s_load_dword s99, s[10:11], 0
    buffer_load_dwordx4 v209, s[32:35], s57 offen offset:1024 lds
    buffer_load_dwordx4 v210, s[32:35], s57 offen offset:2048 lds
    s_load_dword s99, s[24:25], 0
    buffer_load_dwordx4 v211, s[32:35], s57 offen offset:3072 lds
    s_add_u32 m0, s53, 32768
    s_nop 0
    buffer_load_dwordx4 v208, s[36:39], s57 offen offset:0 lds
    s_load_dword s99, s[10:11], 64
    buffer_load_dwordx4 v209, s[36:39], s57 offen offset:1024 lds
    buffer_load_dwordx4 v210, s[36:39], s57 offen offset:2048 lds
    s_load_dword s99, s[24:25], 64
    buffer_load_dwordx4 v211, s[36:39], s57 offen offset:3072 lds
    s_mov_b32 m0, s53
    s_nop 0
    buffer_load_dwordx4 v206, s[28:31], s56 offen offset:0 sc1 lds
    s_load_dword s99, s[10:11], 128
    buffer_load_dwordx4 v206, s[28:31], s56 offen offset:1024 sc1 lds
    buffer_load_dwordx4 v207, s[28:31], s56 offen offset:2048 sc1 lds
    s_load_dword s99, s[24:25], 128
    buffer_load_dwordx4 v207, s[28:31], s56 offen offset:3072 sc1 lds
    s_add_u32 s53, s53, 49152
    s_cmp_ge_u32 s53, s61
    s_cselect_b32 s53, s60, s53
    s_add_u32 s10, s10, 192
    s_addc_u32 s11, s11, 0
    s_add_u32 s24, s24, 192
    s_addc_u32 s25, s25, 0
    s_sub_u32 s54, s54, 1
    s_cbranch_scc0 M_Q_loop2
    s_movk_i32 s54, 2
M_Q_loop3:
    s_waitcnt vmcnt(12)
    s_barrier
    s_and_b32 s57, s58, 15
    s_lshr_b64 s[58:59], s[58:59], 4
    s_lshl_b32 s56, s57, 11
    s_mul_i32 s57, s57, 0x70000
    s_add_u32 m0, s53, 16384
    s_nop 0
    buffer_load_dwordx4 v208, s[32:35], s57 offen offset:0 lds
    buffer_load_dwordx4 v209, s[32:35], s57 offen offset:1024 lds
    buffer_load_dwordx4 v210, s[32:35], s57 offen offset:2048 lds
    buffer_load_dwordx4 v211, s[32:35], s57 offen offset:3072 lds
    s_add_u32 m0, s53, 32768
    s_nop 0
    buffer_load_dwordx4 v208, s[36:39], s57 offen offset:0 lds
    buffer_load_dwordx4 v209, s[36:39], s57 offen offset:1024 lds
    buffer_load_dwordx4 v210, s[36:39], s57 offen offset:2048 lds
    buffer_load_dwordx4 v211, s[36:39], s57 offen offset:3072 lds
    s_mov_b32 m0, s53
    s_nop 0
    buffer_load_dwordx4 v206, s[28:31], s56 offen offset:0 sc1 lds
    buffer_load_dwordx4 v206, s[28:31], s56 offen offset:1024 sc1 lds
    buffer_load_dwordx4 v207, s[28:31], s56 offen offset:2048 sc1 lds
    buffer_load_dwordx4 v207, s[28:31], s56 offen offset:3072 sc1 lds
    s_add_u32 s53, s53, 49152
    s_cmp_ge_u32 s53, s61
    s_cselect_b32 s53, s60, s53
    s_sub_u32 s54, s54, 1
    s_cbranch_scc0 M_Q_loop3
    s_waitcnt vmcnt(12)
    s_barrier
    s_bfe_u32 s66, s2, 0x30003
    s_lshr_b32 s55, s2, 6
    s_add_u32 s66, s66, s55
    s_mul_i32 s55, s66, 11
    s_lshr_b32 s55, s55, 5
    s_mul_i32 s55, s55, 3
    s_sub_u32 s66, s66, s55
    s_mov_b32 s58, 0x67534201
    s_mov_b32 s59, 0xfecdb9a8
    s_cmp_eq_u32 s66, 1
    s_cselect_b32 s58, 0x86453120, s58
    s_cselect_b32 s59, 0xfdecab97, s59
    s_cmp_eq_u32 s66, 2
    s_cselect_b32 s58, 0x75642310, s58
    s_cselect_b32 s59, 0xefdbca89, s59
    v_or_b32 v206, s69, v206
    v_or_b32 v207, s69, v207
    s_and_b32 s57, s58, 15
    s_lshr_b64 s[58:59], s[58:59], 4
    s_lshl_b32 s56, s57, 11
    s_mul_i32 s57, s57, 0x70000
    s_add_u32 m0, s53, 16384
    s_nop 0
    buffer_load_dwordx4 v212, s[32:35], s57 offen offset:0 lds
    buffer_load_dwordx4 v213, s[32:35], s57 offen offset:1024 lds
    buffer_load_dwordx4 v214, s[32:35], s57 offen offset:2048 lds
    buffer_load_dwordx4 v215, s[32:35], s57 offen offset:3072 lds
    s_add_u32 m0, s53, 32768
    s_nop 0
    buffer_load_dwordx4 v212, s[36:39], s57 offen offset:0 lds
    buffer_load_dwordx4 v213, s[36:39], s57 offen offset:1024 lds
    buffer_load_dwordx4 v214, s[36:39], s57 offen offset:2048 lds
    buffer_load_dwordx4 v215, s[36:39], s57 offen offset:3072 lds
    s_mov_b32 m0, s53
    s_nop 0
    buffer_load_dwordx4 v206, s[28:31], s56 offen offset:0 sc1 lds
    buffer_load_dwordx4 v206, s[28:31], s56 offen offset:1024 sc1 lds
    buffer_load_dwordx4 v207, s[28:31], s56 offen offset:2048 sc1 lds
    buffer_load_dwordx4 v207, s[28:31], s56 offen offset:3072 sc1 lds
    s_add_u32 s53, s53, 49152
    s_cmp_ge_u32 s53, s61
    s_cselect_b32 s53, s60, s53
    s_waitcnt vmcnt(12)
    s_barrier
    s_and_b32 s57, s58, 15
    s_lshr_b64 s[58:59], s[58:59], 4
    s_lshl_b32 s56, s57, 11
    s_mul_i32 s57, s57, 0x70000
    s_add_u32 m0, s53, 16384
    s_nop 0
    buffer_load_dwordx4 v212, s[32:35], s57 offen offset:0 lds
    buffer_load_dwordx4 v213, s[32:35], s57 offen offset:1024 lds
    buffer_load_dwordx4 v214, s[32:35], s57 offen offset:2048 lds
    buffer_load_dwordx4 v215, s[32:35], s57 offen offset:3072 lds
    s_add_u32 m0, s53, 32768
    s_nop 0
    buffer_load_dwordx4 v212, s[36:39], s57 offen offset:0 lds
    buffer_load_dwordx4 v213, s[36:39], s57 offen offset:1024 lds
    buffer_load_dwordx4 v214, s[36:39], s57 offen offset:2048 lds
    buffer_load_dwordx4 v215, s[36:39], s57 offen offset:3072 lds
    s_mov_b32 m0, s53
    s_nop 0
    buffer_load_dwordx4 v206, s[28:31], s56 offen offset:0 sc1 lds
    buffer_load_dwordx4 v206, s[28:31], s56 offen offset:1024 sc1 lds
    buffer_load_dwordx4 v207, s[28:31], s56 offen offset:2048 sc1 lds
    buffer_load_dwordx4 v207, s[28:31], s56 offen offset:3072 sc1 lds
    s_add_u32 s53, s53, 49152
    s_cmp_ge_u32 s53, s61
    s_cselect_b32 s53, s60, s53
    s_waitcnt vmcnt(12)
    s_barrier
    s_cmp_lg_u32 s69, 0
    s_cbranch_scc1 M_Qidle
    ds_read_b128 v[136:139], v232 offset:0
    ds_read_b64_tr_b16 v[152:153], v235 offset:0
    ds_read_b64_tr_b16 v[154:155], v235 offset:4096
    ds_read_b64_tr_b16 v[156:157], v236 offset:0
    ds_read_b64_tr_b16 v[158:159], v236 offset:4096
    ds_read_b64_tr_b16 v[160:161], v237 offset:0
    ds_read_b64_tr_b16 v[162:163], v237 offset:4096
    ds_read_b64_tr_b16 v[164:165], v238 offset:0
    ds_read_b64_tr_b16 v[166:167], v238 offset:4096
    ds_read_b64_tr_b16 v[168:169], v235 offset:16384
    ds_read_b64_tr_b16 v[170:171], v235 offset:20480
    ds_read_b64_tr_b16 v[172:173], v236 offset:16384
    ds_read_b64_tr_b16 v[174:175], v236 offset:20480
    ds_read_b64_tr_b16 v[176:177], v237 offset:16384
    ds_read_b64_tr_b16 v[178:179], v237 offset:20480
    ds_read_b64_tr_b16 v[180:181], v238 offset:16384
    ds_read_b64_tr_b16 v[182:183], v238 offset:20480
    ds_read_b128 v[140:143], v232 offset:2048
    ds_read_b128 v[144:147], v232 offset:4096
    ds_read_b128 v[148:151], v232 offset:6144
    s_and_b32 s57, s58, 15
    s_lshr_b64 s[58:59], s[58:59], 4
    s_lshl_b32 s56, s57, 11
    s_mul_i32 s57, s57, 0x70000
    s_add_u32 m0, s53, 16384
    s_nop 0
    buffer_load_dwordx4 v212, s[32:35], s57 offen offset:0 lds
    buffer_load_dwordx4 v213, s[32:35], s57 offen offset:1024 lds
    buffer_load_dwordx4 v214, s[32:35], s57 offen offset:2048 lds
    buffer_load_dwordx4 v215, s[32:35], s57 offen offset:3072 lds
    s_add_u32 m0, s53, 32768
    s_nop 0
    buffer_load_dwordx4 v212, s[36:39], s57 offen offset:0 lds
    buffer_load_dwordx4 v213, s[36:39], s57 offen offset:1024 lds
    buffer_load_dwordx4 v214, s[36:39], s57 offen offset:2048 lds
    buffer_load_dwordx4 v215, s[36:39], s57 offen offset:3072 lds
    s_mov_b32 m0, s53
    s_nop 0
    buffer_load_dwordx4 v206, s[28:31], s56 offen offset:0 sc1 lds
    buffer_load_dwordx4 v206, s[28:31], s56 offen offset:1024 sc1 lds
    buffer_load_dwordx4 v207, s[28:31], s56 offen offset:2048 sc1 lds
    buffer_load_dwordx4 v207, s[28:31], s56 offen offset:3072 sc1 lds
    s_add_u32 s53, s53, 49152
    s_cmp_ge_u32 s53, s61
    s_cselect_b32 s53, s60, s53
    s_setprio 2
    s_add_u32 s52, s52, 49152
    s_cmp_ge_u32 s52, 147456
    s_cselect_b32 s52, 0, s52
    s_waitcnt lgkmcnt(0)
    v_mfma_f32_16x16x32_bf16 v[8:11], v[152:155], v[136:139], 0
    ds_read_b128 v[184:187], v232 offset:1024
    v_mfma_f32_16x16x32_bf16 v[12:15], v[156:159], v[136:139], 0
    ds_read_b64_tr_b16 v[200:201], v235 offset:8192
    v_mfma_f32_16x16x32_bf16 v[16:19], v[160:163], v[136:139], 0
    ds_read_b64_tr_b16 v[202:203], v235 offset:12288
    v_mfma_f32_16x16x32_bf16 v[20:23], v[164:167], v[136:139], 0
    ds_read_b64_tr_b16 v[204:205], v236 offset:8192
    v_mfma_f32_16x16x32_bf16 v[24:27], v[168:171], v[136:139], 0
    v_mfma_f32_16x16x32_bf16 v[28:31], v[172:175], v[136:139], 0
    ds_read_b64_tr_b16 v[206:207], v236 offset:12288
    v_mfma_f32_16x16x32_bf16 v[32:35], v[176:179], v[136:139], 0
    ds_read_b64_tr_b16 v[208:209], v237 offset:8192
    v_mfma_f32_16x16x32_bf16 v[36:39], v[180:183], v[136:139], 0
    ds_read_b64_tr_b16 v[210:211], v237 offset:12288
    v_mfma_f32_16x16x32_bf16 v[40:43], v[152:155], v[140:143], 0
    ds_read_b64_tr_b16 v[212:213], v238 offset:8192
    v_mfma_f32_16x16x32_bf16 v[44:47], v[156:159], v[140:143], 0
    v_mfma_f32_16x16x32_bf16 v[48:51], v[160:163], v[140:143], 0
    ds_read_b64_tr_b16 v[214:215], v238 offset:12288
    v_mfma_f32_16x16x32_bf16 v[52:55], v[164:167], v[140:143], 0
    ds_read_b64_tr_b16 v[216:217], v235 offset:24576
    v_mfma_f32_16x16x32_bf16 v[56:59], v[168:171], v[140:143], 0
    ds_read_b64_tr_b16 v[218:219], v235 offset:28672
    v_mfma_f32_16x16x32_bf16 v[60:63], v[172:175], v[140:143], 0
    ds_read_b64_tr_b16 v[220:221], v236 offset:24576
    v_mfma_f32_16x16x32_bf16 v[64:67], v[176:179], v[140:143], 0
    v_mfma_f32_16x16x32_bf16 v[68:71], v[180:183], v[140:143], 0
    ds_read_b64_tr_b16 v[222:223], v236 offset:28672
    v_mfma_f32_16x16x32_bf16 v[72:75], v[152:155], v[144:147], 0
    ds_read_b64_tr_b16 v[224:225], v237 offset:24576
    v_mfma_f32_16x16x32_bf16 v[76:79], v[156:159], v[144:147], 0
    ds_read_b64_tr_b16 v[226:227], v237 offset:28672
    v_mfma_f32_16x16x32_bf16 v[80:83], v[160:163], v[144:147], 0
    ds_read_b64_tr_b16 v[228:229], v238 offset:24576
    v_mfma_f32_16x16x32_bf16 v[84:87], v[164:167], v[144:147], 0
    v_mfma_f32_16x16x32_bf16 v[88:91], v[168:171], v[144:147], 0
    ds_read_b64_tr_b16 v[230:231], v238 offset:28672
    v_mfma_f32_16x16x32_bf16 v[92:95], v[172:175], v[144:147], 0
    ds_read_b128 v[188:191], v232 offset:3072
    v_mfma_f32_16x16x32_bf16 v[96:99], v[176:179], v[144:147], 0
    ds_read_b128 v[192:195], v232 offset:5120
    v_mfma_f32_16x16x32_bf16 v[100:103], v[180:183], v[144:147], 0
    ds_read_b128 v[196:199], v232 offset:7168
    v_mfma_f32_16x16x32_bf16 v[104:107], v[152:155], v[148:151], 0
    v_mfma_f32_16x16x32_bf16 v[108:111], v[156:159], v[148:151], 0
    v_add_u32 v232, s52, v233
    v_mfma_f32_16x16x32_bf16 v[112:115], v[160:163], v[148:151], 0
    v_add_u32 v235, s52, v239
    v_mfma_f32_16x16x32_bf16 v[116:119], v[164:167], v[148:151], 0
    v_add_u32 v236, s52, v240
    v_mfma_f32_16x16x32_bf16 v[120:123], v[168:171], v[148:151], 0
    v_mfma_f32_16x16x32_bf16 v[124:127], v[172:175], v[148:151], 0
    v_add_u32 v237, s52, v241
    v_mfma_f32_16x16x32_bf16 v[128:131], v[176:179], v[148:151], 0
    v_add_u32 v238, s52, v242
    v_mfma_f32_16x16x32_bf16 v[132:135], v[180:183], v[148:151], 0
    s_waitcnt lgkmcnt(0)
    v_mfma_f32_16x16x32_bf16 v[8:11], v[200:203], v[184:187], v[8:11]
    s_waitcnt vmcnt(12)
    s_barrier
    v_mfma_f32_16x16x32_bf16 v[12:15], v[204:207], v[184:187], v[12:15]
    ds_read_b128 v[136:139], v232 offset:0
    v_mfma_f32_16x16x32_bf16 v[16:19], v[208:211], v[184:187], v[16:19]
    ds_read_b64_tr_b16 v[152:153], v235 offset:0
    v_mfma_f32_16x16x32_bf16 v[20:23], v[212:215], v[184:187], v[20:23]
    ds_read_b64_tr_b16 v[154:155], v235 offset:4096
    v_mfma_f32_16x16x32_bf16 v[24:27], v[216:219], v[184:187], v[24:27]
    ds_read_b64_tr_b16 v[156:157], v236 offset:0
    v_mfma_f32_16x16x32_bf16 v[28:31], v[220:223], v[184:187], v[28:31]
    ds_read_b64_tr_b16 v[158:159], v236 offset:4096
    v_mfma_f32_16x16x32_bf16 v[32:35], v[224:227], v[184:187], v[32:35]
    v_mfma_f32_16x16x32_bf16 v[36:39], v[228:231], v[184:187], v[36:39]
    ds_read_b64_tr_b16 v[160:161], v237 offset:0
    v_mfma_f32_16x16x32_bf16 v[40:43], v[200:203], v[188:191], v[40:43]
    ds_read_b64_tr_b16 v[162:163], v237 offset:4096
    v_mfma_f32_16x16x32_bf16 v[44:47], v[204:207], v[188:191], v[44:47]
    ds_read_b64_tr_b16 v[164:165], v238 offset:0
    v_mfma_f32_16x16x32_bf16 v[48:51], v[208:211], v[188:191], v[48:51]
    ds_read_b64_tr_b16 v[166:167], v238 offset:4096
    v_mfma_f32_16x16x32_bf16 v[52:55], v[212:215], v[188:191], v[52:55]
    ds_read_b64_tr_b16 v[168:169], v235 offset:16384
    v_mfma_f32_16x16x32_bf16 v[56:59], v[216:219], v[188:191], v[56:59]
    v_mfma_f32_16x16x32_bf16 v[60:63], v[220:223], v[188:191], v[60:63]
    ds_read_b64_tr_b16 v[170:171], v235 offset:20480
    v_mfma_f32_16x16x32_bf16 v[64:67], v[224:227], v[188:191], v[64:67]
    ds_read_b64_tr_b16 v[172:173], v236 offset:16384
    v_mfma_f32_16x16x32_bf16 v[68:71], v[228:231], v[188:191], v[68:71]
    ds_read_b64_tr_b16 v[174:175], v236 offset:20480
    v_mfma_f32_16x16x32_bf16 v[72:75], v[200:203], v[192:195], v[72:75]
    ds_read_b64_tr_b16 v[176:177], v237 offset:16384
    v_mfma_f32_16x16x32_bf16 v[76:79], v[204:207], v[192:195], v[76:79]
    ds_read_b64_tr_b16 v[178:179], v237 offset:20480
    v_mfma_f32_16x16x32_bf16 v[80:83], v[208:211], v[192:195], v[80:83]
    v_mfma_f32_16x16x32_bf16 v[84:87], v[212:215], v[192:195], v[84:87]
    ds_read_b64_tr_b16 v[180:181], v238 offset:16384
    v_mfma_f32_16x16x32_bf16 v[88:91], v[216:219], v[192:195], v[88:91]
    ds_read_b64_tr_b16 v[182:183], v238 offset:20480
    v_mfma_f32_16x16x32_bf16 v[92:95], v[220:223], v[192:195], v[92:95]
    ds_read_b128 v[140:143], v232 offset:2048
    v_mfma_f32_16x16x32_bf16 v[96:99], v[224:227], v[192:195], v[96:99]
    ds_read_b128 v[144:147], v232 offset:4096
    v_mfma_f32_16x16x32_bf16 v[100:103], v[228:231], v[192:195], v[100:103]
    ds_read_b128 v[148:151], v232 offset:6144
    v_mfma_f32_16x16x32_bf16 v[104:107], v[200:203], v[196:199], v[104:107]
    v_mfma_f32_16x16x32_bf16 v[108:111], v[204:207], v[196:199], v[108:111]
    v_mfma_f32_16x16x32_bf16 v[112:115], v[208:211], v[196:199], v[112:115]
    v_mfma_f32_16x16x32_bf16 v[116:119], v[212:215], v[196:199], v[116:119]
    v_mfma_f32_16x16x32_bf16 v[120:123], v[216:219], v[196:199], v[120:123]
    v_mfma_f32_16x16x32_bf16 v[124:127], v[220:223], v[196:199], v[124:127]
    v_mfma_f32_16x16x32_bf16 v[128:131], v[224:227], v[196:199], v[128:131]
    s_add_u32 s52, s52, 49152
    s_cmp_ge_u32 s52, 147456
    s_cselect_b32 s52, 0, s52
    v_mfma_f32_16x16x32_bf16 v[132:135], v[228:231], v[196:199], v[132:135]
    s_waitcnt lgkmcnt(0)
    v_mfma_f32_16x16x32_bf16 v[8:11], v[152:155], v[136:139], v[8:11]
    ds_read_b128 v[184:187], v232 offset:1024
    v_mfma_f32_16x16x32_bf16 v[12:15], v[156:159], v[136:139], v[12:15]
    ds_read_b64_tr_b16 v[200:201], v235 offset:8192
    v_mfma_f32_16x16x32_bf16 v[16:19], v[160:163], v[136:139], v[16:19]
    ds_read_b64_tr_b16 v[202:203], v235 offset:12288
    v_mfma_f32_16x16x32_bf16 v[20:23], v[164:167], v[136:139], v[20:23]
    ds_read_b64_tr_b16 v[204:205], v236 offset:8192
    v_mfma_f32_16x16x32_bf16 v[24:27], v[168:171], v[136:139], v[24:27]
    v_mfma_f32_16x16x32_bf16 v[28:31], v[172:175], v[136:139], v[28:31]
    ds_read_b64_tr_b16 v[206:207], v236 offset:12288
    v_mfma_f32_16x16x32_bf16 v[32:35], v[176:179], v[136:139], v[32:35]
    ds_read_b64_tr_b16 v[208:209], v237 offset:8192
    v_mfma_f32_16x16x32_bf16 v[36:39], v[180:183], v[136:139], v[36:39]
    ds_read_b64_tr_b16 v[210:211], v237 offset:12288
    v_mfma_f32_16x16x32_bf16 v[40:43], v[152:155], v[140:143], v[40:43]
    ds_read_b64_tr_b16 v[212:213], v238 offset:8192
    v_mfma_f32_16x16x32_bf16 v[44:47], v[156:159], v[140:143], v[44:47]
    v_mfma_f32_16x16x32_bf16 v[48:51], v[160:163], v[140:143], v[48:51]
    ds_read_b64_tr_b16 v[214:215], v238 offset:12288
    v_mfma_f32_16x16x32_bf16 v[52:55], v[164:167], v[140:143], v[52:55]
    ds_read_b64_tr_b16 v[216:217], v235 offset:24576
    v_mfma_f32_16x16x32_bf16 v[56:59], v[168:171], v[140:143], v[56:59]
    ds_read_b64_tr_b16 v[218:219], v235 offset:28672
    v_mfma_f32_16x16x32_bf16 v[60:63], v[172:175], v[140:143], v[60:63]
    ds_read_b64_tr_b16 v[220:221], v236 offset:24576
    v_mfma_f32_16x16x32_bf16 v[64:67], v[176:179], v[140:143], v[64:67]
    v_mfma_f32_16x16x32_bf16 v[68:71], v[180:183], v[140:143], v[68:71]
    ds_read_b64_tr_b16 v[222:223], v236 offset:28672
    v_mfma_f32_16x16x32_bf16 v[72:75], v[152:155], v[144:147], v[72:75]
    ds_read_b64_tr_b16 v[224:225], v237 offset:24576
    v_mfma_f32_16x16x32_bf16 v[76:79], v[156:159], v[144:147], v[76:79]
    ds_read_b64_tr_b16 v[226:227], v237 offset:28672
    v_mfma_f32_16x16x32_bf16 v[80:83], v[160:163], v[144:147], v[80:83]
    ds_read_b64_tr_b16 v[228:229], v238 offset:24576
    v_mfma_f32_16x16x32_bf16 v[84:87], v[164:167], v[144:147], v[84:87]
    v_mfma_f32_16x16x32_bf16 v[88:91], v[168:171], v[144:147], v[88:91]
    ds_read_b64_tr_b16 v[230:231], v238 offset:28672
    v_mfma_f32_16x16x32_bf16 v[92:95], v[172:175], v[144:147], v[92:95]
    ds_read_b128 v[188:191], v232 offset:3072
    v_mfma_f32_16x16x32_bf16 v[96:99], v[176:179], v[144:147], v[96:99]
    ds_read_b128 v[192:195], v232 offset:5120
    v_mfma_f32_16x16x32_bf16 v[100:103], v[180:183], v[144:147], v[100:103]
    ds_read_b128 v[196:199], v232 offset:7168
    v_mfma_f32_16x16x32_bf16 v[104:107], v[152:155], v[148:151], v[104:107]
    v_mfma_f32_16x16x32_bf16 v[108:111], v[156:159], v[148:151], v[108:111]
    v_add_u32 v232, s52, v233
    v_mfma_f32_16x16x32_bf16 v[112:115], v[160:163], v[148:151], v[112:115]
    v_add_u32 v235, s52, v239
    v_mfma_f32_16x16x32_bf16 v[116:119], v[164:167], v[148:151], v[116:119]
    v_add_u32 v236, s52, v240
    v_mfma_f32_16x16x32_bf16 v[120:123], v[168:171], v[148:151], v[120:123]
    v_mfma_f32_16x16x32_bf16 v[124:127], v[172:175], v[148:151], v[124:127]
    v_add_u32 v237, s52, v241
    v_mfma_f32_16x16x32_bf16 v[128:131], v[176:179], v[148:151], v[128:131]
    v_add_u32 v238, s52, v242
    v_mfma_f32_16x16x32_bf16 v[132:135], v[180:183], v[148:151], v[132:135]
    s_waitcnt lgkmcnt(0)
    v_mfma_f32_16x16x32_bf16 v[8:11], v[200:203], v[184:187], v[8:11]
    s_waitcnt vmcnt(0)
    s_barrier
    v_mfma_f32_16x16x32_bf16 v[12:15], v[204:207], v[184:187], v[12:15]
    ds_read_b128 v[136:139], v232 offset:0
    v_mfma_f32_16x16x32_bf16 v[16:19], v[208:211], v[184:187], v[16:19]
    ds_read_b64_tr_b16 v[152:153], v235 offset:0
    v_mfma_f32_16x16x32_bf16 v[20:23], v[212:215], v[184:187], v[20:23]
    ds_read_b64_tr_b16 v[154:155], v235 offset:4096
    v_mfma_f32_16x16x32_bf16 v[24:27], v[216:219], v[184:187], v[24:27]
    ds_read_b64_tr_b16 v[156:157], v236 offset:0
    v_mfma_f32_16x16x32_bf16 v[28:31], v[220:223], v[184:187], v[28:31]
    ds_read_b64_tr_b16 v[158:159], v236 offset:4096
    v_mfma_f32_16x16x32_bf16 v[32:35], v[224:227], v[184:187], v[32:35]
    v_mfma_f32_16x16x32_bf16 v[36:39], v[228:231], v[184:187], v[36:39]
    ds_read_b64_tr_b16 v[160:161], v237 offset:0
    v_mfma_f32_16x16x32_bf16 v[40:43], v[200:203], v[188:191], v[40:43]
    ds_read_b64_tr_b16 v[162:163], v237 offset:4096
    v_mfma_f32_16x16x32_bf16 v[44:47], v[204:207], v[188:191], v[44:47]
    ds_read_b64_tr_b16 v[164:165], v238 offset:0
    v_mfma_f32_16x16x32_bf16 v[48:51], v[208:211], v[188:191], v[48:51]
    ds_read_b64_tr_b16 v[166:167], v238 offset:4096
    v_mfma_f32_16x16x32_bf16 v[52:55], v[212:215], v[188:191], v[52:55]
    ds_read_b64_tr_b16 v[168:169], v235 offset:16384
    v_mfma_f32_16x16x32_bf16 v[56:59], v[216:219], v[188:191], v[56:59]
    v_mfma_f32_16x16x32_bf16 v[60:63], v[220:223], v[188:191], v[60:63]
    ds_read_b64_tr_b16 v[170:171], v235 offset:20480
    v_mfma_f32_16x16x32_bf16 v[64:67], v[224:227], v[188:191], v[64:67]
    ds_read_b64_tr_b16 v[172:173], v236 offset:16384
    v_mfma_f32_16x16x32_bf16 v[68:71], v[228:231], v[188:191], v[68:71]
    ds_read_b64_tr_b16 v[174:175], v236 offset:20480
    v_mfma_f32_16x16x32_bf16 v[72:75], v[200:203], v[192:195], v[72:75]
    ds_read_b64_tr_b16 v[176:177], v237 offset:16384
    v_mfma_f32_16x16x32_bf16 v[76:79], v[204:207], v[192:195], v[76:79]
    ds_read_b64_tr_b16 v[178:179], v237 offset:20480
    v_mfma_f32_16x16x32_bf16 v[80:83], v[208:211], v[192:195], v[80:83]
    v_mfma_f32_16x16x32_bf16 v[84:87], v[212:215], v[192:195], v[84:87]
    ds_read_b64_tr_b16 v[180:181], v238 offset:16384
    v_mfma_f32_16x16x32_bf16 v[88:91], v[216:219], v[192:195], v[88:91]
    ds_read_b64_tr_b16 v[182:183], v238 offset:20480
    v_mfma_f32_16x16x32_bf16 v[92:95], v[220:223], v[192:195], v[92:95]
    ds_read_b128 v[140:143], v232 offset:2048
    v_mfma_f32_16x16x32_bf16 v[96:99], v[224:227], v[192:195], v[96:99]
    ds_read_b128 v[144:147], v232 offset:4096
    v_mfma_f32_16x16x32_bf16 v[100:103], v[228:231], v[192:195], v[100:103]
    ds_read_b128 v[148:151], v232 offset:6144
    v_mfma_f32_16x16x32_bf16 v[104:107], v[200:203], v[196:199], v[104:107]
    v_mfma_f32_16x16x32_bf16 v[108:111], v[204:207], v[196:199], v[108:111]
    v_mfma_f32_16x16x32_bf16 v[112:115], v[208:211], v[196:199], v[112:115]
    v_mfma_f32_16x16x32_bf16 v[116:119], v[212:215], v[196:199], v[116:119]
    v_mfma_f32_16x16x32_bf16 v[120:123], v[216:219], v[196:199], v[120:123]
    v_mfma_f32_16x16x32_bf16 v[124:127], v[220:223], v[196:199], v[124:127]
    v_mfma_f32_16x16x32_bf16 v[128:131], v[224:227], v[196:199], v[128:131]
    s_add_u32 s52, s52, 49152
    s_cmp_ge_u32 s52, 147456
    s_cselect_b32 s52, 0, s52
    v_mfma_f32_16x16x32_bf16 v[132:135], v[228:231], v[196:199], v[132:135]
    s_waitcnt lgkmcnt(0)
    v_mfma_f32_16x16x32_bf16 v[8:11], v[152:155], v[136:139], v[8:11]
    ds_read_b128 v[184:187], v232 offset:1024
    v_mfma_f32_16x16x32_bf16 v[12:15], v[156:159], v[136:139], v[12:15]
    ds_read_b64_tr_b16 v[200:201], v235 offset:8192
    v_mfma_f32_16x16x32_bf16 v[16:19], v[160:163], v[136:139], v[16:19]
    ds_read_b64_tr_b16 v[202:203], v235 offset:12288
    v_mfma_f32_16x16x32_bf16 v[20:23], v[164:167], v[136:139], v[20:23]
    ds_read_b64_tr_b16 v[204:205], v236 offset:8192
    v_mfma_f32_16x16x32_bf16 v[24:27], v[168:171], v[136:139], v[24:27]
    v_mfma_f32_16x16x32_bf16 v[28:31], v[172:175], v[136:139], v[28:31]
    ds_read_b64_tr_b16 v[206:207], v236 offset:12288
    v_mfma_f32_16x16x32_bf16 v[32:35], v[176:179], v[136:139], v[32:35]
    ds_read_b64_tr_b16 v[208:209], v237 offset:8192
    v_mfma_f32_16x16x32_bf16 v[36:39], v[180:183], v[136:139], v[36:39]
    ds_read_b64_tr_b16 v[210:211], v237 offset:12288
    v_mfma_f32_16x16x32_bf16 v[40:43], v[152:155], v[140:143], v[40:43]
    ds_read_b64_tr_b16 v[212:213], v238 offset:8192
    v_mfma_f32_16x16x32_bf16 v[44:47], v[156:159], v[140:143], v[44:47]
    v_mfma_f32_16x16x32_bf16 v[48:51], v[160:163], v[140:143], v[48:51]
    ds_read_b64_tr_b16 v[214:215], v238 offset:12288
    v_mfma_f32_16x16x32_bf16 v[52:55], v[164:167], v[140:143], v[52:55]
    ds_read_b64_tr_b16 v[216:217], v235 offset:24576
    v_mfma_f32_16x16x32_bf16 v[56:59], v[168:171], v[140:143], v[56:59]
    ds_read_b64_tr_b16 v[218:219], v235 offset:28672
    v_mfma_f32_16x16x32_bf16 v[60:63], v[172:175], v[140:143], v[60:63]
    ds_read_b64_tr_b16 v[220:221], v236 offset:24576
    v_mfma_f32_16x16x32_bf16 v[64:67], v[176:179], v[140:143], v[64:67]
    v_mfma_f32_16x16x32_bf16 v[68:71], v[180:183], v[140:143], v[68:71]
    ds_read_b64_tr_b16 v[222:223], v236 offset:28672
    v_mfma_f32_16x16x32_bf16 v[72:75], v[152:155], v[144:147], v[72:75]
    s_movk_i32 s54, 12
M_Q_loop4:
    ds_read_b64_tr_b16 v[224:225], v237 offset:24576
    v_mfma_f32_16x16x32_bf16 v[76:79], v[156:159], v[144:147], v[76:79]
    ds_read_b64_tr_b16 v[226:227], v237 offset:28672
    v_mfma_f32_16x16x32_bf16 v[80:83], v[160:163], v[144:147], v[80:83]
    ds_read_b64_tr_b16 v[228:229], v238 offset:24576
    v_mfma_f32_16x16x32_bf16 v[84:87], v[164:167], v[144:147], v[84:87]
    v_mfma_f32_16x16x32_bf16 v[88:91], v[168:171], v[144:147], v[88:91]
    ds_read_b64_tr_b16 v[230:231], v238 offset:28672
    v_mfma_f32_16x16x32_bf16 v[92:95], v[172:175], v[144:147], v[92:95]
    ds_read_b128 v[188:191], v232 offset:3072
    v_mfma_f32_16x16x32_bf16 v[96:99], v[176:179], v[144:147], v[96:99]
    ds_read_b128 v[192:195], v232 offset:5120
    v_mfma_f32_16x16x32_bf16 v[100:103], v[180:183], v[144:147], v[100:103]
    ds_read_b128 v[196:199], v232 offset:7168
    v_mfma_f32_16x16x32_bf16 v[104:107], v[152:155], v[148:151], v[104:107]
    v_mfma_f32_16x16x32_bf16 v[108:111], v[156:159], v[148:151], v[108:111]
    v_add_u32 v232, s52, v233
    v_mfma_f32_16x16x32_bf16 v[112:115], v[160:163], v[148:151], v[112:115]
    v_add_u32 v235, s52, v239
    v_mfma_f32_16x16x32_bf16 v[116:119], v[164:167], v[148:151], v[116:119]
    v_add_u32 v236, s52, v240
    v_mfma_f32_16x16x32_bf16 v[120:123], v[168:171], v[148:151], v[120:123]
    v_mfma_f32_16x16x32_bf16 v[124:127], v[172:175], v[148:151], v[124:127]
    v_add_u32 v237, s52, v241
    v_mfma_f32_16x16x32_bf16 v[128:131], v[176:179], v[148:151], v[128:131]
    v_add_u32 v238, s52, v242
    v_mfma_f32_16x16x32_bf16 v[132:135], v[180:183], v[148:151], v[132:135]
    s_waitcnt lgkmcnt(0)
    v_mfma_f32_16x16x32_bf16 v[8:11], v[200:203], v[184:187], v[8:11]
    s_barrier
    v_mfma_f32_16x16x32_bf16 v[12:15], v[204:207], v[184:187], v[12:15]
    ds_read_b128 v[136:139], v232 offset:0
    v_mfma_f32_16x16x32_bf16 v[16:19], v[208:211], v[184:187], v[16:19]
    ds_read_b64_tr_b16 v[152:153], v235 offset:0
    v_mfma_f32_16x16x32_bf16 v[20:23], v[212:215], v[184:187], v[20:23]
    ds_read_b64_tr_b16 v[154:155], v235 offset:4096
    v_mfma_f32_16x16x32_bf16 v[24:27], v[216:219], v[184:187], v[24:27]
    ds_read_b64_tr_b16 v[156:157], v236 offset:0
    v_mfma_f32_16x16x32_bf16 v[28:31], v[220:223], v[184:187], v[28:31]
    ds_read_b64_tr_b16 v[158:159], v236 offset:4096
    v_mfma_f32_16x16x32_bf16 v[32:35], v[224:227], v[184:187], v[32:35]
    v_mfma_f32_16x16x32_bf16 v[36:39], v[228:231], v[184:187], v[36:39]
    ds_read_b64_tr_b16 v[160:161], v237 offset:0
    v_mfma_f32_16x16x32_bf16 v[40:43], v[200:203], v[188:191], v[40:43]
    ds_read_b64_tr_b16 v[162:163], v237 offset:4096
    v_mfma_f32_16x16x32_bf16 v[44:47], v[204:207], v[188:191], v[44:47]
    ds_read_b64_tr_b16 v[164:165], v238 offset:0
    v_mfma_f32_16x16x32_bf16 v[48:51], v[208:211], v[188:191], v[48:51]
    ds_read_b64_tr_b16 v[166:167], v238 offset:4096
    v_mfma_f32_16x16x32_bf16 v[52:55], v[212:215], v[188:191], v[52:55]
    ds_read_b64_tr_b16 v[168:169], v235 offset:16384
    v_mfma_f32_16x16x32_bf16 v[56:59], v[216:219], v[188:191], v[56:59]
    v_mfma_f32_16x16x32_bf16 v[60:63], v[220:223], v[188:191], v[60:63]
    ds_read_b64_tr_b16 v[170:171], v235 offset:20480
    v_mfma_f32_16x16x32_bf16 v[64:67], v[224:227], v[188:191], v[64:67]
    ds_read_b64_tr_b16 v[172:173], v236 offset:16384
    v_mfma_f32_16x16x32_bf16 v[68:71], v[228:231], v[188:191], v[68:71]
    ds_read_b64_tr_b16 v[174:175], v236 offset:20480
    v_mfma_f32_16x16x32_bf16 v[72:75], v[200:203], v[192:195], v[72:75]
    ds_read_b64_tr_b16 v[176:177], v237 offset:16384
    v_mfma_f32_16x16x32_bf16 v[76:79], v[204:207], v[192:195], v[76:79]
    ds_read_b64_tr_b16 v[178:179], v237 offset:20480
    v_mfma_f32_16x16x32_bf16 v[80:83], v[208:211], v[192:195], v[80:83]
    v_mfma_f32_16x16x32_bf16 v[84:87], v[212:215], v[192:195], v[84:87]
    ds_read_b64_tr_b16 v[180:181], v238 offset:16384
    v_mfma_f32_16x16x32_bf16 v[88:91], v[216:219], v[192:195], v[88:91]
    ds_read_b64_tr_b16 v[182:183], v238 offset:20480
    v_mfma_f32_16x16x32_bf16 v[92:95], v[220:223], v[192:195], v[92:95]
    ds_read_b128 v[140:143], v232 offset:2048
    v_mfma_f32_16x16x32_bf16 v[96:99], v[224:227], v[192:195], v[96:99]
    ds_read_b128 v[144:147], v232 offset:4096
    v_mfma_f32_16x16x32_bf16 v[100:103], v[228:231], v[192:195], v[100:103]
    ds_read_b128 v[148:151], v232 offset:6144
    v_mfma_f32_16x16x32_bf16 v[104:107], v[200:203], v[196:199], v[104:107]
    v_mfma_f32_16x16x32_bf16 v[108:111], v[204:207], v[196:199], v[108:111]
    v_mfma_f32_16x16x32_bf16 v[112:115], v[208:211], v[196:199], v[112:115]
    v_mfma_f32_16x16x32_bf16 v[116:119], v[212:215], v[196:199], v[116:119]
    v_mfma_f32_16x16x32_bf16 v[120:123], v[216:219], v[196:199], v[120:123]
    v_mfma_f32_16x16x32_bf16 v[124:127], v[220:223], v[196:199], v[124:127]
    v_mfma_f32_16x16x32_bf16 v[128:131], v[224:227], v[196:199], v[128:131]
    s_add_u32 s52, s52, 49152
    s_cmp_ge_u32 s52, 147456
    s_cselect_b32 s52, 0, s52
    v_mfma_f32_16x16x32_bf16 v[132:135], v[228:231], v[196:199], v[132:135]
    s_waitcnt lgkmcnt(0)
    v_mfma_f32_16x16x32_bf16 v[8:11], v[152:155], v[136:139], v[8:11]
    ds_read_b128 v[184:187], v232 offset:1024
    v_mfma_f32_16x16x32_bf16 v[12:15], v[156:159], v[136:139], v[12:15]
    ds_read_b64_tr_b16 v[200:201], v235 offset:8192
    v_mfma_f32_16x16x32_bf16 v[16:19], v[160:163], v[136:139], v[16:19]
    ds_read_b64_tr_b16 v[202:203], v235 offset:12288
    v_mfma_f32_16x16x32_bf16 v[20:23], v[164:167], v[136:139], v[20:23]
    ds_read_b64_tr_b16 v[204:205], v236 offset:8192
    v_mfma_f32_16x16x32_bf16 v[24:27], v[168:171], v[136:139], v[24:27]
    v_mfma_f32_16x16x32_bf16 v[28:31], v[172:175], v[136:139], v[28:31]
    ds_read_b64_tr_b16 v[206:207], v236 offset:12288
    v_mfma_f32_16x16x32_bf16 v[32:35], v[176:179], v[136:139], v[32:35]
    ds_read_b64_tr_b16 v[208:209], v237 offset:8192
    v_mfma_f32_16x16x32_bf16 v[36:39], v[180:183], v[136:139], v[36:39]
    ds_read_b64_tr_b16 v[210:211], v237 offset:12288
    v_mfma_f32_16x16x32_bf16 v[40:43], v[152:155], v[140:143], v[40:43]
    ds_read_b64_tr_b16 v[212:213], v238 offset:8192
    v_mfma_f32_16x16x32_bf16 v[44:47], v[156:159], v[140:143], v[44:47]
    v_mfma_f32_16x16x32_bf16 v[48:51], v[160:163], v[140:143], v[48:51]
    ds_read_b64_tr_b16 v[214:215], v238 offset:12288
    v_mfma_f32_16x16x32_bf16 v[52:55], v[164:167], v[140:143], v[52:55]
    ds_read_b64_tr_b16 v[216:217], v235 offset:24576
    v_mfma_f32_16x16x32_bf16 v[56:59], v[168:171], v[140:143], v[56:59]
    ds_read_b64_tr_b16 v[218:219], v235 offset:28672
    v_mfma_f32_16x16x32_bf16 v[60:63], v[172:175], v[140:143], v[60:63]
    ds_read_b64_tr_b16 v[220:221], v236 offset:24576
    v_mfma_f32_16x16x32_bf16 v[64:67], v[176:179], v[140:143], v[64:67]
    v_mfma_f32_16x16x32_bf16 v[68:71], v[180:183], v[140:143], v[68:71]
    s_sub_u32 s54, s54, 1
    ds_read_b64_tr_b16 v[222:223], v236 offset:28672
    v_mfma_f32_16x16x32_bf16 v[72:75], v[152:155], v[144:147], v[72:75]
    s_cbranch_scc0 M_Q_loop4
    ds_read_b64_tr_b16 v[224:225], v237 offset:24576
    v_mfma_f32_16x16x32_bf16 v[76:79], v[156:159], v[144:147], v[76:79]
    ds_read_b64_tr_b16 v[226:227], v237 offset:28672
    v_mfma_f32_16x16x32_bf16 v[80:83], v[160:163], v[144:147], v[80:83]
    ds_read_b64_tr_b16 v[228:229], v238 offset:24576
    v_mfma_f32_16x16x32_bf16 v[84:87], v[164:167], v[144:147], v[84:87]
    v_mfma_f32_16x16x32_bf16 v[88:91], v[168:171], v[144:147], v[88:91]
    ds_read_b64_tr_b16 v[230:231], v238 offset:28672
    v_mfma_f32_16x16x32_bf16 v[92:95], v[172:175], v[144:147], v[92:95]
    ds_read_b128 v[188:191], v232 offset:3072
    v_mfma_f32_16x16x32_bf16 v[96:99], v[176:179], v[144:147], v[96:99]
    ds_read_b128 v[192:195], v232 offset:5120
    v_mfma_f32_16x16x32_bf16 v[100:103], v[180:183], v[144:147], v[100:103]
    ds_read_b128 v[196:199], v232 offset:7168
    v_mfma_f32_16x16x32_bf16 v[104:107], v[152:155], v[148:151], v[104:107]
    v_mfma_f32_16x16x32_bf16 v[108:111], v[156:159], v[148:151], v[108:111]
    v_mfma_f32_16x16x32_bf16 v[112:115], v[160:163], v[148:151], v[112:115]
    v_mfma_f32_16x16x32_bf16 v[116:119], v[164:167], v[148:151], v[116:119]
    v_mfma_f32_16x16x32_bf16 v[120:123], v[168:171], v[148:151], v[120:123]
    v_mfma_f32_16x16x32_bf16 v[124:127], v[172:175], v[148:151], v[124:127]
    v_mfma_f32_16x16x32_bf16 v[128:131], v[176:179], v[148:151], v[128:131]
    v_mfma_f32_16x16x32_bf16 v[132:135], v[180:183], v[148:151], v[132:135]
    s_waitcnt lgkmcnt(0)
    v_mfma_f32_16x16x32_bf16 v[8:11], v[200:203], v[184:187], v[8:11]
    s_barrier
    v_mfma_f32_16x16x32_bf16 v[12:15], v[204:207], v[184:187], v[12:15]
    v_mfma_f32_16x16x32_bf16 v[16:19], v[208:211], v[184:187], v[16:19]
    v_mfma_f32_16x16x32_bf16 v[20:23], v[212:215], v[184:187], v[20:23]
    v_mfma_f32_16x16x32_bf16 v[24:27], v[216:219], v[184:187], v[24:27]
    v_mfma_f32_16x16x32_bf16 v[28:31], v[220:223], v[184:187], v[28:31]
    v_mfma_f32_16x16x32_bf16 v[32:35], v[224:227], v[184:187], v[32:35]
    v_mfma_f32_16x16x32_bf16 v[36:39], v[228:231], v[184:187], v[36:39]
    v_mfma_f32_16x16x32_bf16 v[40:43], v[200:203], v[188:191], v[40:43]
    v_mfma_f32_16x16x32_bf16 v[44:47], v[204:207], v[188:191], v[44:47]
    v_mfma_f32_16x16x32_bf16 v[48:51], v[208:211], v[188:191], v[48:51]
    v_mfma_f32_16x16x32_bf16 v[52:55], v[212:215], v[188:191], v[52:55]
    v_mfma_f32_16x16x32_bf16 v[56:59], v[216:219], v[188:191], v[56:59]
    v_mfma_f32_16x16x32_bf16 v[60:63], v[220:223], v[188:191], v[60:63]
    v_mfma_f32_16x16x32_bf16 v[64:67], v[224:227], v[188:191], v[64:67]
    v_mfma_f32_16x16x32_bf16 v[68:71], v[228:231], v[188:191], v[68:71]
    v_mfma_f32_16x16x32_bf16 v[72:75], v[200:203], v[192:195], v[72:75]
    v_mfma_f32_16x16x32_bf16 v[76:79], v[204:207], v[192:195], v[76:79]
    v_mfma_f32_16x16x32_bf16 v[80:83], v[208:211], v[192:195], v[80:83]
    v_mfma_f32_16x16x32_bf16 v[84:87], v[212:215], v[192:195], v[84:87]
    v_mfma_f32_16x16x32_bf16 v[88:91], v[216:219], v[192:195], v[88:91]
    v_mfma_f32_16x16x32_bf16 v[92:95], v[220:223], v[192:195], v[92:95]
    v_mfma_f32_16x16x32_bf16 v[96:99], v[224:227], v[192:195], v[96:99]
    v_mfma_f32_16x16x32_bf16 v[100:103], v[228:231], v[192:195], v[100:103]
    v_mfma_f32_16x16x32_bf16 v[104:107], v[200:203], v[196:199], v[104:107]
    v_mfma_f32_16x16x32_bf16 v[108:111], v[204:207], v[196:199], v[108:111]
    v_mfma_f32_16x16x32_bf16 v[112:115], v[208:211], v[196:199], v[112:115]
    v_mfma_f32_16x16x32_bf16 v[116:119], v[212:215], v[196:199], v[116:119]
    v_mfma_f32_16x16x32_bf16 v[120:123], v[216:219], v[196:199], v[120:123]
    v_mfma_f32_16x16x32_bf16 v[124:127], v[220:223], v[196:199], v[124:127]
    v_mfma_f32_16x16x32_bf16 v[128:131], v[224:227], v[196:199], v[128:131]
    v_mfma_f32_16x16x32_bf16 v[132:135], v[228:231], v[196:199], v[132:135]
M_Qjoin:
    s_setprio 0
    s_lshl_b32 s60, s44, 12
    s_add_u32 s61, s60, 147456
    s_add_u32 s53, s60, 98304
    s_bfe_u32 s66, s2, 0x30003
    s_lshr_b32 s55, s2, 6
    s_add_u32 s66, s66, s55
    s_and_b32 s66, s66, 3
    s_mov_b32 s58, 0x31076453
    s_mov_b32 s59, 0x542
    s_cmp_eq_u32 s66, 1
    s_cselect_b32 s58, 0x20175643, s58
    s_cselect_b32 s59, 0x534, s59
    s_cmp_eq_u32 s66, 2
    s_cselect_b32 s58, 0x21067542, s58
    s_cselect_b32 s59, 0x453, s59
    s_cmp_eq_u32 s66, 3
    s_cselect_b32 s58, 0x20176534, s58
    s_cselect_b32 s59, 0x543, s59
    s_lshl_b32 s55, s49, 3
    s_mov_b32 s32, s16
    s_mov_b32 s33, s17
    s_mov_b32 s34, 0x700000
    s_mov_b32 s35, 0x20000
    s_add_u32 s36, s16, 0x100
    s_addc_u32 s37, s17, 0
    s_mov_b32 s38, 0x6fff00
    s_mov_b32 s39, 0x20000
    s_lshr_b32 s62, s48, 2
    s_sub_u32 s62, s48, s62
    s_add_u32 s62, s62, 16
    s_lshl_b32 s70, s62, 12
    s_lshl_b32 s64, s47, 3
    s_lshl_b32 s65, s45, 2
    s_add_u32 s64, s64, s65
    s_mul_i32 s64, s64, 114688
    s_add_u32 s64, s64, s70
    s_lshl_b32 s65, s46, 11
    s_add_u32 s64, s64, s65
    s_add_u32 s64, s64, 0x1500000
    s_or_b32 s64, s64, s69
    v_lshl_add_u32 v198, v1, 4, s64
    v_mul_f32 v24, v8, v24
    v_exp_f32 v216, -v8
    v_mul_f32 v25, v9, v25
    v_exp_f32 v217, -v9
    v_mul_f32 v26, v10, v26
    v_exp_f32 v218, -v10
    v_mul_f32 v27, v11, v27
    v_exp_f32 v219, -v11
    v_mul_f32 v28, v12, v28
    v_exp_f32 v220, -v12
    v_mul_f32 v29, v13, v29
    v_exp_f32 v221, -v13
    v_mul_f32 v30, v14, v30
    v_exp_f32 v222, -v14
    v_mul_f32 v31, v15, v31
    v_exp_f32 v223, -v15
    v_fma_f32 v216, v216, s67, s67
    v_fma_f32 v217, v217, s67, s67
    v_rcp_f32 v216, v216
    v_fma_f32 v218, v218, s67, s67
    v_rcp_f32 v217, v217
    v_fma_f32 v219, v219, s67, s67
    v_rcp_f32 v218, v218
    v_fma_f32 v220, v220, s67, s67
    v_rcp_f32 v219, v219
    v_fma_f32 v221, v221, s67, s67
    v_rcp_f32 v220, v220
    v_fma_f32 v222, v222, s67, s67
    v_rcp_f32 v221, v221
    v_fma_f32 v223, v223, s67, s67
    v_rcp_f32 v222, v222
    v_rcp_f32 v223, v223
    v_mul_f32 v24, v24, v216
    v_mul_f32 v25, v25, v217
    v_mul_f32 v26, v26, v218
    v_mul_f32 v27, v27, v219
    v_mul_f32 v28, v28, v220
    v_mul_f32 v29, v29, v221
    v_mul_f32 v30, v30, v222
    v_mul_f32 v31, v31, v223
    s_barrier
    s_and_b32 s57, s58, 15
    s_lshr_b64 s[58:59], s[58:59], 4
    s_add_u32 s57, s57, s55
    s_lshl_b32 s56, s57, 11
    s_mul_i32 s57, s57, 0x20000
    s_add_u32 m0, s53, 16384
    s_nop 0
    buffer_load_dwordx4 v248, s[32:35], s57 offen offset:0 lds
    v_cvt_pk_bf16_f32 v200, v24, v25
    v_cvt_pk_bf16_f32 v201, v26, v27
    v_cvt_pk_bf16_f32 v202, v28, v29
    v_cvt_pk_bf16_f32 v203, v30, v31
    buffer_load_dwordx4 v249, s[32:35], s57 offen offset:1024 lds
    v_mul_f32 v32, v16, v32
    v_exp_f32 v224, -v16
    v_mul_f32 v33, v17, v33
    v_exp_f32 v225, -v17
    v_mul_f32 v34, v18, v34
    buffer_load_dwordx4 v250, s[32:35], s57 offen offset:2048 lds
    v_exp_f32 v226, -v18
    v_mul_f32 v35, v19, v35
    v_exp_f32 v227, -v19
    v_mul_f32 v36, v20, v36
    v_exp_f32 v228, -v20
    v_mul_f32 v37, v21, v37
    buffer_load_dwordx4 v251, s[32:35], s57 offen offset:3072 lds
    v_exp_f32 v229, -v21
    v_mul_f32 v38, v22, v38
    v_exp_f32 v230, -v22
    v_mul_f32 v39, v23, v39
    s_add_u32 m0, s53, 32768
    s_nop 0
    buffer_load_dwordx4 v248, s[36:39], s57 offen offset:0 lds
    v_exp_f32 v231, -v23
    v_fma_f32 v224, v224, s67, s67
    v_fma_f32 v225, v225, s67, s67
    v_rcp_f32 v224, v224
    v_fma_f32 v226, v226, s67, s67
    v_rcp_f32 v225, v225
    buffer_load_dwordx4 v249, s[36:39], s57 offen offset:1024 lds
    v_fma_f32 v227, v227, s67, s67
    v_rcp_f32 v226, v226
    v_fma_f32 v228, v228, s67, s67
    v_rcp_f32 v227, v227
    v_fma_f32 v229, v229, s67, s67
    v_rcp_f32 v228, v228
    buffer_load_dwordx4 v250, s[36:39], s57 offen offset:2048 lds
    v_fma_f32 v230, v230, s67, s67
    v_rcp_f32 v229, v229
    v_fma_f32 v231, v231, s67, s67
    v_rcp_f32 v230, v230
    buffer_load_dwordx4 v251, s[36:39], s57 offen offset:3072 lds
    v_rcp_f32 v231, v231
    v_mul_f32 v32, v32, v224
    v_mul_f32 v33, v33, v225
    v_mul_f32 v34, v34, v226
    v_mul_f32 v35, v35, v227
    v_mul_f32 v36, v36, v228
    s_mov_b32 m0, s53
    s_nop 0
    buffer_load_dwordx4 v246, s[28:31], s56 offen offset:0 sc1 lds
    v_mul_f32 v37, v37, v229
    v_mul_f32 v38, v38, v230
    v_mul_f32 v39, v39, v231
    v_cvt_pk_bf16_f32 v204, v32, v33
    v_cvt_pk_bf16_f32 v205, v34, v35
    v_cvt_pk_bf16_f32 v206, v36, v37
    buffer_load_dwordx4 v246, s[28:31], s56 offen offset:1024 sc1 lds
    v_cvt_pk_bf16_f32 v207, v38, v39
    v_mul_f32 v56, v40, v56
    v_exp_f32 v216, -v40
    v_mul_f32 v57, v41, v57
    buffer_load_dwordx4 v247, s[28:31], s56 offen offset:2048 sc1 lds
    v_exp_f32 v217, -v41
    v_mul_f32 v58, v42, v58
    v_exp_f32 v218, -v42
    v_mul_f32 v59, v43, v59
    buffer_load_dwordx4 v247, s[28:31], s56 offen offset:3072 sc1 lds
    v_exp_f32 v219, -v43
    v_mul_f32 v60, v44, v60
    v_exp_f32 v220, -v44
    v_mul_f32 v61, v45, v61
    v_exp_f32 v221, -v45
    v_mul_f32 v62, v46, v62
    s_add_u32 s53, s53, 49152
    s_cmp_ge_u32 s53, s61
    s_cselect_b32 s53, s60, s53
    buffer_store_dwordx4 v[200:203], v198, s[28:31], 0 offen offset:0 sc1
    buffer_store_dwordx4 v[204:207], v198, s[28:31], 0 offen offset:1024 sc1
    v_add_u32 v198, 114688, v198
    s_barrier
    s_and_b32 s57, s58, 15
    s_lshr_b64 s[58:59], s[58:59], 4
    s_add_u32 s57, s57, s55
    s_lshl_b32 s56, s57, 11
    s_mul_i32 s57, s57, 0x20000
    s_add_u32 m0, s53, 16384
    s_nop 0
    buffer_load_dwordx4 v248, s[32:35], s57 offen offset:0 lds
    v_exp_f32 v222, -v46
    v_mul_f32 v63, v47, v63
    v_exp_f32 v223, -v47
    v_fma_f32 v216, v216, s67, s67
    v_fma_f32 v217, v217, s67, s67
    v_rcp_f32 v216, v216
    buffer_load_dwordx4 v249, s[32:35], s57 offen offset:1024 lds
    v_fma_f32 v218, v218, s67, s67
    v_rcp_f32 v217, v217
    v_fma_f32 v219, v219, s67, s67
    v_rcp_f32 v218, v218
    buffer_load_dwordx4 v250, s[32:35], s57 offen offset:2048 lds
    v_fma_f32 v220, v220, s67, s67
    v_rcp_f32 v219, v219
    v_fma_f32 v221, v221, s67, s67
    v_rcp_f32 v220, v220
    v_fma_f32 v222, v222, s67, s67
    v_rcp_f32 v221, v221
    buffer_load_dwordx4 v251, s[32:35], s57 offen offset:3072 lds
    v_fma_f32 v223, v223, s67, s67
    v_rcp_f32 v222, v222
    v_rcp_f32 v223, v223
    v_mul_f32 v56, v56, v216
    v_mul_f32 v57, v57, v217
    v_mul_f32 v58, v58, v218
    s_add_u32 m0, s53, 32768
    s_nop 0
    buffer_load_dwordx4 v248, s[36:39], s57 offen offset:0 lds
    v_mul_f32 v59, v59, v219
    v_mul_f32 v60, v60, v220
    v_mul_f32 v61, v61, v221
    v_mul_f32 v62, v62, v222
    buffer_load_dwordx4 v249, s[36:39], s57 offen offset:1024 lds
    v_mul_f32 v63, v63, v223
    v_cvt_pk_bf16_f32 v208, v56, v57
    v_cvt_pk_bf16_f32 v209, v58, v59
    v_cvt_pk_bf16_f32 v210, v60, v61
    v_cvt_pk_bf16_f32 v211, v62, v63
    buffer_load_dwordx4 v250, s[36:39], s57 offen offset:2048 lds
    v_mul_f32 v64, v48, v64
    v_exp_f32 v224, -v48
    v_mul_f32 v65, v49, v65
    v_exp_f32 v225, -v49
    v_mul_f32 v66, v50, v66
    v_exp_f32 v226, -v50
    buffer_load_dwordx4 v251, s[36:39], s57 offen offset:3072 lds
    v_mul_f32 v67, v51, v67
    v_exp_f32 v227, -v51
    v_mul_f32 v68, v52, v68
    v_exp_f32 v228, -v52
    v_mul_f32 v69, v53, v69
    v_exp_f32 v229, -v53
    s_mov_b32 m0, s53
    s_nop 0
    buffer_load_dwordx4 v246, s[28:31], s56 offen offset:0 sc1 lds
    v_mul_f32 v70, v54, v70
    v_exp_f32 v230, -v54
    v_mul_f32 v71, v55, v71
    v_exp_f32 v231, -v55
    buffer_load_dwordx4 v246, s[28:31], s56 offen offset:1024 sc1 lds
    v_fma_f32 v224, v224, s67, s67
    v_fma_f32 v225, v225, s67, s67
    v_rcp_f32 v224, v224
    v_fma_f32 v226, v226, s67, s67
    v_rcp_f32 v225, v225
    v_fma_f32 v227, v227, s67, s67
    buffer_load_dwordx4 v247, s[28:31], s56 offen offset:2048 sc1 lds
    v_rcp_f32 v226, v226
    v_fma_f32 v228, v228, s67, s67
    v_rcp_f32 v227, v227
    v_fma_f32 v229, v229, s67, s67
    v_rcp_f32 v228, v228
    v_fma_f32 v230, v230, s67, s67
    buffer_load_dwordx4 v247, s[28:31], s56 offen offset:3072 sc1 lds
    v_rcp_f32 v229, v229
    v_fma_f32 v231, v231, s67, s67
    v_rcp_f32 v230, v230
    v_rcp_f32 v231, v231
    s_add_u32 s53, s53, 49152
    s_cmp_ge_u32 s53, s61
    s_cselect_b32 s53, s60, s53
    buffer_store_dwordx4 v[208:211], v198, s[28:31], 0 offen offset:0 sc1
    s_waitcnt vmcnt(15)
    s_barrier
    s_and_b32 s57, s58, 15
    s_lshr_b64 s[58:59], s[58:59], 4
    s_add_u32 s57, s57, s55
    s_lshl_b32 s56, s57, 11
    s_mul_i32 s57, s57, 0x20000
    s_add_u32 m0, s53, 16384
    s_nop 0
    buffer_load_dwordx4 v248, s[32:35], s57 offen offset:0 lds
    v_mul_f32 v64, v64, v224
    v_mul_f32 v65, v65, v225
    v_mul_f32 v66, v66, v226
    v_mul_f32 v67, v67, v227
    v_mul_f32 v68, v68, v228
    v_mul_f32 v69, v69, v229
    buffer_load_dwordx4 v249, s[32:35], s57 offen offset:1024 lds
    v_mul_f32 v70, v70, v230
    v_mul_f32 v71, v71, v231
    v_cvt_pk_bf16_f32 v212, v64, v65
    v_cvt_pk_bf16_f32 v213, v66, v67
    v_cvt_pk_bf16_f32 v214, v68, v69
    v_cvt_pk_bf16_f32 v215, v70, v71
    buffer_load_dwordx4 v250, s[32:35], s57 offen offset:2048 lds
    v_mul_f32 v88, v72, v88
    v_exp_f32 v216, -v72
    buffer_load_dwordx4 v251, s[32:35], s57 offen offset:3072 lds
    v_mul_f32 v89, v73, v89
    v_exp_f32 v217, -v73
    v_mul_f32 v90, v74, v90
    v_exp_f32 v218, -v74
    v_mul_f32 v91, v75, v91
    v_exp_f32 v219, -v75
    s_add_u32 m0, s53, 32768
    s_nop 0
    buffer_load_dwordx4 v248, s[36:39], s57 offen offset:0 lds
    v_mul_f32 v92, v76, v92
    v_exp_f32 v220, -v76
    v_mul_f32 v93, v77, v93
    v_exp_f32 v221, -v77
    v_mul_f32 v94, v78, v94
    v_exp_f32 v222, -v78
    buffer_load_dwordx4 v249, s[36:39], s57 offen offset:1024 lds
    v_mul_f32 v95, v79, v95
    v_exp_f32 v223, -v79
    v_fma_f32 v216, v216, s67, s67
    v_fma_f32 v217, v217, s67, s67
    v_rcp_f32 v216, v216
    v_fma_f32 v218, v218, s67, s67
    buffer_load_dwordx4 v250, s[36:39], s57 offen offset:2048 lds
    v_rcp_f32 v217, v217
    v_fma_f32 v219, v219, s67, s67
    v_rcp_f32 v218, v218
    v_fma_f32 v220, v220, s67, s67
    buffer_load_dwordx4 v251, s[36:39], s57 offen offset:3072 lds
    v_rcp_f32 v219, v219
    v_fma_f32 v221, v221, s67, s67
    v_rcp_f32 v220, v220
    v_fma_f32 v222, v222, s67, s67
    v_rcp_f32 v221, v221
    v_fma_f32 v223, v223, s67, s67
    s_mov_b32 m0, s53
    s_nop 0
    buffer_load_dwordx4 v246, s[28:31], s56 offen offset:0 sc1 lds
    v_rcp_f32 v222, v222
    v_rcp_f32 v223, v223
    v_mul_f32 v88, v88, v216
    v_mul_f32 v89, v89, v217
    v_mul_f32 v90, v90, v218
    v_mul_f32 v91, v91, v219
    buffer_load_dwordx4 v246, s[28:31], s56 offen offset:1024 sc1 lds
    v_mul_f32 v92, v92, v220
    v_mul_f32 v93, v93, v221
    v_mul_f32 v94, v94, v222
    v_mul_f32 v95, v95, v223
    buffer_load_dwordx4 v247, s[28:31], s56 offen offset:2048 sc1 lds
    v_cvt_pk_bf16_f32 v200, v88, v89
    v_cvt_pk_bf16_f32 v201, v90, v91
    v_cvt_pk_bf16_f32 v202, v92, v93
    v_cvt_pk_bf16_f32 v203, v94, v95
    v_mul_f32 v96, v80, v96
    buffer_load_dwordx4 v247, s[28:31], s56 offen offset:3072 sc1 lds
    v_exp_f32 v224, -v80
    v_mul_f32 v97, v81, v97
    v_exp_f32 v225, -v81
    v_mul_f32 v98, v82, v98
    v_exp_f32 v226, -v82
    v_mul_f32 v99, v83, v99
    s_add_u32 s53, s53, 49152
    s_cmp_ge_u32 s53, s61
    s_cselect_b32 s53, s60, s53
    buffer_store_dwordx4 v[212:215], v198, s[28:31], 0 offen offset:1024 sc1
    v_add_u32 v198, 114688, v198
    buffer_store_dwordx4 v[200:203], v198, s[28:31], 0 offen offset:0 sc1
    s_waitcnt vmcnt(15)
    s_barrier
    s_and_b32 s57, s58, 15
    s_lshr_b64 s[58:59], s[58:59], 4
    s_add_u32 s57, s57, s55
    s_lshl_b32 s56, s57, 11
    s_mul_i32 s57, s57, 0x20000
    s_add_u32 m0, s53, 16384
    s_nop 0
    buffer_load_dwordx4 v248, s[32:35], s57 offen offset:0 lds
    v_exp_f32 v227, -v83
    v_mul_f32 v100, v84, v100
    v_exp_f32 v228, -v84
    v_mul_f32 v101, v85, v101
    buffer_load_dwordx4 v249, s[32:35], s57 offen offset:1024 lds
    v_exp_f32 v229, -v85
    v_mul_f32 v102, v86, v102
    v_exp_f32 v230, -v86
    v_mul_f32 v103, v87, v103
    v_exp_f32 v231, -v87
    v_fma_f32 v224, v224, s67, s67
    buffer_load_dwordx4 v250, s[32:35], s57 offen offset:2048 lds
    v_fma_f32 v225, v225, s67, s67
    v_rcp_f32 v224, v224
    v_fma_f32 v226, v226, s67, s67
    v_rcp_f32 v225, v225
    v_fma_f32 v227, v227, s67, s67
    v_rcp_f32 v226, v226
    buffer_load_dwordx4 v251, s[32:35], s57 offen offset:3072 lds
    v_fma_f32 v228, v228, s67, s67
    v_rcp_f32 v227, v227
    v_fma_f32 v229, v229, s67, s67
    v_rcp_f32 v228, v228
    v_fma_f32 v230, v230, s67, s67
    v_rcp_f32 v229, v229
    s_add_u32 m0, s53, 32768
    s_nop 0
    buffer_load_dwordx4 v248, s[36:39], s57 offen offset:0 lds
    v_fma_f32 v231, v231, s67, s67
    v_rcp_f32 v230, v230
    v_rcp_f32 v231, v231
    v_mul_f32 v96, v96, v224
    buffer_load_dwordx4 v249, s[36:39], s57 offen offset:1024 lds
    v_mul_f32 v97, v97, v225
    v_mul_f32 v98, v98, v226
    v_mul_f32 v99, v99, v227
    v_mul_f32 v100, v100, v228
    v_mul_f32 v101, v101, v229
    v_mul_f32 v102, v102, v230
    buffer_load_dwordx4 v250, s[36:39], s57 offen offset:2048 lds
    v_mul_f32 v103, v103, v231
    v_cvt_pk_bf16_f32 v204, v96, v97
    v_cvt_pk_bf16_f32 v205, v98, v99
    v_cvt_pk_bf16_f32 v206, v100, v101
    v_cvt_pk_bf16_f32 v207, v102, v103
    buffer_load_dwordx4 v251, s[36:39], s57 offen offset:3072 lds
    v_mul_f32 v120, v104, v120
    v_exp_f32 v216, -v104
    v_mul_f32 v121, v105, v121
    s_mov_b32 m0, s53
    s_nop 0
    buffer_load_dwordx4 v246, s[28:31], s56 offen offset:0 sc1 lds
    v_exp_f32 v217, -v105
    v_mul_f32 v122, v106, v122
    v_exp_f32 v218, -v106
    v_mul_f32 v123, v107, v123
    v_exp_f32 v219, -v107
    v_mul_f32 v124, v108, v124
    buffer_load_dwordx4 v246, s[28:31], s56 offen offset:1024 sc1 lds
    v_exp_f32 v220, -v108
    v_mul_f32 v125, v109, v125
    v_exp_f32 v221, -v109
    v_mul_f32 v126, v110, v126
    v_exp_f32 v222, -v110
    v_mul_f32 v127, v111, v127
    buffer_load_dwordx4 v247, s[28:31], s56 offen offset:2048 sc1 lds
    v_exp_f32 v223, -v111
    v_fma_f32 v216, v216, s67, s67
    v_fma_f32 v217, v217, s67, s67
    v_rcp_f32 v216, v216
    buffer_load_dwordx4 v247, s[28:31], s56 offen offset:3072 sc1 lds
    v_fma_f32 v218, v218, s67, s67
    v_rcp_f32 v217, v217
    v_fma_f32 v219, v219, s67, s67
    v_rcp_f32 v218, v218
    v_fma_f32 v220, v220, s67, s67
    v_rcp_f32 v219, v219
    s_add_u32 s53, s53, 49152
    s_cmp_ge_u32 s53, s61
    s_cselect_b32 s53, s60, s53
    buffer_store_dwordx4 v[204:207], v198, s[28:31], 0 offen offset:1024 sc1
    v_add_u32 v198, 114688, v198
    s_waitcnt vmcnt(15)
    s_barrier
    s_and_b32 s57, s58, 15
    s_lshr_b64 s[58:59], s[58:59], 4
    s_add_u32 s57, s57, s55
    s_lshl_b32 s56, s57, 11
    s_mul_i32 s57, s57, 0x20000
    s_add_u32 m0, s53, 16384
    s_nop 0
    buffer_load_dwordx4 v248, s[32:35], s57 offen offset:0 lds
    v_fma_f32 v221, v221, s67, s67
    v_rcp_f32 v220, v220
    v_fma_f32 v222, v222, s67, s67
    v_rcp_f32 v221, v221
    v_fma_f32 v223, v223, s67, s67
    v_rcp_f32 v222, v222
    buffer_load_dwordx4 v249, s[32:35], s57 offen offset:1024 lds
    v_rcp_f32 v223, v223
    v_mul_f32 v120, v120, v216
    v_mul_f32 v121, v121, v217
    v_mul_f32 v122, v122, v218
    v_mul_f32 v123, v123, v219
    v_mul_f32 v124, v124, v220
    buffer_load_dwordx4 v250, s[32:35], s57 offen offset:2048 lds
    v_mul_f32 v125, v125, v221
    v_mul_f32 v126, v126, v222
    v_mul_f32 v127, v127, v223
    v_cvt_pk_bf16_f32 v208, v120, v121
    buffer_load_dwordx4 v251, s[32:35], s57 offen offset:3072 lds
    v_cvt_pk_bf16_f32 v209, v122, v123
    v_cvt_pk_bf16_f32 v210, v124, v125
    v_cvt_pk_bf16_f32 v211, v126, v127
    v_mul_f32 v128, v112, v128
    v_exp_f32 v224, -v112
    s_add_u32 m0, s53, 32768
    s_nop 0
    buffer_load_dwordx4 v248, s[36:39], s57 offen offset:0 lds
    v_mul_f32 v129, v113, v129
    v_exp_f32 v225, -v113
    v_mul_f32 v130, v114, v130
    v_exp_f32 v226, -v114
    v_mul_f32 v131, v115, v131
    v_exp_f32 v227, -v115
    buffer_load_dwordx4 v249, s[36:39], s57 offen offset:1024 lds
    v_mul_f32 v132, v116, v132
    v_exp_f32 v228, -v116
    v_mul_f32 v133, v117, v133
    v_exp_f32 v229, -v117
    buffer_load_dwordx4 v250, s[36:39], s57 offen offset:2048 lds
    v_mul_f32 v134, v118, v134
    v_exp_f32 v230, -v118
    v_mul_f32 v135, v119, v135
    v_exp_f32 v231, -v119
    v_fma_f32 v224, v224, s67, s67
    v_fma_f32 v225, v225, s67, s67
    buffer_load_dwordx4 v251, s[36:39], s57 offen offset:3072 lds
    v_rcp_f32 v224, v224
    v_fma_f32 v226, v226, s67, s67
    v_rcp_f32 v225, v225
    v_fma_f32 v227, v227, s67, s67
    v_rcp_f32 v226, v226
    v_fma_f32 v228, v228, s67, s67
    s_mov_b32 m0, s53
    s_nop 0
    buffer_load_dwordx4 v246, s[28:31], s56 offen offset:0 sc1 lds
    v_rcp_f32 v227, v227
    v_fma_f32 v229, v229, s67, s67
    v_rcp_f32 v228, v228
    v_fma_f32 v230, v230, s67, s67
    buffer_load_dwordx4 v246, s[28:31], s56 offen offset:1024 sc1 lds
    v_rcp_f32 v229, v229
    v_fma_f32 v231, v231, s67, s67
    v_rcp_f32 v230, v230
    v_rcp_f32 v231, v231
    v_mul_f32 v128, v128, v224
    v_mul_f32 v129, v129, v225
    buffer_load_dwordx4 v247, s[28:31], s56 offen offset:2048 sc1 lds
    v_mul_f32 v130, v130, v226
    v_mul_f32 v131, v131, v227
    v_mul_f32 v132, v132, v228
    v_mul_f32 v133, v133, v229
    v_mul_f32 v134, v134, v230
    v_mul_f32 v135, v135, v231
    buffer_load_dwordx4 v247, s[28:31], s56 offen offset:3072 sc1 lds
    v_cvt_pk_bf16_f32 v212, v128, v129
    v_cvt_pk_bf16_f32 v213, v130, v131
    v_cvt_pk_bf16_f32 v214, v132, v133
    v_cvt_pk_bf16_f32 v215, v134, v135
    s_add_u32 s53, s53, 49152
    s_cmp_ge_u32 s53, s61
    s_cselect_b32 s53, s60, s53
    buffer_store_dwordx4 v[208:211], v198, s[28:31], 0 offen offset:0 sc1
    buffer_store_dwordx4 v[212:215], v198, s[28:31], 0 offen offset:1024 sc1
    s_waitcnt vmcnt(15)
    s_barrier
    s_mul_i32 s55, s49, 6
    s_add_u32 s55, s55, 32
    s_lshl_b32 s66, s51, 1
    s_and_b32 s57, s58, 15
    s_lshr_b64 s[58:59], s[58:59], 4
    s_add_u32 s57, s57, s66
    s_sub_u32 s56, s57, 6
    s_cselect_b32 s57, s57, s56
    s_add_u32 s57, s57, s55
    s_lshl_b32 s56, s57, 11
    s_mul_i32 s57, s57, 0x20000
    s_add_u32 m0, s53, 16384
    s_nop 0
    buffer_load_dwordx4 v248, s[32:35], s57 offen offset:0 lds
    buffer_load_dwordx4 v249, s[32:35], s57 offen offset:1024 lds
    buffer_load_dwordx4 v250, s[32:35], s57 offen offset:2048 lds
    buffer_load_dwordx4 v251, s[32:35], s57 offen offset:3072 lds
    s_add_u32 m0, s53, 32768
    s_nop 0
    buffer_load_dwordx4 v248, s[36:39], s57 offen offset:0 lds
    buffer_load_dwordx4 v249, s[36:39], s57 offen offset:1024 lds
    buffer_load_dwordx4 v250, s[36:39], s57 offen offset:2048 lds
    buffer_load_dwordx4 v251, s[36:39], s57 offen offset:3072 lds
    s_mov_b32 s62, s53
    s_mov_b32 s63, s56
    s_add_u32 s53, s53, 49152
    s_cmp_ge_u32 s53, s61
    s_cselect_b32 s53, s60, s53
    s_lshl_b32 s64, s47, 9
    s_lshl_b32 s65, s49, 7
    s_add_u32 s64, s64, s65
    s_lshl_b32 s65, s51, 4
    s_add_u32 s64, s64, s65
    s_lshl_b32 s65, s44, 2
    s_add_u32 s64, s64, s65
    s_add_u32 s64, s64, 0x52000
    v_mov_b32 v2, s0
    s_waitcnt vmcnt(8)
    s_mov_b64 exec, 1
    buffer_store_dword v2, v234, s[28:31], s64 offen sc1
    s_mov_b64 exec, -1
    s_barrier
    s_cmp_eq_u32 s69, 0
    s_cbranch_scc1 M_pi_ok
    s_lshl_b32 s68, s47, 2
    s_add_u32 s68, s68, s49
    s_lshl_b32 s68, s68, 7
    s_add_u32 s68, s68, 0x52000
    v_min_u32 v234, 44, v234
    v_mov_b32 v245, 0
    v_xor_b32 v245, -1, v2
    s_mov_b32 s3, 0x40000
M_pi_chk:
    v_cmp_ne_u32 vcc, s0, v245
    s_nop 4
    s_cbranch_vccz M_pi_ok
    s_sub_u32 s3, s3, 1
    s_cbranch_scc1 M_pi_ok
    s_sleep 12
    buffer_load_dword v245, v234, s[28:31], s68 offen sc1
    s_waitcnt vmcnt(0)
    s_branch M_pi_chk
M_pi_ok:
    s_mov_b32 m0, s62
    s_nop 0
    buffer_load_dwordx4 v246, s[28:31], s63 offen offset:0 sc1 lds
    buffer_load_dwordx4 v246, s[28:31], s63 offen offset:1024 sc1 lds
    buffer_load_dwordx4 v247, s[28:31], s63 offen offset:2048 sc1 lds
    buffer_load_dwordx4 v247, s[28:31], s63 offen offset:3072 sc1 lds
    s_and_b32 s57, s58, 15
    s_lshr_b64 s[58:59], s[58:59], 4
    s_add_u32 s57, s57, s66
    s_sub_u32 s56, s57, 6
    s_cselect_b32 s57, s57, s56
    s_add_u32 s57, s57, s55
    s_lshl_b32 s56, s57, 11
    s_mul_i32 s57, s57, 0x20000
    s_add_u32 m0, s53, 16384
    s_nop 0
    buffer_load_dwordx4 v248, s[32:35], s57 offen offset:0 lds
    buffer_load_dwordx4 v249, s[32:35], s57 offen offset:1024 lds
    buffer_load_dwordx4 v250, s[32:35], s57 offen offset:2048 lds
    buffer_load_dwordx4 v251, s[32:35], s57 offen offset:3072 lds
    s_add_u32 m0, s53, 32768
    s_nop 0
    buffer_load_dwordx4 v248, s[36:39], s57 offen offset:0 lds
    buffer_load_dwordx4 v249, s[36:39], s57 offen offset:1024 lds
    buffer_load_dwordx4 v250, s[36:39], s57 offen offset:2048 lds
    buffer_load_dwordx4 v251, s[36:39], s57 offen offset:3072 lds
    s_mov_b32 m0, s53
    s_nop 0
    buffer_load_dwordx4 v246, s[28:31], s56 offen offset:0 sc1 lds
    buffer_load_dwordx4 v246, s[28:31], s56 offen offset:1024 sc1 lds
    buffer_load_dwordx4 v247, s[28:31], s56 offen offset:2048 sc1 lds
    buffer_load_dwordx4 v247, s[28:31], s56 offen offset:3072 sc1 lds
    s_add_u32 s53, s53, 49152
    s_cmp_ge_u32 s53, s61
    s_cselect_b32 s53, s60, s53
    s_waitcnt vmcnt(12)
    s_barrier
    s_and_b32 s57, s58, 15
    s_lshr_b64 s[58:59], s[58:59], 4
    s_add_u32 s57, s57, s66
    s_sub_u32 s56, s57, 6
    s_cselect_b32 s57, s57, s56
    s_add_u32 s57, s57, s55
    s_lshl_b32 s56, s57, 11
    s_mul_i32 s57, s57, 0x20000
    s_add_u32 m0, s53, 16384
    s_nop 0
    buffer_load_dwordx4 v248, s[32:35], s57 offen offset:0 lds
    buffer_load_dwordx4 v249, s[32:35], s57 offen offset:1024 lds
    buffer_load_dwordx4 v250, s[32:35], s57 offen offset:2048 lds
    buffer_load_dwordx4 v251, s[32:35], s57 offen offset:3072 lds
    s_add_u32 m0, s53, 32768
    s_nop 0
    buffer_load_dwordx4 v248, s[36:39], s57 offen offset:0 lds
    buffer_load_dwordx4 v249, s[36:39], s57 offen offset:1024 lds
    buffer_load_dwordx4 v250, s[36:39], s57 offen offset:2048 lds
    buffer_load_dwordx4 v251, s[36:39], s57 offen offset:3072 lds
    s_mov_b32 s62, s53
    s_mov_b32 s63, s56
    s_add_u32 s53, s53, 49152
    s_cmp_ge_u32 s53, s61
    s_cselect_b32 s53, s60, s53
    s_lshl_b32 s68, s47, 2
    s_add_u32 s68, s68, s49
    s_lshl_b32 s68, s68, 7
    s_add_u32 s68, s68, 0x52000
    v_min_u32 v234, 44, v234
    buffer_load_dword v245, v234, s[28:31], s68 offen sc1
    s_waitcnt vmcnt(9)
    s_barrier
    s_waitcnt vmcnt(0)
    s_mov_b32 s3, 0x40000
M_pb_chk:
    v_cmp_ne_u32 vcc, s0, v245
    s_nop 4
    s_cbranch_vccz M_pb_ok
    s_sub_u32 s3, s3, 1
    s_cbranch_scc1 M_pb_ok
    s_sleep 2
    s_cmp_eq_u32 s69, 0
    s_cbranch_scc1 M_pb_rl
    s_sleep 48
M_pb_rl:
    buffer_load_dword v245, v234, s[28:31], s68 offen sc1
    s_waitcnt vmcnt(0)
    s_branch M_pb_chk
M_pb_ok:
    s_mov_b32 m0, s62
    s_nop 0
    buffer_load_dwordx4 v246, s[28:31], s63 offen offset:0 sc1 lds
    buffer_load_dwordx4 v246, s[28:31], s63 offen offset:1024 sc1 lds
    buffer_load_dwordx4 v247, s[28:31], s63 offen offset:2048 sc1 lds
    buffer_load_dwordx4 v247, s[28:31], s63 offen offset:3072 sc1 lds
    s_and_b32 s57, s58, 15
    s_lshr_b64 s[58:59], s[58:59], 4
    s_add_u32 s57, s57, s66
    s_sub_u32 s56, s57, 6
    s_cselect_b32 s57, s57, s56
    s_add_u32 s57, s57, s55
    s_lshl_b32 s56, s57, 11
    s_mul_i32 s57, s57, 0x20000
    s_add_u32 m0, s53, 16384
    s_nop 0
    buffer_load_dwordx4 v248, s[32:35], s57 offen offset:0 lds
    buffer_load_dwordx4 v249, s[32:35], s57 offen offset:1024 lds
    buffer_load_dwordx4 v250, s[32:35], s57 offen offset:2048 lds
    buffer_load_dwordx4 v251, s[32:35], s57 offen offset:3072 lds
    s_add_u32 m0, s53, 32768
    s_nop 0
    buffer_load_dwordx4 v248, s[36:39], s57 offen offset:0 lds
    buffer_load_dwordx4 v249, s[36:39], s57 offen offset:1024 lds
    buffer_load_dwordx4 v250, s[36:39], s57 offen offset:2048 lds
    buffer_load_dwordx4 v251, s[36:39], s57 offen offset:3072 lds
    s_mov_b32 m0, s53
    s_nop 0
    buffer_load_dwordx4 v246, s[28:31], s56 offen offset:0 sc1 lds
    buffer_load_dwordx4 v246, s[28:31], s56 offen offset:1024 sc1 lds
    buffer_load_dwordx4 v247, s[28:31], s56 offen offset:2048 sc1 lds
    buffer_load_dwordx4 v247, s[28:31], s56 offen offset:3072 sc1 lds
    s_add_u32 s53, s53, 49152
    s_cmp_ge_u32 s53, s61
    s_cselect_b32 s53, s60, s53
    s_movk_i32 s54, 1
M_Q_loop5:
    s_waitcnt vmcnt(12)
    s_barrier
    s_and_b32 s57, s58, 15
    s_lshr_b64 s[58:59], s[58:59], 4
    s_add_u32 s57, s57, s66
    s_sub_u32 s56, s57, 6
    s_cselect_b32 s57, s57, s56
    s_add_u32 s57, s57, s55
    s_lshl_b32 s56, s57, 11
    s_mul_i32 s57, s57, 0x20000
    s_add_u32 m0, s53, 16384
    s_nop 0
    buffer_load_dwordx4 v248, s[32:35], s57 offen offset:0 lds
    buffer_load_dwordx4 v249, s[32:35], s57 offen offset:1024 lds
    buffer_load_dwordx4 v250, s[32:35], s57 offen offset:2048 lds
    buffer_load_dwordx4 v251, s[32:35], s57 offen offset:3072 lds
    s_add_u32 m0, s53, 32768
    s_nop 0
    buffer_load_dwordx4 v248, s[36:39], s57 offen offset:0 lds
    buffer_load_dwordx4 v249, s[36:39], s57 offen offset:1024 lds
    buffer_load_dwordx4 v250, s[36:39], s57 offen offset:2048 lds
    buffer_load_dwordx4 v251, s[36:39], s57 offen offset:3072 lds
    s_mov_b32 m0, s53
    s_nop 0
    buffer_load_dwordx4 v246, s[28:31], s56 offen offset:0 sc1 lds
    buffer_load_dwordx4 v246, s[28:31], s56 offen offset:1024 sc1 lds
    buffer_load_dwordx4 v247, s[28:31], s56 offen offset:2048 sc1 lds
    buffer_load_dwordx4 v247, s[28:31], s56 offen offset:3072 sc1 lds
    s_add_u32 s53, s53, 49152
    s_cmp_ge_u32 s53, s61
    s_cselect_b32 s53, s60, s53
    s_sub_u32 s54, s54, 1
    s_cbranch_scc0 M_Q_loop5
    s_waitcnt vmcnt(12)
    s_barrier
    s_waitcnt vmcnt(0)
    s_barrier
    s_branch M_fin
M_Qidle:
    s_waitcnt vmcnt(0)
    s_barrier
    v_and_b32 v2, 255, v0
    s_and_b32 s64, s2, 63
    s_lshl_b32 s64, s64, 8
    v_add_lshl_u32 v243, v2, s64, 6
    s_mov_b32 s40, s16
    s_mov_b32 s41, s17
    s_mov_b32 s42, 0x100000
    s_mov_b32 s43, 0x20000
    s_mov_b32 s64, 0x0
    buffer_load_dword v244, v243, s[40:43], s64 offen
    s_waitcnt vmcnt(0)
    s_mov_b32 s40, s16
    s_mov_b32 s41, s17
    s_mov_b32 s42, 0x200000
    s_mov_b32 s43, 0x20000
    s_mov_b32 s64, 0x100000
    buffer_load_dword v244, v243, s[40:43], s64 offen
    s_waitcnt vmcnt(0)
    s_mov_b32 s40, s16
    s_mov_b32 s41, s17
    s_mov_b32 s42, 0x300000
    s_mov_b32 s43, 0x20000
    s_mov_b32 s64, 0x200000
    buffer_load_dword v244, v243, s[40:43], s64 offen
    s_waitcnt vmcnt(0)
    s_mov_b32 s40, s16
    s_mov_b32 s41, s17
    s_mov_b32 s42, 0x400000
    s_mov_b32 s43, 0x20000
    s_mov_b32 s64, 0x300000
    buffer_load_dword v244, v243, s[40:43], s64 offen
    s_waitcnt vmcnt(0)
    s_mov_b32 s40, s16
    s_mov_b32 s41, s17
    s_mov_b32 s42, 0x500000
    s_mov_b32 s43, 0x20000
    s_mov_b32 s64, 0x400000
    buffer_load_dword v244, v243, s[40:43], s64 offen
    s_waitcnt vmcnt(0)
    s_mov_b32 s40, s16
    s_mov_b32 s41, s17
    s_mov_b32 s42, 0x600000
    s_mov_b32 s43, 0x20000
    s_mov_b32 s64, 0x500000
    buffer_load_dword v244, v243, s[40:43], s64 offen
    s_waitcnt vmcnt(0)
    s_mov_b32 s40, s16
    s_mov_b32 s41, s17
    s_mov_b32 s42, 0x700000
    s_mov_b32 s43, 0x20000
    s_mov_b32 s64, 0x600000
    buffer_load_dword v244, v243, s[40:43], s64 offen
    s_waitcnt vmcnt(0)
    s_waitcnt vmcnt(0)
    s_barrier
    s_barrier
    s_barrier
    s_branch M_Qjoin
M_fin:
M_end:
    s_endpgm

.section .rodata,"a"
.p2align 6
.amdhsa_kernel adaLN_cond__sliding_local_dilated__glu_gated_swiglu__prompt_kernel
  .amdhsa_next_free_vgpr 252
  .amdhsa_next_free_sgpr 102
  .amdhsa_accum_offset 252
  .amdhsa_group_segment_fixed_size 0
  .amdhsa_kernarg_size 96
  .amdhsa_user_sgpr_count 2
  .amdhsa_user_sgpr_kernarg_segment_ptr 1
  .amdhsa_system_sgpr_workgroup_id_x 1
  .amdhsa_float_denorm_mode_32 3
.end_amdhsa_kernel
```

```asm
; @launch grid=(256,1,1) block=(512,1,1) lds=163840
.amdgcn_target "amdgcn-amd-amdhsa--gfx950"
.text
.globl adaLN_cond__sliding_local_dilated__glu_gated_swiglu__prompt_kernel
.p2align 8
.type adaLN_cond__sliding_local_dilated__glu_gated_swiglu__prompt_kernel,@function
adaLN_cond__sliding_local_dilated__glu_gated_swiglu__prompt_kernel:
    s_cmp_ge_u32 s2, 256
    s_cbranch_scc1 M_end
    s_load_dwordx16 s[4:19], s[0:1], 0
    s_load_dwordx8 s[20:27], s[0:1], 64
    v_lshrrev_b32 v2, 6, v0
    v_and_b32 v1, 63, v0
    v_readfirstlane_b32 s44, v2
    s_and_b32 s47, s2, 1
    s_lshl_b32 s47, s47, 3
    s_bfe_u32 s64, s2, 0x30003
    s_add_u32 s47, s47, s64
    s_and_b32 s48, s2, 6
    s_lshl_b32 s48, s48, 1
    s_lshr_b32 s64, s2, 6
    s_add_u32 s48, s48, s64
    s_getpc_b64 s[28:29]
M_pc:
    s_lshr_b32 s64, s2, 3
    s_lshl_b32 s64, s64, 3
    s_add_u32 s64, s64, s44
    s_lshl_b32 s64, s64, 8
    v_lshl_add_u32 v2, v1, 7, s64
    v_min_u32 v2, M_end-M_pc, v2
    s_mov_b64 exec, 3
    global_load_dword v244, v2, s[28:29]
    s_mov_b64 exec, -1
    s_cmp_lt_u32 s44, 4
    s_cbranch_scc1 M_P
    s_setprio 0
    s_sub_u32 s44, s44, 4
    s_lshl_b32 s62, s47, 4
    s_add_u32 s62, s62, s48
    s_lshl_b32 s62, s62, 2
    s_add_u32 s62, s62, s44
    s_lshl_b32 s64, s62, 12
    v_lshl_add_u32 v2, v1, 4, s64
    s_waitcnt lgkmcnt(0)
    s_load_dword s0, s[26:27], 0
    s_mov_b32 s40, s4
    s_mov_b32 s41, s5
    s_mov_b32 s42, 0x400000
    s_mov_b32 s43, 0x20000
    buffer_load_dwordx4 v[104:107], v2, s[40:43], 0 offen offset:0
    buffer_load_dwordx4 v[108:111], v2, s[40:43], 0 offen offset:1024
    buffer_load_dwordx4 v[112:115], v2, s[40:43], 0 offen offset:2048
    buffer_load_dwordx4 v[116:119], v2, s[40:43], 0 offen offset:3072
    s_barrier
    s_branch M_Q
M_P:
    s_lshr_b32 s70, s47, 1
    s_lshl_b32 s70, s70, 7
    s_and_b32 s71, s47, 1
    s_lshl_b32 s71, s71, 4
    s_add_u32 s71, s71, s48
    s_lshl_b32 s71, s71, 7
    v_lshrrev_b32 v48, 3, v0
    v_add_u32 v48, s70, v48
    v_lshlrev_b32 v9, 1, v48
    s_movk_i32 s64, 12288
    v_mul_lo_u32 v48, s64, v48
    v_and_b32 v8, 7, v0
    v_lshl_add_u32 v48, v8, 4, v48
    v_add_u32 v8, s71, v48
    s_waitcnt lgkmcnt(0)
    s_load_dword s0, s[26:27], 0
    s_mov_b32 s40, s18
    s_mov_b32 s41, s19
    s_mov_b32 s42, 0x800
    s_mov_b32 s43, 0x20000
    s_mov_b32 s36, s20
    s_mov_b32 s37, s21
    s_mov_b32 s38, 0xc00000
    s_mov_b32 s39, 0x20000
    s_barrier
    buffer_load_ushort v20, v9, s[40:43], 0 offen offset:0
    buffer_load_ushort v21, v9, s[40:43], 0 offen offset:64
    buffer_load_ushort v22, v9, s[40:43], 0 offen offset:128
    buffer_load_ushort v23, v9, s[40:43], 0 offen offset:192
    s_mov_b32 s64, 0x0
    buffer_load_dwordx4 v[24:27], v8, s[36:39], s64 offen
    s_mov_b32 s64, 0x60000
    buffer_load_dwordx4 v[28:31], v8, s[36:39], s64 offen
    s_mov_b32 s64, 0xc0000
    buffer_load_dwordx4 v[32:35], v8, s[36:39], s64 offen
    s_mov_b32 s64, 0x120000
    buffer_load_dwordx4 v[36:39], v8, s[36:39], s64 offen
    s_mov_b32 s28, s26
    s_mov_b32 s29, s27
    s_mov_b32 s30, 0x3100000
    s_mov_b32 s31, 0x20000
    s_lshl_b32 s64, s48, 13
    s_add_u32 s64, s64, 0x30000
    s_lshl_b32 s65, s47, 9
    s_add_u32 s62, s64, s65
    s_lshl_b32 s65, s44, 9
    s_add_u32 s64, s64, s65
    v_lshl_add_u32 v16, v1, 3, s64
    s_lshl_b32 s64, s44, 7
    s_add_u32 s64, s64, s62
    v_lshl_add_u32 v2, v1, 2, s64
    s_lshl_b32 s64, s47, 4
    s_add_u32 s64, s64, s48
    s_lshl_b32 s64, s64, 7
    s_add_u32 s64, s64, 0x10000
    v_writelane_b32 v2, s64, 4
    s_mov_b64 exec, 31
    buffer_load_dword v244, v2, s[28:31], 0 offen sc1
    s_mov_b64 exec, -1
    s_lshr_b32 s45, s44, 1
    s_and_b32 s46, s44, 1
    s_lshr_b32 s49, s48, 2
    s_and_b32 s51, s48, 3
    s_cmp_ge_u32 s2, 192
    s_cselect_b32 s69, 0x80000000, 0
    s_mov_b32 s67, 0x40053526
    v_lshlrev_b32 v234, 2, v1
    s_mov_b32 s52, 0
    s_lshl_b32 s64, s45, 13
    v_lshl_add_u32 v233, v1, 4, s64
    v_lshrrev_b32 v3, 4, v1
    v_bfe_u32 v2, v1, 2, 2
    v_lshl_add_u32 v4, v3, 3, v2
    v_mul_u32_u24 v4, 384, v4
    v_and_b32 v5, 3, v1
    v_lshl_add_u32 v4, v5, 3, v4
    v_add_u32 v4, 18432, v4
    v_bfe_u32 v2, v1, 3, 2
    s_lshl_b32 s64, s46, 1
    v_xor_b32 v2, s64, v2
    v_lshl_add_u32 v239, v2, 5, v4
    v_xor_b32 v2, 1, v2
    v_lshl_add_u32 v240, v2, 5, v4
    v_and_b32 v2, 15, v1
    v_lshlrev_b32 v3, 2, v3
    v_sub_u32 v3, v2, v3
    s_mov_b32 s64, 0x80000001
    v_sub_u32 v4, -2, v3
    v_and_b32 v4, s64, v4
    v_cmp_eq_u32 s[72:73], 0, v4
    v_subrev_u32 v4, 0, v3
    v_and_b32 v4, s64, v4
    v_cmp_eq_u32 s[80:81], 0, v4
    v_sub_u32 v4, -1, v3
    v_and_b32 v4, s64, v4
    v_cmp_eq_u32 s[74:75], 0, v4
    v_subrev_u32 v4, 1, v3
    v_and_b32 v4, s64, v4
    v_cmp_eq_u32 s[82:83], 0, v4
    v_sub_u32 v4, 0, v3
    v_and_b32 v4, s64, v4
    v_cmp_eq_u32 s[76:77], 0, v4
    v_subrev_u32 v4, 2, v3
    v_and_b32 v4, s64, v4
    v_cmp_eq_u32 s[84:85], 0, v4
    v_sub_u32 v4, 1, v3
    v_and_b32 v4, s64, v4
    v_cmp_eq_u32 s[78:79], 0, v4
    v_subrev_u32 v4, 3, v3
    v_and_b32 v4, s64, v4
    v_cmp_eq_u32 s[86:87], 0, v4
    s_lshl_b32 s64, s47, 1
    s_add_u32 s64, s64, s45
    s_cmp_eq_u32 s64, 0
    s_cselect_b64 s[88:89], 0, s[72:73]
    s_cselect_b64 s[90:91], 0, s[74:75]
    s_cselect_b64 s[92:93], 0, s[76:77]
    s_cselect_b64 s[94:95], 0, s[78:79]
    s_mul_i32 s64, s64, 131072
    s_lshl_b32 s65, s48, 11
    s_add_u32 s64, s64, s65
    s_lshl_b32 s65, s46, 10
    s_add_u32 s64, s64, s65
    s_add_u32 s64, s64, 0x600000
    v_lshl_add_u32 v237, v1, 4, s64
    s_lshl_b32 s64, s2, 8
    v_add_lshl_u32 v243, v0, s64, 5
    s_lshl_b32 s64, s47, 3
    s_lshl_b32 s65, s44, 1
    s_add_u32 s64, s64, s65
    s_mul_i32 s64, s64, 32768
    s_add_u32 s64, s64, 0x600000
    v_lshl_add_u32 v208, v1, 4, s64
    v_add_u32 v209, 30720, v208
    v_lshrrev_b32 v3, 3, v1
    s_lshl_b32 s64, s44, 4
    v_add_lshl_u32 v2, v3, s64, 11
    s_lshl_b32 s64, s48, 7
    v_add_u32 v2, s64, v2
    v_and_b32 v3, 6, v3
    v_and_b32 v4, 7, v1
    v_xor_b32 v3, v3, v4
    v_lshl_add_u32 v210, v3, 4, v2
    v_add_u32 v211, 15360, v210
    s_lshl_b32 s65, s48, 8
    v_lshrrev_b32 v3, 4, v1
    s_lshl_b32 s64, s44, 4
    v_add_u32 v2, s64, v3
    s_movk_i32 s64, 7168
    v_mul_u32_u24 v2, s64, v2
    v_add_u32 v2, s65, v2
    v_lshlrev_b32 v3, 1, v3
    v_and_b32 v4, 15, v1
    v_xor_b32 v3, v3, v4
    v_lshl_add_u32 v212, v3, 4, v2
    v_add_u32 v214, 55296, v212
    v_xor_b32 v3, 8, v3
    v_lshl_add_u32 v213, v3, 4, v2
    v_add_u32 v213, 27648, v213
    v_add_u32 v215, 55296, v213
    v_add_u32 v232, s52, v233
    v_add_u32 v235, s52, v239
    v_add_u32 v236, s52, v240
    s_lshl_b32 s60, s44, 12
    s_add_u32 s61, s60, 147456
    s_add_u32 s53, s60, 49152
    s_lshl_b32 s70, s44, 11
    s_sub_u32 s70, 16384, s70
    s_bfe_u32 s66, s2, 0x30003
    s_lshr_b32 s55, s2, 6
    s_add_u32 s66, s66, s55
    s_and_b32 s66, s66, 3
    s_mov_b32 s58, 0x76453210
    s_mov_b32 s59, 0xfecdba89
    s_cmp_eq_u32 s66, 1
    s_cselect_b32 s58, 0x75643120, s58
    s_cselect_b32 s59, 0xfdecb9a8, s59
    s_cmp_eq_u32 s66, 2
    s_cselect_b32 s58, 0x67542310, s58
    s_cselect_b32 s59, 0xefdcab98, s59
    s_cmp_eq_u32 s66, 3
    s_cselect_b32 s58, 0x86534210, s58
    s_cselect_b32 s59, 0xfedbca97, s59
    s_mov_b32 s32, s8
    s_mov_b32 s33, s9
    s_mov_b32 s34, 0x200000
    s_mov_b32 s35, 0x20000
    s_waitcnt lgkmcnt(0)
    s_add_u32 s0, s0, 1
    s_setprio 2
    s_barrier
    s_waitcnt vmcnt(5)
    v_lshlrev_b32 v20, 16, v20
    v_lshlrev_b32 v21, 16, v21
    v_lshlrev_b32 v22, 16, v22
    v_lshlrev_b32 v23, 16, v23
    v_mul_f32 v48, 0xbfb8aa3b, v20
    v_mul_f32 v49, 0xbfb8aa3b, v21
    v_mul_f32 v50, 0xbfb8aa3b, v22
    v_mul_f32 v51, 0xbfb8aa3b, v23
    v_exp_f32 v48, v48
    v_exp_f32 v49, v49
    v_exp_f32 v50, v50
    v_exp_f32 v51, v51
    v_add_f32 v48, 1.0, v48
    v_add_f32 v49, 1.0, v49
    v_add_f32 v50, 1.0, v50
    v_add_f32 v51, 1.0, v51
    v_rcp_f32 v48, v48
    v_rcp_f32 v49, v49
    v_rcp_f32 v50, v50
    v_rcp_f32 v51, v51
    v_mul_f32 v20, v20, v48
    v_mul_f32 v21, v21, v49
    v_mul_f32 v22, v22, v50
    v_mul_f32 v23, v23, v51
    v_cvt_pk_bf16_f32 v48, v20, v20
    v_lshlrev_b32 v20, 16, v48
    v_cvt_pk_bf16_f32 v49, v21, v21
    v_lshlrev_b32 v21, 16, v49
    v_cvt_pk_bf16_f32 v50, v22, v22
    v_lshlrev_b32 v22, 16, v50
    v_cvt_pk_bf16_f32 v51, v23, v23
    v_lshlrev_b32 v23, 16, v51
    s_waitcnt vmcnt(4)
    v_lshlrev_b32 v48, 16, v24
    v_and_b32 v49, 0xffff0000, v24
    v_lshlrev_b32 v50, 16, v25
    v_and_b32 v51, 0xffff0000, v25
    v_lshlrev_b32 v52, 16, v26
    v_and_b32 v53, 0xffff0000, v26
    v_lshlrev_b32 v54, 16, v27
    v_and_b32 v55, 0xffff0000, v27
    v_mul_f32 v40, v20, v48
    v_mul_f32 v41, v20, v49
    v_mul_f32 v42, v20, v50
    v_mul_f32 v43, v20, v51
    v_mul_f32 v44, v20, v52
    v_mul_f32 v45, v20, v53
    v_mul_f32 v46, v20, v54
    v_mul_f32 v47, v20, v55
    s_waitcnt vmcnt(3)
    v_lshlrev_b32 v48, 16, v28
    v_and_b32 v49, 0xffff0000, v28
    v_lshlrev_b32 v50, 16, v29
    v_and_b32 v51, 0xffff0000, v29
    v_lshlrev_b32 v52, 16, v30
    v_and_b32 v53, 0xffff0000, v30
    v_lshlrev_b32 v54, 16, v31
    v_and_b32 v55, 0xffff0000, v31
    v_fmac_f32 v40, v21, v48
    v_fmac_f32 v41, v21, v49
    v_fmac_f32 v42, v21, v50
    v_fmac_f32 v43, v21, v51
    v_fmac_f32 v44, v21, v52
    v_fmac_f32 v45, v21, v53
    v_fmac_f32 v46, v21, v54
    v_fmac_f32 v47, v21, v55
    s_waitcnt vmcnt(2)
    v_lshlrev_b32 v48, 16, v32
    v_and_b32 v49, 0xffff0000, v32
    v_lshlrev_b32 v50, 16, v33
    v_and_b32 v51, 0xffff0000, v33
    v_lshlrev_b32 v52, 16, v34
    v_and_b32 v53, 0xffff0000, v34
    v_lshlrev_b32 v54, 16, v35
    v_and_b32 v55, 0xffff0000, v35
    v_fmac_f32 v40, v22, v48
    v_fmac_f32 v41, v22, v49
    v_fmac_f32 v42, v22, v50
    v_fmac_f32 v43, v22, v51
    v_fmac_f32 v44, v22, v52
    v_fmac_f32 v45, v22, v53
    v_fmac_f32 v46, v22, v54
    v_fmac_f32 v47, v22, v55
    s_waitcnt vmcnt(1)
    v_lshlrev_b32 v48, 16, v36
    v_and_b32 v49, 0xffff0000, v36
    v_lshlrev_b32 v50, 16, v37
    v_and_b32 v51, 0xffff0000, v37
    v_lshlrev_b32 v52, 16, v38
    v_and_b32 v53, 0xffff0000, v38
    v_lshlrev_b32 v54, 16, v39
    v_and_b32 v55, 0xffff0000, v39
    v_fmac_f32 v40, v23, v48
    v_fmac_f32 v41, v23, v49
    v_fmac_f32 v42, v23, v50
    v_fmac_f32 v43, v23, v51
    v_fmac_f32 v44, v23, v52
    v_fmac_f32 v45, v23, v53
    v_fmac_f32 v46, v23, v54
    v_fmac_f32 v47, v23, v55
    v_add_f32_dpp v40, v40, v40 row_ror:8 row_mask:0xf bank_mask:0xf
    v_add_f32_dpp v41, v41, v41 row_ror:8 row_mask:0xf bank_mask:0xf
    v_add_f32_dpp v42, v42, v42 row_ror:8 row_mask:0xf bank_mask:0xf
    v_add_f32_dpp v43, v43, v43 row_ror:8 row_mask:0xf bank_mask:0xf
    v_add_f32_dpp v44, v44, v44 row_ror:8 row_mask:0xf bank_mask:0xf
    v_add_f32_dpp v45, v45, v45 row_ror:8 row_mask:0xf bank_mask:0xf
    v_add_f32_dpp v46, v46, v46 row_ror:8 row_mask:0xf bank_mask:0xf
    v_add_f32_dpp v47, v47, v47 row_ror:8 row_mask:0xf bank_mask:0xf
    v_mov_b32 v48, v40
    v_mov_b32 v49, v41
    v_mov_b32 v50, v42
    v_mov_b32 v51, v43
    v_mov_b32 v52, v44
    v_mov_b32 v53, v45
    v_mov_b32 v54, v46
    v_mov_b32 v55, v47
    v_permlane32_swap_b32 v40, v48
    v_permlane32_swap_b32 v41, v49
    v_permlane32_swap_b32 v42, v50
    v_permlane32_swap_b32 v43, v51
    v_permlane32_swap_b32 v44, v52
    v_permlane32_swap_b32 v45, v53
    v_permlane32_swap_b32 v46, v54
    v_permlane32_swap_b32 v47, v55
    v_add_f32 v40, v40, v48
    v_add_f32 v41, v41, v49
    v_add_f32 v42, v42, v50
    v_add_f32 v43, v43, v51
    v_add_f32 v44, v44, v52
    v_add_f32 v45, v45, v53
    v_add_f32 v46, v46, v54
    v_add_f32 v47, v47, v55
    v_mov_b32 v48, v40
    v_mov_b32 v49, v41
    v_mov_b32 v50, v42
    v_mov_b32 v51, v43
    v_mov_b32 v52, v44
    v_mov_b32 v53, v45
    v_mov_b32 v54, v46
    v_mov_b32 v55, v47
    v_permlane16_swap_b32 v40, v48
    v_permlane16_swap_b32 v41, v49
    v_permlane16_swap_b32 v42, v50
    v_permlane16_swap_b32 v43, v51
    v_permlane16_swap_b32 v44, v52
    v_permlane16_swap_b32 v45, v53
    v_permlane16_swap_b32 v46, v54
    v_permlane16_swap_b32 v47, v55
    v_add_f32 v40, v40, v48
    v_add_f32 v41, v41, v49
    v_add_f32 v42, v42, v50
    v_add_f32 v43, v43, v51
    v_add_f32 v44, v44, v52
    v_add_f32 v45, v45, v53
    v_add_f32 v46, v46, v54
    v_add_f32 v47, v47, v55
    s_lshl_b32 s64, s44, 8
    s_add_u32 s64, s64, 147456
    v_and_b32 v48, 7, v0
    v_lshl_add_u32 v48, v48, 5, s64
    ds_write_b128 v48, v[40:43]
    ds_write_b128 v48, v[44:47] offset:16
    v_mov_b32 v49, 148492
    v_mov_b32 v50, 1
    s_waitcnt lgkmcnt(0)
    s_mov_b64 exec, 1
    ds_add_rtn_u32 v51, v49, v50
    s_mov_b64 exec, -1
    v_add_u32 v49, 147456, v234
    s_waitcnt lgkmcnt(0)
    ds_read_b32 v40, v49 offset:0
    ds_read_b32 v41, v49 offset:256
    ds_read_b32 v42, v49 offset:512
    ds_read_b32 v43, v49 offset:768
    v_readfirstlane_b32 s64, v51
    s_nop 3
    s_cmp_eq_u32 s64, 3
    s_cselect_b32 s62, s62, 0x80000000
    v_lshl_add_u32 v48, v1, 3, s62
    s_waitcnt lgkmcnt(0)
    v_add_f32 v40, v40, v41
    v_add_f32 v42, v42, v43
    v_add_f32 v40, v40, v42
    v_mov_b32 v41, s0
    buffer_store_dwordx2 v[40:41], v48, s[28:31], 0 offen sc1
    s_cmp_ge_u32 s44, 2
    s_cbranch_scc1 M_spf
    s_movk_i32 s63, 4096
    buffer_load_dwordx2 v[88:89], v16, s[28:31], 0 offen offset:0 sc1
    buffer_load_dwordx2 v[90:91], v16, s[28:31], 0 offen offset:1024 sc1
    buffer_load_dwordx2 v[92:93], v16, s[28:31], 0 offen offset:2048 sc1
    buffer_load_dwordx2 v[94:95], v16, s[28:31], 0 offen offset:3072 sc1
    buffer_load_dwordx2 v[96:97], v16, s[28:31], s63 offen offset:0 sc1
    buffer_load_dwordx2 v[98:99], v16, s[28:31], s63 offen offset:1024 sc1
    buffer_load_dwordx2 v[100:101], v16, s[28:31], s63 offen offset:2048 sc1
    buffer_load_dwordx2 v[102:103], v16, s[28:31], s63 offen offset:3072 sc1
    s_waitcnt vmcnt(0)
    s_mov_b32 s3, 0x40000
M_pt_chk:
    v_xor_b32 v48, s0, v89
    v_xor_b32 v49, s0, v91
    v_xor_b32 v50, s0, v93
    v_xor_b32 v51, s0, v95
    v_xor_b32 v52, s0, v97
    v_xor_b32 v53, s0, v99
    v_xor_b32 v54, s0, v101
    v_xor_b32 v55, s0, v103
    v_or3_b32 v48, v48, v49, v50
    v_or3_b32 v48, v48, v51, v52
    v_or3_b32 v48, v48, v53, v54
    v_or_b32 v48, v48, v55
    v_cmp_ne_u32 vcc, 0, v48
    s_nop 4
    s_cbranch_vccz M_pt_ok
    s_sub_u32 s3, s3, 1
    s_cbranch_scc1 M_pt_ok
    v_cmp_ne_u32 vcc, s0, v89
    s_nop 4
    s_mov_b64 exec, vcc
    buffer_load_dwordx2 v[88:89], v16, s[28:31], 0 offen offset:0 sc1
    s_mov_b64 exec, -1
    v_cmp_ne_u32 vcc, s0, v91
    s_nop 4
    s_mov_b64 exec, vcc
    buffer_load_dwordx2 v[90:91], v16, s[28:31], 0 offen offset:1024 sc1
    s_mov_b64 exec, -1
    v_cmp_ne_u32 vcc, s0, v93
    s_nop 4
    s_mov_b64 exec, vcc
    buffer_load_dwordx2 v[92:93], v16, s[28:31], 0 offen offset:2048 sc1
    s_mov_b64 exec, -1
    v_cmp_ne_u32 vcc, s0, v95
    s_nop 4
    s_mov_b64 exec, vcc
    buffer_load_dwordx2 v[94:95], v16, s[28:31], 0 offen offset:3072 sc1
    s_mov_b64 exec, -1
    v_cmp_ne_u32 vcc, s0, v97
    s_nop 4
    s_mov_b64 exec, vcc
    buffer_load_dwordx2 v[96:97], v16, s[28:31], s63 offen offset:0 sc1
    s_mov_b64 exec, -1
    v_cmp_ne_u32 vcc, s0, v99
    s_nop 4
    s_mov_b64 exec, vcc
    buffer_load_dwordx2 v[98:99], v16, s[28:31], s63 offen offset:1024 sc1
    s_mov_b64 exec, -1
    v_cmp_ne_u32 vcc, s0, v101
    s_nop 4
    s_mov_b64 exec, vcc
    buffer_load_dwordx2 v[100:101], v16, s[28:31], s63 offen offset:2048 sc1
    s_mov_b64 exec, -1
    v_cmp_ne_u32 vcc, s0, v103
    s_nop 4
    s_mov_b64 exec, vcc
    buffer_load_dwordx2 v[102:103], v16, s[28:31], s63 offen offset:3072 sc1
    s_mov_b64 exec, -1
    s_waitcnt vmcnt(0)
    s_branch M_pt_chk
M_pt_ok:
    v_add_f32 v88, v88, v90
    v_add_f32 v92, v92, v94
    v_add_f32 v96, v96, v98
    v_add_f32 v100, v100, v102
    v_add_f32 v88, v88, v92
    v_add_f32 v96, v96, v100
    v_add_f32 v88, v88, v96
    v_cvt_pk_bf16_f32 v89, v88, v88
    v_lshlrev_b32 v88, 16, v89
    s_cmp_eq_u32 s44, 1
    s_cselect_b32 s64, 1.0, 0
    v_add_f32 v88, s64, v88
    v_cvt_pk_bf16_f32 v89, v88, v88
    v_lshlrev_b32 v88, 16, v89
    s_lshl_b32 s64, s44, 8
    s_add_u32 s64, s64, 149504
    v_add_u32 v2, s64, v234
    ds_write_b32 v2, v88
    s_waitcnt lgkmcnt(0)
    s_branch M_tbl
M_spf:
    s_lshl_b32 s64, s47, 2
    s_add_u32 s64, s64, s49
    s_lshl_b32 s64, s64, 7
    s_load_dword s99, s[26:27], s64 offset:0x58000
    s_load_dword s99, s[26:27], s64 offset:0x54000
    s_load_dword s99, s[26:27], s64 offset:0x56000
    s_load_dword s99, s[26:27], s64 offset:0x50000
    s_load_dword s99, s[26:27], s64 offset:0x52000
    s_lshl_b32 s64, s2, 1
    s_add_u32 s64, s64, s46
    s_mul_i32 s65, s64, 12288
    s_add_u32 s56, s6, s65
    s_addc_u32 s57, s7, 0
    s_load_dword s99, s[56:57], 384
    s_load_dword s99, s[56:57], 448
    s_load_dword s99, s[56:57], 1408
    s_load_dword s99, s[56:57], 1472
    s_load_dword s99, s[56:57], 2432
    s_load_dword s99, s[56:57], 2496
    s_load_dword s99, s[56:57], 3456
    s_load_dword s99, s[56:57], 3520
    s_load_dword s99, s[56:57], 4480
    s_load_dword s99, s[56:57], 4544
    s_load_dword s99, s[56:57], 5504
    s_load_dword s99, s[56:57], 5568
    s_load_dword s99, s[56:57], 6528
    s_load_dword s99, s[56:57], 6592
    s_load_dword s99, s[56:57], 7552
    s_load_dword s99, s[56:57], 7616
    s_load_dword s99, s[56:57], 8576
    s_load_dword s99, s[56:57], 8640
    s_load_dword s99, s[56:57], 9600
    s_load_dword s99, s[56:57], 9664
    s_load_dword s99, s[56:57], 10624
    s_load_dword s99, s[56:57], 10688
    s_load_dword s99, s[56:57], 11648
    s_load_dword s99, s[56:57], 11712
M_tbl:
    s_barrier
    s_or_b32 s64, s2, s44
    s_cmp_eq_u32 s64, 0
    s_cselect_b32 s64, 0, 0x80000000
    v_mov_b32 v2, s64
    v_mov_b32 v3, s0
    s_barrier
    ds_read_b128 v[120:123], v232 offset:0
    ds_read_b64_tr_b16 v[148:149], v235 offset:128
    ds_read_b64_tr_b16 v[150:151], v235 offset:1664
    ds_read_b64_tr_b16 v[152:153], v236 offset:128
    ds_read_b64_tr_b16 v[154:155], v236 offset:1664
    ds_read_b64_tr_b16 v[156:157], v235 offset:256
    ds_read_b64_tr_b16 v[158:159], v235 offset:1792
    ds_read_b64_tr_b16 v[160:161], v236 offset:256
    ds_read_b64_tr_b16 v[162:163], v236 offset:1792
    ds_read_b128 v[124:127], v232 offset:2048
    ds_read_b64_tr_b16 v[140:141], v235 offset:0
    ds_read_b64_tr_b16 v[142:143], v235 offset:1536
    ds_read_b64_tr_b16 v[144:145], v236 offset:0
    ds_read_b64_tr_b16 v[146:147], v236 offset:1536
    ds_read_b128 v[128:131], v232 offset:4096
    ds_read_b128 v[132:135], v232 offset:6144
    ds_read_b128 v[136:139], v232 offset:8192
    s_add_u32 s52, s52, 49152
    s_cmp_ge_u32 s52, 147456
    s_cselect_b32 s52, 0, s52
    s_waitcnt lgkmcnt(0)
    v_mfma_f32_16x16x32_bf16 v[40:43], v[148:151], v[120:123], 0
    ds_read_b128 v[164:167], v232 offset:1024
    v_mfma_f32_16x16x32_bf16 v[44:47], v[152:155], v[120:123], 0
    ds_read_b64_tr_b16 v[192:193], v235 offset:12416
    v_mfma_f32_16x16x32_bf16 v[80:83], v[120:123], v[156:159], 0
    ds_read_b64_tr_b16 v[194:195], v235 offset:13952
    v_mfma_f32_16x16x32_bf16 v[84:87], v[120:123], v[160:163], 0
    ds_read_b64_tr_b16 v[196:197], v236 offset:12416
    v_mfma_f32_16x16x32_bf16 v[48:51], v[148:151], v[124:127], 0
    ds_read_b64_tr_b16 v[198:199], v236 offset:13952
    v_mfma_f32_16x16x32_bf16 v[52:55], v[152:155], v[124:127], 0
    v_mfma_f32_16x16x32_bf16 v[88:91], v[124:127], v[156:159], 0
    ds_read_b64_tr_b16 v[200:201], v235 offset:12544
    v_mfma_f32_16x16x32_bf16 v[92:95], v[124:127], v[160:163], 0
    ds_read_b64_tr_b16 v[202:203], v235 offset:14080
    v_mfma_f32_16x16x32_bf16 v[8:11], v[140:143], v[124:127], 0
    ds_read_b64_tr_b16 v[204:205], v236 offset:12544
    v_mfma_f32_16x16x32_bf16 v[12:15], v[144:147], v[124:127], 0
    ds_read_b64_tr_b16 v[206:207], v236 offset:14080
    v_mfma_f32_16x16x32_bf16 v[56:59], v[148:151], v[128:131], 0
    v_mfma_f32_16x16x32_bf16 v[60:63], v[152:155], v[128:131], 0
    ds_read_b128 v[168:171], v232 offset:3072
    v_mfma_f32_16x16x32_bf16 v[96:99], v[128:131], v[156:159], 0
    ds_read_b64_tr_b16 v[184:185], v235 offset:12288
    v_mfma_f32_16x16x32_bf16 v[100:103], v[128:131], v[160:163], 0
    ds_read_b64_tr_b16 v[186:187], v235 offset:13824
    v_mfma_f32_16x16x32_bf16 v[16:19], v[140:143], v[128:131], 0
    ds_read_b64_tr_b16 v[188:189], v236 offset:12288
    v_mfma_f32_16x16x32_bf16 v[20:23], v[144:147], v[128:131], 0
    v_mfma_f32_16x16x32_bf16 v[64:67], v[148:151], v[132:135], 0
    ds_read_b64_tr_b16 v[190:191], v236 offset:13824
    v_mfma_f32_16x16x32_bf16 v[68:71], v[152:155], v[132:135], 0
    ds_read_b128 v[172:175], v232 offset:5120
    v_mfma_f32_16x16x32_bf16 v[104:107], v[132:135], v[156:159], 0
    ds_read_b128 v[176:179], v232 offset:7168
    v_mfma_f32_16x16x32_bf16 v[108:111], v[132:135], v[160:163], 0
    ds_read_b128 v[180:183], v232 offset:9216
    v_mfma_f32_16x16x32_bf16 v[24:27], v[140:143], v[132:135], 0
    v_mfma_f32_16x16x32_bf16 v[28:31], v[144:147], v[132:135], 0
    v_add_u32 v232, s52, v233
    v_mfma_f32_16x16x32_bf16 v[72:75], v[148:151], v[136:139], 0
    v_mfma_f32_16x16x32_bf16 v[76:79], v[152:155], v[136:139], 0
    v_add_u32 v235, s52, v239
    v_mfma_f32_16x16x32_bf16 v[112:115], v[136:139], v[156:159], 0
    v_mfma_f32_16x16x32_bf16 v[116:119], v[136:139], v[160:163], 0
    v_add_u32 v236, s52, v240
    v_mfma_f32_16x16x32_bf16 v[32:35], v[140:143], v[136:139], 0
    v_mfma_f32_16x16x32_bf16 v[36:39], v[144:147], v[136:139], 0
    s_waitcnt lgkmcnt(0)
    v_mfma_f32_16x16x32_bf16 v[40:43], v[192:195], v[164:167], v[40:43]
    v_mfma_f32_16x16x32_bf16 v[44:47], v[196:199], v[164:167], v[44:47]
    v_mfma_f32_16x16x32_bf16 v[80:83], v[164:167], v[200:203], v[80:83]
    v_mfma_f32_16x16x32_bf16 v[84:87], v[164:167], v[204:207], v[84:87]
    v_mfma_f32_16x16x32_bf16 v[48:51], v[192:195], v[168:171], v[48:51]
    v_mfma_f32_16x16x32_bf16 v[52:55], v[196:199], v[168:171], v[52:55]
    v_mfma_f32_16x16x32_bf16 v[88:91], v[168:171], v[200:203], v[88:91]
    v_mfma_f32_16x16x32_bf16 v[92:95], v[168:171], v[204:207], v[92:95]
    v_mfma_f32_16x16x32_bf16 v[8:11], v[184:187], v[168:171], v[8:11]
    v_mfma_f32_16x16x32_bf16 v[12:15], v[188:191], v[168:171], v[12:15]
    v_mfma_f32_16x16x32_bf16 v[56:59], v[192:195], v[172:175], v[56:59]
    v_mfma_f32_16x16x32_bf16 v[60:63], v[196:199], v[172:175], v[60:63]
    v_mfma_f32_16x16x32_bf16 v[96:99], v[172:175], v[200:203], v[96:99]
    v_mfma_f32_16x16x32_bf16 v[100:103], v[172:175], v[204:207], v[100:103]
    v_mfma_f32_16x16x32_bf16 v[16:19], v[184:187], v[172:175], v[16:19]
    v_mfma_f32_16x16x32_bf16 v[20:23], v[188:191], v[172:175], v[20:23]
    v_mfma_f32_16x16x32_bf16 v[64:67], v[192:195], v[176:179], v[64:67]
    v_mfma_f32_16x16x32_bf16 v[68:71], v[196:199], v[176:179], v[68:71]
    v_mfma_f32_16x16x32_bf16 v[104:107], v[176:179], v[200:203], v[104:107]
    v_mfma_f32_16x16x32_bf16 v[108:111], v[176:179], v[204:207], v[108:111]
    v_mfma_f32_16x16x32_bf16 v[24:27], v[184:187], v[176:179], v[24:27]
    v_mfma_f32_16x16x32_bf16 v[28:31], v[188:191], v[176:179], v[28:31]
    v_mfma_f32_16x16x32_bf16 v[72:75], v[192:195], v[180:183], v[72:75]
    v_mfma_f32_16x16x32_bf16 v[76:79], v[196:199], v[180:183], v[76:79]
    v_mfma_f32_16x16x32_bf16 v[112:115], v[180:183], v[200:203], v[112:115]
    v_mfma_f32_16x16x32_bf16 v[116:119], v[180:183], v[204:207], v[116:119]
    v_mfma_f32_16x16x32_bf16 v[32:35], v[184:187], v[180:183], v[32:35]
    v_mfma_f32_16x16x32_bf16 v[36:39], v[188:191], v[180:183], v[36:39]
    s_barrier
    s_mov_b64 exec, 1
    buffer_store_dword v3, v2, s[28:31], 0 offen sc1
    s_mov_b64 exec, -1
    s_barrier
    ds_read_b128 v[120:123], v232 offset:0
    ds_read_b64_tr_b16 v[148:149], v235 offset:128
    ds_read_b64_tr_b16 v[150:151], v235 offset:1664
    ds_read_b64_tr_b16 v[152:153], v236 offset:128
    ds_read_b64_tr_b16 v[154:155], v236 offset:1664
    ds_read_b64_tr_b16 v[156:157], v235 offset:256
    ds_read_b64_tr_b16 v[158:159], v235 offset:1792
    ds_read_b64_tr_b16 v[160:161], v236 offset:256
    ds_read_b64_tr_b16 v[162:163], v236 offset:1792
    ds_read_b128 v[124:127], v232 offset:2048
    ds_read_b64_tr_b16 v[140:141], v235 offset:0
    ds_read_b64_tr_b16 v[142:143], v235 offset:1536
    ds_read_b64_tr_b16 v[144:145], v236 offset:0
    ds_read_b64_tr_b16 v[146:147], v236 offset:1536
    ds_read_b128 v[128:131], v232 offset:4096
    ds_read_b128 v[132:135], v232 offset:6144
    ds_read_b128 v[136:139], v232 offset:8192
    s_add_u32 s52, s52, 49152
    s_cmp_ge_u32 s52, 147456
    s_cselect_b32 s52, 0, s52
    s_waitcnt lgkmcnt(0)
    v_mfma_f32_16x16x32_bf16 v[40:43], v[148:151], v[120:123], v[40:43]
    ds_read_b128 v[164:167], v232 offset:1024
    v_mfma_f32_16x16x32_bf16 v[44:47], v[152:155], v[120:123], v[44:47]
    ds_read_b64_tr_b16 v[192:193], v235 offset:12416
    v_mfma_f32_16x16x32_bf16 v[80:83], v[120:123], v[156:159], v[80:83]
    ds_read_b64_tr_b16 v[194:195], v235 offset:13952
    v_mfma_f32_16x16x32_bf16 v[84:87], v[120:123], v[160:163], v[84:87]
    ds_read_b64_tr_b16 v[196:197], v236 offset:12416
    v_mfma_f32_16x16x32_bf16 v[48:51], v[148:151], v[124:127], v[48:51]
    ds_read_b64_tr_b16 v[198:199], v236 offset:13952
    v_mfma_f32_16x16x32_bf16 v[52:55], v[152:155], v[124:127], v[52:55]
    v_mfma_f32_16x16x32_bf16 v[88:91], v[124:127], v[156:159], v[88:91]
    ds_read_b64_tr_b16 v[200:201], v235 offset:12544
    v_mfma_f32_16x16x32_bf16 v[92:95], v[124:127], v[160:163], v[92:95]
    ds_read_b64_tr_b16 v[202:203], v235 offset:14080
    v_mfma_f32_16x16x32_bf16 v[8:11], v[140:143], v[124:127], v[8:11]
    ds_read_b64_tr_b16 v[204:205], v236 offset:12544
    v_mfma_f32_16x16x32_bf16 v[12:15], v[144:147], v[124:127], v[12:15]
    ds_read_b64_tr_b16 v[206:207], v236 offset:14080
    v_mfma_f32_16x16x32_bf16 v[56:59], v[148:151], v[128:131], v[56:59]
    v_mfma_f32_16x16x32_bf16 v[60:63], v[152:155], v[128:131], v[60:63]
    ds_read_b128 v[168:171], v232 offset:3072
    v_mfma_f32_16x16x32_bf16 v[96:99], v[128:131], v[156:159], v[96:99]
    ds_read_b64_tr_b16 v[184:185], v235 offset:12288
    v_mfma_f32_16x16x32_bf16 v[100:103], v[128:131], v[160:163], v[100:103]
    ds_read_b64_tr_b16 v[186:187], v235 offset:13824
    v_mfma_f32_16x16x32_bf16 v[16:19], v[140:143], v[128:131], v[16:19]
    s_movk_i32 s54, 13
M_P_loop0:
    ds_read_b64_tr_b16 v[188:189], v236 offset:12288
    v_mfma_f32_16x16x32_bf16 v[20:23], v[144:147], v[128:131], v[20:23]
    v_mfma_f32_16x16x32_bf16 v[64:67], v[148:151], v[132:135], v[64:67]
    ds_read_b64_tr_b16 v[190:191], v236 offset:13824
    v_mfma_f32_16x16x32_bf16 v[68:71], v[152:155], v[132:135], v[68:71]
    ds_read_b128 v[172:175], v232 offset:5120
    v_mfma_f32_16x16x32_bf16 v[104:107], v[132:135], v[156:159], v[104:107]
    ds_read_b128 v[176:179], v232 offset:7168
    v_mfma_f32_16x16x32_bf16 v[108:111], v[132:135], v[160:163], v[108:111]
    ds_read_b128 v[180:183], v232 offset:9216
    v_mfma_f32_16x16x32_bf16 v[24:27], v[140:143], v[132:135], v[24:27]
    v_mfma_f32_16x16x32_bf16 v[28:31], v[144:147], v[132:135], v[28:31]
    v_add_u32 v232, s52, v233
    v_mfma_f32_16x16x32_bf16 v[72:75], v[148:151], v[136:139], v[72:75]
    v_mfma_f32_16x16x32_bf16 v[76:79], v[152:155], v[136:139], v[76:79]
    v_add_u32 v235, s52, v239
    v_mfma_f32_16x16x32_bf16 v[112:115], v[136:139], v[156:159], v[112:115]
    v_mfma_f32_16x16x32_bf16 v[116:119], v[136:139], v[160:163], v[116:119]
    v_add_u32 v236, s52, v240
    v_mfma_f32_16x16x32_bf16 v[32:35], v[140:143], v[136:139], v[32:35]
    v_mfma_f32_16x16x32_bf16 v[36:39], v[144:147], v[136:139], v[36:39]
    s_waitcnt lgkmcnt(0)
    v_mfma_f32_16x16x32_bf16 v[40:43], v[192:195], v[164:167], v[40:43]
    s_barrier
    v_mfma_f32_16x16x32_bf16 v[44:47], v[196:199], v[164:167], v[44:47]
    ds_read_b128 v[120:123], v232 offset:0
    v_mfma_f32_16x16x32_bf16 v[80:83], v[164:167], v[200:203], v[80:83]
    ds_read_b64_tr_b16 v[148:149], v235 offset:128
    v_mfma_f32_16x16x32_bf16 v[84:87], v[164:167], v[204:207], v[84:87]
    ds_read_b64_tr_b16 v[150:151], v235 offset:1664
    v_mfma_f32_16x16x32_bf16 v[48:51], v[192:195], v[168:171], v[48:51]
    ds_read_b64_tr_b16 v[152:153], v236 offset:128
    v_mfma_f32_16x16x32_bf16 v[52:55], v[196:199], v[168:171], v[52:55]
    ds_read_b64_tr_b16 v[154:155], v236 offset:1664
    v_mfma_f32_16x16x32_bf16 v[88:91], v[168:171], v[200:203], v[88:91]
    ds_read_b64_tr_b16 v[156:157], v235 offset:256
    v_mfma_f32_16x16x32_bf16 v[92:95], v[168:171], v[204:207], v[92:95]
    v_mfma_f32_16x16x32_bf16 v[8:11], v[184:187], v[168:171], v[8:11]
    ds_read_b64_tr_b16 v[158:159], v235 offset:1792
    v_mfma_f32_16x16x32_bf16 v[12:15], v[188:191], v[168:171], v[12:15]
    ds_read_b64_tr_b16 v[160:161], v236 offset:256
    v_mfma_f32_16x16x32_bf16 v[56:59], v[192:195], v[172:175], v[56:59]
    ds_read_b64_tr_b16 v[162:163], v236 offset:1792
    v_mfma_f32_16x16x32_bf16 v[60:63], v[196:199], v[172:175], v[60:63]
    ds_read_b128 v[124:127], v232 offset:2048
    v_mfma_f32_16x16x32_bf16 v[96:99], v[172:175], v[200:203], v[96:99]
    ds_read_b64_tr_b16 v[140:141], v235 offset:0
    v_mfma_f32_16x16x32_bf16 v[100:103], v[172:175], v[204:207], v[100:103]
    ds_read_b64_tr_b16 v[142:143], v235 offset:1536
    v_mfma_f32_16x16x32_bf16 v[16:19], v[184:187], v[172:175], v[16:19]
    v_mfma_f32_16x16x32_bf16 v[20:23], v[188:191], v[172:175], v[20:23]
    ds_read_b64_tr_b16 v[144:145], v236 offset:0
    v_mfma_f32_16x16x32_bf16 v[64:67], v[192:195], v[176:179], v[64:67]
    ds_read_b64_tr_b16 v[146:147], v236 offset:1536
    v_mfma_f32_16x16x32_bf16 v[68:71], v[196:199], v[176:179], v[68:71]
    ds_read_b128 v[128:131], v232 offset:4096
    v_mfma_f32_16x16x32_bf16 v[104:107], v[176:179], v[200:203], v[104:107]
    ds_read_b128 v[132:135], v232 offset:6144
    v_mfma_f32_16x16x32_bf16 v[108:111], v[176:179], v[204:207], v[108:111]
    ds_read_b128 v[136:139], v232 offset:8192
    v_mfma_f32_16x16x32_bf16 v[24:27], v[184:187], v[176:179], v[24:27]
    v_mfma_f32_16x16x32_bf16 v[28:31], v[188:191], v[176:179], v[28:31]
    v_mfma_f32_16x16x32_bf16 v[72:75], v[192:195], v[180:183], v[72:75]
    v_mfma_f32_16x16x32_bf16 v[76:79], v[196:199], v[180:183], v[76:79]
    v_mfma_f32_16x16x32_bf16 v[112:115], v[180:183], v[200:203], v[112:115]
    v_mfma_f32_16x16x32_bf16 v[116:119], v[180:183], v[204:207], v[116:119]
    v_mfma_f32_16x16x32_bf16 v[32:35], v[184:187], v[180:183], v[32:35]
    s_add_u32 s52, s52, 49152
    s_cmp_ge_u32 s52, 147456
    s_cselect_b32 s52, 0, s52
    v_mfma_f32_16x16x32_bf16 v[36:39], v[188:191], v[180:183], v[36:39]
    s_waitcnt lgkmcnt(0)
    v_mfma_f32_16x16x32_bf16 v[40:43], v[148:151], v[120:123], v[40:43]
    ds_read_b128 v[164:167], v232 offset:1024
    v_mfma_f32_16x16x32_bf16 v[44:47], v[152:155], v[120:123], v[44:47]
    ds_read_b64_tr_b16 v[192:193], v235 offset:12416
    v_mfma_f32_16x16x32_bf16 v[80:83], v[120:123], v[156:159], v[80:83]
    ds_read_b64_tr_b16 v[194:195], v235 offset:13952
    v_mfma_f32_16x16x32_bf16 v[84:87], v[120:123], v[160:163], v[84:87]
    ds_read_b64_tr_b16 v[196:197], v236 offset:12416
    v_mfma_f32_16x16x32_bf16 v[48:51], v[148:151], v[124:127], v[48:51]
    ds_read_b64_tr_b16 v[198:199], v236 offset:13952
    v_mfma_f32_16x16x32_bf16 v[52:55], v[152:155], v[124:127], v[52:55]
    v_mfma_f32_16x16x32_bf16 v[88:91], v[124:127], v[156:159], v[88:91]
    ds_read_b64_tr_b16 v[200:201], v235 offset:12544
    v_mfma_f32_16x16x32_bf16 v[92:95], v[124:127], v[160:163], v[92:95]
    ds_read_b64_tr_b16 v[202:203], v235 offset:14080
    v_mfma_f32_16x16x32_bf16 v[8:11], v[140:143], v[124:127], v[8:11]
    ds_read_b64_tr_b16 v[204:205], v236 offset:12544
    v_mfma_f32_16x16x32_bf16 v[12:15], v[144:147], v[124:127], v[12:15]
    ds_read_b64_tr_b16 v[206:207], v236 offset:14080
    v_mfma_f32_16x16x32_bf16 v[56:59], v[148:151], v[128:131], v[56:59]
    v_mfma_f32_16x16x32_bf16 v[60:63], v[152:155], v[128:131], v[60:63]
    ds_read_b128 v[168:171], v232 offset:3072
    v_mfma_f32_16x16x32_bf16 v[96:99], v[128:131], v[156:159], v[96:99]
    ds_read_b64_tr_b16 v[184:185], v235 offset:12288
    v_mfma_f32_16x16x32_bf16 v[100:103], v[128:131], v[160:163], v[100:103]
    s_sub_u32 s54, s54, 1
    ds_read_b64_tr_b16 v[186:187], v235 offset:13824
    v_mfma_f32_16x16x32_bf16 v[16:19], v[140:143], v[128:131], v[16:19]
    s_cbranch_scc0 M_P_loop0
    ds_read_b64_tr_b16 v[188:189], v236 offset:12288
    v_mfma_f32_16x16x32_bf16 v[20:23], v[144:147], v[128:131], v[20:23]
    v_mfma_f32_16x16x32_bf16 v[64:67], v[148:151], v[132:135], v[64:67]
    ds_read_b64_tr_b16 v[190:191], v236 offset:13824
    v_mfma_f32_16x16x32_bf16 v[68:71], v[152:155], v[132:135], v[68:71]
    ds_read_b128 v[172:175], v232 offset:5120
    v_mfma_f32_16x16x32_bf16 v[104:107], v[132:135], v[156:159], v[104:107]
    ds_read_b128 v[176:179], v232 offset:7168
    v_mfma_f32_16x16x32_bf16 v[108:111], v[132:135], v[160:163], v[108:111]
    ds_read_b128 v[180:183], v232 offset:9216
    v_mfma_f32_16x16x32_bf16 v[24:27], v[140:143], v[132:135], v[24:27]
    v_mfma_f32_16x16x32_bf16 v[28:31], v[144:147], v[132:135], v[28:31]
    v_mfma_f32_16x16x32_bf16 v[72:75], v[148:151], v[136:139], v[72:75]
    v_mfma_f32_16x16x32_bf16 v[76:79], v[152:155], v[136:139], v[76:79]
    v_mfma_f32_16x16x32_bf16 v[112:115], v[136:139], v[156:159], v[112:115]
    v_mfma_f32_16x16x32_bf16 v[116:119], v[136:139], v[160:163], v[116:119]
    v_mfma_f32_16x16x32_bf16 v[32:35], v[140:143], v[136:139], v[32:35]
    v_mfma_f32_16x16x32_bf16 v[36:39], v[144:147], v[136:139], v[36:39]
    s_waitcnt lgkmcnt(0)
    v_mfma_f32_16x16x32_bf16 v[40:43], v[192:195], v[164:167], v[40:43]
    s_barrier
    v_mfma_f32_16x16x32_bf16 v[44:47], v[196:199], v[164:167], v[44:47]
    v_mfma_f32_16x16x32_bf16 v[80:83], v[164:167], v[200:203], v[80:83]
    v_mfma_f32_16x16x32_bf16 v[84:87], v[164:167], v[204:207], v[84:87]
    v_mfma_f32_16x16x32_bf16 v[48:51], v[192:195], v[168:171], v[48:51]
    v_mfma_f32_16x16x32_bf16 v[52:55], v[196:199], v[168:171], v[52:55]
    v_mfma_f32_16x16x32_bf16 v[88:91], v[168:171], v[200:203], v[88:91]
    v_mfma_f32_16x16x32_bf16 v[92:95], v[168:171], v[204:207], v[92:95]
    v_mfma_f32_16x16x32_bf16 v[8:11], v[184:187], v[168:171], v[8:11]
    v_mfma_f32_16x16x32_bf16 v[12:15], v[188:191], v[168:171], v[12:15]
    v_mfma_f32_16x16x32_bf16 v[56:59], v[192:195], v[172:175], v[56:59]
    v_mfma_f32_16x16x32_bf16 v[60:63], v[196:199], v[172:175], v[60:63]
    v_mfma_f32_16x16x32_bf16 v[96:99], v[172:175], v[200:203], v[96:99]
    v_mfma_f32_16x16x32_bf16 v[100:103], v[172:175], v[204:207], v[100:103]
    v_mfma_f32_16x16x32_bf16 v[16:19], v[184:187], v[172:175], v[16:19]
    v_mfma_f32_16x16x32_bf16 v[20:23], v[188:191], v[172:175], v[20:23]
    v_mfma_f32_16x16x32_bf16 v[64:67], v[192:195], v[176:179], v[64:67]
    v_mfma_f32_16x16x32_bf16 v[68:71], v[196:199], v[176:179], v[68:71]
    v_mfma_f32_16x16x32_bf16 v[104:107], v[176:179], v[200:203], v[104:107]
    v_mfma_f32_16x16x32_bf16 v[108:111], v[176:179], v[204:207], v[108:111]
    v_mfma_f32_16x16x32_bf16 v[24:27], v[184:187], v[176:179], v[24:27]
    v_mfma_f32_16x16x32_bf16 v[28:31], v[188:191], v[176:179], v[28:31]
    v_mfma_f32_16x16x32_bf16 v[72:75], v[192:195], v[180:183], v[72:75]
    v_mfma_f32_16x16x32_bf16 v[76:79], v[196:199], v[180:183], v[76:79]
    v_mfma_f32_16x16x32_bf16 v[112:115], v[180:183], v[200:203], v[112:115]
    v_mfma_f32_16x16x32_bf16 v[116:119], v[180:183], v[204:207], v[116:119]
    v_mfma_f32_16x16x32_bf16 v[32:35], v[184:187], v[180:183], v[32:35]
    v_mfma_f32_16x16x32_bf16 v[36:39], v[188:191], v[180:183], v[36:39]
    v_cvt_pk_bf16_f32 v120, v40, v41
    v_cvt_pk_bf16_f32 v121, v42, v43
    v_cvt_pk_bf16_f32 v122, v44, v45
    v_cvt_pk_bf16_f32 v123, v46, v47
    v_cvt_pk_bf16_f32 v124, v48, v49
    v_cvt_pk_bf16_f32 v125, v50, v51
    v_cvt_pk_bf16_f32 v126, v52, v53
    v_cvt_pk_bf16_f32 v127, v54, v55
    v_cvt_pk_bf16_f32 v140, v8, v9
    v_cvt_pk_bf16_f32 v141, v10, v11
    v_cvt_pk_bf16_f32 v142, v12, v13
    v_cvt_pk_bf16_f32 v143, v14, v15
    v_cvt_pk_bf16_f32 v128, v56, v57
    v_cvt_pk_bf16_f32 v129, v58, v59
    v_cvt_pk_bf16_f32 v130, v60, v61
    v_cvt_pk_bf16_f32 v131, v62, v63
    v_cvt_pk_bf16_f32 v144, v16, v17
    v_cvt_pk_bf16_f32 v145, v18, v19
    v_cvt_pk_bf16_f32 v146, v20, v21
    v_cvt_pk_bf16_f32 v147, v22, v23
    v_cvt_pk_bf16_f32 v132, v64, v65
    v_cvt_pk_bf16_f32 v133, v66, v67
    v_cvt_pk_bf16_f32 v134, v68, v69
    v_cvt_pk_bf16_f32 v135, v70, v71
    v_cvt_pk_bf16_f32 v148, v24, v25
    v_cvt_pk_bf16_f32 v149, v26, v27
    v_cvt_pk_bf16_f32 v150, v28, v29
    v_cvt_pk_bf16_f32 v151, v30, v31
    v_cvt_pk_bf16_f32 v136, v72, v73
    v_cvt_pk_bf16_f32 v137, v74, v75
    v_cvt_pk_bf16_f32 v138, v76, v77
    v_cvt_pk_bf16_f32 v139, v78, v79
    v_cvt_pk_bf16_f32 v152, v32, v33
    v_cvt_pk_bf16_f32 v153, v34, v35
    v_cvt_pk_bf16_f32 v154, v36, v37
    v_cvt_pk_bf16_f32 v155, v38, v39
    v_mfma_f32_16x16x32_bf16 v[8:11], v[120:123], v[140:143], 0
    v_mfma_f32_16x16x32_bf16 v[12:15], v[124:127], v[140:143], 0
    v_mfma_f32_16x16x32_bf16 v[16:19], v[124:127], v[144:147], 0
    v_mfma_f32_16x16x32_bf16 v[20:23], v[128:131], v[144:147], 0
    v_mfma_f32_16x16x32_bf16 v[24:27], v[128:131], v[148:151], 0
    v_mfma_f32_16x16x32_bf16 v[28:31], v[132:135], v[148:151], 0
    v_mfma_f32_16x16x32_bf16 v[32:35], v[132:135], v[152:155], 0
    v_mfma_f32_16x16x32_bf16 v[36:39], v[136:139], v[152:155], 0
    v_cvt_pk_bf16_f32 v156, v80, v81
    v_cvt_pk_bf16_f32 v157, v82, v83
    v_cvt_pk_bf16_f32 v166, v84, v85
    v_cvt_pk_bf16_f32 v167, v86, v87
    v_cvt_pk_bf16_f32 v158, v88, v89
    v_cvt_pk_bf16_f32 v159, v90, v91
    v_cvt_pk_bf16_f32 v168, v92, v93
    v_cvt_pk_bf16_f32 v169, v94, v95
    v_cvt_pk_bf16_f32 v160, v96, v97
    v_cvt_pk_bf16_f32 v161, v98, v99
    v_cvt_pk_bf16_f32 v170, v100, v101
    v_cvt_pk_bf16_f32 v171, v102, v103
    v_cvt_pk_bf16_f32 v162, v104, v105
    v_cvt_pk_bf16_f32 v163, v106, v107
    v_cvt_pk_bf16_f32 v172, v108, v109
    v_cvt_pk_bf16_f32 v173, v110, v111
    v_cvt_pk_bf16_f32 v164, v112, v113
    v_cvt_pk_bf16_f32 v165, v114, v115
    v_cvt_pk_bf16_f32 v174, v116, v117
    v_cvt_pk_bf16_f32 v175, v118, v119
    s_mov_b32 s64, 0x3e8293ee
    v_mov_b32 v5, 0xf149f2ca
    v_cndmask_b32 v8, v5, v8, s[88:89]
    v_cndmask_b32 v12, v5, v12, s[80:81]
    v_cndmask_b32 v9, v5, v9, s[90:91]
    v_cndmask_b32 v13, v5, v13, s[82:83]
    v_cndmask_b32 v10, v5, v10, s[92:93]
    v_cndmask_b32 v14, v5, v14, s[84:85]
    v_cndmask_b32 v11, v5, v11, s[94:95]
    v_cndmask_b32 v15, v5, v15, s[86:87]
    v_cndmask_b32 v16, v5, v16, s[72:73]
    v_cndmask_b32 v20, v5, v20, s[80:81]
    v_cndmask_b32 v17, v5, v17, s[74:75]
    v_cndmask_b32 v21, v5, v21, s[82:83]
    v_cndmask_b32 v18, v5, v18, s[76:77]
    v_cndmask_b32 v22, v5, v22, s[84:85]
    v_cndmask_b32 v19, v5, v19, s[78:79]
    v_cndmask_b32 v23, v5, v23, s[86:87]
    v_cndmask_b32 v24, v5, v24, s[72:73]
    v_cndmask_b32 v28, v5, v28, s[80:81]
    v_cndmask_b32 v25, v5, v25, s[74:75]
    v_cndmask_b32 v29, v5, v29, s[82:83]
    v_cndmask_b32 v26, v5, v26, s[76:77]
    v_cndmask_b32 v30, v5, v30, s[84:85]
    v_cndmask_b32 v27, v5, v27, s[78:79]
    v_cndmask_b32 v31, v5, v31, s[86:87]
    v_cndmask_b32 v32, v5, v32, s[72:73]
    v_cndmask_b32 v36, v5, v36, s[80:81]
    v_cndmask_b32 v33, v5, v33, s[74:75]
    v_cndmask_b32 v37, v5, v37, s[82:83]
    v_cndmask_b32 v34, v5, v34, s[76:77]
    v_cndmask_b32 v38, v5, v38, s[84:85]
    v_cndmask_b32 v35, v5, v35, s[78:79]
    v_cndmask_b32 v39, v5, v39, s[86:87]
    v_max3_f32 v192, v8, v9, v10
    v_max3_f32 v196, v11, v12, v13
    v_max3_f32 v193, v16, v17, v18
    v_max3_f32 v197, v19, v20, v21
    v_max3_f32 v194, v24, v25, v26
    v_max3_f32 v198, v27, v28, v29
    v_max3_f32 v195, v32, v33, v34
    v_max3_f32 v199, v35, v36, v37
    v_max3_f32 v192, v192, v14, v15
    v_max3_f32 v193, v193, v22, v23
    v_max3_f32 v194, v194, v30, v31
    v_max3_f32 v195, v195, v38, v39
    v_max_f32 v192, v192, v196
    v_max_f32 v193, v193, v197
    v_max_f32 v194, v194, v198
    v_max_f32 v195, v195, v199
    v_mov_b32 v196, v192
    v_mov_b32 v197, v193
    v_mov_b32 v198, v194
    v_mov_b32 v199, v195
    v_permlane32_swap_b32 v192, v196
    v_permlane32_swap_b32 v193, v197
    v_permlane32_swap_b32 v194, v198
    v_permlane32_swap_b32 v195, v199
    v_max_f32 v192, v192, v196
    v_max_f32 v193, v193, v197
    v_max_f32 v194, v194, v198
    v_max_f32 v195, v195, v199
    v_mov_b32 v196, v192
    v_mov_b32 v197, v193
    v_mov_b32 v198, v194
    v_mov_b32 v199, v195
    v_permlane16_swap_b32 v192, v196
    v_permlane16_swap_b32 v193, v197
    v_permlane16_swap_b32 v194, v198
    v_permlane16_swap_b32 v195, v199
    v_max_f32 v192, v192, v196
    v_max_f32 v193, v193, v197
    v_max_f32 v194, v194, v198
    v_max_f32 v195, v195, v199
    v_mul_f32 v192, s64, v192
    v_mul_f32 v193, s64, v193
    v_mul_f32 v194, s64, v194
    v_mul_f32 v195, s64, v195
    v_fma_f32 v8, v8, s64, -v192
    v_fma_f32 v9, v9, s64, -v192
    v_fma_f32 v10, v10, s64, -v192
    v_fma_f32 v11, v11, s64, -v192
    v_fma_f32 v12, v12, s64, -v192
    v_fma_f32 v13, v13, s64, -v192
    v_fma_f32 v14, v14, s64, -v192
    v_fma_f32 v15, v15, s64, -v192
    v_fma_f32 v16, v16, s64, -v193
    v_fma_f32 v17, v17, s64, -v193
    v_fma_f32 v18, v18, s64, -v193
    v_fma_f32 v19, v19, s64, -v193
    v_fma_f32 v20, v20, s64, -v193
    v_fma_f32 v21, v21, s64, -v193
    v_fma_f32 v22, v22, s64, -v193
    v_fma_f32 v23, v23, s64, -v193
    v_fma_f32 v24, v24, s64, -v194
    v_fma_f32 v25, v25, s64, -v194
    v_fma_f32 v26, v26, s64, -v194
    v_fma_f32 v27, v27, s64, -v194
    v_fma_f32 v28, v28, s64, -v194
    v_fma_f32 v29, v29, s64, -v194
    v_fma_f32 v30, v30, s64, -v194
    v_fma_f32 v31, v31, s64, -v194
    v_fma_f32 v32, v32, s64, -v195
    v_fma_f32 v33, v33, s64, -v195
    v_fma_f32 v34, v34, s64, -v195
    v_fma_f32 v35, v35, s64, -v195
    v_fma_f32 v36, v36, s64, -v195
    v_fma_f32 v37, v37, s64, -v195
    v_fma_f32 v38, v38, s64, -v195
    v_fma_f32 v39, v39, s64, -v195
    v_exp_f32 v8, v8
    v_exp_f32 v9, v9
    v_exp_f32 v10, v10
    v_exp_f32 v11, v11
    v_exp_f32 v12, v12
    v_exp_f32 v13, v13
    v_exp_f32 v14, v14
    v_exp_f32 v15, v15
    v_exp_f32 v16, v16
    v_exp_f32 v17, v17
    v_exp_f32 v18, v18
    v_exp_f32 v19, v19
    v_exp_f32 v20, v20
    v_exp_f32 v21, v21
    v_exp_f32 v22, v22
    v_exp_f32 v23, v23
    v_exp_f32 v24, v24
    v_exp_f32 v25, v25
    v_exp_f32 v26, v26
    v_exp_f32 v27, v27
    v_exp_f32 v28, v28
    v_exp_f32 v29, v29
    v_exp_f32 v30, v30
    v_exp_f32 v31, v31
    v_exp_f32 v32, v32
    v_exp_f32 v33, v33
    v_exp_f32 v34, v34
    v_exp_f32 v35, v35
    v_exp_f32 v36, v36
    v_exp_f32 v37, v37
    v_exp_f32 v38, v38
    v_exp_f32 v39, v39
    v_pk_add_f32 v[200:201], v[8:9], v[10:11]
    v_pk_add_f32 v[202:203], v[16:17], v[18:19]
    v_pk_add_f32 v[204:205], v[24:25], v[26:27]
    v_pk_add_f32 v[206:207], v[32:33], v[34:35]
    v_pk_add_f32 v[200:201], v[200:201], v[12:13]
    v_pk_add_f32 v[202:203], v[202:203], v[20:21]
    v_pk_add_f32 v[204:205], v[204:205], v[28:29]
    v_pk_add_f32 v[206:207], v[206:207], v[36:37]
    v_pk_add_f32 v[200:201], v[200:201], v[14:15]
    v_pk_add_f32 v[202:203], v[202:203], v[22:23]
    v_pk_add_f32 v[204:205], v[204:205], v[30:31]
    v_pk_add_f32 v[206:207], v[206:207], v[38:39]
    v_add_f32 v200, v200, v201
    v_add_f32 v202, v202, v203
    v_add_f32 v204, v204, v205
    v_add_f32 v206, v206, v207
    v_mov_b32 v196, v200
    v_mov_b32 v197, v202
    v_mov_b32 v198, v204
    v_mov_b32 v199, v206
    v_permlane32_swap_b32 v200, v196
    v_permlane32_swap_b32 v202, v197
    v_permlane32_swap_b32 v204, v198
    v_permlane32_swap_b32 v206, v199
    v_add_f32 v200, v200, v196
    v_add_f32 v202, v202, v197
    v_add_f32 v204, v204, v198
    v_add_f32 v206, v206, v199
    v_mov_b32 v196, v200
    v_mov_b32 v197, v202
    v_mov_b32 v198, v204
    v_mov_b32 v199, v206
    v_permlane16_swap_b32 v200, v196
    v_permlane16_swap_b32 v202, v197
    v_permlane16_swap_b32 v204, v198
    v_permlane16_swap_b32 v206, v199
    v_add_f32 v200, v200, v196
    v_add_f32 v202, v202, v197
    v_add_f32 v204, v204, v198
    v_add_f32 v206, v206, v199
    v_rcp_f32 v200, v200
    v_rcp_f32 v202, v202
    v_rcp_f32 v204, v204
    v_rcp_f32 v206, v206
    v_pk_mul_f32 v[8:9], v[8:9], v[200:201] op_sel_hi:[1,0]
    v_pk_mul_f32 v[10:11], v[10:11], v[200:201] op_sel_hi:[1,0]
    v_pk_mul_f32 v[12:13], v[12:13], v[200:201] op_sel_hi:[1,0]
    v_pk_mul_f32 v[14:15], v[14:15], v[200:201] op_sel_hi:[1,0]
    v_pk_mul_f32 v[16:17], v[16:17], v[202:203] op_sel_hi:[1,0]
    v_pk_mul_f32 v[18:19], v[18:19], v[202:203] op_sel_hi:[1,0]
    v_pk_mul_f32 v[20:21], v[20:21], v[202:203] op_sel_hi:[1,0]
    v_pk_mul_f32 v[22:23], v[22:23], v[202:203] op_sel_hi:[1,0]
    v_pk_mul_f32 v[24:25], v[24:25], v[204:205] op_sel_hi:[1,0]
    v_pk_mul_f32 v[26:27], v[26:27], v[204:205] op_sel_hi:[1,0]
    v_pk_mul_f32 v[28:29], v[28:29], v[204:205] op_sel_hi:[1,0]
    v_pk_mul_f32 v[30:31], v[30:31], v[204:205] op_sel_hi:[1,0]
    v_pk_mul_f32 v[32:33], v[32:33], v[206:207] op_sel_hi:[1,0]
    v_pk_mul_f32 v[34:35], v[34:35], v[206:207] op_sel_hi:[1,0]
    v_pk_mul_f32 v[36:37], v[36:37], v[206:207] op_sel_hi:[1,0]
    v_pk_mul_f32 v[38:39], v[38:39], v[206:207] op_sel_hi:[1,0]
    v_cvt_pk_bf16_f32 v176, v8, v9
    v_cvt_pk_bf16_f32 v177, v10, v11
    v_cvt_pk_bf16_f32 v178, v12, v13
    v_cvt_pk_bf16_f32 v179, v14, v15
    v_cvt_pk_bf16_f32 v180, v16, v17
    v_cvt_pk_bf16_f32 v181, v18, v19
    v_cvt_pk_bf16_f32 v182, v20, v21
    v_cvt_pk_bf16_f32 v183, v22, v23
    v_cvt_pk_bf16_f32 v184, v24, v25
    v_cvt_pk_bf16_f32 v185, v26, v27
    v_cvt_pk_bf16_f32 v186, v28, v29
    v_cvt_pk_bf16_f32 v187, v30, v31
    v_cvt_pk_bf16_f32 v188, v32, v33
    v_cvt_pk_bf16_f32 v189, v34, v35
    v_cvt_pk_bf16_f32 v190, v36, v37
    v_cvt_pk_bf16_f32 v191, v38, v39
    v_mfma_f32_16x16x32_bf16 v[40:43], v[156:159], v[176:179], 0
    v_mfma_f32_16x16x32_bf16 v[44:47], v[166:169], v[176:179], 0
    v_mfma_f32_16x16x32_bf16 v[48:51], v[158:161], v[180:183], 0
    v_mfma_f32_16x16x32_bf16 v[52:55], v[168:171], v[180:183], 0
    v_mfma_f32_16x16x32_bf16 v[56:59], v[160:163], v[184:187], 0
    v_mfma_f32_16x16x32_bf16 v[60:63], v[170:173], v[184:187], 0
    v_mfma_f32_16x16x32_bf16 v[64:67], v[162:165], v[188:191], 0
    v_mfma_f32_16x16x32_bf16 v[68:71], v[172:175], v[188:191], 0
    s_mov_b32 s72, 0x0
    s_mov_b32 s73, 0x8000
    s_mov_b32 s74, 0x10000
    s_mov_b32 s75, 0x18000
    v_cvt_pk_bf16_f32 v120, v40, v41
    v_cvt_pk_bf16_f32 v121, v42, v43
    v_cvt_pk_bf16_f32 v122, v44, v45
    v_cvt_pk_bf16_f32 v123, v46, v47
    buffer_store_dwordx4 v[120:123], v237, s[28:31], s72 offen sc1
    v_cvt_pk_bf16_f32 v124, v48, v49
    v_cvt_pk_bf16_f32 v125, v50, v51
    v_cvt_pk_bf16_f32 v126, v52, v53
    v_cvt_pk_bf16_f32 v127, v54, v55
    buffer_store_dwordx4 v[124:127], v237, s[28:31], s73 offen sc1
    v_cvt_pk_bf16_f32 v128, v56, v57
    v_cvt_pk_bf16_f32 v129, v58, v59
    v_cvt_pk_bf16_f32 v130, v60, v61
    v_cvt_pk_bf16_f32 v131, v62, v63
    buffer_store_dwordx4 v[128:131], v237, s[28:31], s74 offen sc1
    v_cvt_pk_bf16_f32 v132, v64, v65
    v_cvt_pk_bf16_f32 v133, v66, v67
    v_cvt_pk_bf16_f32 v134, v68, v69
    v_cvt_pk_bf16_f32 v135, v70, v71
    buffer_store_dwordx4 v[132:135], v237, s[28:31], s75 offen sc1
    s_lshl_b32 s64, s44, 13
    s_lshl_b32 s65, s48, 9
    s_add_u32 s64, s64, s65
    s_add_u32 s64, s64, 0xa0000
    v_lshl_add_u32 v200, v1, 3, s64
    s_mov_b32 s76, 0
    s_mov_b32 s77, 32768
    s_mov_b32 s78, 65536
    s_mov_b32 s79, 98304
    s_lshl_b32 s68, s47, 9
    s_add_u32 s68, s68, 0x54000
    s_add_u32 s62, s26, s68
    s_addc_u32 s63, s27, 0
    s_lshr_b32 s68, s48, 2
    s_lshl_b32 s68, s68, 7
    v_mov_b32 v2, 1
    v_mov_b32 v5, 148484
    s_waitcnt vmcnt(0)
    s_mov_b64 exec, 1
    ds_add_rtn_u32 v245, v5, v2
    s_mov_b64 exec, -1
    s_mov_b32 s1, s0
    s_lshl_b32 s64, s48, 2
    s_waitcnt lgkmcnt(0)
    v_readfirstlane_b32 s3, v245
    s_nop 3
    s_cmp_lg_u32 s3, 3
    s_cbranch_scc1 M_po_ok
    s_atomic_swap s0, s[62:63], s64 offset:0
    s_atomic_swap s0, s[62:63], s64 offset:128
    s_atomic_swap s0, s[62:63], s64 offset:256
    s_atomic_swap s0, s[62:63], s64 offset:384
    s_mov_b32 s3, 0x40000
M_po_chk:
    s_load_dwordx16 s[80:95], s[62:63], s68 glc
    s_sub_u32 s3, s3, 1
    s_cbranch_scc1 M_po_ok
M_po_c2:
    s_waitcnt lgkmcnt(0)
    s_xor_b64 s[80:81], s[80:81], s[0:1]
    s_xor_b64 s[82:83], s[82:83], s[0:1]
    s_xor_b64 s[84:85], s[84:85], s[0:1]
    s_xor_b64 s[86:87], s[86:87], s[0:1]
    s_xor_b64 s[88:89], s[88:89], s[0:1]
    s_xor_b64 s[90:91], s[90:91], s[0:1]
    s_xor_b64 s[92:93], s[92:93], s[0:1]
    s_xor_b64 s[94:95], s[94:95], s[0:1]
    s_or_b64 s[80:81], s[80:81], s[82:83]
    s_or_b64 s[84:85], s[84:85], s[86:87]
    s_or_b64 s[88:89], s[88:89], s[90:91]
    s_or_b64 s[92:93], s[92:93], s[94:95]
    s_or_b64 s[80:81], s[80:81], s[84:85]
    s_or_b64 s[88:89], s[88:89], s[92:93]
    s_or_b64 s[80:81], s[80:81], s[88:89]
    s_cbranch_scc1 M_po_chk
M_po_ok:
    s_barrier
    s_setprio 0
    s_and_b32 s57, s58, 15
    s_lshr_b64 s[58:59], s[58:59], 4
    s_lshl_b32 s56, s57, 11
    s_mul_i32 s57, s57, 0x20000
    s_mov_b32 m0, s53
    s_nop 0
    buffer_load_dwordx4 v208, s[28:31], s56 offen offset:0 sc1 lds
    buffer_load_dwordx4 v208, s[28:31], s56 offen offset:1024 sc1 lds
    buffer_load_dwordx4 v209, s[28:31], s56 offen offset:2048 sc1 lds
    buffer_load_dwordx4 v209, s[28:31], s56 offen offset:3072 sc1 lds
    s_add_u32 s53, s53, 24576
    s_cmp_ge_u32 s53, s61
    s_cselect_b32 s53, s60, s53
    s_and_b32 s57, s58, 15
    s_lshr_b64 s[58:59], s[58:59], 4
    s_lshl_b32 s56, s57, 11
    s_mul_i32 s57, s57, 0x20000
    s_mov_b32 m0, s53
    s_nop 0
    buffer_load_dwordx4 v208, s[28:31], s56 offen offset:0 sc1 lds
    buffer_load_dwordx4 v208, s[28:31], s56 offen offset:1024 sc1 lds
    buffer_load_dwordx4 v209, s[28:31], s56 offen offset:2048 sc1 lds
    buffer_load_dwordx4 v209, s[28:31], s56 offen offset:3072 sc1 lds
    s_add_u32 s53, s53, 24576
    s_cmp_ge_u32 s53, s61
    s_cselect_b32 s53, s60, s53
    s_and_b32 s57, s58, 15
    s_lshr_b64 s[58:59], s[58:59], 4
    s_lshl_b32 s56, s57, 11
    s_mul_i32 s57, s57, 0x20000
    s_mov_b32 m0, s53
    s_nop 0
    buffer_load_dwordx4 v208, s[28:31], s56 offen offset:0 sc1 lds
    buffer_load_dwordx4 v208, s[28:31], s56 offen offset:1024 sc1 lds
    buffer_load_dwordx4 v209, s[28:31], s56 offen offset:2048 sc1 lds
    buffer_load_dwordx4 v209, s[28:31], s56 offen offset:3072 sc1 lds
    s_add_u32 s53, s53, 24576
    s_cmp_ge_u32 s53, s61
    s_cselect_b32 s53, s60, s53
    buffer_load_dwordx2 v[192:193], v200, s[28:31], s76 offen sc1
    buffer_load_dwordx2 v[194:195], v200, s[28:31], s77 offen sc1
    buffer_load_dwordx2 v[196:197], v200, s[28:31], s78 offen sc1
    buffer_load_dwordx2 v[198:199], v200, s[28:31], s79 offen sc1
    s_lshl_b32 s64, s45, 13
    v_lshl_add_u32 v233, v1, 4, s64
    v_lshrrev_b32 v2, 2, v1
    v_lshlrev_b32 v4, 8, v2
    v_and_b32 v5, 3, v1
    v_lshl_add_u32 v4, v5, 3, v4
    v_add_u32 v4, 16384, v4
    v_and_b32 v2, 7, v2
    s_lshl_b32 s64, s46, 2
    v_xor_b32 v2, s64, v2
    v_xor_b32 v3, 0, v2
    v_lshl_add_u32 v239, v3, 5, v4
    v_xor_b32 v3, 1, v2
    v_lshl_add_u32 v240, v3, 5, v4
    v_xor_b32 v3, 2, v2
    v_lshl_add_u32 v241, v3, 5, v4
    v_xor_b32 v3, 3, v2
    v_lshl_add_u32 v242, v3, 5, v4
    s_lshl_b32 s64, s2, 2
    s_add_u32 s64, s64, s44
    s_mul_i32 s64, s64, 7168
    s_add_u32 s64, s64, 5248
    s_add_u32 s10, s12, s64
    s_addc_u32 s11, s13, 0
    s_add_u32 s24, s14, s64
    s_addc_u32 s25, s15, 0
    s_mov_b32 s52, 0
    v_add_u32 v232, s52, v233
    v_add_u32 v235, s52, v239
    v_add_u32 v236, s52, v240
    v_add_u32 v237, s52, v241
    v_add_u32 v238, s52, v242
    s_movk_i32 s54, 2
M_P_loop1:
    s_waitcnt vmcnt(12)
    s_barrier
    s_and_b32 s57, s58, 15
    s_lshr_b64 s[58:59], s[58:59], 4
    s_lshl_b32 s56, s57, 11
    s_mul_i32 s57, s57, 0x20000
    s_mov_b32 m0, s53
    s_nop 0
    buffer_load_dwordx4 v208, s[28:31], s56 offen offset:0 sc1 lds
    buffer_load_dwordx4 v208, s[28:31], s56 offen offset:1024 sc1 lds
    buffer_load_dwordx4 v209, s[28:31], s56 offen offset:2048 sc1 lds
    buffer_load_dwordx4 v209, s[28:31], s56 offen offset:3072 sc1 lds
    s_add_u32 s53, s53, 24576
    s_cmp_ge_u32 s53, s61
    s_cselect_b32 s53, s60, s53
    s_sub_u32 s54, s54, 1
    s_cbranch_scc0 M_P_loop1
    s_waitcnt vmcnt(8)
    s_barrier
    s_and_b32 s57, s58, 15
    s_lshr_b64 s[58:59], s[58:59], 4
    s_lshl_b32 s56, s57, 11
    s_mul_i32 s57, s57, 0x20000
    s_add_u32 m0, s53, s70
    s_nop 0
    buffer_load_dwordx4 v210, s[32:35], s57 offen offset:0 lds
    buffer_load_dwordx4 v211, s[32:35], s57 offen offset:1024 lds
    s_mov_b32 m0, s53
    s_nop 0
    buffer_load_dwordx4 v208, s[28:31], s56 offen offset:0 sc1 lds
    buffer_load_dwordx4 v208, s[28:31], s56 offen offset:1024 sc1 lds
    buffer_load_dwordx4 v209, s[28:31], s56 offen offset:2048 sc1 lds
    buffer_load_dwordx4 v209, s[28:31], s56 offen offset:3072 sc1 lds
    s_add_u32 s53, s53, 24576
    s_cmp_ge_u32 s53, s61
    s_cselect_b32 s53, s60, s53
    s_mov_b32 s3, 0x40000
M_tb_chk:
    v_xor_b32 v2, s0, v193
    v_xor_b32 v3, s0, v195
    v_xor_b32 v4, s0, v197
    v_xor_b32 v5, s0, v199
    v_or3_b32 v2, v2, v3, v4
    v_or_b32 v2, v2, v5
    v_cmp_ne_u32 vcc, 0, v2
    s_nop 4
    s_cbranch_vccz M_tb_ok
    s_sub_u32 s3, s3, 1
    s_cbranch_scc1 M_tb_ok
    s_sleep 1
    buffer_load_dwordx2 v[192:193], v200, s[28:31], s76 offen sc1
    buffer_load_dwordx2 v[194:195], v200, s[28:31], s77 offen sc1
    buffer_load_dwordx2 v[196:197], v200, s[28:31], s78 offen sc1
    buffer_load_dwordx2 v[198:199], v200, s[28:31], s79 offen sc1
    s_waitcnt vmcnt(0)
    s_branch M_tb_chk
M_tb_ok:
    v_add_f32 v192, v192, v194
    v_add_f32 v196, v196, v198
    v_add_f32 v192, v192, v196
    v_cvt_pk_bf16_f32 v193, v192, v192
    v_lshlrev_b32 v192, 16, v193
    s_cmp_eq_u32 s44, 2
    s_cselect_b32 s64, 1.0, 0
    v_add_f32 v192, s64, v192
    v_cvt_pk_bf16_f32 v193, v192, v192
    v_lshlrev_b32 v192, 16, v193
    s_cmp_lg_u32 s45, s46
    s_cselect_b32 s64, 0x3fb8aa3b, 1.0
    v_mul_f32 v192, s64, v192
    s_lshl_b32 s64, s44, 8
    s_add_u32 s64, s64, 149504
    v_add_u32 v2, s64, v234
    ds_write_b32 v2, v192
    s_lshl_b32 s64, s47, 12
    s_lshl_b32 s65, s48, 8
    s_add_u32 s64, s64, s65
    s_add_u32 s64, s64, 0xc0000
    s_cmp_eq_u32 s44, 3
    s_cselect_b32 s64, s64, 0x80000000
    v_add_u32 v2, s64, v234
    buffer_store_dword v192, v2, s[28:31], 0 offen sc1
    s_waitcnt lgkmcnt(0)
    s_waitcnt vmcnt(11)
    s_barrier
    s_and_b32 s57, s58, 15
    s_lshr_b64 s[58:59], s[58:59], 4
    s_lshl_b32 s56, s57, 11
    s_mul_i32 s57, s57, 0x20000
    s_add_u32 m0, s53, s70
    s_nop 0
    buffer_load_dwordx4 v210, s[32:35], s57 offen offset:0 lds
    buffer_load_dwordx4 v211, s[32:35], s57 offen offset:1024 lds
    s_mov_b32 m0, s53
    s_nop 0
    buffer_load_dwordx4 v208, s[28:31], s56 offen offset:0 sc1 lds
    buffer_load_dwordx4 v208, s[28:31], s56 offen offset:1024 sc1 lds
    buffer_load_dwordx4 v209, s[28:31], s56 offen offset:2048 sc1 lds
    buffer_load_dwordx4 v209, s[28:31], s56 offen offset:3072 sc1 lds
    s_add_u32 s53, s53, 24576
    s_cmp_ge_u32 s53, s61
    s_cselect_b32 s53, s60, s53
    s_movk_i32 s54, 1
M_P_loop2:
    s_waitcnt vmcnt(13)
    s_barrier
    s_and_b32 s57, s58, 15
    s_lshr_b64 s[58:59], s[58:59], 4
    s_lshl_b32 s56, s57, 11
    s_mul_i32 s57, s57, 0x20000
    s_add_u32 m0, s53, s70
    s_nop 0
    buffer_load_dwordx4 v210, s[32:35], s57 offen offset:0 lds
    buffer_load_dwordx4 v211, s[32:35], s57 offen offset:1024 lds
    s_mov_b32 m0, s53
    s_nop 0
    buffer_load_dwordx4 v208, s[28:31], s56 offen offset:0 sc1 lds
    buffer_load_dwordx4 v208, s[28:31], s56 offen offset:1024 sc1 lds
    buffer_load_dwordx4 v209, s[28:31], s56 offen offset:2048 sc1 lds
    buffer_load_dwordx4 v209, s[28:31], s56 offen offset:3072 sc1 lds
    s_add_u32 s53, s53, 24576
    s_cmp_ge_u32 s53, s61
    s_cselect_b32 s53, s60, s53
    s_sub_u32 s54, s54, 1
    s_cbranch_scc0 M_P_loop2
    s_movk_i32 s54, 4
M_P_loop3:
    s_waitcnt vmcnt(12)
    s_barrier
    s_and_b32 s57, s58, 15
    s_lshr_b64 s[58:59], s[58:59], 4
    s_lshl_b32 s56, s57, 11
    s_mul_i32 s57, s57, 0x20000
    s_add_u32 m0, s53, s70
    s_nop 0
    buffer_load_dwordx4 v210, s[32:35], s57 offen offset:0 lds
    buffer_load_dwordx4 v211, s[32:35], s57 offen offset:1024 lds
    s_mov_b32 m0, s53
    s_nop 0
    buffer_load_dwordx4 v208, s[28:31], s56 offen offset:0 sc1 lds
    buffer_load_dwordx4 v208, s[28:31], s56 offen offset:1024 sc1 lds
    buffer_load_dwordx4 v209, s[28:31], s56 offen offset:2048 sc1 lds
    buffer_load_dwordx4 v209, s[28:31], s56 offen offset:3072 sc1 lds
    s_add_u32 s53, s53, 24576
    s_cmp_ge_u32 s53, s61
    s_cselect_b32 s53, s60, s53
    s_sub_u32 s54, s54, 1
    s_cbranch_scc0 M_P_loop3
    s_waitcnt vmcnt(12)
    s_barrier
    s_and_b32 s57, s58, 15
    s_lshr_b64 s[58:59], s[58:59], 4
    s_lshl_b32 s56, s57, 11
    s_mul_i32 s57, s57, 0x20000
    s_add_u32 m0, s53, s70
    s_nop 0
    buffer_load_dwordx4 v210, s[32:35], s57 offen offset:0 lds
    buffer_load_dwordx4 v211, s[32:35], s57 offen offset:1024 lds
    s_mov_b32 m0, s53
    s_nop 0
    buffer_load_dwordx4 v208, s[28:31], s56 offen offset:0 sc1 lds
    buffer_load_dwordx4 v208, s[28:31], s56 offen offset:1024 sc1 lds
    buffer_load_dwordx4 v209, s[28:31], s56 offen offset:2048 sc1 lds
    buffer_load_dwordx4 v209, s[28:31], s56 offen offset:3072 sc1 lds
    s_add_u32 s53, s53, 24576
    s_cmp_ge_u32 s53, s61
    s_cselect_b32 s53, s60, s53
    s_lshl_b32 s60, s44, 12
    s_add_u32 s61, s60, 147456
    s_add_u32 s53, s60, 0
    s_bfe_u32 s66, s2, 0x30003
    s_lshr_b32 s55, s2, 6
    s_add_u32 s66, s66, s55
    s_and_b32 s66, s66, 3
    s_mov_b32 s58, 0x76453210
    s_mov_b32 s59, 0xfecdba89
    s_cmp_eq_u32 s66, 1
    s_cselect_b32 s58, 0x75643120, s58
    s_cselect_b32 s59, 0xfdecb9a8, s59
    s_cmp_eq_u32 s66, 2
    s_cselect_b32 s58, 0x67542310, s58
    s_cselect_b32 s59, 0xefdcab98, s59
    s_cmp_eq_u32 s66, 3
    s_cselect_b32 s58, 0x86534210, s58
    s_cselect_b32 s59, 0xfedbca97, s59
    s_and_b32 s66, s48, 15
    s_lshl_b32 s55, s66, 2
    s_lshr_b64 s[56:57], s[58:59], s55
    s_and_b32 s55, s56, 15
    s_lshl_b32 s55, s55, 2
    s_lshl_b64 s[56:57], 15, s55
    s_andn2_b64 s[58:59], s[58:59], s[56:57]
    s_or_b32 s58, s58, s66
    s_mov_b32 s32, s12
    s_mov_b32 s33, s13
    s_mov_b32 s34, 0x700000
    s_mov_b32 s35, 0x20000
    s_mov_b32 s36, s14
    s_mov_b32 s37, s15
    s_mov_b32 s38, 0x700000
    s_mov_b32 s39, 0x20000
    s_and_b32 s57, s58, 15
    s_lshr_b64 s[58:59], s[58:59], 4
    s_lshl_b32 s56, s57, 11
    s_mul_i32 s57, s57, 0x70000
    s_add_u32 m0, s53, 16384
    s_nop 0
    buffer_load_dwordx4 v212, s[32:35], s57 offen offset:0 lds
    buffer_load_dwordx4 v213, s[32:35], s57 offen offset:1024 lds
    s_waitcnt vmcnt(14)
    s_barrier
    buffer_load_dwordx4 v214, s[32:35], s57 offen offset:2048 lds
    buffer_load_dwordx4 v215, s[32:35], s57 offen offset:3072 lds
    s_add_u32 m0, s53, 32768
    s_nop 0
    buffer_load_dwordx4 v212, s[36:39], s57 offen offset:0 lds
    s_waitcnt vmcnt(11)
    s_barrier
    buffer_load_dwordx4 v213, s[36:39], s57 offen offset:1024 lds
    buffer_load_dwordx4 v214, s[36:39], s57 offen offset:2048 lds
    buffer_load_dwordx4 v215, s[36:39], s57 offen offset:3072 lds
    s_waitcnt vmcnt(8)
    s_barrier
    s_add_u32 s53, s53, 49152
    s_cmp_ge_u32 s53, s61
    s_cselect_b32 s53, s60, s53
    s_barrier
    s_setprio 2
    s_waitcnt vmcnt(0)
    s_barrier
    ds_read_b128 v[136:139], v232 offset:0
    ds_read_b64_tr_b16 v[152:153], v235 offset:0
    ds_read_b64_tr_b16 v[154:155], v235 offset:4096
    ds_read_b64_tr_b16 v[156:157], v236 offset:0
    ds_read_b64_tr_b16 v[158:159], v236 offset:4096
    ds_read_b64_tr_b16 v[160:161], v237 offset:0
    ds_read_b64_tr_b16 v[162:163], v237 offset:4096
    ds_read_b64_tr_b16 v[164:165], v238 offset:0
    ds_read_b64_tr_b16 v[166:167], v238 offset:4096
    ds_read_b64_tr_b16 v[168:169], v235 offset:16384
    ds_read_b64_tr_b16 v[170:171], v235 offset:20480
    ds_read_b64_tr_b16 v[172:173], v236 offset:16384
    ds_read_b64_tr_b16 v[174:175], v236 offset:20480
    ds_read_b64_tr_b16 v[176:177], v237 offset:16384
    ds_read_b64_tr_b16 v[178:179], v237 offset:20480
    ds_read_b64_tr_b16 v[180:181], v238 offset:16384
    ds_read_b64_tr_b16 v[182:183], v238 offset:20480
    ds_read_b128 v[140:143], v232 offset:2048
    ds_read_b128 v[144:147], v232 offset:4096
    ds_read_b128 v[148:151], v232 offset:6144
    s_add_u32 s52, s52, 49152
    s_cmp_ge_u32 s52, 147456
    s_cselect_b32 s52, 0, s52
    s_waitcnt lgkmcnt(0)
    v_mfma_f32_16x16x32_bf16 v[8:11], v[152:155], v[136:139], 0
    ds_read_b128 v[184:187], v232 offset:1024
    v_mfma_f32_16x16x32_bf16 v[12:15], v[156:159], v[136:139], 0
    ds_read_b64_tr_b16 v[200:201], v235 offset:8192
    v_mfma_f32_16x16x32_bf16 v[16:19], v[160:163], v[136:139], 0
    ds_read_b64_tr_b16 v[202:203], v235 offset:12288
    v_mfma_f32_16x16x32_bf16 v[20:23], v[164:167], v[136:139], 0
    ds_read_b64_tr_b16 v[204:205], v236 offset:8192
    v_mfma_f32_16x16x32_bf16 v[24:27], v[168:171], v[136:139], 0
    v_mfma_f32_16x16x32_bf16 v[28:31], v[172:175], v[136:139], 0
    ds_read_b64_tr_b16 v[206:207], v236 offset:12288
    v_mfma_f32_16x16x32_bf16 v[32:35], v[176:179], v[136:139], 0
    ds_read_b64_tr_b16 v[208:209], v237 offset:8192
    v_mfma_f32_16x16x32_bf16 v[36:39], v[180:183], v[136:139], 0
    ds_read_b64_tr_b16 v[210:211], v237 offset:12288
    v_mfma_f32_16x16x32_bf16 v[40:43], v[152:155], v[140:143], 0
    ds_read_b64_tr_b16 v[212:213], v238 offset:8192
    v_mfma_f32_16x16x32_bf16 v[44:47], v[156:159], v[140:143], 0
    v_mfma_f32_16x16x32_bf16 v[48:51], v[160:163], v[140:143], 0
    ds_read_b64_tr_b16 v[214:215], v238 offset:12288
    v_mfma_f32_16x16x32_bf16 v[52:55], v[164:167], v[140:143], 0
    ds_read_b64_tr_b16 v[216:217], v235 offset:24576
    v_mfma_f32_16x16x32_bf16 v[56:59], v[168:171], v[140:143], 0
    ds_read_b64_tr_b16 v[218:219], v235 offset:28672
    v_mfma_f32_16x16x32_bf16 v[60:63], v[172:175], v[140:143], 0
    ds_read_b64_tr_b16 v[220:221], v236 offset:24576
    v_mfma_f32_16x16x32_bf16 v[64:67], v[176:179], v[140:143], 0
    v_mfma_f32_16x16x32_bf16 v[68:71], v[180:183], v[140:143], 0
    ds_read_b64_tr_b16 v[222:223], v236 offset:28672
    v_mfma_f32_16x16x32_bf16 v[72:75], v[152:155], v[144:147], 0
    ds_read_b64_tr_b16 v[224:225], v237 offset:24576
    v_mfma_f32_16x16x32_bf16 v[76:79], v[156:159], v[144:147], 0
    ds_read_b64_tr_b16 v[226:227], v237 offset:28672
    v_mfma_f32_16x16x32_bf16 v[80:83], v[160:163], v[144:147], 0
    ds_read_b64_tr_b16 v[228:229], v238 offset:24576
    v_mfma_f32_16x16x32_bf16 v[84:87], v[164:167], v[144:147], 0
    v_mfma_f32_16x16x32_bf16 v[88:91], v[168:171], v[144:147], 0
    ds_read_b64_tr_b16 v[230:231], v238 offset:28672
    v_mfma_f32_16x16x32_bf16 v[92:95], v[172:175], v[144:147], 0
    ds_read_b128 v[188:191], v232 offset:3072
    v_mfma_f32_16x16x32_bf16 v[96:99], v[176:179], v[144:147], 0
    ds_read_b128 v[192:195], v232 offset:5120
    v_mfma_f32_16x16x32_bf16 v[100:103], v[180:183], v[144:147], 0
    ds_read_b128 v[196:199], v232 offset:7168
    v_mfma_f32_16x16x32_bf16 v[104:107], v[152:155], v[148:151], 0
    v_mfma_f32_16x16x32_bf16 v[108:111], v[156:159], v[148:151], 0
    v_add_u32 v232, s52, v233
    v_mfma_f32_16x16x32_bf16 v[112:115], v[160:163], v[148:151], 0
    v_add_u32 v235, s52, v239
    v_mfma_f32_16x16x32_bf16 v[116:119], v[164:167], v[148:151], 0
    v_add_u32 v236, s52, v240
    v_mfma_f32_16x16x32_bf16 v[120:123], v[168:171], v[148:151], 0
    v_mfma_f32_16x16x32_bf16 v[124:127], v[172:175], v[148:151], 0
    v_add_u32 v237, s52, v241
    v_mfma_f32_16x16x32_bf16 v[128:131], v[176:179], v[148:151], 0
    v_add_u32 v238, s52, v242
    v_mfma_f32_16x16x32_bf16 v[132:135], v[180:183], v[148:151], 0
    s_waitcnt lgkmcnt(0)
    v_mfma_f32_16x16x32_bf16 v[8:11], v[200:203], v[184:187], v[8:11]
    v_mfma_f32_16x16x32_bf16 v[12:15], v[204:207], v[184:187], v[12:15]
    v_mfma_f32_16x16x32_bf16 v[16:19], v[208:211], v[184:187], v[16:19]
    v_mfma_f32_16x16x32_bf16 v[20:23], v[212:215], v[184:187], v[20:23]
    v_mfma_f32_16x16x32_bf16 v[24:27], v[216:219], v[184:187], v[24:27]
    v_mfma_f32_16x16x32_bf16 v[28:31], v[220:223], v[184:187], v[28:31]
    v_mfma_f32_16x16x32_bf16 v[32:35], v[224:227], v[184:187], v[32:35]
    v_mfma_f32_16x16x32_bf16 v[36:39], v[228:231], v[184:187], v[36:39]
    v_mfma_f32_16x16x32_bf16 v[40:43], v[200:203], v[188:191], v[40:43]
    v_mfma_f32_16x16x32_bf16 v[44:47], v[204:207], v[188:191], v[44:47]
    v_mfma_f32_16x16x32_bf16 v[48:51], v[208:211], v[188:191], v[48:51]
    v_mfma_f32_16x16x32_bf16 v[52:55], v[212:215], v[188:191], v[52:55]
    v_mfma_f32_16x16x32_bf16 v[56:59], v[216:219], v[188:191], v[56:59]
    v_mfma_f32_16x16x32_bf16 v[60:63], v[220:223], v[188:191], v[60:63]
    v_mfma_f32_16x16x32_bf16 v[64:67], v[224:227], v[188:191], v[64:67]
    v_mfma_f32_16x16x32_bf16 v[68:71], v[228:231], v[188:191], v[68:71]
    v_mfma_f32_16x16x32_bf16 v[72:75], v[200:203], v[192:195], v[72:75]
    v_mfma_f32_16x16x32_bf16 v[76:79], v[204:207], v[192:195], v[76:79]
    v_mfma_f32_16x16x32_bf16 v[80:83], v[208:211], v[192:195], v[80:83]
    v_mfma_f32_16x16x32_bf16 v[84:87], v[212:215], v[192:195], v[84:87]
    v_mfma_f32_16x16x32_bf16 v[88:91], v[216:219], v[192:195], v[88:91]
    v_mfma_f32_16x16x32_bf16 v[92:95], v[220:223], v[192:195], v[92:95]
    v_mfma_f32_16x16x32_bf16 v[96:99], v[224:227], v[192:195], v[96:99]
    v_mfma_f32_16x16x32_bf16 v[100:103], v[228:231], v[192:195], v[100:103]
    v_mfma_f32_16x16x32_bf16 v[104:107], v[200:203], v[196:199], v[104:107]
    v_mfma_f32_16x16x32_bf16 v[108:111], v[204:207], v[196:199], v[108:111]
    v_mfma_f32_16x16x32_bf16 v[112:115], v[208:211], v[196:199], v[112:115]
    v_mfma_f32_16x16x32_bf16 v[116:119], v[212:215], v[196:199], v[116:119]
    v_mfma_f32_16x16x32_bf16 v[120:123], v[216:219], v[196:199], v[120:123]
    v_mfma_f32_16x16x32_bf16 v[124:127], v[220:223], v[196:199], v[124:127]
    v_mfma_f32_16x16x32_bf16 v[128:131], v[224:227], v[196:199], v[128:131]
    v_mfma_f32_16x16x32_bf16 v[132:135], v[228:231], v[196:199], v[132:135]
    s_barrier
    s_barrier
    ds_read_b128 v[136:139], v232 offset:0
    ds_read_b64_tr_b16 v[152:153], v235 offset:0
    ds_read_b64_tr_b16 v[154:155], v235 offset:4096
    ds_read_b64_tr_b16 v[156:157], v236 offset:0
    ds_read_b64_tr_b16 v[158:159], v236 offset:4096
    ds_read_b64_tr_b16 v[160:161], v237 offset:0
    ds_read_b64_tr_b16 v[162:163], v237 offset:4096
    ds_read_b64_tr_b16 v[164:165], v238 offset:0
    ds_read_b64_tr_b16 v[166:167], v238 offset:4096
    ds_read_b64_tr_b16 v[168:169], v235 offset:16384
    ds_read_b64_tr_b16 v[170:171], v235 offset:20480
    ds_read_b64_tr_b16 v[172:173], v236 offset:16384
    ds_read_b64_tr_b16 v[174:175], v236 offset:20480
    ds_read_b64_tr_b16 v[176:177], v237 offset:16384
    ds_read_b64_tr_b16 v[178:179], v237 offset:20480
    ds_read_b64_tr_b16 v[180:181], v238 offset:16384
    ds_read_b64_tr_b16 v[182:183], v238 offset:20480
    ds_read_b128 v[140:143], v232 offset:2048
    ds_read_b128 v[144:147], v232 offset:4096
    ds_read_b128 v[148:151], v232 offset:6144
    s_add_u32 s52, s52, 49152
    s_cmp_ge_u32 s52, 147456
    s_cselect_b32 s52, 0, s52
    s_waitcnt lgkmcnt(0)
    v_mfma_f32_16x16x32_bf16 v[8:11], v[152:155], v[136:139], v[8:11]
    ds_read_b128 v[184:187], v232 offset:1024
    v_mfma_f32_16x16x32_bf16 v[12:15], v[156:159], v[136:139], v[12:15]
    ds_read_b64_tr_b16 v[200:201], v235 offset:8192
    v_mfma_f32_16x16x32_bf16 v[16:19], v[160:163], v[136:139], v[16:19]
    ds_read_b64_tr_b16 v[202:203], v235 offset:12288
    v_mfma_f32_16x16x32_bf16 v[20:23], v[164:167], v[136:139], v[20:23]
    ds_read_b64_tr_b16 v[204:205], v236 offset:8192
    v_mfma_f32_16x16x32_bf16 v[24:27], v[168:171], v[136:139], v[24:27]
    v_mfma_f32_16x16x32_bf16 v[28:31], v[172:175], v[136:139], v[28:31]
    ds_read_b64_tr_b16 v[206:207], v236 offset:12288
    v_mfma_f32_16x16x32_bf16 v[32:35], v[176:179], v[136:139], v[32:35]
    ds_read_b64_tr_b16 v[208:209], v237 offset:8192
    v_mfma_f32_16x16x32_bf16 v[36:39], v[180:183], v[136:139], v[36:39]
    ds_read_b64_tr_b16 v[210:211], v237 offset:12288
    v_mfma_f32_16x16x32_bf16 v[40:43], v[152:155], v[140:143], v[40:43]
    ds_read_b64_tr_b16 v[212:213], v238 offset:8192
    v_mfma_f32_16x16x32_bf16 v[44:47], v[156:159], v[140:143], v[44:47]
    v_mfma_f32_16x16x32_bf16 v[48:51], v[160:163], v[140:143], v[48:51]
    ds_read_b64_tr_b16 v[214:215], v238 offset:12288
    v_mfma_f32_16x16x32_bf16 v[52:55], v[164:167], v[140:143], v[52:55]
    ds_read_b64_tr_b16 v[216:217], v235 offset:24576
    v_mfma_f32_16x16x32_bf16 v[56:59], v[168:171], v[140:143], v[56:59]
    ds_read_b64_tr_b16 v[218:219], v235 offset:28672
    v_mfma_f32_16x16x32_bf16 v[60:63], v[172:175], v[140:143], v[60:63]
    ds_read_b64_tr_b16 v[220:221], v236 offset:24576
    v_mfma_f32_16x16x32_bf16 v[64:67], v[176:179], v[140:143], v[64:67]
    v_mfma_f32_16x16x32_bf16 v[68:71], v[180:183], v[140:143], v[68:71]
    ds_read_b64_tr_b16 v[222:223], v236 offset:28672
    v_mfma_f32_16x16x32_bf16 v[72:75], v[152:155], v[144:147], v[72:75]
    s_movk_i32 s54, 13
M_P_loop4:
    ds_read_b64_tr_b16 v[224:225], v237 offset:24576
    v_mfma_f32_16x16x32_bf16 v[76:79], v[156:159], v[144:147], v[76:79]
    ds_read_b64_tr_b16 v[226:227], v237 offset:28672
    v_mfma_f32_16x16x32_bf16 v[80:83], v[160:163], v[144:147], v[80:83]
    ds_read_b64_tr_b16 v[228:229], v238 offset:24576
    v_mfma_f32_16x16x32_bf16 v[84:87], v[164:167], v[144:147], v[84:87]
    v_mfma_f32_16x16x32_bf16 v[88:91], v[168:171], v[144:147], v[88:91]
    ds_read_b64_tr_b16 v[230:231], v238 offset:28672
    v_mfma_f32_16x16x32_bf16 v[92:95], v[172:175], v[144:147], v[92:95]
    ds_read_b128 v[188:191], v232 offset:3072
    v_mfma_f32_16x16x32_bf16 v[96:99], v[176:179], v[144:147], v[96:99]
    ds_read_b128 v[192:195], v232 offset:5120
    v_mfma_f32_16x16x32_bf16 v[100:103], v[180:183], v[144:147], v[100:103]
    ds_read_b128 v[196:199], v232 offset:7168
    v_mfma_f32_16x16x32_bf16 v[104:107], v[152:155], v[148:151], v[104:107]
    v_mfma_f32_16x16x32_bf16 v[108:111], v[156:159], v[148:151], v[108:111]
    v_add_u32 v232, s52, v233
    v_mfma_f32_16x16x32_bf16 v[112:115], v[160:163], v[148:151], v[112:115]
    v_add_u32 v235, s52, v239
    v_mfma_f32_16x16x32_bf16 v[116:119], v[164:167], v[148:151], v[116:119]
    v_add_u32 v236, s52, v240
    v_mfma_f32_16x16x32_bf16 v[120:123], v[168:171], v[148:151], v[120:123]
    v_mfma_f32_16x16x32_bf16 v[124:127], v[172:175], v[148:151], v[124:127]
    v_add_u32 v237, s52, v241
    v_mfma_f32_16x16x32_bf16 v[128:131], v[176:179], v[148:151], v[128:131]
    v_add_u32 v238, s52, v242
    v_mfma_f32_16x16x32_bf16 v[132:135], v[180:183], v[148:151], v[132:135]
    s_waitcnt lgkmcnt(0)
    v_mfma_f32_16x16x32_bf16 v[8:11], v[200:203], v[184:187], v[8:11]
    s_barrier
    v_mfma_f32_16x16x32_bf16 v[12:15], v[204:207], v[184:187], v[12:15]
    ds_read_b128 v[136:139], v232 offset:0
    v_mfma_f32_16x16x32_bf16 v[16:19], v[208:211], v[184:187], v[16:19]
    ds_read_b64_tr_b16 v[152:153], v235 offset:0
    v_mfma_f32_16x16x32_bf16 v[20:23], v[212:215], v[184:187], v[20:23]
    ds_read_b64_tr_b16 v[154:155], v235 offset:4096
    v_mfma_f32_16x16x32_bf16 v[24:27], v[216:219], v[184:187], v[24:27]
    ds_read_b64_tr_b16 v[156:157], v236 offset:0
    v_mfma_f32_16x16x32_bf16 v[28:31], v[220:223], v[184:187], v[28:31]
    ds_read_b64_tr_b16 v[158:159], v236 offset:4096
    v_mfma_f32_16x16x32_bf16 v[32:35], v[224:227], v[184:187], v[32:35]
    v_mfma_f32_16x16x32_bf16 v[36:39], v[228:231], v[184:187], v[36:39]
    ds_read_b64_tr_b16 v[160:161], v237 offset:0
    v_mfma_f32_16x16x32_bf16 v[40:43], v[200:203], v[188:191], v[40:43]
    ds_read_b64_tr_b16 v[162:163], v237 offset:4096
    v_mfma_f32_16x16x32_bf16 v[44:47], v[204:207], v[188:191], v[44:47]
    ds_read_b64_tr_b16 v[164:165], v238 offset:0
    v_mfma_f32_16x16x32_bf16 v[48:51], v[208:211], v[188:191], v[48:51]
    ds_read_b64_tr_b16 v[166:167], v238 offset:4096
    v_mfma_f32_16x16x32_bf16 v[52:55], v[212:215], v[188:191], v[52:55]
    ds_read_b64_tr_b16 v[168:169], v235 offset:16384
    v_mfma_f32_16x16x32_bf16 v[56:59], v[216:219], v[188:191], v[56:59]
    v_mfma_f32_16x16x32_bf16 v[60:63], v[220:223], v[188:191], v[60:63]
    ds_read_b64_tr_b16 v[170:171], v235 offset:20480
    v_mfma_f32_16x16x32_bf16 v[64:67], v[224:227], v[188:191], v[64:67]
    ds_read_b64_tr_b16 v[172:173], v236 offset:16384
    v_mfma_f32_16x16x32_bf16 v[68:71], v[228:231], v[188:191], v[68:71]
    ds_read_b64_tr_b16 v[174:175], v236 offset:20480
    v_mfma_f32_16x16x32_bf16 v[72:75], v[200:203], v[192:195], v[72:75]
    ds_read_b64_tr_b16 v[176:177], v237 offset:16384
    v_mfma_f32_16x16x32_bf16 v[76:79], v[204:207], v[192:195], v[76:79]
    ds_read_b64_tr_b16 v[178:179], v237 offset:20480
    v_mfma_f32_16x16x32_bf16 v[80:83], v[208:211], v[192:195], v[80:83]
    v_mfma_f32_16x16x32_bf16 v[84:87], v[212:215], v[192:195], v[84:87]
    ds_read_b64_tr_b16 v[180:181], v238 offset:16384
    v_mfma_f32_16x16x32_bf16 v[88:91], v[216:219], v[192:195], v[88:91]
    ds_read_b64_tr_b16 v[182:183], v238 offset:20480
    v_mfma_f32_16x16x32_bf16 v[92:95], v[220:223], v[192:195], v[92:95]
    ds_read_b128 v[140:143], v232 offset:2048
    v_mfma_f32_16x16x32_bf16 v[96:99], v[224:227], v[192:195], v[96:99]
    ds_read_b128 v[144:147], v232 offset:4096
    v_mfma_f32_16x16x32_bf16 v[100:103], v[228:231], v[192:195], v[100:103]
    ds_read_b128 v[148:151], v232 offset:6144
    v_mfma_f32_16x16x32_bf16 v[104:107], v[200:203], v[196:199], v[104:107]
    v_mfma_f32_16x16x32_bf16 v[108:111], v[204:207], v[196:199], v[108:111]
    v_mfma_f32_16x16x32_bf16 v[112:115], v[208:211], v[196:199], v[112:115]
    v_mfma_f32_16x16x32_bf16 v[116:119], v[212:215], v[196:199], v[116:119]
    v_mfma_f32_16x16x32_bf16 v[120:123], v[216:219], v[196:199], v[120:123]
    v_mfma_f32_16x16x32_bf16 v[124:127], v[220:223], v[196:199], v[124:127]
    v_mfma_f32_16x16x32_bf16 v[128:131], v[224:227], v[196:199], v[128:131]
    s_add_u32 s52, s52, 49152
    s_cmp_ge_u32 s52, 147456
    s_cselect_b32 s52, 0, s52
    v_mfma_f32_16x16x32_bf16 v[132:135], v[228:231], v[196:199], v[132:135]
    s_waitcnt lgkmcnt(0)
    v_mfma_f32_16x16x32_bf16 v[8:11], v[152:155], v[136:139], v[8:11]
    ds_read_b128 v[184:187], v232 offset:1024
    v_mfma_f32_16x16x32_bf16 v[12:15], v[156:159], v[136:139], v[12:15]
    ds_read_b64_tr_b16 v[200:201], v235 offset:8192
    v_mfma_f32_16x16x32_bf16 v[16:19], v[160:163], v[136:139], v[16:19]
    ds_read_b64_tr_b16 v[202:203], v235 offset:12288
    v_mfma_f32_16x16x32_bf16 v[20:23], v[164:167], v[136:139], v[20:23]
    ds_read_b64_tr_b16 v[204:205], v236 offset:8192
    v_mfma_f32_16x16x32_bf16 v[24:27], v[168:171], v[136:139], v[24:27]
    v_mfma_f32_16x16x32_bf16 v[28:31], v[172:175], v[136:139], v[28:31]
    ds_read_b64_tr_b16 v[206:207], v236 offset:12288
    v_mfma_f32_16x16x32_bf16 v[32:35], v[176:179], v[136:139], v[32:35]
    ds_read_b64_tr_b16 v[208:209], v237 offset:8192
    v_mfma_f32_16x16x32_bf16 v[36:39], v[180:183], v[136:139], v[36:39]
    ds_read_b64_tr_b16 v[210:211], v237 offset:12288
    v_mfma_f32_16x16x32_bf16 v[40:43], v[152:155], v[140:143], v[40:43]
    ds_read_b64_tr_b16 v[212:213], v238 offset:8192
    v_mfma_f32_16x16x32_bf16 v[44:47], v[156:159], v[140:143], v[44:47]
    v_mfma_f32_16x16x32_bf16 v[48:51], v[160:163], v[140:143], v[48:51]
    ds_read_b64_tr_b16 v[214:215], v238 offset:12288
    v_mfma_f32_16x16x32_bf16 v[52:55], v[164:167], v[140:143], v[52:55]
    ds_read_b64_tr_b16 v[216:217], v235 offset:24576
    v_mfma_f32_16x16x32_bf16 v[56:59], v[168:171], v[140:143], v[56:59]
    ds_read_b64_tr_b16 v[218:219], v235 offset:28672
    v_mfma_f32_16x16x32_bf16 v[60:63], v[172:175], v[140:143], v[60:63]
    ds_read_b64_tr_b16 v[220:221], v236 offset:24576
    v_mfma_f32_16x16x32_bf16 v[64:67], v[176:179], v[140:143], v[64:67]
    v_mfma_f32_16x16x32_bf16 v[68:71], v[180:183], v[140:143], v[68:71]
    s_sub_u32 s54, s54, 1
    ds_read_b64_tr_b16 v[222:223], v236 offset:28672
    v_mfma_f32_16x16x32_bf16 v[72:75], v[152:155], v[144:147], v[72:75]
    s_cbranch_scc0 M_P_loop4
    ds_read_b64_tr_b16 v[224:225], v237 offset:24576
    v_mfma_f32_16x16x32_bf16 v[76:79], v[156:159], v[144:147], v[76:79]
    ds_read_b64_tr_b16 v[226:227], v237 offset:28672
    v_mfma_f32_16x16x32_bf16 v[80:83], v[160:163], v[144:147], v[80:83]
    ds_read_b64_tr_b16 v[228:229], v238 offset:24576
    v_mfma_f32_16x16x32_bf16 v[84:87], v[164:167], v[144:147], v[84:87]
    v_mfma_f32_16x16x32_bf16 v[88:91], v[168:171], v[144:147], v[88:91]
    ds_read_b64_tr_b16 v[230:231], v238 offset:28672
    v_mfma_f32_16x16x32_bf16 v[92:95], v[172:175], v[144:147], v[92:95]
    ds_read_b128 v[188:191], v232 offset:3072
    v_mfma_f32_16x16x32_bf16 v[96:99], v[176:179], v[144:147], v[96:99]
    ds_read_b128 v[192:195], v232 offset:5120
    v_mfma_f32_16x16x32_bf16 v[100:103], v[180:183], v[144:147], v[100:103]
    ds_read_b128 v[196:199], v232 offset:7168
    v_mfma_f32_16x16x32_bf16 v[104:107], v[152:155], v[148:151], v[104:107]
    v_mfma_f32_16x16x32_bf16 v[108:111], v[156:159], v[148:151], v[108:111]
    v_mfma_f32_16x16x32_bf16 v[112:115], v[160:163], v[148:151], v[112:115]
    v_mfma_f32_16x16x32_bf16 v[116:119], v[164:167], v[148:151], v[116:119]
    v_mfma_f32_16x16x32_bf16 v[120:123], v[168:171], v[148:151], v[120:123]
    v_mfma_f32_16x16x32_bf16 v[124:127], v[172:175], v[148:151], v[124:127]
    v_mfma_f32_16x16x32_bf16 v[128:131], v[176:179], v[148:151], v[128:131]
    v_mfma_f32_16x16x32_bf16 v[132:135], v[180:183], v[148:151], v[132:135]
    s_waitcnt lgkmcnt(0)
    v_mfma_f32_16x16x32_bf16 v[8:11], v[200:203], v[184:187], v[8:11]
    s_barrier
    v_mfma_f32_16x16x32_bf16 v[12:15], v[204:207], v[184:187], v[12:15]
    v_mfma_f32_16x16x32_bf16 v[16:19], v[208:211], v[184:187], v[16:19]
    v_mfma_f32_16x16x32_bf16 v[20:23], v[212:215], v[184:187], v[20:23]
    v_mfma_f32_16x16x32_bf16 v[24:27], v[216:219], v[184:187], v[24:27]
    v_mfma_f32_16x16x32_bf16 v[28:31], v[220:223], v[184:187], v[28:31]
    v_mfma_f32_16x16x32_bf16 v[32:35], v[224:227], v[184:187], v[32:35]
    v_mfma_f32_16x16x32_bf16 v[36:39], v[228:231], v[184:187], v[36:39]
    v_mfma_f32_16x16x32_bf16 v[40:43], v[200:203], v[188:191], v[40:43]
    v_mfma_f32_16x16x32_bf16 v[44:47], v[204:207], v[188:191], v[44:47]
    v_mfma_f32_16x16x32_bf16 v[48:51], v[208:211], v[188:191], v[48:51]
    v_mfma_f32_16x16x32_bf16 v[52:55], v[212:215], v[188:191], v[52:55]
    v_mfma_f32_16x16x32_bf16 v[56:59], v[216:219], v[188:191], v[56:59]
    v_mfma_f32_16x16x32_bf16 v[60:63], v[220:223], v[188:191], v[60:63]
    v_mfma_f32_16x16x32_bf16 v[64:67], v[224:227], v[188:191], v[64:67]
    v_mfma_f32_16x16x32_bf16 v[68:71], v[228:231], v[188:191], v[68:71]
    v_mfma_f32_16x16x32_bf16 v[72:75], v[200:203], v[192:195], v[72:75]
    v_mfma_f32_16x16x32_bf16 v[76:79], v[204:207], v[192:195], v[76:79]
    v_mfma_f32_16x16x32_bf16 v[80:83], v[208:211], v[192:195], v[80:83]
    v_mfma_f32_16x16x32_bf16 v[84:87], v[212:215], v[192:195], v[84:87]
    v_mfma_f32_16x16x32_bf16 v[88:91], v[216:219], v[192:195], v[88:91]
    v_mfma_f32_16x16x32_bf16 v[92:95], v[220:223], v[192:195], v[92:95]
    v_mfma_f32_16x16x32_bf16 v[96:99], v[224:227], v[192:195], v[96:99]
    v_mfma_f32_16x16x32_bf16 v[100:103], v[228:231], v[192:195], v[100:103]
    v_mfma_f32_16x16x32_bf16 v[104:107], v[200:203], v[196:199], v[104:107]
    v_mfma_f32_16x16x32_bf16 v[108:111], v[204:207], v[196:199], v[108:111]
    v_mfma_f32_16x16x32_bf16 v[112:115], v[208:211], v[196:199], v[112:115]
    v_mfma_f32_16x16x32_bf16 v[116:119], v[212:215], v[196:199], v[116:119]
    v_mfma_f32_16x16x32_bf16 v[120:123], v[216:219], v[196:199], v[120:123]
    v_mfma_f32_16x16x32_bf16 v[124:127], v[220:223], v[196:199], v[124:127]
    v_mfma_f32_16x16x32_bf16 v[128:131], v[224:227], v[196:199], v[128:131]
    v_mfma_f32_16x16x32_bf16 v[132:135], v[228:231], v[196:199], v[132:135]
    s_setprio 0
    s_cmp_lg_u32 s69, 0
    s_cbranch_scc1 M_Pidle
    s_lshl_b32 s64, s47, 3
    s_lshl_b32 s65, s44, 1
    s_add_u32 s64, s64, s65
    s_mul_i32 s64, s64, 32768
    s_add_u32 s64, s64, 0x1000000
    v_lshl_add_u32 v184, v1, 4, s64
    v_add_u32 v185, 30720, v184
    s_lshr_b32 s65, s48, 2
    s_sub_u32 s65, s48, s65
    s_add_u32 s65, s65, 16
    s_lshl_b32 s65, s65, 8
    s_or_b32 s65, s65, s69
    v_lshrrev_b32 v3, 4, v1
    s_lshl_b32 s64, s44, 4
    v_add_u32 v2, s64, v3
    s_movk_i32 s64, 7168
    v_mul_u32_u24 v2, s64, v2
    v_add_u32 v2, s65, v2
    v_lshlrev_b32 v3, 1, v3
    v_and_b32 v4, 15, v1
    v_xor_b32 v3, v3, v4
    v_lshl_add_u32 v188, v3, 4, v2
    v_add_u32 v190, 55296, v188
    v_xor_b32 v3, 8, v3
    v_lshl_add_u32 v189, v3, 4, v2
    v_add_u32 v189, 27648, v189
    v_add_u32 v191, 55296, v189
    s_lshl_b32 s60, s44, 12
    s_add_u32 s61, s60, 147456
    s_add_u32 s53, s60, 49152
    s_bfe_u32 s66, s2, 0x30003
    s_lshr_b32 s55, s2, 6
    s_add_u32 s66, s66, s55
    s_mul_i32 s55, s66, 11
    s_lshr_b32 s55, s55, 5
    s_mul_i32 s55, s55, 3
    s_sub_u32 s66, s66, s55
    s_mov_b32 s58, 0x9a867534
    s_mov_b32 s59, 0xfecdb
    s_cmp_eq_u32 s66, 1
    s_cselect_b32 s58, 0xb9786453, s58
    s_cselect_b32 s59, 0xfdeca, s59
    s_cmp_eq_u32 s66, 2
    s_cselect_b32 s58, 0xa8975642, s58
    s_cselect_b32 s59, 0xefdbc, s59
    s_mov_b32 s32, s12
    s_mov_b32 s33, s13
    s_mov_b32 s34, 0x700000
    s_mov_b32 s35, 0x20000
    s_mov_b32 s36, s14
    s_mov_b32 s37, s15
    s_mov_b32 s38, 0x700000
    s_mov_b32 s39, 0x20000
    s_lshl_b32 s70, s48, 12
    s_lshl_b32 s64, s47, 3
    s_lshl_b32 s65, s45, 2
    s_add_u32 s64, s64, s65
    s_mul_i32 s64, s64, 114688
    s_add_u32 s64, s64, s70
    s_lshl_b32 s65, s46, 11
    s_add_u32 s64, s64, s65
    s_add_u32 s64, s64, 0x1500000
    v_lshl_add_u32 v198, v1, 4, s64
    v_mul_f32 v24, v8, v24
    v_exp_f32 v216, -v8
    v_mul_f32 v25, v9, v25
    v_exp_f32 v217, -v9
    v_mul_f32 v26, v10, v26
    v_exp_f32 v218, -v10
    v_mul_f32 v27, v11, v27
    v_exp_f32 v219, -v11
    v_mul_f32 v28, v12, v28
    v_exp_f32 v220, -v12
    v_mul_f32 v29, v13, v29
    v_exp_f32 v221, -v13
    v_mul_f32 v30, v14, v30
    v_exp_f32 v222, -v14
    v_mul_f32 v31, v15, v31
    v_exp_f32 v223, -v15
    s_barrier
    s_and_b32 s57, s58, 15
    s_lshr_b64 s[58:59], s[58:59], 4
    s_lshl_b32 s56, s57, 11
    s_mul_i32 s57, s57, 0x70000
    s_add_u32 m0, s53, 16384
    s_nop 0
    buffer_load_dwordx4 v188, s[32:35], s57 offen offset:0 lds
    v_fma_f32 v216, v216, s67, s67
    v_fma_f32 v217, v217, s67, s67
    v_rcp_f32 v216, v216
    v_fma_f32 v218, v218, s67, s67
    buffer_load_dwordx4 v189, s[32:35], s57 offen offset:1024 lds
    v_rcp_f32 v217, v217
    v_fma_f32 v219, v219, s67, s67
    v_rcp_f32 v218, v218
    v_fma_f32 v220, v220, s67, s67
    buffer_load_dwordx4 v190, s[32:35], s57 offen offset:2048 lds
    v_rcp_f32 v219, v219
    v_fma_f32 v221, v221, s67, s67
    v_rcp_f32 v220, v220
    v_fma_f32 v222, v222, s67, s67
    buffer_load_dwordx4 v191, s[32:35], s57 offen offset:3072 lds
    v_rcp_f32 v221, v221
    v_fma_f32 v223, v223, s67, s67
    v_rcp_f32 v222, v222
    v_rcp_f32 v223, v223
    s_add_u32 m0, s53, 32768
    s_nop 0
    buffer_load_dwordx4 v188, s[36:39], s57 offen offset:0 lds
    v_mul_f32 v24, v24, v216
    v_mul_f32 v25, v25, v217
    v_mul_f32 v26, v26, v218
    v_mul_f32 v27, v27, v219
    buffer_load_dwordx4 v189, s[36:39], s57 offen offset:1024 lds
    v_mul_f32 v28, v28, v220
    v_mul_f32 v29, v29, v221
    v_mul_f32 v30, v30, v222
    v_mul_f32 v31, v31, v223
    buffer_load_dwordx4 v190, s[36:39], s57 offen offset:2048 lds
    v_cvt_pk_bf16_f32 v200, v24, v25
    v_cvt_pk_bf16_f32 v201, v26, v27
    v_cvt_pk_bf16_f32 v202, v28, v29
    v_cvt_pk_bf16_f32 v203, v30, v31
    buffer_load_dwordx4 v191, s[36:39], s57 offen offset:3072 lds
    v_mul_f32 v32, v16, v32
    v_exp_f32 v224, -v16
    v_mul_f32 v33, v17, v33
    s_mov_b32 m0, s53
    s_nop 0
    buffer_load_dwordx4 v184, s[28:31], s56 offen offset:0 sc1 lds
    v_exp_f32 v225, -v17
    v_mul_f32 v34, v18, v34
    v_exp_f32 v226, -v18
    v_mul_f32 v35, v19, v35
    buffer_load_dwordx4 v184, s[28:31], s56 offen offset:1024 sc1 lds
    v_exp_f32 v227, -v19
    v_mul_f32 v36, v20, v36
    v_exp_f32 v228, -v20
    v_mul_f32 v37, v21, v37
    buffer_load_dwordx4 v185, s[28:31], s56 offen offset:2048 sc1 lds
    v_exp_f32 v229, -v21
    v_mul_f32 v38, v22, v38
    v_exp_f32 v230, -v22
    v_mul_f32 v39, v23, v39
    buffer_load_dwordx4 v185, s[28:31], s56 offen offset:3072 sc1 lds
    v_exp_f32 v231, -v23
    v_fma_f32 v224, v224, s67, s67
    v_fma_f32 v225, v225, s67, s67
    v_rcp_f32 v224, v224
    s_add_u32 s53, s53, 49152
    s_cmp_ge_u32 s53, s61
    s_cselect_b32 s53, s60, s53
    buffer_store_dwordx4 v[200:203], v198, s[28:31], 0 offen offset:0 sc1
    s_barrier
    s_and_b32 s57, s58, 15
    s_lshr_b64 s[58:59], s[58:59], 4
    s_lshl_b32 s56, s57, 11
    s_mul_i32 s57, s57, 0x70000
    s_add_u32 m0, s53, 16384
    s_nop 0
    buffer_load_dwordx4 v188, s[32:35], s57 offen offset:0 lds
    v_fma_f32 v226, v226, s67, s67
    v_rcp_f32 v225, v225
    v_fma_f32 v227, v227, s67, s67
    v_rcp_f32 v226, v226
    buffer_load_dwordx4 v189, s[32:35], s57 offen offset:1024 lds
    v_fma_f32 v228, v228, s67, s67
    v_rcp_f32 v227, v227
    v_fma_f32 v229, v229, s67, s67
    v_rcp_f32 v228, v228
    buffer_load_dwordx4 v190, s[32:35], s57 offen offset:2048 lds
    v_fma_f32 v230, v230, s67, s67
    v_rcp_f32 v229, v229
    v_fma_f32 v231, v231, s67, s67
    v_rcp_f32 v230, v230
    buffer_load_dwordx4 v191, s[32:35], s57 offen offset:3072 lds
    v_rcp_f32 v231, v231
    v_mul_f32 v32, v32, v224
    v_mul_f32 v33, v33, v225
    v_mul_f32 v34, v34, v226
    s_add_u32 m0, s53, 32768
    s_nop 0
    buffer_load_dwordx4 v188, s[36:39], s57 offen offset:0 lds
    v_mul_f32 v35, v35, v227
    v_mul_f32 v36, v36, v228
    v_mul_f32 v37, v37, v229
    v_mul_f32 v38, v38, v230
    buffer_load_dwordx4 v189, s[36:39], s57 offen offset:1024 lds
    v_mul_f32 v39, v39, v231
    v_cvt_pk_bf16_f32 v204, v32, v33
    v_cvt_pk_bf16_f32 v205, v34, v35
    v_cvt_pk_bf16_f32 v206, v36, v37
    buffer_load_dwordx4 v190, s[36:39], s57 offen offset:2048 lds
    v_cvt_pk_bf16_f32 v207, v38, v39
    v_mul_f32 v56, v40, v56
    buffer_load_dwordx4 v191, s[36:39], s57 offen offset:3072 lds
    v_exp_f32 v216, -v40
    v_mul_f32 v57, v41, v57
    v_exp_f32 v217, -v41
    v_mul_f32 v58, v42, v58
    s_mov_b32 m0, s53
    s_nop 0
    buffer_load_dwordx4 v184, s[28:31], s56 offen offset:0 sc1 lds
    v_exp_f32 v218, -v42
    v_mul_f32 v59, v43, v59
    v_exp_f32 v219, -v43
    v_mul_f32 v60, v44, v60
    buffer_load_dwordx4 v184, s[28:31], s56 offen offset:1024 sc1 lds
    v_exp_f32 v220, -v44
    v_mul_f32 v61, v45, v61
    v_exp_f32 v221, -v45
    v_mul_f32 v62, v46, v62
    buffer_load_dwordx4 v185, s[28:31], s56 offen offset:2048 sc1 lds
    v_exp_f32 v222, -v46
    v_mul_f32 v63, v47, v63
    v_exp_f32 v223, -v47
    v_fma_f32 v216, v216, s67, s67
    buffer_load_dwordx4 v185, s[28:31], s56 offen offset:3072 sc1 lds
    v_fma_f32 v217, v217, s67, s67
    v_rcp_f32 v216, v216
    v_fma_f32 v218, v218, s67, s67
    v_rcp_f32 v217, v217
    s_add_u32 s53, s53, 49152
    s_cmp_ge_u32 s53, s61
    s_cselect_b32 s53, s60, s53
    buffer_store_dwordx4 v[204:207], v198, s[28:31], 0 offen offset:1024 sc1
    v_add_u32 v198, 114688, v198
    s_waitcnt vmcnt(14)
    s_barrier
    s_and_b32 s57, s58, 15
    s_lshr_b64 s[58:59], s[58:59], 4
    s_lshl_b32 s56, s57, 11
    s_mul_i32 s57, s57, 0x70000
    s_add_u32 m0, s53, 16384
    s_nop 0
    buffer_load_dwordx4 v188, s[32:35], s57 offen offset:0 lds
    v_fma_f32 v219, v219, s67, s67
    v_rcp_f32 v218, v218
    v_fma_f32 v220, v220, s67, s67
    v_rcp_f32 v219, v219
    buffer_load_dwordx4 v189, s[32:35], s57 offen offset:1024 lds
    v_fma_f32 v221, v221, s67, s67
    v_rcp_f32 v220, v220
    v_fma_f32 v222, v222, s67, s67
    v_rcp_f32 v221, v221
    buffer_load_dwordx4 v190, s[32:35], s57 offen offset:2048 lds
    v_fma_f32 v223, v223, s67, s67
    v_rcp_f32 v222, v222
    v_rcp_f32 v223, v223
    v_mul_f32 v56, v56, v216
    buffer_load_dwordx4 v191, s[32:35], s57 offen offset:3072 lds
    v_mul_f32 v57, v57, v217
    v_mul_f32 v58, v58, v218
    v_mul_f32 v59, v59, v219
    v_mul_f32 v60, v60, v220
    s_add_u32 m0, s53, 32768
    s_nop 0
    buffer_load_dwordx4 v188, s[36:39], s57 offen offset:0 lds
    v_mul_f32 v61, v61, v221
    v_mul_f32 v62, v62, v222
    v_mul_f32 v63, v63, v223
    v_cvt_pk_bf16_f32 v208, v56, v57
    buffer_load_dwordx4 v189, s[36:39], s57 offen offset:1024 lds
    v_cvt_pk_bf16_f32 v209, v58, v59
    v_cvt_pk_bf16_f32 v210, v60, v61
    v_cvt_pk_bf16_f32 v211, v62, v63
    buffer_load_dwordx4 v190, s[36:39], s57 offen offset:2048 lds
    v_mul_f32 v64, v48, v64
    v_exp_f32 v224, -v48
    v_mul_f32 v65, v49, v65
    v_exp_f32 v225, -v49
    buffer_load_dwordx4 v191, s[36:39], s57 offen offset:3072 lds
    v_mul_f32 v66, v50, v66
    v_exp_f32 v226, -v50
    v_mul_f32 v67, v51, v67
    v_exp_f32 v227, -v51
    s_mov_b32 m0, s53
    s_nop 0
    buffer_load_dwordx4 v184, s[28:31], s56 offen offset:0 sc1 lds
    v_mul_f32 v68, v52, v68
    v_exp_f32 v228, -v52
    v_mul_f32 v69, v53, v69
    v_exp_f32 v229, -v53
    buffer_load_dwordx4 v184, s[28:31], s56 offen offset:1024 sc1 lds
    v_mul_f32 v70, v54, v70
    v_exp_f32 v230, -v54
    v_mul_f32 v71, v55, v71
    v_exp_f32 v231, -v55
    buffer_load_dwordx4 v185, s[28:31], s56 offen offset:2048 sc1 lds
    v_fma_f32 v224, v224, s67, s67
    v_fma_f32 v225, v225, s67, s67
    v_rcp_f32 v224, v224
    v_fma_f32 v226, v226, s67, s67
    buffer_load_dwordx4 v185, s[28:31], s56 offen offset:3072 sc1 lds
    v_rcp_f32 v225, v225
    v_fma_f32 v227, v227, s67, s67
    v_rcp_f32 v226, v226
    v_fma_f32 v228, v228, s67, s67
    s_add_u32 s53, s53, 49152
    s_cmp_ge_u32 s53, s61
    s_cselect_b32 s53, s60, s53
    buffer_store_dwordx4 v[208:211], v198, s[28:31], 0 offen offset:0 sc1
    s_waitcnt vmcnt(14)
    s_barrier
    s_and_b32 s57, s58, 15
    s_lshr_b64 s[58:59], s[58:59], 4
    s_lshl_b32 s56, s57, 11
    s_mul_i32 s57, s57, 0x70000
    s_add_u32 m0, s53, 16384
    s_nop 0
    buffer_load_dwordx4 v188, s[32:35], s57 offen offset:0 lds
    v_rcp_f32 v227, v227
    v_fma_f32 v229, v229, s67, s67
    v_rcp_f32 v228, v228
    v_fma_f32 v230, v230, s67, s67
    buffer_load_dwordx4 v189, s[32:35], s57 offen offset:1024 lds
    v_rcp_f32 v229, v229
    v_fma_f32 v231, v231, s67, s67
    v_rcp_f32 v230, v230
    v_rcp_f32 v231, v231
    buffer_load_dwordx4 v190, s[32:35], s57 offen offset:2048 lds
    v_mul_f32 v64, v64, v224
    v_mul_f32 v65, v65, v225
    v_mul_f32 v66, v66, v226
    v_mul_f32 v67, v67, v227
    buffer_load_dwordx4 v191, s[32:35], s57 offen offset:3072 lds
    v_mul_f32 v68, v68, v228
    v_mul_f32 v69, v69, v229
    v_mul_f32 v70, v70, v230
    v_mul_f32 v71, v71, v231
    s_add_u32 m0, s53, 32768
    s_nop 0
    buffer_load_dwordx4 v188, s[36:39], s57 offen offset:0 lds
    v_cvt_pk_bf16_f32 v212, v64, v65
    v_cvt_pk_bf16_f32 v213, v66, v67
    v_cvt_pk_bf16_f32 v214, v68, v69
    v_cvt_pk_bf16_f32 v215, v70, v71
    buffer_load_dwordx4 v189, s[36:39], s57 offen offset:1024 lds
    v_mul_f32 v88, v72, v88
    v_exp_f32 v216, -v72
    buffer_load_dwordx4 v190, s[36:39], s57 offen offset:2048 lds
    v_mul_f32 v89, v73, v89
    v_exp_f32 v217, -v73
    v_mul_f32 v90, v74, v90
    v_exp_f32 v218, -v74
    buffer_load_dwordx4 v191, s[36:39], s57 offen offset:3072 lds
    v_mul_f32 v91, v75, v91
    v_exp_f32 v219, -v75
    v_mul_f32 v92, v76, v92
    v_exp_f32 v220, -v76
    s_mov_b32 m0, s53
    s_nop 0
    buffer_load_dwordx4 v184, s[28:31], s56 offen offset:0 sc1 lds
    v_mul_f32 v93, v77, v93
    v_exp_f32 v221, -v77
    v_mul_f32 v94, v78, v94
    v_exp_f32 v222, -v78
    buffer_load_dwordx4 v184, s[28:31], s56 offen offset:1024 sc1 lds
    v_mul_f32 v95, v79, v95
    v_exp_f32 v223, -v79
    v_fma_f32 v216, v216, s67, s67
    v_fma_f32 v217, v217, s67, s67
    buffer_load_dwordx4 v185, s[28:31], s56 offen offset:2048 sc1 lds
    v_rcp_f32 v216, v216
    v_fma_f32 v218, v218, s67, s67
    v_rcp_f32 v217, v217
    v_fma_f32 v219, v219, s67, s67
    buffer_load_dwordx4 v185, s[28:31], s56 offen offset:3072 sc1 lds
    v_rcp_f32 v218, v218
    v_fma_f32 v220, v220, s67, s67
    v_rcp_f32 v219, v219
    v_fma_f32 v221, v221, s67, s67
    s_add_u32 s53, s53, 49152
    s_cmp_ge_u32 s53, s61
    s_cselect_b32 s53, s60, s53
    buffer_store_dwordx4 v[212:215], v198, s[28:31], 0 offen offset:1024 sc1
    v_add_u32 v198, 114688, v198
    s_waitcnt vmcnt(14)
    s_barrier
    s_and_b32 s57, s58, 15
    s_lshr_b64 s[58:59], s[58:59], 4
    s_lshl_b32 s56, s57, 11
    s_mul_i32 s57, s57, 0x70000
    s_add_u32 m0, s53, 16384
    s_nop 0
    buffer_load_dwordx4 v188, s[32:35], s57 offen offset:0 lds
    v_rcp_f32 v220, v220
    v_fma_f32 v222, v222, s67, s67
    v_rcp_f32 v221, v221
    v_fma_f32 v223, v223, s67, s67
    buffer_load_dwordx4 v189, s[32:35], s57 offen offset:1024 lds
    v_rcp_f32 v222, v222
    v_rcp_f32 v223, v223
    v_mul_f32 v88, v88, v216
    v_mul_f32 v89, v89, v217
    buffer_load_dwordx4 v190, s[32:35], s57 offen offset:2048 lds
    v_mul_f32 v90, v90, v218
    v_mul_f32 v91, v91, v219
    v_mul_f32 v92, v92, v220
    v_mul_f32 v93, v93, v221
    buffer_load_dwordx4 v191, s[32:35], s57 offen offset:3072 lds
    v_mul_f32 v94, v94, v222
    v_mul_f32 v95, v95, v223
    v_cvt_pk_bf16_f32 v200, v88, v89
    v_cvt_pk_bf16_f32 v201, v90, v91
    s_add_u32 m0, s53, 32768
    s_nop 0
    buffer_load_dwordx4 v188, s[36:39], s57 offen offset:0 lds
    v_cvt_pk_bf16_f32 v202, v92, v93
    v_cvt_pk_bf16_f32 v203, v94, v95
    v_mul_f32 v96, v80, v96
    buffer_load_dwordx4 v189, s[36:39], s57 offen offset:1024 lds
    v_exp_f32 v224, -v80
    v_mul_f32 v97, v81, v97
    v_exp_f32 v225, -v81
    v_mul_f32 v98, v82, v98
    buffer_load_dwordx4 v190, s[36:39], s57 offen offset:2048 lds
    v_exp_f32 v226, -v82
    v_mul_f32 v99, v83, v99
    v_exp_f32 v227, -v83
    v_mul_f32 v100, v84, v100
    buffer_load_dwordx4 v191, s[36:39], s57 offen offset:3072 lds
    v_exp_f32 v228, -v84
    v_mul_f32 v101, v85, v101
    v_exp_f32 v229, -v85
    v_mul_f32 v102, v86, v102
    s_mov_b32 m0, s53
    s_nop 0
    buffer_load_dwordx4 v184, s[28:31], s56 offen offset:0 sc1 lds
    v_exp_f32 v230, -v86
    v_mul_f32 v103, v87, v103
    v_exp_f32 v231, -v87
    v_fma_f32 v224, v224, s67, s67
    buffer_load_dwordx4 v184, s[28:31], s56 offen offset:1024 sc1 lds
    v_fma_f32 v225, v225, s67, s67
    v_rcp_f32 v224, v224
    v_fma_f32 v226, v226, s67, s67
    v_rcp_f32 v225, v225
    buffer_load_dwordx4 v185, s[28:31], s56 offen offset:2048 sc1 lds
    v_fma_f32 v227, v227, s67, s67
    v_rcp_f32 v226, v226
    v_fma_f32 v228, v228, s67, s67
    v_rcp_f32 v227, v227
    buffer_load_dwordx4 v185, s[28:31], s56 offen offset:3072 sc1 lds
    v_fma_f32 v229, v229, s67, s67
    v_rcp_f32 v228, v228
    v_fma_f32 v230, v230, s67, s67
    v_rcp_f32 v229, v229
    s_add_u32 s53, s53, 49152
    s_cmp_ge_u32 s53, s61
    s_cselect_b32 s53, s60, s53
    buffer_store_dwordx4 v[200:203], v198, s[28:31], 0 offen offset:0 sc1
    s_waitcnt vmcnt(14)
    s_barrier
    s_and_b32 s57, s58, 15
    s_lshr_b64 s[58:59], s[58:59], 4
    s_lshl_b32 s56, s57, 11
    s_mul_i32 s57, s57, 0x70000
    s_add_u32 m0, s53, 16384
    s_nop 0
    buffer_load_dwordx4 v188, s[32:35], s57 offen offset:0 lds
    v_fma_f32 v231, v231, s67, s67
    v_rcp_f32 v230, v230
    v_rcp_f32 v231, v231
    v_mul_f32 v96, v96, v224
    buffer_load_dwordx4 v189, s[32:35], s57 offen offset:1024 lds
    v_mul_f32 v97, v97, v225
    v_mul_f32 v98, v98, v226
    v_mul_f32 v99, v99, v227
    v_mul_f32 v100, v100, v228
    buffer_load_dwordx4 v190, s[32:35], s57 offen offset:2048 lds
    v_mul_f32 v101, v101, v229
    v_mul_f32 v102, v102, v230
    v_mul_f32 v103, v103, v231
    v_cvt_pk_bf16_f32 v204, v96, v97
    buffer_load_dwordx4 v191, s[32:35], s57 offen offset:3072 lds
    v_cvt_pk_bf16_f32 v205, v98, v99
    v_cvt_pk_bf16_f32 v206, v100, v101
    v_cvt_pk_bf16_f32 v207, v102, v103
    s_add_u32 m0, s53, 32768
    s_nop 0
    buffer_load_dwordx4 v188, s[36:39], s57 offen offset:0 lds
    v_mul_f32 v120, v104, v120
    v_exp_f32 v216, -v104
    v_mul_f32 v121, v105, v121
    buffer_load_dwordx4 v189, s[36:39], s57 offen offset:1024 lds
    v_exp_f32 v217, -v105
    v_mul_f32 v122, v106, v122
    v_exp_f32 v218, -v106
    v_mul_f32 v123, v107, v123
    buffer_load_dwordx4 v190, s[36:39], s57 offen offset:2048 lds
    v_exp_f32 v219, -v107
    v_mul_f32 v124, v108, v124
    v_exp_f32 v220, -v108
    v_mul_f32 v125, v109, v125
    buffer_load_dwordx4 v191, s[36:39], s57 offen offset:3072 lds
    v_exp_f32 v221, -v109
    v_mul_f32 v126, v110, v126
    v_exp_f32 v222, -v110
    v_mul_f32 v127, v111, v127
    s_mov_b32 m0, s53
    s_nop 0
    buffer_load_dwordx4 v184, s[28:31], s56 offen offset:0 sc1 lds
    v_exp_f32 v223, -v111
    v_fma_f32 v216, v216, s67, s67
    v_fma_f32 v217, v217, s67, s67
    v_rcp_f32 v216, v216
    buffer_load_dwordx4 v184, s[28:31], s56 offen offset:1024 sc1 lds
    v_fma_f32 v218, v218, s67, s67
    v_rcp_f32 v217, v217
    v_fma_f32 v219, v219, s67, s67
    v_rcp_f32 v218, v218
    buffer_load_dwordx4 v185, s[28:31], s56 offen offset:2048 sc1 lds
    v_fma_f32 v220, v220, s67, s67
    v_rcp_f32 v219, v219
    v_fma_f32 v221, v221, s67, s67
    v_rcp_f32 v220, v220
    buffer_load_dwordx4 v185, s[28:31], s56 offen offset:3072 sc1 lds
    v_fma_f32 v222, v222, s67, s67
    v_rcp_f32 v221, v221
    v_fma_f32 v223, v223, s67, s67
    v_rcp_f32 v222, v222
    s_add_u32 s53, s53, 49152
    s_cmp_ge_u32 s53, s61
    s_cselect_b32 s53, s60, s53
    buffer_store_dwordx4 v[204:207], v198, s[28:31], 0 offen offset:1024 sc1
    v_add_u32 v198, 114688, v198
    s_waitcnt vmcnt(14)
    s_barrier
    s_and_b32 s57, s58, 15
    s_lshr_b64 s[58:59], s[58:59], 4
    s_lshl_b32 s56, s57, 11
    s_mul_i32 s57, s57, 0x70000
    s_add_u32 m0, s53, 16384
    s_nop 0
    buffer_load_dwordx4 v188, s[32:35], s57 offen offset:0 lds
    v_rcp_f32 v223, v223
    v_mul_f32 v120, v120, v216
    v_mul_f32 v121, v121, v217
    v_mul_f32 v122, v122, v218
    buffer_load_dwordx4 v189, s[32:35], s57 offen offset:1024 lds
    v_mul_f32 v123, v123, v219
    v_mul_f32 v124, v124, v220
    v_mul_f32 v125, v125, v221
    v_mul_f32 v126, v126, v222
    buffer_load_dwordx4 v190, s[32:35], s57 offen offset:2048 lds
    v_mul_f32 v127, v127, v223
    v_cvt_pk_bf16_f32 v208, v120, v121
    v_cvt_pk_bf16_f32 v209, v122, v123
    v_cvt_pk_bf16_f32 v210, v124, v125
    buffer_load_dwordx4 v191, s[32:35], s57 offen offset:3072 lds
    v_cvt_pk_bf16_f32 v211, v126, v127
    v_mul_f32 v128, v112, v128
    v_exp_f32 v224, -v112
    s_add_u32 m0, s53, 32768
    s_nop 0
    buffer_load_dwordx4 v188, s[36:39], s57 offen offset:0 lds
    v_mul_f32 v129, v113, v129
    v_exp_f32 v225, -v113
    v_mul_f32 v130, v114, v130
    v_exp_f32 v226, -v114
    buffer_load_dwordx4 v189, s[36:39], s57 offen offset:1024 lds
    v_mul_f32 v131, v115, v131
    v_exp_f32 v227, -v115
    v_mul_f32 v132, v116, v132
    v_exp_f32 v228, -v116
    buffer_load_dwordx4 v190, s[36:39], s57 offen offset:2048 lds
    v_mul_f32 v133, v117, v133
    v_exp_f32 v229, -v117
    v_mul_f32 v134, v118, v134
    v_exp_f32 v230, -v118
    buffer_load_dwordx4 v191, s[36:39], s57 offen offset:3072 lds
    v_mul_f32 v135, v119, v135
    v_exp_f32 v231, -v119
    v_fma_f32 v224, v224, s67, s67
    v_fma_f32 v225, v225, s67, s67
    s_mov_b32 m0, s53
    s_nop 0
    buffer_load_dwordx4 v184, s[28:31], s56 offen offset:0 sc1 lds
    v_rcp_f32 v224, v224
    v_fma_f32 v226, v226, s67, s67
    v_rcp_f32 v225, v225
    v_fma_f32 v227, v227, s67, s67
    buffer_load_dwordx4 v184, s[28:31], s56 offen offset:1024 sc1 lds
    v_rcp_f32 v226, v226
    v_fma_f32 v228, v228, s67, s67
    v_rcp_f32 v227, v227
    v_fma_f32 v229, v229, s67, s67
    buffer_load_dwordx4 v185, s[28:31], s56 offen offset:2048 sc1 lds
    v_rcp_f32 v228, v228
    v_fma_f32 v230, v230, s67, s67
    v_rcp_f32 v229, v229
    v_fma_f32 v231, v231, s67, s67
    buffer_load_dwordx4 v185, s[28:31], s56 offen offset:3072 sc1 lds
    v_rcp_f32 v230, v230
    v_rcp_f32 v231, v231
    v_mul_f32 v128, v128, v224
    v_mul_f32 v129, v129, v225
    s_add_u32 s53, s53, 49152
    s_cmp_ge_u32 s53, s61
    s_cselect_b32 s53, s60, s53
    buffer_store_dwordx4 v[208:211], v198, s[28:31], 0 offen offset:0 sc1
    s_waitcnt vmcnt(14)
    s_barrier
    s_and_b32 s57, s58, 15
    s_lshr_b64 s[58:59], s[58:59], 4
    s_lshl_b32 s56, s57, 11
    s_mul_i32 s57, s57, 0x70000
    s_add_u32 m0, s53, 16384
    s_nop 0
    buffer_load_dwordx4 v188, s[32:35], s57 offen offset:0 lds
    v_mul_f32 v130, v130, v226
    v_mul_f32 v131, v131, v227
    v_mul_f32 v132, v132, v228
    v_mul_f32 v133, v133, v229
    buffer_load_dwordx4 v189, s[32:35], s57 offen offset:1024 lds
    v_mul_f32 v134, v134, v230
    v_mul_f32 v135, v135, v231
    v_cvt_pk_bf16_f32 v212, v128, v129
    v_cvt_pk_bf16_f32 v213, v130, v131
    buffer_load_dwordx4 v190, s[32:35], s57 offen offset:2048 lds
    v_cvt_pk_bf16_f32 v214, v132, v133
    v_cvt_pk_bf16_f32 v215, v134, v135
    buffer_load_dwordx4 v191, s[32:35], s57 offen offset:3072 lds
    s_add_u32 m0, s53, 32768
    s_nop 0
    buffer_load_dwordx4 v188, s[36:39], s57 offen offset:0 lds
    buffer_load_dwordx4 v189, s[36:39], s57 offen offset:1024 lds
    buffer_load_dwordx4 v190, s[36:39], s57 offen offset:2048 lds
    buffer_load_dwordx4 v191, s[36:39], s57 offen offset:3072 lds
    s_mov_b32 m0, s53
    s_nop 0
    buffer_load_dwordx4 v184, s[28:31], s56 offen offset:0 sc1 lds
    buffer_load_dwordx4 v184, s[28:31], s56 offen offset:1024 sc1 lds
    buffer_load_dwordx4 v185, s[28:31], s56 offen offset:2048 sc1 lds
    buffer_load_dwordx4 v185, s[28:31], s56 offen offset:3072 sc1 lds
    s_add_u32 s53, s53, 49152
    s_cmp_ge_u32 s53, s61
    s_cselect_b32 s53, s60, s53
    buffer_store_dwordx4 v[212:215], v198, s[28:31], 0 offen offset:1024 sc1
    s_waitcnt vmcnt(14)
    s_barrier
    s_and_b32 s57, s58, 15
    s_lshr_b64 s[58:59], s[58:59], 4
    s_lshl_b32 s56, s57, 11
    s_mul_i32 s57, s57, 0x70000
    s_add_u32 m0, s53, 16384
    s_nop 0
    buffer_load_dwordx4 v188, s[32:35], s57 offen offset:0 lds
    buffer_load_dwordx4 v189, s[32:35], s57 offen offset:1024 lds
    buffer_load_dwordx4 v190, s[32:35], s57 offen offset:2048 lds
    buffer_load_dwordx4 v191, s[32:35], s57 offen offset:3072 lds
    s_add_u32 m0, s53, 32768
    s_nop 0
    buffer_load_dwordx4 v188, s[36:39], s57 offen offset:0 lds
    buffer_load_dwordx4 v189, s[36:39], s57 offen offset:1024 lds
    buffer_load_dwordx4 v190, s[36:39], s57 offen offset:2048 lds
    buffer_load_dwordx4 v191, s[36:39], s57 offen offset:3072 lds
    s_mov_b32 m0, s53
    s_nop 0
    buffer_load_dwordx4 v184, s[28:31], s56 offen offset:0 sc1 lds
    buffer_load_dwordx4 v184, s[28:31], s56 offen offset:1024 sc1 lds
    buffer_load_dwordx4 v185, s[28:31], s56 offen offset:2048 sc1 lds
    buffer_load_dwordx4 v185, s[28:31], s56 offen offset:3072 sc1 lds
    s_add_u32 s53, s53, 49152
    s_cmp_ge_u32 s53, s61
    s_cselect_b32 s53, s60, s53
    s_lshl_b32 s64, s47, 9
    s_lshl_b32 s65, s49, 7
    s_add_u32 s64, s64, s65
    s_lshl_b32 s65, s51, 4
    s_add_u32 s64, s64, s65
    s_lshl_b32 s65, s44, 2
    s_add_u32 s64, s64, s65
    s_add_u32 s64, s64, 0x50000
    v_mov_b32 v2, s0
    s_waitcnt vmcnt(12)
    s_mov_b64 exec, 1
    buffer_store_dword v2, v234, s[28:31], s64 offen sc1
    s_mov_b64 exec, -1
    s_lshl_b32 s65, s44, 1
    s_xor_b32 s65, s65, s49
    s_lshl_b32 s64, s47, 3
    s_add_u32 s64, s64, s65
    s_mul_i32 s64, s64, 114688
    s_add_u32 s64, s64, 0x1500000
    v_lshl_add_u32 v192, v1, 4, s64
    s_lshl_b32 s65, s44, 1
    s_or_b32 s65, s65, 1
    s_xor_b32 s65, s65, s49
    s_lshl_b32 s64, s47, 3
    s_add_u32 s64, s64, s65
    s_mul_i32 s64, s64, 114688
    s_add_u32 s64, s64, 0x14ff800
    v_lshl_add_u32 v193, v1, 4, s64
    s_lshl_b32 s65, s51, 9
    v_lshrrev_b32 v3, 4, v1
    s_lshl_b32 s64, s44, 4
    v_add_u32 v2, s64, v3
    s_movk_i32 s64, 2048
    v_mul_u32_u24 v2, s64, v2
    v_add_u32 v2, s65, v2
    v_lshlrev_b32 v3, 1, v3
    v_and_b32 v4, 15, v1
    v_xor_b32 v3, v3, v4
    v_lshl_add_u32 v194, v3, 4, v2
    v_add_u32 v196, 14336, v194
    v_xor_b32 v3, 8, v3
    v_lshl_add_u32 v195, v3, 4, v2
    v_add_u32 v195, 7168, v195
    v_add_u32 v197, 14336, v195
    s_barrier
    s_and_b32 s57, s58, 15
    s_lshr_b64 s[58:59], s[58:59], 4
    s_lshl_b32 s56, s57, 11
    s_mul_i32 s57, s57, 0x70000
    s_add_u32 m0, s53, 16384
    s_nop 0
    buffer_load_dwordx4 v188, s[32:35], s57 offen offset:0 lds
    buffer_load_dwordx4 v189, s[32:35], s57 offen offset:1024 lds
    buffer_load_dwordx4 v190, s[32:35], s57 offen offset:2048 lds
    buffer_load_dwordx4 v191, s[32:35], s57 offen offset:3072 lds
    s_add_u32 m0, s53, 32768
    s_nop 0
    buffer_load_dwordx4 v188, s[36:39], s57 offen offset:0 lds
    buffer_load_dwordx4 v189, s[36:39], s57 offen offset:1024 lds
    buffer_load_dwordx4 v190, s[36:39], s57 offen offset:2048 lds
    buffer_load_dwordx4 v191, s[36:39], s57 offen offset:3072 lds
    s_mov_b32 m0, s53
    s_nop 0
    buffer_load_dwordx4 v184, s[28:31], s56 offen offset:0 sc1 lds
    buffer_load_dwordx4 v184, s[28:31], s56 offen offset:1024 sc1 lds
    buffer_load_dwordx4 v185, s[28:31], s56 offen offset:2048 sc1 lds
    buffer_load_dwordx4 v185, s[28:31], s56 offen offset:3072 sc1 lds
    s_add_u32 s53, s53, 49152
    s_cmp_ge_u32 s53, s61
    s_cselect_b32 s53, s60, s53
    s_waitcnt vmcnt(13)
    s_barrier
    s_and_b32 s57, s58, 15
    s_lshr_b64 s[58:59], s[58:59], 4
    s_lshl_b32 s56, s57, 11
    s_mul_i32 s57, s57, 0x70000
    s_add_u32 m0, s53, 16384
    s_nop 0
    buffer_load_dwordx4 v188, s[32:35], s57 offen offset:0 lds
    buffer_load_dwordx4 v189, s[32:35], s57 offen offset:1024 lds
    buffer_load_dwordx4 v190, s[32:35], s57 offen offset:2048 lds
    buffer_load_dwordx4 v191, s[32:35], s57 offen offset:3072 lds
    s_add_u32 m0, s53, 32768
    s_nop 0
    buffer_load_dwordx4 v188, s[36:39], s57 offen offset:0 lds
    buffer_load_dwordx4 v189, s[36:39], s57 offen offset:1024 lds
    buffer_load_dwordx4 v190, s[36:39], s57 offen offset:2048 lds
    buffer_load_dwordx4 v191, s[36:39], s57 offen offset:3072 lds
    s_mov_b32 m0, s53
    s_nop 0
    buffer_load_dwordx4 v184, s[28:31], s56 offen offset:0 sc1 lds
    buffer_load_dwordx4 v184, s[28:31], s56 offen offset:1024 sc1 lds
    buffer_load_dwordx4 v185, s[28:31], s56 offen offset:2048 sc1 lds
    buffer_load_dwordx4 v185, s[28:31], s56 offen offset:3072 sc1 lds
    s_add_u32 s53, s53, 49152
    s_cmp_ge_u32 s53, s61
    s_cselect_b32 s53, s60, s53
    s_waitcnt vmcnt(12)
    s_barrier
    s_and_b32 s57, s58, 15
    s_lshr_b64 s[58:59], s[58:59], 4
    s_lshl_b32 s56, s57, 11
    s_mul_i32 s57, s57, 0x70000
    s_add_u32 m0, s53, 16384
    s_nop 0
    buffer_load_dwordx4 v188, s[32:35], s57 offen offset:0 lds
    buffer_load_dwordx4 v189, s[32:35], s57 offen offset:1024 lds
    buffer_load_dwordx4 v190, s[32:35], s57 offen offset:2048 lds
    buffer_load_dwordx4 v191, s[32:35], s57 offen offset:3072 lds
    s_add_u32 m0, s53, 32768
    s_nop 0
    buffer_load_dwordx4 v188, s[36:39], s57 offen offset:0 lds
    buffer_load_dwordx4 v189, s[36:39], s57 offen offset:1024 lds
    buffer_load_dwordx4 v190, s[36:39], s57 offen offset:2048 lds
    buffer_load_dwordx4 v191, s[36:39], s57 offen offset:3072 lds
    s_mov_b32 m0, s53
    s_nop 0
    buffer_load_dwordx4 v184, s[28:31], s56 offen offset:0 sc1 lds
    buffer_load_dwordx4 v184, s[28:31], s56 offen offset:1024 sc1 lds
    buffer_load_dwordx4 v185, s[28:31], s56 offen offset:2048 sc1 lds
    buffer_load_dwordx4 v185, s[28:31], s56 offen offset:3072 sc1 lds
    s_add_u32 s53, s53, 49152
    s_cmp_ge_u32 s53, s61
    s_cselect_b32 s53, s60, s53
    s_waitcnt vmcnt(12)
    s_barrier
    s_lshl_b32 s68, s47, 2
    s_add_u32 s68, s68, s49
    s_lshl_b32 s68, s68, 7
    s_add_u32 s68, s68, 0x50000
    v_min_u32 v234, 60, v234
    buffer_load_dword v245, v234, s[28:31], s68 offen sc1
    s_and_b32 s57, s58, 15
    s_lshr_b64 s[58:59], s[58:59], 4
    s_lshl_b32 s56, s57, 11
    s_mul_i32 s57, s57, 0x70000
    s_add_u32 m0, s53, 16384
    s_nop 0
    buffer_load_dwordx4 v188, s[32:35], s57 offen offset:0 lds
    buffer_load_dwordx4 v189, s[32:35], s57 offen offset:1024 lds
    buffer_load_dwordx4 v190, s[32:35], s57 offen offset:2048 lds
    buffer_load_dwordx4 v191, s[32:35], s57 offen offset:3072 lds
    s_add_u32 m0, s53, 32768
    s_nop 0
    buffer_load_dwordx4 v188, s[36:39], s57 offen offset:0 lds
    buffer_load_dwordx4 v189, s[36:39], s57 offen offset:1024 lds
    buffer_load_dwordx4 v190, s[36:39], s57 offen offset:2048 lds
    buffer_load_dwordx4 v191, s[36:39], s57 offen offset:3072 lds
    s_mov_b32 m0, s53
    s_nop 0
    buffer_load_dwordx4 v184, s[28:31], s56 offen offset:0 sc1 lds
    buffer_load_dwordx4 v184, s[28:31], s56 offen offset:1024 sc1 lds
    buffer_load_dwordx4 v185, s[28:31], s56 offen offset:2048 sc1 lds
    buffer_load_dwordx4 v185, s[28:31], s56 offen offset:3072 sc1 lds
    s_add_u32 s53, s53, 49152
    s_cmp_ge_u32 s53, s61
    s_cselect_b32 s53, s60, s53
    s_waitcnt vmcnt(13)
    s_barrier
M_Pjoin:
    s_waitcnt vmcnt(12)
    s_mov_b32 s3, 0x40000
M_pa_chk:
    v_cmp_ne_u32 vcc, s0, v245
    s_nop 4
    s_cbranch_vccz M_pa_ok
    s_sub_u32 s3, s3, 1
    s_cbranch_scc1 M_pa_ok
    s_sleep 4
    s_cmp_eq_u32 s69, 0
    s_cbranch_scc1 M_pa_rl
    s_sleep 48
M_pa_rl:
    buffer_load_dword v245, v234, s[28:31], s68 offen sc1
    s_waitcnt vmcnt(0)
    s_branch M_pa_chk
M_pa_ok:
    s_lshl_b32 s60, s44, 12
    s_add_u32 s61, s60, 147456
    s_add_u32 s53, s60, 98304
    s_bfe_u32 s66, s2, 0x30003
    s_lshr_b32 s55, s2, 6
    s_add_u32 s66, s66, s55
    s_and_b32 s66, s66, 3
    s_mov_b32 s58, 0x76453201
    s_mov_b32 s59, 0x542310
    s_cmp_eq_u32 s66, 1
    s_cselect_b32 s58, 0x75643120, s58
    s_cselect_b32 s59, 0x534201, s59
    s_cmp_eq_u32 s66, 2
    s_cselect_b32 s58, 0x67542310, s58
    s_cselect_b32 s59, 0x453210, s59
    s_cmp_eq_u32 s66, 3
    s_cselect_b32 s58, 0x76534210, s58
    s_cselect_b32 s59, 0x543201, s59
    s_lshl_b32 s55, s49, 3
    s_mov_b32 s32, s16
    s_mov_b32 s33, s17
    s_mov_b32 s34, 0x700000
    s_mov_b32 s35, 0x20000
    s_add_u32 s36, s16, 0x100
    s_addc_u32 s37, s17, 0
    s_mov_b32 s38, 0x6fff00
    s_mov_b32 s39, 0x20000
    s_and_b32 s57, s58, 15
    s_lshr_b64 s[58:59], s[58:59], 4
    s_add_u32 s57, s57, s55
    s_lshl_b32 s56, s57, 11
    s_mul_i32 s57, s57, 0x20000
    s_add_u32 m0, s53, 16384
    s_nop 0
    buffer_load_dwordx4 v194, s[32:35], s57 offen offset:0 lds
    buffer_load_dwordx4 v195, s[32:35], s57 offen offset:1024 lds
    buffer_load_dwordx4 v196, s[32:35], s57 offen offset:2048 lds
    buffer_load_dwordx4 v197, s[32:35], s57 offen offset:3072 lds
    s_add_u32 m0, s53, 32768
    s_nop 0
    buffer_load_dwordx4 v194, s[36:39], s57 offen offset:0 lds
    buffer_load_dwordx4 v195, s[36:39], s57 offen offset:1024 lds
    buffer_load_dwordx4 v196, s[36:39], s57 offen offset:2048 lds
    buffer_load_dwordx4 v197, s[36:39], s57 offen offset:3072 lds
    s_mov_b32 m0, s53
    s_nop 0
    buffer_load_dwordx4 v192, s[28:31], s56 offen offset:0 sc1 lds
    buffer_load_dwordx4 v192, s[28:31], s56 offen offset:1024 sc1 lds
    buffer_load_dwordx4 v193, s[28:31], s56 offen offset:2048 sc1 lds
    buffer_load_dwordx4 v193, s[28:31], s56 offen offset:3072 sc1 lds
    s_add_u32 s53, s53, 49152
    s_cmp_ge_u32 s53, s61
    s_cselect_b32 s53, s60, s53
    s_lshl_b32 s70, s47, 1
    s_add_u32 s70, s70, s45
    s_lshl_b32 s70, s70, 2
    s_add_u32 s70, s70, s49
    s_lshl_b32 s71, s51, 2
    s_add_u32 s71, s71, s46
    s_lshl_b32 s64, s70, 15
    s_lshl_b32 s65, s71, 7
    s_add_u32 s64, s64, s65
    v_and_b32 v2, 15, v1
    v_lshl_add_u32 v2, v2, 11, s64
    v_bfe_u32 v3, v1, 4, 1
    v_lshl_add_u32 v2, v3, 5, v2
    v_lshrrev_b32 v3, 5, v1
    v_lshl_add_u32 v246, v3, 4, v2
    s_mul_i32 s64, s70, 32768
    s_lshl_b32 s65, s71, 11
    s_add_u32 s64, s64, s65
    s_add_u32 s64, s64, 0xb00000
    v_lshl_add_u32 v248, v1, 4, s64
    s_lshl_b32 s64, s47, 12
    s_lshl_b32 s65, s71, 8
    s_add_u32 s64, s64, s65
    s_add_u32 s64, s64, 0xc0000
    v_and_b32 v2, 48, v1
    v_add_u32 v247, s64, v2
    v_lshlrev_b32 v249, 4, v1
    s_xor_b32 s64, s48, 0
    s_lshl_b32 s65, s47, 4
    s_add_u32 s64, s64, s65
    s_lshl_b32 s64, s64, 2
    s_add_u32 s64, s64, s44
    s_lshl_b32 s72, s64, 12
    s_lshl_b32 s76, s64, 9
    s_add_u32 s76, s76, 0x3000000
    s_xor_b32 s64, s48, 4
    s_lshl_b32 s65, s47, 4
    s_add_u32 s64, s64, s65
    s_lshl_b32 s64, s64, 2
    s_add_u32 s64, s64, s44
    s_lshl_b32 s73, s64, 12
    s_add_u32 s73, s73, 0x2400000
    s_lshl_b32 s77, s64, 9
    s_add_u32 s77, s77, 0x3000000
    s_xor_b32 s64, s48, 8
    s_lshl_b32 s65, s47, 4
    s_add_u32 s64, s64, s65
    s_lshl_b32 s64, s64, 2
    s_add_u32 s64, s64, s44
    s_lshl_b32 s74, s64, 12
    s_add_u32 s74, s74, 0x2800000
    s_lshl_b32 s78, s64, 9
    s_add_u32 s78, s78, 0x3000080
    s_xor_b32 s64, s48, 12
    s_lshl_b32 s65, s47, 4
    s_add_u32 s64, s64, s65
    s_lshl_b32 s64, s64, 2
    s_add_u32 s64, s64, s44
    s_lshl_b32 s75, s64, 12
    s_add_u32 s75, s75, 0x2c00000
    s_lshl_b32 s79, s64, 9
    s_add_u32 s79, s79, 0x3000100
    s_add_u32 s80, s72, 0x2400000
    s_add_u32 s81, s72, 0x2800000
    s_add_u32 s82, s72, 0x2c00000
    s_movk_i32 s83, 4096
    s_add_u32 s62, s26, s76
    s_addc_u32 s63, s27, 0
    s_load_dword s99, s[62:63], 0 glc
    s_load_dword s99, s[62:63], 128 glc
    s_load_dword s99, s[62:63], 256 glc
    s_mov_b32 s52, 98304
    s_waitcnt vmcnt(12)
    s_barrier
    s_and_b32 s57, s58, 15
    s_lshr_b64 s[58:59], s[58:59], 4
    s_add_u32 s57, s57, s55
    s_lshl_b32 s56, s57, 11
    s_mul_i32 s57, s57, 0x20000
    s_add_u32 m0, s53, 16384
    s_nop 0
    buffer_load_dwordx4 v194, s[32:35], s57 offen offset:0 lds
    buffer_load_dwordx4 v195, s[32:35], s57 offen offset:1024 lds
    buffer_load_dwordx4 v196, s[32:35], s57 offen offset:2048 lds
    buffer_load_dwordx4 v197, s[32:35], s57 offen offset:3072 lds
    s_add_u32 m0, s53, 32768
    s_nop 0
    buffer_load_dwordx4 v194, s[36:39], s57 offen offset:0 lds
    buffer_load_dwordx4 v195, s[36:39], s57 offen offset:1024 lds
    buffer_load_dwordx4 v196, s[36:39], s57 offen offset:2048 lds
    buffer_load_dwordx4 v197, s[36:39], s57 offen offset:3072 lds
    s_mov_b32 m0, s53
    s_nop 0
    buffer_load_dwordx4 v192, s[28:31], s56 offen offset:0 sc1 lds
    buffer_load_dwordx4 v192, s[28:31], s56 offen offset:1024 sc1 lds
    buffer_load_dwordx4 v193, s[28:31], s56 offen offset:2048 sc1 lds
    buffer_load_dwordx4 v193, s[28:31], s56 offen offset:3072 sc1 lds
    s_add_u32 s53, s53, 49152
    s_cmp_ge_u32 s53, s61
    s_cselect_b32 s53, s60, s53
    v_add_u32 v232, s52, v233
    v_add_u32 v235, s52, v239
    v_add_u32 v236, s52, v240
    v_add_u32 v237, s52, v241
    v_add_u32 v238, s52, v242
    s_mov_b32 s40, s22
    s_mov_b32 s41, s23
    s_mov_b32 s42, 0x400000
    s_mov_b32 s43, 0x20000
    s_waitcnt vmcnt(12)
    s_barrier
    ds_read_b128 v[140:143], v232 offset:2048
    ds_read_b64_tr_b16 v[152:153], v235 offset:0
    ds_read_b64_tr_b16 v[154:155], v235 offset:4096
    ds_read_b64_tr_b16 v[156:157], v236 offset:0
    ds_read_b64_tr_b16 v[158:159], v236 offset:4096
    ds_read_b64_tr_b16 v[160:161], v237 offset:0
    ds_read_b64_tr_b16 v[162:163], v237 offset:4096
    ds_read_b64_tr_b16 v[164:165], v238 offset:0
    ds_read_b64_tr_b16 v[166:167], v238 offset:4096
    ds_read_b64_tr_b16 v[168:169], v235 offset:16384
    ds_read_b64_tr_b16 v[170:171], v235 offset:20480
    ds_read_b64_tr_b16 v[172:173], v236 offset:16384
    ds_read_b64_tr_b16 v[174:175], v236 offset:20480
    ds_read_b64_tr_b16 v[176:177], v237 offset:16384
    ds_read_b64_tr_b16 v[178:179], v237 offset:20480
    ds_read_b64_tr_b16 v[180:181], v238 offset:16384
    ds_read_b64_tr_b16 v[182:183], v238 offset:20480
    ds_read_b128 v[144:147], v232 offset:4096
    ds_read_b128 v[148:151], v232 offset:6144
    ds_read_b128 v[136:139], v232 offset:0
    s_and_b32 s57, s58, 15
    s_lshr_b64 s[58:59], s[58:59], 4
    s_add_u32 s57, s57, s55
    s_lshl_b32 s56, s57, 11
    s_mul_i32 s57, s57, 0x20000
    s_add_u32 m0, s53, 16384
    s_nop 0
    buffer_load_dwordx4 v194, s[32:35], s57 offen offset:0 lds
    buffer_load_dwordx4 v195, s[32:35], s57 offen offset:1024 lds
    buffer_load_dwordx4 v196, s[32:35], s57 offen offset:2048 lds
    buffer_load_dwordx4 v197, s[32:35], s57 offen offset:3072 lds
    s_add_u32 m0, s53, 32768
    s_nop 0
    buffer_load_dwordx4 v194, s[36:39], s57 offen offset:0 lds
    buffer_load_dwordx4 v195, s[36:39], s57 offen offset:1024 lds
    buffer_load_dwordx4 v196, s[36:39], s57 offen offset:2048 lds
    buffer_load_dwordx4 v197, s[36:39], s57 offen offset:3072 lds
    s_mov_b32 m0, s53
    s_nop 0
    buffer_load_dwordx4 v192, s[28:31], s56 offen offset:0 sc1 lds
    buffer_load_dwordx4 v192, s[28:31], s56 offen offset:1024 sc1 lds
    buffer_load_dwordx4 v193, s[28:31], s56 offen offset:2048 sc1 lds
    buffer_load_dwordx4 v193, s[28:31], s56 offen offset:3072 sc1 lds
    s_add_u32 s53, s53, 49152
    s_cmp_ge_u32 s53, s61
    s_cselect_b32 s53, s60, s53
    s_setprio 2
    s_add_u32 s52, s52, 49152
    s_cmp_ge_u32 s52, 147456
    s_cselect_b32 s52, 0, s52
    s_waitcnt lgkmcnt(0)
    v_mfma_f32_16x16x32_bf16 v[40:43], v[152:155], v[140:143], 0
    ds_read_b128 v[188:191], v232 offset:3072
    v_mfma_f32_16x16x32_bf16 v[44:47], v[156:159], v[140:143], 0
    ds_read_b64_tr_b16 v[200:201], v235 offset:8192
    v_mfma_f32_16x16x32_bf16 v[48:51], v[160:163], v[140:143], 0
    ds_read_b64_tr_b16 v[202:203], v235 offset:12288
    v_mfma_f32_16x16x32_bf16 v[52:55], v[164:167], v[140:143], 0
    ds_read_b64_tr_b16 v[204:205], v236 offset:8192
    v_mfma_f32_16x16x32_bf16 v[56:59], v[168:171], v[140:143], 0
    v_mfma_f32_16x16x32_bf16 v[60:63], v[172:175], v[140:143], 0
    ds_read_b64_tr_b16 v[206:207], v236 offset:12288
    v_mfma_f32_16x16x32_bf16 v[64:67], v[176:179], v[140:143], 0
    ds_read_b64_tr_b16 v[208:209], v237 offset:8192
    v_mfma_f32_16x16x32_bf16 v[68:71], v[180:183], v[140:143], 0
    ds_read_b64_tr_b16 v[210:211], v237 offset:12288
    v_mfma_f32_16x16x32_bf16 v[72:75], v[152:155], v[144:147], 0
    ds_read_b64_tr_b16 v[212:213], v238 offset:8192
    v_mfma_f32_16x16x32_bf16 v[76:79], v[156:159], v[144:147], 0
    v_mfma_f32_16x16x32_bf16 v[80:83], v[160:163], v[144:147], 0
    ds_read_b64_tr_b16 v[214:215], v238 offset:12288
    v_mfma_f32_16x16x32_bf16 v[84:87], v[164:167], v[144:147], 0
    ds_read_b64_tr_b16 v[216:217], v235 offset:24576
    v_mfma_f32_16x16x32_bf16 v[88:91], v[168:171], v[144:147], 0
    ds_read_b64_tr_b16 v[218:219], v235 offset:28672
    v_mfma_f32_16x16x32_bf16 v[92:95], v[172:175], v[144:147], 0
    ds_read_b64_tr_b16 v[220:221], v236 offset:24576
    v_mfma_f32_16x16x32_bf16 v[96:99], v[176:179], v[144:147], 0
    v_mfma_f32_16x16x32_bf16 v[100:103], v[180:183], v[144:147], 0
    ds_read_b64_tr_b16 v[222:223], v236 offset:28672
    v_mfma_f32_16x16x32_bf16 v[104:107], v[152:155], v[148:151], 0
    ds_read_b64_tr_b16 v[224:225], v237 offset:24576
    v_mfma_f32_16x16x32_bf16 v[108:111], v[156:159], v[148:151], 0
    ds_read_b64_tr_b16 v[226:227], v237 offset:28672
    v_mfma_f32_16x16x32_bf16 v[112:115], v[160:163], v[148:151], 0
    ds_read_b64_tr_b16 v[228:229], v238 offset:24576
    v_mfma_f32_16x16x32_bf16 v[116:119], v[164:167], v[148:151], 0
    v_mfma_f32_16x16x32_bf16 v[120:123], v[168:171], v[148:151], 0
    ds_read_b64_tr_b16 v[230:231], v238 offset:28672
    v_mfma_f32_16x16x32_bf16 v[124:127], v[172:175], v[148:151], 0
    ds_read_b128 v[192:195], v232 offset:5120
    v_mfma_f32_16x16x32_bf16 v[128:131], v[176:179], v[148:151], 0
    ds_read_b128 v[196:199], v232 offset:7168
    v_mfma_f32_16x16x32_bf16 v[132:135], v[180:183], v[148:151], 0
    ds_read_b128 v[184:187], v232 offset:1024
    v_mfma_f32_16x16x32_bf16 v[8:11], v[152:155], v[136:139], 0
    v_mfma_f32_16x16x32_bf16 v[12:15], v[156:159], v[136:139], 0
    v_add_u32 v232, s52, v233
    v_mfma_f32_16x16x32_bf16 v[16:19], v[160:163], v[136:139], 0
    v_add_u32 v235, s52, v239
    v_mfma_f32_16x16x32_bf16 v[20:23], v[164:167], v[136:139], 0
    v_add_u32 v236, s52, v240
    v_mfma_f32_16x16x32_bf16 v[24:27], v[168:171], v[136:139], 0
    v_mfma_f32_16x16x32_bf16 v[28:31], v[172:175], v[136:139], 0
    v_add_u32 v237, s52, v241
    v_mfma_f32_16x16x32_bf16 v[32:35], v[176:179], v[136:139], 0
    v_add_u32 v238, s52, v242
    v_mfma_f32_16x16x32_bf16 v[36:39], v[180:183], v[136:139], 0
    s_waitcnt lgkmcnt(0)
    v_mfma_f32_16x16x32_bf16 v[40:43], v[200:203], v[188:191], v[40:43]
    s_waitcnt vmcnt(12)
    s_barrier
    v_mfma_f32_16x16x32_bf16 v[44:47], v[204:207], v[188:191], v[44:47]
    ds_read_b128 v[140:143], v232 offset:2048
    v_mfma_f32_16x16x32_bf16 v[48:51], v[208:211], v[188:191], v[48:51]
    ds_read_b64_tr_b16 v[152:153], v235 offset:0
    v_mfma_f32_16x16x32_bf16 v[52:55], v[212:215], v[188:191], v[52:55]
    ds_read_b64_tr_b16 v[154:155], v235 offset:4096
    v_mfma_f32_16x16x32_bf16 v[56:59], v[216:219], v[188:191], v[56:59]
    ds_read_b64_tr_b16 v[156:157], v236 offset:0
    v_mfma_f32_16x16x32_bf16 v[60:63], v[220:223], v[188:191], v[60:63]
    ds_read_b64_tr_b16 v[158:159], v236 offset:4096
    v_mfma_f32_16x16x32_bf16 v[64:67], v[224:227], v[188:191], v[64:67]
    v_mfma_f32_16x16x32_bf16 v[68:71], v[228:231], v[188:191], v[68:71]
    ds_read_b64_tr_b16 v[160:161], v237 offset:0
    v_mfma_f32_16x16x32_bf16 v[72:75], v[200:203], v[192:195], v[72:75]
    ds_read_b64_tr_b16 v[162:163], v237 offset:4096
    v_mfma_f32_16x16x32_bf16 v[76:79], v[204:207], v[192:195], v[76:79]
    ds_read_b64_tr_b16 v[164:165], v238 offset:0
    v_mfma_f32_16x16x32_bf16 v[80:83], v[208:211], v[192:195], v[80:83]
    ds_read_b64_tr_b16 v[166:167], v238 offset:4096
    v_mfma_f32_16x16x32_bf16 v[84:87], v[212:215], v[192:195], v[84:87]
    ds_read_b64_tr_b16 v[168:169], v235 offset:16384
    v_mfma_f32_16x16x32_bf16 v[88:91], v[216:219], v[192:195], v[88:91]
    v_mfma_f32_16x16x32_bf16 v[92:95], v[220:223], v[192:195], v[92:95]
    ds_read_b64_tr_b16 v[170:171], v235 offset:20480
    v_mfma_f32_16x16x32_bf16 v[96:99], v[224:227], v[192:195], v[96:99]
    ds_read_b64_tr_b16 v[172:173], v236 offset:16384
    v_mfma_f32_16x16x32_bf16 v[100:103], v[228:231], v[192:195], v[100:103]
    ds_read_b64_tr_b16 v[174:175], v236 offset:20480
    v_mfma_f32_16x16x32_bf16 v[104:107], v[200:203], v[196:199], v[104:107]
    ds_read_b64_tr_b16 v[176:177], v237 offset:16384
    v_mfma_f32_16x16x32_bf16 v[108:111], v[204:207], v[196:199], v[108:111]
    ds_read_b64_tr_b16 v[178:179], v237 offset:20480
    v_mfma_f32_16x16x32_bf16 v[112:115], v[208:211], v[196:199], v[112:115]
    v_mfma_f32_16x16x32_bf16 v[116:119], v[212:215], v[196:199], v[116:119]
    ds_read_b64_tr_b16 v[180:181], v238 offset:16384
    v_mfma_f32_16x16x32_bf16 v[120:123], v[216:219], v[196:199], v[120:123]
    ds_read_b64_tr_b16 v[182:183], v238 offset:20480
    v_mfma_f32_16x16x32_bf16 v[124:127], v[220:223], v[196:199], v[124:127]
    ds_read_b128 v[144:147], v232 offset:4096
    v_mfma_f32_16x16x32_bf16 v[128:131], v[224:227], v[196:199], v[128:131]
    ds_read_b128 v[148:151], v232 offset:6144
    v_mfma_f32_16x16x32_bf16 v[132:135], v[228:231], v[196:199], v[132:135]
    ds_read_b128 v[136:139], v232 offset:0
    v_mfma_f32_16x16x32_bf16 v[8:11], v[200:203], v[184:187], v[8:11]
    v_mfma_f32_16x16x32_bf16 v[12:15], v[204:207], v[184:187], v[12:15]
    v_mfma_f32_16x16x32_bf16 v[16:19], v[208:211], v[184:187], v[16:19]
    v_mfma_f32_16x16x32_bf16 v[20:23], v[212:215], v[184:187], v[20:23]
    v_mfma_f32_16x16x32_bf16 v[24:27], v[216:219], v[184:187], v[24:27]
    v_mfma_f32_16x16x32_bf16 v[28:31], v[220:223], v[184:187], v[28:31]
    v_mfma_f32_16x16x32_bf16 v[32:35], v[224:227], v[184:187], v[32:35]
    s_add_u32 s52, s52, 49152
    s_cmp_ge_u32 s52, 147456
    s_cselect_b32 s52, 0, s52
    v_mfma_f32_16x16x32_bf16 v[36:39], v[228:231], v[184:187], v[36:39]
    s_waitcnt lgkmcnt(0)
    v_mfma_f32_16x16x32_bf16 v[40:43], v[152:155], v[140:143], v[40:43]
    ds_read_b128 v[188:191], v232 offset:3072
    v_mfma_f32_16x16x32_bf16 v[44:47], v[156:159], v[140:143], v[44:47]
    ds_read_b64_tr_b16 v[200:201], v235 offset:8192
    v_mfma_f32_16x16x32_bf16 v[48:51], v[160:163], v[140:143], v[48:51]
    ds_read_b64_tr_b16 v[202:203], v235 offset:12288
    v_mfma_f32_16x16x32_bf16 v[52:55], v[164:167], v[140:143], v[52:55]
    ds_read_b64_tr_b16 v[204:205], v236 offset:8192
    v_mfma_f32_16x16x32_bf16 v[56:59], v[168:171], v[140:143], v[56:59]
    v_mfma_f32_16x16x32_bf16 v[60:63], v[172:175], v[140:143], v[60:63]
    ds_read_b64_tr_b16 v[206:207], v236 offset:12288
    v_mfma_f32_16x16x32_bf16 v[64:67], v[176:179], v[140:143], v[64:67]
    ds_read_b64_tr_b16 v[208:209], v237 offset:8192
    v_mfma_f32_16x16x32_bf16 v[68:71], v[180:183], v[140:143], v[68:71]
    ds_read_b64_tr_b16 v[210:211], v237 offset:12288
    v_mfma_f32_16x16x32_bf16 v[72:75], v[152:155], v[144:147], v[72:75]
    ds_read_b64_tr_b16 v[212:213], v238 offset:8192
    v_mfma_f32_16x16x32_bf16 v[76:79], v[156:159], v[144:147], v[76:79]
    v_mfma_f32_16x16x32_bf16 v[80:83], v[160:163], v[144:147], v[80:83]
    ds_read_b64_tr_b16 v[214:215], v238 offset:12288
    v_mfma_f32_16x16x32_bf16 v[84:87], v[164:167], v[144:147], v[84:87]
    ds_read_b64_tr_b16 v[216:217], v235 offset:24576
    v_mfma_f32_16x16x32_bf16 v[88:91], v[168:171], v[144:147], v[88:91]
    ds_read_b64_tr_b16 v[218:219], v235 offset:28672
    v_mfma_f32_16x16x32_bf16 v[92:95], v[172:175], v[144:147], v[92:95]
    ds_read_b64_tr_b16 v[220:221], v236 offset:24576
    v_mfma_f32_16x16x32_bf16 v[96:99], v[176:179], v[144:147], v[96:99]
    v_mfma_f32_16x16x32_bf16 v[100:103], v[180:183], v[144:147], v[100:103]
    ds_read_b64_tr_b16 v[222:223], v236 offset:28672
    v_mfma_f32_16x16x32_bf16 v[104:107], v[152:155], v[148:151], v[104:107]
    ds_read_b64_tr_b16 v[224:225], v237 offset:24576
    v_mfma_f32_16x16x32_bf16 v[108:111], v[156:159], v[148:151], v[108:111]
    ds_read_b64_tr_b16 v[226:227], v237 offset:28672
    v_mfma_f32_16x16x32_bf16 v[112:115], v[160:163], v[148:151], v[112:115]
    ds_read_b64_tr_b16 v[228:229], v238 offset:24576
    v_mfma_f32_16x16x32_bf16 v[116:119], v[164:167], v[148:151], v[116:119]
    v_mfma_f32_16x16x32_bf16 v[120:123], v[168:171], v[148:151], v[120:123]
    ds_read_b64_tr_b16 v[230:231], v238 offset:28672
    v_mfma_f32_16x16x32_bf16 v[124:127], v[172:175], v[148:151], v[124:127]
    ds_read_b128 v[192:195], v232 offset:5120
    v_mfma_f32_16x16x32_bf16 v[128:131], v[176:179], v[148:151], v[128:131]
    ds_read_b128 v[196:199], v232 offset:7168
    v_mfma_f32_16x16x32_bf16 v[132:135], v[180:183], v[148:151], v[132:135]
    ds_read_b128 v[184:187], v232 offset:1024
    v_mfma_f32_16x16x32_bf16 v[8:11], v[152:155], v[136:139], v[8:11]
    v_mfma_f32_16x16x32_bf16 v[12:15], v[156:159], v[136:139], v[12:15]
    v_add_u32 v232, s52, v233
    v_mfma_f32_16x16x32_bf16 v[16:19], v[160:163], v[136:139], v[16:19]
    v_add_u32 v235, s52, v239
    v_mfma_f32_16x16x32_bf16 v[20:23], v[164:167], v[136:139], v[20:23]
    v_add_u32 v236, s52, v240
    v_mfma_f32_16x16x32_bf16 v[24:27], v[168:171], v[136:139], v[24:27]
    v_mfma_f32_16x16x32_bf16 v[28:31], v[172:175], v[136:139], v[28:31]
    v_add_u32 v237, s52, v241
    v_mfma_f32_16x16x32_bf16 v[32:35], v[176:179], v[136:139], v[32:35]
    v_add_u32 v238, s52, v242
    v_mfma_f32_16x16x32_bf16 v[36:39], v[180:183], v[136:139], v[36:39]
    s_waitcnt lgkmcnt(0)
    v_mfma_f32_16x16x32_bf16 v[40:43], v[200:203], v[188:191], v[40:43]
    s_waitcnt vmcnt(0)
    s_barrier
    v_mfma_f32_16x16x32_bf16 v[44:47], v[204:207], v[188:191], v[44:47]
    ds_read_b128 v[140:143], v232 offset:2048
    v_mfma_f32_16x16x32_bf16 v[48:51], v[208:211], v[188:191], v[48:51]
    ds_read_b64_tr_b16 v[152:153], v235 offset:0
    v_mfma_f32_16x16x32_bf16 v[52:55], v[212:215], v[188:191], v[52:55]
    ds_read_b64_tr_b16 v[154:155], v235 offset:4096
    v_mfma_f32_16x16x32_bf16 v[56:59], v[216:219], v[188:191], v[56:59]
    ds_read_b64_tr_b16 v[156:157], v236 offset:0
    v_mfma_f32_16x16x32_bf16 v[60:63], v[220:223], v[188:191], v[60:63]
    ds_read_b64_tr_b16 v[158:159], v236 offset:4096
    v_mfma_f32_16x16x32_bf16 v[64:67], v[224:227], v[188:191], v[64:67]
    v_mfma_f32_16x16x32_bf16 v[68:71], v[228:231], v[188:191], v[68:71]
    ds_read_b64_tr_b16 v[160:161], v237 offset:0
    v_mfma_f32_16x16x32_bf16 v[72:75], v[200:203], v[192:195], v[72:75]
    ds_read_b64_tr_b16 v[162:163], v237 offset:4096
    v_mfma_f32_16x16x32_bf16 v[76:79], v[204:207], v[192:195], v[76:79]
    ds_read_b64_tr_b16 v[164:165], v238 offset:0
    v_mfma_f32_16x16x32_bf16 v[80:83], v[208:211], v[192:195], v[80:83]
    ds_read_b64_tr_b16 v[166:167], v238 offset:4096
    v_mfma_f32_16x16x32_bf16 v[84:87], v[212:215], v[192:195], v[84:87]
    ds_read_b64_tr_b16 v[168:169], v235 offset:16384
    v_mfma_f32_16x16x32_bf16 v[88:91], v[216:219], v[192:195], v[88:91]
    v_mfma_f32_16x16x32_bf16 v[92:95], v[220:223], v[192:195], v[92:95]
    ds_read_b64_tr_b16 v[170:171], v235 offset:20480
    v_mfma_f32_16x16x32_bf16 v[96:99], v[224:227], v[192:195], v[96:99]
    ds_read_b64_tr_b16 v[172:173], v236 offset:16384
    v_mfma_f32_16x16x32_bf16 v[100:103], v[228:231], v[192:195], v[100:103]
    ds_read_b64_tr_b16 v[174:175], v236 offset:20480
    v_mfma_f32_16x16x32_bf16 v[104:107], v[200:203], v[196:199], v[104:107]
    ds_read_b64_tr_b16 v[176:177], v237 offset:16384
    v_mfma_f32_16x16x32_bf16 v[108:111], v[204:207], v[196:199], v[108:111]
    ds_read_b64_tr_b16 v[178:179], v237 offset:20480
    v_mfma_f32_16x16x32_bf16 v[112:115], v[208:211], v[196:199], v[112:115]
    v_mfma_f32_16x16x32_bf16 v[116:119], v[212:215], v[196:199], v[116:119]
    ds_read_b64_tr_b16 v[180:181], v238 offset:16384
    v_mfma_f32_16x16x32_bf16 v[120:123], v[216:219], v[196:199], v[120:123]
    ds_read_b64_tr_b16 v[182:183], v238 offset:20480
    v_mfma_f32_16x16x32_bf16 v[124:127], v[220:223], v[196:199], v[124:127]
    ds_read_b128 v[144:147], v232 offset:4096
    v_mfma_f32_16x16x32_bf16 v[128:131], v[224:227], v[196:199], v[128:131]
    ds_read_b128 v[148:151], v232 offset:6144
    v_mfma_f32_16x16x32_bf16 v[132:135], v[228:231], v[196:199], v[132:135]
    ds_read_b128 v[136:139], v232 offset:0
    v_mfma_f32_16x16x32_bf16 v[8:11], v[200:203], v[184:187], v[8:11]
    v_mfma_f32_16x16x32_bf16 v[12:15], v[204:207], v[184:187], v[12:15]
    v_mfma_f32_16x16x32_bf16 v[16:19], v[208:211], v[184:187], v[16:19]
    v_mfma_f32_16x16x32_bf16 v[20:23], v[212:215], v[184:187], v[20:23]
    v_mfma_f32_16x16x32_bf16 v[24:27], v[216:219], v[184:187], v[24:27]
    v_mfma_f32_16x16x32_bf16 v[28:31], v[220:223], v[184:187], v[28:31]
    v_mfma_f32_16x16x32_bf16 v[32:35], v[224:227], v[184:187], v[32:35]
    s_add_u32 s52, s52, 49152
    s_cmp_ge_u32 s52, 147456
    s_cselect_b32 s52, 0, s52
    v_mfma_f32_16x16x32_bf16 v[36:39], v[228:231], v[184:187], v[36:39]
    s_waitcnt lgkmcnt(0)
    v_mfma_f32_16x16x32_bf16 v[40:43], v[152:155], v[140:143], v[40:43]
    ds_read_b128 v[188:191], v232 offset:3072
    v_mfma_f32_16x16x32_bf16 v[44:47], v[156:159], v[140:143], v[44:47]
    ds_read_b64_tr_b16 v[200:201], v235 offset:8192
    v_mfma_f32_16x16x32_bf16 v[48:51], v[160:163], v[140:143], v[48:51]
    ds_read_b64_tr_b16 v[202:203], v235 offset:12288
    v_mfma_f32_16x16x32_bf16 v[52:55], v[164:167], v[140:143], v[52:55]
    ds_read_b64_tr_b16 v[204:205], v236 offset:8192
    v_mfma_f32_16x16x32_bf16 v[56:59], v[168:171], v[140:143], v[56:59]
    v_mfma_f32_16x16x32_bf16 v[60:63], v[172:175], v[140:143], v[60:63]
    ds_read_b64_tr_b16 v[206:207], v236 offset:12288
    v_mfma_f32_16x16x32_bf16 v[64:67], v[176:179], v[140:143], v[64:67]
    ds_read_b64_tr_b16 v[208:209], v237 offset:8192
    v_mfma_f32_16x16x32_bf16 v[68:71], v[180:183], v[140:143], v[68:71]
    ds_read_b64_tr_b16 v[210:211], v237 offset:12288
    v_mfma_f32_16x16x32_bf16 v[72:75], v[152:155], v[144:147], v[72:75]
    ds_read_b64_tr_b16 v[212:213], v238 offset:8192
    v_mfma_f32_16x16x32_bf16 v[76:79], v[156:159], v[144:147], v[76:79]
    v_mfma_f32_16x16x32_bf16 v[80:83], v[160:163], v[144:147], v[80:83]
    ds_read_b64_tr_b16 v[214:215], v238 offset:12288
    v_mfma_f32_16x16x32_bf16 v[84:87], v[164:167], v[144:147], v[84:87]
    ds_read_b64_tr_b16 v[216:217], v235 offset:24576
    v_mfma_f32_16x16x32_bf16 v[88:91], v[168:171], v[144:147], v[88:91]
    ds_read_b64_tr_b16 v[218:219], v235 offset:28672
    v_mfma_f32_16x16x32_bf16 v[92:95], v[172:175], v[144:147], v[92:95]
    ds_read_b64_tr_b16 v[220:221], v236 offset:24576
    v_mfma_f32_16x16x32_bf16 v[96:99], v[176:179], v[144:147], v[96:99]
    v_mfma_f32_16x16x32_bf16 v[100:103], v[180:183], v[144:147], v[100:103]
    ds_read_b64_tr_b16 v[222:223], v236 offset:28672
    v_mfma_f32_16x16x32_bf16 v[104:107], v[152:155], v[148:151], v[104:107]
    s_movk_i32 s54, 7
M_P_loop5:
    ds_read_b64_tr_b16 v[224:225], v237 offset:24576
    v_mfma_f32_16x16x32_bf16 v[108:111], v[156:159], v[148:151], v[108:111]
    ds_read_b64_tr_b16 v[226:227], v237 offset:28672
    v_mfma_f32_16x16x32_bf16 v[112:115], v[160:163], v[148:151], v[112:115]
    ds_read_b64_tr_b16 v[228:229], v238 offset:24576
    v_mfma_f32_16x16x32_bf16 v[116:119], v[164:167], v[148:151], v[116:119]
    v_mfma_f32_16x16x32_bf16 v[120:123], v[168:171], v[148:151], v[120:123]
    ds_read_b64_tr_b16 v[230:231], v238 offset:28672
    v_mfma_f32_16x16x32_bf16 v[124:127], v[172:175], v[148:151], v[124:127]
    ds_read_b128 v[192:195], v232 offset:5120
    v_mfma_f32_16x16x32_bf16 v[128:131], v[176:179], v[148:151], v[128:131]
    ds_read_b128 v[196:199], v232 offset:7168
    v_mfma_f32_16x16x32_bf16 v[132:135], v[180:183], v[148:151], v[132:135]
    ds_read_b128 v[184:187], v232 offset:1024
    v_mfma_f32_16x16x32_bf16 v[8:11], v[152:155], v[136:139], v[8:11]
    v_mfma_f32_16x16x32_bf16 v[12:15], v[156:159], v[136:139], v[12:15]
    v_add_u32 v232, s52, v233
    v_mfma_f32_16x16x32_bf16 v[16:19], v[160:163], v[136:139], v[16:19]
    v_add_u32 v235, s52, v239
    v_mfma_f32_16x16x32_bf16 v[20:23], v[164:167], v[136:139], v[20:23]
    v_add_u32 v236, s52, v240
    v_mfma_f32_16x16x32_bf16 v[24:27], v[168:171], v[136:139], v[24:27]
    v_mfma_f32_16x16x32_bf16 v[28:31], v[172:175], v[136:139], v[28:31]
    v_add_u32 v237, s52, v241
    v_mfma_f32_16x16x32_bf16 v[32:35], v[176:179], v[136:139], v[32:35]
    v_add_u32 v238, s52, v242
    v_mfma_f32_16x16x32_bf16 v[36:39], v[180:183], v[136:139], v[36:39]
    s_waitcnt lgkmcnt(0)
    v_mfma_f32_16x16x32_bf16 v[40:43], v[200:203], v[188:191], v[40:43]
    s_barrier
    v_mfma_f32_16x16x32_bf16 v[44:47], v[204:207], v[188:191], v[44:47]
    ds_read_b128 v[140:143], v232 offset:2048
    v_mfma_f32_16x16x32_bf16 v[48:51], v[208:211], v[188:191], v[48:51]
    ds_read_b64_tr_b16 v[152:153], v235 offset:0
    v_mfma_f32_16x16x32_bf16 v[52:55], v[212:215], v[188:191], v[52:55]
    ds_read_b64_tr_b16 v[154:155], v235 offset:4096
    v_mfma_f32_16x16x32_bf16 v[56:59], v[216:219], v[188:191], v[56:59]
    ds_read_b64_tr_b16 v[156:157], v236 offset:0
    v_mfma_f32_16x16x32_bf16 v[60:63], v[220:223], v[188:191], v[60:63]
    ds_read_b64_tr_b16 v[158:159], v236 offset:4096
    v_mfma_f32_16x16x32_bf16 v[64:67], v[224:227], v[188:191], v[64:67]
    v_mfma_f32_16x16x32_bf16 v[68:71], v[228:231], v[188:191], v[68:71]
    ds_read_b64_tr_b16 v[160:161], v237 offset:0
    v_mfma_f32_16x16x32_bf16 v[72:75], v[200:203], v[192:195], v[72:75]
    ds_read_b64_tr_b16 v[162:163], v237 offset:4096
    v_mfma_f32_16x16x32_bf16 v[76:79], v[204:207], v[192:195], v[76:79]
    ds_read_b64_tr_b16 v[164:165], v238 offset:0
    v_mfma_f32_16x16x32_bf16 v[80:83], v[208:211], v[192:195], v[80:83]
    ds_read_b64_tr_b16 v[166:167], v238 offset:4096
    v_mfma_f32_16x16x32_bf16 v[84:87], v[212:215], v[192:195], v[84:87]
    ds_read_b64_tr_b16 v[168:169], v235 offset:16384
    v_mfma_f32_16x16x32_bf16 v[88:91], v[216:219], v[192:195], v[88:91]
    v_mfma_f32_16x16x32_bf16 v[92:95], v[220:223], v[192:195], v[92:95]
    ds_read_b64_tr_b16 v[170:171], v235 offset:20480
    v_mfma_f32_16x16x32_bf16 v[96:99], v[224:227], v[192:195], v[96:99]
    ds_read_b64_tr_b16 v[172:173], v236 offset:16384
    v_mfma_f32_16x16x32_bf16 v[100:103], v[228:231], v[192:195], v[100:103]
    ds_read_b64_tr_b16 v[174:175], v236 offset:20480
    v_mfma_f32_16x16x32_bf16 v[104:107], v[200:203], v[196:199], v[104:107]
    ds_read_b64_tr_b16 v[176:177], v237 offset:16384
    v_mfma_f32_16x16x32_bf16 v[108:111], v[204:207], v[196:199], v[108:111]
    ds_read_b64_tr_b16 v[178:179], v237 offset:20480
    v_mfma_f32_16x16x32_bf16 v[112:115], v[208:211], v[196:199], v[112:115]
    v_mfma_f32_16x16x32_bf16 v[116:119], v[212:215], v[196:199], v[116:119]
    ds_read_b64_tr_b16 v[180:181], v238 offset:16384
    v_mfma_f32_16x16x32_bf16 v[120:123], v[216:219], v[196:199], v[120:123]
    ds_read_b64_tr_b16 v[182:183], v238 offset:20480
    v_mfma_f32_16x16x32_bf16 v[124:127], v[220:223], v[196:199], v[124:127]
    ds_read_b128 v[144:147], v232 offset:4096
    v_mfma_f32_16x16x32_bf16 v[128:131], v[224:227], v[196:199], v[128:131]
    ds_read_b128 v[148:151], v232 offset:6144
    v_mfma_f32_16x16x32_bf16 v[132:135], v[228:231], v[196:199], v[132:135]
    ds_read_b128 v[136:139], v232 offset:0
    v_mfma_f32_16x16x32_bf16 v[8:11], v[200:203], v[184:187], v[8:11]
    v_mfma_f32_16x16x32_bf16 v[12:15], v[204:207], v[184:187], v[12:15]
    v_mfma_f32_16x16x32_bf16 v[16:19], v[208:211], v[184:187], v[16:19]
    v_mfma_f32_16x16x32_bf16 v[20:23], v[212:215], v[184:187], v[20:23]
    v_mfma_f32_16x16x32_bf16 v[24:27], v[216:219], v[184:187], v[24:27]
    v_mfma_f32_16x16x32_bf16 v[28:31], v[220:223], v[184:187], v[28:31]
    v_mfma_f32_16x16x32_bf16 v[32:35], v[224:227], v[184:187], v[32:35]
    s_add_u32 s52, s52, 49152
    s_cmp_ge_u32 s52, 147456
    s_cselect_b32 s52, 0, s52
    v_mfma_f32_16x16x32_bf16 v[36:39], v[228:231], v[184:187], v[36:39]
    s_waitcnt lgkmcnt(0)
    v_mfma_f32_16x16x32_bf16 v[40:43], v[152:155], v[140:143], v[40:43]
    ds_read_b128 v[188:191], v232 offset:3072
    v_mfma_f32_16x16x32_bf16 v[44:47], v[156:159], v[140:143], v[44:47]
    ds_read_b64_tr_b16 v[200:201], v235 offset:8192
    v_mfma_f32_16x16x32_bf16 v[48:51], v[160:163], v[140:143], v[48:51]
    ds_read_b64_tr_b16 v[202:203], v235 offset:12288
    v_mfma_f32_16x16x32_bf16 v[52:55], v[164:167], v[140:143], v[52:55]
    ds_read_b64_tr_b16 v[204:205], v236 offset:8192
    v_mfma_f32_16x16x32_bf16 v[56:59], v[168:171], v[140:143], v[56:59]
    v_mfma_f32_16x16x32_bf16 v[60:63], v[172:175], v[140:143], v[60:63]
    ds_read_b64_tr_b16 v[206:207], v236 offset:12288
    v_mfma_f32_16x16x32_bf16 v[64:67], v[176:179], v[140:143], v[64:67]
    ds_read_b64_tr_b16 v[208:209], v237 offset:8192
    v_mfma_f32_16x16x32_bf16 v[68:71], v[180:183], v[140:143], v[68:71]
    ds_read_b64_tr_b16 v[210:211], v237 offset:12288
    v_mfma_f32_16x16x32_bf16 v[72:75], v[152:155], v[144:147], v[72:75]
    ds_read_b64_tr_b16 v[212:213], v238 offset:8192
    v_mfma_f32_16x16x32_bf16 v[76:79], v[156:159], v[144:147], v[76:79]
    v_mfma_f32_16x16x32_bf16 v[80:83], v[160:163], v[144:147], v[80:83]
    ds_read_b64_tr_b16 v[214:215], v238 offset:12288
    v_mfma_f32_16x16x32_bf16 v[84:87], v[164:167], v[144:147], v[84:87]
    ds_read_b64_tr_b16 v[216:217], v235 offset:24576
    v_mfma_f32_16x16x32_bf16 v[88:91], v[168:171], v[144:147], v[88:91]
    ds_read_b64_tr_b16 v[218:219], v235 offset:28672
    v_mfma_f32_16x16x32_bf16 v[92:95], v[172:175], v[144:147], v[92:95]
    ds_read_b64_tr_b16 v[220:221], v236 offset:24576
    v_mfma_f32_16x16x32_bf16 v[96:99], v[176:179], v[144:147], v[96:99]
    v_mfma_f32_16x16x32_bf16 v[100:103], v[180:183], v[144:147], v[100:103]
    s_sub_u32 s54, s54, 1
    ds_read_b64_tr_b16 v[222:223], v236 offset:28672
    v_mfma_f32_16x16x32_bf16 v[104:107], v[152:155], v[148:151], v[104:107]
    s_cbranch_scc0 M_P_loop5
    ds_read_b64_tr_b16 v[224:225], v237 offset:24576
    v_mfma_f32_16x16x32_bf16 v[108:111], v[156:159], v[148:151], v[108:111]
    ds_read_b64_tr_b16 v[226:227], v237 offset:28672
    v_mfma_f32_16x16x32_bf16 v[112:115], v[160:163], v[148:151], v[112:115]
    ds_read_b64_tr_b16 v[228:229], v238 offset:24576
    v_mfma_f32_16x16x32_bf16 v[116:119], v[164:167], v[148:151], v[116:119]
    v_mfma_f32_16x16x32_bf16 v[120:123], v[168:171], v[148:151], v[120:123]
    ds_read_b64_tr_b16 v[230:231], v238 offset:28672
    v_mfma_f32_16x16x32_bf16 v[124:127], v[172:175], v[148:151], v[124:127]
    ds_read_b128 v[192:195], v232 offset:5120
    v_mfma_f32_16x16x32_bf16 v[128:131], v[176:179], v[148:151], v[128:131]
    ds_read_b128 v[196:199], v232 offset:7168
    v_mfma_f32_16x16x32_bf16 v[132:135], v[180:183], v[148:151], v[132:135]
    ds_read_b128 v[184:187], v232 offset:1024
    v_mfma_f32_16x16x32_bf16 v[8:11], v[152:155], v[136:139], v[8:11]
    v_mfma_f32_16x16x32_bf16 v[12:15], v[156:159], v[136:139], v[12:15]
    v_add_u32 v232, s52, v233
    v_mfma_f32_16x16x32_bf16 v[16:19], v[160:163], v[136:139], v[16:19]
    v_add_u32 v235, s52, v239
    v_mfma_f32_16x16x32_bf16 v[20:23], v[164:167], v[136:139], v[20:23]
    v_add_u32 v236, s52, v240
    v_mfma_f32_16x16x32_bf16 v[24:27], v[168:171], v[136:139], v[24:27]
    v_mfma_f32_16x16x32_bf16 v[28:31], v[172:175], v[136:139], v[28:31]
    v_add_u32 v237, s52, v241
    v_mfma_f32_16x16x32_bf16 v[32:35], v[176:179], v[136:139], v[32:35]
    v_add_u32 v238, s52, v242
    v_mfma_f32_16x16x32_bf16 v[36:39], v[180:183], v[136:139], v[36:39]
    s_waitcnt lgkmcnt(0)
    v_mfma_f32_16x16x32_bf16 v[40:43], v[200:203], v[188:191], v[40:43]
    s_barrier
    v_mfma_f32_16x16x32_bf16 v[44:47], v[204:207], v[188:191], v[44:47]
    ds_read_b128 v[140:143], v232 offset:2048
    v_mfma_f32_16x16x32_bf16 v[48:51], v[208:211], v[188:191], v[48:51]
    ds_read_b64_tr_b16 v[152:153], v235 offset:0
    v_mfma_f32_16x16x32_bf16 v[52:55], v[212:215], v[188:191], v[52:55]
    ds_read_b64_tr_b16 v[154:155], v235 offset:4096
    v_mfma_f32_16x16x32_bf16 v[56:59], v[216:219], v[188:191], v[56:59]
    v_mfma_f32_16x16x32_bf16 v[60:63], v[220:223], v[188:191], v[60:63]
    ds_read_b64_tr_b16 v[156:157], v236 offset:0
    v_mfma_f32_16x16x32_bf16 v[64:67], v[224:227], v[188:191], v[64:67]
    ds_read_b64_tr_b16 v[158:159], v236 offset:4096
    v_mfma_f32_16x16x32_bf16 v[68:71], v[228:231], v[188:191], v[68:71]
    ds_read_b64_tr_b16 v[160:161], v237 offset:0
    v_mfma_f32_16x16x32_bf16 v[72:75], v[200:203], v[192:195], v[72:75]
    v_mfma_f32_16x16x32_bf16 v[76:79], v[204:207], v[192:195], v[76:79]
    ds_read_b64_tr_b16 v[162:163], v237 offset:4096
    v_mfma_f32_16x16x32_bf16 v[80:83], v[208:211], v[192:195], v[80:83]
    ds_read_b64_tr_b16 v[164:165], v238 offset:0
    v_mfma_f32_16x16x32_bf16 v[84:87], v[212:215], v[192:195], v[84:87]
    ds_read_b64_tr_b16 v[166:167], v238 offset:4096
    v_mfma_f32_16x16x32_bf16 v[88:91], v[216:219], v[192:195], v[88:91]
    v_mfma_f32_16x16x32_bf16 v[92:95], v[220:223], v[192:195], v[92:95]
    ds_read_b64_tr_b16 v[168:169], v235 offset:16384
    v_mfma_f32_16x16x32_bf16 v[96:99], v[224:227], v[192:195], v[96:99]
    ds_read_b64_tr_b16 v[170:171], v235 offset:20480
    v_mfma_f32_16x16x32_bf16 v[100:103], v[228:231], v[192:195], v[100:103]
    ds_read_b64_tr_b16 v[172:173], v236 offset:16384
    v_mfma_f32_16x16x32_bf16 v[104:107], v[200:203], v[196:199], v[104:107]
    v_mfma_f32_16x16x32_bf16 v[108:111], v[204:207], v[196:199], v[108:111]
    ds_read_b64_tr_b16 v[174:175], v236 offset:20480
    v_mfma_f32_16x16x32_bf16 v[112:115], v[208:211], v[196:199], v[112:115]
    ds_read_b64_tr_b16 v[176:177], v237 offset:16384
    v_mfma_f32_16x16x32_bf16 v[116:119], v[212:215], v[196:199], v[116:119]
    ds_read_b64_tr_b16 v[178:179], v237 offset:20480
    v_mfma_f32_16x16x32_bf16 v[120:123], v[216:219], v[196:199], v[120:123]
    v_mfma_f32_16x16x32_bf16 v[124:127], v[220:223], v[196:199], v[124:127]
    ds_read_b64_tr_b16 v[180:181], v238 offset:16384
    v_mfma_f32_16x16x32_bf16 v[128:131], v[224:227], v[196:199], v[128:131]
    ds_read_b64_tr_b16 v[182:183], v238 offset:20480
    v_mfma_f32_16x16x32_bf16 v[132:135], v[228:231], v[196:199], v[132:135]
    ds_read_b128 v[144:147], v232 offset:4096
    v_mfma_f32_16x16x32_bf16 v[8:11], v[200:203], v[184:187], v[8:11]
    v_mfma_f32_16x16x32_bf16 v[12:15], v[204:207], v[184:187], v[12:15]
    v_mfma_f32_16x16x32_bf16 v[16:19], v[208:211], v[184:187], v[16:19]
    v_mfma_f32_16x16x32_bf16 v[20:23], v[212:215], v[184:187], v[20:23]
    v_mfma_f32_16x16x32_bf16 v[24:27], v[216:219], v[184:187], v[24:27]
    v_mfma_f32_16x16x32_bf16 v[28:31], v[220:223], v[184:187], v[28:31]
    v_mfma_f32_16x16x32_bf16 v[32:35], v[224:227], v[184:187], v[32:35]
    s_add_u32 s52, s52, 49152
    s_cmp_ge_u32 s52, 147456
    s_cselect_b32 s52, 0, s52
    v_mfma_f32_16x16x32_bf16 v[36:39], v[228:231], v[184:187], v[36:39]
    s_waitcnt lgkmcnt(0)
    v_mfma_f32_16x16x32_bf16 v[40:43], v[152:155], v[140:143], v[40:43]
    ds_read_b128 v[188:191], v232 offset:3072
    ds_read_b64_tr_b16 v[200:201], v235 offset:8192
    v_mfma_f32_16x16x32_bf16 v[44:47], v[156:159], v[140:143], v[44:47]
    ds_read_b64_tr_b16 v[202:203], v235 offset:12288
    v_mfma_f32_16x16x32_bf16 v[48:51], v[160:163], v[140:143], v[48:51]
    ds_read_b64_tr_b16 v[204:205], v236 offset:8192
    ds_read_b64_tr_b16 v[206:207], v236 offset:12288
    v_mfma_f32_16x16x32_bf16 v[52:55], v[164:167], v[140:143], v[52:55]
    ds_read_b64_tr_b16 v[208:209], v237 offset:8192
    v_mfma_f32_16x16x32_bf16 v[56:59], v[168:171], v[140:143], v[56:59]
    ds_read_b64_tr_b16 v[210:211], v237 offset:12288
    ds_read_b64_tr_b16 v[212:213], v238 offset:8192
    v_mfma_f32_16x16x32_bf16 v[60:63], v[172:175], v[140:143], v[60:63]
    ds_read_b64_tr_b16 v[214:215], v238 offset:12288
    v_mfma_f32_16x16x32_bf16 v[64:67], v[176:179], v[140:143], v[64:67]
    ds_read_b64_tr_b16 v[216:217], v235 offset:24576
    ds_read_b64_tr_b16 v[218:219], v235 offset:28672
    v_mfma_f32_16x16x32_bf16 v[68:71], v[180:183], v[140:143], v[68:71]
    ds_read_b64_tr_b16 v[220:221], v236 offset:24576
    v_mfma_f32_16x16x32_bf16 v[72:75], v[152:155], v[144:147], v[72:75]
    s_movk_i32 s54, 1
M_P_loop6:
    ds_read_b64_tr_b16 v[222:223], v236 offset:28672
    ds_read_b64_tr_b16 v[224:225], v237 offset:24576
    v_mfma_f32_16x16x32_bf16 v[76:79], v[156:159], v[144:147], v[76:79]
    ds_read_b64_tr_b16 v[226:227], v237 offset:28672
    v_mfma_f32_16x16x32_bf16 v[80:83], v[160:163], v[144:147], v[80:83]
    ds_read_b64_tr_b16 v[228:229], v238 offset:24576
    ds_read_b64_tr_b16 v[230:231], v238 offset:28672
    v_mfma_f32_16x16x32_bf16 v[84:87], v[164:167], v[144:147], v[84:87]
    ds_read_b128 v[192:195], v232 offset:5120
    v_mfma_f32_16x16x32_bf16 v[88:91], v[168:171], v[144:147], v[88:91]
    v_add_u32 v232, s52, v233
    v_add_u32 v235, s52, v239
    v_mfma_f32_16x16x32_bf16 v[92:95], v[172:175], v[144:147], v[92:95]
    v_add_u32 v236, s52, v240
    v_mfma_f32_16x16x32_bf16 v[96:99], v[176:179], v[144:147], v[96:99]
    v_add_u32 v237, s52, v241
    v_mfma_f32_16x16x32_bf16 v[100:103], v[180:183], v[144:147], v[100:103]
    v_add_u32 v238, s52, v242
    s_waitcnt lgkmcnt(0)
    v_mfma_f32_16x16x32_bf16 v[40:43], v[200:203], v[188:191], v[40:43]
    s_barrier
    v_mfma_f32_16x16x32_bf16 v[44:47], v[204:207], v[188:191], v[44:47]
    ds_read_b128 v[140:143], v232 offset:2048
    ds_read_b64_tr_b16 v[152:153], v235 offset:0
    v_mfma_f32_16x16x32_bf16 v[48:51], v[208:211], v[188:191], v[48:51]
    ds_read_b64_tr_b16 v[154:155], v235 offset:4096
    ds_read_b64_tr_b16 v[156:157], v236 offset:0
    v_mfma_f32_16x16x32_bf16 v[52:55], v[212:215], v[188:191], v[52:55]
    ds_read_b64_tr_b16 v[158:159], v236 offset:4096
    v_mfma_f32_16x16x32_bf16 v[56:59], v[216:219], v[188:191], v[56:59]
    ds_read_b64_tr_b16 v[160:161], v237 offset:0
    ds_read_b64_tr_b16 v[162:163], v237 offset:4096
    v_mfma_f32_16x16x32_bf16 v[60:63], v[220:223], v[188:191], v[60:63]
    ds_read_b64_tr_b16 v[164:165], v238 offset:0
    ds_read_b64_tr_b16 v[166:167], v238 offset:4096
    v_mfma_f32_16x16x32_bf16 v[64:67], v[224:227], v[188:191], v[64:67]
    ds_read_b64_tr_b16 v[168:169], v235 offset:16384
    v_mfma_f32_16x16x32_bf16 v[68:71], v[228:231], v[188:191], v[68:71]
    ds_read_b64_tr_b16 v[170:171], v235 offset:20480
    ds_read_b64_tr_b16 v[172:173], v236 offset:16384
    v_mfma_f32_16x16x32_bf16 v[72:75], v[200:203], v[192:195], v[72:75]
    ds_read_b64_tr_b16 v[174:175], v236 offset:20480
    ds_read_b64_tr_b16 v[176:177], v237 offset:16384
    v_mfma_f32_16x16x32_bf16 v[76:79], v[204:207], v[192:195], v[76:79]
    ds_read_b64_tr_b16 v[178:179], v237 offset:20480
    v_mfma_f32_16x16x32_bf16 v[80:83], v[208:211], v[192:195], v[80:83]
    ds_read_b64_tr_b16 v[180:181], v238 offset:16384
    ds_read_b64_tr_b16 v[182:183], v238 offset:20480
    v_mfma_f32_16x16x32_bf16 v[84:87], v[212:215], v[192:195], v[84:87]
    ds_read_b128 v[144:147], v232 offset:4096
    v_mfma_f32_16x16x32_bf16 v[88:91], v[216:219], v[192:195], v[88:91]
    v_mfma_f32_16x16x32_bf16 v[92:95], v[220:223], v[192:195], v[92:95]
    v_mfma_f32_16x16x32_bf16 v[96:99], v[224:227], v[192:195], v[96:99]
    s_add_u32 s52, s52, 49152
    s_cmp_ge_u32 s52, 147456
    s_cselect_b32 s52, 0, s52
    v_mfma_f32_16x16x32_bf16 v[100:103], v[228:231], v[192:195], v[100:103]
    s_waitcnt lgkmcnt(0)
    v_mfma_f32_16x16x32_bf16 v[40:43], v[152:155], v[140:143], v[40:43]
    ds_read_b128 v[188:191], v232 offset:3072
    ds_read_b64_tr_b16 v[200:201], v235 offset:8192
    v_mfma_f32_16x16x32_bf16 v[44:47], v[156:159], v[140:143], v[44:47]
    ds_read_b64_tr_b16 v[202:203], v235 offset:12288
    v_mfma_f32_16x16x32_bf16 v[48:51], v[160:163], v[140:143], v[48:51]
    ds_read_b64_tr_b16 v[204:205], v236 offset:8192
    ds_read_b64_tr_b16 v[206:207], v236 offset:12288
    v_mfma_f32_16x16x32_bf16 v[52:55], v[164:167], v[140:143], v[52:55]
    ds_read_b64_tr_b16 v[208:209], v237 offset:8192
    v_mfma_f32_16x16x32_bf16 v[56:59], v[168:171], v[140:143], v[56:59]
    ds_read_b64_tr_b16 v[210:211], v237 offset:12288
    ds_read_b64_tr_b16 v[212:213], v238 offset:8192
    v_mfma_f32_16x16x32_bf16 v[60:63], v[172:175], v[140:143], v[60:63]
    ds_read_b64_tr_b16 v[214:215], v238 offset:12288
    v_mfma_f32_16x16x32_bf16 v[64:67], v[176:179], v[140:143], v[64:67]
    ds_read_b64_tr_b16 v[216:217], v235 offset:24576
    ds_read_b64_tr_b16 v[218:219], v235 offset:28672
    v_mfma_f32_16x16x32_bf16 v[68:71], v[180:183], v[140:143], v[68:71]
    s_sub_u32 s54, s54, 1
    ds_read_b64_tr_b16 v[220:221], v236 offset:24576
    v_mfma_f32_16x16x32_bf16 v[72:75], v[152:155], v[144:147], v[72:75]
    s_cbranch_scc0 M_P_loop6
    ds_read_b64_tr_b16 v[222:223], v236 offset:28672
    ds_read_b64_tr_b16 v[224:225], v237 offset:24576
    v_mfma_f32_16x16x32_bf16 v[76:79], v[156:159], v[144:147], v[76:79]
    ds_read_b64_tr_b16 v[226:227], v237 offset:28672
    v_mfma_f32_16x16x32_bf16 v[80:83], v[160:163], v[144:147], v[80:83]
    ds_read_b64_tr_b16 v[228:229], v238 offset:24576
    ds_read_b64_tr_b16 v[230:231], v238 offset:28672
    v_mfma_f32_16x16x32_bf16 v[84:87], v[164:167], v[144:147], v[84:87]
    ds_read_b128 v[192:195], v232 offset:5120
    v_mfma_f32_16x16x32_bf16 v[88:91], v[168:171], v[144:147], v[88:91]
    v_mfma_f32_16x16x32_bf16 v[92:95], v[172:175], v[144:147], v[92:95]
    v_mfma_f32_16x16x32_bf16 v[96:99], v[176:179], v[144:147], v[96:99]
    v_mfma_f32_16x16x32_bf16 v[100:103], v[180:183], v[144:147], v[100:103]
    s_waitcnt lgkmcnt(0)
    v_mfma_f32_16x16x32_bf16 v[40:43], v[200:203], v[188:191], v[40:43]
    v_add_u32 v232, 49152, v233
    v_add_u32 v235, 49152, v239
    v_mfma_f32_16x16x32_bf16 v[44:47], v[204:207], v[188:191], v[44:47]
    v_add_u32 v236, 49152, v240
    v_add_u32 v237, 49152, v241
    v_mfma_f32_16x16x32_bf16 v[48:51], v[208:211], v[188:191], v[48:51]
    v_add_u32 v238, 49152, v242
    v_mfma_f32_16x16x32_bf16 v[52:55], v[212:215], v[188:191], v[52:55]
    ds_read_b128 v[148:151], v232 offset:6144
    ds_read_b64_tr_b16 v[152:153], v235 offset:0
    v_mfma_f32_16x16x32_bf16 v[56:59], v[216:219], v[188:191], v[56:59]
    ds_read_b64_tr_b16 v[154:155], v235 offset:4096
    v_mfma_f32_16x16x32_bf16 v[60:63], v[220:223], v[188:191], v[60:63]
    ds_read_b64_tr_b16 v[156:157], v236 offset:0
    ds_read_b64_tr_b16 v[158:159], v236 offset:4096
    v_mfma_f32_16x16x32_bf16 v[64:67], v[224:227], v[188:191], v[64:67]
    ds_read_b64_tr_b16 v[160:161], v237 offset:0
    v_mfma_f32_16x16x32_bf16 v[68:71], v[228:231], v[188:191], v[68:71]
    ds_read_b64_tr_b16 v[162:163], v237 offset:4096
    ds_read_b64_tr_b16 v[164:165], v238 offset:0
    v_mfma_f32_16x16x32_bf16 v[72:75], v[200:203], v[192:195], v[72:75]
    ds_read_b64_tr_b16 v[166:167], v238 offset:4096
    ds_read_b64_tr_b16 v[168:169], v235 offset:16384
    v_mfma_f32_16x16x32_bf16 v[76:79], v[204:207], v[192:195], v[76:79]
    ds_read_b64_tr_b16 v[170:171], v235 offset:20480
    v_mfma_f32_16x16x32_bf16 v[80:83], v[208:211], v[192:195], v[80:83]
    ds_read_b64_tr_b16 v[172:173], v236 offset:16384
    ds_read_b64_tr_b16 v[174:175], v236 offset:20480
    v_mfma_f32_16x16x32_bf16 v[84:87], v[212:215], v[192:195], v[84:87]
    ds_read_b64_tr_b16 v[176:177], v237 offset:16384
    v_cvt_pk_bf16_f32 v40, v40, v41
    v_cvt_pk_bf16_f32 v41, v42, v43
    v_mfma_f32_16x16x32_bf16 v[88:91], v[216:219], v[192:195], v[88:91]
    ds_read_b64_tr_b16 v[178:179], v237 offset:20480
    ds_read_b64_tr_b16 v[180:181], v238 offset:16384
    v_cvt_pk_bf16_f32 v42, v44, v45
    v_cvt_pk_bf16_f32 v43, v46, v47
    v_mfma_f32_16x16x32_bf16 v[92:95], v[220:223], v[192:195], v[92:95]
    ds_read_b64_tr_b16 v[182:183], v238 offset:20480
    buffer_store_dwordx4 v[40:43], v249, s[28:31], s73 offen offset:0 sc1
    v_cvt_pk_bf16_f32 v48, v48, v49
    v_mfma_f32_16x16x32_bf16 v[96:99], v[224:227], v[192:195], v[96:99]
    v_cvt_pk_bf16_f32 v49, v50, v51
    v_cvt_pk_bf16_f32 v50, v52, v53
    v_mfma_f32_16x16x32_bf16 v[100:103], v[228:231], v[192:195], v[100:103]
    v_cvt_pk_bf16_f32 v51, v54, v55
    buffer_store_dwordx4 v[48:51], v249, s[28:31], s73 offen offset:1024 sc1
    s_waitcnt lgkmcnt(14)
    v_mfma_f32_16x16x32_bf16 v[104:107], v[152:155], v[148:151], v[104:107]
    ds_read_b128 v[196:199], v232 offset:7168
    ds_read_b64_tr_b16 v[200:201], v235 offset:8192
    v_cvt_pk_bf16_f32 v56, v56, v57
    s_waitcnt lgkmcnt(14)
    v_mfma_f32_16x16x32_bf16 v[108:111], v[156:159], v[148:151], v[108:111]
    ds_read_b64_tr_b16 v[202:203], v235 offset:12288
    ds_read_b64_tr_b16 v[204:205], v236 offset:8192
    v_cvt_pk_bf16_f32 v57, v58, v59
    s_waitcnt lgkmcnt(14)
    v_mfma_f32_16x16x32_bf16 v[112:115], v[160:163], v[148:151], v[112:115]
    ds_read_b64_tr_b16 v[206:207], v236 offset:12288
    ds_read_b64_tr_b16 v[208:209], v237 offset:8192
    v_cvt_pk_bf16_f32 v58, v60, v61
    s_waitcnt lgkmcnt(14)
    v_mfma_f32_16x16x32_bf16 v[116:119], v[164:167], v[148:151], v[116:119]
    ds_read_b64_tr_b16 v[210:211], v237 offset:12288
    ds_read_b64_tr_b16 v[212:213], v238 offset:8192
    v_cvt_pk_bf16_f32 v59, v62, v63
    s_waitcnt lgkmcnt(14)
    v_mfma_f32_16x16x32_bf16 v[120:123], v[168:171], v[148:151], v[120:123]
    ds_read_b64_tr_b16 v[214:215], v238 offset:12288
    ds_read_b64_tr_b16 v[216:217], v235 offset:24576
    buffer_store_dwordx4 v[56:59], v249, s[28:31], s73 offen offset:2048 sc1
    s_waitcnt lgkmcnt(14)
    v_mfma_f32_16x16x32_bf16 v[124:127], v[172:175], v[148:151], v[124:127]
    ds_read_b64_tr_b16 v[218:219], v235 offset:28672
    ds_read_b64_tr_b16 v[220:221], v236 offset:24576
    v_cvt_pk_bf16_f32 v64, v64, v65
    s_waitcnt lgkmcnt(14)
    v_mfma_f32_16x16x32_bf16 v[128:131], v[176:179], v[148:151], v[128:131]
    ds_read_b64_tr_b16 v[222:223], v236 offset:28672
    ds_read_b64_tr_b16 v[224:225], v237 offset:24576
    v_cvt_pk_bf16_f32 v65, v66, v67
    s_waitcnt lgkmcnt(14)
    v_mfma_f32_16x16x32_bf16 v[132:135], v[180:183], v[148:151], v[132:135]
    ds_read_b64_tr_b16 v[226:227], v237 offset:28672
    ds_read_b64_tr_b16 v[228:229], v238 offset:24576
    ds_read_b64_tr_b16 v[230:231], v238 offset:28672
    v_cvt_pk_bf16_f32 v66, v68, v69
    s_waitcnt lgkmcnt(14)
    v_mfma_f32_16x16x32_bf16 v[104:107], v[200:203], v[196:199], v[104:107]
    v_add_u32 v232, 98304, v233
    v_add_u32 v235, 98304, v239
    v_cvt_pk_bf16_f32 v67, v70, v71
    s_waitcnt lgkmcnt(12)
    v_mfma_f32_16x16x32_bf16 v[108:111], v[204:207], v[196:199], v[108:111]
    v_add_u32 v236, 98304, v240
    v_add_u32 v237, 98304, v241
    v_add_u32 v238, 98304, v242
    buffer_store_dwordx4 v[64:67], v249, s[28:31], s73 offen offset:3072 sc1
    s_waitcnt lgkmcnt(10)
    v_mfma_f32_16x16x32_bf16 v[112:115], v[208:211], v[196:199], v[112:115]
    ds_read_b128 v[148:151], v232 offset:6144
    ds_read_b64_tr_b16 v[152:153], v235 offset:0
    ds_read_b64_tr_b16 v[154:155], v235 offset:4096
    v_cvt_pk_bf16_f32 v72, v72, v73
    s_waitcnt lgkmcnt(11)
    v_mfma_f32_16x16x32_bf16 v[116:119], v[212:215], v[196:199], v[116:119]
    ds_read_b64_tr_b16 v[156:157], v236 offset:0
    ds_read_b64_tr_b16 v[158:159], v236 offset:4096
    ds_read_b64_tr_b16 v[160:161], v237 offset:0
    v_cvt_pk_bf16_f32 v73, v74, v75
    s_waitcnt lgkmcnt(12)
    v_mfma_f32_16x16x32_bf16 v[120:123], v[216:219], v[196:199], v[120:123]
    ds_read_b64_tr_b16 v[162:163], v237 offset:4096
    ds_read_b64_tr_b16 v[164:165], v238 offset:0
    v_cvt_pk_bf16_f32 v74, v76, v77
    s_waitcnt lgkmcnt(12)
    v_mfma_f32_16x16x32_bf16 v[124:127], v[220:223], v[196:199], v[124:127]
    ds_read_b64_tr_b16 v[166:167], v238 offset:4096
    ds_read_b64_tr_b16 v[168:169], v235 offset:16384
    ds_read_b64_tr_b16 v[170:171], v235 offset:20480
    v_cvt_pk_bf16_f32 v75, v78, v79
    s_waitcnt lgkmcnt(13)
    v_mfma_f32_16x16x32_bf16 v[128:131], v[224:227], v[196:199], v[128:131]
    ds_read_b64_tr_b16 v[172:173], v236 offset:16384
    ds_read_b64_tr_b16 v[174:175], v236 offset:20480
    ds_read_b64_tr_b16 v[176:177], v237 offset:16384
    buffer_store_dwordx4 v[72:75], v249, s[28:31], s74 offen offset:0 sc1
    s_waitcnt lgkmcnt(14)
    v_mfma_f32_16x16x32_bf16 v[132:135], v[228:231], v[196:199], v[132:135]
    ds_read_b64_tr_b16 v[178:179], v237 offset:20480
    ds_read_b64_tr_b16 v[180:181], v238 offset:16384
    ds_read_b64_tr_b16 v[182:183], v238 offset:20480
    v_cvt_pk_bf16_f32 v80, v80, v81
    s_waitcnt lgkmcnt(14)
    v_mfma_f32_16x16x32_bf16 v[104:107], v[152:155], v[148:151], v[104:107]
    ds_read_b128 v[196:199], v232 offset:7168
    ds_read_b64_tr_b16 v[200:201], v235 offset:8192
    v_cvt_pk_bf16_f32 v81, v82, v83
    s_waitcnt lgkmcnt(14)
    v_mfma_f32_16x16x32_bf16 v[108:111], v[156:159], v[148:151], v[108:111]
    ds_read_b64_tr_b16 v[202:203], v235 offset:12288
    ds_read_b64_tr_b16 v[204:205], v236 offset:8192
    v_cvt_pk_bf16_f32 v82, v84, v85
    s_waitcnt lgkmcnt(14)
    v_mfma_f32_16x16x32_bf16 v[112:115], v[160:163], v[148:151], v[112:115]
    ds_read_b64_tr_b16 v[206:207], v236 offset:12288
    ds_read_b64_tr_b16 v[208:209], v237 offset:8192
    v_cvt_pk_bf16_f32 v83, v86, v87
    s_waitcnt lgkmcnt(14)
    v_mfma_f32_16x16x32_bf16 v[116:119], v[164:167], v[148:151], v[116:119]
    ds_read_b64_tr_b16 v[210:211], v237 offset:12288
    ds_read_b64_tr_b16 v[212:213], v238 offset:8192
    buffer_store_dwordx4 v[80:83], v249, s[28:31], s74 offen offset:1024 sc1
    s_waitcnt lgkmcnt(14)
    v_mfma_f32_16x16x32_bf16 v[120:123], v[168:171], v[148:151], v[120:123]
    ds_read_b64_tr_b16 v[214:215], v238 offset:12288
    ds_read_b64_tr_b16 v[216:217], v235 offset:24576
    v_cvt_pk_bf16_f32 v88, v88, v89
    s_waitcnt lgkmcnt(14)
    v_mfma_f32_16x16x32_bf16 v[124:127], v[172:175], v[148:151], v[124:127]
    ds_read_b64_tr_b16 v[218:219], v235 offset:28672
    ds_read_b64_tr_b16 v[220:221], v236 offset:24576
    v_cvt_pk_bf16_f32 v89, v90, v91
    s_waitcnt lgkmcnt(14)
    v_mfma_f32_16x16x32_bf16 v[128:131], v[176:179], v[148:151], v[128:131]
    ds_read_b64_tr_b16 v[222:223], v236 offset:28672
    ds_read_b64_tr_b16 v[224:225], v237 offset:24576
    v_cvt_pk_bf16_f32 v90, v92, v93
    s_waitcnt lgkmcnt(14)
    v_mfma_f32_16x16x32_bf16 v[132:135], v[180:183], v[148:151], v[132:135]
    ds_read_b64_tr_b16 v[226:227], v237 offset:28672
    ds_read_b64_tr_b16 v[228:229], v238 offset:24576
    ds_read_b64_tr_b16 v[230:231], v238 offset:28672
    v_cvt_pk_bf16_f32 v91, v94, v95
    s_waitcnt lgkmcnt(14)
    v_mfma_f32_16x16x32_bf16 v[104:107], v[200:203], v[196:199], v[104:107]
    v_add_u32 v232, 0, v233
    v_add_u32 v235, 0, v239
    buffer_store_dwordx4 v[88:91], v249, s[28:31], s74 offen offset:2048 sc1
    s_waitcnt lgkmcnt(12)
    v_mfma_f32_16x16x32_bf16 v[108:111], v[204:207], v[196:199], v[108:111]
    v_add_u32 v236, 0, v240
    v_add_u32 v237, 0, v241
    v_add_u32 v238, 0, v242
    v_cvt_pk_bf16_f32 v96, v96, v97
    s_waitcnt lgkmcnt(10)
    v_mfma_f32_16x16x32_bf16 v[112:115], v[208:211], v[196:199], v[112:115]
    ds_read_b128 v[148:151], v232 offset:6144
    ds_read_b64_tr_b16 v[152:153], v235 offset:0
    ds_read_b64_tr_b16 v[154:155], v235 offset:4096
    v_cvt_pk_bf16_f32 v97, v98, v99
    s_waitcnt lgkmcnt(11)
    v_mfma_f32_16x16x32_bf16 v[116:119], v[212:215], v[196:199], v[116:119]
    ds_read_b64_tr_b16 v[156:157], v236 offset:0
    ds_read_b64_tr_b16 v[158:159], v236 offset:4096
    ds_read_b64_tr_b16 v[160:161], v237 offset:0
    v_cvt_pk_bf16_f32 v98, v100, v101
    s_waitcnt lgkmcnt(12)
    v_mfma_f32_16x16x32_bf16 v[120:123], v[216:219], v[196:199], v[120:123]
    ds_read_b64_tr_b16 v[162:163], v237 offset:4096
    ds_read_b64_tr_b16 v[164:165], v238 offset:0
    v_cvt_pk_bf16_f32 v99, v102, v103
    s_waitcnt lgkmcnt(12)
    v_mfma_f32_16x16x32_bf16 v[124:127], v[220:223], v[196:199], v[124:127]
    ds_read_b64_tr_b16 v[166:167], v238 offset:4096
    ds_read_b64_tr_b16 v[168:169], v235 offset:16384
    ds_read_b64_tr_b16 v[170:171], v235 offset:20480
    buffer_store_dwordx4 v[96:99], v249, s[28:31], s74 offen offset:3072 sc1
    s_waitcnt lgkmcnt(13)
    v_mfma_f32_16x16x32_bf16 v[128:131], v[224:227], v[196:199], v[128:131]
    ds_read_b64_tr_b16 v[172:173], v236 offset:16384
    ds_read_b64_tr_b16 v[174:175], v236 offset:20480
    ds_read_b64_tr_b16 v[176:177], v237 offset:16384
    s_waitcnt lgkmcnt(14)
    v_mfma_f32_16x16x32_bf16 v[132:135], v[228:231], v[196:199], v[132:135]
    ds_read_b64_tr_b16 v[178:179], v237 offset:20480
    ds_read_b64_tr_b16 v[180:181], v238 offset:16384
    ds_read_b64_tr_b16 v[182:183], v238 offset:20480
    s_waitcnt lgkmcnt(14)
    v_mfma_f32_16x16x32_bf16 v[104:107], v[152:155], v[148:151], v[104:107]
    ds_read_b128 v[196:199], v232 offset:7168
    ds_read_b64_tr_b16 v[200:201], v235 offset:8192
    s_waitcnt lgkmcnt(14)
    v_mfma_f32_16x16x32_bf16 v[108:111], v[156:159], v[148:151], v[108:111]
    ds_read_b64_tr_b16 v[202:203], v235 offset:12288
    ds_read_b64_tr_b16 v[204:205], v236 offset:8192
    s_waitcnt lgkmcnt(14)
    v_mfma_f32_16x16x32_bf16 v[112:115], v[160:163], v[148:151], v[112:115]
    ds_read_b64_tr_b16 v[206:207], v236 offset:12288
    ds_read_b64_tr_b16 v[208:209], v237 offset:8192
    s_waitcnt lgkmcnt(14)
    v_mfma_f32_16x16x32_bf16 v[116:119], v[164:167], v[148:151], v[116:119]
    ds_read_b64_tr_b16 v[210:211], v237 offset:12288
    ds_read_b64_tr_b16 v[212:213], v238 offset:8192
    s_waitcnt lgkmcnt(14)
    v_mfma_f32_16x16x32_bf16 v[120:123], v[168:171], v[148:151], v[120:123]
    ds_read_b64_tr_b16 v[214:215], v238 offset:12288
    ds_read_b64_tr_b16 v[216:217], v235 offset:24576
    s_waitcnt lgkmcnt(14)
    v_mfma_f32_16x16x32_bf16 v[124:127], v[172:175], v[148:151], v[124:127]
    ds_read_b64_tr_b16 v[218:219], v235 offset:28672
    ds_read_b64_tr_b16 v[220:221], v236 offset:24576
    s_waitcnt lgkmcnt(14)
    v_mfma_f32_16x16x32_bf16 v[128:131], v[176:179], v[148:151], v[128:131]
    ds_read_b64_tr_b16 v[222:223], v236 offset:28672
    ds_read_b64_tr_b16 v[224:225], v237 offset:24576
    s_waitcnt lgkmcnt(14)
    v_mfma_f32_16x16x32_bf16 v[132:135], v[180:183], v[148:151], v[132:135]
    ds_read_b64_tr_b16 v[226:227], v237 offset:28672
    ds_read_b64_tr_b16 v[228:229], v238 offset:24576
    ds_read_b64_tr_b16 v[230:231], v238 offset:28672
    s_waitcnt lgkmcnt(14)
    v_mfma_f32_16x16x32_bf16 v[104:107], v[200:203], v[196:199], v[104:107]
    v_add_u32 v232, 49152, v233
    v_add_u32 v235, 49152, v239
    s_waitcnt lgkmcnt(12)
    v_mfma_f32_16x16x32_bf16 v[108:111], v[204:207], v[196:199], v[108:111]
    v_add_u32 v236, 49152, v240
    v_add_u32 v237, 49152, v241
    v_add_u32 v238, 49152, v242
    s_waitcnt lgkmcnt(10)
    v_mfma_f32_16x16x32_bf16 v[112:115], v[208:211], v[196:199], v[112:115]
    ds_read_b128 v[136:139], v232 offset:0
    ds_read_b64_tr_b16 v[152:153], v235 offset:0
    ds_read_b64_tr_b16 v[154:155], v235 offset:4096
    s_waitcnt lgkmcnt(11)
    v_mfma_f32_16x16x32_bf16 v[116:119], v[212:215], v[196:199], v[116:119]
    ds_read_b64_tr_b16 v[156:157], v236 offset:0
    ds_read_b64_tr_b16 v[158:159], v236 offset:4096
    ds_read_b64_tr_b16 v[160:161], v237 offset:0
    s_waitcnt lgkmcnt(12)
    v_mfma_f32_16x16x32_bf16 v[120:123], v[216:219], v[196:199], v[120:123]
    ds_read_b64_tr_b16 v[162:163], v237 offset:4096
    ds_read_b64_tr_b16 v[164:165], v238 offset:0
    s_waitcnt lgkmcnt(12)
    v_mfma_f32_16x16x32_bf16 v[124:127], v[220:223], v[196:199], v[124:127]
    ds_read_b64_tr_b16 v[166:167], v238 offset:4096
    ds_read_b64_tr_b16 v[168:169], v235 offset:16384
    ds_read_b64_tr_b16 v[170:171], v235 offset:20480
    s_waitcnt lgkmcnt(13)
    v_mfma_f32_16x16x32_bf16 v[128:131], v[224:227], v[196:199], v[128:131]
    ds_read_b64_tr_b16 v[172:173], v236 offset:16384
    ds_read_b64_tr_b16 v[174:175], v236 offset:20480
    ds_read_b64_tr_b16 v[176:177], v237 offset:16384
    s_waitcnt lgkmcnt(14)
    v_mfma_f32_16x16x32_bf16 v[132:135], v[228:231], v[196:199], v[132:135]
    ds_read_b64_tr_b16 v[178:179], v237 offset:20480
    ds_read_b64_tr_b16 v[180:181], v238 offset:16384
    ds_read_b64_tr_b16 v[182:183], v238 offset:20480
    s_waitcnt lgkmcnt(14)
    v_mfma_f32_16x16x32_bf16 v[8:11], v[152:155], v[136:139], v[8:11]
    ds_read_b128 v[184:187], v232 offset:1024
    ds_read_b64_tr_b16 v[200:201], v235 offset:8192
    v_cvt_pk_bf16_f32 v104, v104, v105
    v_cvt_pk_bf16_f32 v105, v106, v107
    s_waitcnt lgkmcnt(14)
    v_mfma_f32_16x16x32_bf16 v[12:15], v[156:159], v[136:139], v[12:15]
    ds_read_b64_tr_b16 v[202:203], v235 offset:12288
    ds_read_b64_tr_b16 v[204:205], v236 offset:8192
    v_cvt_pk_bf16_f32 v106, v108, v109
    v_cvt_pk_bf16_f32 v107, v110, v111
    s_waitcnt lgkmcnt(14)
    v_mfma_f32_16x16x32_bf16 v[16:19], v[160:163], v[136:139], v[16:19]
    ds_read_b64_tr_b16 v[206:207], v236 offset:12288
    ds_read_b64_tr_b16 v[208:209], v237 offset:8192
    buffer_store_dwordx4 v[104:107], v249, s[28:31], s75 offen offset:0 sc1
    v_cvt_pk_bf16_f32 v112, v112, v113
    s_waitcnt lgkmcnt(14)
    v_mfma_f32_16x16x32_bf16 v[20:23], v[164:167], v[136:139], v[20:23]
    ds_read_b64_tr_b16 v[210:211], v237 offset:12288
    ds_read_b64_tr_b16 v[212:213], v238 offset:8192
    v_cvt_pk_bf16_f32 v113, v114, v115
    v_cvt_pk_bf16_f32 v114, v116, v117
    s_waitcnt lgkmcnt(14)
    v_mfma_f32_16x16x32_bf16 v[24:27], v[168:171], v[136:139], v[24:27]
    ds_read_b64_tr_b16 v[214:215], v238 offset:12288
    ds_read_b64_tr_b16 v[216:217], v235 offset:24576
    v_cvt_pk_bf16_f32 v115, v118, v119
    buffer_store_dwordx4 v[112:115], v249, s[28:31], s75 offen offset:1024 sc1
    s_waitcnt lgkmcnt(14)
    v_mfma_f32_16x16x32_bf16 v[28:31], v[172:175], v[136:139], v[28:31]
    ds_read_b64_tr_b16 v[218:219], v235 offset:28672
    ds_read_b64_tr_b16 v[220:221], v236 offset:24576
    v_cvt_pk_bf16_f32 v120, v120, v121
    v_cvt_pk_bf16_f32 v121, v122, v123
    s_waitcnt lgkmcnt(14)
    v_mfma_f32_16x16x32_bf16 v[32:35], v[176:179], v[136:139], v[32:35]
    ds_read_b64_tr_b16 v[222:223], v236 offset:28672
    ds_read_b64_tr_b16 v[224:225], v237 offset:24576
    v_cvt_pk_bf16_f32 v122, v124, v125
    v_cvt_pk_bf16_f32 v123, v126, v127
    s_waitcnt lgkmcnt(14)
    v_mfma_f32_16x16x32_bf16 v[36:39], v[180:183], v[136:139], v[36:39]
    ds_read_b64_tr_b16 v[226:227], v237 offset:28672
    ds_read_b64_tr_b16 v[228:229], v238 offset:24576
    ds_read_b64_tr_b16 v[230:231], v238 offset:28672
    buffer_store_dwordx4 v[120:123], v249, s[28:31], s75 offen offset:2048 sc1
    v_cvt_pk_bf16_f32 v128, v128, v129
    s_waitcnt lgkmcnt(14)
    v_mfma_f32_16x16x32_bf16 v[8:11], v[200:203], v[184:187], v[8:11]
    v_add_u32 v232, 98304, v233
    v_add_u32 v235, 98304, v239
    v_cvt_pk_bf16_f32 v129, v130, v131
    v_cvt_pk_bf16_f32 v130, v132, v133
    s_waitcnt lgkmcnt(12)
    v_mfma_f32_16x16x32_bf16 v[12:15], v[204:207], v[184:187], v[12:15]
    v_add_u32 v236, 98304, v240
    v_add_u32 v237, 98304, v241
    v_add_u32 v238, 98304, v242
    v_cvt_pk_bf16_f32 v131, v134, v135
    buffer_store_dwordx4 v[128:131], v249, s[28:31], s75 offen offset:3072 sc1
    s_waitcnt lgkmcnt(10)
    v_mfma_f32_16x16x32_bf16 v[16:19], v[208:211], v[184:187], v[16:19]
    ds_read_b128 v[136:139], v232 offset:0
    ds_read_b64_tr_b16 v[152:153], v235 offset:0
    ds_read_b64_tr_b16 v[154:155], v235 offset:4096
    buffer_load_dwordx4 v[44:47], v248, s[28:31], 0 offen offset:0 sc1
    buffer_load_dwordx4 v[52:55], v248, s[28:31], 0 offen offset:1024 sc1
    s_waitcnt lgkmcnt(11)
    v_mfma_f32_16x16x32_bf16 v[20:23], v[212:215], v[184:187], v[20:23]
    ds_read_b64_tr_b16 v[156:157], v236 offset:0
    ds_read_b64_tr_b16 v[158:159], v236 offset:4096
    ds_read_b64_tr_b16 v[160:161], v237 offset:0
    buffer_load_dwordx4 v[60:63], v248, s[28:31], s83 offen offset:0 sc1
    buffer_load_dwordx4 v[68:71], v248, s[28:31], s83 offen offset:1024 sc1
    s_waitcnt lgkmcnt(12)
    v_mfma_f32_16x16x32_bf16 v[24:27], v[216:219], v[184:187], v[24:27]
    ds_read_b64_tr_b16 v[162:163], v237 offset:4096
    ds_read_b64_tr_b16 v[164:165], v238 offset:0
    buffer_load_dwordx4 v[76:79], v247, s[28:31], 0 offen offset:0 sc1
    buffer_load_dwordx4 v[84:87], v247, s[28:31], 0 offen offset:64 sc1
    s_waitcnt lgkmcnt(12)
    v_mfma_f32_16x16x32_bf16 v[28:31], v[220:223], v[184:187], v[28:31]
    ds_read_b64_tr_b16 v[166:167], v238 offset:4096
    ds_read_b64_tr_b16 v[168:169], v235 offset:16384
    ds_read_b64_tr_b16 v[170:171], v235 offset:20480
    buffer_load_dwordx4 v[92:95], v247, s[28:31], 0 offen offset:128 sc1
    buffer_load_dwordx4 v[100:103], v247, s[28:31], 0 offen offset:192 sc1
    s_waitcnt lgkmcnt(13)
    v_mfma_f32_16x16x32_bf16 v[32:35], v[224:227], v[184:187], v[32:35]
    ds_read_b64_tr_b16 v[172:173], v236 offset:16384
    ds_read_b64_tr_b16 v[174:175], v236 offset:20480
    ds_read_b64_tr_b16 v[176:177], v237 offset:16384
    buffer_load_dwordx4 v[108:111], v247, s[28:31], 0 offen offset:512 sc1
    buffer_load_dwordx4 v[116:119], v247, s[28:31], 0 offen offset:576 sc1
    s_waitcnt lgkmcnt(14)
    v_mfma_f32_16x16x32_bf16 v[36:39], v[228:231], v[184:187], v[36:39]
    ds_read_b64_tr_b16 v[178:179], v237 offset:20480
    ds_read_b64_tr_b16 v[180:181], v238 offset:16384
    ds_read_b64_tr_b16 v[182:183], v238 offset:20480
    buffer_load_dwordx4 v[124:127], v247, s[28:31], 0 offen offset:640 sc1
    buffer_load_dwordx4 v[132:135], v247, s[28:31], 0 offen offset:704 sc1
    s_waitcnt lgkmcnt(14)
    v_mfma_f32_16x16x32_bf16 v[8:11], v[152:155], v[136:139], v[8:11]
    ds_read_b128 v[184:187], v232 offset:1024
    ds_read_b64_tr_b16 v[200:201], v235 offset:8192
    s_waitcnt lgkmcnt(14)
    v_mfma_f32_16x16x32_bf16 v[12:15], v[156:159], v[136:139], v[12:15]
    ds_read_b64_tr_b16 v[202:203], v235 offset:12288
    ds_read_b64_tr_b16 v[204:205], v236 offset:8192
    s_waitcnt lgkmcnt(14)
    v_mfma_f32_16x16x32_bf16 v[16:19], v[160:163], v[136:139], v[16:19]
    ds_read_b64_tr_b16 v[206:207], v236 offset:12288
    ds_read_b64_tr_b16 v[208:209], v237 offset:8192
    s_waitcnt lgkmcnt(14)
    v_mfma_f32_16x16x32_bf16 v[20:23], v[164:167], v[136:139], v[20:23]
    ds_read_b64_tr_b16 v[210:211], v237 offset:12288
    ds_read_b64_tr_b16 v[212:213], v238 offset:8192
    s_waitcnt lgkmcnt(14)
    v_mfma_f32_16x16x32_bf16 v[24:27], v[168:171], v[136:139], v[24:27]
    ds_read_b64_tr_b16 v[214:215], v238 offset:12288
    ds_read_b64_tr_b16 v[216:217], v235 offset:24576
    s_waitcnt lgkmcnt(14)
    v_mfma_f32_16x16x32_bf16 v[28:31], v[172:175], v[136:139], v[28:31]
    ds_read_b64_tr_b16 v[218:219], v235 offset:28672
    ds_read_b64_tr_b16 v[220:221], v236 offset:24576
    s_waitcnt lgkmcnt(14)
    v_mfma_f32_16x16x32_bf16 v[32:35], v[176:179], v[136:139], v[32:35]
    ds_read_b64_tr_b16 v[222:223], v236 offset:28672
    ds_read_b64_tr_b16 v[224:225], v237 offset:24576
    s_waitcnt lgkmcnt(14)
    v_mfma_f32_16x16x32_bf16 v[36:39], v[180:183], v[136:139], v[36:39]
    ds_read_b64_tr_b16 v[226:227], v237 offset:28672
    ds_read_b64_tr_b16 v[228:229], v238 offset:24576
    ds_read_b64_tr_b16 v[230:231], v238 offset:28672
    s_waitcnt lgkmcnt(14)
    v_mfma_f32_16x16x32_bf16 v[8:11], v[200:203], v[184:187], v[8:11]
    v_add_u32 v232, 0, v233
    v_add_u32 v235, 0, v239
    s_waitcnt lgkmcnt(12)
    v_mfma_f32_16x16x32_bf16 v[12:15], v[204:207], v[184:187], v[12:15]
    v_add_u32 v236, 0, v240
    v_add_u32 v237, 0, v241
    v_add_u32 v238, 0, v242
    s_waitcnt lgkmcnt(10)
    v_mfma_f32_16x16x32_bf16 v[16:19], v[208:211], v[184:187], v[16:19]
    ds_read_b128 v[136:139], v232 offset:0
    ds_read_b64_tr_b16 v[152:153], v235 offset:0
    ds_read_b64_tr_b16 v[154:155], v235 offset:4096
    s_waitcnt lgkmcnt(11)
    v_mfma_f32_16x16x32_bf16 v[20:23], v[212:215], v[184:187], v[20:23]
    ds_read_b64_tr_b16 v[156:157], v236 offset:0
    ds_read_b64_tr_b16 v[158:159], v236 offset:4096
    ds_read_b64_tr_b16 v[160:161], v237 offset:0
    s_waitcnt lgkmcnt(12)
    v_mfma_f32_16x16x32_bf16 v[24:27], v[216:219], v[184:187], v[24:27]
    ds_read_b64_tr_b16 v[162:163], v237 offset:4096
    ds_read_b64_tr_b16 v[164:165], v238 offset:0
    s_waitcnt lgkmcnt(12)
    v_mfma_f32_16x16x32_bf16 v[28:31], v[220:223], v[184:187], v[28:31]
    ds_read_b64_tr_b16 v[166:167], v238 offset:4096
    ds_read_b64_tr_b16 v[168:169], v235 offset:16384
    ds_read_b64_tr_b16 v[170:171], v235 offset:20480
    s_waitcnt lgkmcnt(13)
    v_mfma_f32_16x16x32_bf16 v[32:35], v[224:227], v[184:187], v[32:35]
    ds_read_b64_tr_b16 v[172:173], v236 offset:16384
    ds_read_b64_tr_b16 v[174:175], v236 offset:20480
    ds_read_b64_tr_b16 v[176:177], v237 offset:16384
    s_waitcnt lgkmcnt(14)
    v_mfma_f32_16x16x32_bf16 v[36:39], v[228:231], v[184:187], v[36:39]
    ds_read_b64_tr_b16 v[178:179], v237 offset:20480
    ds_read_b64_tr_b16 v[180:181], v238 offset:16384
    ds_read_b64_tr_b16 v[182:183], v238 offset:20480
    s_waitcnt lgkmcnt(14)
    v_mfma_f32_16x16x32_bf16 v[8:11], v[152:155], v[136:139], v[8:11]
    ds_read_b128 v[184:187], v232 offset:1024
    ds_read_b64_tr_b16 v[200:201], v235 offset:8192
    s_waitcnt lgkmcnt(14)
    v_mfma_f32_16x16x32_bf16 v[12:15], v[156:159], v[136:139], v[12:15]
    ds_read_b64_tr_b16 v[202:203], v235 offset:12288
    ds_read_b64_tr_b16 v[204:205], v236 offset:8192
    s_waitcnt lgkmcnt(14)
    v_mfma_f32_16x16x32_bf16 v[16:19], v[160:163], v[136:139], v[16:19]
    ds_read_b64_tr_b16 v[206:207], v236 offset:12288
    ds_read_b64_tr_b16 v[208:209], v237 offset:8192
    s_waitcnt lgkmcnt(14)
    v_mfma_f32_16x16x32_bf16 v[20:23], v[164:167], v[136:139], v[20:23]
    ds_read_b64_tr_b16 v[210:211], v237 offset:12288
    ds_read_b64_tr_b16 v[212:213], v238 offset:8192
    s_waitcnt lgkmcnt(14)
    v_mfma_f32_16x16x32_bf16 v[24:27], v[168:171], v[136:139], v[24:27]
    ds_read_b64_tr_b16 v[214:215], v238 offset:12288
    ds_read_b64_tr_b16 v[216:217], v235 offset:24576
    s_waitcnt lgkmcnt(14)
    v_mfma_f32_16x16x32_bf16 v[28:31], v[172:175], v[136:139], v[28:31]
    ds_read_b64_tr_b16 v[218:219], v235 offset:28672
    ds_read_b64_tr_b16 v[220:221], v236 offset:24576
    s_waitcnt lgkmcnt(14)
    v_mfma_f32_16x16x32_bf16 v[32:35], v[176:179], v[136:139], v[32:35]
    ds_read_b64_tr_b16 v[222:223], v236 offset:28672
    ds_read_b64_tr_b16 v[224:225], v237 offset:24576
    s_waitcnt lgkmcnt(14)
    v_mfma_f32_16x16x32_bf16 v[36:39], v[180:183], v[136:139], v[36:39]
    ds_read_b64_tr_b16 v[226:227], v237 offset:28672
    ds_read_b64_tr_b16 v[228:229], v238 offset:24576
    ds_read_b64_tr_b16 v[230:231], v238 offset:28672
    s_waitcnt lgkmcnt(14)
    v_mfma_f32_16x16x32_bf16 v[8:11], v[200:203], v[184:187], v[8:11]
    s_waitcnt lgkmcnt(12)
    v_mfma_f32_16x16x32_bf16 v[12:15], v[204:207], v[184:187], v[12:15]
    s_waitcnt lgkmcnt(10)
    v_mfma_f32_16x16x32_bf16 v[16:19], v[208:211], v[184:187], v[16:19]
    s_waitcnt lgkmcnt(8)
    v_mfma_f32_16x16x32_bf16 v[20:23], v[212:215], v[184:187], v[20:23]
    s_waitcnt lgkmcnt(6)
    v_mfma_f32_16x16x32_bf16 v[24:27], v[216:219], v[184:187], v[24:27]
    s_waitcnt lgkmcnt(4)
    v_mfma_f32_16x16x32_bf16 v[28:31], v[220:223], v[184:187], v[28:31]
    s_waitcnt lgkmcnt(2)
    v_mfma_f32_16x16x32_bf16 v[32:35], v[224:227], v[184:187], v[32:35]
    s_waitcnt lgkmcnt(0)
    v_mfma_f32_16x16x32_bf16 v[36:39], v[228:231], v[184:187], v[36:39]
    s_waitcnt vmcnt(20)
    s_atomic_swap s0, s[26:27], s77
    s_waitcnt vmcnt(16)
    s_atomic_swap s0, s[26:27], s78
    s_waitcnt vmcnt(12)
    s_atomic_swap s0, s[26:27], s79
    s_mov_b32 s3, 0x40000
    s_mov_b32 s88, 0
M_fchk:
    s_load_dword s84, s[62:63], 0 glc
    s_load_dword s85, s[62:63], 128 glc
    s_load_dword s86, s[62:63], 256 glc
    s_sub_u32 s3, s3, 1
    s_cbranch_scc1 M_fgo
    s_waitcnt lgkmcnt(0)
    s_cmp_lg_u32 s84, s0
    s_cbranch_scc1 M_fn0
    s_bitcmp1_b32 s88, 0
    s_cbranch_scc1 M_fn0
    s_bitset1_b32 s88, 0
    buffer_load_dwordx4 v[184:187], v249, s[28:31], s80 offen offset:0 sc1
    buffer_load_dwordx4 v[196:199], v249, s[28:31], s80 offen offset:1024 sc1
    buffer_load_dwordx4 v[208:211], v249, s[28:31], s80 offen offset:2048 sc1
    buffer_load_dwordx4 v[220:223], v249, s[28:31], s80 offen offset:3072 sc1
M_fn0:
    s_cmp_lg_u32 s85, s0
    s_cbranch_scc1 M_fn1
    s_bitcmp1_b32 s88, 1
    s_cbranch_scc1 M_fn1
    s_bitset1_b32 s88, 1
    buffer_load_dwordx4 v[188:191], v249, s[28:31], s81 offen offset:0 sc1
    buffer_load_dwordx4 v[200:203], v249, s[28:31], s81 offen offset:1024 sc1
    buffer_load_dwordx4 v[212:215], v249, s[28:31], s81 offen offset:2048 sc1
    buffer_load_dwordx4 v[224:227], v249, s[28:31], s81 offen offset:3072 sc1
M_fn1:
    s_cmp_lg_u32 s86, s0
    s_cbranch_scc1 M_fn2
    s_bitcmp1_b32 s88, 2
    s_cbranch_scc1 M_fn2
    s_bitset1_b32 s88, 2
    buffer_load_dwordx4 v[192:195], v249, s[28:31], s82 offen offset:0 sc1
    buffer_load_dwordx4 v[204:207], v249, s[28:31], s82 offen offset:1024 sc1
    buffer_load_dwordx4 v[216:219], v249, s[28:31], s82 offen offset:2048 sc1
    buffer_load_dwordx4 v[228:231], v249, s[28:31], s82 offen offset:3072 sc1
M_fn2:
    s_cmp_lg_u32 s88, 7
    s_cbranch_scc1 M_fchk
M_fgo:
    s_movk_i32 s88, 16384
    s_waitcnt vmcnt(3)
    v_lshlrev_b32 v160, 16, v44
    v_and_b32 v161, 0xffff0000, v44
    v_lshlrev_b32 v162, 16, v45
    v_and_b32 v163, 0xffff0000, v45
    v_lshlrev_b32 v164, 16, v46
    v_and_b32 v165, 0xffff0000, v46
    v_lshlrev_b32 v166, 16, v47
    v_and_b32 v167, 0xffff0000, v47
    v_lshlrev_b32 v136, 16, v184
    v_and_b32 v137, 0xffff0000, v184
    v_lshlrev_b32 v138, 16, v185
    v_and_b32 v139, 0xffff0000, v185
    v_lshlrev_b32 v140, 16, v186
    v_and_b32 v141, 0xffff0000, v186
    v_lshlrev_b32 v142, 16, v187
    v_and_b32 v143, 0xffff0000, v187
    v_lshlrev_b32 v144, 16, v188
    v_and_b32 v145, 0xffff0000, v188
    v_lshlrev_b32 v146, 16, v189
    v_and_b32 v147, 0xffff0000, v189
    v_lshlrev_b32 v148, 16, v190
    v_and_b32 v149, 0xffff0000, v190
    v_lshlrev_b32 v150, 16, v191
    v_and_b32 v151, 0xffff0000, v191
    v_lshlrev_b32 v152, 16, v192
    v_and_b32 v153, 0xffff0000, v192
    v_lshlrev_b32 v154, 16, v193
    v_and_b32 v155, 0xffff0000, v193
    v_lshlrev_b32 v156, 16, v194
    v_and_b32 v157, 0xffff0000, v194
    v_lshlrev_b32 v158, 16, v195
    v_and_b32 v159, 0xffff0000, v195
    v_pk_add_f32 v[8:9], v[8:9], v[136:137]
    v_pk_add_f32 v[144:145], v[144:145], v[152:153]
    v_pk_add_f32 v[10:11], v[10:11], v[138:139]
    v_pk_add_f32 v[146:147], v[146:147], v[154:155]
    v_pk_add_f32 v[12:13], v[12:13], v[140:141]
    v_pk_add_f32 v[148:149], v[148:149], v[156:157]
    v_pk_add_f32 v[14:15], v[14:15], v[142:143]
    v_pk_add_f32 v[150:151], v[150:151], v[158:159]
    v_pk_add_f32 v[8:9], v[8:9], v[144:145]
    v_pk_add_f32 v[10:11], v[10:11], v[146:147]
    v_pk_add_f32 v[12:13], v[12:13], v[148:149]
    v_pk_add_f32 v[14:15], v[14:15], v[150:151]
    v_pk_fma_f32 v[8:9], v[8:9], v[76:77], v[160:161]
    v_pk_fma_f32 v[10:11], v[10:11], v[78:79], v[162:163]
    v_pk_fma_f32 v[12:13], v[12:13], v[84:85], v[164:165]
    v_pk_fma_f32 v[14:15], v[14:15], v[86:87], v[166:167]
    v_cvt_pk_bf16_f32 v44, v8, v9
    v_cvt_pk_bf16_f32 v45, v10, v11
    v_cvt_pk_bf16_f32 v46, v12, v13
    v_cvt_pk_bf16_f32 v47, v14, v15
    s_nop 0
    v_permlane16_swap_b32 v44, v46
    v_permlane16_swap_b32 v45, v47
    buffer_store_dwordx4 v[44:47], v246, s[40:43], 0 offen offset:0
    s_waitcnt vmcnt(3)
    v_lshlrev_b32 v160, 16, v52
    v_and_b32 v161, 0xffff0000, v52
    v_lshlrev_b32 v162, 16, v53
    v_and_b32 v163, 0xffff0000, v53
    v_lshlrev_b32 v164, 16, v54
    v_and_b32 v165, 0xffff0000, v54
    v_lshlrev_b32 v166, 16, v55
    v_and_b32 v167, 0xffff0000, v55
    v_lshlrev_b32 v136, 16, v196
    v_and_b32 v137, 0xffff0000, v196
    v_lshlrev_b32 v138, 16, v197
    v_and_b32 v139, 0xffff0000, v197
    v_lshlrev_b32 v140, 16, v198
    v_and_b32 v141, 0xffff0000, v198
    v_lshlrev_b32 v142, 16, v199
    v_and_b32 v143, 0xffff0000, v199
    v_lshlrev_b32 v144, 16, v200
    v_and_b32 v145, 0xffff0000, v200
    v_lshlrev_b32 v146, 16, v201
    v_and_b32 v147, 0xffff0000, v201
    v_lshlrev_b32 v148, 16, v202
    v_and_b32 v149, 0xffff0000, v202
    v_lshlrev_b32 v150, 16, v203
    v_and_b32 v151, 0xffff0000, v203
    v_lshlrev_b32 v152, 16, v204
    v_and_b32 v153, 0xffff0000, v204
    v_lshlrev_b32 v154, 16, v205
    v_and_b32 v155, 0xffff0000, v205
    v_lshlrev_b32 v156, 16, v206
    v_and_b32 v157, 0xffff0000, v206
    v_lshlrev_b32 v158, 16, v207
    v_and_b32 v159, 0xffff0000, v207
    v_pk_add_f32 v[16:17], v[16:17], v[136:137]
    v_pk_add_f32 v[144:145], v[144:145], v[152:153]
    v_pk_add_f32 v[18:19], v[18:19], v[138:139]
    v_pk_add_f32 v[146:147], v[146:147], v[154:155]
    v_pk_add_f32 v[20:21], v[20:21], v[140:141]
    v_pk_add_f32 v[148:149], v[148:149], v[156:157]
    v_pk_add_f32 v[22:23], v[22:23], v[142:143]
    v_pk_add_f32 v[150:151], v[150:151], v[158:159]
    v_pk_add_f32 v[16:17], v[16:17], v[144:145]
    v_pk_add_f32 v[18:19], v[18:19], v[146:147]
    v_pk_add_f32 v[20:21], v[20:21], v[148:149]
    v_pk_add_f32 v[22:23], v[22:23], v[150:151]
    v_pk_fma_f32 v[16:17], v[16:17], v[92:93], v[160:161]
    v_pk_fma_f32 v[18:19], v[18:19], v[94:95], v[162:163]
    v_pk_fma_f32 v[20:21], v[20:21], v[100:101], v[164:165]
    v_pk_fma_f32 v[22:23], v[22:23], v[102:103], v[166:167]
    v_cvt_pk_bf16_f32 v52, v16, v17
    v_cvt_pk_bf16_f32 v53, v18, v19
    v_cvt_pk_bf16_f32 v54, v20, v21
    v_cvt_pk_bf16_f32 v55, v22, v23
    s_nop 0
    v_permlane16_swap_b32 v52, v54
    v_permlane16_swap_b32 v53, v55
    buffer_store_dwordx4 v[52:55], v246, s[40:43], 0 offen offset:64
    s_waitcnt vmcnt(3)
    v_lshlrev_b32 v160, 16, v60
    v_and_b32 v161, 0xffff0000, v60
    v_lshlrev_b32 v162, 16, v61
    v_and_b32 v163, 0xffff0000, v61
    v_lshlrev_b32 v164, 16, v62
    v_and_b32 v165, 0xffff0000, v62
    v_lshlrev_b32 v166, 16, v63
    v_and_b32 v167, 0xffff0000, v63
    v_lshlrev_b32 v136, 16, v208
    v_and_b32 v137, 0xffff0000, v208
    v_lshlrev_b32 v138, 16, v209
    v_and_b32 v139, 0xffff0000, v209
    v_lshlrev_b32 v140, 16, v210
    v_and_b32 v141, 0xffff0000, v210
    v_lshlrev_b32 v142, 16, v211
    v_and_b32 v143, 0xffff0000, v211
    v_lshlrev_b32 v144, 16, v212
    v_and_b32 v145, 0xffff0000, v212
    v_lshlrev_b32 v146, 16, v213
    v_and_b32 v147, 0xffff0000, v213
    v_lshlrev_b32 v148, 16, v214
    v_and_b32 v149, 0xffff0000, v214
    v_lshlrev_b32 v150, 16, v215
    v_and_b32 v151, 0xffff0000, v215
    v_lshlrev_b32 v152, 16, v216
    v_and_b32 v153, 0xffff0000, v216
    v_lshlrev_b32 v154, 16, v217
    v_and_b32 v155, 0xffff0000, v217
    v_lshlrev_b32 v156, 16, v218
    v_and_b32 v157, 0xffff0000, v218
    v_lshlrev_b32 v158, 16, v219
    v_and_b32 v159, 0xffff0000, v219
    v_pk_add_f32 v[24:25], v[24:25], v[136:137]
    v_pk_add_f32 v[144:145], v[144:145], v[152:153]
    v_pk_add_f32 v[26:27], v[26:27], v[138:139]
    v_pk_add_f32 v[146:147], v[146:147], v[154:155]
    v_pk_add_f32 v[28:29], v[28:29], v[140:141]
    v_pk_add_f32 v[148:149], v[148:149], v[156:157]
    v_pk_add_f32 v[30:31], v[30:31], v[142:143]
    v_pk_add_f32 v[150:151], v[150:151], v[158:159]
    v_pk_add_f32 v[24:25], v[24:25], v[144:145]
    v_pk_add_f32 v[26:27], v[26:27], v[146:147]
    v_pk_add_f32 v[28:29], v[28:29], v[148:149]
    v_pk_add_f32 v[30:31], v[30:31], v[150:151]
    v_pk_fma_f32 v[24:25], v[24:25], v[108:109], v[160:161]
    v_pk_fma_f32 v[26:27], v[26:27], v[110:111], v[162:163]
    v_pk_fma_f32 v[28:29], v[28:29], v[116:117], v[164:165]
    v_pk_fma_f32 v[30:31], v[30:31], v[118:119], v[166:167]
    v_cvt_pk_bf16_f32 v60, v24, v25
    v_cvt_pk_bf16_f32 v61, v26, v27
    v_cvt_pk_bf16_f32 v62, v28, v29
    v_cvt_pk_bf16_f32 v63, v30, v31
    s_nop 0
    v_permlane16_swap_b32 v60, v62
    v_permlane16_swap_b32 v61, v63
    buffer_store_dwordx4 v[60:63], v246, s[40:43], 0 offen offset:256
    s_waitcnt vmcnt(3)
    v_lshlrev_b32 v160, 16, v68
    v_and_b32 v161, 0xffff0000, v68
    v_lshlrev_b32 v162, 16, v69
    v_and_b32 v163, 0xffff0000, v69
    v_lshlrev_b32 v164, 16, v70
    v_and_b32 v165, 0xffff0000, v70
    v_lshlrev_b32 v166, 16, v71
    v_and_b32 v167, 0xffff0000, v71
    v_lshlrev_b32 v136, 16, v220
    v_and_b32 v137, 0xffff0000, v220
    v_lshlrev_b32 v138, 16, v221
    v_and_b32 v139, 0xffff0000, v221
    v_lshlrev_b32 v140, 16, v222
    v_and_b32 v141, 0xffff0000, v222
    v_lshlrev_b32 v142, 16, v223
    v_and_b32 v143, 0xffff0000, v223
    v_lshlrev_b32 v144, 16, v224
    v_and_b32 v145, 0xffff0000, v224
    v_lshlrev_b32 v146, 16, v225
    v_and_b32 v147, 0xffff0000, v225
    v_lshlrev_b32 v148, 16, v226
    v_and_b32 v149, 0xffff0000, v226
    v_lshlrev_b32 v150, 16, v227
    v_and_b32 v151, 0xffff0000, v227
    v_lshlrev_b32 v152, 16, v228
    v_and_b32 v153, 0xffff0000, v228
    v_lshlrev_b32 v154, 16, v229
    v_and_b32 v155, 0xffff0000, v229
    v_lshlrev_b32 v156, 16, v230
    v_and_b32 v157, 0xffff0000, v230
    v_lshlrev_b32 v158, 16, v231
    v_and_b32 v159, 0xffff0000, v231
    v_pk_add_f32 v[32:33], v[32:33], v[136:137]
    v_pk_add_f32 v[144:145], v[144:145], v[152:153]
    v_pk_add_f32 v[34:35], v[34:35], v[138:139]
    v_pk_add_f32 v[146:147], v[146:147], v[154:155]
    v_pk_add_f32 v[36:37], v[36:37], v[140:141]
    v_pk_add_f32 v[148:149], v[148:149], v[156:157]
    v_pk_add_f32 v[38:39], v[38:39], v[142:143]
    v_pk_add_f32 v[150:151], v[150:151], v[158:159]
    v_pk_add_f32 v[32:33], v[32:33], v[144:145]
    v_pk_add_f32 v[34:35], v[34:35], v[146:147]
    v_pk_add_f32 v[36:37], v[36:37], v[148:149]
    v_pk_add_f32 v[38:39], v[38:39], v[150:151]
    v_pk_fma_f32 v[32:33], v[32:33], v[124:125], v[160:161]
    v_pk_fma_f32 v[34:35], v[34:35], v[126:127], v[162:163]
    v_pk_fma_f32 v[36:37], v[36:37], v[132:133], v[164:165]
    v_pk_fma_f32 v[38:39], v[38:39], v[134:135], v[166:167]
    v_cvt_pk_bf16_f32 v68, v32, v33
    v_cvt_pk_bf16_f32 v69, v34, v35
    v_cvt_pk_bf16_f32 v70, v36, v37
    v_cvt_pk_bf16_f32 v71, v38, v39
    s_nop 0
    v_permlane16_swap_b32 v68, v70
    v_permlane16_swap_b32 v69, v71
    buffer_store_dwordx4 v[68:71], v246, s[40:43], 0 offen offset:320
    s_branch M_fin
M_Pidle:
    s_nop 7
    s_barrier
    s_lshl_b32 s70, s48, 12
    s_lshl_b32 s64, s47, 3
    s_lshl_b32 s65, s45, 2
    s_add_u32 s64, s64, s65
    s_mul_i32 s64, s64, 114688
    s_add_u32 s64, s64, s70
    s_lshl_b32 s65, s46, 11
    s_add_u32 s64, s64, s65
    s_add_u32 s64, s64, 0x1500000
    v_lshl_add_u32 v198, v1, 4, s64
    v_mul_f32 v24, v8, v24
    v_exp_f32 v216, -v8
    v_mul_f32 v25, v9, v25
    v_exp_f32 v217, -v9
    v_mul_f32 v26, v10, v26
    v_exp_f32 v218, -v10
    v_mul_f32 v27, v11, v27
    v_exp_f32 v219, -v11
    v_mul_f32 v28, v12, v28
    v_exp_f32 v220, -v12
    v_mul_f32 v29, v13, v29
    v_exp_f32 v221, -v13
    v_mul_f32 v30, v14, v30
    v_exp_f32 v222, -v14
    v_mul_f32 v31, v15, v31
    v_exp_f32 v223, -v15
    v_fma_f32 v216, v216, s67, s67
    v_fma_f32 v217, v217, s67, s67
    v_rcp_f32 v216, v216
    v_fma_f32 v218, v218, s67, s67
    v_rcp_f32 v217, v217
    v_fma_f32 v219, v219, s67, s67
    v_rcp_f32 v218, v218
    v_fma_f32 v220, v220, s67, s67
    v_rcp_f32 v219, v219
    v_fma_f32 v221, v221, s67, s67
    v_rcp_f32 v220, v220
    v_fma_f32 v222, v222, s67, s67
    v_rcp_f32 v221, v221
    v_fma_f32 v223, v223, s67, s67
    v_rcp_f32 v222, v222
    v_rcp_f32 v223, v223
    v_mul_f32 v24, v24, v216
    v_mul_f32 v25, v25, v217
    v_mul_f32 v26, v26, v218
    v_mul_f32 v27, v27, v219
    v_mul_f32 v28, v28, v220
    v_mul_f32 v29, v29, v221
    v_mul_f32 v30, v30, v222
    v_mul_f32 v31, v31, v223
    v_cvt_pk_bf16_f32 v200, v24, v25
    v_cvt_pk_bf16_f32 v201, v26, v27
    v_cvt_pk_bf16_f32 v202, v28, v29
    v_cvt_pk_bf16_f32 v203, v30, v31
    buffer_store_dwordx4 v[200:203], v198, s[28:31], 0 offen offset:0 sc1
    v_mul_f32 v32, v16, v32
    v_exp_f32 v224, -v16
    v_mul_f32 v33, v17, v33
    v_exp_f32 v225, -v17
    v_mul_f32 v34, v18, v34
    v_exp_f32 v226, -v18
    v_mul_f32 v35, v19, v35
    v_exp_f32 v227, -v19
    v_mul_f32 v36, v20, v36
    v_exp_f32 v228, -v20
    v_mul_f32 v37, v21, v37
    v_exp_f32 v229, -v21
    v_mul_f32 v38, v22, v38
    v_exp_f32 v230, -v22
    v_mul_f32 v39, v23, v39
    v_exp_f32 v231, -v23
    v_fma_f32 v224, v224, s67, s67
    v_fma_f32 v225, v225, s67, s67
    v_rcp_f32 v224, v224
    v_fma_f32 v226, v226, s67, s67
    v_rcp_f32 v225, v225
    v_fma_f32 v227, v227, s67, s67
    v_rcp_f32 v226, v226
    v_fma_f32 v228, v228, s67, s67
    v_rcp_f32 v227, v227
    v_fma_f32 v229, v229, s67, s67
    v_rcp_f32 v228, v228
    v_fma_f32 v230, v230, s67, s67
    v_rcp_f32 v229, v229
    v_fma_f32 v231, v231, s67, s67
    v_rcp_f32 v230, v230
    v_rcp_f32 v231, v231
    v_mul_f32 v32, v32, v224
    v_mul_f32 v33, v33, v225
    v_mul_f32 v34, v34, v226
    v_mul_f32 v35, v35, v227
    v_mul_f32 v36, v36, v228
    v_mul_f32 v37, v37, v229
    v_mul_f32 v38, v38, v230
    v_mul_f32 v39, v39, v231
    v_cvt_pk_bf16_f32 v204, v32, v33
    v_cvt_pk_bf16_f32 v205, v34, v35
    v_cvt_pk_bf16_f32 v206, v36, v37
    v_cvt_pk_bf16_f32 v207, v38, v39
    buffer_store_dwordx4 v[204:207], v198, s[28:31], 0 offen offset:1024 sc1
    v_add_u32 v198, 114688, v198
    v_mul_f32 v56, v40, v56
    v_exp_f32 v216, -v40
    v_mul_f32 v57, v41, v57
    v_exp_f32 v217, -v41
    v_mul_f32 v58, v42, v58
    v_exp_f32 v218, -v42
    v_mul_f32 v59, v43, v59
    v_exp_f32 v219, -v43
    v_mul_f32 v60, v44, v60
    v_exp_f32 v220, -v44
    v_mul_f32 v61, v45, v61
    v_exp_f32 v221, -v45
    v_mul_f32 v62, v46, v62
    v_exp_f32 v222, -v46
    v_mul_f32 v63, v47, v63
    v_exp_f32 v223, -v47
    v_fma_f32 v216, v216, s67, s67
    v_fma_f32 v217, v217, s67, s67
    v_rcp_f32 v216, v216
    v_fma_f32 v218, v218, s67, s67
    v_rcp_f32 v217, v217
    v_fma_f32 v219, v219, s67, s67
    v_rcp_f32 v218, v218
    v_fma_f32 v220, v220, s67, s67
    v_rcp_f32 v219, v219
    v_fma_f32 v221, v221, s67, s67
    v_rcp_f32 v220, v220
    v_fma_f32 v222, v222, s67, s67
    v_rcp_f32 v221, v221
    v_fma_f32 v223, v223, s67, s67
    v_rcp_f32 v222, v222
    v_rcp_f32 v223, v223
    v_mul_f32 v56, v56, v216
    v_mul_f32 v57, v57, v217
    v_mul_f32 v58, v58, v218
    v_mul_f32 v59, v59, v219
    v_mul_f32 v60, v60, v220
    v_mul_f32 v61, v61, v221
    v_mul_f32 v62, v62, v222
    v_mul_f32 v63, v63, v223
    v_cvt_pk_bf16_f32 v208, v56, v57
    v_cvt_pk_bf16_f32 v209, v58, v59
    v_cvt_pk_bf16_f32 v210, v60, v61
    v_cvt_pk_bf16_f32 v211, v62, v63
    buffer_store_dwordx4 v[208:211], v198, s[28:31], 0 offen offset:0 sc1
    v_mul_f32 v64, v48, v64
    v_exp_f32 v224, -v48
    v_mul_f32 v65, v49, v65
    v_exp_f32 v225, -v49
    v_mul_f32 v66, v50, v66
    v_exp_f32 v226, -v50
    v_mul_f32 v67, v51, v67
    v_exp_f32 v227, -v51
    v_mul_f32 v68, v52, v68
    v_exp_f32 v228, -v52
    v_mul_f32 v69, v53, v69
    v_exp_f32 v229, -v53
    v_mul_f32 v70, v54, v70
    v_exp_f32 v230, -v54
    v_mul_f32 v71, v55, v71
    v_exp_f32 v231, -v55
    v_fma_f32 v224, v224, s67, s67
    v_fma_f32 v225, v225, s67, s67
    v_rcp_f32 v224, v224
    v_fma_f32 v226, v226, s67, s67
    v_rcp_f32 v225, v225
    v_fma_f32 v227, v227, s67, s67
    v_rcp_f32 v226, v226
    v_fma_f32 v228, v228, s67, s67
    v_rcp_f32 v227, v227
    v_fma_f32 v229, v229, s67, s67
    v_rcp_f32 v228, v228
    v_fma_f32 v230, v230, s67, s67
    v_rcp_f32 v229, v229
    v_fma_f32 v231, v231, s67, s67
    v_rcp_f32 v230, v230
    v_rcp_f32 v231, v231
    v_mul_f32 v64, v64, v224
    v_mul_f32 v65, v65, v225
    v_mul_f32 v66, v66, v226
    v_mul_f32 v67, v67, v227
    v_mul_f32 v68, v68, v228
    v_mul_f32 v69, v69, v229
    v_mul_f32 v70, v70, v230
    v_mul_f32 v71, v71, v231
    v_cvt_pk_bf16_f32 v212, v64, v65
    v_cvt_pk_bf16_f32 v213, v66, v67
    v_cvt_pk_bf16_f32 v214, v68, v69
    v_cvt_pk_bf16_f32 v215, v70, v71
    buffer_store_dwordx4 v[212:215], v198, s[28:31], 0 offen offset:1024 sc1
    v_add_u32 v198, 114688, v198
    v_mul_f32 v88, v72, v88
    v_exp_f32 v216, -v72
    v_mul_f32 v89, v73, v89
    v_exp_f32 v217, -v73
    v_mul_f32 v90, v74, v90
    v_exp_f32 v218, -v74
    v_mul_f32 v91, v75, v91
    v_exp_f32 v219, -v75
    v_mul_f32 v92, v76, v92
    v_exp_f32 v220, -v76
    v_mul_f32 v93, v77, v93
    v_exp_f32 v221, -v77
    v_mul_f32 v94, v78, v94
    v_exp_f32 v222, -v78
    v_mul_f32 v95, v79, v95
    v_exp_f32 v223, -v79
    v_fma_f32 v216, v216, s67, s67
    v_fma_f32 v217, v217, s67, s67
    v_rcp_f32 v216, v216
    v_fma_f32 v218, v218, s67, s67
    v_rcp_f32 v217, v217
    v_fma_f32 v219, v219, s67, s67
    v_rcp_f32 v218, v218
    v_fma_f32 v220, v220, s67, s67
    v_rcp_f32 v219, v219
    v_fma_f32 v221, v221, s67, s67
    v_rcp_f32 v220, v220
    v_fma_f32 v222, v222, s67, s67
    v_rcp_f32 v221, v221
    v_fma_f32 v223, v223, s67, s67
    v_rcp_f32 v222, v222
    v_rcp_f32 v223, v223
    v_mul_f32 v88, v88, v216
    v_mul_f32 v89, v89, v217
    v_mul_f32 v90, v90, v218
    v_mul_f32 v91, v91, v219
    v_mul_f32 v92, v92, v220
    v_mul_f32 v93, v93, v221
    v_mul_f32 v94, v94, v222
    v_mul_f32 v95, v95, v223
    v_cvt_pk_bf16_f32 v200, v88, v89
    v_cvt_pk_bf16_f32 v201, v90, v91
    v_cvt_pk_bf16_f32 v202, v92, v93
    v_cvt_pk_bf16_f32 v203, v94, v95
    buffer_store_dwordx4 v[200:203], v198, s[28:31], 0 offen offset:0 sc1
    v_mul_f32 v96, v80, v96
    v_exp_f32 v224, -v80
    v_mul_f32 v97, v81, v97
    v_exp_f32 v225, -v81
    v_mul_f32 v98, v82, v98
    v_exp_f32 v226, -v82
    v_mul_f32 v99, v83, v99
    v_exp_f32 v227, -v83
    v_mul_f32 v100, v84, v100
    v_exp_f32 v228, -v84
    v_mul_f32 v101, v85, v101
    v_exp_f32 v229, -v85
    v_mul_f32 v102, v86, v102
    v_exp_f32 v230, -v86
    v_mul_f32 v103, v87, v103
    v_exp_f32 v231, -v87
    v_fma_f32 v224, v224, s67, s67
    v_fma_f32 v225, v225, s67, s67
    v_rcp_f32 v224, v224
    v_fma_f32 v226, v226, s67, s67
    v_rcp_f32 v225, v225
    v_fma_f32 v227, v227, s67, s67
    v_rcp_f32 v226, v226
    v_fma_f32 v228, v228, s67, s67
    v_rcp_f32 v227, v227
    v_fma_f32 v229, v229, s67, s67
    v_rcp_f32 v228, v228
    v_fma_f32 v230, v230, s67, s67
    v_rcp_f32 v229, v229
    v_fma_f32 v231, v231, s67, s67
    v_rcp_f32 v230, v230
    v_rcp_f32 v231, v231
    v_mul_f32 v96, v96, v224
    v_mul_f32 v97, v97, v225
    v_mul_f32 v98, v98, v226
    v_mul_f32 v99, v99, v227
    v_mul_f32 v100, v100, v228
    v_mul_f32 v101, v101, v229
    v_mul_f32 v102, v102, v230
    v_mul_f32 v103, v103, v231
    v_cvt_pk_bf16_f32 v204, v96, v97
    v_cvt_pk_bf16_f32 v205, v98, v99
    v_cvt_pk_bf16_f32 v206, v100, v101
    v_cvt_pk_bf16_f32 v207, v102, v103
    buffer_store_dwordx4 v[204:207], v198, s[28:31], 0 offen offset:1024 sc1
    v_add_u32 v198, 114688, v198
    v_mul_f32 v120, v104, v120
    v_exp_f32 v216, -v104
    v_mul_f32 v121, v105, v121
    v_exp_f32 v217, -v105
    v_mul_f32 v122, v106, v122
    v_exp_f32 v218, -v106
    v_mul_f32 v123, v107, v123
    v_exp_f32 v219, -v107
    v_mul_f32 v124, v108, v124
    v_exp_f32 v220, -v108
    v_mul_f32 v125, v109, v125
    v_exp_f32 v221, -v109
    v_mul_f32 v126, v110, v126
    v_exp_f32 v222, -v110
    v_mul_f32 v127, v111, v127
    v_exp_f32 v223, -v111
    v_fma_f32 v216, v216, s67, s67
    v_fma_f32 v217, v217, s67, s67
    v_rcp_f32 v216, v216
    v_fma_f32 v218, v218, s67, s67
    v_rcp_f32 v217, v217
    v_fma_f32 v219, v219, s67, s67
    v_rcp_f32 v218, v218
    v_fma_f32 v220, v220, s67, s67
    v_rcp_f32 v219, v219
    v_fma_f32 v221, v221, s67, s67
    v_rcp_f32 v220, v220
    v_fma_f32 v222, v222, s67, s67
    v_rcp_f32 v221, v221
    v_fma_f32 v223, v223, s67, s67
    v_rcp_f32 v222, v222
    v_rcp_f32 v223, v223
    v_mul_f32 v120, v120, v216
    v_mul_f32 v121, v121, v217
    v_mul_f32 v122, v122, v218
    v_mul_f32 v123, v123, v219
    v_mul_f32 v124, v124, v220
    v_mul_f32 v125, v125, v221
    v_mul_f32 v126, v126, v222
    v_mul_f32 v127, v127, v223
    v_cvt_pk_bf16_f32 v208, v120, v121
    v_cvt_pk_bf16_f32 v209, v122, v123
    v_cvt_pk_bf16_f32 v210, v124, v125
    v_cvt_pk_bf16_f32 v211, v126, v127
    buffer_store_dwordx4 v[208:211], v198, s[28:31], 0 offen offset:0 sc1
    v_mul_f32 v128, v112, v128
    v_exp_f32 v224, -v112
    v_mul_f32 v129, v113, v129
    v_exp_f32 v225, -v113
    v_mul_f32 v130, v114, v130
    v_exp_f32 v226, -v114
    v_mul_f32 v131, v115, v131
    v_exp_f32 v227, -v115
    v_mul_f32 v132, v116, v132
    v_exp_f32 v228, -v116
    v_mul_f32 v133, v117, v133
    v_exp_f32 v229, -v117
    v_mul_f32 v134, v118, v134
    v_exp_f32 v230, -v118
    v_mul_f32 v135, v119, v135
    v_exp_f32 v231, -v119
    v_fma_f32 v224, v224, s67, s67
    v_fma_f32 v225, v225, s67, s67
    v_rcp_f32 v224, v224
    v_fma_f32 v226, v226, s67, s67
    v_rcp_f32 v225, v225
    v_fma_f32 v227, v227, s67, s67
    v_rcp_f32 v226, v226
    v_fma_f32 v228, v228, s67, s67
    v_rcp_f32 v227, v227
    v_fma_f32 v229, v229, s67, s67
    v_rcp_f32 v228, v228
    v_fma_f32 v230, v230, s67, s67
    v_rcp_f32 v229, v229
    v_fma_f32 v231, v231, s67, s67
    v_rcp_f32 v230, v230
    v_rcp_f32 v231, v231
    v_mul_f32 v128, v128, v224
    v_mul_f32 v129, v129, v225
    v_mul_f32 v130, v130, v226
    v_mul_f32 v131, v131, v227
    v_mul_f32 v132, v132, v228
    v_mul_f32 v133, v133, v229
    v_mul_f32 v134, v134, v230
    v_mul_f32 v135, v135, v231
    v_cvt_pk_bf16_f32 v212, v128, v129
    v_cvt_pk_bf16_f32 v213, v130, v131
    v_cvt_pk_bf16_f32 v214, v132, v133
    v_cvt_pk_bf16_f32 v215, v134, v135
    buffer_store_dwordx4 v[212:215], v198, s[28:31], 0 offen offset:1024 sc1
    s_lshl_b32 s65, s44, 1
    s_xor_b32 s65, s65, s49
    s_lshl_b32 s64, s47, 3
    s_add_u32 s64, s64, s65
    s_mul_i32 s64, s64, 114688
    s_add_u32 s64, s64, 0x1500000
    v_lshl_add_u32 v192, v1, 4, s64
    s_lshl_b32 s65, s44, 1
    s_or_b32 s65, s65, 1
    s_xor_b32 s65, s65, s49
    s_lshl_b32 s64, s47, 3
    s_add_u32 s64, s64, s65
    s_mul_i32 s64, s64, 114688
    s_add_u32 s64, s64, 0x14ff800
    v_lshl_add_u32 v193, v1, 4, s64
    s_lshl_b32 s65, s51, 9
    v_lshrrev_b32 v3, 4, v1
    s_lshl_b32 s64, s44, 4
    v_add_u32 v2, s64, v3
    s_movk_i32 s64, 2048
    v_mul_u32_u24 v2, s64, v2
    v_add_u32 v2, s65, v2
    v_lshlrev_b32 v3, 1, v3
    v_and_b32 v4, 15, v1
    v_xor_b32 v3, v3, v4
    v_lshl_add_u32 v194, v3, 4, v2
    v_add_u32 v196, 14336, v194
    v_xor_b32 v3, 8, v3
    v_lshl_add_u32 v195, v3, 4, v2
    v_add_u32 v195, 7168, v195
    v_add_u32 v197, 14336, v195
    s_lshl_b32 s64, s47, 9
    s_lshl_b32 s65, s49, 7
    s_add_u32 s64, s64, s65
    s_lshl_b32 s65, s51, 4
    s_add_u32 s64, s64, s65
    s_lshl_b32 s65, s44, 2
    s_add_u32 s64, s64, s65
    s_add_u32 s64, s64, 0x50000
    v_mov_b32 v2, s0
    s_waitcnt vmcnt(0)
    s_mov_b64 exec, 1
    buffer_store_dword v2, v234, s[28:31], s64 offen sc1
    s_mov_b64 exec, -1
    s_barrier
    s_lshl_b32 s68, s47, 2
    s_add_u32 s68, s68, s49
    s_lshl_b32 s68, s68, 7
    s_add_u32 s68, s68, 0x50000
    v_min_u32 v234, 60, v234
    buffer_load_dword v245, v234, s[28:31], s68 offen sc1
    s_waitcnt vmcnt(0)
    s_branch M_Pjoin
M_Q:
    v_and_b32 v2, 7, v1
    s_lshl_b32 s64, s44, 3
    v_add_u32 v2, s64, v2
    v_lshrrev_b32 v3, 3, v1
    v_lshlrev_b32 v14, 5, v3
    v_add_u32 v14, 149504, v14
    s_lshl_b32 s64, s48, 7
    v_lshl_add_u32 v4, v3, 4, s64
    s_lshl_b32 s70, s47, 7
    v_add_u32 v12, s70, v2
    v_lshl_add_u32 v8, v12, 11, v4
    s_max_u32 s70, s70, 16
    s_sub_u32 s70, s70, 16
    v_and_b32 v5, 15, v2
    v_add_u32 v13, s70, v5
    v_lshl_add_u32 v9, v13, 11, v4
    v_and_b32 v4, 7, v2
    v_lshlrev_b32 v4, 3, v4
    v_add_u32 v4, 0x10000, v4
    v_lshrrev_b32 v12, 3, v12
    v_lshl_add_u32 v12, v12, 7, v4
    v_lshrrev_b32 v13, 3, v13
    v_lshl_add_u32 v13, v13, 7, v4
    v_lshlrev_b32 v3, 8, v3
    v_lshl_add_u32 v3, v5, 4, v3
    s_mul_i32 s64, s47, 294912
    s_lshl_b32 s65, s48, 11
    s_add_u32 s64, s64, s65
    s_add_u32 s64, s64, 0x100000
    s_cmp_ge_u32 s44, 2
    s_cselect_b32 s65, 0x80000000, s64
    v_add_u32 v11, s65, v3
    s_cselect_b32 s65, 32768, 0
    s_add_u32 s64, s64, s65
    s_add_u32 s64, s64, 32768
    v_add_u32 v10, s64, v3
    v_mov_b32 v19, v3
    s_lshr_b32 s64, s44, 1
    s_lshl_b32 s64, s64, 11
    s_add_u32 s64, s64, 2048
    v_add_u32 v15, s64, v3
    s_mov_b32 s53, 0
    s_lshl_b32 s72, s44, 12
    s_add_u32 s72, s72, 2048
    s_lshl_b32 s73, s44, 9
    s_mul_i32 s74, s44, 6144
    s_add_u32 s74, s74, 18432
    s_add_u32 s75, s74, 4096
    s_bfe_u32 s66, s2, 0x30003
    s_lshr_b32 s55, s2, 6
    s_add_u32 s66, s66, s55
    s_and_b32 s66, s66, 3
    s_mov_b32 s58, 0x76453210
    s_mov_b32 s59, 0xfecdba89
    s_cmp_eq_u32 s66, 1
    s_cselect_b32 s58, 0x75643120, s58
    s_cselect_b32 s59, 0xfdecb9a8, s59
    s_cmp_eq_u32 s66, 2
    s_cselect_b32 s58, 0x67542310, s58
    s_cselect_b32 s59, 0xefdcab98, s59
    s_cmp_eq_u32 s66, 3
    s_cselect_b32 s58, 0x86534210, s58
    s_cselect_b32 s59, 0xfedbca97, s59
    s_and_b32 s66, s48, 15
    s_lshl_b32 s55, s66, 2
    s_lshr_b64 s[56:57], s[58:59], s55
    s_and_b32 s55, s56, 15
    s_lshl_b32 s55, s55, 2
    s_lshl_b64 s[56:57], 15, s55
    s_andn2_b64 s[58:59], s[58:59], s[56:57]
    s_or_b32 s58, s58, s66
    s_lshl_b32 s65, s48, 7
    s_mul_i32 s64, s44, 98304
    s_add_u32 s65, s65, s64
    s_movk_i32 s64, 6144
    v_add_u32 v2, 0, v1
    v_mul_u32_u24 v3, 0xab, v2
    v_lshrrev_b32 v3, 12, v3
    v_mul_u32_u24 v4, 24, v3
    v_sub_u32 v2, v2, v4
    v_and_b32 v4, 2, v3
    v_lshrrev_b32 v5, 3, v3
    v_lshl_or_b32 v4, v5, 2, v4
    v_xor_b32 v2, v2, v4
    v_mul_u32_u24 v3, s64, v3
    v_lshrrev_b32 v4, 3, v2
    v_lshl_add_u32 v3, v4, 11, v3
    v_and_b32 v2, 7, v2
    v_lshl_add_u32 v3, v2, 4, v3
    v_add_u32 v187, s65, v3
    v_add_u32 v2, 64, v1
    v_mul_u32_u24 v3, 0xab, v2
    v_lshrrev_b32 v3, 12, v3
    v_mul_u32_u24 v4, 24, v3
    v_sub_u32 v2, v2, v4
    v_and_b32 v4, 2, v3
    v_lshrrev_b32 v5, 3, v3
    v_lshl_or_b32 v4, v5, 2, v4
    v_xor_b32 v2, v2, v4
    v_mul_u32_u24 v3, s64, v3
    v_lshrrev_b32 v4, 3, v2
    v_lshl_add_u32 v3, v4, 11, v3
    v_and_b32 v2, 7, v2
    v_lshl_add_u32 v3, v2, 4, v3
    v_subrev_u32 v3, 1024, v3
    v_add_u32 v188, s65, v3
    v_add_u32 v2, 128, v1
    v_mul_u32_u24 v3, 0xab, v2
    v_lshrrev_b32 v3, 12, v3
    v_mul_u32_u24 v4, 24, v3
    v_sub_u32 v2, v2, v4
    v_and_b32 v4, 2, v3
    v_lshrrev_b32 v5, 3, v3
    v_lshl_or_b32 v4, v5, 2, v4
    v_xor_b32 v2, v2, v4
    v_mul_u32_u24 v3, s64, v3
    v_lshrrev_b32 v4, 3, v2
    v_lshl_add_u32 v3, v4, 11, v3
    v_and_b32 v2, 7, v2
    v_lshl_add_u32 v3, v2, 4, v3
    v_subrev_u32 v3, 2048, v3
    v_add_u32 v189, s65, v3
    v_add_u32 v2, 192, v1
    v_mul_u32_u24 v3, 0xab, v2
    v_lshrrev_b32 v3, 12, v3
    v_mul_u32_u24 v4, 24, v3
    v_sub_u32 v2, v2, v4
    v_and_b32 v4, 2, v3
    v_lshrrev_b32 v5, 3, v3
    v_lshl_or_b32 v4, v5, 2, v4
    v_xor_b32 v2, v2, v4
    v_mul_u32_u24 v3, s64, v3
    v_lshrrev_b32 v4, 3, v2
    v_lshl_add_u32 v3, v4, 11, v3
    v_and_b32 v2, 7, v2
    v_lshl_add_u32 v3, v2, 4, v3
    v_subrev_u32 v3, 3072, v3
    v_add_u32 v190, s65, v3
    v_add_u32 v2, 256, v1
    v_mul_u32_u24 v3, 0xab, v2
    v_lshrrev_b32 v3, 12, v3
    v_mul_u32_u24 v4, 24, v3
    v_sub_u32 v2, v2, v4
    v_and_b32 v4, 2, v3
    v_lshrrev_b32 v5, 3, v3
    v_lshl_or_b32 v4, v5, 2, v4
    v_xor_b32 v2, v2, v4
    v_mul_u32_u24 v3, s64, v3
    v_lshrrev_b32 v4, 3, v2
    v_lshl_add_u32 v3, v4, 11, v3
    v_and_b32 v2, 7, v2
    v_lshl_add_u32 v3, v2, 4, v3
    v_add_u32 v191, s65, v3
    v_add_u32 v2, 320, v1
    v_mul_u32_u24 v3, 0xab, v2
    v_lshrrev_b32 v3, 12, v3
    v_mul_u32_u24 v4, 24, v3
    v_sub_u32 v2, v2, v4
    v_and_b32 v4, 2, v3
    v_lshrrev_b32 v5, 3, v3
    v_lshl_or_b32 v4, v5, 2, v4
    v_xor_b32 v2, v2, v4
    v_mul_u32_u24 v3, s64, v3
    v_lshrrev_b32 v4, 3, v2
    v_lshl_add_u32 v3, v4, 11, v3
    v_and_b32 v2, 7, v2
    v_lshl_add_u32 v3, v2, 4, v3
    v_subrev_u32 v3, 1024, v3
    v_add_u32 v192, s65, v3
    s_mul_i32 s64, s47, 294912
    s_add_u32 s64, s64, 0x100000
    s_add_u32 s65, s64, s73
    v_lshl_add_u32 v186, v1, 4, s65
    s_mul_i32 s65, s44, 65536
    s_add_u32 s64, s64, s65
    s_add_u32 s64, s64, 32768
    v_lshl_add_u32 v184, v1, 4, s64
    v_add_u32 v185, 30720, v184
    s_mov_b32 s32, s6
    s_mov_b32 s33, s7
    s_mov_b32 s34, 0x600000
    s_mov_b32 s35, 0x20000
    s_mov_b32 s28, s26
    s_mov_b32 s29, s27
    s_mov_b32 s30, 0x3100000
    s_mov_b32 s31, 0x20000
    s_lshr_b32 s45, s44, 1
    s_and_b32 s46, s44, 1
    s_lshr_b32 s49, s48, 2
    s_and_b32 s51, s48, 3
    s_cmp_ge_u32 s2, 192
    s_cselect_b32 s69, 0x80000000, 0
    s_mov_b32 s67, 0x40053526
    v_lshlrev_b32 v234, 2, v1
    v_lshrrev_b32 v3, 3, v1
    s_lshl_b32 s64, s44, 4
    v_add_lshl_u32 v2, v3, s64, 11
    s_lshl_b32 s64, s48, 7
    v_add_u32 v2, s64, v2
    v_and_b32 v3, 6, v3
    v_and_b32 v4, 7, v1
    v_xor_b32 v3, v3, v4
    v_lshl_add_u32 v193, v3, 4, v2
    v_add_u32 v194, 15360, v193
    s_lshl_b32 s64, s47, 3
    s_lshl_b32 s65, s44, 1
    s_add_u32 s64, s64, s65
    s_mul_i32 s64, s64, 32768
    s_add_u32 s64, s64, 0x1000000
    v_lshl_add_u32 v206, v1, 4, s64
    v_add_u32 v207, 30720, v206
    s_lshl_b32 s65, s48, 8
    v_lshrrev_b32 v3, 4, v1
    s_lshl_b32 s64, s44, 4
    v_add_u32 v2, s64, v3
    s_movk_i32 s64, 7168
    v_mul_u32_u24 v2, s64, v2
    v_add_u32 v2, s65, v2
    v_lshlrev_b32 v3, 1, v3
    v_and_b32 v4, 15, v1
    v_xor_b32 v3, v3, v4
    v_lshl_add_u32 v208, v3, 4, v2
    v_add_u32 v210, 55296, v208
    v_xor_b32 v3, 8, v3
    v_lshl_add_u32 v209, v3, 4, v2
    v_add_u32 v209, 27648, v209
    v_add_u32 v211, 55296, v209
    s_lshr_b32 s65, s48, 2
    s_sub_u32 s65, s48, s65
    s_add_u32 s65, s65, 16
    s_lshl_b32 s65, s65, 8
    s_or_b32 s65, s65, s69
    v_lshrrev_b32 v3, 4, v1
    s_lshl_b32 s64, s44, 4
    v_add_u32 v2, s64, v3
    s_movk_i32 s64, 7168
    v_mul_u32_u24 v2, s64, v2
    v_add_u32 v2, s65, v2
    v_lshlrev_b32 v3, 1, v3
    v_and_b32 v4, 15, v1
    v_xor_b32 v3, v3, v4
    v_lshl_add_u32 v212, v3, 4, v2
    v_add_u32 v214, 55296, v212
    v_xor_b32 v3, 8, v3
    v_lshl_add_u32 v213, v3, 4, v2
    v_add_u32 v213, 27648, v213
    v_add_u32 v215, 55296, v213
    s_lshl_b32 s65, s44, 1
    s_xor_b32 s65, s65, s49
    s_lshl_b32 s64, s47, 3
    s_add_u32 s64, s64, s65
    s_mul_i32 s64, s64, 114688
    s_add_u32 s64, s64, 0x1500000
    v_lshl_add_u32 v246, v1, 4, s64
    s_lshl_b32 s65, s44, 1
    s_or_b32 s65, s65, 1
    s_xor_b32 s65, s65, s49
    s_lshl_b32 s64, s47, 3
    s_add_u32 s64, s64, s65
    s_mul_i32 s64, s64, 114688
    s_add_u32 s64, s64, 0x14ff800
    v_lshl_add_u32 v247, v1, 4, s64
    s_lshl_b32 s65, s51, 9
    v_lshrrev_b32 v3, 4, v1
    s_lshl_b32 s64, s44, 4
    v_add_u32 v2, s64, v3
    s_movk_i32 s64, 2048
    v_mul_u32_u24 v2, s64, v2
    v_add_u32 v2, s65, v2
    v_lshlrev_b32 v3, 1, v3
    v_and_b32 v4, 15, v1
    v_xor_b32 v3, v3, v4
    v_lshl_add_u32 v248, v3, 4, v2
    v_add_u32 v250, 14336, v248
    v_xor_b32 v3, 8, v3
    v_lshl_add_u32 v249, v3, 4, v2
    v_add_u32 v249, 7168, v249
    v_add_u32 v251, 14336, v249
    s_lshl_b32 s64, s44, 12
    v_lshl_add_u32 v233, v1, 4, s64
    v_lshrrev_b32 v2, 2, v1
    v_lshlrev_b32 v4, 7, v2
    v_and_b32 v5, 3, v1
    v_lshl_add_u32 v4, v5, 3, v4
    v_add_u32 v4, 16384, v4
    v_bfe_u32 v2, v1, 3, 2
    v_xor_b32 v3, 0, v2
    v_lshl_add_u32 v239, v3, 5, v4
    v_xor_b32 v3, 1, v2
    v_lshl_add_u32 v240, v3, 5, v4
    v_xor_b32 v3, 2, v2
    v_lshl_add_u32 v241, v3, 5, v4
    v_xor_b32 v3, 3, v2
    v_lshl_add_u32 v242, v3, 5, v4
    s_mov_b32 s52, 49152
    v_add_u32 v232, s52, v233
    v_add_u32 v235, s52, v239
    v_add_u32 v236, s52, v240
    v_add_u32 v237, s52, v241
    v_add_u32 v238, s52, v242
    s_lshl_b32 s70, s47, 2
    s_add_u32 s70, s70, s44
    s_lshl_b32 s64, s70, 16
    s_lshl_b32 s65, s48, 7
    s_add_u32 s64, s64, s65
    v_and_b32 v2, 15, v1
    v_lshl_add_u32 v2, v2, 11, s64
    v_bfe_u32 v3, v1, 4, 1
    v_lshl_add_u32 v2, v3, 5, v2
    v_lshrrev_b32 v3, 5, v1
    v_lshl_add_u32 v196, v3, 4, v2
    s_mul_i32 s64, s70, 65536
    s_lshl_b32 s65, s48, 11
    s_add_u32 s64, s64, s65
    v_lshl_add_u32 v197, v1, 4, s64
    s_lshl_b32 s64, s70, 12
    s_add_u32 s64, s64, 0x60000
    v_lshl_add_u32 v198, v1, 3, s64
    v_lshrrev_b32 v2, 5, v1
    s_mov_b32 s64, 0x3ff00
    v_mad_u32_u24 v195, v2, s64, v198
    s_lshl_b32 s64, s48, 8
    v_add_u32 v195, s64, v195
    v_and_b32 v2, 48, v1
    v_add_u32 v199, 149504, v2
    v_mov_b32 v72, 148480
    v_mov_b32 v73, 0
    ds_write_b32 v72, v73 offset:0
    ds_write_b32 v72, v73 offset:4
    ds_write_b32 v72, v73 offset:8
    ds_write_b32 v72, v73 offset:12
    ds_write_b32 v72, v73 offset:16
    ds_write_b32 v72, v73 offset:20
    v_and_b32 v16, 255, v0
    s_lshr_b32 s76, s2, 6
    s_lshl_b32 s77, s76, 8
    s_and_b32 s78, s2, 63
    s_lshl_b32 s79, s78, 7
    s_add_u32 s79, s79, 4096
    s_lshl_b32 s76, s76, 15
    s_lshl_b32 s78, s78, 9
    s_add_u32 s76, s76, s78
    s_add_u32 s76, s76, 0xa0000
    v_lshrrev_b32 v72, 3, v16
    v_add_u32 v72, s77, v72
    v_lshlrev_b32 v18, 1, v72
    s_movk_i32 s64, 12288
    v_mul_lo_u32 v72, s64, v72
    v_and_b32 v17, 7, v0
    v_lshl_add_u32 v72, v17, 4, v72
    v_add_u32 v17, s79, v72
    s_lshl_b32 s64, s2, 8
    v_add_lshl_u32 v243, v16, s64, 5
    s_mov_b32 s36, s20
    s_mov_b32 s37, s21
    s_mov_b32 s38, 0xc00000
    s_mov_b32 s39, 0x20000
    s_lshl_b32 s64, s2, 2
    s_add_u32 s64, s64, s44
    s_mul_i32 s64, s64, 7168
    s_add_u32 s64, s64, 4096
    s_add_u32 s10, s12, s64
    s_addc_u32 s11, s13, 0
    s_add_u32 s24, s14, s64
    s_addc_u32 s25, s15, 0
    s_waitcnt lgkmcnt(0)
    s_add_u32 s0, s0, 1
    s_barrier
    s_waitcnt vmcnt(0)
    v_lshlrev_b32 v120, 16, v104
    v_and_b32 v121, 0xffff0000, v104
    v_lshlrev_b32 v122, 16, v105
    v_and_b32 v123, 0xffff0000, v105
    v_lshlrev_b32 v124, 16, v106
    v_and_b32 v125, 0xffff0000, v106
    v_lshlrev_b32 v126, 16, v107
    v_and_b32 v127, 0xffff0000, v107
    v_lshlrev_b32 v128, 16, v108
    v_and_b32 v129, 0xffff0000, v108
    v_lshlrev_b32 v130, 16, v109
    v_and_b32 v131, 0xffff0000, v109
    v_lshlrev_b32 v132, 16, v110
    v_and_b32 v133, 0xffff0000, v110
    v_lshlrev_b32 v134, 16, v111
    v_and_b32 v135, 0xffff0000, v111
    v_lshlrev_b32 v136, 16, v112
    v_and_b32 v137, 0xffff0000, v112
    v_lshlrev_b32 v138, 16, v113
    v_and_b32 v139, 0xffff0000, v113
    v_lshlrev_b32 v140, 16, v114
    v_and_b32 v141, 0xffff0000, v114
    v_lshlrev_b32 v142, 16, v115
    v_and_b32 v143, 0xffff0000, v115
    v_lshlrev_b32 v144, 16, v116
    v_and_b32 v145, 0xffff0000, v116
    v_lshlrev_b32 v146, 16, v117
    v_and_b32 v147, 0xffff0000, v117
    v_lshlrev_b32 v148, 16, v118
    v_and_b32 v149, 0xffff0000, v118
    v_lshlrev_b32 v150, 16, v119
    v_and_b32 v151, 0xffff0000, v119
    v_pk_add_f32 v[104:105], v[120:121], v[122:123]
    v_pk_mul_f32 v[108:109], v[120:121], v[120:121]
    v_pk_add_f32 v[106:107], v[136:137], v[138:139]
    v_pk_mul_f32 v[110:111], v[136:137], v[136:137]
    v_pk_fma_f32 v[108:109], v[122:123], v[122:123], v[108:109]
    v_pk_fma_f32 v[110:111], v[138:139], v[138:139], v[110:111]
    v_pk_add_f32 v[104:105], v[104:105], v[124:125]
    v_pk_fma_f32 v[108:109], v[124:125], v[124:125], v[108:109]
    v_pk_add_f32 v[106:107], v[106:107], v[140:141]
    v_pk_fma_f32 v[110:111], v[140:141], v[140:141], v[110:111]
    v_pk_add_f32 v[104:105], v[104:105], v[126:127]
    v_pk_fma_f32 v[108:109], v[126:127], v[126:127], v[108:109]
    v_pk_add_f32 v[106:107], v[106:107], v[142:143]
    v_pk_fma_f32 v[110:111], v[142:143], v[142:143], v[110:111]
    v_pk_add_f32 v[104:105], v[104:105], v[128:129]
    v_pk_fma_f32 v[108:109], v[128:129], v[128:129], v[108:109]
    v_pk_add_f32 v[106:107], v[106:107], v[144:145]
    v_pk_fma_f32 v[110:111], v[144:145], v[144:145], v[110:111]
    v_pk_add_f32 v[104:105], v[104:105], v[130:131]
    v_pk_fma_f32 v[108:109], v[130:131], v[130:131], v[108:109]
    v_pk_add_f32 v[106:107], v[106:107], v[146:147]
    v_pk_fma_f32 v[110:111], v[146:147], v[146:147], v[110:111]
    v_pk_add_f32 v[104:105], v[104:105], v[132:133]
    v_pk_fma_f32 v[108:109], v[132:133], v[132:133], v[108:109]
    v_pk_add_f32 v[106:107], v[106:107], v[148:149]
    v_pk_fma_f32 v[110:111], v[148:149], v[148:149], v[110:111]
    v_pk_add_f32 v[104:105], v[104:105], v[134:135]
    v_pk_fma_f32 v[108:109], v[134:135], v[134:135], v[108:109]
    v_pk_add_f32 v[106:107], v[106:107], v[150:151]
    v_pk_fma_f32 v[110:111], v[150:151], v[150:151], v[110:111]
    v_add_f32 v152, v104, v105
    v_add_f32 v153, v108, v109
    v_add_f32 v156, v106, v107
    v_add_f32 v157, v110, v111
    v_add_f32_dpp v152, v152, v152 quad_perm:[1,0,3,2] row_mask:0xf bank_mask:0xf
    v_add_f32_dpp v153, v153, v153 quad_perm:[1,0,3,2] row_mask:0xf bank_mask:0xf
    v_add_f32_dpp v156, v156, v156 quad_perm:[1,0,3,2] row_mask:0xf bank_mask:0xf
    v_add_f32_dpp v157, v157, v157 quad_perm:[1,0,3,2] row_mask:0xf bank_mask:0xf
    v_add_f32_dpp v152, v152, v152 quad_perm:[2,3,0,1] row_mask:0xf bank_mask:0xf
    v_add_f32_dpp v153, v153, v153 quad_perm:[2,3,0,1] row_mask:0xf bank_mask:0xf
    v_add_f32_dpp v156, v156, v156 quad_perm:[2,3,0,1] row_mask:0xf bank_mask:0xf
    v_add_f32_dpp v157, v157, v157 quad_perm:[2,3,0,1] row_mask:0xf bank_mask:0xf
    v_add_f32_dpp v152, v152, v152 row_half_mirror row_mask:0xf bank_mask:0xf
    v_add_f32_dpp v153, v153, v153 row_half_mirror row_mask:0xf bank_mask:0xf
    v_add_f32_dpp v156, v156, v156 row_half_mirror row_mask:0xf bank_mask:0xf
    v_add_f32_dpp v157, v157, v157 row_half_mirror row_mask:0xf bank_mask:0xf
    v_add_f32_dpp v152, v152, v152 row_mirror row_mask:0xf bank_mask:0xf
    v_add_f32_dpp v153, v153, v153 row_mirror row_mask:0xf bank_mask:0xf
    v_add_f32_dpp v156, v156, v156 row_mirror row_mask:0xf bank_mask:0xf
    v_add_f32_dpp v157, v157, v157 row_mirror row_mask:0xf bank_mask:0xf
    v_mov_b32 v154, v152
    v_mov_b32 v155, v153
    v_mov_b32 v158, v156
    v_mov_b32 v159, v157
    v_permlane32_swap_b32 v152, v154
    v_permlane32_swap_b32 v153, v155
    v_permlane32_swap_b32 v156, v158
    v_permlane32_swap_b32 v157, v159
    v_add_f32 v152, v152, v154
    v_add_f32 v153, v153, v155
    v_add_f32 v156, v156, v158
    v_add_f32 v157, v157, v159
    v_mov_b32 v154, v152
    v_mov_b32 v155, v153
    v_mov_b32 v158, v156
    v_mov_b32 v159, v157
    v_permlane16_swap_b32 v152, v154
    v_permlane16_swap_b32 v153, v155
    v_permlane16_swap_b32 v156, v158
    v_permlane16_swap_b32 v157, v159
    v_add_f32 v152, v152, v154
    v_add_f32 v153, v153, v155
    v_add_f32 v156, v156, v158
    v_add_f32 v157, v157, v159
    v_mul_f32 v152, 0x3a800000, v152
    v_mul_f32 v153, 0x3a800000, v153
    v_mul_f32 v156, 0x3a800000, v156
    v_mul_f32 v157, 0x3a800000, v157
    v_fma_f32 v153, -v152, v152, v153
    v_fma_f32 v157, -v156, v156, v157
    v_max_f32 v153, 0, v153
    v_max_f32 v157, 0, v157
    v_cvt_pk_bf16_f32 v154, v152, v153
    v_lshlrev_b32 v152, 16, v154
    v_and_b32 v153, 0xffff0000, v154
    v_cvt_pk_bf16_f32 v158, v156, v157
    v_lshlrev_b32 v156, 16, v158
    v_and_b32 v157, 0xffff0000, v158
    v_add_f32 v153, 0x3727c5ac, v153
    v_add_f32 v157, 0x3727c5ac, v157
    v_cvt_pk_bf16_f32 v154, v153, v153
    v_lshlrev_b32 v153, 16, v154
    v_cvt_pk_bf16_f32 v158, v157, v157
    v_lshlrev_b32 v157, 16, v158
    v_sqrt_f32 v153, v153
    v_sqrt_f32 v157, v157
    v_cvt_pk_bf16_f32 v154, v153, v153
    v_lshlrev_b32 v153, 16, v154
    v_cvt_pk_bf16_f32 v158, v157, v157
    v_lshlrev_b32 v157, 16, v158
    v_lshrrev_b32 v153, 16, v153
    v_or_b32 v160, v152, v153
    v_mov_b32 v161, s0
    v_lshrrev_b32 v157, 16, v157
    v_or_b32 v162, v156, v157
    v_mov_b32 v163, s0
    s_lshl_b32 s64, s44, 4
    s_add_u32 s64, s64, 150528
    v_mov_b32 v2, s64
    v_mov_b32 v3, 148500
    v_mov_b32 v4, 1
    s_mov_b64 exec, 1
    ds_write_b128 v2, v[160:163]
    ds_add_rtn_u32 v5, v3, v4
    s_mov_b64 exec, 0xf
    v_and_b32 v2, 3, v1
    v_lshlrev_b32 v2, 4, v2
    v_add_u32 v3, 150528, v2
    ds_read_b128 v[164:167], v3
    v_lshrrev_b32 v4, 2, v1
    v_lshl_add_u32 v2, v4, 15, v2
    s_lshr_b32 s64, s62, 2
    s_lshl_b32 s64, s64, 7
    s_add_u32 s64, s64, 0x10000
    s_waitcnt lgkmcnt(0)
    v_readfirstlane_b32 s65, v5
    s_nop 3
    s_cmp_eq_u32 s65, 3
    s_cselect_b32 s64, s64, 0x80000000
    v_add_u32 v2, s64, v2
    buffer_store_dwordx4 v[164:167], v2, s[28:31], 0 offen sc1
    s_mov_b64 exec, -1
    s_mov_b32 s64, 0x0
    buffer_load_dwordx4 v[80:83], v8, s[40:43], s64 offen
    s_mov_b32 s64, 0x10000
    buffer_load_dwordx4 v[84:87], v8, s[40:43], s64 offen
    s_mov_b32 s64, 0x20000
    buffer_load_dwordx4 v[88:91], v8, s[40:43], s64 offen
    s_mov_b32 s64, 0x30000
    buffer_load_dwordx4 v[92:95], v8, s[40:43], s64 offen
    buffer_load_dwordx4 v[96:99], v9, s[40:43], 0 offen
    v_mov_b32 v6, -1
    v_mov_b32 v7, -1
    s_mov_b32 exec_hi, 0
    buffer_store_dwordx2 v[6:7], v195, s[28:31], 0 offen sc1
    s_mov_b32 exec_hi, -1
    s_mov_b32 s40, s18
    s_mov_b32 s41, s19
    s_mov_b32 s42, 0x800
    s_mov_b32 s43, 0x20000
    buffer_load_ushort v24, v18, s[40:43], 0 offen offset:0
    buffer_load_ushort v25, v18, s[40:43], 0 offen offset:64
    buffer_load_ushort v26, v18, s[40:43], 0 offen offset:128
    buffer_load_ushort v27, v18, s[40:43], 0 offen offset:192
    buffer_load_ushort v28, v18, s[40:43], 0 offen offset:256
    buffer_load_ushort v29, v18, s[40:43], 0 offen offset:320
    buffer_load_ushort v30, v18, s[40:43], 0 offen offset:384
    buffer_load_ushort v31, v18, s[40:43], 0 offen offset:448
    buffer_load_dwordx2 v[168:169], v12, s[28:31], 0 offen offset:0 sc1
    buffer_load_dwordx2 v[170:171], v12, s[28:31], 0 offen offset:512 sc1
    buffer_load_dwordx2 v[172:173], v12, s[28:31], 0 offen offset:1024 sc1
    buffer_load_dwordx2 v[174:175], v12, s[28:31], 0 offen offset:1536 sc1
    buffer_load_dwordx2 v[176:177], v13, s[28:31], 0 offen sc1
    s_waitcnt vmcnt(14)
    v_lshlrev_b32 v120, 16, v80
    v_and_b32 v121, 0xffff0000, v80
    v_lshlrev_b32 v122, 16, v81
    v_and_b32 v123, 0xffff0000, v81
    v_lshlrev_b32 v124, 16, v82
    v_and_b32 v125, 0xffff0000, v82
    v_lshlrev_b32 v126, 16, v83
    v_and_b32 v127, 0xffff0000, v83
    v_lshlrev_b32 v128, 16, v84
    v_and_b32 v129, 0xffff0000, v84
    v_lshlrev_b32 v130, 16, v85
    v_and_b32 v131, 0xffff0000, v85
    v_lshlrev_b32 v132, 16, v86
    v_and_b32 v133, 0xffff0000, v86
    v_lshlrev_b32 v134, 16, v87
    v_and_b32 v135, 0xffff0000, v87
    v_lshlrev_b32 v136, 16, v88
    v_and_b32 v137, 0xffff0000, v88
    v_lshlrev_b32 v138, 16, v89
    v_and_b32 v139, 0xffff0000, v89
    v_lshlrev_b32 v140, 16, v90
    v_and_b32 v141, 0xffff0000, v90
    v_lshlrev_b32 v142, 16, v91
    v_and_b32 v143, 0xffff0000, v91
    v_lshlrev_b32 v144, 16, v92
    v_and_b32 v145, 0xffff0000, v92
    v_lshlrev_b32 v146, 16, v93
    v_and_b32 v147, 0xffff0000, v93
    v_lshlrev_b32 v148, 16, v94
    v_and_b32 v149, 0xffff0000, v94
    v_lshlrev_b32 v150, 16, v95
    v_and_b32 v151, 0xffff0000, v95
    v_lshlrev_b32 v152, 16, v96
    v_and_b32 v153, 0xffff0000, v96
    v_lshlrev_b32 v154, 16, v97
    v_and_b32 v155, 0xffff0000, v97
    v_lshlrev_b32 v156, 16, v98
    v_and_b32 v157, 0xffff0000, v98
    v_lshlrev_b32 v158, 16, v99
    v_and_b32 v159, 0xffff0000, v99
    s_waitcnt vmcnt(0)
    s_mov_b32 s3, 0x40000
M_s1_chk:
    v_xor_b32 v72, s0, v169
    v_xor_b32 v73, s0, v171
    v_xor_b32 v74, s0, v173
    v_xor_b32 v75, s0, v175
    v_xor_b32 v76, s0, v177
    v_or3_b32 v72, v72, v73, v74
    v_or3_b32 v72, v72, v75, v76
    v_cmp_ne_u32 vcc, 0, v72
    s_nop 4
    s_cbranch_vccz M_s1_ok
    s_sub_u32 s3, s3, 1
    s_cbranch_scc1 M_s1_ok
    s_sleep 2
    v_cmp_ne_u32 vcc, s0, v169
    s_nop 4
    s_mov_b64 exec, vcc
    buffer_load_dwordx2 v[168:169], v12, s[28:31], 0 offen offset:0 sc1
    s_mov_b64 exec, -1
    v_cmp_ne_u32 vcc, s0, v171
    s_nop 4
    s_mov_b64 exec, vcc
    buffer_load_dwordx2 v[170:171], v12, s[28:31], 0 offen offset:512 sc1
    s_mov_b64 exec, -1
    v_cmp_ne_u32 vcc, s0, v173
    s_nop 4
    s_mov_b64 exec, vcc
    buffer_load_dwordx2 v[172:173], v12, s[28:31], 0 offen offset:1024 sc1
    s_mov_b64 exec, -1
    v_cmp_ne_u32 vcc, s0, v175
    s_nop 4
    s_mov_b64 exec, vcc
    buffer_load_dwordx2 v[174:175], v12, s[28:31], 0 offen offset:1536 sc1
    s_mov_b64 exec, -1
    v_cmp_ne_u32 vcc, s0, v177
    s_nop 4
    s_mov_b64 exec, vcc
    buffer_load_dwordx2 v[176:177], v13, s[28:31], 0 offen sc1
    s_mov_b64 exec, -1
    s_waitcnt vmcnt(0)
    s_branch M_s1_chk
M_s1_ok:
    v_lshlrev_b32 v169, 16, v168
    v_and_b32 v168, 0xffff0000, v168
    v_lshlrev_b32 v171, 16, v170
    v_and_b32 v170, 0xffff0000, v170
    v_lshlrev_b32 v173, 16, v172
    v_and_b32 v172, 0xffff0000, v172
    v_lshlrev_b32 v175, 16, v174
    v_and_b32 v174, 0xffff0000, v174
    v_lshlrev_b32 v177, 16, v176
    v_and_b32 v176, 0xffff0000, v176
    v_rcp_f32 v169, v169
    v_rcp_f32 v171, v171
    v_rcp_f32 v173, v173
    v_rcp_f32 v175, v175
    v_rcp_f32 v177, v177
    v_pk_add_f32 v[120:121], v[120:121], v[168:169] op_sel_hi:[1,0] neg_lo:[0,1] neg_hi:[0,1]
    v_pk_add_f32 v[122:123], v[122:123], v[168:169] op_sel_hi:[1,0] neg_lo:[0,1] neg_hi:[0,1]
    v_pk_add_f32 v[124:125], v[124:125], v[168:169] op_sel_hi:[1,0] neg_lo:[0,1] neg_hi:[0,1]
    v_pk_add_f32 v[126:127], v[126:127], v[168:169] op_sel_hi:[1,0] neg_lo:[0,1] neg_hi:[0,1]
    v_cvt_pk_bf16_f32 v72, v120, v121
    v_lshlrev_b32 v120, 16, v72
    v_and_b32 v121, 0xffff0000, v72
    v_cvt_pk_bf16_f32 v73, v122, v123
    v_lshlrev_b32 v122, 16, v73
    v_and_b32 v123, 0xffff0000, v73
    v_cvt_pk_bf16_f32 v74, v124, v125
    v_lshlrev_b32 v124, 16, v74
    v_and_b32 v125, 0xffff0000, v74
    v_cvt_pk_bf16_f32 v75, v126, v127
    v_lshlrev_b32 v126, 16, v75
    v_and_b32 v127, 0xffff0000, v75
    v_pk_mul_f32 v[120:121], v[120:121], v[168:169] op_sel:[0,1] op_sel_hi:[1,1]
    v_pk_mul_f32 v[122:123], v[122:123], v[168:169] op_sel:[0,1] op_sel_hi:[1,1]
    v_pk_mul_f32 v[124:125], v[124:125], v[168:169] op_sel:[0,1] op_sel_hi:[1,1]
    v_pk_mul_f32 v[126:127], v[126:127], v[168:169] op_sel:[0,1] op_sel_hi:[1,1]
    v_cvt_pk_bf16_f32 v72, v120, v121
    v_lshlrev_b32 v120, 16, v72
    v_and_b32 v121, 0xffff0000, v72
    v_cvt_pk_bf16_f32 v73, v122, v123
    v_lshlrev_b32 v122, 16, v73
    v_and_b32 v123, 0xffff0000, v73
    v_cvt_pk_bf16_f32 v74, v124, v125
    v_lshlrev_b32 v124, 16, v74
    v_and_b32 v125, 0xffff0000, v74
    v_cvt_pk_bf16_f32 v75, v126, v127
    v_lshlrev_b32 v126, 16, v75
    v_and_b32 v127, 0xffff0000, v75
    v_pk_add_f32 v[128:129], v[128:129], v[170:171] op_sel_hi:[1,0] neg_lo:[0,1] neg_hi:[0,1]
    v_pk_add_f32 v[130:131], v[130:131], v[170:171] op_sel_hi:[1,0] neg_lo:[0,1] neg_hi:[0,1]
    v_pk_add_f32 v[132:133], v[132:133], v[170:171] op_sel_hi:[1,0] neg_lo:[0,1] neg_hi:[0,1]
    v_pk_add_f32 v[134:135], v[134:135], v[170:171] op_sel_hi:[1,0] neg_lo:[0,1] neg_hi:[0,1]
    v_cvt_pk_bf16_f32 v72, v128, v129
    v_lshlrev_b32 v128, 16, v72
    v_and_b32 v129, 0xffff0000, v72
    v_cvt_pk_bf16_f32 v73, v130, v131
    v_lshlrev_b32 v130, 16, v73
    v_and_b32 v131, 0xffff0000, v73
    v_cvt_pk_bf16_f32 v74, v132, v133
    v_lshlrev_b32 v132, 16, v74
    v_and_b32 v133, 0xffff0000, v74
    v_cvt_pk_bf16_f32 v75, v134, v135
    v_lshlrev_b32 v134, 16, v75
    v_and_b32 v135, 0xffff0000, v75
    v_pk_mul_f32 v[128:129], v[128:129], v[170:171] op_sel:[0,1] op_sel_hi:[1,1]
    v_pk_mul_f32 v[130:131], v[130:131], v[170:171] op_sel:[0,1] op_sel_hi:[1,1]
    v_pk_mul_f32 v[132:133], v[132:133], v[170:171] op_sel:[0,1] op_sel_hi:[1,1]
    v_pk_mul_f32 v[134:135], v[134:135], v[170:171] op_sel:[0,1] op_sel_hi:[1,1]
    v_cvt_pk_bf16_f32 v72, v128, v129
    v_lshlrev_b32 v128, 16, v72
    v_and_b32 v129, 0xffff0000, v72
    v_cvt_pk_bf16_f32 v73, v130, v131
    v_lshlrev_b32 v130, 16, v73
    v_and_b32 v131, 0xffff0000, v73
    v_cvt_pk_bf16_f32 v74, v132, v133
    v_lshlrev_b32 v132, 16, v74
    v_and_b32 v133, 0xffff0000, v74
    v_cvt_pk_bf16_f32 v75, v134, v135
    v_lshlrev_b32 v134, 16, v75
    v_and_b32 v135, 0xffff0000, v75
    v_pk_add_f32 v[136:137], v[136:137], v[172:173] op_sel_hi:[1,0] neg_lo:[0,1] neg_hi:[0,1]
    v_pk_add_f32 v[138:139], v[138:139], v[172:173] op_sel_hi:[1,0] neg_lo:[0,1] neg_hi:[0,1]
    v_pk_add_f32 v[140:141], v[140:141], v[172:173] op_sel_hi:[1,0] neg_lo:[0,1] neg_hi:[0,1]
    v_pk_add_f32 v[142:143], v[142:143], v[172:173] op_sel_hi:[1,0] neg_lo:[0,1] neg_hi:[0,1]
    v_cvt_pk_bf16_f32 v72, v136, v137
    v_lshlrev_b32 v136, 16, v72
    v_and_b32 v137, 0xffff0000, v72
    v_cvt_pk_bf16_f32 v73, v138, v139
    v_lshlrev_b32 v138, 16, v73
    v_and_b32 v139, 0xffff0000, v73
    v_cvt_pk_bf16_f32 v74, v140, v141
    v_lshlrev_b32 v140, 16, v74
    v_and_b32 v141, 0xffff0000, v74
    v_cvt_pk_bf16_f32 v75, v142, v143
    v_lshlrev_b32 v142, 16, v75
    v_and_b32 v143, 0xffff0000, v75
    v_pk_mul_f32 v[136:137], v[136:137], v[172:173] op_sel:[0,1] op_sel_hi:[1,1]
    v_pk_mul_f32 v[138:139], v[138:139], v[172:173] op_sel:[0,1] op_sel_hi:[1,1]
    v_pk_mul_f32 v[140:141], v[140:141], v[172:173] op_sel:[0,1] op_sel_hi:[1,1]
    v_pk_mul_f32 v[142:143], v[142:143], v[172:173] op_sel:[0,1] op_sel_hi:[1,1]
    v_cvt_pk_bf16_f32 v72, v136, v137
    v_lshlrev_b32 v136, 16, v72
    v_and_b32 v137, 0xffff0000, v72
    v_cvt_pk_bf16_f32 v73, v138, v139
    v_lshlrev_b32 v138, 16, v73
    v_and_b32 v139, 0xffff0000, v73
    v_cvt_pk_bf16_f32 v74, v140, v141
    v_lshlrev_b32 v140, 16, v74
    v_and_b32 v141, 0xffff0000, v74
    v_cvt_pk_bf16_f32 v75, v142, v143
    v_lshlrev_b32 v142, 16, v75
    v_and_b32 v143, 0xffff0000, v75
    v_pk_add_f32 v[144:145], v[144:145], v[174:175] op_sel_hi:[1,0] neg_lo:[0,1] neg_hi:[0,1]
    v_pk_add_f32 v[146:147], v[146:147], v[174:175] op_sel_hi:[1,0] neg_lo:[0,1] neg_hi:[0,1]
    v_pk_add_f32 v[148:149], v[148:149], v[174:175] op_sel_hi:[1,0] neg_lo:[0,1] neg_hi:[0,1]
    v_pk_add_f32 v[150:151], v[150:151], v[174:175] op_sel_hi:[1,0] neg_lo:[0,1] neg_hi:[0,1]
    v_cvt_pk_bf16_f32 v72, v144, v145
    v_lshlrev_b32 v144, 16, v72
    v_and_b32 v145, 0xffff0000, v72
    v_cvt_pk_bf16_f32 v73, v146, v147
    v_lshlrev_b32 v146, 16, v73
    v_and_b32 v147, 0xffff0000, v73
    v_cvt_pk_bf16_f32 v74, v148, v149
    v_lshlrev_b32 v148, 16, v74
    v_and_b32 v149, 0xffff0000, v74
    v_cvt_pk_bf16_f32 v75, v150, v151
    v_lshlrev_b32 v150, 16, v75
    v_and_b32 v151, 0xffff0000, v75
    v_pk_mul_f32 v[144:145], v[144:145], v[174:175] op_sel:[0,1] op_sel_hi:[1,1]
    v_pk_mul_f32 v[146:147], v[146:147], v[174:175] op_sel:[0,1] op_sel_hi:[1,1]
    v_pk_mul_f32 v[148:149], v[148:149], v[174:175] op_sel:[0,1] op_sel_hi:[1,1]
    v_pk_mul_f32 v[150:151], v[150:151], v[174:175] op_sel:[0,1] op_sel_hi:[1,1]
    v_cvt_pk_bf16_f32 v72, v144, v145
    v_lshlrev_b32 v144, 16, v72
    v_and_b32 v145, 0xffff0000, v72
    v_cvt_pk_bf16_f32 v73, v146, v147
    v_lshlrev_b32 v146, 16, v73
    v_and_b32 v147, 0xffff0000, v73
    v_cvt_pk_bf16_f32 v74, v148, v149
    v_lshlrev_b32 v148, 16, v74
    v_and_b32 v149, 0xffff0000, v74
    v_cvt_pk_bf16_f32 v75, v150, v151
    v_lshlrev_b32 v150, 16, v75
    v_and_b32 v151, 0xffff0000, v75
    v_pk_add_f32 v[152:153], v[152:153], v[176:177] op_sel_hi:[1,0] neg_lo:[0,1] neg_hi:[0,1]
    v_pk_add_f32 v[154:155], v[154:155], v[176:177] op_sel_hi:[1,0] neg_lo:[0,1] neg_hi:[0,1]
    v_pk_add_f32 v[156:157], v[156:157], v[176:177] op_sel_hi:[1,0] neg_lo:[0,1] neg_hi:[0,1]
    v_pk_add_f32 v[158:159], v[158:159], v[176:177] op_sel_hi:[1,0] neg_lo:[0,1] neg_hi:[0,1]
    v_cvt_pk_bf16_f32 v72, v152, v153
    v_lshlrev_b32 v152, 16, v72
    v_and_b32 v153, 0xffff0000, v72
    v_cvt_pk_bf16_f32 v73, v154, v155
    v_lshlrev_b32 v154, 16, v73
    v_and_b32 v155, 0xffff0000, v73
    v_cvt_pk_bf16_f32 v74, v156, v157
    v_lshlrev_b32 v156, 16, v74
    v_and_b32 v157, 0xffff0000, v74
    v_cvt_pk_bf16_f32 v75, v158, v159
    v_lshlrev_b32 v158, 16, v75
    v_and_b32 v159, 0xffff0000, v75
    v_pk_mul_f32 v[152:153], v[152:153], v[176:177] op_sel:[0,1] op_sel_hi:[1,1]
    v_pk_mul_f32 v[154:155], v[154:155], v[176:177] op_sel:[0,1] op_sel_hi:[1,1]
    v_pk_mul_f32 v[156:157], v[156:157], v[176:177] op_sel:[0,1] op_sel_hi:[1,1]
    v_pk_mul_f32 v[158:159], v[158:159], v[176:177] op_sel:[0,1] op_sel_hi:[1,1]
    v_cvt_pk_bf16_f32 v72, v152, v153
    v_lshlrev_b32 v152, 16, v72
    v_and_b32 v153, 0xffff0000, v72
    v_cvt_pk_bf16_f32 v73, v154, v155
    v_lshlrev_b32 v154, 16, v73
    v_and_b32 v155, 0xffff0000, v73
    v_cvt_pk_bf16_f32 v74, v156, v157
    v_lshlrev_b32 v156, 16, v74
    v_and_b32 v157, 0xffff0000, v74
    v_cvt_pk_bf16_f32 v75, v158, v159
    v_lshlrev_b32 v158, 16, v75
    v_and_b32 v159, 0xffff0000, v75
    s_lshl_b32 s68, s47, 9
    s_add_u32 s68, s68, 0x58000
    s_add_u32 s62, s26, s68
    s_addc_u32 s63, s27, 0
    s_lshr_b32 s68, s48, 2
    s_lshl_b32 s68, s68, 7
    v_mov_b32 v2, 1
    v_mov_b32 v5, 148496
    s_and_b32 s57, s58, 15
    s_lshr_b64 s[58:59], s[58:59], 4
    s_lshl_b32 s56, s57, 11
    s_mul_i32 s57, s57, 0x60000
    s_add_u32 m0, s53, s74
    s_nop 0
    buffer_load_dwordx4 v187, s[32:35], s57 offen offset:0 lds
    buffer_load_dwordx4 v188, s[32:35], s57 offen offset:1024 lds
    buffer_load_dwordx4 v189, s[32:35], s57 offen offset:2048 lds
    buffer_load_dwordx4 v190, s[32:35], s57 offen offset:3072 lds
    s_add_u32 m0, s53, s75
    s_nop 0
    buffer_load_dwordx4 v191, s[32:35], s57 offen offset:0 lds
    buffer_load_dwordx4 v192, s[32:35], s57 offen offset:1024 lds
    s_add_u32 s53, s53, 49152
    s_cmp_ge_u32 s53, 147456
    s_cselect_b32 s53, 0, s53
    s_barrier
    ds_read_b128 v[32:35], v14 offset:0
    ds_read_b128 v[36:39], v14 offset:16
    ds_read_b128 v[40:43], v14 offset:256
    ds_read_b128 v[44:47], v14 offset:272
    s_waitcnt lgkmcnt(0)
    v_pk_mul_f32 v[120:121], v[120:121], v[40:41]
    v_pk_mul_f32 v[122:123], v[122:123], v[42:43]
    v_pk_mul_f32 v[124:125], v[124:125], v[44:45]
    v_pk_mul_f32 v[126:127], v[126:127], v[46:47]
    v_cvt_pk_bf16_f32 v72, v120, v121
    v_lshlrev_b32 v120, 16, v72
    v_and_b32 v121, 0xffff0000, v72
    v_cvt_pk_bf16_f32 v73, v122, v123
    v_lshlrev_b32 v122, 16, v73
    v_and_b32 v123, 0xffff0000, v73
    v_cvt_pk_bf16_f32 v74, v124, v125
    v_lshlrev_b32 v124, 16, v74
    v_and_b32 v125, 0xffff0000, v74
    v_cvt_pk_bf16_f32 v75, v126, v127
    v_lshlrev_b32 v126, 16, v75
    v_and_b32 v127, 0xffff0000, v75
    v_pk_add_f32 v[120:121], v[120:121], v[32:33]
    v_pk_add_f32 v[122:123], v[122:123], v[34:35]
    v_pk_add_f32 v[124:125], v[124:125], v[36:37]
    v_pk_add_f32 v[126:127], v[126:127], v[38:39]
    v_cvt_pk_bf16_f32 v80, v120, v121
    v_cvt_pk_bf16_f32 v81, v122, v123
    v_cvt_pk_bf16_f32 v82, v124, v125
    v_cvt_pk_bf16_f32 v83, v126, v127
    s_mov_b32 s64, 0x0
    buffer_store_dwordx4 v[80:83], v10, s[28:31], s64 offen sc1
    ds_write_b128 v15, v[80:83] offset:0
    v_pk_mul_f32 v[128:129], v[128:129], v[40:41]
    v_pk_mul_f32 v[130:131], v[130:131], v[42:43]
    v_pk_mul_f32 v[132:133], v[132:133], v[44:45]
    v_pk_mul_f32 v[134:135], v[134:135], v[46:47]
    v_cvt_pk_bf16_f32 v72, v128, v129
    v_lshlrev_b32 v128, 16, v72
    v_and_b32 v129, 0xffff0000, v72
    v_cvt_pk_bf16_f32 v73, v130, v131
    v_lshlrev_b32 v130, 16, v73
    v_and_b32 v131, 0xffff0000, v73
    v_cvt_pk_bf16_f32 v74, v132, v133
    v_lshlrev_b32 v132, 16, v74
    v_and_b32 v133, 0xffff0000, v74
    v_cvt_pk_bf16_f32 v75, v134, v135
    v_lshlrev_b32 v134, 16, v75
    v_and_b32 v135, 0xffff0000, v75
    v_pk_add_f32 v[128:129], v[128:129], v[32:33]
    v_pk_add_f32 v[130:131], v[130:131], v[34:35]
    v_pk_add_f32 v[132:133], v[132:133], v[36:37]
    v_pk_add_f32 v[134:135], v[134:135], v[38:39]
    v_cvt_pk_bf16_f32 v84, v128, v129
    v_cvt_pk_bf16_f32 v85, v130, v131
    v_cvt_pk_bf16_f32 v86, v132, v133
    v_cvt_pk_bf16_f32 v87, v134, v135
    s_mov_b32 s64, 0x10000
    buffer_store_dwordx4 v[84:87], v10, s[28:31], s64 offen sc1
    ds_write_b128 v15, v[84:87] offset:4096
    v_pk_mul_f32 v[136:137], v[136:137], v[40:41]
    v_pk_mul_f32 v[138:139], v[138:139], v[42:43]
    v_pk_mul_f32 v[140:141], v[140:141], v[44:45]
    v_pk_mul_f32 v[142:143], v[142:143], v[46:47]
    v_cvt_pk_bf16_f32 v72, v136, v137
    v_lshlrev_b32 v136, 16, v72
    v_and_b32 v137, 0xffff0000, v72
    v_cvt_pk_bf16_f32 v73, v138, v139
    v_lshlrev_b32 v138, 16, v73
    v_and_b32 v139, 0xffff0000, v73
    v_cvt_pk_bf16_f32 v74, v140, v141
    v_lshlrev_b32 v140, 16, v74
    v_and_b32 v141, 0xffff0000, v74
    v_cvt_pk_bf16_f32 v75, v142, v143
    v_lshlrev_b32 v142, 16, v75
    v_and_b32 v143, 0xffff0000, v75
    v_pk_add_f32 v[136:137], v[136:137], v[32:33]
    v_pk_add_f32 v[138:139], v[138:139], v[34:35]
    v_pk_add_f32 v[140:141], v[140:141], v[36:37]
    v_pk_add_f32 v[142:143], v[142:143], v[38:39]
    v_cvt_pk_bf16_f32 v88, v136, v137
    v_cvt_pk_bf16_f32 v89, v138, v139
    v_cvt_pk_bf16_f32 v90, v140, v141
    v_cvt_pk_bf16_f32 v91, v142, v143
    s_mov_b32 s64, 0x20000
    buffer_store_dwordx4 v[88:91], v10, s[28:31], s64 offen sc1
    ds_write_b128 v15, v[88:91] offset:8192
    v_pk_mul_f32 v[144:145], v[144:145], v[40:41]
    v_pk_mul_f32 v[146:147], v[146:147], v[42:43]
    v_pk_mul_f32 v[148:149], v[148:149], v[44:45]
    v_pk_mul_f32 v[150:151], v[150:151], v[46:47]
    v_cvt_pk_bf16_f32 v72, v144, v145
    v_lshlrev_b32 v144, 16, v72
    v_and_b32 v145, 0xffff0000, v72
    v_cvt_pk_bf16_f32 v73, v146, v147
    v_lshlrev_b32 v146, 16, v73
    v_and_b32 v147, 0xffff0000, v73
    v_cvt_pk_bf16_f32 v74, v148, v149
    v_lshlrev_b32 v148, 16, v74
    v_and_b32 v149, 0xffff0000, v74
    v_cvt_pk_bf16_f32 v75, v150, v151
    v_lshlrev_b32 v150, 16, v75
    v_and_b32 v151, 0xffff0000, v75
    v_pk_add_f32 v[144:145], v[144:145], v[32:33]
    v_pk_add_f32 v[146:147], v[146:147], v[34:35]
    v_pk_add_f32 v[148:149], v[148:149], v[36:37]
    v_pk_add_f32 v[150:151], v[150:151], v[38:39]
    v_cvt_pk_bf16_f32 v92, v144, v145
    v_cvt_pk_bf16_f32 v93, v146, v147
    v_cvt_pk_bf16_f32 v94, v148, v149
    v_cvt_pk_bf16_f32 v95, v150, v151
    s_mov_b32 s64, 0x30000
    buffer_store_dwordx4 v[92:95], v10, s[28:31], s64 offen sc1
    ds_write_b128 v15, v[92:95] offset:12288
    v_pk_mul_f32 v[152:153], v[152:153], v[40:41]
    v_pk_mul_f32 v[154:155], v[154:155], v[42:43]
    v_pk_mul_f32 v[156:157], v[156:157], v[44:45]
    v_pk_mul_f32 v[158:159], v[158:159], v[46:47]
    v_cvt_pk_bf16_f32 v72, v152, v153
    v_lshlrev_b32 v152, 16, v72
    v_and_b32 v153, 0xffff0000, v72
    v_cvt_pk_bf16_f32 v73, v154, v155
    v_lshlrev_b32 v154, 16, v73
    v_and_b32 v155, 0xffff0000, v73
    v_cvt_pk_bf16_f32 v74, v156, v157
    v_lshlrev_b32 v156, 16, v74
    v_and_b32 v157, 0xffff0000, v74
    v_cvt_pk_bf16_f32 v75, v158, v159
    v_lshlrev_b32 v158, 16, v75
    v_and_b32 v159, 0xffff0000, v75
    v_pk_add_f32 v[152:153], v[152:153], v[32:33]
    v_pk_add_f32 v[154:155], v[154:155], v[34:35]
    v_pk_add_f32 v[156:157], v[156:157], v[36:37]
    v_pk_add_f32 v[158:159], v[158:159], v[38:39]
    v_cvt_pk_bf16_f32 v96, v152, v153
    v_cvt_pk_bf16_f32 v97, v154, v155
    v_cvt_pk_bf16_f32 v98, v156, v157
    v_cvt_pk_bf16_f32 v99, v158, v159
    buffer_store_dwordx4 v[96:99], v11, s[28:31], 0 offen sc1
    ds_write_b128 v19, v[96:99] offset:0
    s_waitcnt lgkmcnt(0)
    s_waitcnt vmcnt(5)
    s_barrier
    s_and_b32 s57, s58, 15
    s_lshr_b64 s[58:59], s[58:59], 4
    s_lshl_b32 s56, s57, 11
    s_mul_i32 s57, s57, 0x60000
    s_add_u32 m0, s53, s74
    s_nop 0
    buffer_load_dwordx4 v187, s[32:35], s57 offen offset:0 lds
    buffer_load_dwordx4 v188, s[32:35], s57 offen offset:1024 lds
    buffer_load_dwordx4 v189, s[32:35], s57 offen offset:2048 lds
    buffer_load_dwordx4 v190, s[32:35], s57 offen offset:3072 lds
    s_add_u32 m0, s53, s75
    s_nop 0
    buffer_load_dwordx4 v191, s[32:35], s57 offen offset:0 lds
    buffer_load_dwordx4 v192, s[32:35], s57 offen offset:1024 lds
    s_add_u32 s53, s53, 49152
    s_cmp_ge_u32 s53, 147456
    s_cselect_b32 s53, 0, s53
    s_mov_b32 s64, 0x0
    buffer_load_dwordx4 v[32:35], v17, s[36:39], s64 offen
    s_mov_b32 s64, 0x60000
    buffer_load_dwordx4 v[36:39], v17, s[36:39], s64 offen
    s_mov_b32 s64, 0xc0000
    buffer_load_dwordx4 v[40:43], v17, s[36:39], s64 offen
    s_mov_b32 s53, 0
    s_bfe_u32 s66, s2, 0x30003
    s_lshr_b32 s55, s2, 6
    s_add_u32 s66, s66, s55
    s_and_b32 s66, s66, 3
    s_mov_b32 s58, 0x76453210
    s_mov_b32 s59, 0xfecdba89
    s_cmp_eq_u32 s66, 1
    s_cselect_b32 s58, 0x75643120, s58
    s_cselect_b32 s59, 0xfdecb9a8, s59
    s_cmp_eq_u32 s66, 2
    s_cselect_b32 s58, 0x67542310, s58
    s_cselect_b32 s59, 0xefdcab98, s59
    s_cmp_eq_u32 s66, 3
    s_cselect_b32 s58, 0x86534210, s58
    s_cselect_b32 s59, 0xfedbca97, s59
    s_and_b32 s66, s48, 15
    s_lshl_b32 s55, s66, 2
    s_lshr_b64 s[56:57], s[58:59], s55
    s_and_b32 s55, s56, 15
    s_lshl_b32 s55, s55, 2
    s_lshl_b64 s[56:57], 15, s55
    s_andn2_b64 s[58:59], s[58:59], s[56:57]
    s_or_b32 s58, s58, s66
    s_waitcnt vmcnt(9)
    s_mov_b64 exec, 1
    ds_add_rtn_u32 v245, v5, v2
    s_mov_b64 exec, -1
    s_mov_b32 s1, s0
    s_lshl_b32 s64, s48, 2
    s_waitcnt lgkmcnt(0)
    v_readfirstlane_b32 s3, v245
    s_nop 3
    s_cmp_lg_u32 s3, 3
    s_cbranch_scc1 M_p1_ok
    s_atomic_swap s0, s[62:63], s64 offset:0
    s_atomic_swap s0, s[62:63], s64 offset:128
    s_atomic_swap s0, s[62:63], s64 offset:256
    s_atomic_swap s0, s[62:63], s64 offset:384
    s_mov_b32 s3, 0x40000
M_p1_chk:
    s_load_dwordx16 s[80:95], s[62:63], s68 glc
    s_sub_u32 s3, s3, 1
    s_cbranch_scc1 M_p1_ok
M_p1_c2:
    s_waitcnt lgkmcnt(0)
    s_xor_b64 s[80:81], s[80:81], s[0:1]
    s_xor_b64 s[82:83], s[82:83], s[0:1]
    s_xor_b64 s[84:85], s[84:85], s[0:1]
    s_xor_b64 s[86:87], s[86:87], s[0:1]
    s_xor_b64 s[88:89], s[88:89], s[0:1]
    s_xor_b64 s[90:91], s[90:91], s[0:1]
    s_xor_b64 s[92:93], s[92:93], s[0:1]
    s_xor_b64 s[94:95], s[94:95], s[0:1]
    s_or_b64 s[80:81], s[80:81], s[82:83]
    s_or_b64 s[84:85], s[84:85], s[86:87]
    s_or_b64 s[88:89], s[88:89], s[90:91]
    s_or_b64 s[92:93], s[92:93], s[94:95]
    s_or_b64 s[80:81], s[80:81], s[84:85]
    s_or_b64 s[88:89], s[88:89], s[92:93]
    s_or_b64 s[80:81], s[80:81], s[88:89]
    s_cbranch_scc1 M_p1_chk
M_p1_ok:
    s_barrier
    s_and_b32 s57, s58, 15
    s_lshr_b64 s[58:59], s[58:59], 4
    s_lshl_b32 s56, s57, 11
    s_mul_i32 s57, s57, 0x60000
    s_add_u32 s53, s53, 49152
    s_cmp_ge_u32 s53, 147456
    s_cselect_b32 s53, 0, s53
    s_and_b32 s57, s58, 15
    s_lshr_b64 s[58:59], s[58:59], 4
    s_lshl_b32 s56, s57, 11
    s_mul_i32 s57, s57, 0x60000
    s_add_u32 m0, s53, s72
    s_nop 0
    buffer_load_dwordx4 v184, s[28:31], s56 offen offset:0 sc1 lds
    buffer_load_dwordx4 v184, s[28:31], s56 offen offset:1024 sc1 lds
    buffer_load_dwordx4 v185, s[28:31], s56 offen offset:2048 sc1 lds
    buffer_load_dwordx4 v185, s[28:31], s56 offen offset:3072 sc1 lds
    s_add_u32 m0, s53, s73
    s_mov_b32 exec_hi, 0
    buffer_load_dwordx4 v186, s[28:31], s56 offen offset:0 sc1 lds
    s_mov_b32 exec_hi, -1
    s_add_u32 s53, s53, 49152
    s_cmp_ge_u32 s53, 147456
    s_cselect_b32 s53, 0, s53
    s_and_b32 s57, s58, 15
    s_lshr_b64 s[58:59], s[58:59], 4
    s_lshl_b32 s56, s57, 11
    s_mul_i32 s57, s57, 0x60000
    s_add_u32 m0, s53, s74
    s_nop 0
    buffer_load_dwordx4 v187, s[32:35], s57 offen offset:0 lds
    buffer_load_dwordx4 v188, s[32:35], s57 offen offset:1024 lds
    buffer_load_dwordx4 v189, s[32:35], s57 offen offset:2048 lds
    buffer_load_dwordx4 v190, s[32:35], s57 offen offset:3072 lds
    s_add_u32 m0, s53, s75
    s_nop 0
    buffer_load_dwordx4 v191, s[32:35], s57 offen offset:0 lds
    buffer_load_dwordx4 v192, s[32:35], s57 offen offset:1024 lds
    s_add_u32 m0, s53, s72
    s_nop 0
    buffer_load_dwordx4 v184, s[28:31], s56 offen offset:0 sc1 lds
    buffer_load_dwordx4 v184, s[28:31], s56 offen offset:1024 sc1 lds
    buffer_load_dwordx4 v185, s[28:31], s56 offen offset:2048 sc1 lds
    buffer_load_dwordx4 v185, s[28:31], s56 offen offset:3072 sc1 lds
    s_add_u32 m0, s53, s73
    s_mov_b32 exec_hi, 0
    buffer_load_dwordx4 v186, s[28:31], s56 offen offset:0 sc1 lds
    s_mov_b32 exec_hi, -1
    s_add_u32 s53, s53, 49152
    s_cmp_ge_u32 s53, 147456
    s_cselect_b32 s53, 0, s53
    s_waitcnt vmcnt(11)
    s_barrier
    s_and_b32 s57, s58, 15
    s_lshr_b64 s[58:59], s[58:59], 4
    s_lshl_b32 s56, s57, 11
    s_mul_i32 s57, s57, 0x60000
    s_add_u32 m0, s53, s74
    s_nop 0
    buffer_load_dwordx4 v187, s[32:35], s57 offen offset:0 lds
    buffer_load_dwordx4 v188, s[32:35], s57 offen offset:1024 lds
    s_load_dword s99, s[10:11], -3712
    buffer_load_dwordx4 v189, s[32:35], s57 offen offset:2048 lds
    buffer_load_dwordx4 v190, s[32:35], s57 offen offset:3072 lds
    s_load_dword s99, s[24:25], -3712
    s_add_u32 m0, s53, s75
    s_nop 0
    buffer_load_dwordx4 v191, s[32:35], s57 offen offset:0 lds
    buffer_load_dwordx4 v192, s[32:35], s57 offen offset:1024 lds
    s_load_dword s99, s[10:11], -3648
    s_add_u32 m0, s53, s72
    s_nop 0
    buffer_load_dwordx4 v184, s[28:31], s56 offen offset:0 sc1 lds
    buffer_load_dwordx4 v184, s[28:31], s56 offen offset:1024 sc1 lds
    s_load_dword s99, s[24:25], -3648
    buffer_load_dwordx4 v185, s[28:31], s56 offen offset:2048 sc1 lds
    buffer_load_dwordx4 v185, s[28:31], s56 offen offset:3072 sc1 lds
    s_load_dword s99, s[10:11], -2688
    s_add_u32 m0, s53, s73
    s_mov_b32 exec_hi, 0
    buffer_load_dwordx4 v186, s[28:31], s56 offen offset:0 sc1 lds
    s_mov_b32 exec_hi, -1
    s_add_u32 s53, s53, 49152
    s_cmp_ge_u32 s53, 147456
    s_cselect_b32 s53, 0, s53
    s_load_dword s99, s[24:25], -2688
    s_waitcnt vmcnt(11)
    s_barrier
    s_and_b32 s57, s58, 15
    s_lshr_b64 s[58:59], s[58:59], 4
    s_lshl_b32 s56, s57, 11
    s_mul_i32 s57, s57, 0x60000
    s_add_u32 m0, s53, s74
    s_nop 0
    buffer_load_dwordx4 v187, s[32:35], s57 offen offset:0 lds
    buffer_load_dwordx4 v188, s[32:35], s57 offen offset:1024 lds
    s_load_dword s99, s[10:11], -2624
    buffer_load_dwordx4 v189, s[32:35], s57 offen offset:2048 lds
    buffer_load_dwordx4 v190, s[32:35], s57 offen offset:3072 lds
    s_load_dword s99, s[24:25], -2624
    s_add_u32 m0, s53, s75
    s_nop 0
    buffer_load_dwordx4 v191, s[32:35], s57 offen offset:0 lds
    buffer_load_dwordx4 v192, s[32:35], s57 offen offset:1024 lds
    s_load_dword s99, s[10:11], -1664
    s_add_u32 m0, s53, s72
    s_nop 0
    buffer_load_dwordx4 v184, s[28:31], s56 offen offset:0 sc1 lds
    buffer_load_dwordx4 v184, s[28:31], s56 offen offset:1024 sc1 lds
    s_load_dword s99, s[24:25], -1664
    buffer_load_dwordx4 v185, s[28:31], s56 offen offset:2048 sc1 lds
    buffer_load_dwordx4 v185, s[28:31], s56 offen offset:3072 sc1 lds
    s_load_dword s99, s[10:11], -1600
    s_add_u32 m0, s53, s73
    s_mov_b32 exec_hi, 0
    buffer_load_dwordx4 v186, s[28:31], s56 offen offset:0 sc1 lds
    s_mov_b32 exec_hi, -1
    s_add_u32 s53, s53, 49152
    s_cmp_ge_u32 s53, 147456
    s_cselect_b32 s53, 0, s53
    s_load_dword s99, s[24:25], -1600
    s_waitcnt vmcnt(11)
    s_barrier
    s_and_b32 s57, s58, 15
    s_lshr_b64 s[58:59], s[58:59], 4
    s_lshl_b32 s56, s57, 11
    s_mul_i32 s57, s57, 0x60000
    s_add_u32 m0, s53, s74
    s_nop 0
    buffer_load_dwordx4 v187, s[32:35], s57 offen offset:0 lds
    buffer_load_dwordx4 v188, s[32:35], s57 offen offset:1024 lds
    buffer_load_dwordx4 v189, s[32:35], s57 offen offset:2048 lds
    s_load_dword s99, s[10:11], -640
    buffer_load_dwordx4 v190, s[32:35], s57 offen offset:3072 lds
    s_add_u32 m0, s53, s75
    s_nop 0
    buffer_load_dwordx4 v191, s[32:35], s57 offen offset:0 lds
    buffer_load_dwordx4 v192, s[32:35], s57 offen offset:1024 lds
    s_load_dword s99, s[24:25], -640
    s_add_u32 m0, s53, s72
    s_nop 0
    buffer_load_dwordx4 v184, s[28:31], s56 offen offset:0 sc1 lds
    buffer_load_dwordx4 v184, s[28:31], s56 offen offset:1024 sc1 lds
    buffer_load_dwordx4 v185, s[28:31], s56 offen offset:2048 sc1 lds
    s_load_dword s99, s[10:11], -576
    buffer_load_dwordx4 v185, s[28:31], s56 offen offset:3072 sc1 lds
    s_add_u32 m0, s53, s73
    s_mov_b32 exec_hi, 0
    buffer_load_dwordx4 v186, s[28:31], s56 offen offset:0 sc1 lds
    s_mov_b32 exec_hi, -1
    s_add_u32 s53, s53, 49152
    s_cmp_ge_u32 s53, 147456
    s_cselect_b32 s53, 0, s53
    s_load_dword s99, s[24:25], -576
    s_movk_i32 s54, 8
M_Q_loop0:
    s_waitcnt vmcnt(11)
    s_barrier
    s_and_b32 s57, s58, 15
    s_lshr_b64 s[58:59], s[58:59], 4
    s_lshl_b32 s56, s57, 11
    s_mul_i32 s57, s57, 0x60000
    s_add_u32 m0, s53, s74
    s_nop 0
    buffer_load_dwordx4 v187, s[32:35], s57 offen offset:0 lds
    buffer_load_dwordx4 v188, s[32:35], s57 offen offset:1024 lds
    s_load_dword s99, s[10:11], 0
    buffer_load_dwordx4 v189, s[32:35], s57 offen offset:2048 lds
    buffer_load_dwordx4 v190, s[32:35], s57 offen offset:3072 lds
    s_add_u32 m0, s53, s75
    s_nop 0
    buffer_load_dwordx4 v191, s[32:35], s57 offen offset:0 lds
    s_load_dword s99, s[24:25], 0
    buffer_load_dwordx4 v192, s[32:35], s57 offen offset:1024 lds
    s_add_u32 m0, s53, s72
    s_nop 0
    buffer_load_dwordx4 v184, s[28:31], s56 offen offset:0 sc1 lds
    s_load_dword s99, s[10:11], 64
    buffer_load_dwordx4 v184, s[28:31], s56 offen offset:1024 sc1 lds
    buffer_load_dwordx4 v185, s[28:31], s56 offen offset:2048 sc1 lds
    buffer_load_dwordx4 v185, s[28:31], s56 offen offset:3072 sc1 lds
    s_load_dword s99, s[24:25], 64
    s_add_u32 m0, s53, s73
    s_mov_b32 exec_hi, 0
    buffer_load_dwordx4 v186, s[28:31], s56 offen offset:0 sc1 lds
    s_mov_b32 exec_hi, -1
    s_add_u32 s53, s53, 49152
    s_cmp_ge_u32 s53, 147456
    s_cselect_b32 s53, 0, s53
    s_add_u32 s10, s10, 128
    s_addc_u32 s11, s11, 0
    s_add_u32 s24, s24, 128
    s_addc_u32 s25, s25, 0
    s_sub_u32 s54, s54, 1
    s_cbranch_scc0 M_Q_loop0
    s_waitcnt vmcnt(11)
    s_barrier
    s_and_b32 s57, s58, 15
    s_lshr_b64 s[58:59], s[58:59], 4
    s_lshl_b32 s56, s57, 11
    s_mul_i32 s57, s57, 0x60000
    s_add_u32 m0, s53, s74
    s_nop 0
    buffer_load_dwordx4 v187, s[32:35], s57 offen offset:0 lds
    buffer_load_dwordx4 v188, s[32:35], s57 offen offset:1024 lds
    buffer_load_dwordx4 v189, s[32:35], s57 offen offset:2048 lds
    buffer_load_dwordx4 v190, s[32:35], s57 offen offset:3072 lds
    s_add_u32 m0, s53, s75
    s_nop 0
    buffer_load_dwordx4 v191, s[32:35], s57 offen offset:0 lds
    buffer_load_dwordx4 v192, s[32:35], s57 offen offset:1024 lds
    s_add_u32 m0, s53, s72
    s_nop 0
    buffer_load_dwordx4 v184, s[28:31], s56 offen offset:0 sc1 lds
    buffer_load_dwordx4 v184, s[28:31], s56 offen offset:1024 sc1 lds
    buffer_load_dwordx4 v185, s[28:31], s56 offen offset:2048 sc1 lds
    buffer_load_dwordx4 v185, s[28:31], s56 offen offset:3072 sc1 lds
    s_add_u32 m0, s53, s73
    s_mov_b32 exec_hi, 0
    buffer_load_dwordx4 v186, s[28:31], s56 offen offset:0 sc1 lds
    s_mov_b32 exec_hi, -1
    s_add_u32 s53, s53, 49152
    s_cmp_ge_u32 s53, 147456
    s_cselect_b32 s53, 0, s53
    s_mov_b32 s64, 0x120000
    buffer_load_dwordx4 v[44:47], v17, s[36:39], s64 offen
    s_mov_b32 s64, 0x180000
    buffer_load_dwordx4 v[48:51], v17, s[36:39], s64 offen
    s_mov_b32 s64, 0x1e0000
    buffer_load_dwordx4 v[52:55], v17, s[36:39], s64 offen
    s_mov_b32 s64, 0x240000
    buffer_load_dwordx4 v[56:59], v17, s[36:39], s64 offen
    s_mov_b32 s64, 0x2a0000
    buffer_load_dwordx4 v[60:63], v17, s[36:39], s64 offen
    s_lshl_b32 s60, s44, 12
    s_add_u32 s61, s60, 147456
    s_add_u32 s53, s60, 49152
    s_lshl_b32 s70, s44, 11
    s_sub_u32 s70, 16384, s70
    s_bfe_u32 s66, s2, 0x30003
    s_lshr_b32 s55, s2, 6
    s_add_u32 s66, s66, s55
    s_and_b32 s66, s66, 3
    s_mov_b32 s58, 0x76453210
    s_mov_b32 s59, 0xfecdba89
    s_cmp_eq_u32 s66, 1
    s_cselect_b32 s58, 0x75643120, s58
    s_cselect_b32 s59, 0xfdecb9a8, s59
    s_cmp_eq_u32 s66, 2
    s_cselect_b32 s58, 0x67542310, s58
    s_cselect_b32 s59, 0xefdcab98, s59
    s_cmp_eq_u32 s66, 3
    s_cselect_b32 s58, 0x86534210, s58
    s_cselect_b32 s59, 0xfedbca97, s59
    s_mov_b32 s32, s8
    s_mov_b32 s33, s9
    s_mov_b32 s34, 0x200000
    s_mov_b32 s35, 0x20000
    s_waitcnt vmcnt(16)
    s_barrier
    s_waitcnt vmcnt(5)
    s_barrier
    s_barrier
    s_and_b32 s57, s58, 15
    s_lshr_b64 s[58:59], s[58:59], 4
    s_lshl_b32 s56, s57, 11
    s_mul_i32 s57, s57, 0x20000
    s_add_u32 m0, s53, s70
    s_nop 0
    buffer_load_dwordx4 v193, s[32:35], s57 offen offset:0 lds
    buffer_load_dwordx4 v194, s[32:35], s57 offen offset:1024 lds
    s_add_u32 s53, s53, 24576
    s_cmp_ge_u32 s53, s61
    s_cselect_b32 s53, s60, s53
    s_and_b32 s57, s58, 15
    s_lshr_b64 s[58:59], s[58:59], 4
    s_lshl_b32 s56, s57, 11
    s_mul_i32 s57, s57, 0x20000
    s_add_u32 m0, s53, s70
    s_nop 0
    buffer_load_dwordx4 v193, s[32:35], s57 offen offset:0 lds
    buffer_load_dwordx4 v194, s[32:35], s57 offen offset:1024 lds
    s_add_u32 s53, s53, 24576
    s_cmp_ge_u32 s53, s61
    s_cselect_b32 s53, s60, s53
    s_mov_b32 s40, s8
    s_mov_b32 s41, s9
    s_mov_b32 s42, 0x200000
    s_mov_b32 s43, 0x20000
    s_mov_b32 s64, 0x0
    buffer_load_dword v244, v243, s[40:43], s64 offen
    v_lshlrev_b32 v24, 16, v24
    v_lshlrev_b32 v25, 16, v25
    v_lshlrev_b32 v26, 16, v26
    v_lshlrev_b32 v27, 16, v27
    v_lshlrev_b32 v28, 16, v28
    v_lshlrev_b32 v29, 16, v29
    v_lshlrev_b32 v30, 16, v30
    v_lshlrev_b32 v31, 16, v31
    v_mul_f32 v72, 0xbfb8aa3b, v24
    v_mul_f32 v73, 0xbfb8aa3b, v25
    v_mul_f32 v74, 0xbfb8aa3b, v26
    v_mul_f32 v75, 0xbfb8aa3b, v27
    v_mul_f32 v76, 0xbfb8aa3b, v28
    v_mul_f32 v77, 0xbfb8aa3b, v29
    v_mul_f32 v78, 0xbfb8aa3b, v30
    v_mul_f32 v79, 0xbfb8aa3b, v31
    v_exp_f32 v72, v72
    v_exp_f32 v73, v73
    v_exp_f32 v74, v74
    v_exp_f32 v75, v75
    v_exp_f32 v76, v76
    v_exp_f32 v77, v77
    v_exp_f32 v78, v78
    v_exp_f32 v79, v79
    v_add_f32 v72, 1.0, v72
    v_add_f32 v73, 1.0, v73
    v_add_f32 v74, 1.0, v74
    v_add_f32 v75, 1.0, v75
    v_add_f32 v76, 1.0, v76
    v_add_f32 v77, 1.0, v77
    v_add_f32 v78, 1.0, v78
    v_add_f32 v79, 1.0, v79
    v_rcp_f32 v72, v72
    v_rcp_f32 v73, v73
    v_rcp_f32 v74, v74
    v_rcp_f32 v75, v75
    v_rcp_f32 v76, v76
    v_rcp_f32 v77, v77
    v_rcp_f32 v78, v78
    v_rcp_f32 v79, v79
    v_mul_f32 v24, v24, v72
    v_mul_f32 v25, v25, v73
    v_mul_f32 v26, v26, v74
    v_mul_f32 v27, v27, v75
    v_mul_f32 v28, v28, v76
    v_mul_f32 v29, v29, v77
    v_mul_f32 v30, v30, v78
    v_mul_f32 v31, v31, v79
    v_cvt_pk_bf16_f32 v72, v24, v24
    v_lshlrev_b32 v24, 16, v72
    v_cvt_pk_bf16_f32 v73, v25, v25
    v_lshlrev_b32 v25, 16, v73
    v_cvt_pk_bf16_f32 v74, v26, v26
    v_lshlrev_b32 v26, 16, v74
    v_cvt_pk_bf16_f32 v75, v27, v27
    v_lshlrev_b32 v27, 16, v75
    v_cvt_pk_bf16_f32 v76, v28, v28
    v_lshlrev_b32 v28, 16, v76
    v_cvt_pk_bf16_f32 v77, v29, v29
    v_lshlrev_b32 v29, 16, v77
    v_cvt_pk_bf16_f32 v78, v30, v30
    v_lshlrev_b32 v30, 16, v78
    v_cvt_pk_bf16_f32 v79, v31, v31
    v_lshlrev_b32 v31, 16, v79
    v_lshlrev_b32 v72, 16, v32
    v_and_b32 v73, 0xffff0000, v32
    v_lshlrev_b32 v74, 16, v33
    v_and_b32 v75, 0xffff0000, v33
    v_lshlrev_b32 v76, 16, v34
    v_and_b32 v77, 0xffff0000, v34
    v_lshlrev_b32 v78, 16, v35
    v_and_b32 v79, 0xffff0000, v35
    v_mul_f32 v64, v24, v72
    v_mul_f32 v65, v24, v73
    v_mul_f32 v66, v24, v74
    v_mul_f32 v67, v24, v75
    v_mul_f32 v68, v24, v76
    v_mul_f32 v69, v24, v77
    v_mul_f32 v70, v24, v78
    v_mul_f32 v71, v24, v79
    v_lshlrev_b32 v72, 16, v36
    v_and_b32 v73, 0xffff0000, v36
    v_lshlrev_b32 v74, 16, v37
    v_and_b32 v75, 0xffff0000, v37
    v_lshlrev_b32 v76, 16, v38
    v_and_b32 v77, 0xffff0000, v38
    v_lshlrev_b32 v78, 16, v39
    v_and_b32 v79, 0xffff0000, v39
    v_fmac_f32 v64, v25, v72
    v_fmac_f32 v65, v25, v73
    v_fmac_f32 v66, v25, v74
    v_fmac_f32 v67, v25, v75
    v_fmac_f32 v68, v25, v76
    v_fmac_f32 v69, v25, v77
    v_fmac_f32 v70, v25, v78
    v_fmac_f32 v71, v25, v79
    v_lshlrev_b32 v72, 16, v40
    v_and_b32 v73, 0xffff0000, v40
    v_lshlrev_b32 v74, 16, v41
    v_and_b32 v75, 0xffff0000, v41
    v_lshlrev_b32 v76, 16, v42
    v_and_b32 v77, 0xffff0000, v42
    v_lshlrev_b32 v78, 16, v43
    v_and_b32 v79, 0xffff0000, v43
    v_fmac_f32 v64, v26, v72
    v_fmac_f32 v65, v26, v73
    v_fmac_f32 v66, v26, v74
    v_fmac_f32 v67, v26, v75
    v_fmac_f32 v68, v26, v76
    v_fmac_f32 v69, v26, v77
    v_fmac_f32 v70, v26, v78
    v_fmac_f32 v71, v26, v79
    s_waitcnt vmcnt(9)
    v_lshlrev_b32 v72, 16, v44
    v_and_b32 v73, 0xffff0000, v44
    v_lshlrev_b32 v74, 16, v45
    v_and_b32 v75, 0xffff0000, v45
    v_lshlrev_b32 v76, 16, v46
    v_and_b32 v77, 0xffff0000, v46
    v_lshlrev_b32 v78, 16, v47
    v_and_b32 v79, 0xffff0000, v47
    v_fmac_f32 v64, v27, v72
    v_fmac_f32 v65, v27, v73
    v_fmac_f32 v66, v27, v74
    v_fmac_f32 v67, v27, v75
    v_fmac_f32 v68, v27, v76
    v_fmac_f32 v69, v27, v77
    v_fmac_f32 v70, v27, v78
    v_fmac_f32 v71, v27, v79
    s_waitcnt vmcnt(8)
    v_lshlrev_b32 v72, 16, v48
    v_and_b32 v73, 0xffff0000, v48
    v_lshlrev_b32 v74, 16, v49
    v_and_b32 v75, 0xffff0000, v49
    v_lshlrev_b32 v76, 16, v50
    v_and_b32 v77, 0xffff0000, v50
    v_lshlrev_b32 v78, 16, v51
    v_and_b32 v79, 0xffff0000, v51
    v_fmac_f32 v64, v28, v72
    v_fmac_f32 v65, v28, v73
    v_fmac_f32 v66, v28, v74
    v_fmac_f32 v67, v28, v75
    v_fmac_f32 v68, v28, v76
    v_fmac_f32 v69, v28, v77
    v_fmac_f32 v70, v28, v78
    v_fmac_f32 v71, v28, v79
    s_waitcnt vmcnt(7)
    v_lshlrev_b32 v72, 16, v52
    v_and_b32 v73, 0xffff0000, v52
    v_lshlrev_b32 v74, 16, v53
    v_and_b32 v75, 0xffff0000, v53
    v_lshlrev_b32 v76, 16, v54
    v_and_b32 v77, 0xffff0000, v54
    v_lshlrev_b32 v78, 16, v55
    v_and_b32 v79, 0xffff0000, v55
    v_fmac_f32 v64, v29, v72
    v_fmac_f32 v65, v29, v73
    v_fmac_f32 v66, v29, v74
    v_fmac_f32 v67, v29, v75
    v_fmac_f32 v68, v29, v76
    v_fmac_f32 v69, v29, v77
    v_fmac_f32 v70, v29, v78
    v_fmac_f32 v71, v29, v79
    s_waitcnt vmcnt(6)
    v_lshlrev_b32 v72, 16, v56
    v_and_b32 v73, 0xffff0000, v56
    v_lshlrev_b32 v74, 16, v57
    v_and_b32 v75, 0xffff0000, v57
    v_lshlrev_b32 v76, 16, v58
    v_and_b32 v77, 0xffff0000, v58
    v_lshlrev_b32 v78, 16, v59
    v_and_b32 v79, 0xffff0000, v59
    v_fmac_f32 v64, v30, v72
    v_fmac_f32 v65, v30, v73
    v_fmac_f32 v66, v30, v74
    v_fmac_f32 v67, v30, v75
    v_fmac_f32 v68, v30, v76
    v_fmac_f32 v69, v30, v77
    v_fmac_f32 v70, v30, v78
    v_fmac_f32 v71, v30, v79
    s_waitcnt vmcnt(5)
    v_lshlrev_b32 v72, 16, v60
    v_and_b32 v73, 0xffff0000, v60
    v_lshlrev_b32 v74, 16, v61
    v_and_b32 v75, 0xffff0000, v61
    v_lshlrev_b32 v76, 16, v62
    v_and_b32 v77, 0xffff0000, v62
    v_lshlrev_b32 v78, 16, v63
    v_and_b32 v79, 0xffff0000, v63
    v_fmac_f32 v64, v31, v72
    v_fmac_f32 v65, v31, v73
    v_fmac_f32 v66, v31, v74
    v_fmac_f32 v67, v31, v75
    v_fmac_f32 v68, v31, v76
    v_fmac_f32 v69, v31, v77
    v_fmac_f32 v70, v31, v78
    v_fmac_f32 v71, v31, v79
    v_add_f32_dpp v64, v64, v64 row_ror:8 row_mask:0xf bank_mask:0xf
    v_add_f32_dpp v65, v65, v65 row_ror:8 row_mask:0xf bank_mask:0xf
    v_add_f32_dpp v66, v66, v66 row_ror:8 row_mask:0xf bank_mask:0xf
    v_add_f32_dpp v67, v67, v67 row_ror:8 row_mask:0xf bank_mask:0xf
    v_add_f32_dpp v68, v68, v68 row_ror:8 row_mask:0xf bank_mask:0xf
    v_add_f32_dpp v69, v69, v69 row_ror:8 row_mask:0xf bank_mask:0xf
    v_add_f32_dpp v70, v70, v70 row_ror:8 row_mask:0xf bank_mask:0xf
    v_add_f32_dpp v71, v71, v71 row_ror:8 row_mask:0xf bank_mask:0xf
    v_mov_b32 v72, v64
    v_mov_b32 v73, v65
    v_mov_b32 v74, v66
    v_mov_b32 v75, v67
    v_mov_b32 v76, v68
    v_mov_b32 v77, v69
    v_mov_b32 v78, v70
    v_mov_b32 v79, v71
    v_permlane32_swap_b32 v64, v72
    v_permlane32_swap_b32 v65, v73
    v_permlane32_swap_b32 v66, v74
    v_permlane32_swap_b32 v67, v75
    v_permlane32_swap_b32 v68, v76
    v_permlane32_swap_b32 v69, v77
    v_permlane32_swap_b32 v70, v78
    v_permlane32_swap_b32 v71, v79
    v_add_f32 v64, v64, v72
    v_add_f32 v65, v65, v73
    v_add_f32 v66, v66, v74
    v_add_f32 v67, v67, v75
    v_add_f32 v68, v68, v76
    v_add_f32 v69, v69, v77
    v_add_f32 v70, v70, v78
    v_add_f32 v71, v71, v79
    v_mov_b32 v72, v64
    v_mov_b32 v73, v65
    v_mov_b32 v74, v66
    v_mov_b32 v75, v67
    v_mov_b32 v76, v68
    v_mov_b32 v77, v69
    v_mov_b32 v78, v70
    v_mov_b32 v79, v71
    v_permlane16_swap_b32 v64, v72
    v_permlane16_swap_b32 v65, v73
    v_permlane16_swap_b32 v66, v74
    v_permlane16_swap_b32 v67, v75
    v_permlane16_swap_b32 v68, v76
    v_permlane16_swap_b32 v69, v77
    v_permlane16_swap_b32 v70, v78
    v_permlane16_swap_b32 v71, v79
    v_add_f32 v64, v64, v72
    v_add_f32 v65, v65, v73
    v_add_f32 v66, v66, v74
    v_add_f32 v67, v67, v75
    v_add_f32 v68, v68, v76
    v_add_f32 v69, v69, v77
    v_add_f32 v70, v70, v78
    v_add_f32 v71, v71, v79
    s_lshl_b32 s64, s44, 8
    s_add_u32 s64, s64, 147456
    v_and_b32 v72, 7, v0
    v_lshl_add_u32 v72, v72, 5, s64
    ds_write_b128 v72, v[64:67]
    ds_write_b128 v72, v[68:71] offset:16
    v_mov_b32 v73, 148480
    v_mov_b32 v74, 1
    s_waitcnt lgkmcnt(0)
    s_mov_b64 exec, 1
    ds_add_rtn_u32 v75, v73, v74
    s_mov_b64 exec, -1
    v_add_u32 v73, 147456, v234
    s_waitcnt lgkmcnt(0)
    ds_read_b32 v64, v73 offset:0
    ds_read_b32 v65, v73 offset:256
    ds_read_b32 v66, v73 offset:512
    ds_read_b32 v67, v73 offset:768
    v_readfirstlane_b32 s64, v75
    s_nop 3
    s_cmp_eq_u32 s64, 3
    s_cselect_b32 s76, s76, 0x80000000
    v_lshl_add_u32 v72, v1, 3, s76
    s_waitcnt lgkmcnt(0)
    v_add_f32 v64, v64, v65
    v_add_f32 v66, v66, v67
    v_add_f32 v64, v64, v66
    v_mov_b32 v65, s0
    buffer_store_dwordx2 v[64:65], v72, s[28:31], 0 offen sc1
    s_mov_b32 s40, s4
    s_mov_b32 s41, s5
    s_mov_b32 s42, 0x400000
    s_mov_b32 s43, 0x20000
    s_mov_b32 s64, 0x8000
    buffer_load_dwordx4 v[88:91], v196, s[40:43], 0 offen offset:0
    buffer_load_dwordx4 v[92:95], v196, s[40:43], 0 offen offset:64
    buffer_load_dwordx4 v[96:99], v196, s[40:43], s64 offen offset:0
    buffer_load_dwordx4 v[100:103], v196, s[40:43], s64 offen offset:64
    s_and_b32 s57, s58, 15
    s_lshr_b64 s[58:59], s[58:59], 4
    s_lshl_b32 s56, s57, 11
    s_mul_i32 s57, s57, 0x20000
    s_add_u32 m0, s53, s70
    s_nop 0
    buffer_load_dwordx4 v193, s[32:35], s57 offen offset:0 lds
    buffer_load_dwordx4 v194, s[32:35], s57 offen offset:1024 lds
    s_add_u32 s53, s53, 24576
    s_cmp_ge_u32 s53, s61
    s_cselect_b32 s53, s60, s53
    s_and_b32 s57, s58, 15
    s_lshr_b64 s[58:59], s[58:59], 4
    s_lshl_b32 s56, s57, 11
    s_mul_i32 s57, s57, 0x20000
    s_add_u32 m0, s53, s70
    s_nop 0
    buffer_load_dwordx4 v193, s[32:35], s57 offen offset:0 lds
    buffer_load_dwordx4 v194, s[32:35], s57 offen offset:1024 lds
    s_add_u32 s53, s53, 24576
    s_cmp_ge_u32 s53, s61
    s_cselect_b32 s53, s60, s53
    s_and_b32 s57, s58, 15
    s_lshr_b64 s[58:59], s[58:59], 4
    s_lshl_b32 s56, s57, 11
    s_mul_i32 s57, s57, 0x20000
    s_add_u32 m0, s53, s70
    s_nop 0
    buffer_load_dwordx4 v193, s[32:35], s57 offen offset:0 lds
    buffer_load_dwordx4 v194, s[32:35], s57 offen offset:1024 lds
    s_add_u32 s53, s53, 24576
    s_cmp_ge_u32 s53, s61
    s_cselect_b32 s53, s60, s53
    s_and_b32 s57, s58, 15
    s_lshr_b64 s[58:59], s[58:59], 4
    s_lshl_b32 s56, s57, 11
    s_mul_i32 s57, s57, 0x20000
    s_add_u32 m0, s53, s70
    s_nop 0
    buffer_load_dwordx4 v193, s[32:35], s57 offen offset:0 lds
    buffer_load_dwordx4 v194, s[32:35], s57 offen offset:1024 lds
    s_add_u32 s53, s53, 24576
    s_cmp_ge_u32 s53, s61
    s_cselect_b32 s53, s60, s53
    s_lshl_b32 s60, s44, 12
    s_add_u32 s61, s60, 147456
    s_add_u32 s53, s60, 0
    s_bfe_u32 s66, s2, 0x30003
    s_lshr_b32 s55, s2, 6
    s_add_u32 s66, s66, s55
    s_and_b32 s66, s66, 3
    s_mov_b32 s58, 0x76453210
    s_mov_b32 s59, 0xfecdba89
    s_cmp_eq_u32 s66, 1
    s_cselect_b32 s58, 0x75643120, s58
    s_cselect_b32 s59, 0xfdecb9a8, s59
    s_cmp_eq_u32 s66, 2
    s_cselect_b32 s58, 0x67542310, s58
    s_cselect_b32 s59, 0xefdcab98, s59
    s_cmp_eq_u32 s66, 3
    s_cselect_b32 s58, 0x86534210, s58
    s_cselect_b32 s59, 0xfedbca97, s59
    s_and_b32 s66, s48, 15
    s_lshl_b32 s55, s66, 2
    s_lshr_b64 s[56:57], s[58:59], s55
    s_and_b32 s55, s56, 15
    s_lshl_b32 s55, s55, 2
    s_lshl_b64 s[56:57], 15, s55
    s_andn2_b64 s[58:59], s[58:59], s[56:57]
    s_or_b32 s58, s58, s66
    s_mov_b32 s32, s12
    s_mov_b32 s33, s13
    s_mov_b32 s34, 0x700000
    s_mov_b32 s35, 0x20000
    s_mov_b32 s36, s14
    s_mov_b32 s37, s15
    s_mov_b32 s38, 0x700000
    s_mov_b32 s39, 0x20000
    s_mov_b32 s72, 0xb00000
    s_mov_b32 s74, 0x1000000
    s_mov_b32 s73, 0xb08000
    s_mov_b32 s75, 0x1008000
    s_lshl_b32 s76, s48, 8
    s_waitcnt vmcnt(8)
    v_permlane16_swap_b32 v88, v90
    v_permlane16_swap_b32 v89, v91
    v_permlane16_swap_b32 v92, v94
    v_permlane16_swap_b32 v93, v95
    v_permlane16_swap_b32 v96, v98
    v_permlane16_swap_b32 v97, v99
    v_permlane16_swap_b32 v100, v102
    v_permlane16_swap_b32 v101, v103
    v_lshlrev_b32 v104, 16, v88
    v_and_b32 v105, 0xffff0000, v88
    v_lshlrev_b32 v106, 16, v89
    v_and_b32 v107, 0xffff0000, v89
    v_lshlrev_b32 v108, 16, v90
    v_and_b32 v109, 0xffff0000, v90
    v_lshlrev_b32 v110, 16, v91
    v_and_b32 v111, 0xffff0000, v91
    v_lshlrev_b32 v112, 16, v92
    v_and_b32 v113, 0xffff0000, v92
    v_lshlrev_b32 v114, 16, v93
    v_and_b32 v115, 0xffff0000, v93
    v_lshlrev_b32 v116, 16, v94
    v_and_b32 v117, 0xffff0000, v94
    v_lshlrev_b32 v118, 16, v95
    v_and_b32 v119, 0xffff0000, v95
    v_lshlrev_b32 v120, 16, v96
    v_and_b32 v121, 0xffff0000, v96
    v_lshlrev_b32 v122, 16, v97
    v_and_b32 v123, 0xffff0000, v97
    v_lshlrev_b32 v124, 16, v98
    v_and_b32 v125, 0xffff0000, v98
    v_lshlrev_b32 v126, 16, v99
    v_and_b32 v127, 0xffff0000, v99
    v_lshlrev_b32 v128, 16, v100
    v_and_b32 v129, 0xffff0000, v100
    v_lshlrev_b32 v130, 16, v101
    v_and_b32 v131, 0xffff0000, v101
    v_lshlrev_b32 v132, 16, v102
    v_and_b32 v133, 0xffff0000, v102
    v_lshlrev_b32 v134, 16, v103
    v_and_b32 v135, 0xffff0000, v103
    s_setprio 2
    s_barrier
    s_barrier
    ds_read_b128 v[40:43], v232 offset:0
    ds_read_b64_tr_b16 v[48:49], v235 offset:0
    ds_read_b64_tr_b16 v[50:51], v235 offset:2048
    ds_read_b64_tr_b16 v[52:53], v236 offset:0
    ds_read_b64_tr_b16 v[54:55], v236 offset:2048
    ds_read_b64_tr_b16 v[56:57], v237 offset:0
    ds_read_b64_tr_b16 v[58:59], v237 offset:2048
    ds_read_b64_tr_b16 v[60:61], v238 offset:0
    ds_read_b64_tr_b16 v[62:63], v238 offset:2048
    ds_read_b128 v[44:47], v232 offset:2048
    s_add_u32 s52, s52, 24576
    s_cmp_ge_u32 s52, 147456
    s_cselect_b32 s52, 0, s52
    s_waitcnt lgkmcnt(0)
    v_mfma_f32_16x16x32_bf16 v[8:11], v[48:51], v[40:43], 0
    ds_read_b128 v[64:67], v232 offset:1024
    ds_read_b64_tr_b16 v[72:73], v235 offset:4096
    v_mfma_f32_16x16x32_bf16 v[12:15], v[52:55], v[40:43], 0
    ds_read_b64_tr_b16 v[74:75], v235 offset:6144
    ds_read_b64_tr_b16 v[76:77], v236 offset:4096
    v_mfma_f32_16x16x32_bf16 v[16:19], v[56:59], v[40:43], 0
    ds_read_b64_tr_b16 v[78:79], v236 offset:6144
    ds_read_b64_tr_b16 v[80:81], v237 offset:4096
    v_mfma_f32_16x16x32_bf16 v[20:23], v[60:63], v[40:43], 0
    ds_read_b64_tr_b16 v[82:83], v237 offset:6144
    ds_read_b64_tr_b16 v[84:85], v238 offset:4096
    v_mfma_f32_16x16x32_bf16 v[24:27], v[48:51], v[44:47], 0
    ds_read_b64_tr_b16 v[86:87], v238 offset:6144
    ds_read_b128 v[68:71], v232 offset:3072
    v_mfma_f32_16x16x32_bf16 v[28:31], v[52:55], v[44:47], 0
    v_add_u32 v232, s52, v233
    v_add_u32 v235, s52, v239
    v_mfma_f32_16x16x32_bf16 v[32:35], v[56:59], v[44:47], 0
    v_add_u32 v236, s52, v240
    v_add_u32 v237, s52, v241
    v_mfma_f32_16x16x32_bf16 v[36:39], v[60:63], v[44:47], 0
    v_add_u32 v238, s52, v242
    s_waitcnt lgkmcnt(0)
    v_mfma_f32_16x16x32_bf16 v[8:11], v[72:75], v[64:67], v[8:11]
    s_barrier
    v_mfma_f32_16x16x32_bf16 v[12:15], v[76:79], v[64:67], v[12:15]
    ds_read_b128 v[40:43], v232 offset:0
    ds_read_b64_tr_b16 v[48:49], v235 offset:0
    ds_read_b64_tr_b16 v[50:51], v235 offset:2048
    v_mfma_f32_16x16x32_bf16 v[16:19], v[80:83], v[64:67], v[16:19]
    ds_read_b64_tr_b16 v[52:53], v236 offset:0
    ds_read_b64_tr_b16 v[54:55], v236 offset:2048
    v_mfma_f32_16x16x32_bf16 v[20:23], v[84:87], v[64:67], v[20:23]
    ds_read_b64_tr_b16 v[56:57], v237 offset:0
    ds_read_b64_tr_b16 v[58:59], v237 offset:2048
    ds_read_b64_tr_b16 v[60:61], v238 offset:0
    v_mfma_f32_16x16x32_bf16 v[24:27], v[72:75], v[68:71], v[24:27]
    ds_read_b64_tr_b16 v[62:63], v238 offset:2048
    ds_read_b128 v[44:47], v232 offset:2048
    v_mfma_f32_16x16x32_bf16 v[28:31], v[76:79], v[68:71], v[28:31]
    v_mfma_f32_16x16x32_bf16 v[32:35], v[80:83], v[68:71], v[32:35]
    s_add_u32 s52, s52, 24576
    s_cmp_ge_u32 s52, 147456
    s_cselect_b32 s52, 0, s52
    v_mfma_f32_16x16x32_bf16 v[36:39], v[84:87], v[68:71], v[36:39]
    s_waitcnt lgkmcnt(0)
    v_mfma_f32_16x16x32_bf16 v[8:11], v[48:51], v[40:43], v[8:11]
    ds_read_b128 v[64:67], v232 offset:1024
    ds_read_b64_tr_b16 v[72:73], v235 offset:4096
    v_mfma_f32_16x16x32_bf16 v[12:15], v[52:55], v[40:43], v[12:15]
    ds_read_b64_tr_b16 v[74:75], v235 offset:6144
    ds_read_b64_tr_b16 v[76:77], v236 offset:4096
    v_mfma_f32_16x16x32_bf16 v[16:19], v[56:59], v[40:43], v[16:19]
    ds_read_b64_tr_b16 v[78:79], v236 offset:6144
    ds_read_b64_tr_b16 v[80:81], v237 offset:4096
    v_mfma_f32_16x16x32_bf16 v[20:23], v[60:63], v[40:43], v[20:23]
    ds_read_b64_tr_b16 v[82:83], v237 offset:6144
    ds_read_b64_tr_b16 v[84:85], v238 offset:4096
    v_mfma_f32_16x16x32_bf16 v[24:27], v[48:51], v[44:47], v[24:27]
    ds_read_b64_tr_b16 v[86:87], v238 offset:6144
    ds_read_b128 v[68:71], v232 offset:3072
    v_mfma_f32_16x16x32_bf16 v[28:31], v[52:55], v[44:47], v[28:31]
    v_add_u32 v232, s52, v233
    v_add_u32 v235, s52, v239
    v_mfma_f32_16x16x32_bf16 v[32:35], v[56:59], v[44:47], v[32:35]
    v_add_u32 v236, s52, v240
    v_add_u32 v237, s52, v241
    v_mfma_f32_16x16x32_bf16 v[36:39], v[60:63], v[44:47], v[36:39]
    v_add_u32 v238, s52, v242
    s_waitcnt lgkmcnt(0)
    v_mfma_f32_16x16x32_bf16 v[8:11], v[72:75], v[64:67], v[8:11]
    s_waitcnt vmcnt(6)
    s_barrier
    v_mfma_f32_16x16x32_bf16 v[12:15], v[76:79], v[64:67], v[12:15]
    ds_read_b128 v[40:43], v232 offset:0
    ds_read_b64_tr_b16 v[48:49], v235 offset:0
    ds_read_b64_tr_b16 v[50:51], v235 offset:2048
    v_mfma_f32_16x16x32_bf16 v[16:19], v[80:83], v[64:67], v[16:19]
    ds_read_b64_tr_b16 v[52:53], v236 offset:0
    ds_read_b64_tr_b16 v[54:55], v236 offset:2048
    v_mfma_f32_16x16x32_bf16 v[20:23], v[84:87], v[64:67], v[20:23]
    ds_read_b64_tr_b16 v[56:57], v237 offset:0
    ds_read_b64_tr_b16 v[58:59], v237 offset:2048
    ds_read_b64_tr_b16 v[60:61], v238 offset:0
    v_mfma_f32_16x16x32_bf16 v[24:27], v[72:75], v[68:71], v[24:27]
    ds_read_b64_tr_b16 v[62:63], v238 offset:2048
    ds_read_b128 v[44:47], v232 offset:2048
    v_mfma_f32_16x16x32_bf16 v[28:31], v[76:79], v[68:71], v[28:31]
    v_mfma_f32_16x16x32_bf16 v[32:35], v[80:83], v[68:71], v[32:35]
    s_add_u32 s52, s52, 24576
    s_cmp_ge_u32 s52, 147456
    s_cselect_b32 s52, 0, s52
    v_mfma_f32_16x16x32_bf16 v[36:39], v[84:87], v[68:71], v[36:39]
    s_waitcnt lgkmcnt(0)
    v_mfma_f32_16x16x32_bf16 v[8:11], v[48:51], v[40:43], v[8:11]
    ds_read_b128 v[64:67], v232 offset:1024
    ds_read_b64_tr_b16 v[72:73], v235 offset:4096
    v_mfma_f32_16x16x32_bf16 v[12:15], v[52:55], v[40:43], v[12:15]
    ds_read_b64_tr_b16 v[74:75], v235 offset:6144
    ds_read_b64_tr_b16 v[76:77], v236 offset:4096
    v_mfma_f32_16x16x32_bf16 v[16:19], v[56:59], v[40:43], v[16:19]
    ds_read_b64_tr_b16 v[78:79], v236 offset:6144
    ds_read_b64_tr_b16 v[80:81], v237 offset:4096
    v_mfma_f32_16x16x32_bf16 v[20:23], v[60:63], v[40:43], v[20:23]
    ds_read_b64_tr_b16 v[82:83], v237 offset:6144
    ds_read_b64_tr_b16 v[84:85], v238 offset:4096
    v_mfma_f32_16x16x32_bf16 v[24:27], v[48:51], v[44:47], v[24:27]
    ds_read_b64_tr_b16 v[86:87], v238 offset:6144
    ds_read_b128 v[68:71], v232 offset:3072
    v_mfma_f32_16x16x32_bf16 v[28:31], v[52:55], v[44:47], v[28:31]
    v_add_u32 v232, s52, v233
    v_add_u32 v235, s52, v239
    v_mfma_f32_16x16x32_bf16 v[32:35], v[56:59], v[44:47], v[32:35]
    v_add_u32 v236, s52, v240
    v_add_u32 v237, s52, v241
    v_mfma_f32_16x16x32_bf16 v[36:39], v[60:63], v[44:47], v[36:39]
    v_add_u32 v238, s52, v242
    s_waitcnt lgkmcnt(0)
    v_mfma_f32_16x16x32_bf16 v[8:11], v[72:75], v[64:67], v[8:11]
    s_waitcnt vmcnt(4)
    s_barrier
    v_mfma_f32_16x16x32_bf16 v[12:15], v[76:79], v[64:67], v[12:15]
    ds_read_b128 v[40:43], v232 offset:0
    ds_read_b64_tr_b16 v[48:49], v235 offset:0
    ds_read_b64_tr_b16 v[50:51], v235 offset:2048
    v_mfma_f32_16x16x32_bf16 v[16:19], v[80:83], v[64:67], v[16:19]
    ds_read_b64_tr_b16 v[52:53], v236 offset:0
    ds_read_b64_tr_b16 v[54:55], v236 offset:2048
    v_mfma_f32_16x16x32_bf16 v[20:23], v[84:87], v[64:67], v[20:23]
    ds_read_b64_tr_b16 v[56:57], v237 offset:0
    ds_read_b64_tr_b16 v[58:59], v237 offset:2048
    ds_read_b64_tr_b16 v[60:61], v238 offset:0
    v_mfma_f32_16x16x32_bf16 v[24:27], v[72:75], v[68:71], v[24:27]
    ds_read_b64_tr_b16 v[62:63], v238 offset:2048
    ds_read_b128 v[44:47], v232 offset:2048
    v_mfma_f32_16x16x32_bf16 v[28:31], v[76:79], v[68:71], v[28:31]
    v_mfma_f32_16x16x32_bf16 v[32:35], v[80:83], v[68:71], v[32:35]
    s_add_u32 s52, s52, 24576
    s_cmp_ge_u32 s52, 147456
    s_cselect_b32 s52, 0, s52
    v_mfma_f32_16x16x32_bf16 v[36:39], v[84:87], v[68:71], v[36:39]
    s_waitcnt lgkmcnt(0)
    v_mfma_f32_16x16x32_bf16 v[8:11], v[48:51], v[40:43], v[8:11]
    ds_read_b128 v[64:67], v232 offset:1024
    ds_read_b64_tr_b16 v[72:73], v235 offset:4096
    v_mfma_f32_16x16x32_bf16 v[12:15], v[52:55], v[40:43], v[12:15]
    ds_read_b64_tr_b16 v[74:75], v235 offset:6144
    ds_read_b64_tr_b16 v[76:77], v236 offset:4096
    v_mfma_f32_16x16x32_bf16 v[16:19], v[56:59], v[40:43], v[16:19]
    ds_read_b64_tr_b16 v[78:79], v236 offset:6144
    ds_read_b64_tr_b16 v[80:81], v237 offset:4096
    v_mfma_f32_16x16x32_bf16 v[20:23], v[60:63], v[40:43], v[20:23]
    ds_read_b64_tr_b16 v[82:83], v237 offset:6144
    ds_read_b64_tr_b16 v[84:85], v238 offset:4096
    v_mfma_f32_16x16x32_bf16 v[24:27], v[48:51], v[44:47], v[24:27]
    ds_read_b64_tr_b16 v[86:87], v238 offset:6144
    ds_read_b128 v[68:71], v232 offset:3072
    v_mfma_f32_16x16x32_bf16 v[28:31], v[52:55], v[44:47], v[28:31]
    v_add_u32 v232, s52, v233
    v_add_u32 v235, s52, v239
    v_mfma_f32_16x16x32_bf16 v[32:35], v[56:59], v[44:47], v[32:35]
    v_add_u32 v236, s52, v240
    v_add_u32 v237, s52, v241
    v_mfma_f32_16x16x32_bf16 v[36:39], v[60:63], v[44:47], v[36:39]
    v_add_u32 v238, s52, v242
    s_waitcnt lgkmcnt(0)
    v_mfma_f32_16x16x32_bf16 v[8:11], v[72:75], v[64:67], v[8:11]
    s_waitcnt vmcnt(2)
    s_barrier
    v_mfma_f32_16x16x32_bf16 v[12:15], v[76:79], v[64:67], v[12:15]
    ds_read_b128 v[40:43], v232 offset:0
    ds_read_b64_tr_b16 v[48:49], v235 offset:0
    ds_read_b64_tr_b16 v[50:51], v235 offset:2048
    v_mfma_f32_16x16x32_bf16 v[16:19], v[80:83], v[64:67], v[16:19]
    ds_read_b64_tr_b16 v[52:53], v236 offset:0
    ds_read_b64_tr_b16 v[54:55], v236 offset:2048
    v_mfma_f32_16x16x32_bf16 v[20:23], v[84:87], v[64:67], v[20:23]
    ds_read_b64_tr_b16 v[56:57], v237 offset:0
    ds_read_b64_tr_b16 v[58:59], v237 offset:2048
    ds_read_b64_tr_b16 v[60:61], v238 offset:0
    v_mfma_f32_16x16x32_bf16 v[24:27], v[72:75], v[68:71], v[24:27]
    ds_read_b64_tr_b16 v[62:63], v238 offset:2048
    ds_read_b128 v[44:47], v232 offset:2048
    v_mfma_f32_16x16x32_bf16 v[28:31], v[76:79], v[68:71], v[28:31]
    v_mfma_f32_16x16x32_bf16 v[32:35], v[80:83], v[68:71], v[32:35]
    s_add_u32 s52, s52, 24576
    s_cmp_ge_u32 s52, 147456
    s_cselect_b32 s52, 0, s52
    v_mfma_f32_16x16x32_bf16 v[36:39], v[84:87], v[68:71], v[36:39]
    s_waitcnt lgkmcnt(0)
    v_mfma_f32_16x16x32_bf16 v[8:11], v[48:51], v[40:43], v[8:11]
    ds_read_b128 v[64:67], v232 offset:1024
    ds_read_b64_tr_b16 v[72:73], v235 offset:4096
    v_mfma_f32_16x16x32_bf16 v[12:15], v[52:55], v[40:43], v[12:15]
    ds_read_b64_tr_b16 v[74:75], v235 offset:6144
    ds_read_b64_tr_b16 v[76:77], v236 offset:4096
    v_mfma_f32_16x16x32_bf16 v[16:19], v[56:59], v[40:43], v[16:19]
    ds_read_b64_tr_b16 v[78:79], v236 offset:6144
    ds_read_b64_tr_b16 v[80:81], v237 offset:4096
    v_mfma_f32_16x16x32_bf16 v[20:23], v[60:63], v[40:43], v[20:23]
    ds_read_b64_tr_b16 v[82:83], v237 offset:6144
    ds_read_b64_tr_b16 v[84:85], v238 offset:4096
    v_mfma_f32_16x16x32_bf16 v[24:27], v[48:51], v[44:47], v[24:27]
    ds_read_b64_tr_b16 v[86:87], v238 offset:6144
    ds_read_b128 v[68:71], v232 offset:3072
    v_mfma_f32_16x16x32_bf16 v[28:31], v[52:55], v[44:47], v[28:31]
    v_add_u32 v232, s52, v233
    v_add_u32 v235, s52, v239
    v_mfma_f32_16x16x32_bf16 v[32:35], v[56:59], v[44:47], v[32:35]
    v_add_u32 v236, s52, v240
    v_add_u32 v237, s52, v241
    v_mfma_f32_16x16x32_bf16 v[36:39], v[60:63], v[44:47], v[36:39]
    v_add_u32 v238, s52, v242
    s_waitcnt lgkmcnt(0)
    v_mfma_f32_16x16x32_bf16 v[8:11], v[72:75], v[64:67], v[8:11]
    s_waitcnt vmcnt(0)
    s_barrier
    v_mfma_f32_16x16x32_bf16 v[12:15], v[76:79], v[64:67], v[12:15]
    ds_read_b128 v[40:43], v232 offset:0
    ds_read_b64_tr_b16 v[48:49], v235 offset:0
    ds_read_b64_tr_b16 v[50:51], v235 offset:2048
    v_mfma_f32_16x16x32_bf16 v[16:19], v[80:83], v[64:67], v[16:19]
    ds_read_b64_tr_b16 v[52:53], v236 offset:0
    ds_read_b64_tr_b16 v[54:55], v236 offset:2048
    v_mfma_f32_16x16x32_bf16 v[20:23], v[84:87], v[64:67], v[20:23]
    ds_read_b64_tr_b16 v[56:57], v237 offset:0
    ds_read_b64_tr_b16 v[58:59], v237 offset:2048
    ds_read_b64_tr_b16 v[60:61], v238 offset:0
    v_mfma_f32_16x16x32_bf16 v[24:27], v[72:75], v[68:71], v[24:27]
    ds_read_b64_tr_b16 v[62:63], v238 offset:2048
    ds_read_b128 v[44:47], v232 offset:2048
    v_mfma_f32_16x16x32_bf16 v[28:31], v[76:79], v[68:71], v[28:31]
    v_mfma_f32_16x16x32_bf16 v[32:35], v[80:83], v[68:71], v[32:35]
    s_add_u32 s52, s52, 24576
    s_cmp_ge_u32 s52, 147456
    s_cselect_b32 s52, 0, s52
    v_mfma_f32_16x16x32_bf16 v[36:39], v[84:87], v[68:71], v[36:39]
    s_waitcnt lgkmcnt(0)
    v_mfma_f32_16x16x32_bf16 v[8:11], v[48:51], v[40:43], v[8:11]
    ds_read_b128 v[64:67], v232 offset:1024
    ds_read_b64_tr_b16 v[72:73], v235 offset:4096
    v_mfma_f32_16x16x32_bf16 v[12:15], v[52:55], v[40:43], v[12:15]
    ds_read_b64_tr_b16 v[74:75], v235 offset:6144
    ds_read_b64_tr_b16 v[76:77], v236 offset:4096
    v_mfma_f32_16x16x32_bf16 v[16:19], v[56:59], v[40:43], v[16:19]
    ds_read_b64_tr_b16 v[78:79], v236 offset:6144
    ds_read_b64_tr_b16 v[80:81], v237 offset:4096
    v_mfma_f32_16x16x32_bf16 v[20:23], v[60:63], v[40:43], v[20:23]
    ds_read_b64_tr_b16 v[82:83], v237 offset:6144
    ds_read_b64_tr_b16 v[84:85], v238 offset:4096
    v_mfma_f32_16x16x32_bf16 v[24:27], v[48:51], v[44:47], v[24:27]
    s_movk_i32 s54, 6
M_Q_loop1:
    ds_read_b64_tr_b16 v[86:87], v238 offset:6144
    ds_read_b128 v[68:71], v232 offset:3072
    v_mfma_f32_16x16x32_bf16 v[28:31], v[52:55], v[44:47], v[28:31]
    v_add_u32 v232, s52, v233
    v_add_u32 v235, s52, v239
    v_mfma_f32_16x16x32_bf16 v[32:35], v[56:59], v[44:47], v[32:35]
    v_add_u32 v236, s52, v240
    v_add_u32 v237, s52, v241
    v_mfma_f32_16x16x32_bf16 v[36:39], v[60:63], v[44:47], v[36:39]
    v_add_u32 v238, s52, v242
    s_waitcnt lgkmcnt(0)
    v_mfma_f32_16x16x32_bf16 v[8:11], v[72:75], v[64:67], v[8:11]
    s_barrier
    v_mfma_f32_16x16x32_bf16 v[12:15], v[76:79], v[64:67], v[12:15]
    ds_read_b128 v[40:43], v232 offset:0
    ds_read_b64_tr_b16 v[48:49], v235 offset:0
    ds_read_b64_tr_b16 v[50:51], v235 offset:2048
    v_mfma_f32_16x16x32_bf16 v[16:19], v[80:83], v[64:67], v[16:19]
    ds_read_b64_tr_b16 v[52:53], v236 offset:0
    ds_read_b64_tr_b16 v[54:55], v236 offset:2048
    v_mfma_f32_16x16x32_bf16 v[20:23], v[84:87], v[64:67], v[20:23]
    ds_read_b64_tr_b16 v[56:57], v237 offset:0
    ds_read_b64_tr_b16 v[58:59], v237 offset:2048
    ds_read_b64_tr_b16 v[60:61], v238 offset:0
    v_mfma_f32_16x16x32_bf16 v[24:27], v[72:75], v[68:71], v[24:27]
    ds_read_b64_tr_b16 v[62:63], v238 offset:2048
    ds_read_b128 v[44:47], v232 offset:2048
    v_mfma_f32_16x16x32_bf16 v[28:31], v[76:79], v[68:71], v[28:31]
    v_mfma_f32_16x16x32_bf16 v[32:35], v[80:83], v[68:71], v[32:35]
    s_add_u32 s52, s52, 24576
    s_cmp_ge_u32 s52, 147456
    s_cselect_b32 s52, 0, s52
    v_mfma_f32_16x16x32_bf16 v[36:39], v[84:87], v[68:71], v[36:39]
    s_waitcnt lgkmcnt(0)
    v_mfma_f32_16x16x32_bf16 v[8:11], v[48:51], v[40:43], v[8:11]
    ds_read_b128 v[64:67], v232 offset:1024
    ds_read_b64_tr_b16 v[72:73], v235 offset:4096
    v_mfma_f32_16x16x32_bf16 v[12:15], v[52:55], v[40:43], v[12:15]
    ds_read_b64_tr_b16 v[74:75], v235 offset:6144
    ds_read_b64_tr_b16 v[76:77], v236 offset:4096
    v_mfma_f32_16x16x32_bf16 v[16:19], v[56:59], v[40:43], v[16:19]
    ds_read_b64_tr_b16 v[78:79], v236 offset:6144
    ds_read_b64_tr_b16 v[80:81], v237 offset:4096
    v_mfma_f32_16x16x32_bf16 v[20:23], v[60:63], v[40:43], v[20:23]
    s_sub_u32 s54, s54, 1
    ds_read_b64_tr_b16 v[82:83], v237 offset:6144
    ds_read_b64_tr_b16 v[84:85], v238 offset:4096
    v_mfma_f32_16x16x32_bf16 v[24:27], v[48:51], v[44:47], v[24:27]
    s_cbranch_scc0 M_Q_loop1
    ds_read_b64_tr_b16 v[86:87], v238 offset:6144
    ds_read_b128 v[68:71], v232 offset:3072
    v_mfma_f32_16x16x32_bf16 v[28:31], v[52:55], v[44:47], v[28:31]
    v_add_u32 v232, s52, v233
    v_add_u32 v235, s52, v239
    v_mfma_f32_16x16x32_bf16 v[32:35], v[56:59], v[44:47], v[32:35]
    v_add_u32 v236, s52, v240
    v_add_u32 v237, s52, v241
    v_mfma_f32_16x16x32_bf16 v[36:39], v[60:63], v[44:47], v[36:39]
    v_add_u32 v238, s52, v242
    s_waitcnt lgkmcnt(0)
    v_mfma_f32_16x16x32_bf16 v[8:11], v[72:75], v[64:67], v[8:11]
    s_barrier
    v_mfma_f32_16x16x32_bf16 v[12:15], v[76:79], v[64:67], v[12:15]
    ds_read_b128 v[40:43], v232 offset:0
    ds_read_b64_tr_b16 v[48:49], v235 offset:0
    ds_read_b64_tr_b16 v[50:51], v235 offset:2048
    v_mfma_f32_16x16x32_bf16 v[16:19], v[80:83], v[64:67], v[16:19]
    ds_read_b64_tr_b16 v[52:53], v236 offset:0
    ds_read_b64_tr_b16 v[54:55], v236 offset:2048
    v_mfma_f32_16x16x32_bf16 v[20:23], v[84:87], v[64:67], v[20:23]
    ds_read_b64_tr_b16 v[56:57], v237 offset:0
    ds_read_b64_tr_b16 v[58:59], v237 offset:2048
    ds_read_b64_tr_b16 v[60:61], v238 offset:0
    v_mfma_f32_16x16x32_bf16 v[24:27], v[72:75], v[68:71], v[24:27]
    ds_read_b64_tr_b16 v[62:63], v238 offset:2048
    ds_read_b128 v[44:47], v232 offset:2048
    v_mfma_f32_16x16x32_bf16 v[28:31], v[76:79], v[68:71], v[28:31]
    v_mfma_f32_16x16x32_bf16 v[32:35], v[80:83], v[68:71], v[32:35]
    s_add_u32 s52, s52, 24576
    s_cmp_ge_u32 s52, 147456
    s_cselect_b32 s52, 0, s52
    v_mfma_f32_16x16x32_bf16 v[36:39], v[84:87], v[68:71], v[36:39]
    s_waitcnt lgkmcnt(0)
    v_mfma_f32_16x16x32_bf16 v[8:11], v[48:51], v[40:43], v[8:11]
    ds_read_b128 v[64:67], v232 offset:1024
    ds_read_b64_tr_b16 v[72:73], v235 offset:4096
    v_mfma_f32_16x16x32_bf16 v[12:15], v[52:55], v[40:43], v[12:15]
    ds_read_b64_tr_b16 v[74:75], v235 offset:6144
    ds_read_b64_tr_b16 v[76:77], v236 offset:4096
    ds_read_b128 v[136:139], v199 offset:0
    v_mfma_f32_16x16x32_bf16 v[16:19], v[56:59], v[40:43], v[16:19]
    ds_read_b64_tr_b16 v[78:79], v236 offset:6144
    ds_read_b64_tr_b16 v[80:81], v237 offset:4096
    ds_read_b128 v[140:143], v199 offset:64
    v_mfma_f32_16x16x32_bf16 v[20:23], v[60:63], v[40:43], v[20:23]
    ds_read_b64_tr_b16 v[82:83], v237 offset:6144
    ds_read_b64_tr_b16 v[84:85], v238 offset:4096
    v_mfma_f32_16x16x32_bf16 v[24:27], v[48:51], v[44:47], v[24:27]
    ds_read_b64_tr_b16 v[86:87], v238 offset:6144
    ds_read_b128 v[68:71], v232 offset:3072
    ds_read_b128 v[144:147], v199 offset:128
    v_mfma_f32_16x16x32_bf16 v[28:31], v[52:55], v[44:47], v[28:31]
    v_add_u32 v232, s52, v233
    v_add_u32 v235, s52, v239
    v_mfma_f32_16x16x32_bf16 v[32:35], v[56:59], v[44:47], v[32:35]
    v_add_u32 v236, s52, v240
    v_add_u32 v237, s52, v241
    ds_read_b128 v[148:151], v199 offset:192
    v_mfma_f32_16x16x32_bf16 v[36:39], v[60:63], v[44:47], v[36:39]
    v_add_u32 v238, s52, v242
    s_waitcnt lgkmcnt(0)
    v_mfma_f32_16x16x32_bf16 v[8:11], v[72:75], v[64:67], v[8:11]
    s_barrier
    v_mfma_f32_16x16x32_bf16 v[12:15], v[76:79], v[64:67], v[12:15]
    ds_read_b128 v[40:43], v232 offset:0
    ds_read_b64_tr_b16 v[48:49], v235 offset:0
    ds_read_b64_tr_b16 v[50:51], v235 offset:2048
    ds_read_b128 v[152:155], v199 offset:256
    v_mfma_f32_16x16x32_bf16 v[16:19], v[80:83], v[64:67], v[16:19]
    ds_read_b64_tr_b16 v[52:53], v236 offset:0
    ds_read_b64_tr_b16 v[54:55], v236 offset:2048
    ds_read_b128 v[156:159], v199 offset:320
    v_mfma_f32_16x16x32_bf16 v[20:23], v[84:87], v[64:67], v[20:23]
    ds_read_b64_tr_b16 v[56:57], v237 offset:0
    ds_read_b64_tr_b16 v[58:59], v237 offset:2048
    ds_read_b64_tr_b16 v[60:61], v238 offset:0
    v_mfma_f32_16x16x32_bf16 v[24:27], v[72:75], v[68:71], v[24:27]
    ds_read_b64_tr_b16 v[62:63], v238 offset:2048
    ds_read_b128 v[44:47], v232 offset:2048
    ds_read_b128 v[160:163], v199 offset:384
    v_mfma_f32_16x16x32_bf16 v[28:31], v[76:79], v[68:71], v[28:31]
    v_mfma_f32_16x16x32_bf16 v[32:35], v[80:83], v[68:71], v[32:35]
    s_add_u32 s52, s52, 24576
    s_cmp_ge_u32 s52, 147456
    s_cselect_b32 s52, 0, s52
    ds_read_b128 v[164:167], v199 offset:448
    v_mfma_f32_16x16x32_bf16 v[36:39], v[84:87], v[68:71], v[36:39]
    s_waitcnt lgkmcnt(0)
    v_mfma_f32_16x16x32_bf16 v[8:11], v[48:51], v[40:43], v[8:11]
    ds_read_b128 v[64:67], v232 offset:1024
    ds_read_b64_tr_b16 v[72:73], v235 offset:4096
    v_mfma_f32_16x16x32_bf16 v[12:15], v[52:55], v[40:43], v[12:15]
    ds_read_b64_tr_b16 v[74:75], v235 offset:6144
    ds_read_b64_tr_b16 v[76:77], v236 offset:4096
    ds_read_b128 v[168:171], v199 offset:512
    v_mfma_f32_16x16x32_bf16 v[16:19], v[56:59], v[40:43], v[16:19]
    ds_read_b64_tr_b16 v[78:79], v236 offset:6144
    ds_read_b64_tr_b16 v[80:81], v237 offset:4096
    ds_read_b128 v[172:175], v199 offset:576
    v_mfma_f32_16x16x32_bf16 v[20:23], v[60:63], v[40:43], v[20:23]
    ds_read_b64_tr_b16 v[82:83], v237 offset:6144
    ds_read_b64_tr_b16 v[84:85], v238 offset:4096
    v_mfma_f32_16x16x32_bf16 v[24:27], v[48:51], v[44:47], v[24:27]
    ds_read_b64_tr_b16 v[86:87], v238 offset:6144
    ds_read_b128 v[68:71], v232 offset:3072
    ds_read_b128 v[176:179], v199 offset:640
    v_mfma_f32_16x16x32_bf16 v[28:31], v[52:55], v[44:47], v[28:31]
    v_add_u32 v232, s52, v233
    v_add_u32 v235, s52, v239
    v_mfma_f32_16x16x32_bf16 v[32:35], v[56:59], v[44:47], v[32:35]
    v_add_u32 v236, s52, v240
    v_add_u32 v237, s52, v241
    ds_read_b128 v[180:183], v199 offset:704
    v_mfma_f32_16x16x32_bf16 v[36:39], v[60:63], v[44:47], v[36:39]
    v_add_u32 v238, s52, v242
    s_waitcnt lgkmcnt(0)
    v_mfma_f32_16x16x32_bf16 v[8:11], v[72:75], v[64:67], v[8:11]
    s_barrier
    v_mfma_f32_16x16x32_bf16 v[12:15], v[76:79], v[64:67], v[12:15]
    ds_read_b128 v[40:43], v232 offset:0
    ds_read_b64_tr_b16 v[48:49], v235 offset:0
    ds_read_b64_tr_b16 v[50:51], v235 offset:2048
    v_mfma_f32_16x16x32_bf16 v[16:19], v[80:83], v[64:67], v[16:19]
    ds_read_b64_tr_b16 v[52:53], v236 offset:0
    ds_read_b64_tr_b16 v[54:55], v236 offset:2048
    v_mfma_f32_16x16x32_bf16 v[20:23], v[84:87], v[64:67], v[20:23]
    ds_read_b64_tr_b16 v[56:57], v237 offset:0
    ds_read_b64_tr_b16 v[58:59], v237 offset:2048
    ds_read_b64_tr_b16 v[60:61], v238 offset:0
    v_mfma_f32_16x16x32_bf16 v[24:27], v[72:75], v[68:71], v[24:27]
    ds_read_b64_tr_b16 v[62:63], v238 offset:2048
    ds_read_b128 v[44:47], v232 offset:2048
    v_mfma_f32_16x16x32_bf16 v[28:31], v[76:79], v[68:71], v[28:31]
    v_mfma_f32_16x16x32_bf16 v[32:35], v[80:83], v[68:71], v[32:35]
    s_add_u32 s52, s52, 24576
    s_cmp_ge_u32 s52, 147456
    s_cselect_b32 s52, 0, s52
    v_mfma_f32_16x16x32_bf16 v[36:39], v[84:87], v[68:71], v[36:39]
    s_waitcnt lgkmcnt(0)
    v_mfma_f32_16x16x32_bf16 v[8:11], v[48:51], v[40:43], v[8:11]
    ds_read_b128 v[64:67], v232 offset:1024
    ds_read_b64_tr_b16 v[72:73], v235 offset:4096
    v_mfma_f32_16x16x32_bf16 v[12:15], v[52:55], v[40:43], v[12:15]
    ds_read_b64_tr_b16 v[74:75], v235 offset:6144
    ds_read_b64_tr_b16 v[76:77], v236 offset:4096
    v_mfma_f32_16x16x32_bf16 v[16:19], v[56:59], v[40:43], v[16:19]
    ds_read_b64_tr_b16 v[78:79], v236 offset:6144
    ds_read_b64_tr_b16 v[80:81], v237 offset:4096
    v_mfma_f32_16x16x32_bf16 v[20:23], v[60:63], v[40:43], v[20:23]
    ds_read_b64_tr_b16 v[82:83], v237 offset:6144
    ds_read_b64_tr_b16 v[84:85], v238 offset:4096
    v_mfma_f32_16x16x32_bf16 v[24:27], v[48:51], v[44:47], v[24:27]
    ds_read_b64_tr_b16 v[86:87], v238 offset:6144
    ds_read_b128 v[68:71], v232 offset:3072
    v_mfma_f32_16x16x32_bf16 v[28:31], v[52:55], v[44:47], v[28:31]
    v_mfma_f32_16x16x32_bf16 v[32:35], v[56:59], v[44:47], v[32:35]
    v_mfma_f32_16x16x32_bf16 v[36:39], v[60:63], v[44:47], v[36:39]
    s_waitcnt lgkmcnt(0)
    v_mfma_f32_16x16x32_bf16 v[8:11], v[72:75], v[64:67], v[8:11]
    s_barrier
    v_mfma_f32_16x16x32_bf16 v[12:15], v[76:79], v[64:67], v[12:15]
    v_mfma_f32_16x16x32_bf16 v[16:19], v[80:83], v[64:67], v[16:19]
    v_mfma_f32_16x16x32_bf16 v[20:23], v[84:87], v[64:67], v[20:23]
    v_mfma_f32_16x16x32_bf16 v[24:27], v[72:75], v[68:71], v[24:27]
    v_mfma_f32_16x16x32_bf16 v[28:31], v[76:79], v[68:71], v[28:31]
    v_mfma_f32_16x16x32_bf16 v[32:35], v[80:83], v[68:71], v[32:35]
    v_mfma_f32_16x16x32_bf16 v[36:39], v[84:87], v[68:71], v[36:39]
    v_pk_fma_f32 v[104:105], v[8:9], v[136:137], v[104:105]
    v_pk_fma_f32 v[106:107], v[10:11], v[138:139], v[106:107]
    v_pk_fma_f32 v[108:109], v[12:13], v[140:141], v[108:109]
    v_pk_fma_f32 v[110:111], v[14:15], v[142:143], v[110:111]
    v_pk_fma_f32 v[112:113], v[16:17], v[144:145], v[112:113]
    v_pk_fma_f32 v[114:115], v[18:19], v[146:147], v[114:115]
    v_pk_fma_f32 v[116:117], v[20:21], v[148:149], v[116:117]
    v_pk_fma_f32 v[118:119], v[22:23], v[150:151], v[118:119]
    v_pk_fma_f32 v[120:121], v[24:25], v[136:137], v[120:121]
    v_pk_fma_f32 v[122:123], v[26:27], v[138:139], v[122:123]
    v_pk_fma_f32 v[124:125], v[28:29], v[140:141], v[124:125]
    v_pk_fma_f32 v[126:127], v[30:31], v[142:143], v[126:127]
    v_pk_fma_f32 v[128:129], v[32:33], v[144:145], v[128:129]
    v_pk_fma_f32 v[130:131], v[34:35], v[146:147], v[130:131]
    v_pk_fma_f32 v[132:133], v[36:37], v[148:149], v[132:133]
    v_pk_fma_f32 v[134:135], v[38:39], v[150:151], v[134:135]
    v_cvt_pk_bf16_f32 v88, v104, v105
    v_cvt_pk_bf16_f32 v89, v106, v107
    v_cvt_pk_bf16_f32 v90, v108, v109
    v_cvt_pk_bf16_f32 v91, v110, v111
    v_cvt_pk_bf16_f32 v92, v112, v113
    v_cvt_pk_bf16_f32 v93, v114, v115
    v_cvt_pk_bf16_f32 v94, v116, v117
    v_cvt_pk_bf16_f32 v95, v118, v119
    v_cvt_pk_bf16_f32 v96, v120, v121
    v_cvt_pk_bf16_f32 v97, v122, v123
    v_cvt_pk_bf16_f32 v98, v124, v125
    v_cvt_pk_bf16_f32 v99, v126, v127
    v_cvt_pk_bf16_f32 v100, v128, v129
    v_cvt_pk_bf16_f32 v101, v130, v131
    v_cvt_pk_bf16_f32 v102, v132, v133
    v_cvt_pk_bf16_f32 v103, v134, v135
    v_lshlrev_b32 v104, 16, v88
    v_and_b32 v105, 0xffff0000, v88
    v_lshlrev_b32 v106, 16, v89
    v_and_b32 v107, 0xffff0000, v89
    v_lshlrev_b32 v108, 16, v90
    v_and_b32 v109, 0xffff0000, v90
    v_lshlrev_b32 v110, 16, v91
    v_and_b32 v111, 0xffff0000, v91
    v_lshlrev_b32 v112, 16, v92
    v_and_b32 v113, 0xffff0000, v92
    v_lshlrev_b32 v114, 16, v93
    v_and_b32 v115, 0xffff0000, v93
    v_lshlrev_b32 v116, 16, v94
    v_and_b32 v117, 0xffff0000, v94
    v_lshlrev_b32 v118, 16, v95
    v_and_b32 v119, 0xffff0000, v95
    v_lshlrev_b32 v120, 16, v96
    v_and_b32 v121, 0xffff0000, v96
    v_lshlrev_b32 v122, 16, v97
    v_and_b32 v123, 0xffff0000, v97
    v_lshlrev_b32 v124, 16, v98
    v_and_b32 v125, 0xffff0000, v98
    v_lshlrev_b32 v126, 16, v99
    v_and_b32 v127, 0xffff0000, v99
    v_lshlrev_b32 v128, 16, v100
    v_and_b32 v129, 0xffff0000, v100
    v_lshlrev_b32 v130, 16, v101
    v_and_b32 v131, 0xffff0000, v101
    v_lshlrev_b32 v132, 16, v102
    v_and_b32 v133, 0xffff0000, v102
    v_lshlrev_b32 v134, 16, v103
    v_and_b32 v135, 0xffff0000, v103
    v_pk_add_f32 v[40:41], v[104:105], v[106:107]
    v_pk_mul_f32 v[44:45], v[104:105], v[104:105]
    v_pk_add_f32 v[42:43], v[120:121], v[122:123]
    v_pk_mul_f32 v[46:47], v[120:121], v[120:121]
    v_pk_fma_f32 v[44:45], v[106:107], v[106:107], v[44:45]
    v_pk_fma_f32 v[46:47], v[122:123], v[122:123], v[46:47]
    v_pk_add_f32 v[40:41], v[40:41], v[108:109]
    v_pk_fma_f32 v[44:45], v[108:109], v[108:109], v[44:45]
    v_pk_add_f32 v[42:43], v[42:43], v[124:125]
    v_pk_fma_f32 v[46:47], v[124:125], v[124:125], v[46:47]
    v_pk_add_f32 v[40:41], v[40:41], v[110:111]
    v_pk_fma_f32 v[44:45], v[110:111], v[110:111], v[44:45]
    v_pk_add_f32 v[42:43], v[42:43], v[126:127]
    v_pk_fma_f32 v[46:47], v[126:127], v[126:127], v[46:47]
    v_pk_add_f32 v[40:41], v[40:41], v[112:113]
    v_pk_fma_f32 v[44:45], v[112:113], v[112:113], v[44:45]
    v_pk_add_f32 v[42:43], v[42:43], v[128:129]
    v_pk_fma_f32 v[46:47], v[128:129], v[128:129], v[46:47]
    v_pk_add_f32 v[40:41], v[40:41], v[114:115]
    v_pk_fma_f32 v[44:45], v[114:115], v[114:115], v[44:45]
    v_pk_add_f32 v[42:43], v[42:43], v[130:131]
    v_pk_fma_f32 v[46:47], v[130:131], v[130:131], v[46:47]
    v_pk_add_f32 v[40:41], v[40:41], v[116:117]
    v_pk_fma_f32 v[44:45], v[116:117], v[116:117], v[44:45]
    v_pk_add_f32 v[42:43], v[42:43], v[132:133]
    v_pk_fma_f32 v[46:47], v[132:133], v[132:133], v[46:47]
    v_pk_add_f32 v[40:41], v[40:41], v[118:119]
    v_pk_fma_f32 v[44:45], v[118:119], v[118:119], v[44:45]
    v_pk_add_f32 v[42:43], v[42:43], v[134:135]
    v_pk_fma_f32 v[46:47], v[134:135], v[134:135], v[46:47]
    v_add_f32 v40, v40, v41
    v_add_f32 v42, v42, v43
    v_add_f32 v44, v44, v45
    v_add_f32 v46, v46, v47
    v_permlane16_swap_b32 v40, v42
    s_nop 0
    v_permlane16_swap_b32 v44, v46
    v_add_f32 v48, v40, v42
    v_add_f32 v49, v44, v46
    v_mov_b32 v50, v48
    v_mov_b32 v51, v49
    s_nop 0
    v_permlane32_swap_b32 v48, v50
    v_permlane32_swap_b32 v49, v51
    v_add_f32 v48, v48, v50
    v_add_f32 v49, v49, v51
    s_mov_b32 exec_hi, 0
    buffer_store_dwordx2 v[48:49], v195, s[28:31], 0 offen sc1
    s_mov_b32 exec_hi, -1
    buffer_store_dwordx4 v[88:91], v197, s[28:31], s72 offen offset:0 sc1
    buffer_store_dwordx4 v[92:95], v197, s[28:31], s72 offen offset:1024 sc1
    buffer_store_dwordx4 v[96:99], v197, s[28:31], s73 offen offset:0 sc1
    buffer_store_dwordx4 v[100:103], v197, s[28:31], s73 offen offset:1024 sc1
    s_waitcnt vmcnt(0)
    buffer_load_dwordx2 v[56:57], v198, s[28:31], 0 offen offset:0 sc1
    buffer_load_dwordx2 v[58:59], v198, s[28:31], 0 offen offset:512 sc1
    buffer_load_dwordx2 v[60:61], v198, s[28:31], 0 offen offset:1024 sc1
    buffer_load_dwordx2 v[62:63], v198, s[28:31], 0 offen offset:1536 sc1
    buffer_load_dwordx2 v[64:65], v198, s[28:31], 0 offen offset:2048 sc1
    buffer_load_dwordx2 v[66:67], v198, s[28:31], 0 offen offset:2560 sc1
    buffer_load_dwordx2 v[68:69], v198, s[28:31], 0 offen offset:3072 sc1
    buffer_load_dwordx2 v[70:71], v198, s[28:31], 0 offen offset:3584 sc1
    s_waitcnt vmcnt(0)
    s_mov_b32 s3, 0x40000
M_sp_chk:
    v_cmp_eq_u32 s[80:81], -1, v57
    v_cmp_eq_u32 s[82:83], -1, v59
    v_cmp_eq_u32 s[84:85], -1, v61
    v_cmp_eq_u32 s[86:87], -1, v63
    v_cmp_eq_u32 s[88:89], -1, v65
    v_cmp_eq_u32 s[90:91], -1, v67
    v_cmp_eq_u32 s[92:93], -1, v69
    v_cmp_eq_u32 s[94:95], -1, v71
    v_max3_u32 v52, v57, v59, v61
    v_max3_u32 v53, v63, v65, v67
    v_max3_u32 v52, v52, v69, v71
    v_max_u32 v52, v52, v53
    v_cmp_eq_u32 vcc, -1, v52
    s_nop 4
    s_cbranch_vccz M_sp_ok
    s_sub_u32 s3, s3, 1
    s_cbranch_scc1 M_sp_ok
    s_mov_b64 exec, s[80:81]
    buffer_load_dwordx2 v[56:57], v198, s[28:31], 0 offen offset:0 sc1
    s_mov_b64 exec, s[82:83]
    buffer_load_dwordx2 v[58:59], v198, s[28:31], 0 offen offset:512 sc1
    s_mov_b64 exec, s[84:85]
    buffer_load_dwordx2 v[60:61], v198, s[28:31], 0 offen offset:1024 sc1
    s_mov_b64 exec, s[86:87]
    buffer_load_dwordx2 v[62:63], v198, s[28:31], 0 offen offset:1536 sc1
    s_mov_b64 exec, s[88:89]
    buffer_load_dwordx2 v[64:65], v198, s[28:31], 0 offen offset:2048 sc1
    s_mov_b64 exec, s[90:91]
    buffer_load_dwordx2 v[66:67], v198, s[28:31], 0 offen offset:2560 sc1
    s_mov_b64 exec, s[92:93]
    buffer_load_dwordx2 v[68:69], v198, s[28:31], 0 offen offset:3072 sc1
    s_mov_b64 exec, s[94:95]
    buffer_load_dwordx2 v[70:71], v198, s[28:31], 0 offen offset:3584 sc1
    s_mov_b64 exec, -1
    s_waitcnt vmcnt(0)
    s_branch M_sp_chk
M_sp_ok:
    v_pk_add_f32 v[56:57], v[56:57], v[58:59]
    v_pk_add_f32 v[60:61], v[60:61], v[62:63]
    v_pk_add_f32 v[64:65], v[64:65], v[66:67]
    v_pk_add_f32 v[68:69], v[68:69], v[70:71]
    v_pk_add_f32 v[56:57], v[56:57], v[60:61]
    v_pk_add_f32 v[64:65], v[64:65], v[68:69]
    v_pk_add_f32 v[56:57], v[56:57], v[64:65]
    v_mov_b32 v50, v56
    v_mov_b32 v51, v57
    s_nop 0
    v_permlane32_swap_b32 v56, v50
    v_permlane32_swap_b32 v57, v51
    v_add_f32 v56, v56, v50
    v_add_f32 v57, v57, v51
    v_mul_f32 v56, 0x3a800000, v56
    v_mul_f32 v57, 0x3a800000, v57
    v_fma_f32 v57, -v56, v56, v57
    v_max_f32 v57, 0, v57
    v_cvt_pk_bf16_f32 v50, v56, v57
    v_lshlrev_b32 v56, 16, v50
    v_and_b32 v57, 0xffff0000, v50
    v_add_f32 v57, 0x3727c5ac, v57
    v_cvt_pk_bf16_f32 v50, v57, v57
    v_lshlrev_b32 v57, 16, v50
    v_sqrt_f32 v57, v57
    s_nop 0
    v_cvt_pk_bf16_f32 v50, v57, v57
    v_lshlrev_b32 v57, 16, v50
    v_rcp_f32 v40, v57
    s_nop 0
    v_mul_f32 v44, -v56, v40
    v_mov_b32 v42, v40
    v_mov_b32 v46, v44
    s_nop 0
    v_permlane16_swap_b32 v40, v42
    v_permlane16_swap_b32 v44, v46
    v_pk_fma_f32 v[104:105], v[104:105], v[40:41], v[44:45] op_sel_hi:[1,0,0]
    v_pk_fma_f32 v[106:107], v[106:107], v[40:41], v[44:45] op_sel_hi:[1,0,0]
    v_pk_fma_f32 v[108:109], v[108:109], v[40:41], v[44:45] op_sel_hi:[1,0,0]
    v_pk_fma_f32 v[110:111], v[110:111], v[40:41], v[44:45] op_sel_hi:[1,0,0]
    v_pk_fma_f32 v[112:113], v[112:113], v[40:41], v[44:45] op_sel_hi:[1,0,0]
    v_pk_fma_f32 v[114:115], v[114:115], v[40:41], v[44:45] op_sel_hi:[1,0,0]
    v_pk_fma_f32 v[116:117], v[116:117], v[40:41], v[44:45] op_sel_hi:[1,0,0]
    v_pk_fma_f32 v[118:119], v[118:119], v[40:41], v[44:45] op_sel_hi:[1,0,0]
    v_pk_fma_f32 v[104:105], v[104:105], v[168:169], v[152:153]
    v_pk_fma_f32 v[106:107], v[106:107], v[170:171], v[154:155]
    v_pk_fma_f32 v[108:109], v[108:109], v[172:173], v[156:157]
    v_pk_fma_f32 v[110:111], v[110:111], v[174:175], v[158:159]
    v_pk_fma_f32 v[112:113], v[112:113], v[176:177], v[160:161]
    v_pk_fma_f32 v[114:115], v[114:115], v[178:179], v[162:163]
    v_pk_fma_f32 v[116:117], v[116:117], v[180:181], v[164:165]
    v_pk_fma_f32 v[118:119], v[118:119], v[182:183], v[166:167]
    v_cvt_pk_bf16_f32 v72, v104, v105
    v_cvt_pk_bf16_f32 v73, v106, v107
    v_cvt_pk_bf16_f32 v74, v108, v109
    v_cvt_pk_bf16_f32 v75, v110, v111
    buffer_store_dwordx4 v[72:75], v197, s[28:31], s74 offen offset:0 sc1
    ds_write_b128 v233, v[72:75] offset:0
    v_cvt_pk_bf16_f32 v76, v112, v113
    v_cvt_pk_bf16_f32 v77, v114, v115
    v_cvt_pk_bf16_f32 v78, v116, v117
    v_cvt_pk_bf16_f32 v79, v118, v119
    buffer_store_dwordx4 v[76:79], v197, s[28:31], s74 offen offset:1024 sc1
    ds_write_b128 v233, v[76:79] offset:1024
    v_pk_fma_f32 v[120:121], v[120:121], v[42:43], v[46:47] op_sel_hi:[1,0,0]
    v_pk_fma_f32 v[122:123], v[122:123], v[42:43], v[46:47] op_sel_hi:[1,0,0]
    v_pk_fma_f32 v[124:125], v[124:125], v[42:43], v[46:47] op_sel_hi:[1,0,0]
    v_pk_fma_f32 v[126:127], v[126:127], v[42:43], v[46:47] op_sel_hi:[1,0,0]
    v_pk_fma_f32 v[128:129], v[128:129], v[42:43], v[46:47] op_sel_hi:[1,0,0]
    v_pk_fma_f32 v[130:131], v[130:131], v[42:43], v[46:47] op_sel_hi:[1,0,0]
    v_pk_fma_f32 v[132:133], v[132:133], v[42:43], v[46:47] op_sel_hi:[1,0,0]
    v_pk_fma_f32 v[134:135], v[134:135], v[42:43], v[46:47] op_sel_hi:[1,0,0]
    v_pk_fma_f32 v[120:121], v[120:121], v[168:169], v[152:153]
    v_pk_fma_f32 v[122:123], v[122:123], v[170:171], v[154:155]
    v_pk_fma_f32 v[124:125], v[124:125], v[172:173], v[156:157]
    v_pk_fma_f32 v[126:127], v[126:127], v[174:175], v[158:159]
    v_pk_fma_f32 v[128:129], v[128:129], v[176:177], v[160:161]
    v_pk_fma_f32 v[130:131], v[130:131], v[178:179], v[162:163]
    v_pk_fma_f32 v[132:133], v[132:133], v[180:181], v[164:165]
    v_pk_fma_f32 v[134:135], v[134:135], v[182:183], v[166:167]
    v_cvt_pk_bf16_f32 v80, v120, v121
    v_cvt_pk_bf16_f32 v81, v122, v123
    v_cvt_pk_bf16_f32 v82, v124, v125
    v_cvt_pk_bf16_f32 v83, v126, v127
    buffer_store_dwordx4 v[80:83], v197, s[28:31], s75 offen offset:0 sc1
    ds_write_b128 v233, v[80:83] offset:2048
    v_cvt_pk_bf16_f32 v84, v128, v129
    v_cvt_pk_bf16_f32 v85, v130, v131
    v_cvt_pk_bf16_f32 v86, v132, v133
    v_cvt_pk_bf16_f32 v87, v134, v135
    buffer_store_dwordx4 v[84:87], v197, s[28:31], s75 offen offset:1024 sc1
    ds_write_b128 v233, v[84:87] offset:3072
    s_waitcnt lgkmcnt(0)
    s_barrier
    s_and_b32 s57, s58, 15
    s_lshr_b64 s[58:59], s[58:59], 4
    s_lshl_b32 s56, s57, 11
    s_mul_i32 s57, s57, 0x70000
    s_add_u32 s53, s53, 49152
    s_cmp_ge_u32 s53, s61
    s_cselect_b32 s53, s60, s53
    s_and_b32 s57, s58, 15
    s_lshr_b64 s[58:59], s[58:59], 4
    s_lshl_b32 s56, s57, 11
    s_mul_i32 s57, s57, 0x70000
    s_add_u32 m0, s53, 16384
    s_nop 0
    buffer_load_dwordx4 v208, s[32:35], s57 offen offset:0 lds
    buffer_load_dwordx4 v209, s[32:35], s57 offen offset:1024 lds
    buffer_load_dwordx4 v210, s[32:35], s57 offen offset:2048 lds
    buffer_load_dwordx4 v211, s[32:35], s57 offen offset:3072 lds
    s_add_u32 m0, s53, 32768
    s_nop 0
    buffer_load_dwordx4 v208, s[36:39], s57 offen offset:0 lds
    buffer_load_dwordx4 v209, s[36:39], s57 offen offset:1024 lds
    buffer_load_dwordx4 v210, s[36:39], s57 offen offset:2048 lds
    buffer_load_dwordx4 v211, s[36:39], s57 offen offset:3072 lds
    s_add_u32 s53, s53, 49152
    s_cmp_ge_u32 s53, s61
    s_cselect_b32 s53, s60, s53
    s_lshl_b32 s60, s44, 12
    s_add_u32 s61, s60, 147456
    s_add_u32 s53, s60, 0
    s_bfe_u32 s66, s2, 0x30003
    s_lshr_b32 s55, s2, 6
    s_add_u32 s66, s66, s55
    s_and_b32 s66, s66, 3
    s_mov_b32 s58, 0x76453210
    s_mov_b32 s59, 0xfecdba89
    s_cmp_eq_u32 s66, 1
    s_cselect_b32 s58, 0x75643120, s58
    s_cselect_b32 s59, 0xfdecb9a8, s59
    s_cmp_eq_u32 s66, 2
    s_cselect_b32 s58, 0x67542310, s58
    s_cselect_b32 s59, 0xefdcab98, s59
    s_cmp_eq_u32 s66, 3
    s_cselect_b32 s58, 0x86534210, s58
    s_cselect_b32 s59, 0xfedbca97, s59
    s_and_b32 s66, s48, 15
    s_lshl_b32 s55, s66, 2
    s_lshr_b64 s[56:57], s[58:59], s55
    s_and_b32 s55, s56, 15
    s_lshl_b32 s55, s55, 2
    s_lshl_b64 s[56:57], 15, s55
    s_andn2_b64 s[58:59], s[58:59], s[56:57]
    s_or_b32 s58, s58, s66
    s_mov_b32 s32, s12
    s_mov_b32 s33, s13
    s_mov_b32 s34, 0x700000
    s_mov_b32 s35, 0x20000
    s_mov_b32 s36, s14
    s_mov_b32 s37, s15
    s_mov_b32 s38, 0x700000
    s_mov_b32 s39, 0x20000
    s_lshl_b32 s68, s47, 9
    s_add_u32 s68, s68, 0x56000
    s_add_u32 s62, s26, s68
    s_addc_u32 s63, s27, 0
    s_lshr_b32 s68, s48, 2
    s_lshl_b32 s68, s68, 7
    v_mov_b32 v2, 1
    v_mov_b32 v5, 148488
    s_waitcnt vmcnt(8)
    s_mov_b64 exec, 1
    ds_add_rtn_u32 v245, v5, v2
    s_mov_b64 exec, -1
    s_mov_b32 s1, s0
    s_lshl_b32 s64, s48, 2
    s_waitcnt lgkmcnt(0)
    v_readfirstlane_b32 s3, v245
    s_nop 3
    s_cmp_lg_u32 s3, 3
    s_cbranch_scc1 M_ph_ok
    s_atomic_swap s0, s[62:63], s64 offset:0
    s_atomic_swap s0, s[62:63], s64 offset:128
    s_atomic_swap s0, s[62:63], s64 offset:256
    s_atomic_swap s0, s[62:63], s64 offset:384
    s_mov_b32 s3, 0x40000
M_ph_chk:
    s_load_dwordx16 s[80:95], s[62:63], s68 glc
    s_sub_u32 s3, s3, 1
    s_cbranch_scc1 M_ph_ok
M_ph_c2:
    s_waitcnt lgkmcnt(0)
    s_xor_b64 s[80:81], s[80:81], s[0:1]
    s_xor_b64 s[82:83], s[82:83], s[0:1]
    s_xor_b64 s[84:85], s[84:85], s[0:1]
    s_xor_b64 s[86:87], s[86:87], s[0:1]
    s_xor_b64 s[88:89], s[88:89], s[0:1]
    s_xor_b64 s[90:91], s[90:91], s[0:1]
    s_xor_b64 s[92:93], s[92:93], s[0:1]
    s_xor_b64 s[94:95], s[94:95], s[0:1]
    s_or_b64 s[80:81], s[80:81], s[82:83]
    s_or_b64 s[84:85], s[84:85], s[86:87]
    s_or_b64 s[88:89], s[88:89], s[90:91]
    s_or_b64 s[92:93], s[92:93], s[94:95]
    s_or_b64 s[80:81], s[80:81], s[84:85]
    s_or_b64 s[88:89], s[88:89], s[92:93]
    s_or_b64 s[80:81], s[80:81], s[88:89]
    s_cbranch_scc1 M_ph_chk
M_ph_ok:
    s_barrier
    s_setprio 0
    s_and_b32 s57, s58, 15
    s_lshr_b64 s[58:59], s[58:59], 4
    s_lshl_b32 s56, s57, 11
    s_mul_i32 s57, s57, 0x70000
    s_add_u32 s53, s53, 49152
    s_cmp_ge_u32 s53, s61
    s_cselect_b32 s53, s60, s53
    s_and_b32 s57, s58, 15
    s_lshr_b64 s[58:59], s[58:59], 4
    s_lshl_b32 s56, s57, 11
    s_mul_i32 s57, s57, 0x70000
    s_mov_b32 m0, s53
    s_nop 0
    buffer_load_dwordx4 v206, s[28:31], s56 offen offset:0 sc1 lds
    buffer_load_dwordx4 v206, s[28:31], s56 offen offset:1024 sc1 lds
    buffer_load_dwordx4 v207, s[28:31], s56 offen offset:2048 sc1 lds
    buffer_load_dwordx4 v207, s[28:31], s56 offen offset:3072 sc1 lds
    s_add_u32 s53, s53, 49152
    s_cmp_ge_u32 s53, s61
    s_cselect_b32 s53, s60, s53
    s_and_b32 s57, s58, 15
    s_lshr_b64 s[58:59], s[58:59], 4
    s_lshl_b32 s56, s57, 11
    s_mul_i32 s57, s57, 0x70000
    s_add_u32 m0, s53, 16384
    s_nop 0
    buffer_load_dwordx4 v208, s[32:35], s57 offen offset:0 lds
    buffer_load_dwordx4 v209, s[32:35], s57 offen offset:1024 lds
    buffer_load_dwordx4 v210, s[32:35], s57 offen offset:2048 lds
    buffer_load_dwordx4 v211, s[32:35], s57 offen offset:3072 lds
    s_add_u32 m0, s53, 32768
    s_nop 0
    buffer_load_dwordx4 v208, s[36:39], s57 offen offset:0 lds
    buffer_load_dwordx4 v209, s[36:39], s57 offen offset:1024 lds
    buffer_load_dwordx4 v210, s[36:39], s57 offen offset:2048 lds
    buffer_load_dwordx4 v211, s[36:39], s57 offen offset:3072 lds
    s_mov_b32 m0, s53
    s_nop 0
    buffer_load_dwordx4 v206, s[28:31], s56 offen offset:0 sc1 lds
    buffer_load_dwordx4 v206, s[28:31], s56 offen offset:1024 sc1 lds
    buffer_load_dwordx4 v207, s[28:31], s56 offen offset:2048 sc1 lds
    buffer_load_dwordx4 v207, s[28:31], s56 offen offset:3072 sc1 lds
    s_add_u32 s53, s53, 49152
    s_cmp_ge_u32 s53, s61
    s_cselect_b32 s53, s60, s53
    s_lshl_b32 s64, s45, 13
    v_lshl_add_u32 v233, v1, 4, s64
    v_lshrrev_b32 v2, 2, v1
    v_lshlrev_b32 v4, 8, v2
    v_and_b32 v5, 3, v1
    v_lshl_add_u32 v4, v5, 3, v4
    v_add_u32 v4, 16384, v4
    v_and_b32 v2, 7, v2
    s_lshl_b32 s64, s46, 2
    v_xor_b32 v2, s64, v2
    v_xor_b32 v3, 0, v2
    v_lshl_add_u32 v239, v3, 5, v4
    v_xor_b32 v3, 1, v2
    v_lshl_add_u32 v240, v3, 5, v4
    v_xor_b32 v3, 2, v2
    v_lshl_add_u32 v241, v3, 5, v4
    v_xor_b32 v3, 3, v2
    v_lshl_add_u32 v242, v3, 5, v4
    s_mov_b32 s52, 49152
    v_add_u32 v232, s52, v233
    v_add_u32 v235, s52, v239
    v_add_u32 v236, s52, v240
    v_add_u32 v237, s52, v241
    v_add_u32 v238, s52, v242
    s_lshl_b32 s64, s2, 2
    s_add_u32 s64, s64, s44
    s_mul_i32 s64, s64, 7168
    s_add_u32 s64, s64, 5248
    s_add_u32 s10, s12, s64
    s_addc_u32 s11, s13, 0
    s_add_u32 s24, s14, s64
    s_addc_u32 s25, s15, 0
    s_movk_i32 s54, 9
M_Q_loop2:
    s_waitcnt vmcnt(12)
    s_barrier
    s_and_b32 s57, s58, 15
    s_lshr_b64 s[58:59], s[58:59], 4
    s_lshl_b32 s56, s57, 11
    s_mul_i32 s57, s57, 0x70000
    s_add_u32 m0, s53, 16384
    s_nop 0
    buffer_load_dwordx4 v208, s[32:35], s57 offen offset:0 lds
    s_load_dword s99, s[10:11], 0
    buffer_load_dwordx4 v209, s[32:35], s57 offen offset:1024 lds
    buffer_load_dwordx4 v210, s[32:35], s57 offen offset:2048 lds
    s_load_dword s99, s[24:25], 0
    buffer_load_dwordx4 v211, s[32:35], s57 offen offset:3072 lds
    s_add_u32 m0, s53, 32768
    s_nop 0
    buffer_load_dwordx4 v208, s[36:39], s57 offen offset:0 lds
    s_load_dword s99, s[10:11], 64
    buffer_load_dwordx4 v209, s[36:39], s57 offen offset:1024 lds
    buffer_load_dwordx4 v210, s[36:39], s57 offen offset:2048 lds
    s_load_dword s99, s[24:25], 64
    buffer_load_dwordx4 v211, s[36:39], s57 offen offset:3072 lds
    s_mov_b32 m0, s53
    s_nop 0
    buffer_load_dwordx4 v206, s[28:31], s56 offen offset:0 sc1 lds
    s_load_dword s99, s[10:11], 128
    buffer_load_dwordx4 v206, s[28:31], s56 offen offset:1024 sc1 lds
    buffer_load_dwordx4 v207, s[28:31], s56 offen offset:2048 sc1 lds
    s_load_dword s99, s[24:25], 128
    buffer_load_dwordx4 v207, s[28:31], s56 offen offset:3072 sc1 lds
    s_add_u32 s53, s53, 49152
    s_cmp_ge_u32 s53, s61
    s_cselect_b32 s53, s60, s53
    s_add_u32 s10, s10, 192
    s_addc_u32 s11, s11, 0
    s_add_u32 s24, s24, 192
    s_addc_u32 s25, s25, 0
    s_sub_u32 s54, s54, 1
    s_cbranch_scc0 M_Q_loop2
    s_movk_i32 s54, 2
M_Q_loop3:
    s_waitcnt vmcnt(12)
    s_barrier
    s_and_b32 s57, s58, 15
    s_lshr_b64 s[58:59], s[58:59], 4
    s_lshl_b32 s56, s57, 11
    s_mul_i32 s57, s57, 0x70000
    s_add_u32 m0, s53, 16384
    s_nop 0
    buffer_load_dwordx4 v208, s[32:35], s57 offen offset:0 lds
    buffer_load_dwordx4 v209, s[32:35], s57 offen offset:1024 lds
    buffer_load_dwordx4 v210, s[32:35], s57 offen offset:2048 lds
    buffer_load_dwordx4 v211, s[32:35], s57 offen offset:3072 lds
    s_add_u32 m0, s53, 32768
    s_nop 0
    buffer_load_dwordx4 v208, s[36:39], s57 offen offset:0 lds
    buffer_load_dwordx4 v209, s[36:39], s57 offen offset:1024 lds
    buffer_load_dwordx4 v210, s[36:39], s57 offen offset:2048 lds
    buffer_load_dwordx4 v211, s[36:39], s57 offen offset:3072 lds
    s_mov_b32 m0, s53
    s_nop 0
    buffer_load_dwordx4 v206, s[28:31], s56 offen offset:0 sc1 lds
    buffer_load_dwordx4 v206, s[28:31], s56 offen offset:1024 sc1 lds
    buffer_load_dwordx4 v207, s[28:31], s56 offen offset:2048 sc1 lds
    buffer_load_dwordx4 v207, s[28:31], s56 offen offset:3072 sc1 lds
    s_add_u32 s53, s53, 49152
    s_cmp_ge_u32 s53, s61
    s_cselect_b32 s53, s60, s53
    s_sub_u32 s54, s54, 1
    s_cbranch_scc0 M_Q_loop3
    s_waitcnt vmcnt(12)
    s_barrier
    s_bfe_u32 s66, s2, 0x30003
    s_lshr_b32 s55, s2, 6
    s_add_u32 s66, s66, s55
    s_mul_i32 s55, s66, 11
    s_lshr_b32 s55, s55, 5
    s_mul_i32 s55, s55, 3
    s_sub_u32 s66, s66, s55
    s_mov_b32 s58, 0x67534201
    s_mov_b32 s59, 0xfecdb9a8
    s_cmp_eq_u32 s66, 1
    s_cselect_b32 s58, 0x86453120, s58
    s_cselect_b32 s59, 0xfdecab97, s59
    s_cmp_eq_u32 s66, 2
    s_cselect_b32 s58, 0x75642310, s58
    s_cselect_b32 s59, 0xefdbca89, s59
    v_or_b32 v206, s69, v206
    v_or_b32 v207, s69, v207
    s_and_b32 s57, s58, 15
    s_lshr_b64 s[58:59], s[58:59], 4
    s_lshl_b32 s56, s57, 11
    s_mul_i32 s57, s57, 0x70000
    s_add_u32 m0, s53, 16384
    s_nop 0
    buffer_load_dwordx4 v212, s[32:35], s57 offen offset:0 lds
    buffer_load_dwordx4 v213, s[32:35], s57 offen offset:1024 lds
    buffer_load_dwordx4 v214, s[32:35], s57 offen offset:2048 lds
    buffer_load_dwordx4 v215, s[32:35], s57 offen offset:3072 lds
    s_add_u32 m0, s53, 32768
    s_nop 0
    buffer_load_dwordx4 v212, s[36:39], s57 offen offset:0 lds
    buffer_load_dwordx4 v213, s[36:39], s57 offen offset:1024 lds
    buffer_load_dwordx4 v214, s[36:39], s57 offen offset:2048 lds
    buffer_load_dwordx4 v215, s[36:39], s57 offen offset:3072 lds
    s_mov_b32 m0, s53
    s_nop 0
    buffer_load_dwordx4 v206, s[28:31], s56 offen offset:0 sc1 lds
    buffer_load_dwordx4 v206, s[28:31], s56 offen offset:1024 sc1 lds
    buffer_load_dwordx4 v207, s[28:31], s56 offen offset:2048 sc1 lds
    buffer_load_dwordx4 v207, s[28:31], s56 offen offset:3072 sc1 lds
    s_add_u32 s53, s53, 49152
    s_cmp_ge_u32 s53, s61
    s_cselect_b32 s53, s60, s53
    s_waitcnt vmcnt(12)
    s_barrier
    s_and_b32 s57, s58, 15
    s_lshr_b64 s[58:59], s[58:59], 4
    s_lshl_b32 s56, s57, 11
    s_mul_i32 s57, s57, 0x70000
    s_add_u32 m0, s53, 16384
    s_nop 0
    buffer_load_dwordx4 v212, s[32:35], s57 offen offset:0 lds
    buffer_load_dwordx4 v213, s[32:35], s57 offen offset:1024 lds
    buffer_load_dwordx4 v214, s[32:35], s57 offen offset:2048 lds
    buffer_load_dwordx4 v215, s[32:35], s57 offen offset:3072 lds
    s_add_u32 m0, s53, 32768
    s_nop 0
    buffer_load_dwordx4 v212, s[36:39], s57 offen offset:0 lds
    buffer_load_dwordx4 v213, s[36:39], s57 offen offset:1024 lds
    buffer_load_dwordx4 v214, s[36:39], s57 offen offset:2048 lds
    buffer_load_dwordx4 v215, s[36:39], s57 offen offset:3072 lds
    s_mov_b32 m0, s53
    s_nop 0
    buffer_load_dwordx4 v206, s[28:31], s56 offen offset:0 sc1 lds
    buffer_load_dwordx4 v206, s[28:31], s56 offen offset:1024 sc1 lds
    buffer_load_dwordx4 v207, s[28:31], s56 offen offset:2048 sc1 lds
    buffer_load_dwordx4 v207, s[28:31], s56 offen offset:3072 sc1 lds
    s_add_u32 s53, s53, 49152
    s_cmp_ge_u32 s53, s61
    s_cselect_b32 s53, s60, s53
    s_waitcnt vmcnt(12)
    s_barrier
    s_cmp_lg_u32 s69, 0
    s_cbranch_scc1 M_Qidle
    ds_read_b128 v[136:139], v232 offset:0
    ds_read_b64_tr_b16 v[152:153], v235 offset:0
    ds_read_b64_tr_b16 v[154:155], v235 offset:4096
    ds_read_b64_tr_b16 v[156:157], v236 offset:0
    ds_read_b64_tr_b16 v[158:159], v236 offset:4096
    ds_read_b64_tr_b16 v[160:161], v237 offset:0
    ds_read_b64_tr_b16 v[162:163], v237 offset:4096
    ds_read_b64_tr_b16 v[164:165], v238 offset:0
    ds_read_b64_tr_b16 v[166:167], v238 offset:4096
    ds_read_b64_tr_b16 v[168:169], v235 offset:16384
    ds_read_b64_tr_b16 v[170:171], v235 offset:20480
    ds_read_b64_tr_b16 v[172:173], v236 offset:16384
    ds_read_b64_tr_b16 v[174:175], v236 offset:20480
    ds_read_b64_tr_b16 v[176:177], v237 offset:16384
    ds_read_b64_tr_b16 v[178:179], v237 offset:20480
    ds_read_b64_tr_b16 v[180:181], v238 offset:16384
    ds_read_b64_tr_b16 v[182:183], v238 offset:20480
    ds_read_b128 v[140:143], v232 offset:2048
    ds_read_b128 v[144:147], v232 offset:4096
    ds_read_b128 v[148:151], v232 offset:6144
    s_and_b32 s57, s58, 15
    s_lshr_b64 s[58:59], s[58:59], 4
    s_lshl_b32 s56, s57, 11
    s_mul_i32 s57, s57, 0x70000
    s_add_u32 m0, s53, 16384
    s_nop 0
    buffer_load_dwordx4 v212, s[32:35], s57 offen offset:0 lds
    buffer_load_dwordx4 v213, s[32:35], s57 offen offset:1024 lds
    buffer_load_dwordx4 v214, s[32:35], s57 offen offset:2048 lds
    buffer_load_dwordx4 v215, s[32:35], s57 offen offset:3072 lds
    s_add_u32 m0, s53, 32768
    s_nop 0
    buffer_load_dwordx4 v212, s[36:39], s57 offen offset:0 lds
    buffer_load_dwordx4 v213, s[36:39], s57 offen offset:1024 lds
    buffer_load_dwordx4 v214, s[36:39], s57 offen offset:2048 lds
    buffer_load_dwordx4 v215, s[36:39], s57 offen offset:3072 lds
    s_mov_b32 m0, s53
    s_nop 0
    buffer_load_dwordx4 v206, s[28:31], s56 offen offset:0 sc1 lds
    buffer_load_dwordx4 v206, s[28:31], s56 offen offset:1024 sc1 lds
    buffer_load_dwordx4 v207, s[28:31], s56 offen offset:2048 sc1 lds
    buffer_load_dwordx4 v207, s[28:31], s56 offen offset:3072 sc1 lds
    s_add_u32 s53, s53, 49152
    s_cmp_ge_u32 s53, s61
    s_cselect_b32 s53, s60, s53
    s_setprio 2
    s_add_u32 s52, s52, 49152
    s_cmp_ge_u32 s52, 147456
    s_cselect_b32 s52, 0, s52
    s_waitcnt lgkmcnt(0)
    v_mfma_f32_16x16x32_bf16 v[8:11], v[152:155], v[136:139], 0
    ds_read_b128 v[184:187], v232 offset:1024
    v_mfma_f32_16x16x32_bf16 v[12:15], v[156:159], v[136:139], 0
    ds_read_b64_tr_b16 v[200:201], v235 offset:8192
    v_mfma_f32_16x16x32_bf16 v[16:19], v[160:163], v[136:139], 0
    ds_read_b64_tr_b16 v[202:203], v235 offset:12288
    v_mfma_f32_16x16x32_bf16 v[20:23], v[164:167], v[136:139], 0
    ds_read_b64_tr_b16 v[204:205], v236 offset:8192
    v_mfma_f32_16x16x32_bf16 v[24:27], v[168:171], v[136:139], 0
    v_mfma_f32_16x16x32_bf16 v[28:31], v[172:175], v[136:139], 0
    ds_read_b64_tr_b16 v[206:207], v236 offset:12288
    v_mfma_f32_16x16x32_bf16 v[32:35], v[176:179], v[136:139], 0
    ds_read_b64_tr_b16 v[208:209], v237 offset:8192
    v_mfma_f32_16x16x32_bf16 v[36:39], v[180:183], v[136:139], 0
    ds_read_b64_tr_b16 v[210:211], v237 offset:12288
    v_mfma_f32_16x16x32_bf16 v[40:43], v[152:155], v[140:143], 0
    ds_read_b64_tr_b16 v[212:213], v238 offset:8192
    v_mfma_f32_16x16x32_bf16 v[44:47], v[156:159], v[140:143], 0
    v_mfma_f32_16x16x32_bf16 v[48:51], v[160:163], v[140:143], 0
    ds_read_b64_tr_b16 v[214:215], v238 offset:12288
    v_mfma_f32_16x16x32_bf16 v[52:55], v[164:167], v[140:143], 0
    ds_read_b64_tr_b16 v[216:217], v235 offset:24576
    v_mfma_f32_16x16x32_bf16 v[56:59], v[168:171], v[140:143], 0
    ds_read_b64_tr_b16 v[218:219], v235 offset:28672
    v_mfma_f32_16x16x32_bf16 v[60:63], v[172:175], v[140:143], 0
    ds_read_b64_tr_b16 v[220:221], v236 offset:24576
    v_mfma_f32_16x16x32_bf16 v[64:67], v[176:179], v[140:143], 0
    v_mfma_f32_16x16x32_bf16 v[68:71], v[180:183], v[140:143], 0
    ds_read_b64_tr_b16 v[222:223], v236 offset:28672
    v_mfma_f32_16x16x32_bf16 v[72:75], v[152:155], v[144:147], 0
    ds_read_b64_tr_b16 v[224:225], v237 offset:24576
    v_mfma_f32_16x16x32_bf16 v[76:79], v[156:159], v[144:147], 0
    ds_read_b64_tr_b16 v[226:227], v237 offset:28672
    v_mfma_f32_16x16x32_bf16 v[80:83], v[160:163], v[144:147], 0
    ds_read_b64_tr_b16 v[228:229], v238 offset:24576
    v_mfma_f32_16x16x32_bf16 v[84:87], v[164:167], v[144:147], 0
    v_mfma_f32_16x16x32_bf16 v[88:91], v[168:171], v[144:147], 0
    ds_read_b64_tr_b16 v[230:231], v238 offset:28672
    v_mfma_f32_16x16x32_bf16 v[92:95], v[172:175], v[144:147], 0
    ds_read_b128 v[188:191], v232 offset:3072
    v_mfma_f32_16x16x32_bf16 v[96:99], v[176:179], v[144:147], 0
    ds_read_b128 v[192:195], v232 offset:5120
    v_mfma_f32_16x16x32_bf16 v[100:103], v[180:183], v[144:147], 0
    ds_read_b128 v[196:199], v232 offset:7168
    v_mfma_f32_16x16x32_bf16 v[104:107], v[152:155], v[148:151], 0
    v_mfma_f32_16x16x32_bf16 v[108:111], v[156:159], v[148:151], 0
    v_add_u32 v232, s52, v233
    v_mfma_f32_16x16x32_bf16 v[112:115], v[160:163], v[148:151], 0
    v_add_u32 v235, s52, v239
    v_mfma_f32_16x16x32_bf16 v[116:119], v[164:167], v[148:151], 0
    v_add_u32 v236, s52, v240
    v_mfma_f32_16x16x32_bf16 v[120:123], v[168:171], v[148:151], 0
    v_mfma_f32_16x16x32_bf16 v[124:127], v[172:175], v[148:151], 0
    v_add_u32 v237, s52, v241
    v_mfma_f32_16x16x32_bf16 v[128:131], v[176:179], v[148:151], 0
    v_add_u32 v238, s52, v242
    v_mfma_f32_16x16x32_bf16 v[132:135], v[180:183], v[148:151], 0
    s_waitcnt lgkmcnt(0)
    v_mfma_f32_16x16x32_bf16 v[8:11], v[200:203], v[184:187], v[8:11]
    s_waitcnt vmcnt(12)
    s_barrier
    v_mfma_f32_16x16x32_bf16 v[12:15], v[204:207], v[184:187], v[12:15]
    ds_read_b128 v[136:139], v232 offset:0
    v_mfma_f32_16x16x32_bf16 v[16:19], v[208:211], v[184:187], v[16:19]
    ds_read_b64_tr_b16 v[152:153], v235 offset:0
    v_mfma_f32_16x16x32_bf16 v[20:23], v[212:215], v[184:187], v[20:23]
    ds_read_b64_tr_b16 v[154:155], v235 offset:4096
    v_mfma_f32_16x16x32_bf16 v[24:27], v[216:219], v[184:187], v[24:27]
    ds_read_b64_tr_b16 v[156:157], v236 offset:0
    v_mfma_f32_16x16x32_bf16 v[28:31], v[220:223], v[184:187], v[28:31]
    ds_read_b64_tr_b16 v[158:159], v236 offset:4096
    v_mfma_f32_16x16x32_bf16 v[32:35], v[224:227], v[184:187], v[32:35]
    v_mfma_f32_16x16x32_bf16 v[36:39], v[228:231], v[184:187], v[36:39]
    ds_read_b64_tr_b16 v[160:161], v237 offset:0
    v_mfma_f32_16x16x32_bf16 v[40:43], v[200:203], v[188:191], v[40:43]
    ds_read_b64_tr_b16 v[162:163], v237 offset:4096
    v_mfma_f32_16x16x32_bf16 v[44:47], v[204:207], v[188:191], v[44:47]
    ds_read_b64_tr_b16 v[164:165], v238 offset:0
    v_mfma_f32_16x16x32_bf16 v[48:51], v[208:211], v[188:191], v[48:51]
    ds_read_b64_tr_b16 v[166:167], v238 offset:4096
    v_mfma_f32_16x16x32_bf16 v[52:55], v[212:215], v[188:191], v[52:55]
    ds_read_b64_tr_b16 v[168:169], v235 offset:16384
    v_mfma_f32_16x16x32_bf16 v[56:59], v[216:219], v[188:191], v[56:59]
    v_mfma_f32_16x16x32_bf16 v[60:63], v[220:223], v[188:191], v[60:63]
    ds_read_b64_tr_b16 v[170:171], v235 offset:20480
    v_mfma_f32_16x16x32_bf16 v[64:67], v[224:227], v[188:191], v[64:67]
    ds_read_b64_tr_b16 v[172:173], v236 offset:16384
    v_mfma_f32_16x16x32_bf16 v[68:71], v[228:231], v[188:191], v[68:71]
    ds_read_b64_tr_b16 v[174:175], v236 offset:20480
    v_mfma_f32_16x16x32_bf16 v[72:75], v[200:203], v[192:195], v[72:75]
    ds_read_b64_tr_b16 v[176:177], v237 offset:16384
    v_mfma_f32_16x16x32_bf16 v[76:79], v[204:207], v[192:195], v[76:79]
    ds_read_b64_tr_b16 v[178:179], v237 offset:20480
    v_mfma_f32_16x16x32_bf16 v[80:83], v[208:211], v[192:195], v[80:83]
    v_mfma_f32_16x16x32_bf16 v[84:87], v[212:215], v[192:195], v[84:87]
    ds_read_b64_tr_b16 v[180:181], v238 offset:16384
    v_mfma_f32_16x16x32_bf16 v[88:91], v[216:219], v[192:195], v[88:91]
    ds_read_b64_tr_b16 v[182:183], v238 offset:20480
    v_mfma_f32_16x16x32_bf16 v[92:95], v[220:223], v[192:195], v[92:95]
    ds_read_b128 v[140:143], v232 offset:2048
    v_mfma_f32_16x16x32_bf16 v[96:99], v[224:227], v[192:195], v[96:99]
    ds_read_b128 v[144:147], v232 offset:4096
    v_mfma_f32_16x16x32_bf16 v[100:103], v[228:231], v[192:195], v[100:103]
    ds_read_b128 v[148:151], v232 offset:6144
    v_mfma_f32_16x16x32_bf16 v[104:107], v[200:203], v[196:199], v[104:107]
    v_mfma_f32_16x16x32_bf16 v[108:111], v[204:207], v[196:199], v[108:111]
    v_mfma_f32_16x16x32_bf16 v[112:115], v[208:211], v[196:199], v[112:115]
    v_mfma_f32_16x16x32_bf16 v[116:119], v[212:215], v[196:199], v[116:119]
    v_mfma_f32_16x16x32_bf16 v[120:123], v[216:219], v[196:199], v[120:123]
    v_mfma_f32_16x16x32_bf16 v[124:127], v[220:223], v[196:199], v[124:127]
    v_mfma_f32_16x16x32_bf16 v[128:131], v[224:227], v[196:199], v[128:131]
    s_add_u32 s52, s52, 49152
    s_cmp_ge_u32 s52, 147456
    s_cselect_b32 s52, 0, s52
    v_mfma_f32_16x16x32_bf16 v[132:135], v[228:231], v[196:199], v[132:135]
    s_waitcnt lgkmcnt(0)
    v_mfma_f32_16x16x32_bf16 v[8:11], v[152:155], v[136:139], v[8:11]
    ds_read_b128 v[184:187], v232 offset:1024
    v_mfma_f32_16x16x32_bf16 v[12:15], v[156:159], v[136:139], v[12:15]
    ds_read_b64_tr_b16 v[200:201], v235 offset:8192
    v_mfma_f32_16x16x32_bf16 v[16:19], v[160:163], v[136:139], v[16:19]
    ds_read_b64_tr_b16 v[202:203], v235 offset:12288
    v_mfma_f32_16x16x32_bf16 v[20:23], v[164:167], v[136:139], v[20:23]
    ds_read_b64_tr_b16 v[204:205], v236 offset:8192
    v_mfma_f32_16x16x32_bf16 v[24:27], v[168:171], v[136:139], v[24:27]
    v_mfma_f32_16x16x32_bf16 v[28:31], v[172:175], v[136:139], v[28:31]
    ds_read_b64_tr_b16 v[206:207], v236 offset:12288
    v_mfma_f32_16x16x32_bf16 v[32:35], v[176:179], v[136:139], v[32:35]
    ds_read_b64_tr_b16 v[208:209], v237 offset:8192
    v_mfma_f32_16x16x32_bf16 v[36:39], v[180:183], v[136:139], v[36:39]
    ds_read_b64_tr_b16 v[210:211], v237 offset:12288
    v_mfma_f32_16x16x32_bf16 v[40:43], v[152:155], v[140:143], v[40:43]
    ds_read_b64_tr_b16 v[212:213], v238 offset:8192
    v_mfma_f32_16x16x32_bf16 v[44:47], v[156:159], v[140:143], v[44:47]
    v_mfma_f32_16x16x32_bf16 v[48:51], v[160:163], v[140:143], v[48:51]
    ds_read_b64_tr_b16 v[214:215], v238 offset:12288
    v_mfma_f32_16x16x32_bf16 v[52:55], v[164:167], v[140:143], v[52:55]
    ds_read_b64_tr_b16 v[216:217], v235 offset:24576
    v_mfma_f32_16x16x32_bf16 v[56:59], v[168:171], v[140:143], v[56:59]
    ds_read_b64_tr_b16 v[218:219], v235 offset:28672
    v_mfma_f32_16x16x32_bf16 v[60:63], v[172:175], v[140:143], v[60:63]
    ds_read_b64_tr_b16 v[220:221], v236 offset:24576
    v_mfma_f32_16x16x32_bf16 v[64:67], v[176:179], v[140:143], v[64:67]
    v_mfma_f32_16x16x32_bf16 v[68:71], v[180:183], v[140:143], v[68:71]
    ds_read_b64_tr_b16 v[222:223], v236 offset:28672
    v_mfma_f32_16x16x32_bf16 v[72:75], v[152:155], v[144:147], v[72:75]
    ds_read_b64_tr_b16 v[224:225], v237 offset:24576
    v_mfma_f32_16x16x32_bf16 v[76:79], v[156:159], v[144:147], v[76:79]
    ds_read_b64_tr_b16 v[226:227], v237 offset:28672
    v_mfma_f32_16x16x32_bf16 v[80:83], v[160:163], v[144:147], v[80:83]
    ds_read_b64_tr_b16 v[228:229], v238 offset:24576
    v_mfma_f32_16x16x32_bf16 v[84:87], v[164:167], v[144:147], v[84:87]
    v_mfma_f32_16x16x32_bf16 v[88:91], v[168:171], v[144:147], v[88:91]
    ds_read_b64_tr_b16 v[230:231], v238 offset:28672
    v_mfma_f32_16x16x32_bf16 v[92:95], v[172:175], v[144:147], v[92:95]
    ds_read_b128 v[188:191], v232 offset:3072
    v_mfma_f32_16x16x32_bf16 v[96:99], v[176:179], v[144:147], v[96:99]
    ds_read_b128 v[192:195], v232 offset:5120
    v_mfma_f32_16x16x32_bf16 v[100:103], v[180:183], v[144:147], v[100:103]
    ds_read_b128 v[196:199], v232 offset:7168
    v_mfma_f32_16x16x32_bf16 v[104:107], v[152:155], v[148:151], v[104:107]
    v_mfma_f32_16x16x32_bf16 v[108:111], v[156:159], v[148:151], v[108:111]
    v_add_u32 v232, s52, v233
    v_mfma_f32_16x16x32_bf16 v[112:115], v[160:163], v[148:151], v[112:115]
    v_add_u32 v235, s52, v239
    v_mfma_f32_16x16x32_bf16 v[116:119], v[164:167], v[148:151], v[116:119]
    v_add_u32 v236, s52, v240
    v_mfma_f32_16x16x32_bf16 v[120:123], v[168:171], v[148:151], v[120:123]
    v_mfma_f32_16x16x32_bf16 v[124:127], v[172:175], v[148:151], v[124:127]
    v_add_u32 v237, s52, v241
    v_mfma_f32_16x16x32_bf16 v[128:131], v[176:179], v[148:151], v[128:131]
    v_add_u32 v238, s52, v242
    v_mfma_f32_16x16x32_bf16 v[132:135], v[180:183], v[148:151], v[132:135]
    s_waitcnt lgkmcnt(0)
    v_mfma_f32_16x16x32_bf16 v[8:11], v[200:203], v[184:187], v[8:11]
    s_waitcnt vmcnt(0)
    s_barrier
    v_mfma_f32_16x16x32_bf16 v[12:15], v[204:207], v[184:187], v[12:15]
    ds_read_b128 v[136:139], v232 offset:0
    v_mfma_f32_16x16x32_bf16 v[16:19], v[208:211], v[184:187], v[16:19]
    ds_read_b64_tr_b16 v[152:153], v235 offset:0
    v_mfma_f32_16x16x32_bf16 v[20:23], v[212:215], v[184:187], v[20:23]
    ds_read_b64_tr_b16 v[154:155], v235 offset:4096
    v_mfma_f32_16x16x32_bf16 v[24:27], v[216:219], v[184:187], v[24:27]
    ds_read_b64_tr_b16 v[156:157], v236 offset:0
    v_mfma_f32_16x16x32_bf16 v[28:31], v[220:223], v[184:187], v[28:31]
    ds_read_b64_tr_b16 v[158:159], v236 offset:4096
    v_mfma_f32_16x16x32_bf16 v[32:35], v[224:227], v[184:187], v[32:35]
    v_mfma_f32_16x16x32_bf16 v[36:39], v[228:231], v[184:187], v[36:39]
    ds_read_b64_tr_b16 v[160:161], v237 offset:0
    v_mfma_f32_16x16x32_bf16 v[40:43], v[200:203], v[188:191], v[40:43]
    ds_read_b64_tr_b16 v[162:163], v237 offset:4096
    v_mfma_f32_16x16x32_bf16 v[44:47], v[204:207], v[188:191], v[44:47]
    ds_read_b64_tr_b16 v[164:165], v238 offset:0
    v_mfma_f32_16x16x32_bf16 v[48:51], v[208:211], v[188:191], v[48:51]
    ds_read_b64_tr_b16 v[166:167], v238 offset:4096
    v_mfma_f32_16x16x32_bf16 v[52:55], v[212:215], v[188:191], v[52:55]
    ds_read_b64_tr_b16 v[168:169], v235 offset:16384
    v_mfma_f32_16x16x32_bf16 v[56:59], v[216:219], v[188:191], v[56:59]
    v_mfma_f32_16x16x32_bf16 v[60:63], v[220:223], v[188:191], v[60:63]
    ds_read_b64_tr_b16 v[170:171], v235 offset:20480
    v_mfma_f32_16x16x32_bf16 v[64:67], v[224:227], v[188:191], v[64:67]
    ds_read_b64_tr_b16 v[172:173], v236 offset:16384
    v_mfma_f32_16x16x32_bf16 v[68:71], v[228:231], v[188:191], v[68:71]
    ds_read_b64_tr_b16 v[174:175], v236 offset:20480
    v_mfma_f32_16x16x32_bf16 v[72:75], v[200:203], v[192:195], v[72:75]
    ds_read_b64_tr_b16 v[176:177], v237 offset:16384
    v_mfma_f32_16x16x32_bf16 v[76:79], v[204:207], v[192:195], v[76:79]
    ds_read_b64_tr_b16 v[178:179], v237 offset:20480
    v_mfma_f32_16x16x32_bf16 v[80:83], v[208:211], v[192:195], v[80:83]
    v_mfma_f32_16x16x32_bf16 v[84:87], v[212:215], v[192:195], v[84:87]
    ds_read_b64_tr_b16 v[180:181], v238 offset:16384
    v_mfma_f32_16x16x32_bf16 v[88:91], v[216:219], v[192:195], v[88:91]
    ds_read_b64_tr_b16 v[182:183], v238 offset:20480
    v_mfma_f32_16x16x32_bf16 v[92:95], v[220:223], v[192:195], v[92:95]
    ds_read_b128 v[140:143], v232 offset:2048
    v_mfma_f32_16x16x32_bf16 v[96:99], v[224:227], v[192:195], v[96:99]
    ds_read_b128 v[144:147], v232 offset:4096
    v_mfma_f32_16x16x32_bf16 v[100:103], v[228:231], v[192:195], v[100:103]
    ds_read_b128 v[148:151], v232 offset:6144
    v_mfma_f32_16x16x32_bf16 v[104:107], v[200:203], v[196:199], v[104:107]
    v_mfma_f32_16x16x32_bf16 v[108:111], v[204:207], v[196:199], v[108:111]
    v_mfma_f32_16x16x32_bf16 v[112:115], v[208:211], v[196:199], v[112:115]
    v_mfma_f32_16x16x32_bf16 v[116:119], v[212:215], v[196:199], v[116:119]
    v_mfma_f32_16x16x32_bf16 v[120:123], v[216:219], v[196:199], v[120:123]
    v_mfma_f32_16x16x32_bf16 v[124:127], v[220:223], v[196:199], v[124:127]
    v_mfma_f32_16x16x32_bf16 v[128:131], v[224:227], v[196:199], v[128:131]
    s_add_u32 s52, s52, 49152
    s_cmp_ge_u32 s52, 147456
    s_cselect_b32 s52, 0, s52
    v_mfma_f32_16x16x32_bf16 v[132:135], v[228:231], v[196:199], v[132:135]
    s_waitcnt lgkmcnt(0)
    v_mfma_f32_16x16x32_bf16 v[8:11], v[152:155], v[136:139], v[8:11]
    ds_read_b128 v[184:187], v232 offset:1024
    v_mfma_f32_16x16x32_bf16 v[12:15], v[156:159], v[136:139], v[12:15]
    ds_read_b64_tr_b16 v[200:201], v235 offset:8192
    v_mfma_f32_16x16x32_bf16 v[16:19], v[160:163], v[136:139], v[16:19]
    ds_read_b64_tr_b16 v[202:203], v235 offset:12288
    v_mfma_f32_16x16x32_bf16 v[20:23], v[164:167], v[136:139], v[20:23]
    ds_read_b64_tr_b16 v[204:205], v236 offset:8192
    v_mfma_f32_16x16x32_bf16 v[24:27], v[168:171], v[136:139], v[24:27]
    v_mfma_f32_16x16x32_bf16 v[28:31], v[172:175], v[136:139], v[28:31]
    ds_read_b64_tr_b16 v[206:207], v236 offset:12288
    v_mfma_f32_16x16x32_bf16 v[32:35], v[176:179], v[136:139], v[32:35]
    ds_read_b64_tr_b16 v[208:209], v237 offset:8192
    v_mfma_f32_16x16x32_bf16 v[36:39], v[180:183], v[136:139], v[36:39]
    ds_read_b64_tr_b16 v[210:211], v237 offset:12288
    v_mfma_f32_16x16x32_bf16 v[40:43], v[152:155], v[140:143], v[40:43]
    ds_read_b64_tr_b16 v[212:213], v238 offset:8192
    v_mfma_f32_16x16x32_bf16 v[44:47], v[156:159], v[140:143], v[44:47]
    v_mfma_f32_16x16x32_bf16 v[48:51], v[160:163], v[140:143], v[48:51]
    ds_read_b64_tr_b16 v[214:215], v238 offset:12288
    v_mfma_f32_16x16x32_bf16 v[52:55], v[164:167], v[140:143], v[52:55]
    ds_read_b64_tr_b16 v[216:217], v235 offset:24576
    v_mfma_f32_16x16x32_bf16 v[56:59], v[168:171], v[140:143], v[56:59]
    ds_read_b64_tr_b16 v[218:219], v235 offset:28672
    v_mfma_f32_16x16x32_bf16 v[60:63], v[172:175], v[140:143], v[60:63]
    ds_read_b64_tr_b16 v[220:221], v236 offset:24576
    v_mfma_f32_16x16x32_bf16 v[64:67], v[176:179], v[140:143], v[64:67]
    v_mfma_f32_16x16x32_bf16 v[68:71], v[180:183], v[140:143], v[68:71]
    ds_read_b64_tr_b16 v[222:223], v236 offset:28672
    v_mfma_f32_16x16x32_bf16 v[72:75], v[152:155], v[144:147], v[72:75]
    s_movk_i32 s54, 12
M_Q_loop4:
    ds_read_b64_tr_b16 v[224:225], v237 offset:24576
    v_mfma_f32_16x16x32_bf16 v[76:79], v[156:159], v[144:147], v[76:79]
    ds_read_b64_tr_b16 v[226:227], v237 offset:28672
    v_mfma_f32_16x16x32_bf16 v[80:83], v[160:163], v[144:147], v[80:83]
    ds_read_b64_tr_b16 v[228:229], v238 offset:24576
    v_mfma_f32_16x16x32_bf16 v[84:87], v[164:167], v[144:147], v[84:87]
    v_mfma_f32_16x16x32_bf16 v[88:91], v[168:171], v[144:147], v[88:91]
    ds_read_b64_tr_b16 v[230:231], v238 offset:28672
    v_mfma_f32_16x16x32_bf16 v[92:95], v[172:175], v[144:147], v[92:95]
    ds_read_b128 v[188:191], v232 offset:3072
    v_mfma_f32_16x16x32_bf16 v[96:99], v[176:179], v[144:147], v[96:99]
    ds_read_b128 v[192:195], v232 offset:5120
    v_mfma_f32_16x16x32_bf16 v[100:103], v[180:183], v[144:147], v[100:103]
    ds_read_b128 v[196:199], v232 offset:7168
    v_mfma_f32_16x16x32_bf16 v[104:107], v[152:155], v[148:151], v[104:107]
    v_mfma_f32_16x16x32_bf16 v[108:111], v[156:159], v[148:151], v[108:111]
    v_add_u32 v232, s52, v233
    v_mfma_f32_16x16x32_bf16 v[112:115], v[160:163], v[148:151], v[112:115]
    v_add_u32 v235, s52, v239
    v_mfma_f32_16x16x32_bf16 v[116:119], v[164:167], v[148:151], v[116:119]
    v_add_u32 v236, s52, v240
    v_mfma_f32_16x16x32_bf16 v[120:123], v[168:171], v[148:151], v[120:123]
    v_mfma_f32_16x16x32_bf16 v[124:127], v[172:175], v[148:151], v[124:127]
    v_add_u32 v237, s52, v241
    v_mfma_f32_16x16x32_bf16 v[128:131], v[176:179], v[148:151], v[128:131]
    v_add_u32 v238, s52, v242
    v_mfma_f32_16x16x32_bf16 v[132:135], v[180:183], v[148:151], v[132:135]
    s_waitcnt lgkmcnt(0)
    v_mfma_f32_16x16x32_bf16 v[8:11], v[200:203], v[184:187], v[8:11]
    s_barrier
    v_mfma_f32_16x16x32_bf16 v[12:15], v[204:207], v[184:187], v[12:15]
    ds_read_b128 v[136:139], v232 offset:0
    v_mfma_f32_16x16x32_bf16 v[16:19], v[208:211], v[184:187], v[16:19]
    ds_read_b64_tr_b16 v[152:153], v235 offset:0
    v_mfma_f32_16x16x32_bf16 v[20:23], v[212:215], v[184:187], v[20:23]
    ds_read_b64_tr_b16 v[154:155], v235 offset:4096
    v_mfma_f32_16x16x32_bf16 v[24:27], v[216:219], v[184:187], v[24:27]
    ds_read_b64_tr_b16 v[156:157], v236 offset:0
    v_mfma_f32_16x16x32_bf16 v[28:31], v[220:223], v[184:187], v[28:31]
    ds_read_b64_tr_b16 v[158:159], v236 offset:4096
    v_mfma_f32_16x16x32_bf16 v[32:35], v[224:227], v[184:187], v[32:35]
    v_mfma_f32_16x16x32_bf16 v[36:39], v[228:231], v[184:187], v[36:39]
    ds_read_b64_tr_b16 v[160:161], v237 offset:0
    v_mfma_f32_16x16x32_bf16 v[40:43], v[200:203], v[188:191], v[40:43]
    ds_read_b64_tr_b16 v[162:163], v237 offset:4096
    v_mfma_f32_16x16x32_bf16 v[44:47], v[204:207], v[188:191], v[44:47]
    ds_read_b64_tr_b16 v[164:165], v238 offset:0
    v_mfma_f32_16x16x32_bf16 v[48:51], v[208:211], v[188:191], v[48:51]
    ds_read_b64_tr_b16 v[166:167], v238 offset:4096
    v_mfma_f32_16x16x32_bf16 v[52:55], v[212:215], v[188:191], v[52:55]
    ds_read_b64_tr_b16 v[168:169], v235 offset:16384
    v_mfma_f32_16x16x32_bf16 v[56:59], v[216:219], v[188:191], v[56:59]
    v_mfma_f32_16x16x32_bf16 v[60:63], v[220:223], v[188:191], v[60:63]
    ds_read_b64_tr_b16 v[170:171], v235 offset:20480
    v_mfma_f32_16x16x32_bf16 v[64:67], v[224:227], v[188:191], v[64:67]
    ds_read_b64_tr_b16 v[172:173], v236 offset:16384
    v_mfma_f32_16x16x32_bf16 v[68:71], v[228:231], v[188:191], v[68:71]
    ds_read_b64_tr_b16 v[174:175], v236 offset:20480
    v_mfma_f32_16x16x32_bf16 v[72:75], v[200:203], v[192:195], v[72:75]
    ds_read_b64_tr_b16 v[176:177], v237 offset:16384
    v_mfma_f32_16x16x32_bf16 v[76:79], v[204:207], v[192:195], v[76:79]
    ds_read_b64_tr_b16 v[178:179], v237 offset:20480
    v_mfma_f32_16x16x32_bf16 v[80:83], v[208:211], v[192:195], v[80:83]
    v_mfma_f32_16x16x32_bf16 v[84:87], v[212:215], v[192:195], v[84:87]
    ds_read_b64_tr_b16 v[180:181], v238 offset:16384
    v_mfma_f32_16x16x32_bf16 v[88:91], v[216:219], v[192:195], v[88:91]
    ds_read_b64_tr_b16 v[182:183], v238 offset:20480
    v_mfma_f32_16x16x32_bf16 v[92:95], v[220:223], v[192:195], v[92:95]
    ds_read_b128 v[140:143], v232 offset:2048
    v_mfma_f32_16x16x32_bf16 v[96:99], v[224:227], v[192:195], v[96:99]
    ds_read_b128 v[144:147], v232 offset:4096
    v_mfma_f32_16x16x32_bf16 v[100:103], v[228:231], v[192:195], v[100:103]
    ds_read_b128 v[148:151], v232 offset:6144
    v_mfma_f32_16x16x32_bf16 v[104:107], v[200:203], v[196:199], v[104:107]
    v_mfma_f32_16x16x32_bf16 v[108:111], v[204:207], v[196:199], v[108:111]
    v_mfma_f32_16x16x32_bf16 v[112:115], v[208:211], v[196:199], v[112:115]
    v_mfma_f32_16x16x32_bf16 v[116:119], v[212:215], v[196:199], v[116:119]
    v_mfma_f32_16x16x32_bf16 v[120:123], v[216:219], v[196:199], v[120:123]
    v_mfma_f32_16x16x32_bf16 v[124:127], v[220:223], v[196:199], v[124:127]
    v_mfma_f32_16x16x32_bf16 v[128:131], v[224:227], v[196:199], v[128:131]
    s_add_u32 s52, s52, 49152
    s_cmp_ge_u32 s52, 147456
    s_cselect_b32 s52, 0, s52
    v_mfma_f32_16x16x32_bf16 v[132:135], v[228:231], v[196:199], v[132:135]
    s_waitcnt lgkmcnt(0)
    v_mfma_f32_16x16x32_bf16 v[8:11], v[152:155], v[136:139], v[8:11]
    ds_read_b128 v[184:187], v232 offset:1024
    v_mfma_f32_16x16x32_bf16 v[12:15], v[156:159], v[136:139], v[12:15]
    ds_read_b64_tr_b16 v[200:201], v235 offset:8192
    v_mfma_f32_16x16x32_bf16 v[16:19], v[160:163], v[136:139], v[16:19]
    ds_read_b64_tr_b16 v[202:203], v235 offset:12288
    v_mfma_f32_16x16x32_bf16 v[20:23], v[164:167], v[136:139], v[20:23]
    ds_read_b64_tr_b16 v[204:205], v236 offset:8192
    v_mfma_f32_16x16x32_bf16 v[24:27], v[168:171], v[136:139], v[24:27]
    v_mfma_f32_16x16x32_bf16 v[28:31], v[172:175], v[136:139], v[28:31]
    ds_read_b64_tr_b16 v[206:207], v236 offset:12288
    v_mfma_f32_16x16x32_bf16 v[32:35], v[176:179], v[136:139], v[32:35]
    ds_read_b64_tr_b16 v[208:209], v237 offset:8192
    v_mfma_f32_16x16x32_bf16 v[36:39], v[180:183], v[136:139], v[36:39]
    ds_read_b64_tr_b16 v[210:211], v237 offset:12288
    v_mfma_f32_16x16x32_bf16 v[40:43], v[152:155], v[140:143], v[40:43]
    ds_read_b64_tr_b16 v[212:213], v238 offset:8192
    v_mfma_f32_16x16x32_bf16 v[44:47], v[156:159], v[140:143], v[44:47]
    v_mfma_f32_16x16x32_bf16 v[48:51], v[160:163], v[140:143], v[48:51]
    ds_read_b64_tr_b16 v[214:215], v238 offset:12288
    v_mfma_f32_16x16x32_bf16 v[52:55], v[164:167], v[140:143], v[52:55]
    ds_read_b64_tr_b16 v[216:217], v235 offset:24576
    v_mfma_f32_16x16x32_bf16 v[56:59], v[168:171], v[140:143], v[56:59]
    ds_read_b64_tr_b16 v[218:219], v235 offset:28672
    v_mfma_f32_16x16x32_bf16 v[60:63], v[172:175], v[140:143], v[60:63]
    ds_read_b64_tr_b16 v[220:221], v236 offset:24576
    v_mfma_f32_16x16x32_bf16 v[64:67], v[176:179], v[140:143], v[64:67]
    v_mfma_f32_16x16x32_bf16 v[68:71], v[180:183], v[140:143], v[68:71]
    s_sub_u32 s54, s54, 1
    ds_read_b64_tr_b16 v[222:223], v236 offset:28672
    v_mfma_f32_16x16x32_bf16 v[72:75], v[152:155], v[144:147], v[72:75]
    s_cbranch_scc0 M_Q_loop4
    ds_read_b64_tr_b16 v[224:225], v237 offset:24576
    v_mfma_f32_16x16x32_bf16 v[76:79], v[156:159], v[144:147], v[76:79]
    ds_read_b64_tr_b16 v[226:227], v237 offset:28672
    v_mfma_f32_16x16x32_bf16 v[80:83], v[160:163], v[144:147], v[80:83]
    ds_read_b64_tr_b16 v[228:229], v238 offset:24576
    v_mfma_f32_16x16x32_bf16 v[84:87], v[164:167], v[144:147], v[84:87]
    v_mfma_f32_16x16x32_bf16 v[88:91], v[168:171], v[144:147], v[88:91]
    ds_read_b64_tr_b16 v[230:231], v238 offset:28672
    v_mfma_f32_16x16x32_bf16 v[92:95], v[172:175], v[144:147], v[92:95]
    ds_read_b128 v[188:191], v232 offset:3072
    v_mfma_f32_16x16x32_bf16 v[96:99], v[176:179], v[144:147], v[96:99]
    ds_read_b128 v[192:195], v232 offset:5120
    v_mfma_f32_16x16x32_bf16 v[100:103], v[180:183], v[144:147], v[100:103]
    ds_read_b128 v[196:199], v232 offset:7168
    v_mfma_f32_16x16x32_bf16 v[104:107], v[152:155], v[148:151], v[104:107]
    v_mfma_f32_16x16x32_bf16 v[108:111], v[156:159], v[148:151], v[108:111]
    v_mfma_f32_16x16x32_bf16 v[112:115], v[160:163], v[148:151], v[112:115]
    v_mfma_f32_16x16x32_bf16 v[116:119], v[164:167], v[148:151], v[116:119]
    v_mfma_f32_16x16x32_bf16 v[120:123], v[168:171], v[148:151], v[120:123]
    v_mfma_f32_16x16x32_bf16 v[124:127], v[172:175], v[148:151], v[124:127]
    v_mfma_f32_16x16x32_bf16 v[128:131], v[176:179], v[148:151], v[128:131]
    v_mfma_f32_16x16x32_bf16 v[132:135], v[180:183], v[148:151], v[132:135]
    s_waitcnt lgkmcnt(0)
    v_mfma_f32_16x16x32_bf16 v[8:11], v[200:203], v[184:187], v[8:11]
    s_barrier
    v_mfma_f32_16x16x32_bf16 v[12:15], v[204:207], v[184:187], v[12:15]
    v_mfma_f32_16x16x32_bf16 v[16:19], v[208:211], v[184:187], v[16:19]
    v_mfma_f32_16x16x32_bf16 v[20:23], v[212:215], v[184:187], v[20:23]
    v_mfma_f32_16x16x32_bf16 v[24:27], v[216:219], v[184:187], v[24:27]
    v_mfma_f32_16x16x32_bf16 v[28:31], v[220:223], v[184:187], v[28:31]
    v_mfma_f32_16x16x32_bf16 v[32:35], v[224:227], v[184:187], v[32:35]
    v_mfma_f32_16x16x32_bf16 v[36:39], v[228:231], v[184:187], v[36:39]
    v_mfma_f32_16x16x32_bf16 v[40:43], v[200:203], v[188:191], v[40:43]
    v_mfma_f32_16x16x32_bf16 v[44:47], v[204:207], v[188:191], v[44:47]
    v_mfma_f32_16x16x32_bf16 v[48:51], v[208:211], v[188:191], v[48:51]
    v_mfma_f32_16x16x32_bf16 v[52:55], v[212:215], v[188:191], v[52:55]
    v_mfma_f32_16x16x32_bf16 v[56:59], v[216:219], v[188:191], v[56:59]
    v_mfma_f32_16x16x32_bf16 v[60:63], v[220:223], v[188:191], v[60:63]
    v_mfma_f32_16x16x32_bf16 v[64:67], v[224:227], v[188:191], v[64:67]
    v_mfma_f32_16x16x32_bf16 v[68:71], v[228:231], v[188:191], v[68:71]
    v_mfma_f32_16x16x32_bf16 v[72:75], v[200:203], v[192:195], v[72:75]
    v_mfma_f32_16x16x32_bf16 v[76:79], v[204:207], v[192:195], v[76:79]
    v_mfma_f32_16x16x32_bf16 v[80:83], v[208:211], v[192:195], v[80:83]
    v_mfma_f32_16x16x32_bf16 v[84:87], v[212:215], v[192:195], v[84:87]
    v_mfma_f32_16x16x32_bf16 v[88:91], v[216:219], v[192:195], v[88:91]
    v_mfma_f32_16x16x32_bf16 v[92:95], v[220:223], v[192:195], v[92:95]
    v_mfma_f32_16x16x32_bf16 v[96:99], v[224:227], v[192:195], v[96:99]
    v_mfma_f32_16x16x32_bf16 v[100:103], v[228:231], v[192:195], v[100:103]
    v_mfma_f32_16x16x32_bf16 v[104:107], v[200:203], v[196:199], v[104:107]
    v_mfma_f32_16x16x32_bf16 v[108:111], v[204:207], v[196:199], v[108:111]
    v_mfma_f32_16x16x32_bf16 v[112:115], v[208:211], v[196:199], v[112:115]
    v_mfma_f32_16x16x32_bf16 v[116:119], v[212:215], v[196:199], v[116:119]
    v_mfma_f32_16x16x32_bf16 v[120:123], v[216:219], v[196:199], v[120:123]
    v_mfma_f32_16x16x32_bf16 v[124:127], v[220:223], v[196:199], v[124:127]
    v_mfma_f32_16x16x32_bf16 v[128:131], v[224:227], v[196:199], v[128:131]
    v_mfma_f32_16x16x32_bf16 v[132:135], v[228:231], v[196:199], v[132:135]
M_Qjoin:
    s_setprio 0
    s_lshl_b32 s60, s44, 12
    s_add_u32 s61, s60, 147456
    s_add_u32 s53, s60, 98304
    s_bfe_u32 s66, s2, 0x30003
    s_lshr_b32 s55, s2, 6
    s_add_u32 s66, s66, s55
    s_and_b32 s66, s66, 3
    s_mov_b32 s58, 0x31076453
    s_mov_b32 s59, 0x542
    s_cmp_eq_u32 s66, 1
    s_cselect_b32 s58, 0x20175643, s58
    s_cselect_b32 s59, 0x534, s59
    s_cmp_eq_u32 s66, 2
    s_cselect_b32 s58, 0x21067542, s58
    s_cselect_b32 s59, 0x453, s59
    s_cmp_eq_u32 s66, 3
    s_cselect_b32 s58, 0x20176534, s58
    s_cselect_b32 s59, 0x543, s59
    s_lshl_b32 s55, s49, 3
    s_mov_b32 s32, s16
    s_mov_b32 s33, s17
    s_mov_b32 s34, 0x700000
    s_mov_b32 s35, 0x20000
    s_add_u32 s36, s16, 0x100
    s_addc_u32 s37, s17, 0
    s_mov_b32 s38, 0x6fff00
    s_mov_b32 s39, 0x20000
    s_lshr_b32 s62, s48, 2
    s_sub_u32 s62, s48, s62
    s_add_u32 s62, s62, 16
    s_lshl_b32 s70, s62, 12
    s_lshl_b32 s64, s47, 3
    s_lshl_b32 s65, s45, 2
    s_add_u32 s64, s64, s65
    s_mul_i32 s64, s64, 114688
    s_add_u32 s64, s64, s70
    s_lshl_b32 s65, s46, 11
    s_add_u32 s64, s64, s65
    s_add_u32 s64, s64, 0x1500000
    s_or_b32 s64, s64, s69
    v_lshl_add_u32 v198, v1, 4, s64
    v_mul_f32 v24, v8, v24
    v_exp_f32 v216, -v8
    v_mul_f32 v25, v9, v25
    v_exp_f32 v217, -v9
    v_mul_f32 v26, v10, v26
    v_exp_f32 v218, -v10
    v_mul_f32 v27, v11, v27
    v_exp_f32 v219, -v11
    v_mul_f32 v28, v12, v28
    v_exp_f32 v220, -v12
    v_mul_f32 v29, v13, v29
    v_exp_f32 v221, -v13
    v_mul_f32 v30, v14, v30
    v_exp_f32 v222, -v14
    v_mul_f32 v31, v15, v31
    v_exp_f32 v223, -v15
    v_fma_f32 v216, v216, s67, s67
    v_fma_f32 v217, v217, s67, s67
    v_rcp_f32 v216, v216
    v_fma_f32 v218, v218, s67, s67
    v_rcp_f32 v217, v217
    v_fma_f32 v219, v219, s67, s67
    v_rcp_f32 v218, v218
    v_fma_f32 v220, v220, s67, s67
    v_rcp_f32 v219, v219
    v_fma_f32 v221, v221, s67, s67
    v_rcp_f32 v220, v220
    v_fma_f32 v222, v222, s67, s67
    v_rcp_f32 v221, v221
    v_fma_f32 v223, v223, s67, s67
    v_rcp_f32 v222, v222
    v_rcp_f32 v223, v223
    v_mul_f32 v24, v24, v216
    v_mul_f32 v25, v25, v217
    v_mul_f32 v26, v26, v218
    v_mul_f32 v27, v27, v219
    v_mul_f32 v28, v28, v220
    v_mul_f32 v29, v29, v221
    v_mul_f32 v30, v30, v222
    v_mul_f32 v31, v31, v223
    s_barrier
    s_and_b32 s57, s58, 15
    s_lshr_b64 s[58:59], s[58:59], 4
    s_add_u32 s57, s57, s55
    s_lshl_b32 s56, s57, 11
    s_mul_i32 s57, s57, 0x20000
    s_add_u32 m0, s53, 16384
    s_nop 0
    buffer_load_dwordx4 v248, s[32:35], s57 offen offset:0 lds
    v_cvt_pk_bf16_f32 v200, v24, v25
    v_cvt_pk_bf16_f32 v201, v26, v27
    v_cvt_pk_bf16_f32 v202, v28, v29
    v_cvt_pk_bf16_f32 v203, v30, v31
    buffer_load_dwordx4 v249, s[32:35], s57 offen offset:1024 lds
    v_mul_f32 v32, v16, v32
    v_exp_f32 v224, -v16
    v_mul_f32 v33, v17, v33
    v_exp_f32 v225, -v17
    v_mul_f32 v34, v18, v34
    buffer_load_dwordx4 v250, s[32:35], s57 offen offset:2048 lds
    v_exp_f32 v226, -v18
    v_mul_f32 v35, v19, v35
    v_exp_f32 v227, -v19
    v_mul_f32 v36, v20, v36
    v_exp_f32 v228, -v20
    v_mul_f32 v37, v21, v37
    buffer_load_dwordx4 v251, s[32:35], s57 offen offset:3072 lds
    v_exp_f32 v229, -v21
    v_mul_f32 v38, v22, v38
    v_exp_f32 v230, -v22
    v_mul_f32 v39, v23, v39
    s_add_u32 m0, s53, 32768
    s_nop 0
    buffer_load_dwordx4 v248, s[36:39], s57 offen offset:0 lds
    v_exp_f32 v231, -v23
    v_fma_f32 v224, v224, s67, s67
    v_fma_f32 v225, v225, s67, s67
    v_rcp_f32 v224, v224
    v_fma_f32 v226, v226, s67, s67
    v_rcp_f32 v225, v225
    buffer_load_dwordx4 v249, s[36:39], s57 offen offset:1024 lds
    v_fma_f32 v227, v227, s67, s67
    v_rcp_f32 v226, v226
    v_fma_f32 v228, v228, s67, s67
    v_rcp_f32 v227, v227
    v_fma_f32 v229, v229, s67, s67
    v_rcp_f32 v228, v228
    buffer_load_dwordx4 v250, s[36:39], s57 offen offset:2048 lds
    v_fma_f32 v230, v230, s67, s67
    v_rcp_f32 v229, v229
    v_fma_f32 v231, v231, s67, s67
    v_rcp_f32 v230, v230
    buffer_load_dwordx4 v251, s[36:39], s57 offen offset:3072 lds
    v_rcp_f32 v231, v231
    v_mul_f32 v32, v32, v224
    v_mul_f32 v33, v33, v225
    v_mul_f32 v34, v34, v226
    v_mul_f32 v35, v35, v227
    v_mul_f32 v36, v36, v228
    s_mov_b32 m0, s53
    s_nop 0
    buffer_load_dwordx4 v246, s[28:31], s56 offen offset:0 sc1 lds
    v_mul_f32 v37, v37, v229
    v_mul_f32 v38, v38, v230
    v_mul_f32 v39, v39, v231
    v_cvt_pk_bf16_f32 v204, v32, v33
    v_cvt_pk_bf16_f32 v205, v34, v35
    v_cvt_pk_bf16_f32 v206, v36, v37
    buffer_load_dwordx4 v246, s[28:31], s56 offen offset:1024 sc1 lds
    v_cvt_pk_bf16_f32 v207, v38, v39
    v_mul_f32 v56, v40, v56
    v_exp_f32 v216, -v40
    v_mul_f32 v57, v41, v57
    buffer_load_dwordx4 v247, s[28:31], s56 offen offset:2048 sc1 lds
    v_exp_f32 v217, -v41
    v_mul_f32 v58, v42, v58
    v_exp_f32 v218, -v42
    v_mul_f32 v59, v43, v59
    buffer_load_dwordx4 v247, s[28:31], s56 offen offset:3072 sc1 lds
    v_exp_f32 v219, -v43
    v_mul_f32 v60, v44, v60
    v_exp_f32 v220, -v44
    v_mul_f32 v61, v45, v61
    v_exp_f32 v221, -v45
    v_mul_f32 v62, v46, v62
    s_add_u32 s53, s53, 49152
    s_cmp_ge_u32 s53, s61
    s_cselect_b32 s53, s60, s53
    buffer_store_dwordx4 v[200:203], v198, s[28:31], 0 offen offset:0 sc1
    buffer_store_dwordx4 v[204:207], v198, s[28:31], 0 offen offset:1024 sc1
    v_add_u32 v198, 114688, v198
    s_barrier
    s_and_b32 s57, s58, 15
    s_lshr_b64 s[58:59], s[58:59], 4
    s_add_u32 s57, s57, s55
    s_lshl_b32 s56, s57, 11
    s_mul_i32 s57, s57, 0x20000
    s_add_u32 m0, s53, 16384
    s_nop 0
    buffer_load_dwordx4 v248, s[32:35], s57 offen offset:0 lds
    v_exp_f32 v222, -v46
    v_mul_f32 v63, v47, v63
    v_exp_f32 v223, -v47
    v_fma_f32 v216, v216, s67, s67
    v_fma_f32 v217, v217, s67, s67
    v_rcp_f32 v216, v216
    buffer_load_dwordx4 v249, s[32:35], s57 offen offset:1024 lds
    v_fma_f32 v218, v218, s67, s67
    v_rcp_f32 v217, v217
    v_fma_f32 v219, v219, s67, s67
    v_rcp_f32 v218, v218
    buffer_load_dwordx4 v250, s[32:35], s57 offen offset:2048 lds
    v_fma_f32 v220, v220, s67, s67
    v_rcp_f32 v219, v219
    v_fma_f32 v221, v221, s67, s67
    v_rcp_f32 v220, v220
    v_fma_f32 v222, v222, s67, s67
    v_rcp_f32 v221, v221
    buffer_load_dwordx4 v251, s[32:35], s57 offen offset:3072 lds
    v_fma_f32 v223, v223, s67, s67
    v_rcp_f32 v222, v222
    v_rcp_f32 v223, v223
    v_mul_f32 v56, v56, v216
    v_mul_f32 v57, v57, v217
    v_mul_f32 v58, v58, v218
    s_add_u32 m0, s53, 32768
    s_nop 0
    buffer_load_dwordx4 v248, s[36:39], s57 offen offset:0 lds
    v_mul_f32 v59, v59, v219
    v_mul_f32 v60, v60, v220
    v_mul_f32 v61, v61, v221
    v_mul_f32 v62, v62, v222
    buffer_load_dwordx4 v249, s[36:39], s57 offen offset:1024 lds
    v_mul_f32 v63, v63, v223
    v_cvt_pk_bf16_f32 v208, v56, v57
    v_cvt_pk_bf16_f32 v209, v58, v59
    v_cvt_pk_bf16_f32 v210, v60, v61
    v_cvt_pk_bf16_f32 v211, v62, v63
    buffer_load_dwordx4 v250, s[36:39], s57 offen offset:2048 lds
    v_mul_f32 v64, v48, v64
    v_exp_f32 v224, -v48
    v_mul_f32 v65, v49, v65
    v_exp_f32 v225, -v49
    v_mul_f32 v66, v50, v66
    v_exp_f32 v226, -v50
    buffer_load_dwordx4 v251, s[36:39], s57 offen offset:3072 lds
    v_mul_f32 v67, v51, v67
    v_exp_f32 v227, -v51
    v_mul_f32 v68, v52, v68
    v_exp_f32 v228, -v52
    v_mul_f32 v69, v53, v69
    v_exp_f32 v229, -v53
    s_mov_b32 m0, s53
    s_nop 0
    buffer_load_dwordx4 v246, s[28:31], s56 offen offset:0 sc1 lds
    v_mul_f32 v70, v54, v70
    v_exp_f32 v230, -v54
    v_mul_f32 v71, v55, v71
    v_exp_f32 v231, -v55
    buffer_load_dwordx4 v246, s[28:31], s56 offen offset:1024 sc1 lds
    v_fma_f32 v224, v224, s67, s67
    v_fma_f32 v225, v225, s67, s67
    v_rcp_f32 v224, v224
    v_fma_f32 v226, v226, s67, s67
    v_rcp_f32 v225, v225
    v_fma_f32 v227, v227, s67, s67
    buffer_load_dwordx4 v247, s[28:31], s56 offen offset:2048 sc1 lds
    v_rcp_f32 v226, v226
    v_fma_f32 v228, v228, s67, s67
    v_rcp_f32 v227, v227
    v_fma_f32 v229, v229, s67, s67
    v_rcp_f32 v228, v228
    v_fma_f32 v230, v230, s67, s67
    buffer_load_dwordx4 v247, s[28:31], s56 offen offset:3072 sc1 lds
    v_rcp_f32 v229, v229
    v_fma_f32 v231, v231, s67, s67
    v_rcp_f32 v230, v230
    v_rcp_f32 v231, v231
    s_add_u32 s53, s53, 49152
    s_cmp_ge_u32 s53, s61
    s_cselect_b32 s53, s60, s53
    buffer_store_dwordx4 v[208:211], v198, s[28:31], 0 offen offset:0 sc1
    s_waitcnt vmcnt(15)
    s_barrier
    s_and_b32 s57, s58, 15
    s_lshr_b64 s[58:59], s[58:59], 4
    s_add_u32 s57, s57, s55
    s_lshl_b32 s56, s57, 11
    s_mul_i32 s57, s57, 0x20000
    s_add_u32 m0, s53, 16384
    s_nop 0
    buffer_load_dwordx4 v248, s[32:35], s57 offen offset:0 lds
    v_mul_f32 v64, v64, v224
    v_mul_f32 v65, v65, v225
    v_mul_f32 v66, v66, v226
    v_mul_f32 v67, v67, v227
    v_mul_f32 v68, v68, v228
    v_mul_f32 v69, v69, v229
    buffer_load_dwordx4 v249, s[32:35], s57 offen offset:1024 lds
    v_mul_f32 v70, v70, v230
    v_mul_f32 v71, v71, v231
    v_cvt_pk_bf16_f32 v212, v64, v65
    v_cvt_pk_bf16_f32 v213, v66, v67
    v_cvt_pk_bf16_f32 v214, v68, v69
    v_cvt_pk_bf16_f32 v215, v70, v71
    buffer_load_dwordx4 v250, s[32:35], s57 offen offset:2048 lds
    v_mul_f32 v88, v72, v88
    v_exp_f32 v216, -v72
    buffer_load_dwordx4 v251, s[32:35], s57 offen offset:3072 lds
    v_mul_f32 v89, v73, v89
    v_exp_f32 v217, -v73
    v_mul_f32 v90, v74, v90
    v_exp_f32 v218, -v74
    v_mul_f32 v91, v75, v91
    v_exp_f32 v219, -v75
    s_add_u32 m0, s53, 32768
    s_nop 0
    buffer_load_dwordx4 v248, s[36:39], s57 offen offset:0 lds
    v_mul_f32 v92, v76, v92
    v_exp_f32 v220, -v76
    v_mul_f32 v93, v77, v93
    v_exp_f32 v221, -v77
    v_mul_f32 v94, v78, v94
    v_exp_f32 v222, -v78
    buffer_load_dwordx4 v249, s[36:39], s57 offen offset:1024 lds
    v_mul_f32 v95, v79, v95
    v_exp_f32 v223, -v79
    v_fma_f32 v216, v216, s67, s67
    v_fma_f32 v217, v217, s67, s67
    v_rcp_f32 v216, v216
    v_fma_f32 v218, v218, s67, s67
    buffer_load_dwordx4 v250, s[36:39], s57 offen offset:2048 lds
    v_rcp_f32 v217, v217
    v_fma_f32 v219, v219, s67, s67
    v_rcp_f32 v218, v218
    v_fma_f32 v220, v220, s67, s67
    buffer_load_dwordx4 v251, s[36:39], s57 offen offset:3072 lds
    v_rcp_f32 v219, v219
    v_fma_f32 v221, v221, s67, s67
    v_rcp_f32 v220, v220
    v_fma_f32 v222, v222, s67, s67
    v_rcp_f32 v221, v221
    v_fma_f32 v223, v223, s67, s67
    s_mov_b32 m0, s53
    s_nop 0
    buffer_load_dwordx4 v246, s[28:31], s56 offen offset:0 sc1 lds
    v_rcp_f32 v222, v222
    v_rcp_f32 v223, v223
    v_mul_f32 v88, v88, v216
    v_mul_f32 v89, v89, v217
    v_mul_f32 v90, v90, v218
    v_mul_f32 v91, v91, v219
    buffer_load_dwordx4 v246, s[28:31], s56 offen offset:1024 sc1 lds
    v_mul_f32 v92, v92, v220
    v_mul_f32 v93, v93, v221
    v_mul_f32 v94, v94, v222
    v_mul_f32 v95, v95, v223
    buffer_load_dwordx4 v247, s[28:31], s56 offen offset:2048 sc1 lds
    v_cvt_pk_bf16_f32 v200, v88, v89
    v_cvt_pk_bf16_f32 v201, v90, v91
    v_cvt_pk_bf16_f32 v202, v92, v93
    v_cvt_pk_bf16_f32 v203, v94, v95
    v_mul_f32 v96, v80, v96
    buffer_load_dwordx4 v247, s[28:31], s56 offen offset:3072 sc1 lds
    v_exp_f32 v224, -v80
    v_mul_f32 v97, v81, v97
    v_exp_f32 v225, -v81
    v_mul_f32 v98, v82, v98
    v_exp_f32 v226, -v82
    v_mul_f32 v99, v83, v99
    s_add_u32 s53, s53, 49152
    s_cmp_ge_u32 s53, s61
    s_cselect_b32 s53, s60, s53
    buffer_store_dwordx4 v[212:215], v198, s[28:31], 0 offen offset:1024 sc1
    v_add_u32 v198, 114688, v198
    buffer_store_dwordx4 v[200:203], v198, s[28:31], 0 offen offset:0 sc1
    s_waitcnt vmcnt(15)
    s_barrier
    s_and_b32 s57, s58, 15
    s_lshr_b64 s[58:59], s[58:59], 4
    s_add_u32 s57, s57, s55
    s_lshl_b32 s56, s57, 11
    s_mul_i32 s57, s57, 0x20000
    s_add_u32 m0, s53, 16384
    s_nop 0
    buffer_load_dwordx4 v248, s[32:35], s57 offen offset:0 lds
    v_exp_f32 v227, -v83
    v_mul_f32 v100, v84, v100
    v_exp_f32 v228, -v84
    v_mul_f32 v101, v85, v101
    buffer_load_dwordx4 v249, s[32:35], s57 offen offset:1024 lds
    v_exp_f32 v229, -v85
    v_mul_f32 v102, v86, v102
    v_exp_f32 v230, -v86
    v_mul_f32 v103, v87, v103
    v_exp_f32 v231, -v87
    v_fma_f32 v224, v224, s67, s67
    buffer_load_dwordx4 v250, s[32:35], s57 offen offset:2048 lds
    v_fma_f32 v225, v225, s67, s67
    v_rcp_f32 v224, v224
    v_fma_f32 v226, v226, s67, s67
    v_rcp_f32 v225, v225
    v_fma_f32 v227, v227, s67, s67
    v_rcp_f32 v226, v226
    buffer_load_dwordx4 v251, s[32:35], s57 offen offset:3072 lds
    v_fma_f32 v228, v228, s67, s67
    v_rcp_f32 v227, v227
    v_fma_f32 v229, v229, s67, s67
    v_rcp_f32 v228, v228
    v_fma_f32 v230, v230, s67, s67
    v_rcp_f32 v229, v229
    s_add_u32 m0, s53, 32768
    s_nop 0
    buffer_load_dwordx4 v248, s[36:39], s57 offen offset:0 lds
    v_fma_f32 v231, v231, s67, s67
    v_rcp_f32 v230, v230
    v_rcp_f32 v231, v231
    v_mul_f32 v96, v96, v224
    buffer_load_dwordx4 v249, s[36:39], s57 offen offset:1024 lds
    v_mul_f32 v97, v97, v225
    v_mul_f32 v98, v98, v226
    v_mul_f32 v99, v99, v227
    v_mul_f32 v100, v100, v228
    v_mul_f32 v101, v101, v229
    v_mul_f32 v102, v102, v230
    buffer_load_dwordx4 v250, s[36:39], s57 offen offset:2048 lds
    v_mul_f32 v103, v103, v231
    v_cvt_pk_bf16_f32 v204, v96, v97
    v_cvt_pk_bf16_f32 v205, v98, v99
    v_cvt_pk_bf16_f32 v206, v100, v101
    v_cvt_pk_bf16_f32 v207, v102, v103
    buffer_load_dwordx4 v251, s[36:39], s57 offen offset:3072 lds
    v_mul_f32 v120, v104, v120
    v_exp_f32 v216, -v104
    v_mul_f32 v121, v105, v121
    s_mov_b32 m0, s53
    s_nop 0
    buffer_load_dwordx4 v246, s[28:31], s56 offen offset:0 sc1 lds
    v_exp_f32 v217, -v105
    v_mul_f32 v122, v106, v122
    v_exp_f32 v218, -v106
    v_mul_f32 v123, v107, v123
    v_exp_f32 v219, -v107
    v_mul_f32 v124, v108, v124
    buffer_load_dwordx4 v246, s[28:31], s56 offen offset:1024 sc1 lds
    v_exp_f32 v220, -v108
    v_mul_f32 v125, v109, v125
    v_exp_f32 v221, -v109
    v_mul_f32 v126, v110, v126
    v_exp_f32 v222, -v110
    v_mul_f32 v127, v111, v127
    buffer_load_dwordx4 v247, s[28:31], s56 offen offset:2048 sc1 lds
    v_exp_f32 v223, -v111
    v_fma_f32 v216, v216, s67, s67
    v_fma_f32 v217, v217, s67, s67
    v_rcp_f32 v216, v216
    buffer_load_dwordx4 v247, s[28:31], s56 offen offset:3072 sc1 lds
    v_fma_f32 v218, v218, s67, s67
    v_rcp_f32 v217, v217
    v_fma_f32 v219, v219, s67, s67
    v_rcp_f32 v218, v218
    v_fma_f32 v220, v220, s67, s67
    v_rcp_f32 v219, v219
    s_add_u32 s53, s53, 49152
    s_cmp_ge_u32 s53, s61
    s_cselect_b32 s53, s60, s53
    buffer_store_dwordx4 v[204:207], v198, s[28:31], 0 offen offset:1024 sc1
    v_add_u32 v198, 114688, v198
    s_waitcnt vmcnt(15)
    s_barrier
    s_and_b32 s57, s58, 15
    s_lshr_b64 s[58:59], s[58:59], 4
    s_add_u32 s57, s57, s55
    s_lshl_b32 s56, s57, 11
    s_mul_i32 s57, s57, 0x20000
    s_add_u32 m0, s53, 16384
    s_nop 0
    buffer_load_dwordx4 v248, s[32:35], s57 offen offset:0 lds
    v_fma_f32 v221, v221, s67, s67
    v_rcp_f32 v220, v220
    v_fma_f32 v222, v222, s67, s67
    v_rcp_f32 v221, v221
    v_fma_f32 v223, v223, s67, s67
    v_rcp_f32 v222, v222
    buffer_load_dwordx4 v249, s[32:35], s57 offen offset:1024 lds
    v_rcp_f32 v223, v223
    v_mul_f32 v120, v120, v216
    v_mul_f32 v121, v121, v217
    v_mul_f32 v122, v122, v218
    v_mul_f32 v123, v123, v219
    v_mul_f32 v124, v124, v220
    buffer_load_dwordx4 v250, s[32:35], s57 offen offset:2048 lds
    v_mul_f32 v125, v125, v221
    v_mul_f32 v126, v126, v222
    v_mul_f32 v127, v127, v223
    v_cvt_pk_bf16_f32 v208, v120, v121
    buffer_load_dwordx4 v251, s[32:35], s57 offen offset:3072 lds
    v_cvt_pk_bf16_f32 v209, v122, v123
    v_cvt_pk_bf16_f32 v210, v124, v125
    v_cvt_pk_bf16_f32 v211, v126, v127
    v_mul_f32 v128, v112, v128
    v_exp_f32 v224, -v112
    s_add_u32 m0, s53, 32768
    s_nop 0
    buffer_load_dwordx4 v248, s[36:39], s57 offen offset:0 lds
    v_mul_f32 v129, v113, v129
    v_exp_f32 v225, -v113
    v_mul_f32 v130, v114, v130
    v_exp_f32 v226, -v114
    v_mul_f32 v131, v115, v131
    v_exp_f32 v227, -v115
    buffer_load_dwordx4 v249, s[36:39], s57 offen offset:1024 lds
    v_mul_f32 v132, v116, v132
    v_exp_f32 v228, -v116
    v_mul_f32 v133, v117, v133
    v_exp_f32 v229, -v117
    buffer_load_dwordx4 v250, s[36:39], s57 offen offset:2048 lds
    v_mul_f32 v134, v118, v134
    v_exp_f32 v230, -v118
    v_mul_f32 v135, v119, v135
    v_exp_f32 v231, -v119
    v_fma_f32 v224, v224, s67, s67
    v_fma_f32 v225, v225, s67, s67
    buffer_load_dwordx4 v251, s[36:39], s57 offen offset:3072 lds
    v_rcp_f32 v224, v224
    v_fma_f32 v226, v226, s67, s67
    v_rcp_f32 v225, v225
    v_fma_f32 v227, v227, s67, s67
    v_rcp_f32 v226, v226
    v_fma_f32 v228, v228, s67, s67
    s_mov_b32 m0, s53
    s_nop 0
    buffer_load_dwordx4 v246, s[28:31], s56 offen offset:0 sc1 lds
    v_rcp_f32 v227, v227
    v_fma_f32 v229, v229, s67, s67
    v_rcp_f32 v228, v228
    v_fma_f32 v230, v230, s67, s67
    buffer_load_dwordx4 v246, s[28:31], s56 offen offset:1024 sc1 lds
    v_rcp_f32 v229, v229
    v_fma_f32 v231, v231, s67, s67
    v_rcp_f32 v230, v230
    v_rcp_f32 v231, v231
    v_mul_f32 v128, v128, v224
    v_mul_f32 v129, v129, v225
    buffer_load_dwordx4 v247, s[28:31], s56 offen offset:2048 sc1 lds
    v_mul_f32 v130, v130, v226
    v_mul_f32 v131, v131, v227
    v_mul_f32 v132, v132, v228
    v_mul_f32 v133, v133, v229
    v_mul_f32 v134, v134, v230
    v_mul_f32 v135, v135, v231
    buffer_load_dwordx4 v247, s[28:31], s56 offen offset:3072 sc1 lds
    v_cvt_pk_bf16_f32 v212, v128, v129
    v_cvt_pk_bf16_f32 v213, v130, v131
    v_cvt_pk_bf16_f32 v214, v132, v133
    v_cvt_pk_bf16_f32 v215, v134, v135
    s_add_u32 s53, s53, 49152
    s_cmp_ge_u32 s53, s61
    s_cselect_b32 s53, s60, s53
    buffer_store_dwordx4 v[208:211], v198, s[28:31], 0 offen offset:0 sc1
    buffer_store_dwordx4 v[212:215], v198, s[28:31], 0 offen offset:1024 sc1
    s_waitcnt vmcnt(15)
    s_barrier
    s_mul_i32 s55, s49, 6
    s_add_u32 s55, s55, 32
    s_lshl_b32 s66, s51, 1
    s_and_b32 s57, s58, 15
    s_lshr_b64 s[58:59], s[58:59], 4
    s_add_u32 s57, s57, s66
    s_sub_u32 s56, s57, 6
    s_cselect_b32 s57, s57, s56
    s_add_u32 s57, s57, s55
    s_lshl_b32 s56, s57, 11
    s_mul_i32 s57, s57, 0x20000
    s_add_u32 m0, s53, 16384
    s_nop 0
    buffer_load_dwordx4 v248, s[32:35], s57 offen offset:0 lds
    buffer_load_dwordx4 v249, s[32:35], s57 offen offset:1024 lds
    buffer_load_dwordx4 v250, s[32:35], s57 offen offset:2048 lds
    buffer_load_dwordx4 v251, s[32:35], s57 offen offset:3072 lds
    s_add_u32 m0, s53, 32768
    s_nop 0
    buffer_load_dwordx4 v248, s[36:39], s57 offen offset:0 lds
    buffer_load_dwordx4 v249, s[36:39], s57 offen offset:1024 lds
    buffer_load_dwordx4 v250, s[36:39], s57 offen offset:2048 lds
    buffer_load_dwordx4 v251, s[36:39], s57 offen offset:3072 lds
    s_mov_b32 s62, s53
    s_mov_b32 s63, s56
    s_add_u32 s53, s53, 49152
    s_cmp_ge_u32 s53, s61
    s_cselect_b32 s53, s60, s53
    s_lshl_b32 s64, s47, 9
    s_lshl_b32 s65, s49, 7
    s_add_u32 s64, s64, s65
    s_lshl_b32 s65, s51, 4
    s_add_u32 s64, s64, s65
    s_lshl_b32 s65, s44, 2
    s_add_u32 s64, s64, s65
    s_add_u32 s64, s64, 0x52000
    v_mov_b32 v2, s0
    s_waitcnt vmcnt(8)
    s_mov_b64 exec, 1
    buffer_store_dword v2, v234, s[28:31], s64 offen sc1
    s_mov_b64 exec, -1
    s_barrier
    s_cmp_eq_u32 s69, 0
    s_cbranch_scc1 M_pi_ok
    s_lshl_b32 s68, s47, 2
    s_add_u32 s68, s68, s49
    s_lshl_b32 s68, s68, 7
    s_add_u32 s68, s68, 0x52000
    v_min_u32 v234, 44, v234
    v_mov_b32 v245, 0
    v_xor_b32 v245, -1, v2
    s_mov_b32 s3, 0x40000
M_pi_chk:
    v_cmp_ne_u32 vcc, s0, v245
    s_nop 4
    s_cbranch_vccz M_pi_ok
    s_sub_u32 s3, s3, 1
    s_cbranch_scc1 M_pi_ok
    s_sleep 12
    buffer_load_dword v245, v234, s[28:31], s68 offen sc1
    s_waitcnt vmcnt(0)
    s_branch M_pi_chk
M_pi_ok:
    s_mov_b32 m0, s62
    s_nop 0
    buffer_load_dwordx4 v246, s[28:31], s63 offen offset:0 sc1 lds
    buffer_load_dwordx4 v246, s[28:31], s63 offen offset:1024 sc1 lds
    buffer_load_dwordx4 v247, s[28:31], s63 offen offset:2048 sc1 lds
    buffer_load_dwordx4 v247, s[28:31], s63 offen offset:3072 sc1 lds
    s_and_b32 s57, s58, 15
    s_lshr_b64 s[58:59], s[58:59], 4
    s_add_u32 s57, s57, s66
    s_sub_u32 s56, s57, 6
    s_cselect_b32 s57, s57, s56
    s_add_u32 s57, s57, s55
    s_lshl_b32 s56, s57, 11
    s_mul_i32 s57, s57, 0x20000
    s_add_u32 m0, s53, 16384
    s_nop 0
    buffer_load_dwordx4 v248, s[32:35], s57 offen offset:0 lds
    buffer_load_dwordx4 v249, s[32:35], s57 offen offset:1024 lds
    buffer_load_dwordx4 v250, s[32:35], s57 offen offset:2048 lds
    buffer_load_dwordx4 v251, s[32:35], s57 offen offset:3072 lds
    s_add_u32 m0, s53, 32768
    s_nop 0
    buffer_load_dwordx4 v248, s[36:39], s57 offen offset:0 lds
    buffer_load_dwordx4 v249, s[36:39], s57 offen offset:1024 lds
    buffer_load_dwordx4 v250, s[36:39], s57 offen offset:2048 lds
    buffer_load_dwordx4 v251, s[36:39], s57 offen offset:3072 lds
    s_mov_b32 m0, s53
    s_nop 0
    buffer_load_dwordx4 v246, s[28:31], s56 offen offset:0 sc1 lds
    buffer_load_dwordx4 v246, s[28:31], s56 offen offset:1024 sc1 lds
    buffer_load_dwordx4 v247, s[28:31], s56 offen offset:2048 sc1 lds
    buffer_load_dwordx4 v247, s[28:31], s56 offen offset:3072 sc1 lds
    s_add_u32 s53, s53, 49152
    s_cmp_ge_u32 s53, s61
    s_cselect_b32 s53, s60, s53
    s_waitcnt vmcnt(12)
    s_barrier
    s_and_b32 s57, s58, 15
    s_lshr_b64 s[58:59], s[58:59], 4
    s_add_u32 s57, s57, s66
    s_sub_u32 s56, s57, 6
    s_cselect_b32 s57, s57, s56
    s_add_u32 s57, s57, s55
    s_lshl_b32 s56, s57, 11
    s_mul_i32 s57, s57, 0x20000
    s_add_u32 m0, s53, 16384
    s_nop 0
    buffer_load_dwordx4 v248, s[32:35], s57 offen offset:0 lds
    buffer_load_dwordx4 v249, s[32:35], s57 offen offset:1024 lds
    buffer_load_dwordx4 v250, s[32:35], s57 offen offset:2048 lds
    buffer_load_dwordx4 v251, s[32:35], s57 offen offset:3072 lds
    s_add_u32 m0, s53, 32768
    s_nop 0
    buffer_load_dwordx4 v248, s[36:39], s57 offen offset:0 lds
    buffer_load_dwordx4 v249, s[36:39], s57 offen offset:1024 lds
    buffer_load_dwordx4 v250, s[36:39], s57 offen offset:2048 lds
    buffer_load_dwordx4 v251, s[36:39], s57 offen offset:3072 lds
    s_mov_b32 s62, s53
    s_mov_b32 s63, s56
    s_add_u32 s53, s53, 49152
    s_cmp_ge_u32 s53, s61
    s_cselect_b32 s53, s60, s53
    s_lshl_b32 s68, s47, 2
    s_add_u32 s68, s68, s49
    s_lshl_b32 s68, s68, 7
    s_add_u32 s68, s68, 0x52000
    v_min_u32 v234, 44, v234
    buffer_load_dword v245, v234, s[28:31], s68 offen sc1
    s_waitcnt vmcnt(9)
    s_barrier
    s_waitcnt vmcnt(0)
    s_mov_b32 s3, 0x40000
M_pb_chk:
    v_cmp_ne_u32 vcc, s0, v245
    s_nop 4
    s_cbranch_vccz M_pb_ok
    s_sub_u32 s3, s3, 1
    s_cbranch_scc1 M_pb_ok
    s_sleep 2
    s_cmp_eq_u32 s69, 0
    s_cbranch_scc1 M_pb_rl
    s_sleep 48
M_pb_rl:
    buffer_load_dword v245, v234, s[28:31], s68 offen sc1
    s_waitcnt vmcnt(0)
    s_branch M_pb_chk
M_pb_ok:
    s_mov_b32 m0, s62
    s_nop 0
    buffer_load_dwordx4 v246, s[28:31], s63 offen offset:0 sc1 lds
    buffer_load_dwordx4 v246, s[28:31], s63 offen offset:1024 sc1 lds
    buffer_load_dwordx4 v247, s[28:31], s63 offen offset:2048 sc1 lds
    buffer_load_dwordx4 v247, s[28:31], s63 offen offset:3072 sc1 lds
    s_and_b32 s57, s58, 15
    s_lshr_b64 s[58:59], s[58:59], 4
    s_add_u32 s57, s57, s66
    s_sub_u32 s56, s57, 6
    s_cselect_b32 s57, s57, s56
    s_add_u32 s57, s57, s55
    s_lshl_b32 s56, s57, 11
    s_mul_i32 s57, s57, 0x20000
    s_add_u32 m0, s53, 16384
    s_nop 0
    buffer_load_dwordx4 v248, s[32:35], s57 offen offset:0 lds
    buffer_load_dwordx4 v249, s[32:35], s57 offen offset:1024 lds
    buffer_load_dwordx4 v250, s[32:35], s57 offen offset:2048 lds
    buffer_load_dwordx4 v251, s[32:35], s57 offen offset:3072 lds
    s_add_u32 m0, s53, 32768
    s_nop 0
    buffer_load_dwordx4 v248, s[36:39], s57 offen offset:0 lds
    buffer_load_dwordx4 v249, s[36:39], s57 offen offset:1024 lds
    buffer_load_dwordx4 v250, s[36:39], s57 offen offset:2048 lds
    buffer_load_dwordx4 v251, s[36:39], s57 offen offset:3072 lds
    s_mov_b32 m0, s53
    s_nop 0
    buffer_load_dwordx4 v246, s[28:31], s56 offen offset:0 sc1 lds
    buffer_load_dwordx4 v246, s[28:31], s56 offen offset:1024 sc1 lds
    buffer_load_dwordx4 v247, s[28:31], s56 offen offset:2048 sc1 lds
    buffer_load_dwordx4 v247, s[28:31], s56 offen offset:3072 sc1 lds
    s_add_u32 s53, s53, 49152
    s_cmp_ge_u32 s53, s61
    s_cselect_b32 s53, s60, s53
    s_movk_i32 s54, 1
M_Q_loop5:
    s_waitcnt vmcnt(12)
    s_barrier
    s_and_b32 s57, s58, 15
    s_lshr_b64 s[58:59], s[58:59], 4
    s_add_u32 s57, s57, s66
    s_sub_u32 s56, s57, 6
    s_cselect_b32 s57, s57, s56
    s_add_u32 s57, s57, s55
    s_lshl_b32 s56, s57, 11
    s_mul_i32 s57, s57, 0x20000
    s_add_u32 m0, s53, 16384
    s_nop 0
    buffer_load_dwordx4 v248, s[32:35], s57 offen offset:0 lds
    buffer_load_dwordx4 v249, s[32:35], s57 offen offset:1024 lds
    buffer_load_dwordx4 v250, s[32:35], s57 offen offset:2048 lds
    buffer_load_dwordx4 v251, s[32:35], s57 offen offset:3072 lds
    s_add_u32 m0, s53, 32768
    s_nop 0
    buffer_load_dwordx4 v248, s[36:39], s57 offen offset:0 lds
    buffer_load_dwordx4 v249, s[36:39], s57 offen offset:1024 lds
    buffer_load_dwordx4 v250, s[36:39], s57 offen offset:2048 lds
    buffer_load_dwordx4 v251, s[36:39], s57 offen offset:3072 lds
    s_mov_b32 m0, s53
    s_nop 0
    buffer_load_dwordx4 v246, s[28:31], s56 offen offset:0 sc1 lds
    buffer_load_dwordx4 v246, s[28:31], s56 offen offset:1024 sc1 lds
    buffer_load_dwordx4 v247, s[28:31], s56 offen offset:2048 sc1 lds
    buffer_load_dwordx4 v247, s[28:31], s56 offen offset:3072 sc1 lds
    s_add_u32 s53, s53, 49152
    s_cmp_ge_u32 s53, s61
    s_cselect_b32 s53, s60, s53
    s_sub_u32 s54, s54, 1
    s_cbranch_scc0 M_Q_loop5
    s_waitcnt vmcnt(12)
    s_barrier
    s_waitcnt vmcnt(0)
    s_barrier
    s_branch M_fin
M_Qidle:
    s_waitcnt vmcnt(0)
    s_barrier
    v_and_b32 v2, 255, v0
    s_and_b32 s64, s2, 63
    s_lshl_b32 s64, s64, 8
    v_add_lshl_u32 v243, v2, s64, 6
    s_mov_b32 s40, s16
    s_mov_b32 s41, s17
    s_mov_b32 s42, 0x100000
    s_mov_b32 s43, 0x20000
    s_mov_b32 s64, 0x0
    buffer_load_dword v244, v243, s[40:43], s64 offen
    s_waitcnt vmcnt(0)
    s_mov_b32 s40, s16
    s_mov_b32 s41, s17
    s_mov_b32 s42, 0x200000
    s_mov_b32 s43, 0x20000
    s_mov_b32 s64, 0x100000
    buffer_load_dword v244, v243, s[40:43], s64 offen
    s_waitcnt vmcnt(0)
    s_mov_b32 s40, s16
    s_mov_b32 s41, s17
    s_mov_b32 s42, 0x300000
    s_mov_b32 s43, 0x20000
    s_mov_b32 s64, 0x200000
    buffer_load_dword v244, v243, s[40:43], s64 offen
    s_waitcnt vmcnt(0)
    s_mov_b32 s40, s16
    s_mov_b32 s41, s17
    s_mov_b32 s42, 0x400000
    s_mov_b32 s43, 0x20000
    s_mov_b32 s64, 0x300000
    buffer_load_dword v244, v243, s[40:43], s64 offen
    s_waitcnt vmcnt(0)
    s_mov_b32 s40, s16
    s_mov_b32 s41, s17
    s_mov_b32 s42, 0x500000
    s_mov_b32 s43, 0x20000
    s_mov_b32 s64, 0x400000
    buffer_load_dword v244, v243, s[40:43], s64 offen
    s_waitcnt vmcnt(0)
    s_mov_b32 s40, s16
    s_mov_b32 s41, s17
    s_mov_b32 s42, 0x600000
    s_mov_b32 s43, 0x20000
    s_mov_b32 s64, 0x500000
    buffer_load_dword v244, v243, s[40:43], s64 offen
    s_waitcnt vmcnt(0)
    s_mov_b32 s40, s16
    s_mov_b32 s41, s17
    s_mov_b32 s42, 0x700000
    s_mov_b32 s43, 0x20000
    s_mov_b32 s64, 0x600000
    buffer_load_dword v244, v243, s[40:43], s64 offen
    s_waitcnt vmcnt(0)
    s_waitcnt vmcnt(0)
    s_barrier
    s_barrier
    s_barrier
    s_branch M_Qjoin
M_fin:
M_end:
    s_endpgm

.section .rodata,"a"
.p2align 6
.amdhsa_kernel adaLN_cond__sliding_local_dilated__glu_gated_swiglu__prompt_kernel
  .amdhsa_next_free_vgpr 252
  .amdhsa_next_free_sgpr 102
  .amdhsa_accum_offset 252
  .amdhsa_group_segment_fixed_size 0
  .amdhsa_kernarg_size 96
  .amdhsa_user_sgpr_count 2
  .amdhsa_user_sgpr_kernarg_segment_ptr 1
  .amdhsa_system_sgpr_workgroup_id_x 1
  .amdhsa_float_denorm_mode_32 3
.end_amdhsa_kernel
```

```asm
; @launch grid=(256,1,1) block=(512,1,1) lds=163840
.amdgcn_target "amdgcn-amd-amdhsa--gfx950"
.text
.globl adaLN_cond__sliding_local_dilated__glu_gated_swiglu__prompt_kernel
.p2align 8
.type adaLN_cond__sliding_local_dilated__glu_gated_swiglu__prompt_kernel,@function
adaLN_cond__sliding_local_dilated__glu_gated_swiglu__prompt_kernel:
    s_cmp_ge_u32 s2, 256
    s_cbranch_scc1 M_end
    s_load_dwordx16 s[4:19], s[0:1], 0
    s_load_dwordx8 s[20:27], s[0:1], 64
    v_lshrrev_b32 v2, 6, v0
    v_and_b32 v1, 63, v0
    v_readfirstlane_b32 s44, v2
    s_and_b32 s47, s2, 1
    s_lshl_b32 s47, s47, 3
    s_bfe_u32 s64, s2, 0x30003
    s_add_u32 s47, s47, s64
    s_and_b32 s48, s2, 6
    s_lshl_b32 s48, s48, 1
    s_lshr_b32 s64, s2, 6
    s_add_u32 s48, s48, s64
    s_getpc_b64 s[28:29]
M_pc:
    s_lshr_b32 s64, s2, 3
    s_lshl_b32 s64, s64, 3
    s_add_u32 s64, s64, s44
    s_lshl_b32 s64, s64, 8
    v_lshl_add_u32 v2, v1, 7, s64
    v_min_u32 v2, M_end-M_pc, v2
    s_mov_b64 exec, 3
    global_load_dword v244, v2, s[28:29]
    s_mov_b64 exec, -1
    s_cmp_lt_u32 s44, 4
    s_cbranch_scc1 M_P
    s_setprio 0
    s_sub_u32 s44, s44, 4
    s_lshl_b32 s62, s47, 4
    s_add_u32 s62, s62, s48
    s_lshl_b32 s62, s62, 2
    s_add_u32 s62, s62, s44
    s_lshl_b32 s64, s62, 12
    v_lshl_add_u32 v2, v1, 4, s64
    v_lshlrev_b32 v3, 2, v1
    v_add_u32 v3, 148480, v3
    v_mov_b32 v4, 0
    ds_write_b32 v3, v4
    s_waitcnt lgkmcnt(0)
    s_load_dword s0, s[26:27], 0
    s_mov_b32 s40, s4
    s_mov_b32 s41, s5
    s_mov_b32 s42, 0x400000
    s_mov_b32 s43, 0x20000
    buffer_load_dwordx4 v[104:107], v2, s[40:43], 0 offen offset:0
    buffer_load_dwordx4 v[108:111], v2, s[40:43], 0 offen offset:1024
    buffer_load_dwordx4 v[112:115], v2, s[40:43], 0 offen offset:2048
    buffer_load_dwordx4 v[116:119], v2, s[40:43], 0 offen offset:3072
    s_barrier
    s_branch M_Q
M_P:
    s_lshr_b32 s70, s47, 1
    s_lshl_b32 s70, s70, 7
    s_and_b32 s71, s47, 1
    s_lshl_b32 s71, s71, 4
    s_add_u32 s71, s71, s48
    s_lshl_b32 s71, s71, 7
    v_lshrrev_b32 v48, 3, v0
    v_add_u32 v48, s70, v48
    v_lshlrev_b32 v9, 1, v48
    s_movk_i32 s64, 12288
    v_mul_lo_u32 v48, s64, v48
    v_and_b32 v8, 7, v0
    v_lshl_add_u32 v48, v8, 4, v48
    v_add_u32 v8, s71, v48
    s_waitcnt lgkmcnt(0)
    s_load_dword s0, s[26:27], 0
    s_mov_b32 s40, s18
    s_mov_b32 s41, s19
    s_mov_b32 s42, 0x800
    s_mov_b32 s43, 0x20000
    s_mov_b32 s36, s20
    s_mov_b32 s37, s21
    s_mov_b32 s38, 0xc00000
    s_mov_b32 s39, 0x20000
    s_barrier
    buffer_load_ushort v20, v9, s[40:43], 0 offen offset:0
    buffer_load_ushort v21, v9, s[40:43], 0 offen offset:64
    buffer_load_ushort v22, v9, s[40:43], 0 offen offset:128
    buffer_load_ushort v23, v9, s[40:43], 0 offen offset:192
    s_mov_b32 s64, 0x0
    buffer_load_dwordx4 v[24:27], v8, s[36:39], s64 offen
    s_mov_b32 s64, 0x60000
    buffer_load_dwordx4 v[28:31], v8, s[36:39], s64 offen
    s_mov_b32 s64, 0xc0000
    buffer_load_dwordx4 v[32:35], v8, s[36:39], s64 offen
    s_mov_b32 s64, 0x120000
    buffer_load_dwordx4 v[36:39], v8, s[36:39], s64 offen
    s_mov_b32 s28, s26
    s_mov_b32 s29, s27
    s_mov_b32 s30, 0x3100000
    s_mov_b32 s31, 0x20000
    s_lshl_b32 s64, s48, 13
    s_add_u32 s64, s64, 0x30000
    s_lshl_b32 s65, s47, 9
    s_add_u32 s62, s64, s65
    s_lshl_b32 s65, s44, 9
    s_add_u32 s64, s64, s65
    v_lshl_add_u32 v16, v1, 3, s64
    s_lshl_b32 s64, s44, 7
    s_add_u32 s64, s64, s62
    v_lshl_add_u32 v2, v1, 2, s64
    s_lshl_b32 s64, s47, 4
    s_add_u32 s64, s64, s48
    s_lshl_b32 s64, s64, 7
    s_add_u32 s64, s64, 0x10000
    v_writelane_b32 v2, s64, 4
    s_mov_b64 exec, 31
    buffer_load_dword v244, v2, s[28:31], 0 offen sc1
    s_mov_b64 exec, -1
    s_lshr_b32 s45, s44, 1
    s_and_b32 s46, s44, 1
    s_lshr_b32 s49, s48, 2
    s_and_b32 s51, s48, 3
    s_cmp_ge_u32 s2, 192
    s_cselect_b32 s69, 0x80000000, 0
    s_mov_b32 s67, 0x40053526
    v_lshlrev_b32 v234, 2, v1
    s_setprio 2
    s_waitcnt vmcnt(5)
    v_lshlrev_b32 v20, 16, v20
    v_lshlrev_b32 v21, 16, v21
    v_lshlrev_b32 v22, 16, v22
    v_lshlrev_b32 v23, 16, v23
    v_mul_f32 v48, 0xbfb8aa3b, v20
    v_mul_f32 v49, 0xbfb8aa3b, v21
    v_mul_f32 v50, 0xbfb8aa3b, v22
    v_mul_f32 v51, 0xbfb8aa3b, v23
    v_exp_f32 v48, v48
    v_exp_f32 v49, v49
    v_exp_f32 v50, v50
    v_exp_f32 v51, v51
    v_add_f32 v48, 1.0, v48
    v_add_f32 v49, 1.0, v49
    v_add_f32 v50, 1.0, v50
    v_add_f32 v51, 1.0, v51
    v_rcp_f32 v48, v48
    v_rcp_f32 v49, v49
    v_rcp_f32 v50, v50
    v_rcp_f32 v51, v51
    v_mul_f32 v20, v20, v48
    v_mul_f32 v21, v21, v49
    v_mul_f32 v22, v22, v50
    v_mul_f32 v23, v23, v51
    v_cvt_pk_bf16_f32 v48, v20, v20
    v_lshlrev_b32 v20, 16, v48
    v_cvt_pk_bf16_f32 v49, v21, v21
    v_lshlrev_b32 v21, 16, v49
    v_cvt_pk_bf16_f32 v50, v22, v22
    v_lshlrev_b32 v22, 16, v50
    v_cvt_pk_bf16_f32 v51, v23, v23
    v_lshlrev_b32 v23, 16, v51
    s_waitcnt vmcnt(4)
    v_lshlrev_b32 v48, 16, v24
    v_and_b32 v49, 0xffff0000, v24
    v_lshlrev_b32 v50, 16, v25
    v_and_b32 v51, 0xffff0000, v25
    v_lshlrev_b32 v52, 16, v26
    v_and_b32 v53, 0xffff0000, v26
    v_lshlrev_b32 v54, 16, v27
    v_and_b32 v55, 0xffff0000, v27
    v_mul_f32 v40, v20, v48
    v_mul_f32 v41, v20, v49
    v_mul_f32 v42, v20, v50
    v_mul_f32 v43, v20, v51
    v_mul_f32 v44, v20, v52
    v_mul_f32 v45, v20, v53
    v_mul_f32 v46, v20, v54
    v_mul_f32 v47, v20, v55
    s_waitcnt vmcnt(3)
    v_lshlrev_b32 v48, 16, v28
    v_and_b32 v49, 0xffff0000, v28
    v_lshlrev_b32 v50, 16, v29
    v_and_b32 v51, 0xffff0000, v29
    v_lshlrev_b32 v52, 16, v30
    v_and_b32 v53, 0xffff0000, v30
    v_lshlrev_b32 v54, 16, v31
    v_and_b32 v55, 0xffff0000, v31
    v_fmac_f32 v40, v21, v48
    v_fmac_f32 v41, v21, v49
    v_fmac_f32 v42, v21, v50
    v_fmac_f32 v43, v21, v51
    v_fmac_f32 v44, v21, v52
    v_fmac_f32 v45, v21, v53
    v_fmac_f32 v46, v21, v54
    v_fmac_f32 v47, v21, v55
    s_waitcnt vmcnt(2)
    v_lshlrev_b32 v48, 16, v32
    v_and_b32 v49, 0xffff0000, v32
    v_lshlrev_b32 v50, 16, v33
    v_and_b32 v51, 0xffff0000, v33
    v_lshlrev_b32 v52, 16, v34
    v_and_b32 v53, 0xffff0000, v34
    v_lshlrev_b32 v54, 16, v35
    v_and_b32 v55, 0xffff0000, v35
    v_fmac_f32 v40, v22, v48
    v_fmac_f32 v41, v22, v49
    v_fmac_f32 v42, v22, v50
    v_fmac_f32 v43, v22, v51
    v_fmac_f32 v44, v22, v52
    v_fmac_f32 v45, v22, v53
    v_fmac_f32 v46, v22, v54
    v_fmac_f32 v47, v22, v55
    s_waitcnt vmcnt(1)
    v_lshlrev_b32 v48, 16, v36
    v_and_b32 v49, 0xffff0000, v36
    v_lshlrev_b32 v50, 16, v37
    v_and_b32 v51, 0xffff0000, v37
    v_lshlrev_b32 v52, 16, v38
    v_and_b32 v53, 0xffff0000, v38
    v_lshlrev_b32 v54, 16, v39
    v_and_b32 v55, 0xffff0000, v39
    v_fmac_f32 v40, v23, v48
    v_fmac_f32 v41, v23, v49
    v_fmac_f32 v42, v23, v50
    v_fmac_f32 v43, v23, v51
    v_fmac_f32 v44, v23, v52
    v_fmac_f32 v45, v23, v53
    v_fmac_f32 v46, v23, v54
    v_fmac_f32 v47, v23, v55
    v_add_f32_dpp v40, v40, v40 row_ror:8 row_mask:0xf bank_mask:0xf
    v_add_f32_dpp v41, v41, v41 row_ror:8 row_mask:0xf bank_mask:0xf
    v_add_f32_dpp v42, v42, v42 row_ror:8 row_mask:0xf bank_mask:0xf
    v_add_f32_dpp v43, v43, v43 row_ror:8 row_mask:0xf bank_mask:0xf
    v_add_f32_dpp v44, v44, v44 row_ror:8 row_mask:0xf bank_mask:0xf
    v_add_f32_dpp v45, v45, v45 row_ror:8 row_mask:0xf bank_mask:0xf
    v_add_f32_dpp v46, v46, v46 row_ror:8 row_mask:0xf bank_mask:0xf
    v_add_f32_dpp v47, v47, v47 row_ror:8 row_mask:0xf bank_mask:0xf
    v_mov_b32 v48, v40
    v_mov_b32 v49, v41
    v_mov_b32 v50, v42
    v_mov_b32 v51, v43
    v_mov_b32 v52, v44
    v_mov_b32 v53, v45
    v_mov_b32 v54, v46
    v_mov_b32 v55, v47
    v_permlane32_swap_b32 v40, v48
    v_permlane32_swap_b32 v41, v49
    v_permlane32_swap_b32 v42, v50
    v_permlane32_swap_b32 v43, v51
    v_permlane32_swap_b32 v44, v52
    v_permlane32_swap_b32 v45, v53
    v_permlane32_swap_b32 v46, v54
    v_permlane32_swap_b32 v47, v55
    v_add_f32 v40, v40, v48
    v_add_f32 v41, v41, v49
    v_add_f32 v42, v42, v50
    v_add_f32 v43, v43, v51
    v_add_f32 v44, v44, v52
    v_add_f32 v45, v45, v53
    v_add_f32 v46, v46, v54
    v_add_f32 v47, v47, v55
    v_mov_b32 v48, v40
    v_mov_b32 v49, v41
    v_mov_b32 v50, v42
    v_mov_b32 v51, v43
    v_mov_b32 v52, v44
    v_mov_b32 v53, v45
    v_mov_b32 v54, v46
    v_mov_b32 v55, v47
    v_permlane16_swap_b32 v40, v48
    v_permlane16_swap_b32 v41, v49
    v_permlane16_swap_b32 v42, v50
    v_permlane16_swap_b32 v43, v51
    v_permlane16_swap_b32 v44, v52
    v_permlane16_swap_b32 v45, v53
    v_permlane16_swap_b32 v46, v54
    v_permlane16_swap_b32 v47, v55
    v_add_f32 v40, v40, v48
    v_add_f32 v41, v41, v49
    v_add_f32 v42, v42, v50
    v_add_f32 v43, v43, v51
    v_add_f32 v44, v44, v52
    v_add_f32 v45, v45, v53
    v_add_f32 v46, v46, v54
    v_add_f32 v47, v47, v55
    s_lshl_b32 s64, s44, 8
    s_add_u32 s64, s64, 147456
    v_and_b32 v48, 7, v0
    v_lshl_add_u32 v48, v48, 5, s64
    ds_write_b128 v48, v[40:43]
    ds_write_b128 v48, v[44:47] offset:16
    v_mov_b32 v49, 148492
    v_mov_b32 v50, 1
    s_waitcnt lgkmcnt(0)
    s_add_u32 s0, s0, 1
    s_mov_b64 exec, 1
    ds_add_rtn_u32 v51, v49, v50
    s_mov_b64 exec, -1
    v_add_u32 v49, 147456, v234
    s_waitcnt lgkmcnt(0)
    ds_read_b32 v40, v49 offset:0
    ds_read_b32 v41, v49 offset:256
    ds_read_b32 v42, v49 offset:512
    ds_read_b32 v43, v49 offset:768
    v_readfirstlane_b32 s64, v51
    s_nop 3
    s_cmp_eq_u32 s64, 3
    s_cselect_b32 s62, s62, 0x80000000
    v_lshl_add_u32 v48, v1, 3, s62
    s_waitcnt lgkmcnt(0)
    v_add_f32 v40, v40, v41
    v_add_f32 v42, v42, v43
    v_add_f32 v40, v40, v42
    v_mov_b32 v41, s0
    buffer_store_dwordx2 v[40:41], v48, s[28:31], 0 offen sc1
    s_mov_b32 s52, 0
    s_lshl_b32 s64, s45, 13
    v_lshl_add_u32 v233, v1, 4, s64
    v_lshrrev_b32 v3, 4, v1
    v_bfe_u32 v2, v1, 2, 2
    v_lshl_add_u32 v4, v3, 3, v2
    v_mul_u32_u24 v4, 384, v4
    v_and_b32 v5, 3, v1
    v_lshl_add_u32 v4, v5, 3, v4
    v_add_u32 v4, 18432, v4
    v_bfe_u32 v2, v1, 3, 2
    s_lshl_b32 s64, s46, 1
    v_xor_b32 v2, s64, v2
    v_lshl_add_u32 v239, v2, 5, v4
    v_xor_b32 v2, 1, v2
    v_lshl_add_u32 v240, v2, 5, v4
    v_and_b32 v2, 15, v1
    v_lshlrev_b32 v3, 2, v3
    v_sub_u32 v3, v2, v3
    s_mov_b32 s64, 0x80000001
    v_sub_u32 v4, -2, v3
    v_and_b32 v4, s64, v4
    v_cmp_eq_u32 s[72:73], 0, v4
    v_subrev_u32 v4, 0, v3
    v_and_b32 v4, s64, v4
    v_cmp_eq_u32 s[80:81], 0, v4
    v_sub_u32 v4, -1, v3
    v_and_b32 v4, s64, v4
    v_cmp_eq_u32 s[74:75], 0, v4
    v_subrev_u32 v4, 1, v3
    v_and_b32 v4, s64, v4
    v_cmp_eq_u32 s[82:83], 0, v4
    v_sub_u32 v4, 0, v3
    v_and_b32 v4, s64, v4
    v_cmp_eq_u32 s[76:77], 0, v4
    v_subrev_u32 v4, 2, v3
    v_and_b32 v4, s64, v4
    v_cmp_eq_u32 s[84:85], 0, v4
    v_sub_u32 v4, 1, v3
    v_and_b32 v4, s64, v4
    v_cmp_eq_u32 s[78:79], 0, v4
    v_subrev_u32 v4, 3, v3
    v_and_b32 v4, s64, v4
    v_cmp_eq_u32 s[86:87], 0, v4
    s_lshl_b32 s64, s47, 1
    s_add_u32 s64, s64, s45
    s_cmp_eq_u32 s64, 0
    s_cselect_b64 s[88:89], 0, s[72:73]
    s_cselect_b64 s[90:91], 0, s[74:75]
    s_cselect_b64 s[92:93], 0, s[76:77]
    s_cselect_b64 s[94:95], 0, s[78:79]
    s_mul_i32 s64, s64, 131072
    s_lshl_b32 s65, s48, 11
    s_add_u32 s64, s64, s65
    s_lshl_b32 s65, s46, 10
    s_add_u32 s64, s64, s65
    s_add_u32 s64, s64, 0x600000
    v_lshl_add_u32 v237, v1, 4, s64
    s_lshl_b32 s64, s2, 8
    v_add_lshl_u32 v243, v0, s64, 5
    s_lshl_b32 s64, s47, 3
    s_lshl_b32 s65, s44, 1
    s_add_u32 s64, s64, s65
    s_mul_i32 s64, s64, 32768
    s_add_u32 s64, s64, 0x600000
    v_lshl_add_u32 v208, v1, 4, s64
    v_add_u32 v209, 30720, v208
    v_lshrrev_b32 v3, 3, v1
    s_lshl_b32 s64, s44, 4
    v_add_lshl_u32 v2, v3, s64, 11
    s_lshl_b32 s64, s48, 7
    v_add_u32 v2, s64, v2
    v_and_b32 v3, 6, v3
    v_and_b32 v4, 7, v1
    v_xor_b32 v3, v3, v4
    v_lshl_add_u32 v210, v3, 4, v2
    v_add_u32 v211, 15360, v210
    s_lshl_b32 s65, s48, 8
    v_lshrrev_b32 v3, 4, v1
    s_lshl_b32 s64, s44, 4
    v_add_u32 v2, s64, v3
    s_movk_i32 s64, 7168
    v_mul_u32_u24 v2, s64, v2
    v_add_u32 v2, s65, v2
    v_lshlrev_b32 v3, 1, v3
    v_and_b32 v4, 15, v1
    v_xor_b32 v3, v3, v4
    v_lshl_add_u32 v212, v3, 4, v2
    v_add_u32 v214, 55296, v212
    v_xor_b32 v3, 8, v3
    v_lshl_add_u32 v213, v3, 4, v2
    v_add_u32 v213, 27648, v213
    v_add_u32 v215, 55296, v213
    v_add_u32 v232, s52, v233
    v_add_u32 v235, s52, v239
    v_add_u32 v236, s52, v240
    s_lshl_b32 s60, s44, 12
    s_add_u32 s61, s60, 147456
    s_add_u32 s53, s60, 49152
    s_lshl_b32 s70, s44, 11
    s_sub_u32 s70, 16384, s70
    s_bfe_u32 s66, s2, 0x30003
    s_lshr_b32 s55, s2, 6
    s_add_u32 s66, s66, s55
    s_and_b32 s66, s66, 3
    s_mov_b32 s58, 0x76453210
    s_mov_b32 s59, 0xfecdba89
    s_cmp_eq_u32 s66, 1
    s_cselect_b32 s58, 0x75643120, s58
    s_cselect_b32 s59, 0xfdecb9a8, s59
    s_cmp_eq_u32 s66, 2
    s_cselect_b32 s58, 0x67542310, s58
    s_cselect_b32 s59, 0xefdcab98, s59
    s_cmp_eq_u32 s66, 3
    s_cselect_b32 s58, 0x86534210, s58
    s_cselect_b32 s59, 0xfedbca97, s59
    s_mov_b32 s32, s8
    s_mov_b32 s33, s9
    s_mov_b32 s34, 0x200000
    s_mov_b32 s35, 0x20000
    s_cmp_ge_u32 s44, 2
    s_cbranch_scc1 M_spf
    s_movk_i32 s63, 4096
    buffer_load_dwordx2 v[88:89], v16, s[28:31], 0 offen offset:0 sc1
    buffer_load_dwordx2 v[90:91], v16, s[28:31], 0 offen offset:1024 sc1
    buffer_load_dwordx2 v[92:93], v16, s[28:31], 0 offen offset:2048 sc1
    buffer_load_dwordx2 v[94:95], v16, s[28:31], 0 offen offset:3072 sc1
    buffer_load_dwordx2 v[96:97], v16, s[28:31], s63 offen offset:0 sc1
    buffer_load_dwordx2 v[98:99], v16, s[28:31], s63 offen offset:1024 sc1
    buffer_load_dwordx2 v[100:101], v16, s[28:31], s63 offen offset:2048 sc1
    buffer_load_dwordx2 v[102:103], v16, s[28:31], s63 offen offset:3072 sc1
    s_waitcnt vmcnt(0)
    s_mov_b32 s3, 0x40000
M_pt_chk:
    v_xor_b32 v48, s0, v89
    v_xor_b32 v49, s0, v91
    v_xor_b32 v50, s0, v93
    v_xor_b32 v51, s0, v95
    v_xor_b32 v52, s0, v97
    v_xor_b32 v53, s0, v99
    v_xor_b32 v54, s0, v101
    v_xor_b32 v55, s0, v103
    v_or3_b32 v48, v48, v49, v50
    v_or3_b32 v48, v48, v51, v52
    v_or3_b32 v48, v48, v53, v54
    v_or_b32 v48, v48, v55
    v_cmp_ne_u32 vcc, 0, v48
    s_nop 4
    s_cbranch_vccz M_pt_ok
    s_sub_u32 s3, s3, 1
    s_cbranch_scc1 M_pt_ok
    v_cmp_ne_u32 vcc, s0, v89
    s_nop 4
    s_mov_b64 exec, vcc
    buffer_load_dwordx2 v[88:89], v16, s[28:31], 0 offen offset:0 sc1
    s_mov_b64 exec, -1
    v_cmp_ne_u32 vcc, s0, v91
    s_nop 4
    s_mov_b64 exec, vcc
    buffer_load_dwordx2 v[90:91], v16, s[28:31], 0 offen offset:1024 sc1
    s_mov_b64 exec, -1
    v_cmp_ne_u32 vcc, s0, v93
    s_nop 4
    s_mov_b64 exec, vcc
    buffer_load_dwordx2 v[92:93], v16, s[28:31], 0 offen offset:2048 sc1
    s_mov_b64 exec, -1
    v_cmp_ne_u32 vcc, s0, v95
    s_nop 4
    s_mov_b64 exec, vcc
    buffer_load_dwordx2 v[94:95], v16, s[28:31], 0 offen offset:3072 sc1
    s_mov_b64 exec, -1
    v_cmp_ne_u32 vcc, s0, v97
    s_nop 4
    s_mov_b64 exec, vcc
    buffer_load_dwordx2 v[96:97], v16, s[28:31], s63 offen offset:0 sc1
    s_mov_b64 exec, -1
    v_cmp_ne_u32 vcc, s0, v99
    s_nop 4
    s_mov_b64 exec, vcc
    buffer_load_dwordx2 v[98:99], v16, s[28:31], s63 offen offset:1024 sc1
    s_mov_b64 exec, -1
    v_cmp_ne_u32 vcc, s0, v101
    s_nop 4
    s_mov_b64 exec, vcc
    buffer_load_dwordx2 v[100:101], v16, s[28:31], s63 offen offset:2048 sc1
    s_mov_b64 exec, -1
    v_cmp_ne_u32 vcc, s0, v103
    s_nop 4
    s_mov_b64 exec, vcc
    buffer_load_dwordx2 v[102:103], v16, s[28:31], s63 offen offset:3072 sc1
    s_mov_b64 exec, -1
    s_waitcnt vmcnt(0)
    s_branch M_pt_chk
M_pt_ok:
    v_add_f32 v88, v88, v90
    v_add_f32 v92, v92, v94
    v_add_f32 v96, v96, v98
    v_add_f32 v100, v100, v102
    v_add_f32 v88, v88, v92
    v_add_f32 v96, v96, v100
    v_add_f32 v88, v88, v96
    v_cvt_pk_bf16_f32 v89, v88, v88
    v_lshlrev_b32 v88, 16, v89
    s_cmp_eq_u32 s44, 1
    s_cselect_b32 s64, 1.0, 0
    v_add_f32 v88, s64, v88
    v_cvt_pk_bf16_f32 v89, v88, v88
    v_lshlrev_b32 v88, 16, v89
    s_lshl_b32 s64, s44, 8
    s_add_u32 s64, s64, 149504
    v_add_u32 v2, s64, v234
    ds_write_b32 v2, v88
    s_waitcnt lgkmcnt(0)
    s_branch M_tbl
M_spf:
    s_lshl_b32 s64, s47, 2
    s_add_u32 s64, s64, s49
    s_lshl_b32 s64, s64, 7
    s_load_dword s99, s[26:27], s64 offset:0x58000
    s_load_dword s99, s[26:27], s64 offset:0x54000
    s_load_dword s99, s[26:27], s64 offset:0x56000
    s_load_dword s99, s[26:27], s64 offset:0x50000
    s_load_dword s99, s[26:27], s64 offset:0x52000
    s_lshl_b32 s64, s2, 1
    s_add_u32 s64, s64, s46
M_tbl:
    s_barrier
    s_or_b32 s64, s2, s44
    s_cmp_eq_u32 s64, 0
    s_cselect_b32 s64, 0, 0x80000000
    v_mov_b32 v2, s64
    v_mov_b32 v3, s0
    s_barrier
    ds_read_b128 v[120:123], v232 offset:0
    ds_read_b64_tr_b16 v[148:149], v235 offset:128
    ds_read_b64_tr_b16 v[150:151], v235 offset:1664
    ds_read_b64_tr_b16 v[152:153], v236 offset:128
    ds_read_b64_tr_b16 v[154:155], v236 offset:1664
    ds_read_b64_tr_b16 v[156:157], v235 offset:256
    ds_read_b64_tr_b16 v[158:159], v235 offset:1792
    ds_read_b64_tr_b16 v[160:161], v236 offset:256
    ds_read_b64_tr_b16 v[162:163], v236 offset:1792
    ds_read_b128 v[124:127], v232 offset:2048
    ds_read_b64_tr_b16 v[140:141], v235 offset:0
    ds_read_b64_tr_b16 v[142:143], v235 offset:1536
    ds_read_b64_tr_b16 v[144:145], v236 offset:0
    ds_read_b64_tr_b16 v[146:147], v236 offset:1536
    ds_read_b128 v[128:131], v232 offset:4096
    ds_read_b128 v[132:135], v232 offset:6144
    ds_read_b128 v[136:139], v232 offset:8192
    s_add_u32 s52, s52, 49152
    s_cmp_ge_u32 s52, 147456
    s_cselect_b32 s52, 0, s52
    s_waitcnt lgkmcnt(0)
    v_mfma_f32_16x16x32_bf16 v[40:43], v[148:151], v[120:123], 0
    ds_read_b128 v[164:167], v232 offset:1024
    v_mfma_f32_16x16x32_bf16 v[44:47], v[152:155], v[120:123], 0
    ds_read_b64_tr_b16 v[192:193], v235 offset:12416
    v_mfma_f32_16x16x32_bf16 v[80:83], v[120:123], v[156:159], 0
    ds_read_b64_tr_b16 v[194:195], v235 offset:13952
    v_mfma_f32_16x16x32_bf16 v[84:87], v[120:123], v[160:163], 0
    ds_read_b64_tr_b16 v[196:197], v236 offset:12416
    v_mfma_f32_16x16x32_bf16 v[48:51], v[148:151], v[124:127], 0
    ds_read_b64_tr_b16 v[198:199], v236 offset:13952
    v_mfma_f32_16x16x32_bf16 v[52:55], v[152:155], v[124:127], 0
    v_mfma_f32_16x16x32_bf16 v[88:91], v[124:127], v[156:159], 0
    ds_read_b64_tr_b16 v[200:201], v235 offset:12544
    v_mfma_f32_16x16x32_bf16 v[92:95], v[124:127], v[160:163], 0
    ds_read_b64_tr_b16 v[202:203], v235 offset:14080
    v_mfma_f32_16x16x32_bf16 v[8:11], v[140:143], v[124:127], 0
    ds_read_b64_tr_b16 v[204:205], v236 offset:12544
    v_mfma_f32_16x16x32_bf16 v[12:15], v[144:147], v[124:127], 0
    ds_read_b64_tr_b16 v[206:207], v236 offset:14080
    v_mfma_f32_16x16x32_bf16 v[56:59], v[148:151], v[128:131], 0
    v_mfma_f32_16x16x32_bf16 v[60:63], v[152:155], v[128:131], 0
    ds_read_b128 v[168:171], v232 offset:3072
    v_mfma_f32_16x16x32_bf16 v[96:99], v[128:131], v[156:159], 0
    ds_read_b64_tr_b16 v[184:185], v235 offset:12288
    v_mfma_f32_16x16x32_bf16 v[100:103], v[128:131], v[160:163], 0
    ds_read_b64_tr_b16 v[186:187], v235 offset:13824
    v_mfma_f32_16x16x32_bf16 v[16:19], v[140:143], v[128:131], 0
    ds_read_b64_tr_b16 v[188:189], v236 offset:12288
    v_mfma_f32_16x16x32_bf16 v[20:23], v[144:147], v[128:131], 0
    v_mfma_f32_16x16x32_bf16 v[64:67], v[148:151], v[132:135], 0
    ds_read_b64_tr_b16 v[190:191], v236 offset:13824
    v_mfma_f32_16x16x32_bf16 v[68:71], v[152:155], v[132:135], 0
    ds_read_b128 v[172:175], v232 offset:5120
    v_mfma_f32_16x16x32_bf16 v[104:107], v[132:135], v[156:159], 0
    ds_read_b128 v[176:179], v232 offset:7168
    v_mfma_f32_16x16x32_bf16 v[108:111], v[132:135], v[160:163], 0
    ds_read_b128 v[180:183], v232 offset:9216
    v_mfma_f32_16x16x32_bf16 v[24:27], v[140:143], v[132:135], 0
    v_mfma_f32_16x16x32_bf16 v[28:31], v[144:147], v[132:135], 0
    v_add_u32 v232, s52, v233
    v_mfma_f32_16x16x32_bf16 v[72:75], v[148:151], v[136:139], 0
    v_mfma_f32_16x16x32_bf16 v[76:79], v[152:155], v[136:139], 0
    v_add_u32 v235, s52, v239
    v_mfma_f32_16x16x32_bf16 v[112:115], v[136:139], v[156:159], 0
    v_mfma_f32_16x16x32_bf16 v[116:119], v[136:139], v[160:163], 0
    v_add_u32 v236, s52, v240
    v_mfma_f32_16x16x32_bf16 v[32:35], v[140:143], v[136:139], 0
    v_mfma_f32_16x16x32_bf16 v[36:39], v[144:147], v[136:139], 0
    s_waitcnt lgkmcnt(0)
    v_mfma_f32_16x16x32_bf16 v[40:43], v[192:195], v[164:167], v[40:43]
    v_mfma_f32_16x16x32_bf16 v[44:47], v[196:199], v[164:167], v[44:47]
    v_mfma_f32_16x16x32_bf16 v[80:83], v[164:167], v[200:203], v[80:83]
    v_mfma_f32_16x16x32_bf16 v[84:87], v[164:167], v[204:207], v[84:87]
    v_mfma_f32_16x16x32_bf16 v[48:51], v[192:195], v[168:171], v[48:51]
    v_mfma_f32_16x16x32_bf16 v[52:55], v[196:199], v[168:171], v[52:55]
    v_mfma_f32_16x16x32_bf16 v[88:91], v[168:171], v[200:203], v[88:91]
    v_mfma_f32_16x16x32_bf16 v[92:95], v[168:171], v[204:207], v[92:95]
    v_mfma_f32_16x16x32_bf16 v[8:11], v[184:187], v[168:171], v[8:11]
    v_mfma_f32_16x16x32_bf16 v[12:15], v[188:191], v[168:171], v[12:15]
    v_mfma_f32_16x16x32_bf16 v[56:59], v[192:195], v[172:175], v[56:59]
    v_mfma_f32_16x16x32_bf16 v[60:63], v[196:199], v[172:175], v[60:63]
    v_mfma_f32_16x16x32_bf16 v[96:99], v[172:175], v[200:203], v[96:99]
    v_mfma_f32_16x16x32_bf16 v[100:103], v[172:175], v[204:207], v[100:103]
    v_mfma_f32_16x16x32_bf16 v[16:19], v[184:187], v[172:175], v[16:19]
    v_mfma_f32_16x16x32_bf16 v[20:23], v[188:191], v[172:175], v[20:23]
    v_mfma_f32_16x16x32_bf16 v[64:67], v[192:195], v[176:179], v[64:67]
    v_mfma_f32_16x16x32_bf16 v[68:71], v[196:199], v[176:179], v[68:71]
    v_mfma_f32_16x16x32_bf16 v[104:107], v[176:179], v[200:203], v[104:107]
    v_mfma_f32_16x16x32_bf16 v[108:111], v[176:179], v[204:207], v[108:111]
    v_mfma_f32_16x16x32_bf16 v[24:27], v[184:187], v[176:179], v[24:27]
    v_mfma_f32_16x16x32_bf16 v[28:31], v[188:191], v[176:179], v[28:31]
    v_mfma_f32_16x16x32_bf16 v[72:75], v[192:195], v[180:183], v[72:75]
    v_mfma_f32_16x16x32_bf16 v[76:79], v[196:199], v[180:183], v[76:79]
    v_mfma_f32_16x16x32_bf16 v[112:115], v[180:183], v[200:203], v[112:115]
    v_mfma_f32_16x16x32_bf16 v[116:119], v[180:183], v[204:207], v[116:119]
    v_mfma_f32_16x16x32_bf16 v[32:35], v[184:187], v[180:183], v[32:35]
    v_mfma_f32_16x16x32_bf16 v[36:39], v[188:191], v[180:183], v[36:39]
    s_barrier
    s_mov_b64 exec, 1
    buffer_store_dword v3, v2, s[28:31], 0 offen sc1
    s_mov_b64 exec, -1
    s_barrier
    ds_read_b128 v[120:123], v232 offset:0
    ds_read_b64_tr_b16 v[148:149], v235 offset:128
    ds_read_b64_tr_b16 v[150:151], v235 offset:1664
    ds_read_b64_tr_b16 v[152:153], v236 offset:128
    ds_read_b64_tr_b16 v[154:155], v236 offset:1664
    ds_read_b64_tr_b16 v[156:157], v235 offset:256
    ds_read_b64_tr_b16 v[158:159], v235 offset:1792
    ds_read_b64_tr_b16 v[160:161], v236 offset:256
    ds_read_b64_tr_b16 v[162:163], v236 offset:1792
    ds_read_b128 v[124:127], v232 offset:2048
    ds_read_b64_tr_b16 v[140:141], v235 offset:0
    ds_read_b64_tr_b16 v[142:143], v235 offset:1536
    ds_read_b64_tr_b16 v[144:145], v236 offset:0
    ds_read_b64_tr_b16 v[146:147], v236 offset:1536
    ds_read_b128 v[128:131], v232 offset:4096
    ds_read_b128 v[132:135], v232 offset:6144
    ds_read_b128 v[136:139], v232 offset:8192
    s_add_u32 s52, s52, 49152
    s_cmp_ge_u32 s52, 147456
    s_cselect_b32 s52, 0, s52
    s_waitcnt lgkmcnt(0)
    v_mfma_f32_16x16x32_bf16 v[40:43], v[148:151], v[120:123], v[40:43]
    ds_read_b128 v[164:167], v232 offset:1024
    v_mfma_f32_16x16x32_bf16 v[44:47], v[152:155], v[120:123], v[44:47]
    ds_read_b64_tr_b16 v[192:193], v235 offset:12416
    v_mfma_f32_16x16x32_bf16 v[80:83], v[120:123], v[156:159], v[80:83]
    ds_read_b64_tr_b16 v[194:195], v235 offset:13952
    v_mfma_f32_16x16x32_bf16 v[84:87], v[120:123], v[160:163], v[84:87]
    ds_read_b64_tr_b16 v[196:197], v236 offset:12416
    v_mfma_f32_16x16x32_bf16 v[48:51], v[148:151], v[124:127], v[48:51]
    ds_read_b64_tr_b16 v[198:199], v236 offset:13952
    v_mfma_f32_16x16x32_bf16 v[52:55], v[152:155], v[124:127], v[52:55]
    v_mfma_f32_16x16x32_bf16 v[88:91], v[124:127], v[156:159], v[88:91]
    ds_read_b64_tr_b16 v[200:201], v235 offset:12544
    v_mfma_f32_16x16x32_bf16 v[92:95], v[124:127], v[160:163], v[92:95]
    ds_read_b64_tr_b16 v[202:203], v235 offset:14080
    v_mfma_f32_16x16x32_bf16 v[8:11], v[140:143], v[124:127], v[8:11]
    ds_read_b64_tr_b16 v[204:205], v236 offset:12544
    v_mfma_f32_16x16x32_bf16 v[12:15], v[144:147], v[124:127], v[12:15]
    ds_read_b64_tr_b16 v[206:207], v236 offset:14080
    v_mfma_f32_16x16x32_bf16 v[56:59], v[148:151], v[128:131], v[56:59]
    v_mfma_f32_16x16x32_bf16 v[60:63], v[152:155], v[128:131], v[60:63]
    ds_read_b128 v[168:171], v232 offset:3072
    v_mfma_f32_16x16x32_bf16 v[96:99], v[128:131], v[156:159], v[96:99]
    ds_read_b64_tr_b16 v[184:185], v235 offset:12288
    v_mfma_f32_16x16x32_bf16 v[100:103], v[128:131], v[160:163], v[100:103]
    ds_read_b64_tr_b16 v[186:187], v235 offset:13824
    v_mfma_f32_16x16x32_bf16 v[16:19], v[140:143], v[128:131], v[16:19]
    s_movk_i32 s54, 13
M_P_loop0:
    ds_read_b64_tr_b16 v[188:189], v236 offset:12288
    v_mfma_f32_16x16x32_bf16 v[20:23], v[144:147], v[128:131], v[20:23]
    v_mfma_f32_16x16x32_bf16 v[64:67], v[148:151], v[132:135], v[64:67]
    ds_read_b64_tr_b16 v[190:191], v236 offset:13824
    v_mfma_f32_16x16x32_bf16 v[68:71], v[152:155], v[132:135], v[68:71]
    ds_read_b128 v[172:175], v232 offset:5120
    v_mfma_f32_16x16x32_bf16 v[104:107], v[132:135], v[156:159], v[104:107]
    ds_read_b128 v[176:179], v232 offset:7168
    v_mfma_f32_16x16x32_bf16 v[108:111], v[132:135], v[160:163], v[108:111]
    ds_read_b128 v[180:183], v232 offset:9216
    v_mfma_f32_16x16x32_bf16 v[24:27], v[140:143], v[132:135], v[24:27]
    v_mfma_f32_16x16x32_bf16 v[28:31], v[144:147], v[132:135], v[28:31]
    v_add_u32 v232, s52, v233
    v_mfma_f32_16x16x32_bf16 v[72:75], v[148:151], v[136:139], v[72:75]
    v_mfma_f32_16x16x32_bf16 v[76:79], v[152:155], v[136:139], v[76:79]
    v_add_u32 v235, s52, v239
    v_mfma_f32_16x16x32_bf16 v[112:115], v[136:139], v[156:159], v[112:115]
    v_mfma_f32_16x16x32_bf16 v[116:119], v[136:139], v[160:163], v[116:119]
    v_add_u32 v236, s52, v240
    v_mfma_f32_16x16x32_bf16 v[32:35], v[140:143], v[136:139], v[32:35]
    v_mfma_f32_16x16x32_bf16 v[36:39], v[144:147], v[136:139], v[36:39]
    s_waitcnt lgkmcnt(0)
    v_mfma_f32_16x16x32_bf16 v[40:43], v[192:195], v[164:167], v[40:43]
    s_barrier
    v_mfma_f32_16x16x32_bf16 v[44:47], v[196:199], v[164:167], v[44:47]
    ds_read_b128 v[120:123], v232 offset:0
    v_mfma_f32_16x16x32_bf16 v[80:83], v[164:167], v[200:203], v[80:83]
    ds_read_b64_tr_b16 v[148:149], v235 offset:128
    v_mfma_f32_16x16x32_bf16 v[84:87], v[164:167], v[204:207], v[84:87]
    ds_read_b64_tr_b16 v[150:151], v235 offset:1664
    v_mfma_f32_16x16x32_bf16 v[48:51], v[192:195], v[168:171], v[48:51]
    ds_read_b64_tr_b16 v[152:153], v236 offset:128
    v_mfma_f32_16x16x32_bf16 v[52:55], v[196:199], v[168:171], v[52:55]
    ds_read_b64_tr_b16 v[154:155], v236 offset:1664
    v_mfma_f32_16x16x32_bf16 v[88:91], v[168:171], v[200:203], v[88:91]
    ds_read_b64_tr_b16 v[156:157], v235 offset:256
    v_mfma_f32_16x16x32_bf16 v[92:95], v[168:171], v[204:207], v[92:95]
    v_mfma_f32_16x16x32_bf16 v[8:11], v[184:187], v[168:171], v[8:11]
    ds_read_b64_tr_b16 v[158:159], v235 offset:1792
    v_mfma_f32_16x16x32_bf16 v[12:15], v[188:191], v[168:171], v[12:15]
    ds_read_b64_tr_b16 v[160:161], v236 offset:256
    v_mfma_f32_16x16x32_bf16 v[56:59], v[192:195], v[172:175], v[56:59]
    ds_read_b64_tr_b16 v[162:163], v236 offset:1792
    v_mfma_f32_16x16x32_bf16 v[60:63], v[196:199], v[172:175], v[60:63]
    ds_read_b128 v[124:127], v232 offset:2048
    v_mfma_f32_16x16x32_bf16 v[96:99], v[172:175], v[200:203], v[96:99]
    ds_read_b64_tr_b16 v[140:141], v235 offset:0
    v_mfma_f32_16x16x32_bf16 v[100:103], v[172:175], v[204:207], v[100:103]
    ds_read_b64_tr_b16 v[142:143], v235 offset:1536
    v_mfma_f32_16x16x32_bf16 v[16:19], v[184:187], v[172:175], v[16:19]
    v_mfma_f32_16x16x32_bf16 v[20:23], v[188:191], v[172:175], v[20:23]
    ds_read_b64_tr_b16 v[144:145], v236 offset:0
    v_mfma_f32_16x16x32_bf16 v[64:67], v[192:195], v[176:179], v[64:67]
    ds_read_b64_tr_b16 v[146:147], v236 offset:1536
    v_mfma_f32_16x16x32_bf16 v[68:71], v[196:199], v[176:179], v[68:71]
    ds_read_b128 v[128:131], v232 offset:4096
    v_mfma_f32_16x16x32_bf16 v[104:107], v[176:179], v[200:203], v[104:107]
    ds_read_b128 v[132:135], v232 offset:6144
    v_mfma_f32_16x16x32_bf16 v[108:111], v[176:179], v[204:207], v[108:111]
    ds_read_b128 v[136:139], v232 offset:8192
    v_mfma_f32_16x16x32_bf16 v[24:27], v[184:187], v[176:179], v[24:27]
    v_mfma_f32_16x16x32_bf16 v[28:31], v[188:191], v[176:179], v[28:31]
    v_mfma_f32_16x16x32_bf16 v[72:75], v[192:195], v[180:183], v[72:75]
    v_mfma_f32_16x16x32_bf16 v[76:79], v[196:199], v[180:183], v[76:79]
    v_mfma_f32_16x16x32_bf16 v[112:115], v[180:183], v[200:203], v[112:115]
    v_mfma_f32_16x16x32_bf16 v[116:119], v[180:183], v[204:207], v[116:119]
    v_mfma_f32_16x16x32_bf16 v[32:35], v[184:187], v[180:183], v[32:35]
    s_add_u32 s52, s52, 49152
    s_cmp_ge_u32 s52, 147456
    s_cselect_b32 s52, 0, s52
    v_mfma_f32_16x16x32_bf16 v[36:39], v[188:191], v[180:183], v[36:39]
    s_waitcnt lgkmcnt(0)
    v_mfma_f32_16x16x32_bf16 v[40:43], v[148:151], v[120:123], v[40:43]
    ds_read_b128 v[164:167], v232 offset:1024
    v_mfma_f32_16x16x32_bf16 v[44:47], v[152:155], v[120:123], v[44:47]
    ds_read_b64_tr_b16 v[192:193], v235 offset:12416
    v_mfma_f32_16x16x32_bf16 v[80:83], v[120:123], v[156:159], v[80:83]
    ds_read_b64_tr_b16 v[194:195], v235 offset:13952
    v_mfma_f32_16x16x32_bf16 v[84:87], v[120:123], v[160:163], v[84:87]
    ds_read_b64_tr_b16 v[196:197], v236 offset:12416
    v_mfma_f32_16x16x32_bf16 v[48:51], v[148:151], v[124:127], v[48:51]
    ds_read_b64_tr_b16 v[198:199], v236 offset:13952
    v_mfma_f32_16x16x32_bf16 v[52:55], v[152:155], v[124:127], v[52:55]
    v_mfma_f32_16x16x32_bf16 v[88:91], v[124:127], v[156:159], v[88:91]
    ds_read_b64_tr_b16 v[200:201], v235 offset:12544
    v_mfma_f32_16x16x32_bf16 v[92:95], v[124:127], v[160:163], v[92:95]
    ds_read_b64_tr_b16 v[202:203], v235 offset:14080
    v_mfma_f32_16x16x32_bf16 v[8:11], v[140:143], v[124:127], v[8:11]
    ds_read_b64_tr_b16 v[204:205], v236 offset:12544
    v_mfma_f32_16x16x32_bf16 v[12:15], v[144:147], v[124:127], v[12:15]
    ds_read_b64_tr_b16 v[206:207], v236 offset:14080
    v_mfma_f32_16x16x32_bf16 v[56:59], v[148:151], v[128:131], v[56:59]
    v_mfma_f32_16x16x32_bf16 v[60:63], v[152:155], v[128:131], v[60:63]
    ds_read_b128 v[168:171], v232 offset:3072
    v_mfma_f32_16x16x32_bf16 v[96:99], v[128:131], v[156:159], v[96:99]
    ds_read_b64_tr_b16 v[184:185], v235 offset:12288
    v_mfma_f32_16x16x32_bf16 v[100:103], v[128:131], v[160:163], v[100:103]
    s_sub_u32 s54, s54, 1
    ds_read_b64_tr_b16 v[186:187], v235 offset:13824
    v_mfma_f32_16x16x32_bf16 v[16:19], v[140:143], v[128:131], v[16:19]
    s_cbranch_scc0 M_P_loop0
    ds_read_b64_tr_b16 v[188:189], v236 offset:12288
    v_mfma_f32_16x16x32_bf16 v[20:23], v[144:147], v[128:131], v[20:23]
    v_mfma_f32_16x16x32_bf16 v[64:67], v[148:151], v[132:135], v[64:67]
    ds_read_b64_tr_b16 v[190:191], v236 offset:13824
    v_mfma_f32_16x16x32_bf16 v[68:71], v[152:155], v[132:135], v[68:71]
    ds_read_b128 v[172:175], v232 offset:5120
    v_mfma_f32_16x16x32_bf16 v[104:107], v[132:135], v[156:159], v[104:107]
    ds_read_b128 v[176:179], v232 offset:7168
    v_mfma_f32_16x16x32_bf16 v[108:111], v[132:135], v[160:163], v[108:111]
    ds_read_b128 v[180:183], v232 offset:9216
    v_mfma_f32_16x16x32_bf16 v[24:27], v[140:143], v[132:135], v[24:27]
    v_mfma_f32_16x16x32_bf16 v[28:31], v[144:147], v[132:135], v[28:31]
    v_mfma_f32_16x16x32_bf16 v[72:75], v[148:151], v[136:139], v[72:75]
    v_mfma_f32_16x16x32_bf16 v[76:79], v[152:155], v[136:139], v[76:79]
    v_mfma_f32_16x16x32_bf16 v[112:115], v[136:139], v[156:159], v[112:115]
    v_mfma_f32_16x16x32_bf16 v[116:119], v[136:139], v[160:163], v[116:119]
    v_mfma_f32_16x16x32_bf16 v[32:35], v[140:143], v[136:139], v[32:35]
    v_mfma_f32_16x16x32_bf16 v[36:39], v[144:147], v[136:139], v[36:39]
    s_waitcnt lgkmcnt(0)
    v_mfma_f32_16x16x32_bf16 v[40:43], v[192:195], v[164:167], v[40:43]
    s_barrier
    v_mfma_f32_16x16x32_bf16 v[44:47], v[196:199], v[164:167], v[44:47]
    v_mfma_f32_16x16x32_bf16 v[80:83], v[164:167], v[200:203], v[80:83]
    v_mfma_f32_16x16x32_bf16 v[84:87], v[164:167], v[204:207], v[84:87]
    v_mfma_f32_16x16x32_bf16 v[48:51], v[192:195], v[168:171], v[48:51]
    v_mfma_f32_16x16x32_bf16 v[52:55], v[196:199], v[168:171], v[52:55]
    v_mfma_f32_16x16x32_bf16 v[88:91], v[168:171], v[200:203], v[88:91]
    v_mfma_f32_16x16x32_bf16 v[92:95], v[168:171], v[204:207], v[92:95]
    v_mfma_f32_16x16x32_bf16 v[8:11], v[184:187], v[168:171], v[8:11]
    v_mfma_f32_16x16x32_bf16 v[12:15], v[188:191], v[168:171], v[12:15]
    v_mfma_f32_16x16x32_bf16 v[56:59], v[192:195], v[172:175], v[56:59]
    v_mfma_f32_16x16x32_bf16 v[60:63], v[196:199], v[172:175], v[60:63]
    v_mfma_f32_16x16x32_bf16 v[96:99], v[172:175], v[200:203], v[96:99]
    v_mfma_f32_16x16x32_bf16 v[100:103], v[172:175], v[204:207], v[100:103]
    v_mfma_f32_16x16x32_bf16 v[16:19], v[184:187], v[172:175], v[16:19]
    v_mfma_f32_16x16x32_bf16 v[20:23], v[188:191], v[172:175], v[20:23]
    v_mfma_f32_16x16x32_bf16 v[64:67], v[192:195], v[176:179], v[64:67]
    v_mfma_f32_16x16x32_bf16 v[68:71], v[196:199], v[176:179], v[68:71]
    v_mfma_f32_16x16x32_bf16 v[104:107], v[176:179], v[200:203], v[104:107]
    v_mfma_f32_16x16x32_bf16 v[108:111], v[176:179], v[204:207], v[108:111]
    v_mfma_f32_16x16x32_bf16 v[24:27], v[184:187], v[176:179], v[24:27]
    v_mfma_f32_16x16x32_bf16 v[28:31], v[188:191], v[176:179], v[28:31]
    v_mfma_f32_16x16x32_bf16 v[72:75], v[192:195], v[180:183], v[72:75]
    v_mfma_f32_16x16x32_bf16 v[76:79], v[196:199], v[180:183], v[76:79]
    v_mfma_f32_16x16x32_bf16 v[112:115], v[180:183], v[200:203], v[112:115]
    v_mfma_f32_16x16x32_bf16 v[116:119], v[180:183], v[204:207], v[116:119]
    v_mfma_f32_16x16x32_bf16 v[32:35], v[184:187], v[180:183], v[32:35]
    v_mfma_f32_16x16x32_bf16 v[36:39], v[188:191], v[180:183], v[36:39]
    v_cvt_pk_bf16_f32 v120, v40, v41
    v_cvt_pk_bf16_f32 v121, v42, v43
    v_cvt_pk_bf16_f32 v122, v44, v45
    v_cvt_pk_bf16_f32 v123, v46, v47
    v_cvt_pk_bf16_f32 v124, v48, v49
    v_cvt_pk_bf16_f32 v125, v50, v51
    v_cvt_pk_bf16_f32 v126, v52, v53
    v_cvt_pk_bf16_f32 v127, v54, v55
    v_cvt_pk_bf16_f32 v140, v8, v9
    v_cvt_pk_bf16_f32 v141, v10, v11
    v_cvt_pk_bf16_f32 v142, v12, v13
    v_cvt_pk_bf16_f32 v143, v14, v15
    v_cvt_pk_bf16_f32 v128, v56, v57
    v_cvt_pk_bf16_f32 v129, v58, v59
    v_cvt_pk_bf16_f32 v130, v60, v61
    v_cvt_pk_bf16_f32 v131, v62, v63
    v_cvt_pk_bf16_f32 v144, v16, v17
    v_cvt_pk_bf16_f32 v145, v18, v19
    v_cvt_pk_bf16_f32 v146, v20, v21
    v_cvt_pk_bf16_f32 v147, v22, v23
    v_cvt_pk_bf16_f32 v132, v64, v65
    v_cvt_pk_bf16_f32 v133, v66, v67
    v_cvt_pk_bf16_f32 v134, v68, v69
    v_cvt_pk_bf16_f32 v135, v70, v71
    v_cvt_pk_bf16_f32 v148, v24, v25
    v_cvt_pk_bf16_f32 v149, v26, v27
    v_cvt_pk_bf16_f32 v150, v28, v29
    v_cvt_pk_bf16_f32 v151, v30, v31
    v_cvt_pk_bf16_f32 v136, v72, v73
    v_cvt_pk_bf16_f32 v137, v74, v75
    v_cvt_pk_bf16_f32 v138, v76, v77
    v_cvt_pk_bf16_f32 v139, v78, v79
    v_cvt_pk_bf16_f32 v152, v32, v33
    v_cvt_pk_bf16_f32 v153, v34, v35
    v_cvt_pk_bf16_f32 v154, v36, v37
    v_cvt_pk_bf16_f32 v155, v38, v39
    v_mfma_f32_16x16x32_bf16 v[8:11], v[120:123], v[140:143], 0
    v_mfma_f32_16x16x32_bf16 v[12:15], v[124:127], v[140:143], 0
    v_mfma_f32_16x16x32_bf16 v[16:19], v[124:127], v[144:147], 0
    v_mfma_f32_16x16x32_bf16 v[20:23], v[128:131], v[144:147], 0
    v_mfma_f32_16x16x32_bf16 v[24:27], v[128:131], v[148:151], 0
    v_mfma_f32_16x16x32_bf16 v[28:31], v[132:135], v[148:151], 0
    v_mfma_f32_16x16x32_bf16 v[32:35], v[132:135], v[152:155], 0
    v_mfma_f32_16x16x32_bf16 v[36:39], v[136:139], v[152:155], 0
    v_cvt_pk_bf16_f32 v156, v80, v81
    v_cvt_pk_bf16_f32 v157, v82, v83
    v_cvt_pk_bf16_f32 v166, v84, v85
    v_cvt_pk_bf16_f32 v167, v86, v87
    v_cvt_pk_bf16_f32 v158, v88, v89
    v_cvt_pk_bf16_f32 v159, v90, v91
    v_cvt_pk_bf16_f32 v168, v92, v93
    v_cvt_pk_bf16_f32 v169, v94, v95
    v_cvt_pk_bf16_f32 v160, v96, v97
    v_cvt_pk_bf16_f32 v161, v98, v99
    v_cvt_pk_bf16_f32 v170, v100, v101
    v_cvt_pk_bf16_f32 v171, v102, v103
    v_cvt_pk_bf16_f32 v162, v104, v105
    v_cvt_pk_bf16_f32 v163, v106, v107
    v_cvt_pk_bf16_f32 v172, v108, v109
    v_cvt_pk_bf16_f32 v173, v110, v111
    v_cvt_pk_bf16_f32 v164, v112, v113
    v_cvt_pk_bf16_f32 v165, v114, v115
    v_cvt_pk_bf16_f32 v174, v116, v117
    v_cvt_pk_bf16_f32 v175, v118, v119
    s_mov_b32 s64, 0x3e8293ee
    v_mov_b32 v5, 0xf149f2ca
    v_cndmask_b32 v8, v5, v8, s[88:89]
    v_cndmask_b32 v12, v5, v12, s[80:81]
    v_cndmask_b32 v9, v5, v9, s[90:91]
    v_cndmask_b32 v13, v5, v13, s[82:83]
    v_cndmask_b32 v10, v5, v10, s[92:93]
    v_cndmask_b32 v14, v5, v14, s[84:85]
    v_cndmask_b32 v11, v5, v11, s[94:95]
    v_cndmask_b32 v15, v5, v15, s[86:87]
    v_cndmask_b32 v16, v5, v16, s[72:73]
    v_cndmask_b32 v20, v5, v20, s[80:81]
    v_cndmask_b32 v17, v5, v17, s[74:75]
    v_cndmask_b32 v21, v5, v21, s[82:83]
    v_cndmask_b32 v18, v5, v18, s[76:77]
    v_cndmask_b32 v22, v5, v22, s[84:85]
    v_cndmask_b32 v19, v5, v19, s[78:79]
    v_cndmask_b32 v23, v5, v23, s[86:87]
    v_cndmask_b32 v24, v5, v24, s[72:73]
    v_cndmask_b32 v28, v5, v28, s[80:81]
    v_cndmask_b32 v25, v5, v25, s[74:75]
    v_cndmask_b32 v29, v5, v29, s[82:83]
    v_cndmask_b32 v26, v5, v26, s[76:77]
    v_cndmask_b32 v30, v5, v30, s[84:85]
    v_cndmask_b32 v27, v5, v27, s[78:79]
    v_cndmask_b32 v31, v5, v31, s[86:87]
    v_cndmask_b32 v32, v5, v32, s[72:73]
    v_cndmask_b32 v36, v5, v36, s[80:81]
    v_cndmask_b32 v33, v5, v33, s[74:75]
    v_cndmask_b32 v37, v5, v37, s[82:83]
    v_cndmask_b32 v34, v5, v34, s[76:77]
    v_cndmask_b32 v38, v5, v38, s[84:85]
    v_cndmask_b32 v35, v5, v35, s[78:79]
    v_cndmask_b32 v39, v5, v39, s[86:87]
    v_max3_f32 v192, v8, v9, v10
    v_max3_f32 v196, v11, v12, v13
    v_max3_f32 v193, v16, v17, v18
    v_max3_f32 v197, v19, v20, v21
    v_max3_f32 v194, v24, v25, v26
    v_max3_f32 v198, v27, v28, v29
    v_max3_f32 v195, v32, v33, v34
    v_max3_f32 v199, v35, v36, v37
    v_max3_f32 v192, v192, v14, v15
    v_max3_f32 v193, v193, v22, v23
    v_max3_f32 v194, v194, v30, v31
    v_max3_f32 v195, v195, v38, v39
    v_max_f32 v192, v192, v196
    v_max_f32 v193, v193, v197
    v_max_f32 v194, v194, v198
    v_max_f32 v195, v195, v199
    v_mov_b32 v196, v192
    v_mov_b32 v197, v193
    v_mov_b32 v198, v194
    v_mov_b32 v199, v195
    v_permlane32_swap_b32 v192, v196
    v_permlane32_swap_b32 v193, v197
    v_permlane32_swap_b32 v194, v198
    v_permlane32_swap_b32 v195, v199
    v_max_f32 v192, v192, v196
    v_max_f32 v193, v193, v197
    v_max_f32 v194, v194, v198
    v_max_f32 v195, v195, v199
    v_mov_b32 v196, v192
    v_mov_b32 v197, v193
    v_mov_b32 v198, v194
    v_mov_b32 v199, v195
    v_permlane16_swap_b32 v192, v196
    v_permlane16_swap_b32 v193, v197
    v_permlane16_swap_b32 v194, v198
    v_permlane16_swap_b32 v195, v199
    v_max_f32 v192, v192, v196
    v_max_f32 v193, v193, v197
    v_max_f32 v194, v194, v198
    v_max_f32 v195, v195, v199
    v_mul_f32 v192, s64, v192
    v_mul_f32 v193, s64, v193
    v_mul_f32 v194, s64, v194
    v_mul_f32 v195, s64, v195
    v_fma_f32 v8, v8, s64, -v192
    v_fma_f32 v9, v9, s64, -v192
    v_fma_f32 v10, v10, s64, -v192
    v_fma_f32 v11, v11, s64, -v192
    v_fma_f32 v12, v12, s64, -v192
    v_fma_f32 v13, v13, s64, -v192
    v_fma_f32 v14, v14, s64, -v192
    v_fma_f32 v15, v15, s64, -v192
    v_fma_f32 v16, v16, s64, -v193
    v_fma_f32 v17, v17, s64, -v193
    v_fma_f32 v18, v18, s64, -v193
    v_fma_f32 v19, v19, s64, -v193
    v_fma_f32 v20, v20, s64, -v193
    v_fma_f32 v21, v21, s64, -v193
    v_fma_f32 v22, v22, s64, -v193
    v_fma_f32 v23, v23, s64, -v193
    v_fma_f32 v24, v24, s64, -v194
    v_fma_f32 v25, v25, s64, -v194
    v_fma_f32 v26, v26, s64, -v194
    v_fma_f32 v27, v27, s64, -v194
    v_fma_f32 v28, v28, s64, -v194
    v_fma_f32 v29, v29, s64, -v194
    v_fma_f32 v30, v30, s64, -v194
    v_fma_f32 v31, v31, s64, -v194
    v_fma_f32 v32, v32, s64, -v195
    v_fma_f32 v33, v33, s64, -v195
    v_fma_f32 v34, v34, s64, -v195
    v_fma_f32 v35, v35, s64, -v195
    v_fma_f32 v36, v36, s64, -v195
    v_fma_f32 v37, v37, s64, -v195
    v_fma_f32 v38, v38, s64, -v195
    v_fma_f32 v39, v39, s64, -v195
    v_exp_f32 v8, v8
    v_exp_f32 v9, v9
    v_exp_f32 v10, v10
    v_exp_f32 v11, v11
    v_exp_f32 v12, v12
    v_exp_f32 v13, v13
    v_exp_f32 v14, v14
    v_exp_f32 v15, v15
    v_exp_f32 v16, v16
    v_exp_f32 v17, v17
    v_exp_f32 v18, v18
    v_exp_f32 v19, v19
    v_exp_f32 v20, v20
    v_exp_f32 v21, v21
    v_exp_f32 v22, v22
    v_exp_f32 v23, v23
    v_exp_f32 v24, v24
    v_exp_f32 v25, v25
    v_exp_f32 v26, v26
    v_exp_f32 v27, v27
    v_exp_f32 v28, v28
    v_exp_f32 v29, v29
    v_exp_f32 v30, v30
    v_exp_f32 v31, v31
    v_exp_f32 v32, v32
    v_exp_f32 v33, v33
    v_exp_f32 v34, v34
    v_exp_f32 v35, v35
    v_exp_f32 v36, v36
    v_exp_f32 v37, v37
    v_exp_f32 v38, v38
    v_exp_f32 v39, v39
    v_pk_add_f32 v[200:201], v[8:9], v[10:11]
    v_pk_add_f32 v[202:203], v[16:17], v[18:19]
    v_pk_add_f32 v[204:205], v[24:25], v[26:27]
    v_pk_add_f32 v[206:207], v[32:33], v[34:35]
    v_pk_add_f32 v[200:201], v[200:201], v[12:13]
    v_pk_add_f32 v[202:203], v[202:203], v[20:21]
    v_pk_add_f32 v[204:205], v[204:205], v[28:29]
    v_pk_add_f32 v[206:207], v[206:207], v[36:37]
    v_pk_add_f32 v[200:201], v[200:201], v[14:15]
    v_pk_add_f32 v[202:203], v[202:203], v[22:23]
    v_pk_add_f32 v[204:205], v[204:205], v[30:31]
    v_pk_add_f32 v[206:207], v[206:207], v[38:39]
    v_add_f32 v200, v200, v201
    v_add_f32 v202, v202, v203
    v_add_f32 v204, v204, v205
    v_add_f32 v206, v206, v207
    v_mov_b32 v196, v200
    v_mov_b32 v197, v202
    v_mov_b32 v198, v204
    v_mov_b32 v199, v206
    v_permlane32_swap_b32 v200, v196
    v_permlane32_swap_b32 v202, v197
    v_permlane32_swap_b32 v204, v198
    v_permlane32_swap_b32 v206, v199
    v_add_f32 v200, v200, v196
    v_add_f32 v202, v202, v197
    v_add_f32 v204, v204, v198
    v_add_f32 v206, v206, v199
    v_mov_b32 v196, v200
    v_mov_b32 v197, v202
    v_mov_b32 v198, v204
    v_mov_b32 v199, v206
    v_permlane16_swap_b32 v200, v196
    v_permlane16_swap_b32 v202, v197
    v_permlane16_swap_b32 v204, v198
    v_permlane16_swap_b32 v206, v199
    v_add_f32 v200, v200, v196
    v_add_f32 v202, v202, v197
    v_add_f32 v204, v204, v198
    v_add_f32 v206, v206, v199
    v_rcp_f32 v200, v200
    v_rcp_f32 v202, v202
    v_rcp_f32 v204, v204
    v_rcp_f32 v206, v206
    v_pk_mul_f32 v[8:9], v[8:9], v[200:201] op_sel_hi:[1,0]
    v_pk_mul_f32 v[10:11], v[10:11], v[200:201] op_sel_hi:[1,0]
    v_pk_mul_f32 v[12:13], v[12:13], v[200:201] op_sel_hi:[1,0]
    v_pk_mul_f32 v[14:15], v[14:15], v[200:201] op_sel_hi:[1,0]
    v_pk_mul_f32 v[16:17], v[16:17], v[202:203] op_sel_hi:[1,0]
    v_pk_mul_f32 v[18:19], v[18:19], v[202:203] op_sel_hi:[1,0]
    v_pk_mul_f32 v[20:21], v[20:21], v[202:203] op_sel_hi:[1,0]
    v_pk_mul_f32 v[22:23], v[22:23], v[202:203] op_sel_hi:[1,0]
    v_pk_mul_f32 v[24:25], v[24:25], v[204:205] op_sel_hi:[1,0]
    v_pk_mul_f32 v[26:27], v[26:27], v[204:205] op_sel_hi:[1,0]
    v_pk_mul_f32 v[28:29], v[28:29], v[204:205] op_sel_hi:[1,0]
    v_pk_mul_f32 v[30:31], v[30:31], v[204:205] op_sel_hi:[1,0]
    v_pk_mul_f32 v[32:33], v[32:33], v[206:207] op_sel_hi:[1,0]
    v_pk_mul_f32 v[34:35], v[34:35], v[206:207] op_sel_hi:[1,0]
    v_pk_mul_f32 v[36:37], v[36:37], v[206:207] op_sel_hi:[1,0]
    v_pk_mul_f32 v[38:39], v[38:39], v[206:207] op_sel_hi:[1,0]
    v_cvt_pk_bf16_f32 v176, v8, v9
    v_cvt_pk_bf16_f32 v177, v10, v11
    v_cvt_pk_bf16_f32 v178, v12, v13
    v_cvt_pk_bf16_f32 v179, v14, v15
    v_cvt_pk_bf16_f32 v180, v16, v17
    v_cvt_pk_bf16_f32 v181, v18, v19
    v_cvt_pk_bf16_f32 v182, v20, v21
    v_cvt_pk_bf16_f32 v183, v22, v23
    v_cvt_pk_bf16_f32 v184, v24, v25
    v_cvt_pk_bf16_f32 v185, v26, v27
    v_cvt_pk_bf16_f32 v186, v28, v29
    v_cvt_pk_bf16_f32 v187, v30, v31
    v_cvt_pk_bf16_f32 v188, v32, v33
    v_cvt_pk_bf16_f32 v189, v34, v35
    v_cvt_pk_bf16_f32 v190, v36, v37
    v_cvt_pk_bf16_f32 v191, v38, v39
    v_mfma_f32_16x16x32_bf16 v[40:43], v[156:159], v[176:179], 0
    v_mfma_f32_16x16x32_bf16 v[44:47], v[166:169], v[176:179], 0
    v_mfma_f32_16x16x32_bf16 v[48:51], v[158:161], v[180:183], 0
    v_mfma_f32_16x16x32_bf16 v[52:55], v[168:171], v[180:183], 0
    v_mfma_f32_16x16x32_bf16 v[56:59], v[160:163], v[184:187], 0
    v_mfma_f32_16x16x32_bf16 v[60:63], v[170:173], v[184:187], 0
    v_mfma_f32_16x16x32_bf16 v[64:67], v[162:165], v[188:191], 0
    v_mfma_f32_16x16x32_bf16 v[68:71], v[172:175], v[188:191], 0
    s_mov_b32 s72, 0x0
    s_mov_b32 s73, 0x8000
    s_mov_b32 s74, 0x10000
    s_mov_b32 s75, 0x18000
    v_cvt_pk_bf16_f32 v120, v40, v41
    v_cvt_pk_bf16_f32 v121, v42, v43
    v_cvt_pk_bf16_f32 v122, v44, v45
    v_cvt_pk_bf16_f32 v123, v46, v47
    buffer_store_dwordx4 v[120:123], v237, s[28:31], s72 offen sc1
    v_cvt_pk_bf16_f32 v124, v48, v49
    v_cvt_pk_bf16_f32 v125, v50, v51
    v_cvt_pk_bf16_f32 v126, v52, v53
    v_cvt_pk_bf16_f32 v127, v54, v55
    buffer_store_dwordx4 v[124:127], v237, s[28:31], s73 offen sc1
    v_cvt_pk_bf16_f32 v128, v56, v57
    v_cvt_pk_bf16_f32 v129, v58, v59
    v_cvt_pk_bf16_f32 v130, v60, v61
    v_cvt_pk_bf16_f32 v131, v62, v63
    buffer_store_dwordx4 v[128:131], v237, s[28:31], s74 offen sc1
    v_cvt_pk_bf16_f32 v132, v64, v65
    v_cvt_pk_bf16_f32 v133, v66, v67
    v_cvt_pk_bf16_f32 v134, v68, v69
    v_cvt_pk_bf16_f32 v135, v70, v71
    buffer_store_dwordx4 v[132:135], v237, s[28:31], s75 offen sc1
    s_lshl_b32 s64, s44, 13
    s_lshl_b32 s65, s48, 9
    s_add_u32 s64, s64, s65
    s_add_u32 s64, s64, 0xa0000
    v_lshl_add_u32 v200, v1, 3, s64
    s_mov_b32 s76, 0
    s_mov_b32 s77, 32768
    s_mov_b32 s78, 65536
    s_mov_b32 s79, 98304
    s_lshl_b32 s68, s47, 9
    s_add_u32 s68, s68, 0x54000
    s_add_u32 s62, s26, s68
    s_addc_u32 s63, s27, 0
    s_lshr_b32 s68, s48, 2
    s_lshl_b32 s68, s68, 7
    v_mov_b32 v2, 1
    v_mov_b32 v5, 148484
    s_waitcnt vmcnt(0)
    s_mov_b64 exec, 1
    ds_add_rtn_u32 v245, v5, v2
    s_mov_b64 exec, -1
    s_mov_b32 s1, s0
    s_lshl_b32 s64, s48, 2
    s_waitcnt lgkmcnt(0)
    v_readfirstlane_b32 s3, v245
    s_nop 3
    s_cmp_lg_u32 s3, 3
    s_cbranch_scc1 M_po_ok
    s_atomic_swap s0, s[62:63], s64 offset:0
    s_atomic_swap s0, s[62:63], s64 offset:128
    s_atomic_swap s0, s[62:63], s64 offset:256
    s_atomic_swap s0, s[62:63], s64 offset:384
    s_mov_b32 s3, 0x40000
M_po_chk:
    s_load_dwordx16 s[80:95], s[62:63], s68 glc
    s_sub_u32 s3, s3, 1
    s_cbranch_scc1 M_po_ok
M_po_c2:
    s_waitcnt lgkmcnt(0)
    s_xor_b64 s[80:81], s[80:81], s[0:1]
    s_xor_b64 s[82:83], s[82:83], s[0:1]
    s_xor_b64 s[84:85], s[84:85], s[0:1]
    s_xor_b64 s[86:87], s[86:87], s[0:1]
    s_xor_b64 s[88:89], s[88:89], s[0:1]
    s_xor_b64 s[90:91], s[90:91], s[0:1]
    s_xor_b64 s[92:93], s[92:93], s[0:1]
    s_xor_b64 s[94:95], s[94:95], s[0:1]
    s_or_b64 s[80:81], s[80:81], s[82:83]
    s_or_b64 s[84:85], s[84:85], s[86:87]
    s_or_b64 s[88:89], s[88:89], s[90:91]
    s_or_b64 s[92:93], s[92:93], s[94:95]
    s_or_b64 s[80:81], s[80:81], s[84:85]
    s_or_b64 s[88:89], s[88:89], s[92:93]
    s_or_b64 s[80:81], s[80:81], s[88:89]
    s_cbranch_scc1 M_po_chk
M_po_ok:
    s_barrier
    s_setprio 0
    s_and_b32 s57, s58, 15
    s_lshr_b64 s[58:59], s[58:59], 4
    s_lshl_b32 s56, s57, 11
    s_mul_i32 s57, s57, 0x20000
    s_mov_b32 m0, s53
    s_nop 0
    buffer_load_dwordx4 v208, s[28:31], s56 offen offset:0 sc1 lds
    buffer_load_dwordx4 v208, s[28:31], s56 offen offset:1024 sc1 lds
    buffer_load_dwordx4 v209, s[28:31], s56 offen offset:2048 sc1 lds
    buffer_load_dwordx4 v209, s[28:31], s56 offen offset:3072 sc1 lds
    s_add_u32 s53, s53, 24576
    s_cmp_ge_u32 s53, s61
    s_cselect_b32 s53, s60, s53
    s_and_b32 s57, s58, 15
    s_lshr_b64 s[58:59], s[58:59], 4
    s_lshl_b32 s56, s57, 11
    s_mul_i32 s57, s57, 0x20000
    s_mov_b32 m0, s53
    s_nop 0
    buffer_load_dwordx4 v208, s[28:31], s56 offen offset:0 sc1 lds
    buffer_load_dwordx4 v208, s[28:31], s56 offen offset:1024 sc1 lds
    buffer_load_dwordx4 v209, s[28:31], s56 offen offset:2048 sc1 lds
    buffer_load_dwordx4 v209, s[28:31], s56 offen offset:3072 sc1 lds
    s_add_u32 s53, s53, 24576
    s_cmp_ge_u32 s53, s61
    s_cselect_b32 s53, s60, s53
    s_and_b32 s57, s58, 15
    s_lshr_b64 s[58:59], s[58:59], 4
    s_lshl_b32 s56, s57, 11
    s_mul_i32 s57, s57, 0x20000
    s_mov_b32 m0, s53
    s_nop 0
    buffer_load_dwordx4 v208, s[28:31], s56 offen offset:0 sc1 lds
    buffer_load_dwordx4 v208, s[28:31], s56 offen offset:1024 sc1 lds
    buffer_load_dwordx4 v209, s[28:31], s56 offen offset:2048 sc1 lds
    buffer_load_dwordx4 v209, s[28:31], s56 offen offset:3072 sc1 lds
    s_add_u32 s53, s53, 24576
    s_cmp_ge_u32 s53, s61
    s_cselect_b32 s53, s60, s53
    buffer_load_dwordx2 v[192:193], v200, s[28:31], s76 offen sc1
    buffer_load_dwordx2 v[194:195], v200, s[28:31], s77 offen sc1
    buffer_load_dwordx2 v[196:197], v200, s[28:31], s78 offen sc1
    buffer_load_dwordx2 v[198:199], v200, s[28:31], s79 offen sc1
    s_lshl_b32 s64, s45, 13
    v_lshl_add_u32 v233, v1, 4, s64
    v_lshrrev_b32 v2, 2, v1
    v_lshlrev_b32 v4, 8, v2
    v_and_b32 v5, 3, v1
    v_lshl_add_u32 v4, v5, 3, v4
    v_add_u32 v4, 16384, v4
    v_and_b32 v2, 7, v2
    s_lshl_b32 s64, s46, 2
    v_xor_b32 v2, s64, v2
    v_xor_b32 v3, 0, v2
    v_lshl_add_u32 v239, v3, 5, v4
    v_xor_b32 v3, 1, v2
    v_lshl_add_u32 v240, v3, 5, v4
    v_xor_b32 v3, 2, v2
    v_lshl_add_u32 v241, v3, 5, v4
    v_xor_b32 v3, 3, v2
    v_lshl_add_u32 v242, v3, 5, v4
    s_lshl_b32 s64, s2, 2
    s_add_u32 s64, s64, s44
    s_mul_i32 s64, s64, 7168
    s_add_u32 s64, s64, 5248
    s_add_u32 s10, s12, s64
    s_addc_u32 s11, s13, 0
    s_add_u32 s24, s14, s64
    s_addc_u32 s25, s15, 0
    s_mov_b32 s52, 0
    v_add_u32 v232, s52, v233
    v_add_u32 v235, s52, v239
    v_add_u32 v236, s52, v240
    v_add_u32 v237, s52, v241
    v_add_u32 v238, s52, v242
    s_movk_i32 s54, 2
M_P_loop1:
    s_waitcnt vmcnt(12)
    s_barrier
    s_and_b32 s57, s58, 15
    s_lshr_b64 s[58:59], s[58:59], 4
    s_lshl_b32 s56, s57, 11
    s_mul_i32 s57, s57, 0x20000
    s_mov_b32 m0, s53
    s_nop 0
    buffer_load_dwordx4 v208, s[28:31], s56 offen offset:0 sc1 lds
    buffer_load_dwordx4 v208, s[28:31], s56 offen offset:1024 sc1 lds
    buffer_load_dwordx4 v209, s[28:31], s56 offen offset:2048 sc1 lds
    buffer_load_dwordx4 v209, s[28:31], s56 offen offset:3072 sc1 lds
    s_add_u32 s53, s53, 24576
    s_cmp_ge_u32 s53, s61
    s_cselect_b32 s53, s60, s53
    s_sub_u32 s54, s54, 1
    s_cbranch_scc0 M_P_loop1
    s_waitcnt vmcnt(8)
    s_barrier
    s_and_b32 s57, s58, 15
    s_lshr_b64 s[58:59], s[58:59], 4
    s_lshl_b32 s56, s57, 11
    s_mul_i32 s57, s57, 0x20000
    s_add_u32 m0, s53, s70
    s_nop 0
    buffer_load_dwordx4 v210, s[32:35], s57 offen offset:0 lds
    buffer_load_dwordx4 v211, s[32:35], s57 offen offset:1024 lds
    s_mov_b32 m0, s53
    s_nop 0
    buffer_load_dwordx4 v208, s[28:31], s56 offen offset:0 sc1 lds
    buffer_load_dwordx4 v208, s[28:31], s56 offen offset:1024 sc1 lds
    buffer_load_dwordx4 v209, s[28:31], s56 offen offset:2048 sc1 lds
    buffer_load_dwordx4 v209, s[28:31], s56 offen offset:3072 sc1 lds
    s_add_u32 s53, s53, 24576
    s_cmp_ge_u32 s53, s61
    s_cselect_b32 s53, s60, s53
    s_mov_b32 s3, 0x40000
M_tb_chk:
    v_xor_b32 v2, s0, v193
    v_xor_b32 v3, s0, v195
    v_xor_b32 v4, s0, v197
    v_xor_b32 v5, s0, v199
    v_or3_b32 v2, v2, v3, v4
    v_or_b32 v2, v2, v5
    v_cmp_ne_u32 vcc, 0, v2
    s_nop 4
    s_cbranch_vccz M_tb_ok
    s_sub_u32 s3, s3, 1
    s_cbranch_scc1 M_tb_ok
    s_sleep 1
    buffer_load_dwordx2 v[192:193], v200, s[28:31], s76 offen sc1
    buffer_load_dwordx2 v[194:195], v200, s[28:31], s77 offen sc1
    buffer_load_dwordx2 v[196:197], v200, s[28:31], s78 offen sc1
    buffer_load_dwordx2 v[198:199], v200, s[28:31], s79 offen sc1
    s_waitcnt vmcnt(0)
    s_branch M_tb_chk
M_tb_ok:
    v_add_f32 v192, v192, v194
    v_add_f32 v196, v196, v198
    v_add_f32 v192, v192, v196
    v_cvt_pk_bf16_f32 v193, v192, v192
    v_lshlrev_b32 v192, 16, v193
    s_cmp_eq_u32 s44, 2
    s_cselect_b32 s64, 1.0, 0
    v_add_f32 v192, s64, v192
    v_cvt_pk_bf16_f32 v193, v192, v192
    v_lshlrev_b32 v192, 16, v193
    s_cmp_lg_u32 s45, s46
    s_cselect_b32 s64, 0x3fb8aa3b, 1.0
    v_mul_f32 v192, s64, v192
    s_lshl_b32 s64, s44, 8
    s_add_u32 s64, s64, 149504
    v_add_u32 v2, s64, v234
    ds_write_b32 v2, v192
    s_lshl_b32 s64, s47, 12
    s_lshl_b32 s65, s48, 8
    s_add_u32 s64, s64, s65
    s_add_u32 s64, s64, 0xc0000
    s_cmp_eq_u32 s44, 3
    s_cselect_b32 s64, s64, 0x80000000
    v_add_u32 v2, s64, v234
    buffer_store_dword v192, v2, s[28:31], 0 offen sc1
    s_waitcnt lgkmcnt(0)
    s_waitcnt vmcnt(11)
    s_barrier
    s_and_b32 s57, s58, 15
    s_lshr_b64 s[58:59], s[58:59], 4
    s_lshl_b32 s56, s57, 11
    s_mul_i32 s57, s57, 0x20000
    s_add_u32 m0, s53, s70
    s_nop 0
    buffer_load_dwordx4 v210, s[32:35], s57 offen offset:0 lds
    buffer_load_dwordx4 v211, s[32:35], s57 offen offset:1024 lds
    s_mov_b32 m0, s53
    s_nop 0
    buffer_load_dwordx4 v208, s[28:31], s56 offen offset:0 sc1 lds
    buffer_load_dwordx4 v208, s[28:31], s56 offen offset:1024 sc1 lds
    buffer_load_dwordx4 v209, s[28:31], s56 offen offset:2048 sc1 lds
    buffer_load_dwordx4 v209, s[28:31], s56 offen offset:3072 sc1 lds
    s_add_u32 s53, s53, 24576
    s_cmp_ge_u32 s53, s61
    s_cselect_b32 s53, s60, s53
    s_movk_i32 s54, 1
M_P_loop2:
    s_waitcnt vmcnt(13)
    s_barrier
    s_and_b32 s57, s58, 15
    s_lshr_b64 s[58:59], s[58:59], 4
    s_lshl_b32 s56, s57, 11
    s_mul_i32 s57, s57, 0x20000
    s_add_u32 m0, s53, s70
    s_nop 0
    buffer_load_dwordx4 v210, s[32:35], s57 offen offset:0 lds
    buffer_load_dwordx4 v211, s[32:35], s57 offen offset:1024 lds
    s_mov_b32 m0, s53
    s_nop 0
    buffer_load_dwordx4 v208, s[28:31], s56 offen offset:0 sc1 lds
    buffer_load_dwordx4 v208, s[28:31], s56 offen offset:1024 sc1 lds
    buffer_load_dwordx4 v209, s[28:31], s56 offen offset:2048 sc1 lds
    buffer_load_dwordx4 v209, s[28:31], s56 offen offset:3072 sc1 lds
    s_add_u32 s53, s53, 24576
    s_cmp_ge_u32 s53, s61
    s_cselect_b32 s53, s60, s53
    s_sub_u32 s54, s54, 1
    s_cbranch_scc0 M_P_loop2
    s_movk_i32 s54, 4
M_P_loop3:
    s_waitcnt vmcnt(12)
    s_barrier
    s_and_b32 s57, s58, 15
    s_lshr_b64 s[58:59], s[58:59], 4
    s_lshl_b32 s56, s57, 11
    s_mul_i32 s57, s57, 0x20000
    s_add_u32 m0, s53, s70
    s_nop 0
    buffer_load_dwordx4 v210, s[32:35], s57 offen offset:0 lds
    buffer_load_dwordx4 v211, s[32:35], s57 offen offset:1024 lds
    s_mov_b32 m0, s53
    s_nop 0
    buffer_load_dwordx4 v208, s[28:31], s56 offen offset:0 sc1 lds
    buffer_load_dwordx4 v208, s[28:31], s56 offen offset:1024 sc1 lds
    buffer_load_dwordx4 v209, s[28:31], s56 offen offset:2048 sc1 lds
    buffer_load_dwordx4 v209, s[28:31], s56 offen offset:3072 sc1 lds
    s_add_u32 s53, s53, 24576
    s_cmp_ge_u32 s53, s61
    s_cselect_b32 s53, s60, s53
    s_sub_u32 s54, s54, 1
    s_cbranch_scc0 M_P_loop3
    s_waitcnt vmcnt(12)
    s_barrier
    s_and_b32 s57, s58, 15
    s_lshr_b64 s[58:59], s[58:59], 4
    s_lshl_b32 s56, s57, 11
    s_mul_i32 s57, s57, 0x20000
    s_add_u32 m0, s53, s70
    s_nop 0
    buffer_load_dwordx4 v210, s[32:35], s57 offen offset:0 lds
    buffer_load_dwordx4 v211, s[32:35], s57 offen offset:1024 lds
    s_mov_b32 m0, s53
    s_nop 0
    buffer_load_dwordx4 v208, s[28:31], s56 offen offset:0 sc1 lds
    buffer_load_dwordx4 v208, s[28:31], s56 offen offset:1024 sc1 lds
    buffer_load_dwordx4 v209, s[28:31], s56 offen offset:2048 sc1 lds
    buffer_load_dwordx4 v209, s[28:31], s56 offen offset:3072 sc1 lds
    s_add_u32 s53, s53, 24576
    s_cmp_ge_u32 s53, s61
    s_cselect_b32 s53, s60, s53
    s_lshl_b32 s60, s44, 12
    s_add_u32 s61, s60, 147456
    s_add_u32 s53, s60, 0
    s_bfe_u32 s66, s2, 0x30003
    s_lshr_b32 s55, s2, 6
    s_add_u32 s66, s66, s55
    s_and_b32 s66, s66, 3
    s_mov_b32 s58, 0x76453210
    s_mov_b32 s59, 0xfecdba89
    s_cmp_eq_u32 s66, 1
    s_cselect_b32 s58, 0x75643120, s58
    s_cselect_b32 s59, 0xfdecb9a8, s59
    s_cmp_eq_u32 s66, 2
    s_cselect_b32 s58, 0x67542310, s58
    s_cselect_b32 s59, 0xefdcab98, s59
    s_cmp_eq_u32 s66, 3
    s_cselect_b32 s58, 0x86534210, s58
    s_cselect_b32 s59, 0xfedbca97, s59
    s_and_b32 s66, s48, 15
    s_lshl_b32 s55, s66, 2
    s_lshr_b64 s[56:57], s[58:59], s55
    s_and_b32 s55, s56, 15
    s_lshl_b32 s55, s55, 2
    s_lshl_b64 s[56:57], 15, s55
    s_andn2_b64 s[58:59], s[58:59], s[56:57]
    s_or_b32 s58, s58, s66
    s_mov_b32 s32, s12
    s_mov_b32 s33, s13
    s_mov_b32 s34, 0x700000
    s_mov_b32 s35, 0x20000
    s_mov_b32 s36, s14
    s_mov_b32 s37, s15
    s_mov_b32 s38, 0x700000
    s_mov_b32 s39, 0x20000
    s_and_b32 s57, s58, 15
    s_lshr_b64 s[58:59], s[58:59], 4
    s_lshl_b32 s56, s57, 11
    s_mul_i32 s57, s57, 0x70000
    s_add_u32 m0, s53, 16384
    s_nop 0
    buffer_load_dwordx4 v212, s[32:35], s57 offen offset:0 lds
    buffer_load_dwordx4 v213, s[32:35], s57 offen offset:1024 lds
    s_waitcnt vmcnt(14)
    s_barrier
    buffer_load_dwordx4 v214, s[32:35], s57 offen offset:2048 lds
    buffer_load_dwordx4 v215, s[32:35], s57 offen offset:3072 lds
    s_add_u32 m0, s53, 32768
    s_nop 0
    buffer_load_dwordx4 v212, s[36:39], s57 offen offset:0 lds
    s_waitcnt vmcnt(11)
    s_barrier
    buffer_load_dwordx4 v213, s[36:39], s57 offen offset:1024 lds
    buffer_load_dwordx4 v214, s[36:39], s57 offen offset:2048 lds
    buffer_load_dwordx4 v215, s[36:39], s57 offen offset:3072 lds
    s_waitcnt vmcnt(8)
    s_barrier
    s_add_u32 s53, s53, 49152
    s_cmp_ge_u32 s53, s61
    s_cselect_b32 s53, s60, s53
    s_barrier
    s_setprio 2
    s_waitcnt vmcnt(0)
    s_barrier
    ds_read_b128 v[136:139], v232 offset:0
    ds_read_b64_tr_b16 v[152:153], v235 offset:0
    ds_read_b64_tr_b16 v[154:155], v235 offset:4096
    ds_read_b64_tr_b16 v[156:157], v236 offset:0
    ds_read_b64_tr_b16 v[158:159], v236 offset:4096
    ds_read_b64_tr_b16 v[160:161], v237 offset:0
    ds_read_b64_tr_b16 v[162:163], v237 offset:4096
    ds_read_b64_tr_b16 v[164:165], v238 offset:0
    ds_read_b64_tr_b16 v[166:167], v238 offset:4096
    ds_read_b64_tr_b16 v[168:169], v235 offset:16384
    ds_read_b64_tr_b16 v[170:171], v235 offset:20480
    ds_read_b64_tr_b16 v[172:173], v236 offset:16384
    ds_read_b64_tr_b16 v[174:175], v236 offset:20480
    ds_read_b64_tr_b16 v[176:177], v237 offset:16384
    ds_read_b64_tr_b16 v[178:179], v237 offset:20480
    ds_read_b64_tr_b16 v[180:181], v238 offset:16384
    ds_read_b64_tr_b16 v[182:183], v238 offset:20480
    ds_read_b128 v[140:143], v232 offset:2048
    ds_read_b128 v[144:147], v232 offset:4096
    ds_read_b128 v[148:151], v232 offset:6144
    s_add_u32 s52, s52, 49152
    s_cmp_ge_u32 s52, 147456
    s_cselect_b32 s52, 0, s52
    s_waitcnt lgkmcnt(0)
    v_mfma_f32_16x16x32_bf16 v[8:11], v[152:155], v[136:139], 0
    ds_read_b128 v[184:187], v232 offset:1024
    v_mfma_f32_16x16x32_bf16 v[12:15], v[156:159], v[136:139], 0
    ds_read_b64_tr_b16 v[200:201], v235 offset:8192
    v_mfma_f32_16x16x32_bf16 v[16:19], v[160:163], v[136:139], 0
    ds_read_b64_tr_b16 v[202:203], v235 offset:12288
    v_mfma_f32_16x16x32_bf16 v[20:23], v[164:167], v[136:139], 0
    ds_read_b64_tr_b16 v[204:205], v236 offset:8192
    v_mfma_f32_16x16x32_bf16 v[24:27], v[168:171], v[136:139], 0
    v_mfma_f32_16x16x32_bf16 v[28:31], v[172:175], v[136:139], 0
    ds_read_b64_tr_b16 v[206:207], v236 offset:12288
    v_mfma_f32_16x16x32_bf16 v[32:35], v[176:179], v[136:139], 0
    ds_read_b64_tr_b16 v[208:209], v237 offset:8192
    v_mfma_f32_16x16x32_bf16 v[36:39], v[180:183], v[136:139], 0
    ds_read_b64_tr_b16 v[210:211], v237 offset:12288
    v_mfma_f32_16x16x32_bf16 v[40:43], v[152:155], v[140:143], 0
    ds_read_b64_tr_b16 v[212:213], v238 offset:8192
    v_mfma_f32_16x16x32_bf16 v[44:47], v[156:159], v[140:143], 0
    v_mfma_f32_16x16x32_bf16 v[48:51], v[160:163], v[140:143], 0
    ds_read_b64_tr_b16 v[214:215], v238 offset:12288
    v_mfma_f32_16x16x32_bf16 v[52:55], v[164:167], v[140:143], 0
    ds_read_b64_tr_b16 v[216:217], v235 offset:24576
    v_mfma_f32_16x16x32_bf16 v[56:59], v[168:171], v[140:143], 0
    ds_read_b64_tr_b16 v[218:219], v235 offset:28672
    v_mfma_f32_16x16x32_bf16 v[60:63], v[172:175], v[140:143], 0
    ds_read_b64_tr_b16 v[220:221], v236 offset:24576
    v_mfma_f32_16x16x32_bf16 v[64:67], v[176:179], v[140:143], 0
    v_mfma_f32_16x16x32_bf16 v[68:71], v[180:183], v[140:143], 0
    ds_read_b64_tr_b16 v[222:223], v236 offset:28672
    v_mfma_f32_16x16x32_bf16 v[72:75], v[152:155], v[144:147], 0
    ds_read_b64_tr_b16 v[224:225], v237 offset:24576
    v_mfma_f32_16x16x32_bf16 v[76:79], v[156:159], v[144:147], 0
    ds_read_b64_tr_b16 v[226:227], v237 offset:28672
    v_mfma_f32_16x16x32_bf16 v[80:83], v[160:163], v[144:147], 0
    ds_read_b64_tr_b16 v[228:229], v238 offset:24576
    v_mfma_f32_16x16x32_bf16 v[84:87], v[164:167], v[144:147], 0
    v_mfma_f32_16x16x32_bf16 v[88:91], v[168:171], v[144:147], 0
    ds_read_b64_tr_b16 v[230:231], v238 offset:28672
    v_mfma_f32_16x16x32_bf16 v[92:95], v[172:175], v[144:147], 0
    ds_read_b128 v[188:191], v232 offset:3072
    v_mfma_f32_16x16x32_bf16 v[96:99], v[176:179], v[144:147], 0
    ds_read_b128 v[192:195], v232 offset:5120
    v_mfma_f32_16x16x32_bf16 v[100:103], v[180:183], v[144:147], 0
    ds_read_b128 v[196:199], v232 offset:7168
    v_mfma_f32_16x16x32_bf16 v[104:107], v[152:155], v[148:151], 0
    v_mfma_f32_16x16x32_bf16 v[108:111], v[156:159], v[148:151], 0
    v_add_u32 v232, s52, v233
    v_mfma_f32_16x16x32_bf16 v[112:115], v[160:163], v[148:151], 0
    v_add_u32 v235, s52, v239
    v_mfma_f32_16x16x32_bf16 v[116:119], v[164:167], v[148:151], 0
    v_add_u32 v236, s52, v240
    v_mfma_f32_16x16x32_bf16 v[120:123], v[168:171], v[148:151], 0
    v_mfma_f32_16x16x32_bf16 v[124:127], v[172:175], v[148:151], 0
    v_add_u32 v237, s52, v241
    v_mfma_f32_16x16x32_bf16 v[128:131], v[176:179], v[148:151], 0
    v_add_u32 v238, s52, v242
    v_mfma_f32_16x16x32_bf16 v[132:135], v[180:183], v[148:151], 0
    s_waitcnt lgkmcnt(0)
    v_mfma_f32_16x16x32_bf16 v[8:11], v[200:203], v[184:187], v[8:11]
    v_mfma_f32_16x16x32_bf16 v[12:15], v[204:207], v[184:187], v[12:15]
    v_mfma_f32_16x16x32_bf16 v[16:19], v[208:211], v[184:187], v[16:19]
    v_mfma_f32_16x16x32_bf16 v[20:23], v[212:215], v[184:187], v[20:23]
    v_mfma_f32_16x16x32_bf16 v[24:27], v[216:219], v[184:187], v[24:27]
    v_mfma_f32_16x16x32_bf16 v[28:31], v[220:223], v[184:187], v[28:31]
    v_mfma_f32_16x16x32_bf16 v[32:35], v[224:227], v[184:187], v[32:35]
    v_mfma_f32_16x16x32_bf16 v[36:39], v[228:231], v[184:187], v[36:39]
    v_mfma_f32_16x16x32_bf16 v[40:43], v[200:203], v[188:191], v[40:43]
    v_mfma_f32_16x16x32_bf16 v[44:47], v[204:207], v[188:191], v[44:47]
    v_mfma_f32_16x16x32_bf16 v[48:51], v[208:211], v[188:191], v[48:51]
    v_mfma_f32_16x16x32_bf16 v[52:55], v[212:215], v[188:191], v[52:55]
    v_mfma_f32_16x16x32_bf16 v[56:59], v[216:219], v[188:191], v[56:59]
    v_mfma_f32_16x16x32_bf16 v[60:63], v[220:223], v[188:191], v[60:63]
    v_mfma_f32_16x16x32_bf16 v[64:67], v[224:227], v[188:191], v[64:67]
    v_mfma_f32_16x16x32_bf16 v[68:71], v[228:231], v[188:191], v[68:71]
    v_mfma_f32_16x16x32_bf16 v[72:75], v[200:203], v[192:195], v[72:75]
    v_mfma_f32_16x16x32_bf16 v[76:79], v[204:207], v[192:195], v[76:79]
    v_mfma_f32_16x16x32_bf16 v[80:83], v[208:211], v[192:195], v[80:83]
    v_mfma_f32_16x16x32_bf16 v[84:87], v[212:215], v[192:195], v[84:87]
    v_mfma_f32_16x16x32_bf16 v[88:91], v[216:219], v[192:195], v[88:91]
    v_mfma_f32_16x16x32_bf16 v[92:95], v[220:223], v[192:195], v[92:95]
    v_mfma_f32_16x16x32_bf16 v[96:99], v[224:227], v[192:195], v[96:99]
    v_mfma_f32_16x16x32_bf16 v[100:103], v[228:231], v[192:195], v[100:103]
    v_mfma_f32_16x16x32_bf16 v[104:107], v[200:203], v[196:199], v[104:107]
    v_mfma_f32_16x16x32_bf16 v[108:111], v[204:207], v[196:199], v[108:111]
    v_mfma_f32_16x16x32_bf16 v[112:115], v[208:211], v[196:199], v[112:115]
    v_mfma_f32_16x16x32_bf16 v[116:119], v[212:215], v[196:199], v[116:119]
    v_mfma_f32_16x16x32_bf16 v[120:123], v[216:219], v[196:199], v[120:123]
    v_mfma_f32_16x16x32_bf16 v[124:127], v[220:223], v[196:199], v[124:127]
    v_mfma_f32_16x16x32_bf16 v[128:131], v[224:227], v[196:199], v[128:131]
    v_mfma_f32_16x16x32_bf16 v[132:135], v[228:231], v[196:199], v[132:135]
    s_barrier
    s_barrier
    ds_read_b128 v[136:139], v232 offset:0
    ds_read_b64_tr_b16 v[152:153], v235 offset:0
    ds_read_b64_tr_b16 v[154:155], v235 offset:4096
    ds_read_b64_tr_b16 v[156:157], v236 offset:0
    ds_read_b64_tr_b16 v[158:159], v236 offset:4096
    ds_read_b64_tr_b16 v[160:161], v237 offset:0
    ds_read_b64_tr_b16 v[162:163], v237 offset:4096
    ds_read_b64_tr_b16 v[164:165], v238 offset:0
    ds_read_b64_tr_b16 v[166:167], v238 offset:4096
    ds_read_b64_tr_b16 v[168:169], v235 offset:16384
    ds_read_b64_tr_b16 v[170:171], v235 offset:20480
    ds_read_b64_tr_b16 v[172:173], v236 offset:16384
    ds_read_b64_tr_b16 v[174:175], v236 offset:20480
    ds_read_b64_tr_b16 v[176:177], v237 offset:16384
    ds_read_b64_tr_b16 v[178:179], v237 offset:20480
    ds_read_b64_tr_b16 v[180:181], v238 offset:16384
    ds_read_b64_tr_b16 v[182:183], v238 offset:20480
    ds_read_b128 v[140:143], v232 offset:2048
    ds_read_b128 v[144:147], v232 offset:4096
    ds_read_b128 v[148:151], v232 offset:6144
    s_add_u32 s52, s52, 49152
    s_cmp_ge_u32 s52, 147456
    s_cselect_b32 s52, 0, s52
    s_waitcnt lgkmcnt(0)
    v_mfma_f32_16x16x32_bf16 v[8:11], v[152:155], v[136:139], v[8:11]
    ds_read_b128 v[184:187], v232 offset:1024
    v_mfma_f32_16x16x32_bf16 v[12:15], v[156:159], v[136:139], v[12:15]
    ds_read_b64_tr_b16 v[200:201], v235 offset:8192
    v_mfma_f32_16x16x32_bf16 v[16:19], v[160:163], v[136:139], v[16:19]
    ds_read_b64_tr_b16 v[202:203], v235 offset:12288
    v_mfma_f32_16x16x32_bf16 v[20:23], v[164:167], v[136:139], v[20:23]
    ds_read_b64_tr_b16 v[204:205], v236 offset:8192
    v_mfma_f32_16x16x32_bf16 v[24:27], v[168:171], v[136:139], v[24:27]
    v_mfma_f32_16x16x32_bf16 v[28:31], v[172:175], v[136:139], v[28:31]
    ds_read_b64_tr_b16 v[206:207], v236 offset:12288
    v_mfma_f32_16x16x32_bf16 v[32:35], v[176:179], v[136:139], v[32:35]
    ds_read_b64_tr_b16 v[208:209], v237 offset:8192
    v_mfma_f32_16x16x32_bf16 v[36:39], v[180:183], v[136:139], v[36:39]
    ds_read_b64_tr_b16 v[210:211], v237 offset:12288
    v_mfma_f32_16x16x32_bf16 v[40:43], v[152:155], v[140:143], v[40:43]
    ds_read_b64_tr_b16 v[212:213], v238 offset:8192
    v_mfma_f32_16x16x32_bf16 v[44:47], v[156:159], v[140:143], v[44:47]
    v_mfma_f32_16x16x32_bf16 v[48:51], v[160:163], v[140:143], v[48:51]
    ds_read_b64_tr_b16 v[214:215], v238 offset:12288
    v_mfma_f32_16x16x32_bf16 v[52:55], v[164:167], v[140:143], v[52:55]
    ds_read_b64_tr_b16 v[216:217], v235 offset:24576
    v_mfma_f32_16x16x32_bf16 v[56:59], v[168:171], v[140:143], v[56:59]
    ds_read_b64_tr_b16 v[218:219], v235 offset:28672
    v_mfma_f32_16x16x32_bf16 v[60:63], v[172:175], v[140:143], v[60:63]
    ds_read_b64_tr_b16 v[220:221], v236 offset:24576
    v_mfma_f32_16x16x32_bf16 v[64:67], v[176:179], v[140:143], v[64:67]
    v_mfma_f32_16x16x32_bf16 v[68:71], v[180:183], v[140:143], v[68:71]
    ds_read_b64_tr_b16 v[222:223], v236 offset:28672
    v_mfma_f32_16x16x32_bf16 v[72:75], v[152:155], v[144:147], v[72:75]
    s_movk_i32 s54, 13
M_P_loop4:
    ds_read_b64_tr_b16 v[224:225], v237 offset:24576
    v_mfma_f32_16x16x32_bf16 v[76:79], v[156:159], v[144:147], v[76:79]
    ds_read_b64_tr_b16 v[226:227], v237 offset:28672
    v_mfma_f32_16x16x32_bf16 v[80:83], v[160:163], v[144:147], v[80:83]
    ds_read_b64_tr_b16 v[228:229], v238 offset:24576
    v_mfma_f32_16x16x32_bf16 v[84:87], v[164:167], v[144:147], v[84:87]
    v_mfma_f32_16x16x32_bf16 v[88:91], v[168:171], v[144:147], v[88:91]
    ds_read_b64_tr_b16 v[230:231], v238 offset:28672
    v_mfma_f32_16x16x32_bf16 v[92:95], v[172:175], v[144:147], v[92:95]
    ds_read_b128 v[188:191], v232 offset:3072
    v_mfma_f32_16x16x32_bf16 v[96:99], v[176:179], v[144:147], v[96:99]
    ds_read_b128 v[192:195], v232 offset:5120
    v_mfma_f32_16x16x32_bf16 v[100:103], v[180:183], v[144:147], v[100:103]
    ds_read_b128 v[196:199], v232 offset:7168
    v_mfma_f32_16x16x32_bf16 v[104:107], v[152:155], v[148:151], v[104:107]
    v_mfma_f32_16x16x32_bf16 v[108:111], v[156:159], v[148:151], v[108:111]
    v_add_u32 v232, s52, v233
    v_mfma_f32_16x16x32_bf16 v[112:115], v[160:163], v[148:151], v[112:115]
    v_add_u32 v235, s52, v239
    v_mfma_f32_16x16x32_bf16 v[116:119], v[164:167], v[148:151], v[116:119]
    v_add_u32 v236, s52, v240
    v_mfma_f32_16x16x32_bf16 v[120:123], v[168:171], v[148:151], v[120:123]
    v_mfma_f32_16x16x32_bf16 v[124:127], v[172:175], v[148:151], v[124:127]
    v_add_u32 v237, s52, v241
    v_mfma_f32_16x16x32_bf16 v[128:131], v[176:179], v[148:151], v[128:131]
    v_add_u32 v238, s52, v242
    v_mfma_f32_16x16x32_bf16 v[132:135], v[180:183], v[148:151], v[132:135]
    s_waitcnt lgkmcnt(0)
    v_mfma_f32_16x16x32_bf16 v[8:11], v[200:203], v[184:187], v[8:11]
    s_barrier
    v_mfma_f32_16x16x32_bf16 v[12:15], v[204:207], v[184:187], v[12:15]
    ds_read_b128 v[136:139], v232 offset:0
    v_mfma_f32_16x16x32_bf16 v[16:19], v[208:211], v[184:187], v[16:19]
    ds_read_b64_tr_b16 v[152:153], v235 offset:0
    v_mfma_f32_16x16x32_bf16 v[20:23], v[212:215], v[184:187], v[20:23]
    ds_read_b64_tr_b16 v[154:155], v235 offset:4096
    v_mfma_f32_16x16x32_bf16 v[24:27], v[216:219], v[184:187], v[24:27]
    ds_read_b64_tr_b16 v[156:157], v236 offset:0
    v_mfma_f32_16x16x32_bf16 v[28:31], v[220:223], v[184:187], v[28:31]
    ds_read_b64_tr_b16 v[158:159], v236 offset:4096
    v_mfma_f32_16x16x32_bf16 v[32:35], v[224:227], v[184:187], v[32:35]
    v_mfma_f32_16x16x32_bf16 v[36:39], v[228:231], v[184:187], v[36:39]
    ds_read_b64_tr_b16 v[160:161], v237 offset:0
    v_mfma_f32_16x16x32_bf16 v[40:43], v[200:203], v[188:191], v[40:43]
    ds_read_b64_tr_b16 v[162:163], v237 offset:4096
    v_mfma_f32_16x16x32_bf16 v[44:47], v[204:207], v[188:191], v[44:47]
    ds_read_b64_tr_b16 v[164:165], v238 offset:0
    v_mfma_f32_16x16x32_bf16 v[48:51], v[208:211], v[188:191], v[48:51]
    ds_read_b64_tr_b16 v[166:167], v238 offset:4096
    v_mfma_f32_16x16x32_bf16 v[52:55], v[212:215], v[188:191], v[52:55]
    ds_read_b64_tr_b16 v[168:169], v235 offset:16384
    v_mfma_f32_16x16x32_bf16 v[56:59], v[216:219], v[188:191], v[56:59]
    v_mfma_f32_16x16x32_bf16 v[60:63], v[220:223], v[188:191], v[60:63]
    ds_read_b64_tr_b16 v[170:171], v235 offset:20480
    v_mfma_f32_16x16x32_bf16 v[64:67], v[224:227], v[188:191], v[64:67]
    ds_read_b64_tr_b16 v[172:173], v236 offset:16384
    v_mfma_f32_16x16x32_bf16 v[68:71], v[228:231], v[188:191], v[68:71]
    ds_read_b64_tr_b16 v[174:175], v236 offset:20480
    v_mfma_f32_16x16x32_bf16 v[72:75], v[200:203], v[192:195], v[72:75]
    ds_read_b64_tr_b16 v[176:177], v237 offset:16384
    v_mfma_f32_16x16x32_bf16 v[76:79], v[204:207], v[192:195], v[76:79]
    ds_read_b64_tr_b16 v[178:179], v237 offset:20480
    v_mfma_f32_16x16x32_bf16 v[80:83], v[208:211], v[192:195], v[80:83]
    v_mfma_f32_16x16x32_bf16 v[84:87], v[212:215], v[192:195], v[84:87]
    ds_read_b64_tr_b16 v[180:181], v238 offset:16384
    v_mfma_f32_16x16x32_bf16 v[88:91], v[216:219], v[192:195], v[88:91]
    ds_read_b64_tr_b16 v[182:183], v238 offset:20480
    v_mfma_f32_16x16x32_bf16 v[92:95], v[220:223], v[192:195], v[92:95]
    ds_read_b128 v[140:143], v232 offset:2048
    v_mfma_f32_16x16x32_bf16 v[96:99], v[224:227], v[192:195], v[96:99]
    ds_read_b128 v[144:147], v232 offset:4096
    v_mfma_f32_16x16x32_bf16 v[100:103], v[228:231], v[192:195], v[100:103]
    ds_read_b128 v[148:151], v232 offset:6144
    v_mfma_f32_16x16x32_bf16 v[104:107], v[200:203], v[196:199], v[104:107]
    v_mfma_f32_16x16x32_bf16 v[108:111], v[204:207], v[196:199], v[108:111]
    v_mfma_f32_16x16x32_bf16 v[112:115], v[208:211], v[196:199], v[112:115]
    v_mfma_f32_16x16x32_bf16 v[116:119], v[212:215], v[196:199], v[116:119]
    v_mfma_f32_16x16x32_bf16 v[120:123], v[216:219], v[196:199], v[120:123]
    v_mfma_f32_16x16x32_bf16 v[124:127], v[220:223], v[196:199], v[124:127]
    v_mfma_f32_16x16x32_bf16 v[128:131], v[224:227], v[196:199], v[128:131]
    s_add_u32 s52, s52, 49152
    s_cmp_ge_u32 s52, 147456
    s_cselect_b32 s52, 0, s52
    v_mfma_f32_16x16x32_bf16 v[132:135], v[228:231], v[196:199], v[132:135]
    s_waitcnt lgkmcnt(0)
    v_mfma_f32_16x16x32_bf16 v[8:11], v[152:155], v[136:139], v[8:11]
    ds_read_b128 v[184:187], v232 offset:1024
    v_mfma_f32_16x16x32_bf16 v[12:15], v[156:159], v[136:139], v[12:15]
    ds_read_b64_tr_b16 v[200:201], v235 offset:8192
    v_mfma_f32_16x16x32_bf16 v[16:19], v[160:163], v[136:139], v[16:19]
    ds_read_b64_tr_b16 v[202:203], v235 offset:12288
    v_mfma_f32_16x16x32_bf16 v[20:23], v[164:167], v[136:139], v[20:23]
    ds_read_b64_tr_b16 v[204:205], v236 offset:8192
    v_mfma_f32_16x16x32_bf16 v[24:27], v[168:171], v[136:139], v[24:27]
    v_mfma_f32_16x16x32_bf16 v[28:31], v[172:175], v[136:139], v[28:31]
    ds_read_b64_tr_b16 v[206:207], v236 offset:12288
    v_mfma_f32_16x16x32_bf16 v[32:35], v[176:179], v[136:139], v[32:35]
    ds_read_b64_tr_b16 v[208:209], v237 offset:8192
    v_mfma_f32_16x16x32_bf16 v[36:39], v[180:183], v[136:139], v[36:39]
    ds_read_b64_tr_b16 v[210:211], v237 offset:12288
    v_mfma_f32_16x16x32_bf16 v[40:43], v[152:155], v[140:143], v[40:43]
    ds_read_b64_tr_b16 v[212:213], v238 offset:8192
    v_mfma_f32_16x16x32_bf16 v[44:47], v[156:159], v[140:143], v[44:47]
    v_mfma_f32_16x16x32_bf16 v[48:51], v[160:163], v[140:143], v[48:51]
    ds_read_b64_tr_b16 v[214:215], v238 offset:12288
    v_mfma_f32_16x16x32_bf16 v[52:55], v[164:167], v[140:143], v[52:55]
    ds_read_b64_tr_b16 v[216:217], v235 offset:24576
    v_mfma_f32_16x16x32_bf16 v[56:59], v[168:171], v[140:143], v[56:59]
    ds_read_b64_tr_b16 v[218:219], v235 offset:28672
    v_mfma_f32_16x16x32_bf16 v[60:63], v[172:175], v[140:143], v[60:63]
    ds_read_b64_tr_b16 v[220:221], v236 offset:24576
    v_mfma_f32_16x16x32_bf16 v[64:67], v[176:179], v[140:143], v[64:67]
    v_mfma_f32_16x16x32_bf16 v[68:71], v[180:183], v[140:143], v[68:71]
    s_sub_u32 s54, s54, 1
    ds_read_b64_tr_b16 v[222:223], v236 offset:28672
    v_mfma_f32_16x16x32_bf16 v[72:75], v[152:155], v[144:147], v[72:75]
    s_cbranch_scc0 M_P_loop4
    ds_read_b64_tr_b16 v[224:225], v237 offset:24576
    v_mfma_f32_16x16x32_bf16 v[76:79], v[156:159], v[144:147], v[76:79]
    ds_read_b64_tr_b16 v[226:227], v237 offset:28672
    v_mfma_f32_16x16x32_bf16 v[80:83], v[160:163], v[144:147], v[80:83]
    ds_read_b64_tr_b16 v[228:229], v238 offset:24576
    v_mfma_f32_16x16x32_bf16 v[84:87], v[164:167], v[144:147], v[84:87]
    v_mfma_f32_16x16x32_bf16 v[88:91], v[168:171], v[144:147], v[88:91]
    ds_read_b64_tr_b16 v[230:231], v238 offset:28672
    v_mfma_f32_16x16x32_bf16 v[92:95], v[172:175], v[144:147], v[92:95]
    ds_read_b128 v[188:191], v232 offset:3072
    v_mfma_f32_16x16x32_bf16 v[96:99], v[176:179], v[144:147], v[96:99]
    ds_read_b128 v[192:195], v232 offset:5120
    v_mfma_f32_16x16x32_bf16 v[100:103], v[180:183], v[144:147], v[100:103]
    ds_read_b128 v[196:199], v232 offset:7168
    v_mfma_f32_16x16x32_bf16 v[104:107], v[152:155], v[148:151], v[104:107]
    v_mfma_f32_16x16x32_bf16 v[108:111], v[156:159], v[148:151], v[108:111]
    v_mfma_f32_16x16x32_bf16 v[112:115], v[160:163], v[148:151], v[112:115]
    v_mfma_f32_16x16x32_bf16 v[116:119], v[164:167], v[148:151], v[116:119]
    v_mfma_f32_16x16x32_bf16 v[120:123], v[168:171], v[148:151], v[120:123]
    v_mfma_f32_16x16x32_bf16 v[124:127], v[172:175], v[148:151], v[124:127]
    v_mfma_f32_16x16x32_bf16 v[128:131], v[176:179], v[148:151], v[128:131]
    v_mfma_f32_16x16x32_bf16 v[132:135], v[180:183], v[148:151], v[132:135]
    s_waitcnt lgkmcnt(0)
    v_mfma_f32_16x16x32_bf16 v[8:11], v[200:203], v[184:187], v[8:11]
    s_barrier
    v_mfma_f32_16x16x32_bf16 v[12:15], v[204:207], v[184:187], v[12:15]
    v_mfma_f32_16x16x32_bf16 v[16:19], v[208:211], v[184:187], v[16:19]
    v_mfma_f32_16x16x32_bf16 v[20:23], v[212:215], v[184:187], v[20:23]
    v_mfma_f32_16x16x32_bf16 v[24:27], v[216:219], v[184:187], v[24:27]
    v_mfma_f32_16x16x32_bf16 v[28:31], v[220:223], v[184:187], v[28:31]
    v_mfma_f32_16x16x32_bf16 v[32:35], v[224:227], v[184:187], v[32:35]
    v_mfma_f32_16x16x32_bf16 v[36:39], v[228:231], v[184:187], v[36:39]
    v_mfma_f32_16x16x32_bf16 v[40:43], v[200:203], v[188:191], v[40:43]
    v_mfma_f32_16x16x32_bf16 v[44:47], v[204:207], v[188:191], v[44:47]
    v_mfma_f32_16x16x32_bf16 v[48:51], v[208:211], v[188:191], v[48:51]
    v_mfma_f32_16x16x32_bf16 v[52:55], v[212:215], v[188:191], v[52:55]
    v_mfma_f32_16x16x32_bf16 v[56:59], v[216:219], v[188:191], v[56:59]
    v_mfma_f32_16x16x32_bf16 v[60:63], v[220:223], v[188:191], v[60:63]
    v_mfma_f32_16x16x32_bf16 v[64:67], v[224:227], v[188:191], v[64:67]
    v_mfma_f32_16x16x32_bf16 v[68:71], v[228:231], v[188:191], v[68:71]
    v_mfma_f32_16x16x32_bf16 v[72:75], v[200:203], v[192:195], v[72:75]
    v_mfma_f32_16x16x32_bf16 v[76:79], v[204:207], v[192:195], v[76:79]
    v_mfma_f32_16x16x32_bf16 v[80:83], v[208:211], v[192:195], v[80:83]
    v_mfma_f32_16x16x32_bf16 v[84:87], v[212:215], v[192:195], v[84:87]
    v_mfma_f32_16x16x32_bf16 v[88:91], v[216:219], v[192:195], v[88:91]
    v_mfma_f32_16x16x32_bf16 v[92:95], v[220:223], v[192:195], v[92:95]
    v_mfma_f32_16x16x32_bf16 v[96:99], v[224:227], v[192:195], v[96:99]
    v_mfma_f32_16x16x32_bf16 v[100:103], v[228:231], v[192:195], v[100:103]
    v_mfma_f32_16x16x32_bf16 v[104:107], v[200:203], v[196:199], v[104:107]
    v_mfma_f32_16x16x32_bf16 v[108:111], v[204:207], v[196:199], v[108:111]
    v_mfma_f32_16x16x32_bf16 v[112:115], v[208:211], v[196:199], v[112:115]
    v_mfma_f32_16x16x32_bf16 v[116:119], v[212:215], v[196:199], v[116:119]
    v_mfma_f32_16x16x32_bf16 v[120:123], v[216:219], v[196:199], v[120:123]
    v_mfma_f32_16x16x32_bf16 v[124:127], v[220:223], v[196:199], v[124:127]
    v_mfma_f32_16x16x32_bf16 v[128:131], v[224:227], v[196:199], v[128:131]
    v_mfma_f32_16x16x32_bf16 v[132:135], v[228:231], v[196:199], v[132:135]
    s_setprio 0
    s_cmp_lg_u32 s69, 0
    s_cbranch_scc1 M_Pidle
    s_lshl_b32 s64, s47, 3
    s_lshl_b32 s65, s44, 1
    s_add_u32 s64, s64, s65
    s_mul_i32 s64, s64, 32768
    s_add_u32 s64, s64, 0x1000000
    v_lshl_add_u32 v184, v1, 4, s64
    v_add_u32 v185, 30720, v184
    s_lshr_b32 s65, s48, 2
    s_sub_u32 s65, s48, s65
    s_add_u32 s65, s65, 16
    s_lshl_b32 s65, s65, 8
    s_or_b32 s65, s65, s69
    v_lshrrev_b32 v3, 4, v1
    s_lshl_b32 s64, s44, 4
    v_add_u32 v2, s64, v3
    s_movk_i32 s64, 7168
    v_mul_u32_u24 v2, s64, v2
    v_add_u32 v2, s65, v2
    v_lshlrev_b32 v3, 1, v3
    v_and_b32 v4, 15, v1
    v_xor_b32 v3, v3, v4
    v_lshl_add_u32 v188, v3, 4, v2
    v_add_u32 v190, 55296, v188
    v_xor_b32 v3, 8, v3
    v_lshl_add_u32 v189, v3, 4, v2
    v_add_u32 v189, 27648, v189
    v_add_u32 v191, 55296, v189
    s_lshl_b32 s60, s44, 12
    s_add_u32 s61, s60, 147456
    s_add_u32 s53, s60, 49152
    s_bfe_u32 s66, s2, 0x30003
    s_lshr_b32 s55, s2, 6
    s_add_u32 s66, s66, s55
    s_mul_i32 s55, s66, 11
    s_lshr_b32 s55, s55, 5
    s_mul_i32 s55, s55, 3
    s_sub_u32 s66, s66, s55
    s_mov_b32 s58, 0x9a867534
    s_mov_b32 s59, 0xfecdb
    s_cmp_eq_u32 s66, 1
    s_cselect_b32 s58, 0xb9786453, s58
    s_cselect_b32 s59, 0xfdeca, s59
    s_cmp_eq_u32 s66, 2
    s_cselect_b32 s58, 0xa8975642, s58
    s_cselect_b32 s59, 0xefdbc, s59
    s_mov_b32 s32, s12
    s_mov_b32 s33, s13
    s_mov_b32 s34, 0x700000
    s_mov_b32 s35, 0x20000
    s_mov_b32 s36, s14
    s_mov_b32 s37, s15
    s_mov_b32 s38, 0x700000
    s_mov_b32 s39, 0x20000
    s_lshl_b32 s70, s48, 12
    s_lshl_b32 s64, s47, 3
    s_lshl_b32 s65, s45, 2
    s_add_u32 s64, s64, s65
    s_mul_i32 s64, s64, 114688
    s_add_u32 s64, s64, s70
    s_lshl_b32 s65, s46, 11
    s_add_u32 s64, s64, s65
    s_add_u32 s64, s64, 0x1500000
    v_lshl_add_u32 v198, v1, 4, s64
    v_mul_f32 v24, v8, v24
    v_exp_f32 v216, -v8
    v_mul_f32 v25, v9, v25
    v_exp_f32 v217, -v9
    v_mul_f32 v26, v10, v26
    v_exp_f32 v218, -v10
    v_mul_f32 v27, v11, v27
    v_exp_f32 v219, -v11
    v_mul_f32 v28, v12, v28
    v_exp_f32 v220, -v12
    v_mul_f32 v29, v13, v29
    v_exp_f32 v221, -v13
    v_mul_f32 v30, v14, v30
    v_exp_f32 v222, -v14
    v_mul_f32 v31, v15, v31
    v_exp_f32 v223, -v15
    s_barrier
    s_and_b32 s57, s58, 15
    s_lshr_b64 s[58:59], s[58:59], 4
    s_lshl_b32 s56, s57, 11
    s_mul_i32 s57, s57, 0x70000
    s_add_u32 m0, s53, 16384
    s_nop 0
    buffer_load_dwordx4 v188, s[32:35], s57 offen offset:0 lds
    v_fma_f32 v216, v216, s67, s67
    v_fma_f32 v217, v217, s67, s67
    v_rcp_f32 v216, v216
    v_fma_f32 v218, v218, s67, s67
    buffer_load_dwordx4 v189, s[32:35], s57 offen offset:1024 lds
    v_rcp_f32 v217, v217
    v_fma_f32 v219, v219, s67, s67
    v_rcp_f32 v218, v218
    v_fma_f32 v220, v220, s67, s67
    buffer_load_dwordx4 v190, s[32:35], s57 offen offset:2048 lds
    v_rcp_f32 v219, v219
    v_fma_f32 v221, v221, s67, s67
    v_rcp_f32 v220, v220
    v_fma_f32 v222, v222, s67, s67
    buffer_load_dwordx4 v191, s[32:35], s57 offen offset:3072 lds
    v_rcp_f32 v221, v221
    v_fma_f32 v223, v223, s67, s67
    v_rcp_f32 v222, v222
    v_rcp_f32 v223, v223
    s_add_u32 m0, s53, 32768
    s_nop 0
    buffer_load_dwordx4 v188, s[36:39], s57 offen offset:0 lds
    v_mul_f32 v24, v24, v216
    v_mul_f32 v25, v25, v217
    v_mul_f32 v26, v26, v218
    v_mul_f32 v27, v27, v219
    buffer_load_dwordx4 v189, s[36:39], s57 offen offset:1024 lds
    v_mul_f32 v28, v28, v220
    v_mul_f32 v29, v29, v221
    v_mul_f32 v30, v30, v222
    v_mul_f32 v31, v31, v223
    buffer_load_dwordx4 v190, s[36:39], s57 offen offset:2048 lds
    v_cvt_pk_bf16_f32 v200, v24, v25
    v_cvt_pk_bf16_f32 v201, v26, v27
    v_cvt_pk_bf16_f32 v202, v28, v29
    v_cvt_pk_bf16_f32 v203, v30, v31
    buffer_load_dwordx4 v191, s[36:39], s57 offen offset:3072 lds
    v_mul_f32 v32, v16, v32
    v_exp_f32 v224, -v16
    v_mul_f32 v33, v17, v33
    s_mov_b32 m0, s53
    s_nop 0
    buffer_load_dwordx4 v184, s[28:31], s56 offen offset:0 sc1 lds
    v_exp_f32 v225, -v17
    v_mul_f32 v34, v18, v34
    v_exp_f32 v226, -v18
    v_mul_f32 v35, v19, v35
    buffer_load_dwordx4 v184, s[28:31], s56 offen offset:1024 sc1 lds
    v_exp_f32 v227, -v19
    v_mul_f32 v36, v20, v36
    v_exp_f32 v228, -v20
    v_mul_f32 v37, v21, v37
    buffer_load_dwordx4 v185, s[28:31], s56 offen offset:2048 sc1 lds
    v_exp_f32 v229, -v21
    v_mul_f32 v38, v22, v38
    v_exp_f32 v230, -v22
    v_mul_f32 v39, v23, v39
    buffer_load_dwordx4 v185, s[28:31], s56 offen offset:3072 sc1 lds
    v_exp_f32 v231, -v23
    v_fma_f32 v224, v224, s67, s67
    v_fma_f32 v225, v225, s67, s67
    v_rcp_f32 v224, v224
    s_add_u32 s53, s53, 49152
    s_cmp_ge_u32 s53, s61
    s_cselect_b32 s53, s60, s53
    buffer_store_dwordx4 v[200:203], v198, s[28:31], 0 offen offset:0 sc1
    s_barrier
    s_and_b32 s57, s58, 15
    s_lshr_b64 s[58:59], s[58:59], 4
    s_lshl_b32 s56, s57, 11
    s_mul_i32 s57, s57, 0x70000
    s_add_u32 m0, s53, 16384
    s_nop 0
    buffer_load_dwordx4 v188, s[32:35], s57 offen offset:0 lds
    v_fma_f32 v226, v226, s67, s67
    v_rcp_f32 v225, v225
    v_fma_f32 v227, v227, s67, s67
    v_rcp_f32 v226, v226
    buffer_load_dwordx4 v189, s[32:35], s57 offen offset:1024 lds
    v_fma_f32 v228, v228, s67, s67
    v_rcp_f32 v227, v227
    v_fma_f32 v229, v229, s67, s67
    v_rcp_f32 v228, v228
    buffer_load_dwordx4 v190, s[32:35], s57 offen offset:2048 lds
    v_fma_f32 v230, v230, s67, s67
    v_rcp_f32 v229, v229
    v_fma_f32 v231, v231, s67, s67
    v_rcp_f32 v230, v230
    buffer_load_dwordx4 v191, s[32:35], s57 offen offset:3072 lds
    v_rcp_f32 v231, v231
    v_mul_f32 v32, v32, v224
    v_mul_f32 v33, v33, v225
    v_mul_f32 v34, v34, v226
    s_add_u32 m0, s53, 32768
    s_nop 0
    buffer_load_dwordx4 v188, s[36:39], s57 offen offset:0 lds
    v_mul_f32 v35, v35, v227
    v_mul_f32 v36, v36, v228
    v_mul_f32 v37, v37, v229
    v_mul_f32 v38, v38, v230
    buffer_load_dwordx4 v189, s[36:39], s57 offen offset:1024 lds
    v_mul_f32 v39, v39, v231
    v_cvt_pk_bf16_f32 v204, v32, v33
    v_cvt_pk_bf16_f32 v205, v34, v35
    v_cvt_pk_bf16_f32 v206, v36, v37
    buffer_load_dwordx4 v190, s[36:39], s57 offen offset:2048 lds
    v_cvt_pk_bf16_f32 v207, v38, v39
    v_mul_f32 v56, v40, v56
    buffer_load_dwordx4 v191, s[36:39], s57 offen offset:3072 lds
    v_exp_f32 v216, -v40
    v_mul_f32 v57, v41, v57
    v_exp_f32 v217, -v41
    v_mul_f32 v58, v42, v58
    s_mov_b32 m0, s53
    s_nop 0
    buffer_load_dwordx4 v184, s[28:31], s56 offen offset:0 sc1 lds
    v_exp_f32 v218, -v42
    v_mul_f32 v59, v43, v59
    v_exp_f32 v219, -v43
    v_mul_f32 v60, v44, v60
    buffer_load_dwordx4 v184, s[28:31], s56 offen offset:1024 sc1 lds
    v_exp_f32 v220, -v44
    v_mul_f32 v61, v45, v61
    v_exp_f32 v221, -v45
    v_mul_f32 v62, v46, v62
    buffer_load_dwordx4 v185, s[28:31], s56 offen offset:2048 sc1 lds
    v_exp_f32 v222, -v46
    v_mul_f32 v63, v47, v63
    v_exp_f32 v223, -v47
    v_fma_f32 v216, v216, s67, s67
    buffer_load_dwordx4 v185, s[28:31], s56 offen offset:3072 sc1 lds
    v_fma_f32 v217, v217, s67, s67
    v_rcp_f32 v216, v216
    v_fma_f32 v218, v218, s67, s67
    v_rcp_f32 v217, v217
    s_add_u32 s53, s53, 49152
    s_cmp_ge_u32 s53, s61
    s_cselect_b32 s53, s60, s53
    buffer_store_dwordx4 v[204:207], v198, s[28:31], 0 offen offset:1024 sc1
    v_add_u32 v198, 114688, v198
    s_waitcnt vmcnt(14)
    s_barrier
    s_and_b32 s57, s58, 15
    s_lshr_b64 s[58:59], s[58:59], 4
    s_lshl_b32 s56, s57, 11
    s_mul_i32 s57, s57, 0x70000
    s_add_u32 m0, s53, 16384
    s_nop 0
    buffer_load_dwordx4 v188, s[32:35], s57 offen offset:0 lds
    v_fma_f32 v219, v219, s67, s67
    v_rcp_f32 v218, v218
    v_fma_f32 v220, v220, s67, s67
    v_rcp_f32 v219, v219
    buffer_load_dwordx4 v189, s[32:35], s57 offen offset:1024 lds
    v_fma_f32 v221, v221, s67, s67
    v_rcp_f32 v220, v220
    v_fma_f32 v222, v222, s67, s67
    v_rcp_f32 v221, v221
    buffer_load_dwordx4 v190, s[32:35], s57 offen offset:2048 lds
    v_fma_f32 v223, v223, s67, s67
    v_rcp_f32 v222, v222
    v_rcp_f32 v223, v223
    v_mul_f32 v56, v56, v216
    buffer_load_dwordx4 v191, s[32:35], s57 offen offset:3072 lds
    v_mul_f32 v57, v57, v217
    v_mul_f32 v58, v58, v218
    v_mul_f32 v59, v59, v219
    v_mul_f32 v60, v60, v220
    s_add_u32 m0, s53, 32768
    s_nop 0
    buffer_load_dwordx4 v188, s[36:39], s57 offen offset:0 lds
    v_mul_f32 v61, v61, v221
    v_mul_f32 v62, v62, v222
    v_mul_f32 v63, v63, v223
    v_cvt_pk_bf16_f32 v208, v56, v57
    buffer_load_dwordx4 v189, s[36:39], s57 offen offset:1024 lds
    v_cvt_pk_bf16_f32 v209, v58, v59
    v_cvt_pk_bf16_f32 v210, v60, v61
    v_cvt_pk_bf16_f32 v211, v62, v63
    buffer_load_dwordx4 v190, s[36:39], s57 offen offset:2048 lds
    v_mul_f32 v64, v48, v64
    v_exp_f32 v224, -v48
    v_mul_f32 v65, v49, v65
    v_exp_f32 v225, -v49
    buffer_load_dwordx4 v191, s[36:39], s57 offen offset:3072 lds
    v_mul_f32 v66, v50, v66
    v_exp_f32 v226, -v50
    v_mul_f32 v67, v51, v67
    v_exp_f32 v227, -v51
    s_mov_b32 m0, s53
    s_nop 0
    buffer_load_dwordx4 v184, s[28:31], s56 offen offset:0 sc1 lds
    v_mul_f32 v68, v52, v68
    v_exp_f32 v228, -v52
    v_mul_f32 v69, v53, v69
    v_exp_f32 v229, -v53
    buffer_load_dwordx4 v184, s[28:31], s56 offen offset:1024 sc1 lds
    v_mul_f32 v70, v54, v70
    v_exp_f32 v230, -v54
    v_mul_f32 v71, v55, v71
    v_exp_f32 v231, -v55
    buffer_load_dwordx4 v185, s[28:31], s56 offen offset:2048 sc1 lds
    v_fma_f32 v224, v224, s67, s67
    v_fma_f32 v225, v225, s67, s67
    v_rcp_f32 v224, v224
    v_fma_f32 v226, v226, s67, s67
    buffer_load_dwordx4 v185, s[28:31], s56 offen offset:3072 sc1 lds
    v_rcp_f32 v225, v225
    v_fma_f32 v227, v227, s67, s67
    v_rcp_f32 v226, v226
    v_fma_f32 v228, v228, s67, s67
    s_add_u32 s53, s53, 49152
    s_cmp_ge_u32 s53, s61
    s_cselect_b32 s53, s60, s53
    buffer_store_dwordx4 v[208:211], v198, s[28:31], 0 offen offset:0 sc1
    s_waitcnt vmcnt(14)
    s_barrier
    s_and_b32 s57, s58, 15
    s_lshr_b64 s[58:59], s[58:59], 4
    s_lshl_b32 s56, s57, 11
    s_mul_i32 s57, s57, 0x70000
    s_add_u32 m0, s53, 16384
    s_nop 0
    buffer_load_dwordx4 v188, s[32:35], s57 offen offset:0 lds
    v_rcp_f32 v227, v227
    v_fma_f32 v229, v229, s67, s67
    v_rcp_f32 v228, v228
    v_fma_f32 v230, v230, s67, s67
    buffer_load_dwordx4 v189, s[32:35], s57 offen offset:1024 lds
    v_rcp_f32 v229, v229
    v_fma_f32 v231, v231, s67, s67
    v_rcp_f32 v230, v230
    v_rcp_f32 v231, v231
    buffer_load_dwordx4 v190, s[32:35], s57 offen offset:2048 lds
    v_mul_f32 v64, v64, v224
    v_mul_f32 v65, v65, v225
    v_mul_f32 v66, v66, v226
    v_mul_f32 v67, v67, v227
    buffer_load_dwordx4 v191, s[32:35], s57 offen offset:3072 lds
    v_mul_f32 v68, v68, v228
    v_mul_f32 v69, v69, v229
    v_mul_f32 v70, v70, v230
    v_mul_f32 v71, v71, v231
    s_add_u32 m0, s53, 32768
    s_nop 0
    buffer_load_dwordx4 v188, s[36:39], s57 offen offset:0 lds
    v_cvt_pk_bf16_f32 v212, v64, v65
    v_cvt_pk_bf16_f32 v213, v66, v67
    v_cvt_pk_bf16_f32 v214, v68, v69
    v_cvt_pk_bf16_f32 v215, v70, v71
    buffer_load_dwordx4 v189, s[36:39], s57 offen offset:1024 lds
    v_mul_f32 v88, v72, v88
    v_exp_f32 v216, -v72
    buffer_load_dwordx4 v190, s[36:39], s57 offen offset:2048 lds
    v_mul_f32 v89, v73, v89
    v_exp_f32 v217, -v73
    v_mul_f32 v90, v74, v90
    v_exp_f32 v218, -v74
    buffer_load_dwordx4 v191, s[36:39], s57 offen offset:3072 lds
    v_mul_f32 v91, v75, v91
    v_exp_f32 v219, -v75
    v_mul_f32 v92, v76, v92
    v_exp_f32 v220, -v76
    s_mov_b32 m0, s53
    s_nop 0
    buffer_load_dwordx4 v184, s[28:31], s56 offen offset:0 sc1 lds
    v_mul_f32 v93, v77, v93
    v_exp_f32 v221, -v77
    v_mul_f32 v94, v78, v94
    v_exp_f32 v222, -v78
    buffer_load_dwordx4 v184, s[28:31], s56 offen offset:1024 sc1 lds
    v_mul_f32 v95, v79, v95
    v_exp_f32 v223, -v79
    v_fma_f32 v216, v216, s67, s67
    v_fma_f32 v217, v217, s67, s67
    buffer_load_dwordx4 v185, s[28:31], s56 offen offset:2048 sc1 lds
    v_rcp_f32 v216, v216
    v_fma_f32 v218, v218, s67, s67
    v_rcp_f32 v217, v217
    v_fma_f32 v219, v219, s67, s67
    buffer_load_dwordx4 v185, s[28:31], s56 offen offset:3072 sc1 lds
    v_rcp_f32 v218, v218
    v_fma_f32 v220, v220, s67, s67
    v_rcp_f32 v219, v219
    v_fma_f32 v221, v221, s67, s67
    s_add_u32 s53, s53, 49152
    s_cmp_ge_u32 s53, s61
    s_cselect_b32 s53, s60, s53
    buffer_store_dwordx4 v[212:215], v198, s[28:31], 0 offen offset:1024 sc1
    v_add_u32 v198, 114688, v198
    s_waitcnt vmcnt(14)
    s_barrier
    s_and_b32 s57, s58, 15
    s_lshr_b64 s[58:59], s[58:59], 4
    s_lshl_b32 s56, s57, 11
    s_mul_i32 s57, s57, 0x70000
    s_add_u32 m0, s53, 16384
    s_nop 0
    buffer_load_dwordx4 v188, s[32:35], s57 offen offset:0 lds
    v_rcp_f32 v220, v220
    v_fma_f32 v222, v222, s67, s67
    v_rcp_f32 v221, v221
    v_fma_f32 v223, v223, s67, s67
    buffer_load_dwordx4 v189, s[32:35], s57 offen offset:1024 lds
    v_rcp_f32 v222, v222
    v_rcp_f32 v223, v223
    v_mul_f32 v88, v88, v216
    v_mul_f32 v89, v89, v217
    buffer_load_dwordx4 v190, s[32:35], s57 offen offset:2048 lds
    v_mul_f32 v90, v90, v218
    v_mul_f32 v91, v91, v219
    v_mul_f32 v92, v92, v220
    v_mul_f32 v93, v93, v221
    buffer_load_dwordx4 v191, s[32:35], s57 offen offset:3072 lds
    v_mul_f32 v94, v94, v222
    v_mul_f32 v95, v95, v223
    v_cvt_pk_bf16_f32 v200, v88, v89
    v_cvt_pk_bf16_f32 v201, v90, v91
    s_add_u32 m0, s53, 32768
    s_nop 0
    buffer_load_dwordx4 v188, s[36:39], s57 offen offset:0 lds
    v_cvt_pk_bf16_f32 v202, v92, v93
    v_cvt_pk_bf16_f32 v203, v94, v95
    v_mul_f32 v96, v80, v96
    buffer_load_dwordx4 v189, s[36:39], s57 offen offset:1024 lds
    v_exp_f32 v224, -v80
    v_mul_f32 v97, v81, v97
    v_exp_f32 v225, -v81
    v_mul_f32 v98, v82, v98
    buffer_load_dwordx4 v190, s[36:39], s57 offen offset:2048 lds
    v_exp_f32 v226, -v82
    v_mul_f32 v99, v83, v99
    v_exp_f32 v227, -v83
    v_mul_f32 v100, v84, v100
    buffer_load_dwordx4 v191, s[36:39], s57 offen offset:3072 lds
    v_exp_f32 v228, -v84
    v_mul_f32 v101, v85, v101
    v_exp_f32 v229, -v85
    v_mul_f32 v102, v86, v102
    s_mov_b32 m0, s53
    s_nop 0
    buffer_load_dwordx4 v184, s[28:31], s56 offen offset:0 sc1 lds
    v_exp_f32 v230, -v86
    v_mul_f32 v103, v87, v103
    v_exp_f32 v231, -v87
    v_fma_f32 v224, v224, s67, s67
    buffer_load_dwordx4 v184, s[28:31], s56 offen offset:1024 sc1 lds
    v_fma_f32 v225, v225, s67, s67
    v_rcp_f32 v224, v224
    v_fma_f32 v226, v226, s67, s67
    v_rcp_f32 v225, v225
    buffer_load_dwordx4 v185, s[28:31], s56 offen offset:2048 sc1 lds
    v_fma_f32 v227, v227, s67, s67
    v_rcp_f32 v226, v226
    v_fma_f32 v228, v228, s67, s67
    v_rcp_f32 v227, v227
    buffer_load_dwordx4 v185, s[28:31], s56 offen offset:3072 sc1 lds
    v_fma_f32 v229, v229, s67, s67
    v_rcp_f32 v228, v228
    v_fma_f32 v230, v230, s67, s67
    v_rcp_f32 v229, v229
    s_add_u32 s53, s53, 49152
    s_cmp_ge_u32 s53, s61
    s_cselect_b32 s53, s60, s53
    buffer_store_dwordx4 v[200:203], v198, s[28:31], 0 offen offset:0 sc1
    s_waitcnt vmcnt(14)
    s_barrier
    s_and_b32 s57, s58, 15
    s_lshr_b64 s[58:59], s[58:59], 4
    s_lshl_b32 s56, s57, 11
    s_mul_i32 s57, s57, 0x70000
    s_add_u32 m0, s53, 16384
    s_nop 0
    buffer_load_dwordx4 v188, s[32:35], s57 offen offset:0 lds
    v_fma_f32 v231, v231, s67, s67
    v_rcp_f32 v230, v230
    v_rcp_f32 v231, v231
    v_mul_f32 v96, v96, v224
    buffer_load_dwordx4 v189, s[32:35], s57 offen offset:1024 lds
    v_mul_f32 v97, v97, v225
    v_mul_f32 v98, v98, v226
    v_mul_f32 v99, v99, v227
    v_mul_f32 v100, v100, v228
    buffer_load_dwordx4 v190, s[32:35], s57 offen offset:2048 lds
    v_mul_f32 v101, v101, v229
    v_mul_f32 v102, v102, v230
    v_mul_f32 v103, v103, v231
    v_cvt_pk_bf16_f32 v204, v96, v97
    buffer_load_dwordx4 v191, s[32:35], s57 offen offset:3072 lds
    v_cvt_pk_bf16_f32 v205, v98, v99
    v_cvt_pk_bf16_f32 v206, v100, v101
    v_cvt_pk_bf16_f32 v207, v102, v103
    s_add_u32 m0, s53, 32768
    s_nop 0
    buffer_load_dwordx4 v188, s[36:39], s57 offen offset:0 lds
    v_mul_f32 v120, v104, v120
    v_exp_f32 v216, -v104
    v_mul_f32 v121, v105, v121
    buffer_load_dwordx4 v189, s[36:39], s57 offen offset:1024 lds
    v_exp_f32 v217, -v105
    v_mul_f32 v122, v106, v122
    v_exp_f32 v218, -v106
    v_mul_f32 v123, v107, v123
    buffer_load_dwordx4 v190, s[36:39], s57 offen offset:2048 lds
    v_exp_f32 v219, -v107
    v_mul_f32 v124, v108, v124
    v_exp_f32 v220, -v108
    v_mul_f32 v125, v109, v125
    buffer_load_dwordx4 v191, s[36:39], s57 offen offset:3072 lds
    v_exp_f32 v221, -v109
    v_mul_f32 v126, v110, v126
    v_exp_f32 v222, -v110
    v_mul_f32 v127, v111, v127
    s_mov_b32 m0, s53
    s_nop 0
    buffer_load_dwordx4 v184, s[28:31], s56 offen offset:0 sc1 lds
    v_exp_f32 v223, -v111
    v_fma_f32 v216, v216, s67, s67
    v_fma_f32 v217, v217, s67, s67
    v_rcp_f32 v216, v216
    buffer_load_dwordx4 v184, s[28:31], s56 offen offset:1024 sc1 lds
    v_fma_f32 v218, v218, s67, s67
    v_rcp_f32 v217, v217
    v_fma_f32 v219, v219, s67, s67
    v_rcp_f32 v218, v218
    buffer_load_dwordx4 v185, s[28:31], s56 offen offset:2048 sc1 lds
    v_fma_f32 v220, v220, s67, s67
    v_rcp_f32 v219, v219
    v_fma_f32 v221, v221, s67, s67
    v_rcp_f32 v220, v220
    buffer_load_dwordx4 v185, s[28:31], s56 offen offset:3072 sc1 lds
    v_fma_f32 v222, v222, s67, s67
    v_rcp_f32 v221, v221
    v_fma_f32 v223, v223, s67, s67
    v_rcp_f32 v222, v222
    s_add_u32 s53, s53, 49152
    s_cmp_ge_u32 s53, s61
    s_cselect_b32 s53, s60, s53
    buffer_store_dwordx4 v[204:207], v198, s[28:31], 0 offen offset:1024 sc1
    v_add_u32 v198, 114688, v198
    s_waitcnt vmcnt(14)
    s_barrier
    s_and_b32 s57, s58, 15
    s_lshr_b64 s[58:59], s[58:59], 4
    s_lshl_b32 s56, s57, 11
    s_mul_i32 s57, s57, 0x70000
    s_add_u32 m0, s53, 16384
    s_nop 0
    buffer_load_dwordx4 v188, s[32:35], s57 offen offset:0 lds
    v_rcp_f32 v223, v223
    v_mul_f32 v120, v120, v216
    v_mul_f32 v121, v121, v217
    v_mul_f32 v122, v122, v218
    buffer_load_dwordx4 v189, s[32:35], s57 offen offset:1024 lds
    v_mul_f32 v123, v123, v219
    v_mul_f32 v124, v124, v220
    v_mul_f32 v125, v125, v221
    v_mul_f32 v126, v126, v222
    buffer_load_dwordx4 v190, s[32:35], s57 offen offset:2048 lds
    v_mul_f32 v127, v127, v223
    v_cvt_pk_bf16_f32 v208, v120, v121
    v_cvt_pk_bf16_f32 v209, v122, v123
    v_cvt_pk_bf16_f32 v210, v124, v125
    buffer_load_dwordx4 v191, s[32:35], s57 offen offset:3072 lds
    v_cvt_pk_bf16_f32 v211, v126, v127
    v_mul_f32 v128, v112, v128
    v_exp_f32 v224, -v112
    s_add_u32 m0, s53, 32768
    s_nop 0
    buffer_load_dwordx4 v188, s[36:39], s57 offen offset:0 lds
    v_mul_f32 v129, v113, v129
    v_exp_f32 v225, -v113
    v_mul_f32 v130, v114, v130
    v_exp_f32 v226, -v114
    buffer_load_dwordx4 v189, s[36:39], s57 offen offset:1024 lds
    v_mul_f32 v131, v115, v131
    v_exp_f32 v227, -v115
    v_mul_f32 v132, v116, v132
    v_exp_f32 v228, -v116
    buffer_load_dwordx4 v190, s[36:39], s57 offen offset:2048 lds
    v_mul_f32 v133, v117, v133
    v_exp_f32 v229, -v117
    v_mul_f32 v134, v118, v134
    v_exp_f32 v230, -v118
    buffer_load_dwordx4 v191, s[36:39], s57 offen offset:3072 lds
    v_mul_f32 v135, v119, v135
    v_exp_f32 v231, -v119
    v_fma_f32 v224, v224, s67, s67
    v_fma_f32 v225, v225, s67, s67
    s_mov_b32 m0, s53
    s_nop 0
    buffer_load_dwordx4 v184, s[28:31], s56 offen offset:0 sc1 lds
    v_rcp_f32 v224, v224
    v_fma_f32 v226, v226, s67, s67
    v_rcp_f32 v225, v225
    v_fma_f32 v227, v227, s67, s67
    buffer_load_dwordx4 v184, s[28:31], s56 offen offset:1024 sc1 lds
    v_rcp_f32 v226, v226
    v_fma_f32 v228, v228, s67, s67
    v_rcp_f32 v227, v227
    v_fma_f32 v229, v229, s67, s67
    buffer_load_dwordx4 v185, s[28:31], s56 offen offset:2048 sc1 lds
    v_rcp_f32 v228, v228
    v_fma_f32 v230, v230, s67, s67
    v_rcp_f32 v229, v229
    v_fma_f32 v231, v231, s67, s67
    buffer_load_dwordx4 v185, s[28:31], s56 offen offset:3072 sc1 lds
    v_rcp_f32 v230, v230
    v_rcp_f32 v231, v231
    v_mul_f32 v128, v128, v224
    v_mul_f32 v129, v129, v225
    s_add_u32 s53, s53, 49152
    s_cmp_ge_u32 s53, s61
    s_cselect_b32 s53, s60, s53
    buffer_store_dwordx4 v[208:211], v198, s[28:31], 0 offen offset:0 sc1
    s_waitcnt vmcnt(14)
    s_barrier
    s_and_b32 s57, s58, 15
    s_lshr_b64 s[58:59], s[58:59], 4
    s_lshl_b32 s56, s57, 11
    s_mul_i32 s57, s57, 0x70000
    s_add_u32 m0, s53, 16384
    s_nop 0
    buffer_load_dwordx4 v188, s[32:35], s57 offen offset:0 lds
    v_mul_f32 v130, v130, v226
    v_mul_f32 v131, v131, v227
    v_mul_f32 v132, v132, v228
    v_mul_f32 v133, v133, v229
    buffer_load_dwordx4 v189, s[32:35], s57 offen offset:1024 lds
    v_mul_f32 v134, v134, v230
    v_mul_f32 v135, v135, v231
    v_cvt_pk_bf16_f32 v212, v128, v129
    v_cvt_pk_bf16_f32 v213, v130, v131
    buffer_load_dwordx4 v190, s[32:35], s57 offen offset:2048 lds
    v_cvt_pk_bf16_f32 v214, v132, v133
    v_cvt_pk_bf16_f32 v215, v134, v135
    buffer_load_dwordx4 v191, s[32:35], s57 offen offset:3072 lds
    s_add_u32 m0, s53, 32768
    s_nop 0
    buffer_load_dwordx4 v188, s[36:39], s57 offen offset:0 lds
    buffer_load_dwordx4 v189, s[36:39], s57 offen offset:1024 lds
    buffer_load_dwordx4 v190, s[36:39], s57 offen offset:2048 lds
    buffer_load_dwordx4 v191, s[36:39], s57 offen offset:3072 lds
    s_mov_b32 m0, s53
    s_nop 0
    buffer_load_dwordx4 v184, s[28:31], s56 offen offset:0 sc1 lds
    buffer_load_dwordx4 v184, s[28:31], s56 offen offset:1024 sc1 lds
    buffer_load_dwordx4 v185, s[28:31], s56 offen offset:2048 sc1 lds
    buffer_load_dwordx4 v185, s[28:31], s56 offen offset:3072 sc1 lds
    s_add_u32 s53, s53, 49152
    s_cmp_ge_u32 s53, s61
    s_cselect_b32 s53, s60, s53
    buffer_store_dwordx4 v[212:215], v198, s[28:31], 0 offen offset:1024 sc1
    s_waitcnt vmcnt(14)
    s_barrier
    s_and_b32 s57, s58, 15
    s_lshr_b64 s[58:59], s[58:59], 4
    s_lshl_b32 s56, s57, 11
    s_mul_i32 s57, s57, 0x70000
    s_add_u32 m0, s53, 16384
    s_nop 0
    buffer_load_dwordx4 v188, s[32:35], s57 offen offset:0 lds
    buffer_load_dwordx4 v189, s[32:35], s57 offen offset:1024 lds
    buffer_load_dwordx4 v190, s[32:35], s57 offen offset:2048 lds
    buffer_load_dwordx4 v191, s[32:35], s57 offen offset:3072 lds
    s_add_u32 m0, s53, 32768
    s_nop 0
    buffer_load_dwordx4 v188, s[36:39], s57 offen offset:0 lds
    buffer_load_dwordx4 v189, s[36:39], s57 offen offset:1024 lds
    buffer_load_dwordx4 v190, s[36:39], s57 offen offset:2048 lds
    buffer_load_dwordx4 v191, s[36:39], s57 offen offset:3072 lds
    s_mov_b32 m0, s53
    s_nop 0
    buffer_load_dwordx4 v184, s[28:31], s56 offen offset:0 sc1 lds
    buffer_load_dwordx4 v184, s[28:31], s56 offen offset:1024 sc1 lds
    buffer_load_dwordx4 v185, s[28:31], s56 offen offset:2048 sc1 lds
    buffer_load_dwordx4 v185, s[28:31], s56 offen offset:3072 sc1 lds
    s_add_u32 s53, s53, 49152
    s_cmp_ge_u32 s53, s61
    s_cselect_b32 s53, s60, s53
    s_lshl_b32 s64, s47, 9
    s_lshl_b32 s65, s49, 7
    s_add_u32 s64, s64, s65
    s_lshl_b32 s65, s51, 4
    s_add_u32 s64, s64, s65
    s_lshl_b32 s65, s44, 2
    s_add_u32 s64, s64, s65
    s_add_u32 s64, s64, 0x50000
    v_mov_b32 v2, s0
    s_waitcnt vmcnt(12)
    s_mov_b64 exec, 1
    buffer_store_dword v2, v234, s[28:31], s64 offen sc1
    s_mov_b64 exec, -1
    s_lshl_b32 s65, s44, 1
    s_xor_b32 s65, s65, s49
    s_lshl_b32 s64, s47, 3
    s_add_u32 s64, s64, s65
    s_mul_i32 s64, s64, 114688
    s_add_u32 s64, s64, 0x1500000
    v_lshl_add_u32 v192, v1, 4, s64
    s_lshl_b32 s65, s44, 1
    s_or_b32 s65, s65, 1
    s_xor_b32 s65, s65, s49
    s_lshl_b32 s64, s47, 3
    s_add_u32 s64, s64, s65
    s_mul_i32 s64, s64, 114688
    s_add_u32 s64, s64, 0x14ff800
    v_lshl_add_u32 v193, v1, 4, s64
    s_lshl_b32 s65, s51, 9
    v_lshrrev_b32 v3, 4, v1
    s_lshl_b32 s64, s44, 4
    v_add_u32 v2, s64, v3
    s_movk_i32 s64, 2048
    v_mul_u32_u24 v2, s64, v2
    v_add_u32 v2, s65, v2
    v_lshlrev_b32 v3, 1, v3
    v_and_b32 v4, 15, v1
    v_xor_b32 v3, v3, v4
    v_lshl_add_u32 v194, v3, 4, v2
    v_add_u32 v196, 14336, v194
    v_xor_b32 v3, 8, v3
    v_lshl_add_u32 v195, v3, 4, v2
    v_add_u32 v195, 7168, v195
    v_add_u32 v197, 14336, v195
    s_barrier
    s_and_b32 s57, s58, 15
    s_lshr_b64 s[58:59], s[58:59], 4
    s_lshl_b32 s56, s57, 11
    s_mul_i32 s57, s57, 0x70000
    s_add_u32 m0, s53, 16384
    s_nop 0
    buffer_load_dwordx4 v188, s[32:35], s57 offen offset:0 lds
    buffer_load_dwordx4 v189, s[32:35], s57 offen offset:1024 lds
    buffer_load_dwordx4 v190, s[32:35], s57 offen offset:2048 lds
    buffer_load_dwordx4 v191, s[32:35], s57 offen offset:3072 lds
    s_add_u32 m0, s53, 32768
    s_nop 0
    buffer_load_dwordx4 v188, s[36:39], s57 offen offset:0 lds
    buffer_load_dwordx4 v189, s[36:39], s57 offen offset:1024 lds
    buffer_load_dwordx4 v190, s[36:39], s57 offen offset:2048 lds
    buffer_load_dwordx4 v191, s[36:39], s57 offen offset:3072 lds
    s_mov_b32 m0, s53
    s_nop 0
    buffer_load_dwordx4 v184, s[28:31], s56 offen offset:0 sc1 lds
    buffer_load_dwordx4 v184, s[28:31], s56 offen offset:1024 sc1 lds
    buffer_load_dwordx4 v185, s[28:31], s56 offen offset:2048 sc1 lds
    buffer_load_dwordx4 v185, s[28:31], s56 offen offset:3072 sc1 lds
    s_add_u32 s53, s53, 49152
    s_cmp_ge_u32 s53, s61
    s_cselect_b32 s53, s60, s53
    s_waitcnt vmcnt(13)
    s_barrier
    s_and_b32 s57, s58, 15
    s_lshr_b64 s[58:59], s[58:59], 4
    s_lshl_b32 s56, s57, 11
    s_mul_i32 s57, s57, 0x70000
    s_add_u32 m0, s53, 16384
    s_nop 0
    buffer_load_dwordx4 v188, s[32:35], s57 offen offset:0 lds
    buffer_load_dwordx4 v189, s[32:35], s57 offen offset:1024 lds
    buffer_load_dwordx4 v190, s[32:35], s57 offen offset:2048 lds
    buffer_load_dwordx4 v191, s[32:35], s57 offen offset:3072 lds
    s_add_u32 m0, s53, 32768
    s_nop 0
    buffer_load_dwordx4 v188, s[36:39], s57 offen offset:0 lds
    buffer_load_dwordx4 v189, s[36:39], s57 offen offset:1024 lds
    buffer_load_dwordx4 v190, s[36:39], s57 offen offset:2048 lds
    buffer_load_dwordx4 v191, s[36:39], s57 offen offset:3072 lds
    s_mov_b32 m0, s53
    s_nop 0
    buffer_load_dwordx4 v184, s[28:31], s56 offen offset:0 sc1 lds
    buffer_load_dwordx4 v184, s[28:31], s56 offen offset:1024 sc1 lds
    buffer_load_dwordx4 v185, s[28:31], s56 offen offset:2048 sc1 lds
    buffer_load_dwordx4 v185, s[28:31], s56 offen offset:3072 sc1 lds
    s_add_u32 s53, s53, 49152
    s_cmp_ge_u32 s53, s61
    s_cselect_b32 s53, s60, s53
    s_waitcnt vmcnt(12)
    s_barrier
    s_and_b32 s57, s58, 15
    s_lshr_b64 s[58:59], s[58:59], 4
    s_lshl_b32 s56, s57, 11
    s_mul_i32 s57, s57, 0x70000
    s_add_u32 m0, s53, 16384
    s_nop 0
    buffer_load_dwordx4 v188, s[32:35], s57 offen offset:0 lds
    buffer_load_dwordx4 v189, s[32:35], s57 offen offset:1024 lds
    buffer_load_dwordx4 v190, s[32:35], s57 offen offset:2048 lds
    buffer_load_dwordx4 v191, s[32:35], s57 offen offset:3072 lds
    s_add_u32 m0, s53, 32768
    s_nop 0
    buffer_load_dwordx4 v188, s[36:39], s57 offen offset:0 lds
    buffer_load_dwordx4 v189, s[36:39], s57 offen offset:1024 lds
    buffer_load_dwordx4 v190, s[36:39], s57 offen offset:2048 lds
    buffer_load_dwordx4 v191, s[36:39], s57 offen offset:3072 lds
    s_mov_b32 m0, s53
    s_nop 0
    buffer_load_dwordx4 v184, s[28:31], s56 offen offset:0 sc1 lds
    buffer_load_dwordx4 v184, s[28:31], s56 offen offset:1024 sc1 lds
    buffer_load_dwordx4 v185, s[28:31], s56 offen offset:2048 sc1 lds
    buffer_load_dwordx4 v185, s[28:31], s56 offen offset:3072 sc1 lds
    s_add_u32 s53, s53, 49152
    s_cmp_ge_u32 s53, s61
    s_cselect_b32 s53, s60, s53
    s_waitcnt vmcnt(12)
    s_barrier
    s_lshl_b32 s68, s47, 2
    s_add_u32 s68, s68, s49
    s_lshl_b32 s68, s68, 7
    s_add_u32 s68, s68, 0x50000
    v_min_u32 v234, 60, v234
    buffer_load_dword v245, v234, s[28:31], s68 offen sc1
    s_and_b32 s57, s58, 15
    s_lshr_b64 s[58:59], s[58:59], 4
    s_lshl_b32 s56, s57, 11
    s_mul_i32 s57, s57, 0x70000
    s_add_u32 m0, s53, 16384
    s_nop 0
    buffer_load_dwordx4 v188, s[32:35], s57 offen offset:0 lds
    buffer_load_dwordx4 v189, s[32:35], s57 offen offset:1024 lds
    buffer_load_dwordx4 v190, s[32:35], s57 offen offset:2048 lds
    buffer_load_dwordx4 v191, s[32:35], s57 offen offset:3072 lds
    s_add_u32 m0, s53, 32768
    s_nop 0
    buffer_load_dwordx4 v188, s[36:39], s57 offen offset:0 lds
    buffer_load_dwordx4 v189, s[36:39], s57 offen offset:1024 lds
    buffer_load_dwordx4 v190, s[36:39], s57 offen offset:2048 lds
    buffer_load_dwordx4 v191, s[36:39], s57 offen offset:3072 lds
    s_mov_b32 m0, s53
    s_nop 0
    buffer_load_dwordx4 v184, s[28:31], s56 offen offset:0 sc1 lds
    buffer_load_dwordx4 v184, s[28:31], s56 offen offset:1024 sc1 lds
    buffer_load_dwordx4 v185, s[28:31], s56 offen offset:2048 sc1 lds
    buffer_load_dwordx4 v185, s[28:31], s56 offen offset:3072 sc1 lds
    s_add_u32 s53, s53, 49152
    s_cmp_ge_u32 s53, s61
    s_cselect_b32 s53, s60, s53
    s_waitcnt vmcnt(13)
    s_barrier
M_Pjoin:
    s_waitcnt vmcnt(12)
    s_mov_b32 s3, 0x40000
M_pa_chk:
    v_cmp_ne_u32 vcc, s0, v245
    s_nop 4
    s_cbranch_vccz M_pa_ok
    s_sub_u32 s3, s3, 1
    s_cbranch_scc1 M_pa_ok
    s_sleep 4
    s_cmp_eq_u32 s69, 0
    s_cbranch_scc1 M_pa_rl
    s_sleep 48
M_pa_rl:
    buffer_load_dword v245, v234, s[28:31], s68 offen sc1
    s_waitcnt vmcnt(0)
    s_branch M_pa_chk
M_pa_ok:
    s_lshl_b32 s60, s44, 12
    s_add_u32 s61, s60, 147456
    s_add_u32 s53, s60, 98304
    s_bfe_u32 s66, s2, 0x30003
    s_lshr_b32 s55, s2, 6
    s_add_u32 s66, s66, s55
    s_and_b32 s66, s66, 3
    s_mov_b32 s58, 0x76453201
    s_mov_b32 s59, 0x542310
    s_cmp_eq_u32 s66, 1
    s_cselect_b32 s58, 0x75643120, s58
    s_cselect_b32 s59, 0x534201, s59
    s_cmp_eq_u32 s66, 2
    s_cselect_b32 s58, 0x67542310, s58
    s_cselect_b32 s59, 0x453210, s59
    s_cmp_eq_u32 s66, 3
    s_cselect_b32 s58, 0x76534210, s58
    s_cselect_b32 s59, 0x543201, s59
    s_lshl_b32 s55, s49, 3
    s_mov_b32 s32, s16
    s_mov_b32 s33, s17
    s_mov_b32 s34, 0x700000
    s_mov_b32 s35, 0x20000
    s_add_u32 s36, s16, 0x100
    s_addc_u32 s37, s17, 0
    s_mov_b32 s38, 0x6fff00
    s_mov_b32 s39, 0x20000
    s_and_b32 s57, s58, 15
    s_lshr_b64 s[58:59], s[58:59], 4
    s_add_u32 s57, s57, s55
    s_lshl_b32 s56, s57, 11
    s_mul_i32 s57, s57, 0x20000
    s_add_u32 m0, s53, 16384
    s_nop 0
    buffer_load_dwordx4 v194, s[32:35], s57 offen offset:0 lds
    buffer_load_dwordx4 v195, s[32:35], s57 offen offset:1024 lds
    buffer_load_dwordx4 v196, s[32:35], s57 offen offset:2048 lds
    buffer_load_dwordx4 v197, s[32:35], s57 offen offset:3072 lds
    s_add_u32 m0, s53, 32768
    s_nop 0
    buffer_load_dwordx4 v194, s[36:39], s57 offen offset:0 lds
    buffer_load_dwordx4 v195, s[36:39], s57 offen offset:1024 lds
    buffer_load_dwordx4 v196, s[36:39], s57 offen offset:2048 lds
    buffer_load_dwordx4 v197, s[36:39], s57 offen offset:3072 lds
    s_mov_b32 m0, s53
    s_nop 0
    buffer_load_dwordx4 v192, s[28:31], s56 offen offset:0 sc1 lds
    buffer_load_dwordx4 v192, s[28:31], s56 offen offset:1024 sc1 lds
    buffer_load_dwordx4 v193, s[28:31], s56 offen offset:2048 sc1 lds
    buffer_load_dwordx4 v193, s[28:31], s56 offen offset:3072 sc1 lds
    s_add_u32 s53, s53, 49152
    s_cmp_ge_u32 s53, s61
    s_cselect_b32 s53, s60, s53
    s_lshl_b32 s70, s47, 1
    s_add_u32 s70, s70, s45
    s_lshl_b32 s70, s70, 2
    s_add_u32 s70, s70, s49
    s_lshl_b32 s71, s51, 2
    s_add_u32 s71, s71, s46
    s_lshl_b32 s64, s70, 15
    s_lshl_b32 s65, s71, 7
    s_add_u32 s64, s64, s65
    v_and_b32 v2, 15, v1
    v_lshl_add_u32 v2, v2, 11, s64
    v_bfe_u32 v3, v1, 4, 1
    v_lshl_add_u32 v2, v3, 5, v2
    v_lshrrev_b32 v3, 5, v1
    v_lshl_add_u32 v246, v3, 4, v2
    s_mul_i32 s64, s70, 32768
    s_lshl_b32 s65, s71, 11
    s_add_u32 s64, s64, s65
    s_add_u32 s64, s64, 0xb00000
    v_lshl_add_u32 v248, v1, 4, s64
    s_lshl_b32 s64, s47, 12
    s_lshl_b32 s65, s71, 8
    s_add_u32 s64, s64, s65
    s_add_u32 s64, s64, 0xc0000
    v_and_b32 v2, 48, v1
    v_add_u32 v247, s64, v2
    v_lshlrev_b32 v249, 4, v1
    s_xor_b32 s64, s48, 0
    s_lshl_b32 s65, s47, 4
    s_add_u32 s64, s64, s65
    s_lshl_b32 s64, s64, 2
    s_add_u32 s64, s64, s44
    s_lshl_b32 s72, s64, 12
    s_lshl_b32 s76, s64, 9
    s_add_u32 s76, s76, 0x3000000
    s_xor_b32 s64, s48, 4
    s_lshl_b32 s65, s47, 4
    s_add_u32 s64, s64, s65
    s_lshl_b32 s64, s64, 2
    s_add_u32 s64, s64, s44
    s_lshl_b32 s73, s64, 12
    s_add_u32 s73, s73, 0x2400000
    s_lshl_b32 s77, s64, 9
    s_add_u32 s77, s77, 0x3000000
    s_xor_b32 s64, s48, 8
    s_lshl_b32 s65, s47, 4
    s_add_u32 s64, s64, s65
    s_lshl_b32 s64, s64, 2
    s_add_u32 s64, s64, s44
    s_lshl_b32 s74, s64, 12
    s_add_u32 s74, s74, 0x2800000
    s_lshl_b32 s78, s64, 9
    s_add_u32 s78, s78, 0x3000080
    s_xor_b32 s64, s48, 12
    s_lshl_b32 s65, s47, 4
    s_add_u32 s64, s64, s65
    s_lshl_b32 s64, s64, 2
    s_add_u32 s64, s64, s44
    s_lshl_b32 s75, s64, 12
    s_add_u32 s75, s75, 0x2c00000
    s_lshl_b32 s79, s64, 9
    s_add_u32 s79, s79, 0x3000100
    s_add_u32 s80, s72, 0x2400000
    s_add_u32 s81, s72, 0x2800000
    s_add_u32 s82, s72, 0x2c00000
    s_movk_i32 s83, 4096
    s_add_u32 s62, s26, s76
    s_addc_u32 s63, s27, 0
    s_load_dword s99, s[62:63], 0 glc
    s_load_dword s99, s[62:63], 128 glc
    s_load_dword s99, s[62:63], 256 glc
    s_mov_b32 s52, 98304
    s_waitcnt vmcnt(12)
    s_barrier
    s_and_b32 s57, s58, 15
    s_lshr_b64 s[58:59], s[58:59], 4
    s_add_u32 s57, s57, s55
    s_lshl_b32 s56, s57, 11
    s_mul_i32 s57, s57, 0x20000
    s_add_u32 m0, s53, 16384
    s_nop 0
    buffer_load_dwordx4 v194, s[32:35], s57 offen offset:0 lds
    buffer_load_dwordx4 v195, s[32:35], s57 offen offset:1024 lds
    buffer_load_dwordx4 v196, s[32:35], s57 offen offset:2048 lds
    buffer_load_dwordx4 v197, s[32:35], s57 offen offset:3072 lds
    s_add_u32 m0, s53, 32768
    s_nop 0
    buffer_load_dwordx4 v194, s[36:39], s57 offen offset:0 lds
    buffer_load_dwordx4 v195, s[36:39], s57 offen offset:1024 lds
    buffer_load_dwordx4 v196, s[36:39], s57 offen offset:2048 lds
    buffer_load_dwordx4 v197, s[36:39], s57 offen offset:3072 lds
    s_mov_b32 m0, s53
    s_nop 0
    buffer_load_dwordx4 v192, s[28:31], s56 offen offset:0 sc1 lds
    buffer_load_dwordx4 v192, s[28:31], s56 offen offset:1024 sc1 lds
    buffer_load_dwordx4 v193, s[28:31], s56 offen offset:2048 sc1 lds
    buffer_load_dwordx4 v193, s[28:31], s56 offen offset:3072 sc1 lds
    s_add_u32 s53, s53, 49152
    s_cmp_ge_u32 s53, s61
    s_cselect_b32 s53, s60, s53
    v_add_u32 v232, s52, v233
    v_add_u32 v235, s52, v239
    v_add_u32 v236, s52, v240
    v_add_u32 v237, s52, v241
    v_add_u32 v238, s52, v242
    s_mov_b32 s40, s22
    s_mov_b32 s41, s23
    s_mov_b32 s42, 0x400000
    s_mov_b32 s43, 0x20000
    s_waitcnt vmcnt(12)
    s_barrier
    ds_read_b128 v[140:143], v232 offset:2048
    ds_read_b64_tr_b16 v[152:153], v235 offset:0
    ds_read_b64_tr_b16 v[154:155], v235 offset:4096
    ds_read_b64_tr_b16 v[156:157], v236 offset:0
    ds_read_b64_tr_b16 v[158:159], v236 offset:4096
    ds_read_b64_tr_b16 v[160:161], v237 offset:0
    ds_read_b64_tr_b16 v[162:163], v237 offset:4096
    ds_read_b64_tr_b16 v[164:165], v238 offset:0
    ds_read_b64_tr_b16 v[166:167], v238 offset:4096
    ds_read_b64_tr_b16 v[168:169], v235 offset:16384
    ds_read_b64_tr_b16 v[170:171], v235 offset:20480
    ds_read_b64_tr_b16 v[172:173], v236 offset:16384
    ds_read_b64_tr_b16 v[174:175], v236 offset:20480
    ds_read_b64_tr_b16 v[176:177], v237 offset:16384
    ds_read_b64_tr_b16 v[178:179], v237 offset:20480
    ds_read_b64_tr_b16 v[180:181], v238 offset:16384
    ds_read_b64_tr_b16 v[182:183], v238 offset:20480
    ds_read_b128 v[144:147], v232 offset:4096
    ds_read_b128 v[148:151], v232 offset:6144
    ds_read_b128 v[136:139], v232 offset:0
    s_and_b32 s57, s58, 15
    s_lshr_b64 s[58:59], s[58:59], 4
    s_add_u32 s57, s57, s55
    s_lshl_b32 s56, s57, 11
    s_mul_i32 s57, s57, 0x20000
    s_add_u32 m0, s53, 16384
    s_nop 0
    buffer_load_dwordx4 v194, s[32:35], s57 offen offset:0 lds
    buffer_load_dwordx4 v195, s[32:35], s57 offen offset:1024 lds
    buffer_load_dwordx4 v196, s[32:35], s57 offen offset:2048 lds
    buffer_load_dwordx4 v197, s[32:35], s57 offen offset:3072 lds
    s_add_u32 m0, s53, 32768
    s_nop 0
    buffer_load_dwordx4 v194, s[36:39], s57 offen offset:0 lds
    buffer_load_dwordx4 v195, s[36:39], s57 offen offset:1024 lds
    buffer_load_dwordx4 v196, s[36:39], s57 offen offset:2048 lds
    buffer_load_dwordx4 v197, s[36:39], s57 offen offset:3072 lds
    s_mov_b32 m0, s53
    s_nop 0
    buffer_load_dwordx4 v192, s[28:31], s56 offen offset:0 sc1 lds
    buffer_load_dwordx4 v192, s[28:31], s56 offen offset:1024 sc1 lds
    buffer_load_dwordx4 v193, s[28:31], s56 offen offset:2048 sc1 lds
    buffer_load_dwordx4 v193, s[28:31], s56 offen offset:3072 sc1 lds
    s_add_u32 s53, s53, 49152
    s_cmp_ge_u32 s53, s61
    s_cselect_b32 s53, s60, s53
    s_setprio 2
    s_add_u32 s52, s52, 49152
    s_cmp_ge_u32 s52, 147456
    s_cselect_b32 s52, 0, s52
    s_waitcnt lgkmcnt(0)
    v_mfma_f32_16x16x32_bf16 v[40:43], v[152:155], v[140:143], 0
    ds_read_b128 v[188:191], v232 offset:3072
    v_mfma_f32_16x16x32_bf16 v[44:47], v[156:159], v[140:143], 0
    ds_read_b64_tr_b16 v[200:201], v235 offset:8192
    v_mfma_f32_16x16x32_bf16 v[48:51], v[160:163], v[140:143], 0
    ds_read_b64_tr_b16 v[202:203], v235 offset:12288
    v_mfma_f32_16x16x32_bf16 v[52:55], v[164:167], v[140:143], 0
    ds_read_b64_tr_b16 v[204:205], v236 offset:8192
    v_mfma_f32_16x16x32_bf16 v[56:59], v[168:171], v[140:143], 0
    v_mfma_f32_16x16x32_bf16 v[60:63], v[172:175], v[140:143], 0
    ds_read_b64_tr_b16 v[206:207], v236 offset:12288
    v_mfma_f32_16x16x32_bf16 v[64:67], v[176:179], v[140:143], 0
    ds_read_b64_tr_b16 v[208:209], v237 offset:8192
    v_mfma_f32_16x16x32_bf16 v[68:71], v[180:183], v[140:143], 0
    ds_read_b64_tr_b16 v[210:211], v237 offset:12288
    v_mfma_f32_16x16x32_bf16 v[72:75], v[152:155], v[144:147], 0
    ds_read_b64_tr_b16 v[212:213], v238 offset:8192
    v_mfma_f32_16x16x32_bf16 v[76:79], v[156:159], v[144:147], 0
    v_mfma_f32_16x16x32_bf16 v[80:83], v[160:163], v[144:147], 0
    ds_read_b64_tr_b16 v[214:215], v238 offset:12288
    v_mfma_f32_16x16x32_bf16 v[84:87], v[164:167], v[144:147], 0
    ds_read_b64_tr_b16 v[216:217], v235 offset:24576
    v_mfma_f32_16x16x32_bf16 v[88:91], v[168:171], v[144:147], 0
    ds_read_b64_tr_b16 v[218:219], v235 offset:28672
    v_mfma_f32_16x16x32_bf16 v[92:95], v[172:175], v[144:147], 0
    ds_read_b64_tr_b16 v[220:221], v236 offset:24576
    v_mfma_f32_16x16x32_bf16 v[96:99], v[176:179], v[144:147], 0
    v_mfma_f32_16x16x32_bf16 v[100:103], v[180:183], v[144:147], 0
    ds_read_b64_tr_b16 v[222:223], v236 offset:28672
    v_mfma_f32_16x16x32_bf16 v[104:107], v[152:155], v[148:151], 0
    ds_read_b64_tr_b16 v[224:225], v237 offset:24576
    v_mfma_f32_16x16x32_bf16 v[108:111], v[156:159], v[148:151], 0
    ds_read_b64_tr_b16 v[226:227], v237 offset:28672
    v_mfma_f32_16x16x32_bf16 v[112:115], v[160:163], v[148:151], 0
    ds_read_b64_tr_b16 v[228:229], v238 offset:24576
    v_mfma_f32_16x16x32_bf16 v[116:119], v[164:167], v[148:151], 0
    v_mfma_f32_16x16x32_bf16 v[120:123], v[168:171], v[148:151], 0
    ds_read_b64_tr_b16 v[230:231], v238 offset:28672
    v_mfma_f32_16x16x32_bf16 v[124:127], v[172:175], v[148:151], 0
    ds_read_b128 v[192:195], v232 offset:5120
    v_mfma_f32_16x16x32_bf16 v[128:131], v[176:179], v[148:151], 0
    ds_read_b128 v[196:199], v232 offset:7168
    v_mfma_f32_16x16x32_bf16 v[132:135], v[180:183], v[148:151], 0
    ds_read_b128 v[184:187], v232 offset:1024
    v_mfma_f32_16x16x32_bf16 v[8:11], v[152:155], v[136:139], 0
    v_mfma_f32_16x16x32_bf16 v[12:15], v[156:159], v[136:139], 0
    v_add_u32 v232, s52, v233
    v_mfma_f32_16x16x32_bf16 v[16:19], v[160:163], v[136:139], 0
    v_add_u32 v235, s52, v239
    v_mfma_f32_16x16x32_bf16 v[20:23], v[164:167], v[136:139], 0
    v_add_u32 v236, s52, v240
    v_mfma_f32_16x16x32_bf16 v[24:27], v[168:171], v[136:139], 0
    v_mfma_f32_16x16x32_bf16 v[28:31], v[172:175], v[136:139], 0
    v_add_u32 v237, s52, v241
    v_mfma_f32_16x16x32_bf16 v[32:35], v[176:179], v[136:139], 0
    v_add_u32 v238, s52, v242
    v_mfma_f32_16x16x32_bf16 v[36:39], v[180:183], v[136:139], 0
    s_waitcnt lgkmcnt(0)
    v_mfma_f32_16x16x32_bf16 v[40:43], v[200:203], v[188:191], v[40:43]
    s_waitcnt vmcnt(12)
    s_barrier
    v_mfma_f32_16x16x32_bf16 v[44:47], v[204:207], v[188:191], v[44:47]
    ds_read_b128 v[140:143], v232 offset:2048
    v_mfma_f32_16x16x32_bf16 v[48:51], v[208:211], v[188:191], v[48:51]
    ds_read_b64_tr_b16 v[152:153], v235 offset:0
    v_mfma_f32_16x16x32_bf16 v[52:55], v[212:215], v[188:191], v[52:55]
    ds_read_b64_tr_b16 v[154:155], v235 offset:4096
    v_mfma_f32_16x16x32_bf16 v[56:59], v[216:219], v[188:191], v[56:59]
    ds_read_b64_tr_b16 v[156:157], v236 offset:0
    v_mfma_f32_16x16x32_bf16 v[60:63], v[220:223], v[188:191], v[60:63]
    ds_read_b64_tr_b16 v[158:159], v236 offset:4096
    v_mfma_f32_16x16x32_bf16 v[64:67], v[224:227], v[188:191], v[64:67]
    v_mfma_f32_16x16x32_bf16 v[68:71], v[228:231], v[188:191], v[68:71]
    ds_read_b64_tr_b16 v[160:161], v237 offset:0
    v_mfma_f32_16x16x32_bf16 v[72:75], v[200:203], v[192:195], v[72:75]
    ds_read_b64_tr_b16 v[162:163], v237 offset:4096
    v_mfma_f32_16x16x32_bf16 v[76:79], v[204:207], v[192:195], v[76:79]
    ds_read_b64_tr_b16 v[164:165], v238 offset:0
    v_mfma_f32_16x16x32_bf16 v[80:83], v[208:211], v[192:195], v[80:83]
    ds_read_b64_tr_b16 v[166:167], v238 offset:4096
    v_mfma_f32_16x16x32_bf16 v[84:87], v[212:215], v[192:195], v[84:87]
    ds_read_b64_tr_b16 v[168:169], v235 offset:16384
    v_mfma_f32_16x16x32_bf16 v[88:91], v[216:219], v[192:195], v[88:91]
    v_mfma_f32_16x16x32_bf16 v[92:95], v[220:223], v[192:195], v[92:95]
    ds_read_b64_tr_b16 v[170:171], v235 offset:20480
    v_mfma_f32_16x16x32_bf16 v[96:99], v[224:227], v[192:195], v[96:99]
    ds_read_b64_tr_b16 v[172:173], v236 offset:16384
    v_mfma_f32_16x16x32_bf16 v[100:103], v[228:231], v[192:195], v[100:103]
    ds_read_b64_tr_b16 v[174:175], v236 offset:20480
    v_mfma_f32_16x16x32_bf16 v[104:107], v[200:203], v[196:199], v[104:107]
    ds_read_b64_tr_b16 v[176:177], v237 offset:16384
    v_mfma_f32_16x16x32_bf16 v[108:111], v[204:207], v[196:199], v[108:111]
    ds_read_b64_tr_b16 v[178:179], v237 offset:20480
    v_mfma_f32_16x16x32_bf16 v[112:115], v[208:211], v[196:199], v[112:115]
    v_mfma_f32_16x16x32_bf16 v[116:119], v[212:215], v[196:199], v[116:119]
    ds_read_b64_tr_b16 v[180:181], v238 offset:16384
    v_mfma_f32_16x16x32_bf16 v[120:123], v[216:219], v[196:199], v[120:123]
    ds_read_b64_tr_b16 v[182:183], v238 offset:20480
    v_mfma_f32_16x16x32_bf16 v[124:127], v[220:223], v[196:199], v[124:127]
    ds_read_b128 v[144:147], v232 offset:4096
    v_mfma_f32_16x16x32_bf16 v[128:131], v[224:227], v[196:199], v[128:131]
    ds_read_b128 v[148:151], v232 offset:6144
    v_mfma_f32_16x16x32_bf16 v[132:135], v[228:231], v[196:199], v[132:135]
    ds_read_b128 v[136:139], v232 offset:0
    v_mfma_f32_16x16x32_bf16 v[8:11], v[200:203], v[184:187], v[8:11]
    v_mfma_f32_16x16x32_bf16 v[12:15], v[204:207], v[184:187], v[12:15]
    v_mfma_f32_16x16x32_bf16 v[16:19], v[208:211], v[184:187], v[16:19]
    v_mfma_f32_16x16x32_bf16 v[20:23], v[212:215], v[184:187], v[20:23]
    v_mfma_f32_16x16x32_bf16 v[24:27], v[216:219], v[184:187], v[24:27]
    v_mfma_f32_16x16x32_bf16 v[28:31], v[220:223], v[184:187], v[28:31]
    v_mfma_f32_16x16x32_bf16 v[32:35], v[224:227], v[184:187], v[32:35]
    s_add_u32 s52, s52, 49152
    s_cmp_ge_u32 s52, 147456
    s_cselect_b32 s52, 0, s52
    v_mfma_f32_16x16x32_bf16 v[36:39], v[228:231], v[184:187], v[36:39]
    s_waitcnt lgkmcnt(0)
    v_mfma_f32_16x16x32_bf16 v[40:43], v[152:155], v[140:143], v[40:43]
    ds_read_b128 v[188:191], v232 offset:3072
    v_mfma_f32_16x16x32_bf16 v[44:47], v[156:159], v[140:143], v[44:47]
    ds_read_b64_tr_b16 v[200:201], v235 offset:8192
    v_mfma_f32_16x16x32_bf16 v[48:51], v[160:163], v[140:143], v[48:51]
    ds_read_b64_tr_b16 v[202:203], v235 offset:12288
    v_mfma_f32_16x16x32_bf16 v[52:55], v[164:167], v[140:143], v[52:55]
    ds_read_b64_tr_b16 v[204:205], v236 offset:8192
    v_mfma_f32_16x16x32_bf16 v[56:59], v[168:171], v[140:143], v[56:59]
    v_mfma_f32_16x16x32_bf16 v[60:63], v[172:175], v[140:143], v[60:63]
    ds_read_b64_tr_b16 v[206:207], v236 offset:12288
    v_mfma_f32_16x16x32_bf16 v[64:67], v[176:179], v[140:143], v[64:67]
    ds_read_b64_tr_b16 v[208:209], v237 offset:8192
    v_mfma_f32_16x16x32_bf16 v[68:71], v[180:183], v[140:143], v[68:71]
    ds_read_b64_tr_b16 v[210:211], v237 offset:12288
    v_mfma_f32_16x16x32_bf16 v[72:75], v[152:155], v[144:147], v[72:75]
    ds_read_b64_tr_b16 v[212:213], v238 offset:8192
    v_mfma_f32_16x16x32_bf16 v[76:79], v[156:159], v[144:147], v[76:79]
    v_mfma_f32_16x16x32_bf16 v[80:83], v[160:163], v[144:147], v[80:83]
    ds_read_b64_tr_b16 v[214:215], v238 offset:12288
    v_mfma_f32_16x16x32_bf16 v[84:87], v[164:167], v[144:147], v[84:87]
    ds_read_b64_tr_b16 v[216:217], v235 offset:24576
    v_mfma_f32_16x16x32_bf16 v[88:91], v[168:171], v[144:147], v[88:91]
    ds_read_b64_tr_b16 v[218:219], v235 offset:28672
    v_mfma_f32_16x16x32_bf16 v[92:95], v[172:175], v[144:147], v[92:95]
    ds_read_b64_tr_b16 v[220:221], v236 offset:24576
    v_mfma_f32_16x16x32_bf16 v[96:99], v[176:179], v[144:147], v[96:99]
    v_mfma_f32_16x16x32_bf16 v[100:103], v[180:183], v[144:147], v[100:103]
    ds_read_b64_tr_b16 v[222:223], v236 offset:28672
    v_mfma_f32_16x16x32_bf16 v[104:107], v[152:155], v[148:151], v[104:107]
    ds_read_b64_tr_b16 v[224:225], v237 offset:24576
    v_mfma_f32_16x16x32_bf16 v[108:111], v[156:159], v[148:151], v[108:111]
    ds_read_b64_tr_b16 v[226:227], v237 offset:28672
    v_mfma_f32_16x16x32_bf16 v[112:115], v[160:163], v[148:151], v[112:115]
    ds_read_b64_tr_b16 v[228:229], v238 offset:24576
    v_mfma_f32_16x16x32_bf16 v[116:119], v[164:167], v[148:151], v[116:119]
    v_mfma_f32_16x16x32_bf16 v[120:123], v[168:171], v[148:151], v[120:123]
    ds_read_b64_tr_b16 v[230:231], v238 offset:28672
    v_mfma_f32_16x16x32_bf16 v[124:127], v[172:175], v[148:151], v[124:127]
    ds_read_b128 v[192:195], v232 offset:5120
    v_mfma_f32_16x16x32_bf16 v[128:131], v[176:179], v[148:151], v[128:131]
    ds_read_b128 v[196:199], v232 offset:7168
    v_mfma_f32_16x16x32_bf16 v[132:135], v[180:183], v[148:151], v[132:135]
    ds_read_b128 v[184:187], v232 offset:1024
    v_mfma_f32_16x16x32_bf16 v[8:11], v[152:155], v[136:139], v[8:11]
    v_mfma_f32_16x16x32_bf16 v[12:15], v[156:159], v[136:139], v[12:15]
    v_add_u32 v232, s52, v233
    v_mfma_f32_16x16x32_bf16 v[16:19], v[160:163], v[136:139], v[16:19]
    v_add_u32 v235, s52, v239
    v_mfma_f32_16x16x32_bf16 v[20:23], v[164:167], v[136:139], v[20:23]
    v_add_u32 v236, s52, v240
    v_mfma_f32_16x16x32_bf16 v[24:27], v[168:171], v[136:139], v[24:27]
    v_mfma_f32_16x16x32_bf16 v[28:31], v[172:175], v[136:139], v[28:31]
    v_add_u32 v237, s52, v241
    v_mfma_f32_16x16x32_bf16 v[32:35], v[176:179], v[136:139], v[32:35]
    v_add_u32 v238, s52, v242
    v_mfma_f32_16x16x32_bf16 v[36:39], v[180:183], v[136:139], v[36:39]
    s_waitcnt lgkmcnt(0)
    v_mfma_f32_16x16x32_bf16 v[40:43], v[200:203], v[188:191], v[40:43]
    s_waitcnt vmcnt(0)
    s_barrier
    v_mfma_f32_16x16x32_bf16 v[44:47], v[204:207], v[188:191], v[44:47]
    ds_read_b128 v[140:143], v232 offset:2048
    v_mfma_f32_16x16x32_bf16 v[48:51], v[208:211], v[188:191], v[48:51]
    ds_read_b64_tr_b16 v[152:153], v235 offset:0
    v_mfma_f32_16x16x32_bf16 v[52:55], v[212:215], v[188:191], v[52:55]
    ds_read_b64_tr_b16 v[154:155], v235 offset:4096
    v_mfma_f32_16x16x32_bf16 v[56:59], v[216:219], v[188:191], v[56:59]
    ds_read_b64_tr_b16 v[156:157], v236 offset:0
    v_mfma_f32_16x16x32_bf16 v[60:63], v[220:223], v[188:191], v[60:63]
    ds_read_b64_tr_b16 v[158:159], v236 offset:4096
    v_mfma_f32_16x16x32_bf16 v[64:67], v[224:227], v[188:191], v[64:67]
    v_mfma_f32_16x16x32_bf16 v[68:71], v[228:231], v[188:191], v[68:71]
    ds_read_b64_tr_b16 v[160:161], v237 offset:0
    v_mfma_f32_16x16x32_bf16 v[72:75], v[200:203], v[192:195], v[72:75]
    ds_read_b64_tr_b16 v[162:163], v237 offset:4096
    v_mfma_f32_16x16x32_bf16 v[76:79], v[204:207], v[192:195], v[76:79]
    ds_read_b64_tr_b16 v[164:165], v238 offset:0
    v_mfma_f32_16x16x32_bf16 v[80:83], v[208:211], v[192:195], v[80:83]
    ds_read_b64_tr_b16 v[166:167], v238 offset:4096
    v_mfma_f32_16x16x32_bf16 v[84:87], v[212:215], v[192:195], v[84:87]
    ds_read_b64_tr_b16 v[168:169], v235 offset:16384
    v_mfma_f32_16x16x32_bf16 v[88:91], v[216:219], v[192:195], v[88:91]
    v_mfma_f32_16x16x32_bf16 v[92:95], v[220:223], v[192:195], v[92:95]
    ds_read_b64_tr_b16 v[170:171], v235 offset:20480
    v_mfma_f32_16x16x32_bf16 v[96:99], v[224:227], v[192:195], v[96:99]
    ds_read_b64_tr_b16 v[172:173], v236 offset:16384
    v_mfma_f32_16x16x32_bf16 v[100:103], v[228:231], v[192:195], v[100:103]
    ds_read_b64_tr_b16 v[174:175], v236 offset:20480
    v_mfma_f32_16x16x32_bf16 v[104:107], v[200:203], v[196:199], v[104:107]
    ds_read_b64_tr_b16 v[176:177], v237 offset:16384
    v_mfma_f32_16x16x32_bf16 v[108:111], v[204:207], v[196:199], v[108:111]
    ds_read_b64_tr_b16 v[178:179], v237 offset:20480
    v_mfma_f32_16x16x32_bf16 v[112:115], v[208:211], v[196:199], v[112:115]
    v_mfma_f32_16x16x32_bf16 v[116:119], v[212:215], v[196:199], v[116:119]
    ds_read_b64_tr_b16 v[180:181], v238 offset:16384
    v_mfma_f32_16x16x32_bf16 v[120:123], v[216:219], v[196:199], v[120:123]
    ds_read_b64_tr_b16 v[182:183], v238 offset:20480
    v_mfma_f32_16x16x32_bf16 v[124:127], v[220:223], v[196:199], v[124:127]
    ds_read_b128 v[144:147], v232 offset:4096
    v_mfma_f32_16x16x32_bf16 v[128:131], v[224:227], v[196:199], v[128:131]
    ds_read_b128 v[148:151], v232 offset:6144
    v_mfma_f32_16x16x32_bf16 v[132:135], v[228:231], v[196:199], v[132:135]
    ds_read_b128 v[136:139], v232 offset:0
    v_mfma_f32_16x16x32_bf16 v[8:11], v[200:203], v[184:187], v[8:11]
    v_mfma_f32_16x16x32_bf16 v[12:15], v[204:207], v[184:187], v[12:15]
    v_mfma_f32_16x16x32_bf16 v[16:19], v[208:211], v[184:187], v[16:19]
    v_mfma_f32_16x16x32_bf16 v[20:23], v[212:215], v[184:187], v[20:23]
    v_mfma_f32_16x16x32_bf16 v[24:27], v[216:219], v[184:187], v[24:27]
    v_mfma_f32_16x16x32_bf16 v[28:31], v[220:223], v[184:187], v[28:31]
    v_mfma_f32_16x16x32_bf16 v[32:35], v[224:227], v[184:187], v[32:35]
    s_add_u32 s52, s52, 49152
    s_cmp_ge_u32 s52, 147456
    s_cselect_b32 s52, 0, s52
    v_mfma_f32_16x16x32_bf16 v[36:39], v[228:231], v[184:187], v[36:39]
    s_waitcnt lgkmcnt(0)
    v_mfma_f32_16x16x32_bf16 v[40:43], v[152:155], v[140:143], v[40:43]
    ds_read_b128 v[188:191], v232 offset:3072
    v_mfma_f32_16x16x32_bf16 v[44:47], v[156:159], v[140:143], v[44:47]
    ds_read_b64_tr_b16 v[200:201], v235 offset:8192
    v_mfma_f32_16x16x32_bf16 v[48:51], v[160:163], v[140:143], v[48:51]
    ds_read_b64_tr_b16 v[202:203], v235 offset:12288
    v_mfma_f32_16x16x32_bf16 v[52:55], v[164:167], v[140:143], v[52:55]
    ds_read_b64_tr_b16 v[204:205], v236 offset:8192
    v_mfma_f32_16x16x32_bf16 v[56:59], v[168:171], v[140:143], v[56:59]
    v_mfma_f32_16x16x32_bf16 v[60:63], v[172:175], v[140:143], v[60:63]
    ds_read_b64_tr_b16 v[206:207], v236 offset:12288
    v_mfma_f32_16x16x32_bf16 v[64:67], v[176:179], v[140:143], v[64:67]
    ds_read_b64_tr_b16 v[208:209], v237 offset:8192
    v_mfma_f32_16x16x32_bf16 v[68:71], v[180:183], v[140:143], v[68:71]
    ds_read_b64_tr_b16 v[210:211], v237 offset:12288
    v_mfma_f32_16x16x32_bf16 v[72:75], v[152:155], v[144:147], v[72:75]
    ds_read_b64_tr_b16 v[212:213], v238 offset:8192
    v_mfma_f32_16x16x32_bf16 v[76:79], v[156:159], v[144:147], v[76:79]
    v_mfma_f32_16x16x32_bf16 v[80:83], v[160:163], v[144:147], v[80:83]
    ds_read_b64_tr_b16 v[214:215], v238 offset:12288
    v_mfma_f32_16x16x32_bf16 v[84:87], v[164:167], v[144:147], v[84:87]
    ds_read_b64_tr_b16 v[216:217], v235 offset:24576
    v_mfma_f32_16x16x32_bf16 v[88:91], v[168:171], v[144:147], v[88:91]
    ds_read_b64_tr_b16 v[218:219], v235 offset:28672
    v_mfma_f32_16x16x32_bf16 v[92:95], v[172:175], v[144:147], v[92:95]
    ds_read_b64_tr_b16 v[220:221], v236 offset:24576
    v_mfma_f32_16x16x32_bf16 v[96:99], v[176:179], v[144:147], v[96:99]
    v_mfma_f32_16x16x32_bf16 v[100:103], v[180:183], v[144:147], v[100:103]
    ds_read_b64_tr_b16 v[222:223], v236 offset:28672
    v_mfma_f32_16x16x32_bf16 v[104:107], v[152:155], v[148:151], v[104:107]
    s_movk_i32 s54, 7
M_P_loop5:
    ds_read_b64_tr_b16 v[224:225], v237 offset:24576
    v_mfma_f32_16x16x32_bf16 v[108:111], v[156:159], v[148:151], v[108:111]
    ds_read_b64_tr_b16 v[226:227], v237 offset:28672
    v_mfma_f32_16x16x32_bf16 v[112:115], v[160:163], v[148:151], v[112:115]
    ds_read_b64_tr_b16 v[228:229], v238 offset:24576
    v_mfma_f32_16x16x32_bf16 v[116:119], v[164:167], v[148:151], v[116:119]
    v_mfma_f32_16x16x32_bf16 v[120:123], v[168:171], v[148:151], v[120:123]
    ds_read_b64_tr_b16 v[230:231], v238 offset:28672
    v_mfma_f32_16x16x32_bf16 v[124:127], v[172:175], v[148:151], v[124:127]
    ds_read_b128 v[192:195], v232 offset:5120
    v_mfma_f32_16x16x32_bf16 v[128:131], v[176:179], v[148:151], v[128:131]
    ds_read_b128 v[196:199], v232 offset:7168
    v_mfma_f32_16x16x32_bf16 v[132:135], v[180:183], v[148:151], v[132:135]
    ds_read_b128 v[184:187], v232 offset:1024
    v_mfma_f32_16x16x32_bf16 v[8:11], v[152:155], v[136:139], v[8:11]
    v_mfma_f32_16x16x32_bf16 v[12:15], v[156:159], v[136:139], v[12:15]
    v_add_u32 v232, s52, v233
    v_mfma_f32_16x16x32_bf16 v[16:19], v[160:163], v[136:139], v[16:19]
    v_add_u32 v235, s52, v239
    v_mfma_f32_16x16x32_bf16 v[20:23], v[164:167], v[136:139], v[20:23]
    v_add_u32 v236, s52, v240
    v_mfma_f32_16x16x32_bf16 v[24:27], v[168:171], v[136:139], v[24:27]
    v_mfma_f32_16x16x32_bf16 v[28:31], v[172:175], v[136:139], v[28:31]
    v_add_u32 v237, s52, v241
    v_mfma_f32_16x16x32_bf16 v[32:35], v[176:179], v[136:139], v[32:35]
    v_add_u32 v238, s52, v242
    v_mfma_f32_16x16x32_bf16 v[36:39], v[180:183], v[136:139], v[36:39]
    s_waitcnt lgkmcnt(0)
    v_mfma_f32_16x16x32_bf16 v[40:43], v[200:203], v[188:191], v[40:43]
    s_barrier
    v_mfma_f32_16x16x32_bf16 v[44:47], v[204:207], v[188:191], v[44:47]
    ds_read_b128 v[140:143], v232 offset:2048
    v_mfma_f32_16x16x32_bf16 v[48:51], v[208:211], v[188:191], v[48:51]
    ds_read_b64_tr_b16 v[152:153], v235 offset:0
    v_mfma_f32_16x16x32_bf16 v[52:55], v[212:215], v[188:191], v[52:55]
    ds_read_b64_tr_b16 v[154:155], v235 offset:4096
    v_mfma_f32_16x16x32_bf16 v[56:59], v[216:219], v[188:191], v[56:59]
    ds_read_b64_tr_b16 v[156:157], v236 offset:0
    v_mfma_f32_16x16x32_bf16 v[60:63], v[220:223], v[188:191], v[60:63]
    ds_read_b64_tr_b16 v[158:159], v236 offset:4096
    v_mfma_f32_16x16x32_bf16 v[64:67], v[224:227], v[188:191], v[64:67]
    v_mfma_f32_16x16x32_bf16 v[68:71], v[228:231], v[188:191], v[68:71]
    ds_read_b64_tr_b16 v[160:161], v237 offset:0
    v_mfma_f32_16x16x32_bf16 v[72:75], v[200:203], v[192:195], v[72:75]
    ds_read_b64_tr_b16 v[162:163], v237 offset:4096
    v_mfma_f32_16x16x32_bf16 v[76:79], v[204:207], v[192:195], v[76:79]
    ds_read_b64_tr_b16 v[164:165], v238 offset:0
    v_mfma_f32_16x16x32_bf16 v[80:83], v[208:211], v[192:195], v[80:83]
    ds_read_b64_tr_b16 v[166:167], v238 offset:4096
    v_mfma_f32_16x16x32_bf16 v[84:87], v[212:215], v[192:195], v[84:87]
    ds_read_b64_tr_b16 v[168:169], v235 offset:16384
    v_mfma_f32_16x16x32_bf16 v[88:91], v[216:219], v[192:195], v[88:91]
    v_mfma_f32_16x16x32_bf16 v[92:95], v[220:223], v[192:195], v[92:95]
    ds_read_b64_tr_b16 v[170:171], v235 offset:20480
    v_mfma_f32_16x16x32_bf16 v[96:99], v[224:227], v[192:195], v[96:99]
    ds_read_b64_tr_b16 v[172:173], v236 offset:16384
    v_mfma_f32_16x16x32_bf16 v[100:103], v[228:231], v[192:195], v[100:103]
    ds_read_b64_tr_b16 v[174:175], v236 offset:20480
    v_mfma_f32_16x16x32_bf16 v[104:107], v[200:203], v[196:199], v[104:107]
    ds_read_b64_tr_b16 v[176:177], v237 offset:16384
    v_mfma_f32_16x16x32_bf16 v[108:111], v[204:207], v[196:199], v[108:111]
    ds_read_b64_tr_b16 v[178:179], v237 offset:20480
    v_mfma_f32_16x16x32_bf16 v[112:115], v[208:211], v[196:199], v[112:115]
    v_mfma_f32_16x16x32_bf16 v[116:119], v[212:215], v[196:199], v[116:119]
    ds_read_b64_tr_b16 v[180:181], v238 offset:16384
    v_mfma_f32_16x16x32_bf16 v[120:123], v[216:219], v[196:199], v[120:123]
    ds_read_b64_tr_b16 v[182:183], v238 offset:20480
    v_mfma_f32_16x16x32_bf16 v[124:127], v[220:223], v[196:199], v[124:127]
    ds_read_b128 v[144:147], v232 offset:4096
    v_mfma_f32_16x16x32_bf16 v[128:131], v[224:227], v[196:199], v[128:131]
    ds_read_b128 v[148:151], v232 offset:6144
    v_mfma_f32_16x16x32_bf16 v[132:135], v[228:231], v[196:199], v[132:135]
    ds_read_b128 v[136:139], v232 offset:0
    v_mfma_f32_16x16x32_bf16 v[8:11], v[200:203], v[184:187], v[8:11]
    v_mfma_f32_16x16x32_bf16 v[12:15], v[204:207], v[184:187], v[12:15]
    v_mfma_f32_16x16x32_bf16 v[16:19], v[208:211], v[184:187], v[16:19]
    v_mfma_f32_16x16x32_bf16 v[20:23], v[212:215], v[184:187], v[20:23]
    v_mfma_f32_16x16x32_bf16 v[24:27], v[216:219], v[184:187], v[24:27]
    v_mfma_f32_16x16x32_bf16 v[28:31], v[220:223], v[184:187], v[28:31]
    v_mfma_f32_16x16x32_bf16 v[32:35], v[224:227], v[184:187], v[32:35]
    s_add_u32 s52, s52, 49152
    s_cmp_ge_u32 s52, 147456
    s_cselect_b32 s52, 0, s52
    v_mfma_f32_16x16x32_bf16 v[36:39], v[228:231], v[184:187], v[36:39]
    s_waitcnt lgkmcnt(0)
    v_mfma_f32_16x16x32_bf16 v[40:43], v[152:155], v[140:143], v[40:43]
    ds_read_b128 v[188:191], v232 offset:3072
    v_mfma_f32_16x16x32_bf16 v[44:47], v[156:159], v[140:143], v[44:47]
    ds_read_b64_tr_b16 v[200:201], v235 offset:8192
    v_mfma_f32_16x16x32_bf16 v[48:51], v[160:163], v[140:143], v[48:51]
    ds_read_b64_tr_b16 v[202:203], v235 offset:12288
    v_mfma_f32_16x16x32_bf16 v[52:55], v[164:167], v[140:143], v[52:55]
    ds_read_b64_tr_b16 v[204:205], v236 offset:8192
    v_mfma_f32_16x16x32_bf16 v[56:59], v[168:171], v[140:143], v[56:59]
    v_mfma_f32_16x16x32_bf16 v[60:63], v[172:175], v[140:143], v[60:63]
    ds_read_b64_tr_b16 v[206:207], v236 offset:12288
    v_mfma_f32_16x16x32_bf16 v[64:67], v[176:179], v[140:143], v[64:67]
    ds_read_b64_tr_b16 v[208:209], v237 offset:8192
    v_mfma_f32_16x16x32_bf16 v[68:71], v[180:183], v[140:143], v[68:71]
    ds_read_b64_tr_b16 v[210:211], v237 offset:12288
    v_mfma_f32_16x16x32_bf16 v[72:75], v[152:155], v[144:147], v[72:75]
    ds_read_b64_tr_b16 v[212:213], v238 offset:8192
    v_mfma_f32_16x16x32_bf16 v[76:79], v[156:159], v[144:147], v[76:79]
    v_mfma_f32_16x16x32_bf16 v[80:83], v[160:163], v[144:147], v[80:83]
    ds_read_b64_tr_b16 v[214:215], v238 offset:12288
    v_mfma_f32_16x16x32_bf16 v[84:87], v[164:167], v[144:147], v[84:87]
    ds_read_b64_tr_b16 v[216:217], v235 offset:24576
    v_mfma_f32_16x16x32_bf16 v[88:91], v[168:171], v[144:147], v[88:91]
    ds_read_b64_tr_b16 v[218:219], v235 offset:28672
    v_mfma_f32_16x16x32_bf16 v[92:95], v[172:175], v[144:147], v[92:95]
    ds_read_b64_tr_b16 v[220:221], v236 offset:24576
    v_mfma_f32_16x16x32_bf16 v[96:99], v[176:179], v[144:147], v[96:99]
    v_mfma_f32_16x16x32_bf16 v[100:103], v[180:183], v[144:147], v[100:103]
    s_sub_u32 s54, s54, 1
    ds_read_b64_tr_b16 v[222:223], v236 offset:28672
    v_mfma_f32_16x16x32_bf16 v[104:107], v[152:155], v[148:151], v[104:107]
    s_cbranch_scc0 M_P_loop5
    ds_read_b64_tr_b16 v[224:225], v237 offset:24576
    v_mfma_f32_16x16x32_bf16 v[108:111], v[156:159], v[148:151], v[108:111]
    ds_read_b64_tr_b16 v[226:227], v237 offset:28672
    v_mfma_f32_16x16x32_bf16 v[112:115], v[160:163], v[148:151], v[112:115]
    ds_read_b64_tr_b16 v[228:229], v238 offset:24576
    v_mfma_f32_16x16x32_bf16 v[116:119], v[164:167], v[148:151], v[116:119]
    v_mfma_f32_16x16x32_bf16 v[120:123], v[168:171], v[148:151], v[120:123]
    ds_read_b64_tr_b16 v[230:231], v238 offset:28672
    v_mfma_f32_16x16x32_bf16 v[124:127], v[172:175], v[148:151], v[124:127]
    ds_read_b128 v[192:195], v232 offset:5120
    v_mfma_f32_16x16x32_bf16 v[128:131], v[176:179], v[148:151], v[128:131]
    ds_read_b128 v[196:199], v232 offset:7168
    v_mfma_f32_16x16x32_bf16 v[132:135], v[180:183], v[148:151], v[132:135]
    ds_read_b128 v[184:187], v232 offset:1024
    v_mfma_f32_16x16x32_bf16 v[8:11], v[152:155], v[136:139], v[8:11]
    v_mfma_f32_16x16x32_bf16 v[12:15], v[156:159], v[136:139], v[12:15]
    v_add_u32 v232, s52, v233
    v_mfma_f32_16x16x32_bf16 v[16:19], v[160:163], v[136:139], v[16:19]
    v_add_u32 v235, s52, v239
    v_mfma_f32_16x16x32_bf16 v[20:23], v[164:167], v[136:139], v[20:23]
    v_add_u32 v236, s52, v240
    v_mfma_f32_16x16x32_bf16 v[24:27], v[168:171], v[136:139], v[24:27]
    v_mfma_f32_16x16x32_bf16 v[28:31], v[172:175], v[136:139], v[28:31]
    v_add_u32 v237, s52, v241
    v_mfma_f32_16x16x32_bf16 v[32:35], v[176:179], v[136:139], v[32:35]
    v_add_u32 v238, s52, v242
    v_mfma_f32_16x16x32_bf16 v[36:39], v[180:183], v[136:139], v[36:39]
    s_waitcnt lgkmcnt(0)
    v_mfma_f32_16x16x32_bf16 v[40:43], v[200:203], v[188:191], v[40:43]
    s_barrier
    v_mfma_f32_16x16x32_bf16 v[44:47], v[204:207], v[188:191], v[44:47]
    ds_read_b128 v[140:143], v232 offset:2048
    v_mfma_f32_16x16x32_bf16 v[48:51], v[208:211], v[188:191], v[48:51]
    ds_read_b64_tr_b16 v[152:153], v235 offset:0
    v_mfma_f32_16x16x32_bf16 v[52:55], v[212:215], v[188:191], v[52:55]
    ds_read_b64_tr_b16 v[154:155], v235 offset:4096
    v_mfma_f32_16x16x32_bf16 v[56:59], v[216:219], v[188:191], v[56:59]
    v_mfma_f32_16x16x32_bf16 v[60:63], v[220:223], v[188:191], v[60:63]
    ds_read_b64_tr_b16 v[156:157], v236 offset:0
    v_mfma_f32_16x16x32_bf16 v[64:67], v[224:227], v[188:191], v[64:67]
    ds_read_b64_tr_b16 v[158:159], v236 offset:4096
    v_mfma_f32_16x16x32_bf16 v[68:71], v[228:231], v[188:191], v[68:71]
    ds_read_b64_tr_b16 v[160:161], v237 offset:0
    v_mfma_f32_16x16x32_bf16 v[72:75], v[200:203], v[192:195], v[72:75]
    v_mfma_f32_16x16x32_bf16 v[76:79], v[204:207], v[192:195], v[76:79]
    ds_read_b64_tr_b16 v[162:163], v237 offset:4096
    v_mfma_f32_16x16x32_bf16 v[80:83], v[208:211], v[192:195], v[80:83]
    ds_read_b64_tr_b16 v[164:165], v238 offset:0
    v_mfma_f32_16x16x32_bf16 v[84:87], v[212:215], v[192:195], v[84:87]
    ds_read_b64_tr_b16 v[166:167], v238 offset:4096
    v_mfma_f32_16x16x32_bf16 v[88:91], v[216:219], v[192:195], v[88:91]
    v_mfma_f32_16x16x32_bf16 v[92:95], v[220:223], v[192:195], v[92:95]
    ds_read_b64_tr_b16 v[168:169], v235 offset:16384
    v_mfma_f32_16x16x32_bf16 v[96:99], v[224:227], v[192:195], v[96:99]
    ds_read_b64_tr_b16 v[170:171], v235 offset:20480
    v_mfma_f32_16x16x32_bf16 v[100:103], v[228:231], v[192:195], v[100:103]
    ds_read_b64_tr_b16 v[172:173], v236 offset:16384
    v_mfma_f32_16x16x32_bf16 v[104:107], v[200:203], v[196:199], v[104:107]
    v_mfma_f32_16x16x32_bf16 v[108:111], v[204:207], v[196:199], v[108:111]
    ds_read_b64_tr_b16 v[174:175], v236 offset:20480
    v_mfma_f32_16x16x32_bf16 v[112:115], v[208:211], v[196:199], v[112:115]
    ds_read_b64_tr_b16 v[176:177], v237 offset:16384
    v_mfma_f32_16x16x32_bf16 v[116:119], v[212:215], v[196:199], v[116:119]
    ds_read_b64_tr_b16 v[178:179], v237 offset:20480
    v_mfma_f32_16x16x32_bf16 v[120:123], v[216:219], v[196:199], v[120:123]
    v_mfma_f32_16x16x32_bf16 v[124:127], v[220:223], v[196:199], v[124:127]
    ds_read_b64_tr_b16 v[180:181], v238 offset:16384
    v_mfma_f32_16x16x32_bf16 v[128:131], v[224:227], v[196:199], v[128:131]
    ds_read_b64_tr_b16 v[182:183], v238 offset:20480
    v_mfma_f32_16x16x32_bf16 v[132:135], v[228:231], v[196:199], v[132:135]
    ds_read_b128 v[144:147], v232 offset:4096
    v_mfma_f32_16x16x32_bf16 v[8:11], v[200:203], v[184:187], v[8:11]
    v_mfma_f32_16x16x32_bf16 v[12:15], v[204:207], v[184:187], v[12:15]
    v_mfma_f32_16x16x32_bf16 v[16:19], v[208:211], v[184:187], v[16:19]
    v_mfma_f32_16x16x32_bf16 v[20:23], v[212:215], v[184:187], v[20:23]
    v_mfma_f32_16x16x32_bf16 v[24:27], v[216:219], v[184:187], v[24:27]
    v_mfma_f32_16x16x32_bf16 v[28:31], v[220:223], v[184:187], v[28:31]
    v_mfma_f32_16x16x32_bf16 v[32:35], v[224:227], v[184:187], v[32:35]
    s_add_u32 s52, s52, 49152
    s_cmp_ge_u32 s52, 147456
    s_cselect_b32 s52, 0, s52
    v_mfma_f32_16x16x32_bf16 v[36:39], v[228:231], v[184:187], v[36:39]
    s_waitcnt lgkmcnt(0)
    v_mfma_f32_16x16x32_bf16 v[40:43], v[152:155], v[140:143], v[40:43]
    ds_read_b128 v[188:191], v232 offset:3072
    ds_read_b64_tr_b16 v[200:201], v235 offset:8192
    v_mfma_f32_16x16x32_bf16 v[44:47], v[156:159], v[140:143], v[44:47]
    ds_read_b64_tr_b16 v[202:203], v235 offset:12288
    v_mfma_f32_16x16x32_bf16 v[48:51], v[160:163], v[140:143], v[48:51]
    ds_read_b64_tr_b16 v[204:205], v236 offset:8192
    ds_read_b64_tr_b16 v[206:207], v236 offset:12288
    v_mfma_f32_16x16x32_bf16 v[52:55], v[164:167], v[140:143], v[52:55]
    ds_read_b64_tr_b16 v[208:209], v237 offset:8192
    v_mfma_f32_16x16x32_bf16 v[56:59], v[168:171], v[140:143], v[56:59]
    ds_read_b64_tr_b16 v[210:211], v237 offset:12288
    ds_read_b64_tr_b16 v[212:213], v238 offset:8192
    v_mfma_f32_16x16x32_bf16 v[60:63], v[172:175], v[140:143], v[60:63]
    ds_read_b64_tr_b16 v[214:215], v238 offset:12288
    v_mfma_f32_16x16x32_bf16 v[64:67], v[176:179], v[140:143], v[64:67]
    ds_read_b64_tr_b16 v[216:217], v235 offset:24576
    ds_read_b64_tr_b16 v[218:219], v235 offset:28672
    v_mfma_f32_16x16x32_bf16 v[68:71], v[180:183], v[140:143], v[68:71]
    ds_read_b64_tr_b16 v[220:221], v236 offset:24576
    v_mfma_f32_16x16x32_bf16 v[72:75], v[152:155], v[144:147], v[72:75]
    s_movk_i32 s54, 1
M_P_loop6:
    ds_read_b64_tr_b16 v[222:223], v236 offset:28672
    ds_read_b64_tr_b16 v[224:225], v237 offset:24576
    v_mfma_f32_16x16x32_bf16 v[76:79], v[156:159], v[144:147], v[76:79]
    ds_read_b64_tr_b16 v[226:227], v237 offset:28672
    v_mfma_f32_16x16x32_bf16 v[80:83], v[160:163], v[144:147], v[80:83]
    ds_read_b64_tr_b16 v[228:229], v238 offset:24576
    ds_read_b64_tr_b16 v[230:231], v238 offset:28672
    v_mfma_f32_16x16x32_bf16 v[84:87], v[164:167], v[144:147], v[84:87]
    ds_read_b128 v[192:195], v232 offset:5120
    v_mfma_f32_16x16x32_bf16 v[88:91], v[168:171], v[144:147], v[88:91]
    v_add_u32 v232, s52, v233
    v_add_u32 v235, s52, v239
    v_mfma_f32_16x16x32_bf16 v[92:95], v[172:175], v[144:147], v[92:95]
    v_add_u32 v236, s52, v240
    v_mfma_f32_16x16x32_bf16 v[96:99], v[176:179], v[144:147], v[96:99]
    v_add_u32 v237, s52, v241
    v_mfma_f32_16x16x32_bf16 v[100:103], v[180:183], v[144:147], v[100:103]
    v_add_u32 v238, s52, v242
    s_waitcnt lgkmcnt(0)
    v_mfma_f32_16x16x32_bf16 v[40:43], v[200:203], v[188:191], v[40:43]
    s_barrier
    v_mfma_f32_16x16x32_bf16 v[44:47], v[204:207], v[188:191], v[44:47]
    ds_read_b128 v[140:143], v232 offset:2048
    ds_read_b64_tr_b16 v[152:153], v235 offset:0
    v_mfma_f32_16x16x32_bf16 v[48:51], v[208:211], v[188:191], v[48:51]
    ds_read_b64_tr_b16 v[154:155], v235 offset:4096
    ds_read_b64_tr_b16 v[156:157], v236 offset:0
    v_mfma_f32_16x16x32_bf16 v[52:55], v[212:215], v[188:191], v[52:55]
    ds_read_b64_tr_b16 v[158:159], v236 offset:4096
    v_mfma_f32_16x16x32_bf16 v[56:59], v[216:219], v[188:191], v[56:59]
    ds_read_b64_tr_b16 v[160:161], v237 offset:0
    ds_read_b64_tr_b16 v[162:163], v237 offset:4096
    v_mfma_f32_16x16x32_bf16 v[60:63], v[220:223], v[188:191], v[60:63]
    ds_read_b64_tr_b16 v[164:165], v238 offset:0
    ds_read_b64_tr_b16 v[166:167], v238 offset:4096
    v_mfma_f32_16x16x32_bf16 v[64:67], v[224:227], v[188:191], v[64:67]
    ds_read_b64_tr_b16 v[168:169], v235 offset:16384
    v_mfma_f32_16x16x32_bf16 v[68:71], v[228:231], v[188:191], v[68:71]
    ds_read_b64_tr_b16 v[170:171], v235 offset:20480
    ds_read_b64_tr_b16 v[172:173], v236 offset:16384
    v_mfma_f32_16x16x32_bf16 v[72:75], v[200:203], v[192:195], v[72:75]
    ds_read_b64_tr_b16 v[174:175], v236 offset:20480
    ds_read_b64_tr_b16 v[176:177], v237 offset:16384
    v_mfma_f32_16x16x32_bf16 v[76:79], v[204:207], v[192:195], v[76:79]
    ds_read_b64_tr_b16 v[178:179], v237 offset:20480
    v_mfma_f32_16x16x32_bf16 v[80:83], v[208:211], v[192:195], v[80:83]
    ds_read_b64_tr_b16 v[180:181], v238 offset:16384
    ds_read_b64_tr_b16 v[182:183], v238 offset:20480
    v_mfma_f32_16x16x32_bf16 v[84:87], v[212:215], v[192:195], v[84:87]
    ds_read_b128 v[144:147], v232 offset:4096
    v_mfma_f32_16x16x32_bf16 v[88:91], v[216:219], v[192:195], v[88:91]
    v_mfma_f32_16x16x32_bf16 v[92:95], v[220:223], v[192:195], v[92:95]
    v_mfma_f32_16x16x32_bf16 v[96:99], v[224:227], v[192:195], v[96:99]
    s_add_u32 s52, s52, 49152
    s_cmp_ge_u32 s52, 147456
    s_cselect_b32 s52, 0, s52
    v_mfma_f32_16x16x32_bf16 v[100:103], v[228:231], v[192:195], v[100:103]
    s_waitcnt lgkmcnt(0)
    v_mfma_f32_16x16x32_bf16 v[40:43], v[152:155], v[140:143], v[40:43]
    ds_read_b128 v[188:191], v232 offset:3072
    ds_read_b64_tr_b16 v[200:201], v235 offset:8192
    v_mfma_f32_16x16x32_bf16 v[44:47], v[156:159], v[140:143], v[44:47]
    ds_read_b64_tr_b16 v[202:203], v235 offset:12288
    v_mfma_f32_16x16x32_bf16 v[48:51], v[160:163], v[140:143], v[48:51]
    ds_read_b64_tr_b16 v[204:205], v236 offset:8192
    ds_read_b64_tr_b16 v[206:207], v236 offset:12288
    v_mfma_f32_16x16x32_bf16 v[52:55], v[164:167], v[140:143], v[52:55]
    ds_read_b64_tr_b16 v[208:209], v237 offset:8192
    v_mfma_f32_16x16x32_bf16 v[56:59], v[168:171], v[140:143], v[56:59]
    ds_read_b64_tr_b16 v[210:211], v237 offset:12288
    ds_read_b64_tr_b16 v[212:213], v238 offset:8192
    v_mfma_f32_16x16x32_bf16 v[60:63], v[172:175], v[140:143], v[60:63]
    ds_read_b64_tr_b16 v[214:215], v238 offset:12288
    v_mfma_f32_16x16x32_bf16 v[64:67], v[176:179], v[140:143], v[64:67]
    ds_read_b64_tr_b16 v[216:217], v235 offset:24576
    ds_read_b64_tr_b16 v[218:219], v235 offset:28672
    v_mfma_f32_16x16x32_bf16 v[68:71], v[180:183], v[140:143], v[68:71]
    s_sub_u32 s54, s54, 1
    ds_read_b64_tr_b16 v[220:221], v236 offset:24576
    v_mfma_f32_16x16x32_bf16 v[72:75], v[152:155], v[144:147], v[72:75]
    s_cbranch_scc0 M_P_loop6
    ds_read_b64_tr_b16 v[222:223], v236 offset:28672
    ds_read_b64_tr_b16 v[224:225], v237 offset:24576
    v_mfma_f32_16x16x32_bf16 v[76:79], v[156:159], v[144:147], v[76:79]
    ds_read_b64_tr_b16 v[226:227], v237 offset:28672
    v_mfma_f32_16x16x32_bf16 v[80:83], v[160:163], v[144:147], v[80:83]
    ds_read_b64_tr_b16 v[228:229], v238 offset:24576
    ds_read_b64_tr_b16 v[230:231], v238 offset:28672
    v_mfma_f32_16x16x32_bf16 v[84:87], v[164:167], v[144:147], v[84:87]
    ds_read_b128 v[192:195], v232 offset:5120
    v_mfma_f32_16x16x32_bf16 v[88:91], v[168:171], v[144:147], v[88:91]
    v_mfma_f32_16x16x32_bf16 v[92:95], v[172:175], v[144:147], v[92:95]
    v_mfma_f32_16x16x32_bf16 v[96:99], v[176:179], v[144:147], v[96:99]
    v_mfma_f32_16x16x32_bf16 v[100:103], v[180:183], v[144:147], v[100:103]
    s_waitcnt lgkmcnt(0)
    v_mfma_f32_16x16x32_bf16 v[40:43], v[200:203], v[188:191], v[40:43]
    v_add_u32 v232, 49152, v233
    v_add_u32 v235, 49152, v239
    v_mfma_f32_16x16x32_bf16 v[44:47], v[204:207], v[188:191], v[44:47]
    v_add_u32 v236, 49152, v240
    v_add_u32 v237, 49152, v241
    v_mfma_f32_16x16x32_bf16 v[48:51], v[208:211], v[188:191], v[48:51]
    v_add_u32 v238, 49152, v242
    v_mfma_f32_16x16x32_bf16 v[52:55], v[212:215], v[188:191], v[52:55]
    ds_read_b128 v[148:151], v232 offset:6144
    ds_read_b64_tr_b16 v[152:153], v235 offset:0
    v_mfma_f32_16x16x32_bf16 v[56:59], v[216:219], v[188:191], v[56:59]
    ds_read_b64_tr_b16 v[154:155], v235 offset:4096
    v_mfma_f32_16x16x32_bf16 v[60:63], v[220:223], v[188:191], v[60:63]
    ds_read_b64_tr_b16 v[156:157], v236 offset:0
    ds_read_b64_tr_b16 v[158:159], v236 offset:4096
    v_mfma_f32_16x16x32_bf16 v[64:67], v[224:227], v[188:191], v[64:67]
    ds_read_b64_tr_b16 v[160:161], v237 offset:0
    v_mfma_f32_16x16x32_bf16 v[68:71], v[228:231], v[188:191], v[68:71]
    ds_read_b64_tr_b16 v[162:163], v237 offset:4096
    ds_read_b64_tr_b16 v[164:165], v238 offset:0
    v_mfma_f32_16x16x32_bf16 v[72:75], v[200:203], v[192:195], v[72:75]
    ds_read_b64_tr_b16 v[166:167], v238 offset:4096
    ds_read_b64_tr_b16 v[168:169], v235 offset:16384
    v_mfma_f32_16x16x32_bf16 v[76:79], v[204:207], v[192:195], v[76:79]
    ds_read_b64_tr_b16 v[170:171], v235 offset:20480
    v_mfma_f32_16x16x32_bf16 v[80:83], v[208:211], v[192:195], v[80:83]
    ds_read_b64_tr_b16 v[172:173], v236 offset:16384
    ds_read_b64_tr_b16 v[174:175], v236 offset:20480
    v_mfma_f32_16x16x32_bf16 v[84:87], v[212:215], v[192:195], v[84:87]
    ds_read_b64_tr_b16 v[176:177], v237 offset:16384
    v_cvt_pk_bf16_f32 v40, v40, v41
    v_cvt_pk_bf16_f32 v41, v42, v43
    v_mfma_f32_16x16x32_bf16 v[88:91], v[216:219], v[192:195], v[88:91]
    ds_read_b64_tr_b16 v[178:179], v237 offset:20480
    ds_read_b64_tr_b16 v[180:181], v238 offset:16384
    v_cvt_pk_bf16_f32 v42, v44, v45
    v_cvt_pk_bf16_f32 v43, v46, v47
    v_mfma_f32_16x16x32_bf16 v[92:95], v[220:223], v[192:195], v[92:95]
    ds_read_b64_tr_b16 v[182:183], v238 offset:20480
    buffer_store_dwordx4 v[40:43], v249, s[28:31], s73 offen offset:0 sc1
    v_cvt_pk_bf16_f32 v48, v48, v49
    v_mfma_f32_16x16x32_bf16 v[96:99], v[224:227], v[192:195], v[96:99]
    v_cvt_pk_bf16_f32 v49, v50, v51
    v_cvt_pk_bf16_f32 v50, v52, v53
    v_mfma_f32_16x16x32_bf16 v[100:103], v[228:231], v[192:195], v[100:103]
    v_cvt_pk_bf16_f32 v51, v54, v55
    buffer_store_dwordx4 v[48:51], v249, s[28:31], s73 offen offset:1024 sc1
    s_waitcnt lgkmcnt(14)
    v_mfma_f32_16x16x32_bf16 v[104:107], v[152:155], v[148:151], v[104:107]
    ds_read_b128 v[196:199], v232 offset:7168
    ds_read_b64_tr_b16 v[200:201], v235 offset:8192
    v_cvt_pk_bf16_f32 v56, v56, v57
    s_waitcnt lgkmcnt(14)
    v_mfma_f32_16x16x32_bf16 v[108:111], v[156:159], v[148:151], v[108:111]
    ds_read_b64_tr_b16 v[202:203], v235 offset:12288
    ds_read_b64_tr_b16 v[204:205], v236 offset:8192
    v_cvt_pk_bf16_f32 v57, v58, v59
    s_waitcnt lgkmcnt(14)
    v_mfma_f32_16x16x32_bf16 v[112:115], v[160:163], v[148:151], v[112:115]
    ds_read_b64_tr_b16 v[206:207], v236 offset:12288
    ds_read_b64_tr_b16 v[208:209], v237 offset:8192
    v_cvt_pk_bf16_f32 v58, v60, v61
    s_waitcnt lgkmcnt(14)
    v_mfma_f32_16x16x32_bf16 v[116:119], v[164:167], v[148:151], v[116:119]
    ds_read_b64_tr_b16 v[210:211], v237 offset:12288
    ds_read_b64_tr_b16 v[212:213], v238 offset:8192
    v_cvt_pk_bf16_f32 v59, v62, v63
    s_waitcnt lgkmcnt(14)
    v_mfma_f32_16x16x32_bf16 v[120:123], v[168:171], v[148:151], v[120:123]
    ds_read_b64_tr_b16 v[214:215], v238 offset:12288
    ds_read_b64_tr_b16 v[216:217], v235 offset:24576
    buffer_store_dwordx4 v[56:59], v249, s[28:31], s73 offen offset:2048 sc1
    s_waitcnt lgkmcnt(14)
    v_mfma_f32_16x16x32_bf16 v[124:127], v[172:175], v[148:151], v[124:127]
    ds_read_b64_tr_b16 v[218:219], v235 offset:28672
    ds_read_b64_tr_b16 v[220:221], v236 offset:24576
    v_cvt_pk_bf16_f32 v64, v64, v65
    s_waitcnt lgkmcnt(14)
    v_mfma_f32_16x16x32_bf16 v[128:131], v[176:179], v[148:151], v[128:131]
    ds_read_b64_tr_b16 v[222:223], v236 offset:28672
    ds_read_b64_tr_b16 v[224:225], v237 offset:24576
    v_cvt_pk_bf16_f32 v65, v66, v67
    s_waitcnt lgkmcnt(14)
    v_mfma_f32_16x16x32_bf16 v[132:135], v[180:183], v[148:151], v[132:135]
    ds_read_b64_tr_b16 v[226:227], v237 offset:28672
    ds_read_b64_tr_b16 v[228:229], v238 offset:24576
    ds_read_b64_tr_b16 v[230:231], v238 offset:28672
    v_cvt_pk_bf16_f32 v66, v68, v69
    s_waitcnt lgkmcnt(14)
    v_mfma_f32_16x16x32_bf16 v[104:107], v[200:203], v[196:199], v[104:107]
    v_add_u32 v232, 98304, v233
    v_add_u32 v235, 98304, v239
    v_cvt_pk_bf16_f32 v67, v70, v71
    s_waitcnt lgkmcnt(12)
    v_mfma_f32_16x16x32_bf16 v[108:111], v[204:207], v[196:199], v[108:111]
    v_add_u32 v236, 98304, v240
    v_add_u32 v237, 98304, v241
    v_add_u32 v238, 98304, v242
    buffer_store_dwordx4 v[64:67], v249, s[28:31], s73 offen offset:3072 sc1
    s_waitcnt lgkmcnt(10)
    v_mfma_f32_16x16x32_bf16 v[112:115], v[208:211], v[196:199], v[112:115]
    ds_read_b128 v[148:151], v232 offset:6144
    ds_read_b64_tr_b16 v[152:153], v235 offset:0
    ds_read_b64_tr_b16 v[154:155], v235 offset:4096
    v_cvt_pk_bf16_f32 v72, v72, v73
    s_waitcnt lgkmcnt(11)
    v_mfma_f32_16x16x32_bf16 v[116:119], v[212:215], v[196:199], v[116:119]
    ds_read_b64_tr_b16 v[156:157], v236 offset:0
    ds_read_b64_tr_b16 v[158:159], v236 offset:4096
    ds_read_b64_tr_b16 v[160:161], v237 offset:0
    v_cvt_pk_bf16_f32 v73, v74, v75
    s_waitcnt lgkmcnt(12)
    v_mfma_f32_16x16x32_bf16 v[120:123], v[216:219], v[196:199], v[120:123]
    ds_read_b64_tr_b16 v[162:163], v237 offset:4096
    ds_read_b64_tr_b16 v[164:165], v238 offset:0
    v_cvt_pk_bf16_f32 v74, v76, v77
    s_waitcnt lgkmcnt(12)
    v_mfma_f32_16x16x32_bf16 v[124:127], v[220:223], v[196:199], v[124:127]
    ds_read_b64_tr_b16 v[166:167], v238 offset:4096
    ds_read_b64_tr_b16 v[168:169], v235 offset:16384
    ds_read_b64_tr_b16 v[170:171], v235 offset:20480
    v_cvt_pk_bf16_f32 v75, v78, v79
    s_waitcnt lgkmcnt(13)
    v_mfma_f32_16x16x32_bf16 v[128:131], v[224:227], v[196:199], v[128:131]
    ds_read_b64_tr_b16 v[172:173], v236 offset:16384
    ds_read_b64_tr_b16 v[174:175], v236 offset:20480
    ds_read_b64_tr_b16 v[176:177], v237 offset:16384
    buffer_store_dwordx4 v[72:75], v249, s[28:31], s74 offen offset:0 sc1
    s_waitcnt lgkmcnt(14)
    v_mfma_f32_16x16x32_bf16 v[132:135], v[228:231], v[196:199], v[132:135]
    ds_read_b64_tr_b16 v[178:179], v237 offset:20480
    ds_read_b64_tr_b16 v[180:181], v238 offset:16384
    ds_read_b64_tr_b16 v[182:183], v238 offset:20480
    v_cvt_pk_bf16_f32 v80, v80, v81
    s_waitcnt lgkmcnt(14)
    v_mfma_f32_16x16x32_bf16 v[104:107], v[152:155], v[148:151], v[104:107]
    ds_read_b128 v[196:199], v232 offset:7168
    ds_read_b64_tr_b16 v[200:201], v235 offset:8192
    v_cvt_pk_bf16_f32 v81, v82, v83
    s_waitcnt lgkmcnt(14)
    v_mfma_f32_16x16x32_bf16 v[108:111], v[156:159], v[148:151], v[108:111]
    ds_read_b64_tr_b16 v[202:203], v235 offset:12288
    ds_read_b64_tr_b16 v[204:205], v236 offset:8192
    v_cvt_pk_bf16_f32 v82, v84, v85
    s_waitcnt lgkmcnt(14)
    v_mfma_f32_16x16x32_bf16 v[112:115], v[160:163], v[148:151], v[112:115]
    ds_read_b64_tr_b16 v[206:207], v236 offset:12288
    ds_read_b64_tr_b16 v[208:209], v237 offset:8192
    v_cvt_pk_bf16_f32 v83, v86, v87
    s_waitcnt lgkmcnt(14)
    v_mfma_f32_16x16x32_bf16 v[116:119], v[164:167], v[148:151], v[116:119]
    ds_read_b64_tr_b16 v[210:211], v237 offset:12288
    ds_read_b64_tr_b16 v[212:213], v238 offset:8192
    buffer_store_dwordx4 v[80:83], v249, s[28:31], s74 offen offset:1024 sc1
    s_waitcnt lgkmcnt(14)
    v_mfma_f32_16x16x32_bf16 v[120:123], v[168:171], v[148:151], v[120:123]
    ds_read_b64_tr_b16 v[214:215], v238 offset:12288
    ds_read_b64_tr_b16 v[216:217], v235 offset:24576
    v_cvt_pk_bf16_f32 v88, v88, v89
    s_waitcnt lgkmcnt(14)
    v_mfma_f32_16x16x32_bf16 v[124:127], v[172:175], v[148:151], v[124:127]
    ds_read_b64_tr_b16 v[218:219], v235 offset:28672
    ds_read_b64_tr_b16 v[220:221], v236 offset:24576
    v_cvt_pk_bf16_f32 v89, v90, v91
    s_waitcnt lgkmcnt(14)
    v_mfma_f32_16x16x32_bf16 v[128:131], v[176:179], v[148:151], v[128:131]
    ds_read_b64_tr_b16 v[222:223], v236 offset:28672
    ds_read_b64_tr_b16 v[224:225], v237 offset:24576
    v_cvt_pk_bf16_f32 v90, v92, v93
    s_waitcnt lgkmcnt(14)
    v_mfma_f32_16x16x32_bf16 v[132:135], v[180:183], v[148:151], v[132:135]
    ds_read_b64_tr_b16 v[226:227], v237 offset:28672
    ds_read_b64_tr_b16 v[228:229], v238 offset:24576
    ds_read_b64_tr_b16 v[230:231], v238 offset:28672
    v_cvt_pk_bf16_f32 v91, v94, v95
    s_waitcnt lgkmcnt(14)
    v_mfma_f32_16x16x32_bf16 v[104:107], v[200:203], v[196:199], v[104:107]
    v_add_u32 v232, 0, v233
    v_add_u32 v235, 0, v239
    buffer_store_dwordx4 v[88:91], v249, s[28:31], s74 offen offset:2048 sc1
    s_waitcnt lgkmcnt(12)
    v_mfma_f32_16x16x32_bf16 v[108:111], v[204:207], v[196:199], v[108:111]
    v_add_u32 v236, 0, v240
    v_add_u32 v237, 0, v241
    v_add_u32 v238, 0, v242
    v_cvt_pk_bf16_f32 v96, v96, v97
    s_waitcnt lgkmcnt(10)
    v_mfma_f32_16x16x32_bf16 v[112:115], v[208:211], v[196:199], v[112:115]
    ds_read_b128 v[148:151], v232 offset:6144
    ds_read_b64_tr_b16 v[152:153], v235 offset:0
    ds_read_b64_tr_b16 v[154:155], v235 offset:4096
    v_cvt_pk_bf16_f32 v97, v98, v99
    s_waitcnt lgkmcnt(11)
    v_mfma_f32_16x16x32_bf16 v[116:119], v[212:215], v[196:199], v[116:119]
    ds_read_b64_tr_b16 v[156:157], v236 offset:0
    ds_read_b64_tr_b16 v[158:159], v236 offset:4096
    ds_read_b64_tr_b16 v[160:161], v237 offset:0
    v_cvt_pk_bf16_f32 v98, v100, v101
    s_waitcnt lgkmcnt(12)
    v_mfma_f32_16x16x32_bf16 v[120:123], v[216:219], v[196:199], v[120:123]
    ds_read_b64_tr_b16 v[162:163], v237 offset:4096
    ds_read_b64_tr_b16 v[164:165], v238 offset:0
    v_cvt_pk_bf16_f32 v99, v102, v103
    s_waitcnt lgkmcnt(12)
    v_mfma_f32_16x16x32_bf16 v[124:127], v[220:223], v[196:199], v[124:127]
    ds_read_b64_tr_b16 v[166:167], v238 offset:4096
    ds_read_b64_tr_b16 v[168:169], v235 offset:16384
    ds_read_b64_tr_b16 v[170:171], v235 offset:20480
    buffer_store_dwordx4 v[96:99], v249, s[28:31], s74 offen offset:3072 sc1
    s_waitcnt lgkmcnt(13)
    v_mfma_f32_16x16x32_bf16 v[128:131], v[224:227], v[196:199], v[128:131]
    ds_read_b64_tr_b16 v[172:173], v236 offset:16384
    ds_read_b64_tr_b16 v[174:175], v236 offset:20480
    ds_read_b64_tr_b16 v[176:177], v237 offset:16384
    s_waitcnt lgkmcnt(14)
    v_mfma_f32_16x16x32_bf16 v[132:135], v[228:231], v[196:199], v[132:135]
    ds_read_b64_tr_b16 v[178:179], v237 offset:20480
    ds_read_b64_tr_b16 v[180:181], v238 offset:16384
    ds_read_b64_tr_b16 v[182:183], v238 offset:20480
    s_waitcnt lgkmcnt(14)
    v_mfma_f32_16x16x32_bf16 v[104:107], v[152:155], v[148:151], v[104:107]
    ds_read_b128 v[196:199], v232 offset:7168
    ds_read_b64_tr_b16 v[200:201], v235 offset:8192
    s_waitcnt lgkmcnt(14)
    v_mfma_f32_16x16x32_bf16 v[108:111], v[156:159], v[148:151], v[108:111]
    ds_read_b64_tr_b16 v[202:203], v235 offset:12288
    ds_read_b64_tr_b16 v[204:205], v236 offset:8192
    s_waitcnt lgkmcnt(14)
    v_mfma_f32_16x16x32_bf16 v[112:115], v[160:163], v[148:151], v[112:115]
    ds_read_b64_tr_b16 v[206:207], v236 offset:12288
    ds_read_b64_tr_b16 v[208:209], v237 offset:8192
    s_waitcnt lgkmcnt(14)
    v_mfma_f32_16x16x32_bf16 v[116:119], v[164:167], v[148:151], v[116:119]
    ds_read_b64_tr_b16 v[210:211], v237 offset:12288
    ds_read_b64_tr_b16 v[212:213], v238 offset:8192
    s_waitcnt lgkmcnt(14)
    v_mfma_f32_16x16x32_bf16 v[120:123], v[168:171], v[148:151], v[120:123]
    ds_read_b64_tr_b16 v[214:215], v238 offset:12288
    ds_read_b64_tr_b16 v[216:217], v235 offset:24576
    s_waitcnt lgkmcnt(14)
    v_mfma_f32_16x16x32_bf16 v[124:127], v[172:175], v[148:151], v[124:127]
    ds_read_b64_tr_b16 v[218:219], v235 offset:28672
    ds_read_b64_tr_b16 v[220:221], v236 offset:24576
    s_waitcnt lgkmcnt(14)
    v_mfma_f32_16x16x32_bf16 v[128:131], v[176:179], v[148:151], v[128:131]
    ds_read_b64_tr_b16 v[222:223], v236 offset:28672
    ds_read_b64_tr_b16 v[224:225], v237 offset:24576
    s_waitcnt lgkmcnt(14)
    v_mfma_f32_16x16x32_bf16 v[132:135], v[180:183], v[148:151], v[132:135]
    ds_read_b64_tr_b16 v[226:227], v237 offset:28672
    ds_read_b64_tr_b16 v[228:229], v238 offset:24576
    ds_read_b64_tr_b16 v[230:231], v238 offset:28672
    s_waitcnt lgkmcnt(14)
    v_mfma_f32_16x16x32_bf16 v[104:107], v[200:203], v[196:199], v[104:107]
    v_add_u32 v232, 49152, v233
    v_add_u32 v235, 49152, v239
    s_waitcnt lgkmcnt(12)
    v_mfma_f32_16x16x32_bf16 v[108:111], v[204:207], v[196:199], v[108:111]
    v_add_u32 v236, 49152, v240
    v_add_u32 v237, 49152, v241
    v_add_u32 v238, 49152, v242
    s_waitcnt lgkmcnt(10)
    v_mfma_f32_16x16x32_bf16 v[112:115], v[208:211], v[196:199], v[112:115]
    ds_read_b128 v[136:139], v232 offset:0
    ds_read_b64_tr_b16 v[152:153], v235 offset:0
    ds_read_b64_tr_b16 v[154:155], v235 offset:4096
    s_waitcnt lgkmcnt(11)
    v_mfma_f32_16x16x32_bf16 v[116:119], v[212:215], v[196:199], v[116:119]
    ds_read_b64_tr_b16 v[156:157], v236 offset:0
    ds_read_b64_tr_b16 v[158:159], v236 offset:4096
    ds_read_b64_tr_b16 v[160:161], v237 offset:0
    s_waitcnt lgkmcnt(12)
    v_mfma_f32_16x16x32_bf16 v[120:123], v[216:219], v[196:199], v[120:123]
    ds_read_b64_tr_b16 v[162:163], v237 offset:4096
    ds_read_b64_tr_b16 v[164:165], v238 offset:0
    s_waitcnt lgkmcnt(12)
    v_mfma_f32_16x16x32_bf16 v[124:127], v[220:223], v[196:199], v[124:127]
    ds_read_b64_tr_b16 v[166:167], v238 offset:4096
    ds_read_b64_tr_b16 v[168:169], v235 offset:16384
    ds_read_b64_tr_b16 v[170:171], v235 offset:20480
    s_waitcnt lgkmcnt(13)
    v_mfma_f32_16x16x32_bf16 v[128:131], v[224:227], v[196:199], v[128:131]
    ds_read_b64_tr_b16 v[172:173], v236 offset:16384
    ds_read_b64_tr_b16 v[174:175], v236 offset:20480
    ds_read_b64_tr_b16 v[176:177], v237 offset:16384
    s_waitcnt lgkmcnt(14)
    v_mfma_f32_16x16x32_bf16 v[132:135], v[228:231], v[196:199], v[132:135]
    ds_read_b64_tr_b16 v[178:179], v237 offset:20480
    ds_read_b64_tr_b16 v[180:181], v238 offset:16384
    ds_read_b64_tr_b16 v[182:183], v238 offset:20480
    s_waitcnt lgkmcnt(14)
    v_mfma_f32_16x16x32_bf16 v[8:11], v[152:155], v[136:139], v[8:11]
    ds_read_b128 v[184:187], v232 offset:1024
    ds_read_b64_tr_b16 v[200:201], v235 offset:8192
    v_cvt_pk_bf16_f32 v104, v104, v105
    v_cvt_pk_bf16_f32 v105, v106, v107
    s_waitcnt lgkmcnt(14)
    v_mfma_f32_16x16x32_bf16 v[12:15], v[156:159], v[136:139], v[12:15]
    ds_read_b64_tr_b16 v[202:203], v235 offset:12288
    ds_read_b64_tr_b16 v[204:205], v236 offset:8192
    v_cvt_pk_bf16_f32 v106, v108, v109
    v_cvt_pk_bf16_f32 v107, v110, v111
    s_waitcnt lgkmcnt(14)
    v_mfma_f32_16x16x32_bf16 v[16:19], v[160:163], v[136:139], v[16:19]
    ds_read_b64_tr_b16 v[206:207], v236 offset:12288
    ds_read_b64_tr_b16 v[208:209], v237 offset:8192
    buffer_store_dwordx4 v[104:107], v249, s[28:31], s75 offen offset:0 sc1
    v_cvt_pk_bf16_f32 v112, v112, v113
    s_waitcnt lgkmcnt(14)
    v_mfma_f32_16x16x32_bf16 v[20:23], v[164:167], v[136:139], v[20:23]
    ds_read_b64_tr_b16 v[210:211], v237 offset:12288
    ds_read_b64_tr_b16 v[212:213], v238 offset:8192
    v_cvt_pk_bf16_f32 v113, v114, v115
    v_cvt_pk_bf16_f32 v114, v116, v117
    s_waitcnt lgkmcnt(14)
    v_mfma_f32_16x16x32_bf16 v[24:27], v[168:171], v[136:139], v[24:27]
    ds_read_b64_tr_b16 v[214:215], v238 offset:12288
    ds_read_b64_tr_b16 v[216:217], v235 offset:24576
    v_cvt_pk_bf16_f32 v115, v118, v119
    buffer_store_dwordx4 v[112:115], v249, s[28:31], s75 offen offset:1024 sc1
    s_waitcnt lgkmcnt(14)
    v_mfma_f32_16x16x32_bf16 v[28:31], v[172:175], v[136:139], v[28:31]
    ds_read_b64_tr_b16 v[218:219], v235 offset:28672
    ds_read_b64_tr_b16 v[220:221], v236 offset:24576
    v_cvt_pk_bf16_f32 v120, v120, v121
    v_cvt_pk_bf16_f32 v121, v122, v123
    s_waitcnt lgkmcnt(14)
    v_mfma_f32_16x16x32_bf16 v[32:35], v[176:179], v[136:139], v[32:35]
    ds_read_b64_tr_b16 v[222:223], v236 offset:28672
    ds_read_b64_tr_b16 v[224:225], v237 offset:24576
    v_cvt_pk_bf16_f32 v122, v124, v125
    v_cvt_pk_bf16_f32 v123, v126, v127
    s_waitcnt lgkmcnt(14)
    v_mfma_f32_16x16x32_bf16 v[36:39], v[180:183], v[136:139], v[36:39]
    ds_read_b64_tr_b16 v[226:227], v237 offset:28672
    ds_read_b64_tr_b16 v[228:229], v238 offset:24576
    ds_read_b64_tr_b16 v[230:231], v238 offset:28672
    buffer_store_dwordx4 v[120:123], v249, s[28:31], s75 offen offset:2048 sc1
    v_cvt_pk_bf16_f32 v128, v128, v129
    s_waitcnt lgkmcnt(14)
    v_mfma_f32_16x16x32_bf16 v[8:11], v[200:203], v[184:187], v[8:11]
    v_add_u32 v232, 98304, v233
    v_add_u32 v235, 98304, v239
    v_cvt_pk_bf16_f32 v129, v130, v131
    v_cvt_pk_bf16_f32 v130, v132, v133
    s_waitcnt lgkmcnt(12)
    v_mfma_f32_16x16x32_bf16 v[12:15], v[204:207], v[184:187], v[12:15]
    v_add_u32 v236, 98304, v240
    v_add_u32 v237, 98304, v241
    v_add_u32 v238, 98304, v242
    v_cvt_pk_bf16_f32 v131, v134, v135
    buffer_store_dwordx4 v[128:131], v249, s[28:31], s75 offen offset:3072 sc1
    s_waitcnt lgkmcnt(10)
    v_mfma_f32_16x16x32_bf16 v[16:19], v[208:211], v[184:187], v[16:19]
    ds_read_b128 v[136:139], v232 offset:0
    ds_read_b64_tr_b16 v[152:153], v235 offset:0
    ds_read_b64_tr_b16 v[154:155], v235 offset:4096
    buffer_load_dwordx4 v[44:47], v248, s[28:31], 0 offen offset:0 sc1
    buffer_load_dwordx4 v[52:55], v248, s[28:31], 0 offen offset:1024 sc1
    s_waitcnt lgkmcnt(11)
    v_mfma_f32_16x16x32_bf16 v[20:23], v[212:215], v[184:187], v[20:23]
    ds_read_b64_tr_b16 v[156:157], v236 offset:0
    ds_read_b64_tr_b16 v[158:159], v236 offset:4096
    ds_read_b64_tr_b16 v[160:161], v237 offset:0
    buffer_load_dwordx4 v[60:63], v248, s[28:31], s83 offen offset:0 sc1
    buffer_load_dwordx4 v[68:71], v248, s[28:31], s83 offen offset:1024 sc1
    s_waitcnt lgkmcnt(12)
    v_mfma_f32_16x16x32_bf16 v[24:27], v[216:219], v[184:187], v[24:27]
    ds_read_b64_tr_b16 v[162:163], v237 offset:4096
    ds_read_b64_tr_b16 v[164:165], v238 offset:0
    buffer_load_dwordx4 v[76:79], v247, s[28:31], 0 offen offset:0 sc1
    buffer_load_dwordx4 v[84:87], v247, s[28:31], 0 offen offset:64 sc1
    s_waitcnt lgkmcnt(12)
    v_mfma_f32_16x16x32_bf16 v[28:31], v[220:223], v[184:187], v[28:31]
    ds_read_b64_tr_b16 v[166:167], v238 offset:4096
    ds_read_b64_tr_b16 v[168:169], v235 offset:16384
    ds_read_b64_tr_b16 v[170:171], v235 offset:20480
    buffer_load_dwordx4 v[92:95], v247, s[28:31], 0 offen offset:128 sc1
    buffer_load_dwordx4 v[100:103], v247, s[28:31], 0 offen offset:192 sc1
    s_waitcnt lgkmcnt(13)
    v_mfma_f32_16x16x32_bf16 v[32:35], v[224:227], v[184:187], v[32:35]
    ds_read_b64_tr_b16 v[172:173], v236 offset:16384
    ds_read_b64_tr_b16 v[174:175], v236 offset:20480
    ds_read_b64_tr_b16 v[176:177], v237 offset:16384
    buffer_load_dwordx4 v[108:111], v247, s[28:31], 0 offen offset:512 sc1
    buffer_load_dwordx4 v[116:119], v247, s[28:31], 0 offen offset:576 sc1
    s_waitcnt lgkmcnt(14)
    v_mfma_f32_16x16x32_bf16 v[36:39], v[228:231], v[184:187], v[36:39]
    ds_read_b64_tr_b16 v[178:179], v237 offset:20480
    ds_read_b64_tr_b16 v[180:181], v238 offset:16384
    ds_read_b64_tr_b16 v[182:183], v238 offset:20480
    buffer_load_dwordx4 v[124:127], v247, s[28:31], 0 offen offset:640 sc1
    buffer_load_dwordx4 v[132:135], v247, s[28:31], 0 offen offset:704 sc1
    s_waitcnt lgkmcnt(14)
    v_mfma_f32_16x16x32_bf16 v[8:11], v[152:155], v[136:139], v[8:11]
    ds_read_b128 v[184:187], v232 offset:1024
    ds_read_b64_tr_b16 v[200:201], v235 offset:8192
    s_waitcnt lgkmcnt(14)
    v_mfma_f32_16x16x32_bf16 v[12:15], v[156:159], v[136:139], v[12:15]
    ds_read_b64_tr_b16 v[202:203], v235 offset:12288
    ds_read_b64_tr_b16 v[204:205], v236 offset:8192
    s_waitcnt lgkmcnt(14)
    v_mfma_f32_16x16x32_bf16 v[16:19], v[160:163], v[136:139], v[16:19]
    ds_read_b64_tr_b16 v[206:207], v236 offset:12288
    ds_read_b64_tr_b16 v[208:209], v237 offset:8192
    s_waitcnt lgkmcnt(14)
    v_mfma_f32_16x16x32_bf16 v[20:23], v[164:167], v[136:139], v[20:23]
    ds_read_b64_tr_b16 v[210:211], v237 offset:12288
    ds_read_b64_tr_b16 v[212:213], v238 offset:8192
    s_waitcnt lgkmcnt(14)
    v_mfma_f32_16x16x32_bf16 v[24:27], v[168:171], v[136:139], v[24:27]
    ds_read_b64_tr_b16 v[214:215], v238 offset:12288
    ds_read_b64_tr_b16 v[216:217], v235 offset:24576
    s_waitcnt lgkmcnt(14)
    v_mfma_f32_16x16x32_bf16 v[28:31], v[172:175], v[136:139], v[28:31]
    ds_read_b64_tr_b16 v[218:219], v235 offset:28672
    ds_read_b64_tr_b16 v[220:221], v236 offset:24576
    s_waitcnt lgkmcnt(14)
    v_mfma_f32_16x16x32_bf16 v[32:35], v[176:179], v[136:139], v[32:35]
    ds_read_b64_tr_b16 v[222:223], v236 offset:28672
    ds_read_b64_tr_b16 v[224:225], v237 offset:24576
    s_waitcnt lgkmcnt(14)
    v_mfma_f32_16x16x32_bf16 v[36:39], v[180:183], v[136:139], v[36:39]
    ds_read_b64_tr_b16 v[226:227], v237 offset:28672
    ds_read_b64_tr_b16 v[228:229], v238 offset:24576
    ds_read_b64_tr_b16 v[230:231], v238 offset:28672
    s_waitcnt lgkmcnt(14)
    v_mfma_f32_16x16x32_bf16 v[8:11], v[200:203], v[184:187], v[8:11]
    v_add_u32 v232, 0, v233
    v_add_u32 v235, 0, v239
    s_waitcnt lgkmcnt(12)
    v_mfma_f32_16x16x32_bf16 v[12:15], v[204:207], v[184:187], v[12:15]
    v_add_u32 v236, 0, v240
    v_add_u32 v237, 0, v241
    v_add_u32 v238, 0, v242
    s_waitcnt lgkmcnt(10)
    v_mfma_f32_16x16x32_bf16 v[16:19], v[208:211], v[184:187], v[16:19]
    ds_read_b128 v[136:139], v232 offset:0
    ds_read_b64_tr_b16 v[152:153], v235 offset:0
    ds_read_b64_tr_b16 v[154:155], v235 offset:4096
    s_waitcnt lgkmcnt(11)
    v_mfma_f32_16x16x32_bf16 v[20:23], v[212:215], v[184:187], v[20:23]
    ds_read_b64_tr_b16 v[156:157], v236 offset:0
    ds_read_b64_tr_b16 v[158:159], v236 offset:4096
    ds_read_b64_tr_b16 v[160:161], v237 offset:0
    s_waitcnt lgkmcnt(12)
    v_mfma_f32_16x16x32_bf16 v[24:27], v[216:219], v[184:187], v[24:27]
    ds_read_b64_tr_b16 v[162:163], v237 offset:4096
    ds_read_b64_tr_b16 v[164:165], v238 offset:0
    s_waitcnt lgkmcnt(12)
    v_mfma_f32_16x16x32_bf16 v[28:31], v[220:223], v[184:187], v[28:31]
    ds_read_b64_tr_b16 v[166:167], v238 offset:4096
    ds_read_b64_tr_b16 v[168:169], v235 offset:16384
    ds_read_b64_tr_b16 v[170:171], v235 offset:20480
    s_waitcnt lgkmcnt(13)
    v_mfma_f32_16x16x32_bf16 v[32:35], v[224:227], v[184:187], v[32:35]
    ds_read_b64_tr_b16 v[172:173], v236 offset:16384
    ds_read_b64_tr_b16 v[174:175], v236 offset:20480
    ds_read_b64_tr_b16 v[176:177], v237 offset:16384
    s_waitcnt lgkmcnt(14)
    v_mfma_f32_16x16x32_bf16 v[36:39], v[228:231], v[184:187], v[36:39]
    ds_read_b64_tr_b16 v[178:179], v237 offset:20480
    ds_read_b64_tr_b16 v[180:181], v238 offset:16384
    ds_read_b64_tr_b16 v[182:183], v238 offset:20480
    s_waitcnt lgkmcnt(14)
    v_mfma_f32_16x16x32_bf16 v[8:11], v[152:155], v[136:139], v[8:11]
    ds_read_b128 v[184:187], v232 offset:1024
    ds_read_b64_tr_b16 v[200:201], v235 offset:8192
    s_waitcnt lgkmcnt(14)
    v_mfma_f32_16x16x32_bf16 v[12:15], v[156:159], v[136:139], v[12:15]
    ds_read_b64_tr_b16 v[202:203], v235 offset:12288
    ds_read_b64_tr_b16 v[204:205], v236 offset:8192
    s_waitcnt lgkmcnt(14)
    v_mfma_f32_16x16x32_bf16 v[16:19], v[160:163], v[136:139], v[16:19]
    ds_read_b64_tr_b16 v[206:207], v236 offset:12288
    ds_read_b64_tr_b16 v[208:209], v237 offset:8192
    s_waitcnt lgkmcnt(14)
    v_mfma_f32_16x16x32_bf16 v[20:23], v[164:167], v[136:139], v[20:23]
    ds_read_b64_tr_b16 v[210:211], v237 offset:12288
    ds_read_b64_tr_b16 v[212:213], v238 offset:8192
    s_waitcnt lgkmcnt(14)
    v_mfma_f32_16x16x32_bf16 v[24:27], v[168:171], v[136:139], v[24:27]
    ds_read_b64_tr_b16 v[214:215], v238 offset:12288
    ds_read_b64_tr_b16 v[216:217], v235 offset:24576
    s_waitcnt lgkmcnt(14)
    v_mfma_f32_16x16x32_bf16 v[28:31], v[172:175], v[136:139], v[28:31]
    ds_read_b64_tr_b16 v[218:219], v235 offset:28672
    ds_read_b64_tr_b16 v[220:221], v236 offset:24576
    s_waitcnt lgkmcnt(14)
    v_mfma_f32_16x16x32_bf16 v[32:35], v[176:179], v[136:139], v[32:35]
    ds_read_b64_tr_b16 v[222:223], v236 offset:28672
    ds_read_b64_tr_b16 v[224:225], v237 offset:24576
    s_waitcnt lgkmcnt(14)
    v_mfma_f32_16x16x32_bf16 v[36:39], v[180:183], v[136:139], v[36:39]
    ds_read_b64_tr_b16 v[226:227], v237 offset:28672
    ds_read_b64_tr_b16 v[228:229], v238 offset:24576
    ds_read_b64_tr_b16 v[230:231], v238 offset:28672
    s_waitcnt lgkmcnt(14)
    v_mfma_f32_16x16x32_bf16 v[8:11], v[200:203], v[184:187], v[8:11]
    s_waitcnt lgkmcnt(12)
    v_mfma_f32_16x16x32_bf16 v[12:15], v[204:207], v[184:187], v[12:15]
    s_waitcnt lgkmcnt(10)
    v_mfma_f32_16x16x32_bf16 v[16:19], v[208:211], v[184:187], v[16:19]
    s_waitcnt lgkmcnt(8)
    v_mfma_f32_16x16x32_bf16 v[20:23], v[212:215], v[184:187], v[20:23]
    s_waitcnt lgkmcnt(6)
    v_mfma_f32_16x16x32_bf16 v[24:27], v[216:219], v[184:187], v[24:27]
    s_waitcnt lgkmcnt(4)
    v_mfma_f32_16x16x32_bf16 v[28:31], v[220:223], v[184:187], v[28:31]
    s_waitcnt lgkmcnt(2)
    v_mfma_f32_16x16x32_bf16 v[32:35], v[224:227], v[184:187], v[32:35]
    s_waitcnt lgkmcnt(0)
    v_mfma_f32_16x16x32_bf16 v[36:39], v[228:231], v[184:187], v[36:39]
    s_waitcnt vmcnt(20)
    s_atomic_swap s0, s[26:27], s77
    s_waitcnt vmcnt(16)
    s_atomic_swap s0, s[26:27], s78
    s_waitcnt vmcnt(12)
    s_atomic_swap s0, s[26:27], s79
    s_mov_b32 s3, 0x40000
    s_mov_b32 s88, 0
M_fchk:
    s_load_dword s84, s[62:63], 0 glc
    s_load_dword s85, s[62:63], 128 glc
    s_load_dword s86, s[62:63], 256 glc
    s_sub_u32 s3, s3, 1
    s_cbranch_scc1 M_fgo
    s_waitcnt lgkmcnt(0)
    s_cmp_lg_u32 s84, s0
    s_cbranch_scc1 M_fn0
    s_bitcmp1_b32 s88, 0
    s_cbranch_scc1 M_fn0
    s_bitset1_b32 s88, 0
    buffer_load_dwordx4 v[184:187], v249, s[28:31], s80 offen offset:0 sc1
    buffer_load_dwordx4 v[196:199], v249, s[28:31], s80 offen offset:1024 sc1
    buffer_load_dwordx4 v[208:211], v249, s[28:31], s80 offen offset:2048 sc1
    buffer_load_dwordx4 v[220:223], v249, s[28:31], s80 offen offset:3072 sc1
M_fn0:
    s_cmp_lg_u32 s85, s0
    s_cbranch_scc1 M_fn1
    s_bitcmp1_b32 s88, 1
    s_cbranch_scc1 M_fn1
    s_bitset1_b32 s88, 1
    buffer_load_dwordx4 v[188:191], v249, s[28:31], s81 offen offset:0 sc1
    buffer_load_dwordx4 v[200:203], v249, s[28:31], s81 offen offset:1024 sc1
    buffer_load_dwordx4 v[212:215], v249, s[28:31], s81 offen offset:2048 sc1
    buffer_load_dwordx4 v[224:227], v249, s[28:31], s81 offen offset:3072 sc1
M_fn1:
    s_cmp_lg_u32 s86, s0
    s_cbranch_scc1 M_fn2
    s_bitcmp1_b32 s88, 2
    s_cbranch_scc1 M_fn2
    s_bitset1_b32 s88, 2
    buffer_load_dwordx4 v[192:195], v249, s[28:31], s82 offen offset:0 sc1
    buffer_load_dwordx4 v[204:207], v249, s[28:31], s82 offen offset:1024 sc1
    buffer_load_dwordx4 v[216:219], v249, s[28:31], s82 offen offset:2048 sc1
    buffer_load_dwordx4 v[228:231], v249, s[28:31], s82 offen offset:3072 sc1
M_fn2:
    s_cmp_lg_u32 s88, 7
    s_cbranch_scc1 M_fchk
M_fgo:
    s_movk_i32 s88, 16384
    s_waitcnt vmcnt(3)
    v_lshlrev_b32 v160, 16, v44
    v_and_b32 v161, 0xffff0000, v44
    v_lshlrev_b32 v162, 16, v45
    v_and_b32 v163, 0xffff0000, v45
    v_lshlrev_b32 v164, 16, v46
    v_and_b32 v165, 0xffff0000, v46
    v_lshlrev_b32 v166, 16, v47
    v_and_b32 v167, 0xffff0000, v47
    v_lshlrev_b32 v136, 16, v184
    v_and_b32 v137, 0xffff0000, v184
    v_lshlrev_b32 v138, 16, v185
    v_and_b32 v139, 0xffff0000, v185
    v_lshlrev_b32 v140, 16, v186
    v_and_b32 v141, 0xffff0000, v186
    v_lshlrev_b32 v142, 16, v187
    v_and_b32 v143, 0xffff0000, v187
    v_lshlrev_b32 v144, 16, v188
    v_and_b32 v145, 0xffff0000, v188
    v_lshlrev_b32 v146, 16, v189
    v_and_b32 v147, 0xffff0000, v189
    v_lshlrev_b32 v148, 16, v190
    v_and_b32 v149, 0xffff0000, v190
    v_lshlrev_b32 v150, 16, v191
    v_and_b32 v151, 0xffff0000, v191
    v_lshlrev_b32 v152, 16, v192
    v_and_b32 v153, 0xffff0000, v192
    v_lshlrev_b32 v154, 16, v193
    v_and_b32 v155, 0xffff0000, v193
    v_lshlrev_b32 v156, 16, v194
    v_and_b32 v157, 0xffff0000, v194
    v_lshlrev_b32 v158, 16, v195
    v_and_b32 v159, 0xffff0000, v195
    v_pk_add_f32 v[8:9], v[8:9], v[136:137]
    v_pk_add_f32 v[144:145], v[144:145], v[152:153]
    v_pk_add_f32 v[10:11], v[10:11], v[138:139]
    v_pk_add_f32 v[146:147], v[146:147], v[154:155]
    v_pk_add_f32 v[12:13], v[12:13], v[140:141]
    v_pk_add_f32 v[148:149], v[148:149], v[156:157]
    v_pk_add_f32 v[14:15], v[14:15], v[142:143]
    v_pk_add_f32 v[150:151], v[150:151], v[158:159]
    v_pk_add_f32 v[8:9], v[8:9], v[144:145]
    v_pk_add_f32 v[10:11], v[10:11], v[146:147]
    v_pk_add_f32 v[12:13], v[12:13], v[148:149]
    v_pk_add_f32 v[14:15], v[14:15], v[150:151]
    v_pk_fma_f32 v[8:9], v[8:9], v[76:77], v[160:161]
    v_pk_fma_f32 v[10:11], v[10:11], v[78:79], v[162:163]
    v_pk_fma_f32 v[12:13], v[12:13], v[84:85], v[164:165]
    v_pk_fma_f32 v[14:15], v[14:15], v[86:87], v[166:167]
    v_cvt_pk_bf16_f32 v44, v8, v9
    v_cvt_pk_bf16_f32 v45, v10, v11
    v_cvt_pk_bf16_f32 v46, v12, v13
    v_cvt_pk_bf16_f32 v47, v14, v15
    s_nop 0
    v_permlane16_swap_b32 v44, v46
    v_permlane16_swap_b32 v45, v47
    buffer_store_dwordx4 v[44:47], v246, s[40:43], 0 offen offset:0
    s_waitcnt vmcnt(3)
    v_lshlrev_b32 v160, 16, v52
    v_and_b32 v161, 0xffff0000, v52
    v_lshlrev_b32 v162, 16, v53
    v_and_b32 v163, 0xffff0000, v53
    v_lshlrev_b32 v164, 16, v54
    v_and_b32 v165, 0xffff0000, v54
    v_lshlrev_b32 v166, 16, v55
    v_and_b32 v167, 0xffff0000, v55
    v_lshlrev_b32 v136, 16, v196
    v_and_b32 v137, 0xffff0000, v196
    v_lshlrev_b32 v138, 16, v197
    v_and_b32 v139, 0xffff0000, v197
    v_lshlrev_b32 v140, 16, v198
    v_and_b32 v141, 0xffff0000, v198
    v_lshlrev_b32 v142, 16, v199
    v_and_b32 v143, 0xffff0000, v199
    v_lshlrev_b32 v144, 16, v200
    v_and_b32 v145, 0xffff0000, v200
    v_lshlrev_b32 v146, 16, v201
    v_and_b32 v147, 0xffff0000, v201
    v_lshlrev_b32 v148, 16, v202
    v_and_b32 v149, 0xffff0000, v202
    v_lshlrev_b32 v150, 16, v203
    v_and_b32 v151, 0xffff0000, v203
    v_lshlrev_b32 v152, 16, v204
    v_and_b32 v153, 0xffff0000, v204
    v_lshlrev_b32 v154, 16, v205
    v_and_b32 v155, 0xffff0000, v205
    v_lshlrev_b32 v156, 16, v206
    v_and_b32 v157, 0xffff0000, v206
    v_lshlrev_b32 v158, 16, v207
    v_and_b32 v159, 0xffff0000, v207
    v_pk_add_f32 v[16:17], v[16:17], v[136:137]
    v_pk_add_f32 v[144:145], v[144:145], v[152:153]
    v_pk_add_f32 v[18:19], v[18:19], v[138:139]
    v_pk_add_f32 v[146:147], v[146:147], v[154:155]
    v_pk_add_f32 v[20:21], v[20:21], v[140:141]
    v_pk_add_f32 v[148:149], v[148:149], v[156:157]
    v_pk_add_f32 v[22:23], v[22:23], v[142:143]
    v_pk_add_f32 v[150:151], v[150:151], v[158:159]
    v_pk_add_f32 v[16:17], v[16:17], v[144:145]
    v_pk_add_f32 v[18:19], v[18:19], v[146:147]
    v_pk_add_f32 v[20:21], v[20:21], v[148:149]
    v_pk_add_f32 v[22:23], v[22:23], v[150:151]
    v_pk_fma_f32 v[16:17], v[16:17], v[92:93], v[160:161]
    v_pk_fma_f32 v[18:19], v[18:19], v[94:95], v[162:163]
    v_pk_fma_f32 v[20:21], v[20:21], v[100:101], v[164:165]
    v_pk_fma_f32 v[22:23], v[22:23], v[102:103], v[166:167]
    v_cvt_pk_bf16_f32 v52, v16, v17
    v_cvt_pk_bf16_f32 v53, v18, v19
    v_cvt_pk_bf16_f32 v54, v20, v21
    v_cvt_pk_bf16_f32 v55, v22, v23
    s_nop 0
    v_permlane16_swap_b32 v52, v54
    v_permlane16_swap_b32 v53, v55
    buffer_store_dwordx4 v[52:55], v246, s[40:43], 0 offen offset:64
    s_waitcnt vmcnt(3)
    v_lshlrev_b32 v160, 16, v60
    v_and_b32 v161, 0xffff0000, v60
    v_lshlrev_b32 v162, 16, v61
    v_and_b32 v163, 0xffff0000, v61
    v_lshlrev_b32 v164, 16, v62
    v_and_b32 v165, 0xffff0000, v62
    v_lshlrev_b32 v166, 16, v63
    v_and_b32 v167, 0xffff0000, v63
    v_lshlrev_b32 v136, 16, v208
    v_and_b32 v137, 0xffff0000, v208
    v_lshlrev_b32 v138, 16, v209
    v_and_b32 v139, 0xffff0000, v209
    v_lshlrev_b32 v140, 16, v210
    v_and_b32 v141, 0xffff0000, v210
    v_lshlrev_b32 v142, 16, v211
    v_and_b32 v143, 0xffff0000, v211
    v_lshlrev_b32 v144, 16, v212
    v_and_b32 v145, 0xffff0000, v212
    v_lshlrev_b32 v146, 16, v213
    v_and_b32 v147, 0xffff0000, v213
    v_lshlrev_b32 v148, 16, v214
    v_and_b32 v149, 0xffff0000, v214
    v_lshlrev_b32 v150, 16, v215
    v_and_b32 v151, 0xffff0000, v215
    v_lshlrev_b32 v152, 16, v216
    v_and_b32 v153, 0xffff0000, v216
    v_lshlrev_b32 v154, 16, v217
    v_and_b32 v155, 0xffff0000, v217
    v_lshlrev_b32 v156, 16, v218
    v_and_b32 v157, 0xffff0000, v218
    v_lshlrev_b32 v158, 16, v219
    v_and_b32 v159, 0xffff0000, v219
    v_pk_add_f32 v[24:25], v[24:25], v[136:137]
    v_pk_add_f32 v[144:145], v[144:145], v[152:153]
    v_pk_add_f32 v[26:27], v[26:27], v[138:139]
    v_pk_add_f32 v[146:147], v[146:147], v[154:155]
    v_pk_add_f32 v[28:29], v[28:29], v[140:141]
    v_pk_add_f32 v[148:149], v[148:149], v[156:157]
    v_pk_add_f32 v[30:31], v[30:31], v[142:143]
    v_pk_add_f32 v[150:151], v[150:151], v[158:159]
    v_pk_add_f32 v[24:25], v[24:25], v[144:145]
    v_pk_add_f32 v[26:27], v[26:27], v[146:147]
    v_pk_add_f32 v[28:29], v[28:29], v[148:149]
    v_pk_add_f32 v[30:31], v[30:31], v[150:151]
    v_pk_fma_f32 v[24:25], v[24:25], v[108:109], v[160:161]
    v_pk_fma_f32 v[26:27], v[26:27], v[110:111], v[162:163]
    v_pk_fma_f32 v[28:29], v[28:29], v[116:117], v[164:165]
    v_pk_fma_f32 v[30:31], v[30:31], v[118:119], v[166:167]
    v_cvt_pk_bf16_f32 v60, v24, v25
    v_cvt_pk_bf16_f32 v61, v26, v27
    v_cvt_pk_bf16_f32 v62, v28, v29
    v_cvt_pk_bf16_f32 v63, v30, v31
    s_nop 0
    v_permlane16_swap_b32 v60, v62
    v_permlane16_swap_b32 v61, v63
    buffer_store_dwordx4 v[60:63], v246, s[40:43], 0 offen offset:256
    s_waitcnt vmcnt(3)
    v_lshlrev_b32 v160, 16, v68
    v_and_b32 v161, 0xffff0000, v68
    v_lshlrev_b32 v162, 16, v69
    v_and_b32 v163, 0xffff0000, v69
    v_lshlrev_b32 v164, 16, v70
    v_and_b32 v165, 0xffff0000, v70
    v_lshlrev_b32 v166, 16, v71
    v_and_b32 v167, 0xffff0000, v71
    v_lshlrev_b32 v136, 16, v220
    v_and_b32 v137, 0xffff0000, v220
    v_lshlrev_b32 v138, 16, v221
    v_and_b32 v139, 0xffff0000, v221
    v_lshlrev_b32 v140, 16, v222
    v_and_b32 v141, 0xffff0000, v222
    v_lshlrev_b32 v142, 16, v223
    v_and_b32 v143, 0xffff0000, v223
    v_lshlrev_b32 v144, 16, v224
    v_and_b32 v145, 0xffff0000, v224
    v_lshlrev_b32 v146, 16, v225
    v_and_b32 v147, 0xffff0000, v225
    v_lshlrev_b32 v148, 16, v226
    v_and_b32 v149, 0xffff0000, v226
    v_lshlrev_b32 v150, 16, v227
    v_and_b32 v151, 0xffff0000, v227
    v_lshlrev_b32 v152, 16, v228
    v_and_b32 v153, 0xffff0000, v228
    v_lshlrev_b32 v154, 16, v229
    v_and_b32 v155, 0xffff0000, v229
    v_lshlrev_b32 v156, 16, v230
    v_and_b32 v157, 0xffff0000, v230
    v_lshlrev_b32 v158, 16, v231
    v_and_b32 v159, 0xffff0000, v231
    v_pk_add_f32 v[32:33], v[32:33], v[136:137]
    v_pk_add_f32 v[144:145], v[144:145], v[152:153]
    v_pk_add_f32 v[34:35], v[34:35], v[138:139]
    v_pk_add_f32 v[146:147], v[146:147], v[154:155]
    v_pk_add_f32 v[36:37], v[36:37], v[140:141]
    v_pk_add_f32 v[148:149], v[148:149], v[156:157]
    v_pk_add_f32 v[38:39], v[38:39], v[142:143]
    v_pk_add_f32 v[150:151], v[150:151], v[158:159]
    v_pk_add_f32 v[32:33], v[32:33], v[144:145]
    v_pk_add_f32 v[34:35], v[34:35], v[146:147]
    v_pk_add_f32 v[36:37], v[36:37], v[148:149]
    v_pk_add_f32 v[38:39], v[38:39], v[150:151]
    v_pk_fma_f32 v[32:33], v[32:33], v[124:125], v[160:161]
    v_pk_fma_f32 v[34:35], v[34:35], v[126:127], v[162:163]
    v_pk_fma_f32 v[36:37], v[36:37], v[132:133], v[164:165]
    v_pk_fma_f32 v[38:39], v[38:39], v[134:135], v[166:167]
    v_cvt_pk_bf16_f32 v68, v32, v33
    v_cvt_pk_bf16_f32 v69, v34, v35
    v_cvt_pk_bf16_f32 v70, v36, v37
    v_cvt_pk_bf16_f32 v71, v38, v39
    s_nop 0
    v_permlane16_swap_b32 v68, v70
    v_permlane16_swap_b32 v69, v71
    buffer_store_dwordx4 v[68:71], v246, s[40:43], 0 offen offset:320
    s_branch M_fin
M_Pidle:
    s_nop 7
    s_barrier
    s_lshl_b32 s70, s48, 12
    s_lshl_b32 s64, s47, 3
    s_lshl_b32 s65, s45, 2
    s_add_u32 s64, s64, s65
    s_mul_i32 s64, s64, 114688
    s_add_u32 s64, s64, s70
    s_lshl_b32 s65, s46, 11
    s_add_u32 s64, s64, s65
    s_add_u32 s64, s64, 0x1500000
    v_lshl_add_u32 v198, v1, 4, s64
    v_mul_f32 v24, v8, v24
    v_exp_f32 v216, -v8
    v_mul_f32 v25, v9, v25
    v_exp_f32 v217, -v9
    v_mul_f32 v26, v10, v26
    v_exp_f32 v218, -v10
    v_mul_f32 v27, v11, v27
    v_exp_f32 v219, -v11
    v_mul_f32 v28, v12, v28
    v_exp_f32 v220, -v12
    v_mul_f32 v29, v13, v29
    v_exp_f32 v221, -v13
    v_mul_f32 v30, v14, v30
    v_exp_f32 v222, -v14
    v_mul_f32 v31, v15, v31
    v_exp_f32 v223, -v15
    v_fma_f32 v216, v216, s67, s67
    v_fma_f32 v217, v217, s67, s67
    v_rcp_f32 v216, v216
    v_fma_f32 v218, v218, s67, s67
    v_rcp_f32 v217, v217
    v_fma_f32 v219, v219, s67, s67
    v_rcp_f32 v218, v218
    v_fma_f32 v220, v220, s67, s67
    v_rcp_f32 v219, v219
    v_fma_f32 v221, v221, s67, s67
    v_rcp_f32 v220, v220
    v_fma_f32 v222, v222, s67, s67
    v_rcp_f32 v221, v221
    v_fma_f32 v223, v223, s67, s67
    v_rcp_f32 v222, v222
    v_rcp_f32 v223, v223
    v_mul_f32 v24, v24, v216
    v_mul_f32 v25, v25, v217
    v_mul_f32 v26, v26, v218
    v_mul_f32 v27, v27, v219
    v_mul_f32 v28, v28, v220
    v_mul_f32 v29, v29, v221
    v_mul_f32 v30, v30, v222
    v_mul_f32 v31, v31, v223
    v_cvt_pk_bf16_f32 v200, v24, v25
    v_cvt_pk_bf16_f32 v201, v26, v27
    v_cvt_pk_bf16_f32 v202, v28, v29
    v_cvt_pk_bf16_f32 v203, v30, v31
    buffer_store_dwordx4 v[200:203], v198, s[28:31], 0 offen offset:0 sc1
    v_mul_f32 v32, v16, v32
    v_exp_f32 v224, -v16
    v_mul_f32 v33, v17, v33
    v_exp_f32 v225, -v17
    v_mul_f32 v34, v18, v34
    v_exp_f32 v226, -v18
    v_mul_f32 v35, v19, v35
    v_exp_f32 v227, -v19
    v_mul_f32 v36, v20, v36
    v_exp_f32 v228, -v20
    v_mul_f32 v37, v21, v37
    v_exp_f32 v229, -v21
    v_mul_f32 v38, v22, v38
    v_exp_f32 v230, -v22
    v_mul_f32 v39, v23, v39
    v_exp_f32 v231, -v23
    v_fma_f32 v224, v224, s67, s67
    v_fma_f32 v225, v225, s67, s67
    v_rcp_f32 v224, v224
    v_fma_f32 v226, v226, s67, s67
    v_rcp_f32 v225, v225
    v_fma_f32 v227, v227, s67, s67
    v_rcp_f32 v226, v226
    v_fma_f32 v228, v228, s67, s67
    v_rcp_f32 v227, v227
    v_fma_f32 v229, v229, s67, s67
    v_rcp_f32 v228, v228
    v_fma_f32 v230, v230, s67, s67
    v_rcp_f32 v229, v229
    v_fma_f32 v231, v231, s67, s67
    v_rcp_f32 v230, v230
    v_rcp_f32 v231, v231
    v_mul_f32 v32, v32, v224
    v_mul_f32 v33, v33, v225
    v_mul_f32 v34, v34, v226
    v_mul_f32 v35, v35, v227
    v_mul_f32 v36, v36, v228
    v_mul_f32 v37, v37, v229
    v_mul_f32 v38, v38, v230
    v_mul_f32 v39, v39, v231
    v_cvt_pk_bf16_f32 v204, v32, v33
    v_cvt_pk_bf16_f32 v205, v34, v35
    v_cvt_pk_bf16_f32 v206, v36, v37
    v_cvt_pk_bf16_f32 v207, v38, v39
    buffer_store_dwordx4 v[204:207], v198, s[28:31], 0 offen offset:1024 sc1
    v_add_u32 v198, 114688, v198
    v_mul_f32 v56, v40, v56
    v_exp_f32 v216, -v40
    v_mul_f32 v57, v41, v57
    v_exp_f32 v217, -v41
    v_mul_f32 v58, v42, v58
    v_exp_f32 v218, -v42
    v_mul_f32 v59, v43, v59
    v_exp_f32 v219, -v43
    v_mul_f32 v60, v44, v60
    v_exp_f32 v220, -v44
    v_mul_f32 v61, v45, v61
    v_exp_f32 v221, -v45
    v_mul_f32 v62, v46, v62
    v_exp_f32 v222, -v46
    v_mul_f32 v63, v47, v63
    v_exp_f32 v223, -v47
    v_fma_f32 v216, v216, s67, s67
    v_fma_f32 v217, v217, s67, s67
    v_rcp_f32 v216, v216
    v_fma_f32 v218, v218, s67, s67
    v_rcp_f32 v217, v217
    v_fma_f32 v219, v219, s67, s67
    v_rcp_f32 v218, v218
    v_fma_f32 v220, v220, s67, s67
    v_rcp_f32 v219, v219
    v_fma_f32 v221, v221, s67, s67
    v_rcp_f32 v220, v220
    v_fma_f32 v222, v222, s67, s67
    v_rcp_f32 v221, v221
    v_fma_f32 v223, v223, s67, s67
    v_rcp_f32 v222, v222
    v_rcp_f32 v223, v223
    v_mul_f32 v56, v56, v216
    v_mul_f32 v57, v57, v217
    v_mul_f32 v58, v58, v218
    v_mul_f32 v59, v59, v219
    v_mul_f32 v60, v60, v220
    v_mul_f32 v61, v61, v221
    v_mul_f32 v62, v62, v222
    v_mul_f32 v63, v63, v223
    v_cvt_pk_bf16_f32 v208, v56, v57
    v_cvt_pk_bf16_f32 v209, v58, v59
    v_cvt_pk_bf16_f32 v210, v60, v61
    v_cvt_pk_bf16_f32 v211, v62, v63
    buffer_store_dwordx4 v[208:211], v198, s[28:31], 0 offen offset:0 sc1
    v_mul_f32 v64, v48, v64
    v_exp_f32 v224, -v48
    v_mul_f32 v65, v49, v65
    v_exp_f32 v225, -v49
    v_mul_f32 v66, v50, v66
    v_exp_f32 v226, -v50
    v_mul_f32 v67, v51, v67
    v_exp_f32 v227, -v51
    v_mul_f32 v68, v52, v68
    v_exp_f32 v228, -v52
    v_mul_f32 v69, v53, v69
    v_exp_f32 v229, -v53
    v_mul_f32 v70, v54, v70
    v_exp_f32 v230, -v54
    v_mul_f32 v71, v55, v71
    v_exp_f32 v231, -v55
    v_fma_f32 v224, v224, s67, s67
    v_fma_f32 v225, v225, s67, s67
    v_rcp_f32 v224, v224
    v_fma_f32 v226, v226, s67, s67
    v_rcp_f32 v225, v225
    v_fma_f32 v227, v227, s67, s67
    v_rcp_f32 v226, v226
    v_fma_f32 v228, v228, s67, s67
    v_rcp_f32 v227, v227
    v_fma_f32 v229, v229, s67, s67
    v_rcp_f32 v228, v228
    v_fma_f32 v230, v230, s67, s67
    v_rcp_f32 v229, v229
    v_fma_f32 v231, v231, s67, s67
    v_rcp_f32 v230, v230
    v_rcp_f32 v231, v231
    v_mul_f32 v64, v64, v224
    v_mul_f32 v65, v65, v225
    v_mul_f32 v66, v66, v226
    v_mul_f32 v67, v67, v227
    v_mul_f32 v68, v68, v228
    v_mul_f32 v69, v69, v229
    v_mul_f32 v70, v70, v230
    v_mul_f32 v71, v71, v231
    v_cvt_pk_bf16_f32 v212, v64, v65
    v_cvt_pk_bf16_f32 v213, v66, v67
    v_cvt_pk_bf16_f32 v214, v68, v69
    v_cvt_pk_bf16_f32 v215, v70, v71
    buffer_store_dwordx4 v[212:215], v198, s[28:31], 0 offen offset:1024 sc1
    v_add_u32 v198, 114688, v198
    v_mul_f32 v88, v72, v88
    v_exp_f32 v216, -v72
    v_mul_f32 v89, v73, v89
    v_exp_f32 v217, -v73
    v_mul_f32 v90, v74, v90
    v_exp_f32 v218, -v74
    v_mul_f32 v91, v75, v91
    v_exp_f32 v219, -v75
    v_mul_f32 v92, v76, v92
    v_exp_f32 v220, -v76
    v_mul_f32 v93, v77, v93
    v_exp_f32 v221, -v77
    v_mul_f32 v94, v78, v94
    v_exp_f32 v222, -v78
    v_mul_f32 v95, v79, v95
    v_exp_f32 v223, -v79
    v_fma_f32 v216, v216, s67, s67
    v_fma_f32 v217, v217, s67, s67
    v_rcp_f32 v216, v216
    v_fma_f32 v218, v218, s67, s67
    v_rcp_f32 v217, v217
    v_fma_f32 v219, v219, s67, s67
    v_rcp_f32 v218, v218
    v_fma_f32 v220, v220, s67, s67
    v_rcp_f32 v219, v219
    v_fma_f32 v221, v221, s67, s67
    v_rcp_f32 v220, v220
    v_fma_f32 v222, v222, s67, s67
    v_rcp_f32 v221, v221
    v_fma_f32 v223, v223, s67, s67
    v_rcp_f32 v222, v222
    v_rcp_f32 v223, v223
    v_mul_f32 v88, v88, v216
    v_mul_f32 v89, v89, v217
    v_mul_f32 v90, v90, v218
    v_mul_f32 v91, v91, v219
    v_mul_f32 v92, v92, v220
    v_mul_f32 v93, v93, v221
    v_mul_f32 v94, v94, v222
    v_mul_f32 v95, v95, v223
    v_cvt_pk_bf16_f32 v200, v88, v89
    v_cvt_pk_bf16_f32 v201, v90, v91
    v_cvt_pk_bf16_f32 v202, v92, v93
    v_cvt_pk_bf16_f32 v203, v94, v95
    buffer_store_dwordx4 v[200:203], v198, s[28:31], 0 offen offset:0 sc1
    v_mul_f32 v96, v80, v96
    v_exp_f32 v224, -v80
    v_mul_f32 v97, v81, v97
    v_exp_f32 v225, -v81
    v_mul_f32 v98, v82, v98
    v_exp_f32 v226, -v82
    v_mul_f32 v99, v83, v99
    v_exp_f32 v227, -v83
    v_mul_f32 v100, v84, v100
    v_exp_f32 v228, -v84
    v_mul_f32 v101, v85, v101
    v_exp_f32 v229, -v85
    v_mul_f32 v102, v86, v102
    v_exp_f32 v230, -v86
    v_mul_f32 v103, v87, v103
    v_exp_f32 v231, -v87
    v_fma_f32 v224, v224, s67, s67
    v_fma_f32 v225, v225, s67, s67
    v_rcp_f32 v224, v224
    v_fma_f32 v226, v226, s67, s67
    v_rcp_f32 v225, v225
    v_fma_f32 v227, v227, s67, s67
    v_rcp_f32 v226, v226
    v_fma_f32 v228, v228, s67, s67
    v_rcp_f32 v227, v227
    v_fma_f32 v229, v229, s67, s67
    v_rcp_f32 v228, v228
    v_fma_f32 v230, v230, s67, s67
    v_rcp_f32 v229, v229
    v_fma_f32 v231, v231, s67, s67
    v_rcp_f32 v230, v230
    v_rcp_f32 v231, v231
    v_mul_f32 v96, v96, v224
    v_mul_f32 v97, v97, v225
    v_mul_f32 v98, v98, v226
    v_mul_f32 v99, v99, v227
    v_mul_f32 v100, v100, v228
    v_mul_f32 v101, v101, v229
    v_mul_f32 v102, v102, v230
    v_mul_f32 v103, v103, v231
    v_cvt_pk_bf16_f32 v204, v96, v97
    v_cvt_pk_bf16_f32 v205, v98, v99
    v_cvt_pk_bf16_f32 v206, v100, v101
    v_cvt_pk_bf16_f32 v207, v102, v103
    buffer_store_dwordx4 v[204:207], v198, s[28:31], 0 offen offset:1024 sc1
    v_add_u32 v198, 114688, v198
    v_mul_f32 v120, v104, v120
    v_exp_f32 v216, -v104
    v_mul_f32 v121, v105, v121
    v_exp_f32 v217, -v105
    v_mul_f32 v122, v106, v122
    v_exp_f32 v218, -v106
    v_mul_f32 v123, v107, v123
    v_exp_f32 v219, -v107
    v_mul_f32 v124, v108, v124
    v_exp_f32 v220, -v108
    v_mul_f32 v125, v109, v125
    v_exp_f32 v221, -v109
    v_mul_f32 v126, v110, v126
    v_exp_f32 v222, -v110
    v_mul_f32 v127, v111, v127
    v_exp_f32 v223, -v111
    v_fma_f32 v216, v216, s67, s67
    v_fma_f32 v217, v217, s67, s67
    v_rcp_f32 v216, v216
    v_fma_f32 v218, v218, s67, s67
    v_rcp_f32 v217, v217
    v_fma_f32 v219, v219, s67, s67
    v_rcp_f32 v218, v218
    v_fma_f32 v220, v220, s67, s67
    v_rcp_f32 v219, v219
    v_fma_f32 v221, v221, s67, s67
    v_rcp_f32 v220, v220
    v_fma_f32 v222, v222, s67, s67
    v_rcp_f32 v221, v221
    v_fma_f32 v223, v223, s67, s67
    v_rcp_f32 v222, v222
    v_rcp_f32 v223, v223
    v_mul_f32 v120, v120, v216
    v_mul_f32 v121, v121, v217
    v_mul_f32 v122, v122, v218
    v_mul_f32 v123, v123, v219
    v_mul_f32 v124, v124, v220
    v_mul_f32 v125, v125, v221
    v_mul_f32 v126, v126, v222
    v_mul_f32 v127, v127, v223
    v_cvt_pk_bf16_f32 v208, v120, v121
    v_cvt_pk_bf16_f32 v209, v122, v123
    v_cvt_pk_bf16_f32 v210, v124, v125
    v_cvt_pk_bf16_f32 v211, v126, v127
    buffer_store_dwordx4 v[208:211], v198, s[28:31], 0 offen offset:0 sc1
    v_mul_f32 v128, v112, v128
    v_exp_f32 v224, -v112
    v_mul_f32 v129, v113, v129
    v_exp_f32 v225, -v113
    v_mul_f32 v130, v114, v130
    v_exp_f32 v226, -v114
    v_mul_f32 v131, v115, v131
    v_exp_f32 v227, -v115
    v_mul_f32 v132, v116, v132
    v_exp_f32 v228, -v116
    v_mul_f32 v133, v117, v133
    v_exp_f32 v229, -v117
    v_mul_f32 v134, v118, v134
    v_exp_f32 v230, -v118
    v_mul_f32 v135, v119, v135
    v_exp_f32 v231, -v119
    v_fma_f32 v224, v224, s67, s67
    v_fma_f32 v225, v225, s67, s67
    v_rcp_f32 v224, v224
    v_fma_f32 v226, v226, s67, s67
    v_rcp_f32 v225, v225
    v_fma_f32 v227, v227, s67, s67
    v_rcp_f32 v226, v226
    v_fma_f32 v228, v228, s67, s67
    v_rcp_f32 v227, v227
    v_fma_f32 v229, v229, s67, s67
    v_rcp_f32 v228, v228
    v_fma_f32 v230, v230, s67, s67
    v_rcp_f32 v229, v229
    v_fma_f32 v231, v231, s67, s67
    v_rcp_f32 v230, v230
    v_rcp_f32 v231, v231
    v_mul_f32 v128, v128, v224
    v_mul_f32 v129, v129, v225
    v_mul_f32 v130, v130, v226
    v_mul_f32 v131, v131, v227
    v_mul_f32 v132, v132, v228
    v_mul_f32 v133, v133, v229
    v_mul_f32 v134, v134, v230
    v_mul_f32 v135, v135, v231
    v_cvt_pk_bf16_f32 v212, v128, v129
    v_cvt_pk_bf16_f32 v213, v130, v131
    v_cvt_pk_bf16_f32 v214, v132, v133
    v_cvt_pk_bf16_f32 v215, v134, v135
    buffer_store_dwordx4 v[212:215], v198, s[28:31], 0 offen offset:1024 sc1
    s_lshl_b32 s65, s44, 1
    s_xor_b32 s65, s65, s49
    s_lshl_b32 s64, s47, 3
    s_add_u32 s64, s64, s65
    s_mul_i32 s64, s64, 114688
    s_add_u32 s64, s64, 0x1500000
    v_lshl_add_u32 v192, v1, 4, s64
    s_lshl_b32 s65, s44, 1
    s_or_b32 s65, s65, 1
    s_xor_b32 s65, s65, s49
    s_lshl_b32 s64, s47, 3
    s_add_u32 s64, s64, s65
    s_mul_i32 s64, s64, 114688
    s_add_u32 s64, s64, 0x14ff800
    v_lshl_add_u32 v193, v1, 4, s64
    s_lshl_b32 s65, s51, 9
    v_lshrrev_b32 v3, 4, v1
    s_lshl_b32 s64, s44, 4
    v_add_u32 v2, s64, v3
    s_movk_i32 s64, 2048
    v_mul_u32_u24 v2, s64, v2
    v_add_u32 v2, s65, v2
    v_lshlrev_b32 v3, 1, v3
    v_and_b32 v4, 15, v1
    v_xor_b32 v3, v3, v4
    v_lshl_add_u32 v194, v3, 4, v2
    v_add_u32 v196, 14336, v194
    v_xor_b32 v3, 8, v3
    v_lshl_add_u32 v195, v3, 4, v2
    v_add_u32 v195, 7168, v195
    v_add_u32 v197, 14336, v195
    s_lshl_b32 s64, s47, 9
    s_lshl_b32 s65, s49, 7
    s_add_u32 s64, s64, s65
    s_lshl_b32 s65, s51, 4
    s_add_u32 s64, s64, s65
    s_lshl_b32 s65, s44, 2
    s_add_u32 s64, s64, s65
    s_add_u32 s64, s64, 0x50000
    v_mov_b32 v2, s0
    s_waitcnt vmcnt(0)
    s_mov_b64 exec, 1
    buffer_store_dword v2, v234, s[28:31], s64 offen sc1
    s_mov_b64 exec, -1
    s_barrier
    s_lshl_b32 s68, s47, 2
    s_add_u32 s68, s68, s49
    s_lshl_b32 s68, s68, 7
    s_add_u32 s68, s68, 0x50000
    v_min_u32 v234, 60, v234
    buffer_load_dword v245, v234, s[28:31], s68 offen sc1
    s_waitcnt vmcnt(0)
    s_branch M_Pjoin
M_Q:
    v_and_b32 v2, 7, v1
    s_lshl_b32 s64, s44, 3
    v_add_u32 v2, s64, v2
    v_lshrrev_b32 v3, 3, v1
    v_lshlrev_b32 v14, 5, v3
    v_add_u32 v14, 149504, v14
    s_lshl_b32 s64, s48, 7
    v_lshl_add_u32 v4, v3, 4, s64
    s_lshl_b32 s70, s47, 7
    v_add_u32 v12, s70, v2
    v_lshl_add_u32 v8, v12, 11, v4
    s_max_u32 s70, s70, 16
    s_sub_u32 s70, s70, 16
    v_and_b32 v5, 15, v2
    v_add_u32 v13, s70, v5
    v_lshl_add_u32 v9, v13, 11, v4
    v_and_b32 v4, 7, v2
    v_lshlrev_b32 v4, 3, v4
    v_add_u32 v4, 0x10000, v4
    v_lshrrev_b32 v12, 3, v12
    v_lshl_add_u32 v12, v12, 7, v4
    v_lshrrev_b32 v13, 3, v13
    v_lshl_add_u32 v13, v13, 7, v4
    v_lshlrev_b32 v3, 8, v3
    v_lshl_add_u32 v3, v5, 4, v3
    s_mul_i32 s64, s47, 294912
    s_lshl_b32 s65, s48, 11
    s_add_u32 s64, s64, s65
    s_add_u32 s64, s64, 0x100000
    s_cmp_ge_u32 s44, 2
    s_cselect_b32 s65, 0x80000000, s64
    v_add_u32 v11, s65, v3
    s_cselect_b32 s65, 32768, 0
    s_add_u32 s64, s64, s65
    s_add_u32 s64, s64, 32768
    v_add_u32 v10, s64, v3
    v_mov_b32 v19, v3
    s_lshr_b32 s64, s44, 1
    s_lshl_b32 s64, s64, 11
    s_add_u32 s64, s64, 2048
    v_add_u32 v15, s64, v3
    s_mov_b32 s28, s26
    s_mov_b32 s29, s27
    s_mov_b32 s30, 0x3100000
    s_mov_b32 s31, 0x20000
    s_waitcnt vmcnt(0)
    v_lshlrev_b32 v120, 16, v104
    v_and_b32 v121, 0xffff0000, v104
    v_lshlrev_b32 v122, 16, v105
    v_and_b32 v123, 0xffff0000, v105
    v_lshlrev_b32 v124, 16, v106
    v_and_b32 v125, 0xffff0000, v106
    v_lshlrev_b32 v126, 16, v107
    v_and_b32 v127, 0xffff0000, v107
    v_lshlrev_b32 v128, 16, v108
    v_and_b32 v129, 0xffff0000, v108
    v_lshlrev_b32 v130, 16, v109
    v_and_b32 v131, 0xffff0000, v109
    v_lshlrev_b32 v132, 16, v110
    v_and_b32 v133, 0xffff0000, v110
    v_lshlrev_b32 v134, 16, v111
    v_and_b32 v135, 0xffff0000, v111
    v_lshlrev_b32 v136, 16, v112
    v_and_b32 v137, 0xffff0000, v112
    v_lshlrev_b32 v138, 16, v113
    v_and_b32 v139, 0xffff0000, v113
    v_lshlrev_b32 v140, 16, v114
    v_and_b32 v141, 0xffff0000, v114
    v_lshlrev_b32 v142, 16, v115
    v_and_b32 v143, 0xffff0000, v115
    v_lshlrev_b32 v144, 16, v116
    v_and_b32 v145, 0xffff0000, v116
    v_lshlrev_b32 v146, 16, v117
    v_and_b32 v147, 0xffff0000, v117
    v_lshlrev_b32 v148, 16, v118
    v_and_b32 v149, 0xffff0000, v118
    v_lshlrev_b32 v150, 16, v119
    v_and_b32 v151, 0xffff0000, v119
    v_pk_add_f32 v[104:105], v[120:121], v[122:123]
    v_pk_mul_f32 v[108:109], v[120:121], v[120:121]
    v_pk_add_f32 v[106:107], v[136:137], v[138:139]
    v_pk_mul_f32 v[110:111], v[136:137], v[136:137]
    v_pk_fma_f32 v[108:109], v[122:123], v[122:123], v[108:109]
    v_pk_fma_f32 v[110:111], v[138:139], v[138:139], v[110:111]
    v_pk_add_f32 v[104:105], v[104:105], v[124:125]
    v_pk_fma_f32 v[108:109], v[124:125], v[124:125], v[108:109]
    v_pk_add_f32 v[106:107], v[106:107], v[140:141]
    v_pk_fma_f32 v[110:111], v[140:141], v[140:141], v[110:111]
    v_pk_add_f32 v[104:105], v[104:105], v[126:127]
    v_pk_fma_f32 v[108:109], v[126:127], v[126:127], v[108:109]
    v_pk_add_f32 v[106:107], v[106:107], v[142:143]
    v_pk_fma_f32 v[110:111], v[142:143], v[142:143], v[110:111]
    v_pk_add_f32 v[104:105], v[104:105], v[128:129]
    v_pk_fma_f32 v[108:109], v[128:129], v[128:129], v[108:109]
    v_pk_add_f32 v[106:107], v[106:107], v[144:145]
    v_pk_fma_f32 v[110:111], v[144:145], v[144:145], v[110:111]
    v_pk_add_f32 v[104:105], v[104:105], v[130:131]
    v_pk_fma_f32 v[108:109], v[130:131], v[130:131], v[108:109]
    v_pk_add_f32 v[106:107], v[106:107], v[146:147]
    v_pk_fma_f32 v[110:111], v[146:147], v[146:147], v[110:111]
    v_pk_add_f32 v[104:105], v[104:105], v[132:133]
    v_pk_fma_f32 v[108:109], v[132:133], v[132:133], v[108:109]
    v_pk_add_f32 v[106:107], v[106:107], v[148:149]
    v_pk_fma_f32 v[110:111], v[148:149], v[148:149], v[110:111]
    v_pk_add_f32 v[104:105], v[104:105], v[134:135]
    v_pk_fma_f32 v[108:109], v[134:135], v[134:135], v[108:109]
    v_pk_add_f32 v[106:107], v[106:107], v[150:151]
    v_pk_fma_f32 v[110:111], v[150:151], v[150:151], v[110:111]
    v_add_f32 v152, v104, v105
    v_add_f32 v153, v108, v109
    v_add_f32 v156, v106, v107
    v_add_f32 v157, v110, v111
    v_add_f32_dpp v152, v152, v152 quad_perm:[1,0,3,2] row_mask:0xf bank_mask:0xf
    v_add_f32_dpp v153, v153, v153 quad_perm:[1,0,3,2] row_mask:0xf bank_mask:0xf
    v_add_f32_dpp v156, v156, v156 quad_perm:[1,0,3,2] row_mask:0xf bank_mask:0xf
    v_add_f32_dpp v157, v157, v157 quad_perm:[1,0,3,2] row_mask:0xf bank_mask:0xf
    v_add_f32_dpp v152, v152, v152 quad_perm:[2,3,0,1] row_mask:0xf bank_mask:0xf
    v_add_f32_dpp v153, v153, v153 quad_perm:[2,3,0,1] row_mask:0xf bank_mask:0xf
    v_add_f32_dpp v156, v156, v156 quad_perm:[2,3,0,1] row_mask:0xf bank_mask:0xf
    v_add_f32_dpp v157, v157, v157 quad_perm:[2,3,0,1] row_mask:0xf bank_mask:0xf
    v_add_f32_dpp v152, v152, v152 row_half_mirror row_mask:0xf bank_mask:0xf
    v_add_f32_dpp v153, v153, v153 row_half_mirror row_mask:0xf bank_mask:0xf
    v_add_f32_dpp v156, v156, v156 row_half_mirror row_mask:0xf bank_mask:0xf
    v_add_f32_dpp v157, v157, v157 row_half_mirror row_mask:0xf bank_mask:0xf
    v_add_f32_dpp v152, v152, v152 row_mirror row_mask:0xf bank_mask:0xf
    v_add_f32_dpp v153, v153, v153 row_mirror row_mask:0xf bank_mask:0xf
    v_add_f32_dpp v156, v156, v156 row_mirror row_mask:0xf bank_mask:0xf
    v_add_f32_dpp v157, v157, v157 row_mirror row_mask:0xf bank_mask:0xf
    v_mov_b32 v154, v152
    v_mov_b32 v155, v153
    v_mov_b32 v158, v156
    v_mov_b32 v159, v157
    v_permlane32_swap_b32 v152, v154
    v_permlane32_swap_b32 v153, v155
    v_permlane32_swap_b32 v156, v158
    v_permlane32_swap_b32 v157, v159
    v_add_f32 v152, v152, v154
    v_add_f32 v153, v153, v155
    v_add_f32 v156, v156, v158
    v_add_f32 v157, v157, v159
    v_mov_b32 v154, v152
    v_mov_b32 v155, v153
    v_mov_b32 v158, v156
    v_mov_b32 v159, v157
    v_permlane16_swap_b32 v152, v154
    v_permlane16_swap_b32 v153, v155
    v_permlane16_swap_b32 v156, v158
    v_permlane16_swap_b32 v157, v159
    v_add_f32 v152, v152, v154
    v_add_f32 v153, v153, v155
    v_add_f32 v156, v156, v158
    v_add_f32 v157, v157, v159
    v_mul_f32 v152, 0x3a800000, v152
    v_mul_f32 v153, 0x3a800000, v153
    v_mul_f32 v156, 0x3a800000, v156
    v_mul_f32 v157, 0x3a800000, v157
    v_fma_f32 v153, -v152, v152, v153
    v_fma_f32 v157, -v156, v156, v157
    v_max_f32 v153, 0, v153
    v_max_f32 v157, 0, v157
    v_cvt_pk_bf16_f32 v154, v152, v153
    v_lshlrev_b32 v152, 16, v154
    v_and_b32 v153, 0xffff0000, v154
    v_cvt_pk_bf16_f32 v158, v156, v157
    v_lshlrev_b32 v156, 16, v158
    v_and_b32 v157, 0xffff0000, v158
    v_add_f32 v153, 0x3727c5ac, v153
    v_add_f32 v157, 0x3727c5ac, v157
    v_cvt_pk_bf16_f32 v154, v153, v153
    v_lshlrev_b32 v153, 16, v154
    v_cvt_pk_bf16_f32 v158, v157, v157
    v_lshlrev_b32 v157, 16, v158
    v_sqrt_f32 v153, v153
    v_sqrt_f32 v157, v157
    v_cvt_pk_bf16_f32 v154, v153, v153
    v_lshlrev_b32 v153, 16, v154
    v_cvt_pk_bf16_f32 v158, v157, v157
    v_lshlrev_b32 v157, 16, v158
    s_waitcnt lgkmcnt(0)
    s_add_u32 s0, s0, 1
    v_lshrrev_b32 v153, 16, v153
    v_or_b32 v160, v152, v153
    v_mov_b32 v161, s0
    v_lshrrev_b32 v157, 16, v157
    v_or_b32 v162, v156, v157
    v_mov_b32 v163, s0
    s_lshl_b32 s64, s44, 4
    s_add_u32 s64, s64, 150528
    v_mov_b32 v2, s64
    v_mov_b32 v3, 148500
    v_mov_b32 v4, 1
    s_mov_b64 exec, 1
    ds_write_b128 v2, v[160:163]
    ds_add_rtn_u32 v5, v3, v4
    s_mov_b64 exec, 0xf
    v_and_b32 v2, 3, v1
    v_lshlrev_b32 v2, 4, v2
    v_add_u32 v3, 150528, v2
    ds_read_b128 v[164:167], v3
    v_lshrrev_b32 v4, 2, v1
    v_lshl_add_u32 v2, v4, 15, v2
    s_lshr_b32 s64, s62, 2
    s_lshl_b32 s64, s64, 7
    s_add_u32 s64, s64, 0x10000
    s_waitcnt lgkmcnt(0)
    v_readfirstlane_b32 s65, v5
    s_nop 3
    s_cmp_eq_u32 s65, 3
    s_cselect_b32 s64, s64, 0x80000000
    v_add_u32 v2, s64, v2
    buffer_store_dwordx4 v[164:167], v2, s[28:31], 0 offen sc1
    s_mov_b64 exec, -1
    s_mov_b32 s64, 0x0
    buffer_load_dwordx4 v[80:83], v8, s[40:43], s64 offen
    s_mov_b32 s64, 0x10000
    buffer_load_dwordx4 v[84:87], v8, s[40:43], s64 offen
    s_mov_b32 s64, 0x20000
    buffer_load_dwordx4 v[88:91], v8, s[40:43], s64 offen
    s_mov_b32 s64, 0x30000
    buffer_load_dwordx4 v[92:95], v8, s[40:43], s64 offen
    buffer_load_dwordx4 v[96:99], v9, s[40:43], 0 offen
    s_mov_b32 s53, 0
    s_lshl_b32 s72, s44, 12
    s_add_u32 s72, s72, 2048
    s_lshl_b32 s73, s44, 9
    s_mul_i32 s74, s44, 6144
    s_add_u32 s74, s74, 18432
    s_add_u32 s75, s74, 4096
    s_bfe_u32 s66, s2, 0x30003
    s_lshr_b32 s55, s2, 6
    s_add_u32 s66, s66, s55
    s_and_b32 s66, s66, 3
    s_mov_b32 s58, 0x76453210
    s_mov_b32 s59, 0xfecdba89
    s_cmp_eq_u32 s66, 1
    s_cselect_b32 s58, 0x75643120, s58
    s_cselect_b32 s59, 0xfdecb9a8, s59
    s_cmp_eq_u32 s66, 2
    s_cselect_b32 s58, 0x67542310, s58
    s_cselect_b32 s59, 0xefdcab98, s59
    s_cmp_eq_u32 s66, 3
    s_cselect_b32 s58, 0x86534210, s58
    s_cselect_b32 s59, 0xfedbca97, s59
    s_and_b32 s66, s48, 15
    s_lshl_b32 s55, s66, 2
    s_lshr_b64 s[56:57], s[58:59], s55
    s_and_b32 s55, s56, 15
    s_lshl_b32 s55, s55, 2
    s_lshl_b64 s[56:57], 15, s55
    s_andn2_b64 s[58:59], s[58:59], s[56:57]
    s_or_b32 s58, s58, s66
    s_lshl_b32 s65, s48, 7
    s_mul_i32 s64, s44, 98304
    s_add_u32 s65, s65, s64
    s_movk_i32 s64, 6144
    v_add_u32 v2, 0, v1
    v_mul_u32_u24 v3, 0xab, v2
    v_lshrrev_b32 v3, 12, v3
    v_mul_u32_u24 v4, 24, v3
    v_sub_u32 v2, v2, v4
    v_and_b32 v4, 2, v3
    v_lshrrev_b32 v5, 3, v3
    v_lshl_or_b32 v4, v5, 2, v4
    v_xor_b32 v2, v2, v4
    v_mul_u32_u24 v3, s64, v3
    v_lshrrev_b32 v4, 3, v2
    v_lshl_add_u32 v3, v4, 11, v3
    v_and_b32 v2, 7, v2
    v_lshl_add_u32 v3, v2, 4, v3
    v_add_u32 v187, s65, v3
    v_add_u32 v2, 64, v1
    v_mul_u32_u24 v3, 0xab, v2
    v_lshrrev_b32 v3, 12, v3
    v_mul_u32_u24 v4, 24, v3
    v_sub_u32 v2, v2, v4
    v_and_b32 v4, 2, v3
    v_lshrrev_b32 v5, 3, v3
    v_lshl_or_b32 v4, v5, 2, v4
    v_xor_b32 v2, v2, v4
    v_mul_u32_u24 v3, s64, v3
    v_lshrrev_b32 v4, 3, v2
    v_lshl_add_u32 v3, v4, 11, v3
    v_and_b32 v2, 7, v2
    v_lshl_add_u32 v3, v2, 4, v3
    v_subrev_u32 v3, 1024, v3
    v_add_u32 v188, s65, v3
    v_add_u32 v2, 128, v1
    v_mul_u32_u24 v3, 0xab, v2
    v_lshrrev_b32 v3, 12, v3
    v_mul_u32_u24 v4, 24, v3
    v_sub_u32 v2, v2, v4
    v_and_b32 v4, 2, v3
    v_lshrrev_b32 v5, 3, v3
    v_lshl_or_b32 v4, v5, 2, v4
    v_xor_b32 v2, v2, v4
    v_mul_u32_u24 v3, s64, v3
    v_lshrrev_b32 v4, 3, v2
    v_lshl_add_u32 v3, v4, 11, v3
    v_and_b32 v2, 7, v2
    v_lshl_add_u32 v3, v2, 4, v3
    v_subrev_u32 v3, 2048, v3
    v_add_u32 v189, s65, v3
    v_add_u32 v2, 192, v1
    v_mul_u32_u24 v3, 0xab, v2
    v_lshrrev_b32 v3, 12, v3
    v_mul_u32_u24 v4, 24, v3
    v_sub_u32 v2, v2, v4
    v_and_b32 v4, 2, v3
    v_lshrrev_b32 v5, 3, v3
    v_lshl_or_b32 v4, v5, 2, v4
    v_xor_b32 v2, v2, v4
    v_mul_u32_u24 v3, s64, v3
    v_lshrrev_b32 v4, 3, v2
    v_lshl_add_u32 v3, v4, 11, v3
    v_and_b32 v2, 7, v2
    v_lshl_add_u32 v3, v2, 4, v3
    v_subrev_u32 v3, 3072, v3
    v_add_u32 v190, s65, v3
    v_add_u32 v2, 256, v1
    v_mul_u32_u24 v3, 0xab, v2
    v_lshrrev_b32 v3, 12, v3
    v_mul_u32_u24 v4, 24, v3
    v_sub_u32 v2, v2, v4
    v_and_b32 v4, 2, v3
    v_lshrrev_b32 v5, 3, v3
    v_lshl_or_b32 v4, v5, 2, v4
    v_xor_b32 v2, v2, v4
    v_mul_u32_u24 v3, s64, v3
    v_lshrrev_b32 v4, 3, v2
    v_lshl_add_u32 v3, v4, 11, v3
    v_and_b32 v2, 7, v2
    v_lshl_add_u32 v3, v2, 4, v3
    v_add_u32 v191, s65, v3
    v_add_u32 v2, 320, v1
    v_mul_u32_u24 v3, 0xab, v2
    v_lshrrev_b32 v3, 12, v3
    v_mul_u32_u24 v4, 24, v3
    v_sub_u32 v2, v2, v4
    v_and_b32 v4, 2, v3
    v_lshrrev_b32 v5, 3, v3
    v_lshl_or_b32 v4, v5, 2, v4
    v_xor_b32 v2, v2, v4
    v_mul_u32_u24 v3, s64, v3
    v_lshrrev_b32 v4, 3, v2
    v_lshl_add_u32 v3, v4, 11, v3
    v_and_b32 v2, 7, v2
    v_lshl_add_u32 v3, v2, 4, v3
    v_subrev_u32 v3, 1024, v3
    v_add_u32 v192, s65, v3
    s_mul_i32 s64, s47, 294912
    s_add_u32 s64, s64, 0x100000
    s_add_u32 s65, s64, s73
    v_lshl_add_u32 v186, v1, 4, s65
    s_mul_i32 s65, s44, 65536
    s_add_u32 s64, s64, s65
    s_add_u32 s64, s64, 32768
    v_lshl_add_u32 v184, v1, 4, s64
    v_add_u32 v185, 30720, v184
    s_mov_b32 s32, s6
    s_mov_b32 s33, s7
    s_mov_b32 s34, 0x600000
    s_mov_b32 s35, 0x20000
    s_lshr_b32 s45, s44, 1
    s_and_b32 s46, s44, 1
    s_lshr_b32 s49, s48, 2
    s_and_b32 s51, s48, 3
    s_cmp_ge_u32 s2, 192
    s_cselect_b32 s69, 0x80000000, 0
    s_mov_b32 s67, 0x40053526
    v_lshlrev_b32 v234, 2, v1
    v_lshrrev_b32 v3, 3, v1
    s_lshl_b32 s64, s44, 4
    v_add_lshl_u32 v2, v3, s64, 11
    s_lshl_b32 s64, s48, 7
    v_add_u32 v2, s64, v2
    v_and_b32 v3, 6, v3
    v_and_b32 v4, 7, v1
    v_xor_b32 v3, v3, v4
    v_lshl_add_u32 v193, v3, 4, v2
    v_add_u32 v194, 15360, v193
    s_lshl_b32 s64, s47, 3
    s_lshl_b32 s65, s44, 1
    s_add_u32 s64, s64, s65
    s_mul_i32 s64, s64, 32768
    s_add_u32 s64, s64, 0x1000000
    v_lshl_add_u32 v206, v1, 4, s64
    v_add_u32 v207, 30720, v206
    s_lshl_b32 s65, s48, 8
    v_lshrrev_b32 v3, 4, v1
    s_lshl_b32 s64, s44, 4
    v_add_u32 v2, s64, v3
    s_movk_i32 s64, 7168
    v_mul_u32_u24 v2, s64, v2
    v_add_u32 v2, s65, v2
    v_lshlrev_b32 v3, 1, v3
    v_and_b32 v4, 15, v1
    v_xor_b32 v3, v3, v4
    v_lshl_add_u32 v208, v3, 4, v2
    v_add_u32 v210, 55296, v208
    v_xor_b32 v3, 8, v3
    v_lshl_add_u32 v209, v3, 4, v2
    v_add_u32 v209, 27648, v209
    v_add_u32 v211, 55296, v209
    s_lshr_b32 s65, s48, 2
    s_sub_u32 s65, s48, s65
    s_add_u32 s65, s65, 16
    s_lshl_b32 s65, s65, 8
    s_or_b32 s65, s65, s69
    v_lshrrev_b32 v3, 4, v1
    s_lshl_b32 s64, s44, 4
    v_add_u32 v2, s64, v3
    s_movk_i32 s64, 7168
    v_mul_u32_u24 v2, s64, v2
    v_add_u32 v2, s65, v2
    v_lshlrev_b32 v3, 1, v3
    v_and_b32 v4, 15, v1
    v_xor_b32 v3, v3, v4
    v_lshl_add_u32 v212, v3, 4, v2
    v_add_u32 v214, 55296, v212
    v_xor_b32 v3, 8, v3
    v_lshl_add_u32 v213, v3, 4, v2
    v_add_u32 v213, 27648, v213
    v_add_u32 v215, 55296, v213
    s_lshl_b32 s65, s44, 1
    s_xor_b32 s65, s65, s49
    s_lshl_b32 s64, s47, 3
    s_add_u32 s64, s64, s65
    s_mul_i32 s64, s64, 114688
    s_add_u32 s64, s64, 0x1500000
    v_lshl_add_u32 v246, v1, 4, s64
    s_lshl_b32 s65, s44, 1
    s_or_b32 s65, s65, 1
    s_xor_b32 s65, s65, s49
    s_lshl_b32 s64, s47, 3
    s_add_u32 s64, s64, s65
    s_mul_i32 s64, s64, 114688
    s_add_u32 s64, s64, 0x14ff800
    v_lshl_add_u32 v247, v1, 4, s64
    s_lshl_b32 s65, s51, 9
    v_lshrrev_b32 v3, 4, v1
    s_lshl_b32 s64, s44, 4
    v_add_u32 v2, s64, v3
    s_movk_i32 s64, 2048
    v_mul_u32_u24 v2, s64, v2
    v_add_u32 v2, s65, v2
    v_lshlrev_b32 v3, 1, v3
    v_and_b32 v4, 15, v1
    v_xor_b32 v3, v3, v4
    v_lshl_add_u32 v248, v3, 4, v2
    v_add_u32 v250, 14336, v248
    v_xor_b32 v3, 8, v3
    v_lshl_add_u32 v249, v3, 4, v2
    v_add_u32 v249, 7168, v249
    v_add_u32 v251, 14336, v249
    s_lshl_b32 s64, s44, 12
    v_lshl_add_u32 v233, v1, 4, s64
    v_lshrrev_b32 v2, 2, v1
    v_lshlrev_b32 v4, 7, v2
    v_and_b32 v5, 3, v1
    v_lshl_add_u32 v4, v5, 3, v4
    v_add_u32 v4, 16384, v4
    v_bfe_u32 v2, v1, 3, 2
    v_xor_b32 v3, 0, v2
    v_lshl_add_u32 v239, v3, 5, v4
    v_xor_b32 v3, 1, v2
    v_lshl_add_u32 v240, v3, 5, v4
    v_xor_b32 v3, 2, v2
    v_lshl_add_u32 v241, v3, 5, v4
    v_xor_b32 v3, 3, v2
    v_lshl_add_u32 v242, v3, 5, v4
    s_mov_b32 s52, 49152
    v_add_u32 v232, s52, v233
    v_add_u32 v235, s52, v239
    v_add_u32 v236, s52, v240
    v_add_u32 v237, s52, v241
    v_add_u32 v238, s52, v242
    s_lshl_b32 s70, s47, 2
    s_add_u32 s70, s70, s44
    s_lshl_b32 s64, s70, 16
    s_lshl_b32 s65, s48, 7
    s_add_u32 s64, s64, s65
    v_and_b32 v2, 15, v1
    v_lshl_add_u32 v2, v2, 11, s64
    v_bfe_u32 v3, v1, 4, 1
    v_lshl_add_u32 v2, v3, 5, v2
    v_lshrrev_b32 v3, 5, v1
    v_lshl_add_u32 v196, v3, 4, v2
    s_mul_i32 s64, s70, 65536
    s_lshl_b32 s65, s48, 11
    s_add_u32 s64, s64, s65
    v_lshl_add_u32 v197, v1, 4, s64
    s_lshl_b32 s64, s70, 12
    s_add_u32 s64, s64, 0x60000
    v_lshl_add_u32 v198, v1, 3, s64
    v_lshrrev_b32 v2, 5, v1
    s_mov_b32 s64, 0x3ff00
    v_mad_u32_u24 v195, v2, s64, v198
    s_lshl_b32 s64, s48, 8
    v_add_u32 v195, s64, v195
    v_and_b32 v2, 48, v1
    v_add_u32 v199, 149504, v2
    v_mov_b32 v72, 148480
    v_mov_b32 v73, 0
    v_and_b32 v16, 255, v0
    s_lshr_b32 s76, s2, 6
    s_lshl_b32 s77, s76, 8
    s_and_b32 s78, s2, 63
    s_lshl_b32 s79, s78, 7
    s_add_u32 s79, s79, 4096
    s_lshl_b32 s76, s76, 15
    s_lshl_b32 s78, s78, 9
    s_add_u32 s76, s76, s78
    s_add_u32 s76, s76, 0xa0000
    v_lshrrev_b32 v72, 3, v16
    v_add_u32 v72, s77, v72
    v_lshlrev_b32 v18, 1, v72
    s_movk_i32 s64, 12288
    v_mul_lo_u32 v72, s64, v72
    v_and_b32 v17, 7, v0
    v_lshl_add_u32 v72, v17, 4, v72
    v_add_u32 v17, s79, v72
    s_lshl_b32 s64, s2, 8
    v_add_lshl_u32 v243, v16, s64, 5
    s_mov_b32 s36, s20
    s_mov_b32 s37, s21
    s_mov_b32 s38, 0xc00000
    s_mov_b32 s39, 0x20000
    s_lshl_b32 s64, s2, 2
    s_add_u32 s64, s64, s44
    s_mul_i32 s64, s64, 7168
    s_add_u32 s64, s64, 4096
    s_add_u32 s10, s12, s64
    s_addc_u32 s11, s13, 0
    s_add_u32 s24, s14, s64
    s_addc_u32 s25, s15, 0
    buffer_load_dwordx2 v[168:169], v12, s[28:31], 0 offen offset:0 sc1
    buffer_load_dwordx2 v[170:171], v12, s[28:31], 0 offen offset:512 sc1
    buffer_load_dwordx2 v[172:173], v12, s[28:31], 0 offen offset:1024 sc1
    buffer_load_dwordx2 v[174:175], v12, s[28:31], 0 offen offset:1536 sc1
    buffer_load_dwordx2 v[176:177], v13, s[28:31], 0 offen sc1
    s_waitcnt vmcnt(5)
    v_lshlrev_b32 v120, 16, v80
    v_and_b32 v121, 0xffff0000, v80
    v_lshlrev_b32 v122, 16, v81
    v_and_b32 v123, 0xffff0000, v81
    v_lshlrev_b32 v124, 16, v82
    v_and_b32 v125, 0xffff0000, v82
    v_lshlrev_b32 v126, 16, v83
    v_and_b32 v127, 0xffff0000, v83
    v_lshlrev_b32 v128, 16, v84
    v_and_b32 v129, 0xffff0000, v84
    v_lshlrev_b32 v130, 16, v85
    v_and_b32 v131, 0xffff0000, v85
    v_lshlrev_b32 v132, 16, v86
    v_and_b32 v133, 0xffff0000, v86
    v_lshlrev_b32 v134, 16, v87
    v_and_b32 v135, 0xffff0000, v87
    v_lshlrev_b32 v136, 16, v88
    v_and_b32 v137, 0xffff0000, v88
    v_lshlrev_b32 v138, 16, v89
    v_and_b32 v139, 0xffff0000, v89
    v_lshlrev_b32 v140, 16, v90
    v_and_b32 v141, 0xffff0000, v90
    v_lshlrev_b32 v142, 16, v91
    v_and_b32 v143, 0xffff0000, v91
    v_lshlrev_b32 v144, 16, v92
    v_and_b32 v145, 0xffff0000, v92
    v_lshlrev_b32 v146, 16, v93
    v_and_b32 v147, 0xffff0000, v93
    v_lshlrev_b32 v148, 16, v94
    v_and_b32 v149, 0xffff0000, v94
    v_lshlrev_b32 v150, 16, v95
    v_and_b32 v151, 0xffff0000, v95
    v_lshlrev_b32 v152, 16, v96
    v_and_b32 v153, 0xffff0000, v96
    v_lshlrev_b32 v154, 16, v97
    v_and_b32 v155, 0xffff0000, v97
    v_lshlrev_b32 v156, 16, v98
    v_and_b32 v157, 0xffff0000, v98
    v_lshlrev_b32 v158, 16, v99
    v_and_b32 v159, 0xffff0000, v99
    s_waitcnt vmcnt(0)
    s_mov_b32 s3, 0x40000
M_s1_chk:
    v_xor_b32 v72, s0, v169
    v_xor_b32 v73, s0, v171
    v_xor_b32 v74, s0, v173
    v_xor_b32 v75, s0, v175
    v_xor_b32 v76, s0, v177
    v_or3_b32 v72, v72, v73, v74
    v_or3_b32 v72, v72, v75, v76
    v_cmp_ne_u32 vcc, 0, v72
    s_nop 4
    s_cbranch_vccz M_s1_ok
    s_sub_u32 s3, s3, 1
    s_cbranch_scc1 M_s1_ok
    s_sleep 2
    v_cmp_ne_u32 vcc, s0, v169
    s_nop 4
    s_mov_b64 exec, vcc
    buffer_load_dwordx2 v[168:169], v12, s[28:31], 0 offen offset:0 sc1
    s_mov_b64 exec, -1
    v_cmp_ne_u32 vcc, s0, v171
    s_nop 4
    s_mov_b64 exec, vcc
    buffer_load_dwordx2 v[170:171], v12, s[28:31], 0 offen offset:512 sc1
    s_mov_b64 exec, -1
    v_cmp_ne_u32 vcc, s0, v173
    s_nop 4
    s_mov_b64 exec, vcc
    buffer_load_dwordx2 v[172:173], v12, s[28:31], 0 offen offset:1024 sc1
    s_mov_b64 exec, -1
    v_cmp_ne_u32 vcc, s0, v175
    s_nop 4
    s_mov_b64 exec, vcc
    buffer_load_dwordx2 v[174:175], v12, s[28:31], 0 offen offset:1536 sc1
    s_mov_b64 exec, -1
    v_cmp_ne_u32 vcc, s0, v177
    s_nop 4
    s_mov_b64 exec, vcc
    buffer_load_dwordx2 v[176:177], v13, s[28:31], 0 offen sc1
    s_mov_b64 exec, -1
    s_waitcnt vmcnt(0)
    s_branch M_s1_chk
M_s1_ok:
    v_lshlrev_b32 v169, 16, v168
    v_and_b32 v168, 0xffff0000, v168
    v_lshlrev_b32 v171, 16, v170
    v_and_b32 v170, 0xffff0000, v170
    v_lshlrev_b32 v173, 16, v172
    v_and_b32 v172, 0xffff0000, v172
    v_lshlrev_b32 v175, 16, v174
    v_and_b32 v174, 0xffff0000, v174
    v_lshlrev_b32 v177, 16, v176
    v_and_b32 v176, 0xffff0000, v176
    v_rcp_f32 v169, v169
    v_rcp_f32 v171, v171
    v_rcp_f32 v173, v173
    v_rcp_f32 v175, v175
    v_rcp_f32 v177, v177
    v_pk_add_f32 v[120:121], v[120:121], v[168:169] op_sel_hi:[1,0] neg_lo:[0,1] neg_hi:[0,1]
    v_pk_add_f32 v[122:123], v[122:123], v[168:169] op_sel_hi:[1,0] neg_lo:[0,1] neg_hi:[0,1]
    v_pk_add_f32 v[124:125], v[124:125], v[168:169] op_sel_hi:[1,0] neg_lo:[0,1] neg_hi:[0,1]
    v_pk_add_f32 v[126:127], v[126:127], v[168:169] op_sel_hi:[1,0] neg_lo:[0,1] neg_hi:[0,1]
    v_cvt_pk_bf16_f32 v72, v120, v121
    v_lshlrev_b32 v120, 16, v72
    v_and_b32 v121, 0xffff0000, v72
    v_cvt_pk_bf16_f32 v73, v122, v123
    v_lshlrev_b32 v122, 16, v73
    v_and_b32 v123, 0xffff0000, v73
    v_cvt_pk_bf16_f32 v74, v124, v125
    v_lshlrev_b32 v124, 16, v74
    v_and_b32 v125, 0xffff0000, v74
    v_cvt_pk_bf16_f32 v75, v126, v127
    v_lshlrev_b32 v126, 16, v75
    v_and_b32 v127, 0xffff0000, v75
    v_pk_mul_f32 v[120:121], v[120:121], v[168:169] op_sel:[0,1] op_sel_hi:[1,1]
    v_pk_mul_f32 v[122:123], v[122:123], v[168:169] op_sel:[0,1] op_sel_hi:[1,1]
    v_pk_mul_f32 v[124:125], v[124:125], v[168:169] op_sel:[0,1] op_sel_hi:[1,1]
    v_pk_mul_f32 v[126:127], v[126:127], v[168:169] op_sel:[0,1] op_sel_hi:[1,1]
    v_cvt_pk_bf16_f32 v72, v120, v121
    v_lshlrev_b32 v120, 16, v72
    v_and_b32 v121, 0xffff0000, v72
    v_cvt_pk_bf16_f32 v73, v122, v123
    v_lshlrev_b32 v122, 16, v73
    v_and_b32 v123, 0xffff0000, v73
    v_cvt_pk_bf16_f32 v74, v124, v125
    v_lshlrev_b32 v124, 16, v74
    v_and_b32 v125, 0xffff0000, v74
    v_cvt_pk_bf16_f32 v75, v126, v127
    v_lshlrev_b32 v126, 16, v75
    v_and_b32 v127, 0xffff0000, v75
    v_pk_add_f32 v[128:129], v[128:129], v[170:171] op_sel_hi:[1,0] neg_lo:[0,1] neg_hi:[0,1]
    v_pk_add_f32 v[130:131], v[130:131], v[170:171] op_sel_hi:[1,0] neg_lo:[0,1] neg_hi:[0,1]
    v_pk_add_f32 v[132:133], v[132:133], v[170:171] op_sel_hi:[1,0] neg_lo:[0,1] neg_hi:[0,1]
    v_pk_add_f32 v[134:135], v[134:135], v[170:171] op_sel_hi:[1,0] neg_lo:[0,1] neg_hi:[0,1]
    v_cvt_pk_bf16_f32 v72, v128, v129
    v_lshlrev_b32 v128, 16, v72
    v_and_b32 v129, 0xffff0000, v72
    v_cvt_pk_bf16_f32 v73, v130, v131
    v_lshlrev_b32 v130, 16, v73
    v_and_b32 v131, 0xffff0000, v73
    v_cvt_pk_bf16_f32 v74, v132, v133
    v_lshlrev_b32 v132, 16, v74
    v_and_b32 v133, 0xffff0000, v74
    v_cvt_pk_bf16_f32 v75, v134, v135
    v_lshlrev_b32 v134, 16, v75
    v_and_b32 v135, 0xffff0000, v75
    v_pk_mul_f32 v[128:129], v[128:129], v[170:171] op_sel:[0,1] op_sel_hi:[1,1]
    v_pk_mul_f32 v[130:131], v[130:131], v[170:171] op_sel:[0,1] op_sel_hi:[1,1]
    v_pk_mul_f32 v[132:133], v[132:133], v[170:171] op_sel:[0,1] op_sel_hi:[1,1]
    v_pk_mul_f32 v[134:135], v[134:135], v[170:171] op_sel:[0,1] op_sel_hi:[1,1]
    v_cvt_pk_bf16_f32 v72, v128, v129
    v_lshlrev_b32 v128, 16, v72
    v_and_b32 v129, 0xffff0000, v72
    v_cvt_pk_bf16_f32 v73, v130, v131
    v_lshlrev_b32 v130, 16, v73
    v_and_b32 v131, 0xffff0000, v73
    v_cvt_pk_bf16_f32 v74, v132, v133
    v_lshlrev_b32 v132, 16, v74
    v_and_b32 v133, 0xffff0000, v74
    v_cvt_pk_bf16_f32 v75, v134, v135
    v_lshlrev_b32 v134, 16, v75
    v_and_b32 v135, 0xffff0000, v75
    v_pk_add_f32 v[136:137], v[136:137], v[172:173] op_sel_hi:[1,0] neg_lo:[0,1] neg_hi:[0,1]
    v_pk_add_f32 v[138:139], v[138:139], v[172:173] op_sel_hi:[1,0] neg_lo:[0,1] neg_hi:[0,1]
    v_pk_add_f32 v[140:141], v[140:141], v[172:173] op_sel_hi:[1,0] neg_lo:[0,1] neg_hi:[0,1]
    v_pk_add_f32 v[142:143], v[142:143], v[172:173] op_sel_hi:[1,0] neg_lo:[0,1] neg_hi:[0,1]
    v_cvt_pk_bf16_f32 v72, v136, v137
    v_lshlrev_b32 v136, 16, v72
    v_and_b32 v137, 0xffff0000, v72
    v_cvt_pk_bf16_f32 v73, v138, v139
    v_lshlrev_b32 v138, 16, v73
    v_and_b32 v139, 0xffff0000, v73
    v_cvt_pk_bf16_f32 v74, v140, v141
    v_lshlrev_b32 v140, 16, v74
    v_and_b32 v141, 0xffff0000, v74
    v_cvt_pk_bf16_f32 v75, v142, v143
    v_lshlrev_b32 v142, 16, v75
    v_and_b32 v143, 0xffff0000, v75
    v_pk_mul_f32 v[136:137], v[136:137], v[172:173] op_sel:[0,1] op_sel_hi:[1,1]
    v_pk_mul_f32 v[138:139], v[138:139], v[172:173] op_sel:[0,1] op_sel_hi:[1,1]
    v_pk_mul_f32 v[140:141], v[140:141], v[172:173] op_sel:[0,1] op_sel_hi:[1,1]
    v_pk_mul_f32 v[142:143], v[142:143], v[172:173] op_sel:[0,1] op_sel_hi:[1,1]
    v_cvt_pk_bf16_f32 v72, v136, v137
    v_lshlrev_b32 v136, 16, v72
    v_and_b32 v137, 0xffff0000, v72
    v_cvt_pk_bf16_f32 v73, v138, v139
    v_lshlrev_b32 v138, 16, v73
    v_and_b32 v139, 0xffff0000, v73
    v_cvt_pk_bf16_f32 v74, v140, v141
    v_lshlrev_b32 v140, 16, v74
    v_and_b32 v141, 0xffff0000, v74
    v_cvt_pk_bf16_f32 v75, v142, v143
    v_lshlrev_b32 v142, 16, v75
    v_and_b32 v143, 0xffff0000, v75
    v_pk_add_f32 v[144:145], v[144:145], v[174:175] op_sel_hi:[1,0] neg_lo:[0,1] neg_hi:[0,1]
    v_pk_add_f32 v[146:147], v[146:147], v[174:175] op_sel_hi:[1,0] neg_lo:[0,1] neg_hi:[0,1]
    v_pk_add_f32 v[148:149], v[148:149], v[174:175] op_sel_hi:[1,0] neg_lo:[0,1] neg_hi:[0,1]
    v_pk_add_f32 v[150:151], v[150:151], v[174:175] op_sel_hi:[1,0] neg_lo:[0,1] neg_hi:[0,1]
    v_cvt_pk_bf16_f32 v72, v144, v145
    v_lshlrev_b32 v144, 16, v72
    v_and_b32 v145, 0xffff0000, v72
    v_cvt_pk_bf16_f32 v73, v146, v147
    v_lshlrev_b32 v146, 16, v73
    v_and_b32 v147, 0xffff0000, v73
    v_cvt_pk_bf16_f32 v74, v148, v149
    v_lshlrev_b32 v148, 16, v74
    v_and_b32 v149, 0xffff0000, v74
    v_cvt_pk_bf16_f32 v75, v150, v151
    v_lshlrev_b32 v150, 16, v75
    v_and_b32 v151, 0xffff0000, v75
    v_pk_mul_f32 v[144:145], v[144:145], v[174:175] op_sel:[0,1] op_sel_hi:[1,1]
    v_pk_mul_f32 v[146:147], v[146:147], v[174:175] op_sel:[0,1] op_sel_hi:[1,1]
    v_pk_mul_f32 v[148:149], v[148:149], v[174:175] op_sel:[0,1] op_sel_hi:[1,1]
    v_pk_mul_f32 v[150:151], v[150:151], v[174:175] op_sel:[0,1] op_sel_hi:[1,1]
    v_cvt_pk_bf16_f32 v72, v144, v145
    v_lshlrev_b32 v144, 16, v72
    v_and_b32 v145, 0xffff0000, v72
    v_cvt_pk_bf16_f32 v73, v146, v147
    v_lshlrev_b32 v146, 16, v73
    v_and_b32 v147, 0xffff0000, v73
    v_cvt_pk_bf16_f32 v74, v148, v149
    v_lshlrev_b32 v148, 16, v74
    v_and_b32 v149, 0xffff0000, v74
    v_cvt_pk_bf16_f32 v75, v150, v151
    v_lshlrev_b32 v150, 16, v75
    v_and_b32 v151, 0xffff0000, v75
    v_pk_add_f32 v[152:153], v[152:153], v[176:177] op_sel_hi:[1,0] neg_lo:[0,1] neg_hi:[0,1]
    v_pk_add_f32 v[154:155], v[154:155], v[176:177] op_sel_hi:[1,0] neg_lo:[0,1] neg_hi:[0,1]
    v_pk_add_f32 v[156:157], v[156:157], v[176:177] op_sel_hi:[1,0] neg_lo:[0,1] neg_hi:[0,1]
    v_pk_add_f32 v[158:159], v[158:159], v[176:177] op_sel_hi:[1,0] neg_lo:[0,1] neg_hi:[0,1]
    v_cvt_pk_bf16_f32 v72, v152, v153
    v_lshlrev_b32 v152, 16, v72
    v_and_b32 v153, 0xffff0000, v72
    v_cvt_pk_bf16_f32 v73, v154, v155
    v_lshlrev_b32 v154, 16, v73
    v_and_b32 v155, 0xffff0000, v73
    v_cvt_pk_bf16_f32 v74, v156, v157
    v_lshlrev_b32 v156, 16, v74
    v_and_b32 v157, 0xffff0000, v74
    v_cvt_pk_bf16_f32 v75, v158, v159
    v_lshlrev_b32 v158, 16, v75
    v_and_b32 v159, 0xffff0000, v75
    v_pk_mul_f32 v[152:153], v[152:153], v[176:177] op_sel:[0,1] op_sel_hi:[1,1]
    v_pk_mul_f32 v[154:155], v[154:155], v[176:177] op_sel:[0,1] op_sel_hi:[1,1]
    v_pk_mul_f32 v[156:157], v[156:157], v[176:177] op_sel:[0,1] op_sel_hi:[1,1]
    v_pk_mul_f32 v[158:159], v[158:159], v[176:177] op_sel:[0,1] op_sel_hi:[1,1]
    v_cvt_pk_bf16_f32 v72, v152, v153
    v_lshlrev_b32 v152, 16, v72
    v_and_b32 v153, 0xffff0000, v72
    v_cvt_pk_bf16_f32 v73, v154, v155
    v_lshlrev_b32 v154, 16, v73
    v_and_b32 v155, 0xffff0000, v73
    v_cvt_pk_bf16_f32 v74, v156, v157
    v_lshlrev_b32 v156, 16, v74
    v_and_b32 v157, 0xffff0000, v74
    v_cvt_pk_bf16_f32 v75, v158, v159
    v_lshlrev_b32 v158, 16, v75
    v_and_b32 v159, 0xffff0000, v75
    s_lshl_b32 s68, s47, 9
    s_add_u32 s68, s68, 0x58000
    s_add_u32 s62, s26, s68
    s_addc_u32 s63, s27, 0
    s_lshr_b32 s68, s48, 2
    s_lshl_b32 s68, s68, 7
    v_mov_b32 v2, 1
    v_mov_b32 v5, 148496
    s_and_b32 s57, s58, 15
    s_lshr_b64 s[58:59], s[58:59], 4
    s_lshl_b32 s56, s57, 11
    s_mul_i32 s57, s57, 0x60000
    s_add_u32 m0, s53, s74
    s_nop 0
    buffer_load_dwordx4 v187, s[32:35], s57 offen offset:0 lds
    buffer_load_dwordx4 v188, s[32:35], s57 offen offset:1024 lds
    buffer_load_dwordx4 v189, s[32:35], s57 offen offset:2048 lds
    buffer_load_dwordx4 v190, s[32:35], s57 offen offset:3072 lds
    s_add_u32 m0, s53, s75
    s_nop 0
    buffer_load_dwordx4 v191, s[32:35], s57 offen offset:0 lds
    buffer_load_dwordx4 v192, s[32:35], s57 offen offset:1024 lds
    s_add_u32 s53, s53, 49152
    s_cmp_ge_u32 s53, 147456
    s_cselect_b32 s53, 0, s53
    s_barrier
    ds_read_b128 v[32:35], v14 offset:0
    ds_read_b128 v[36:39], v14 offset:16
    ds_read_b128 v[40:43], v14 offset:256
    ds_read_b128 v[44:47], v14 offset:272
    s_waitcnt lgkmcnt(0)
    v_pk_mul_f32 v[120:121], v[120:121], v[40:41]
    v_pk_mul_f32 v[122:123], v[122:123], v[42:43]
    v_pk_mul_f32 v[124:125], v[124:125], v[44:45]
    v_pk_mul_f32 v[126:127], v[126:127], v[46:47]
    v_cvt_pk_bf16_f32 v72, v120, v121
    v_lshlrev_b32 v120, 16, v72
    v_and_b32 v121, 0xffff0000, v72
    v_cvt_pk_bf16_f32 v73, v122, v123
    v_lshlrev_b32 v122, 16, v73
    v_and_b32 v123, 0xffff0000, v73
    v_cvt_pk_bf16_f32 v74, v124, v125
    v_lshlrev_b32 v124, 16, v74
    v_and_b32 v125, 0xffff0000, v74
    v_cvt_pk_bf16_f32 v75, v126, v127
    v_lshlrev_b32 v126, 16, v75
    v_and_b32 v127, 0xffff0000, v75
    v_pk_add_f32 v[120:121], v[120:121], v[32:33]
    v_pk_add_f32 v[122:123], v[122:123], v[34:35]
    v_pk_add_f32 v[124:125], v[124:125], v[36:37]
    v_pk_add_f32 v[126:127], v[126:127], v[38:39]
    v_cvt_pk_bf16_f32 v80, v120, v121
    v_cvt_pk_bf16_f32 v81, v122, v123
    v_cvt_pk_bf16_f32 v82, v124, v125
    v_cvt_pk_bf16_f32 v83, v126, v127
    s_mov_b32 s64, 0x0
    buffer_store_dwordx4 v[80:83], v10, s[28:31], s64 offen sc1
    ds_write_b128 v15, v[80:83] offset:0
    v_pk_mul_f32 v[128:129], v[128:129], v[40:41]
    v_pk_mul_f32 v[130:131], v[130:131], v[42:43]
    v_pk_mul_f32 v[132:133], v[132:133], v[44:45]
    v_pk_mul_f32 v[134:135], v[134:135], v[46:47]
    v_cvt_pk_bf16_f32 v72, v128, v129
    v_lshlrev_b32 v128, 16, v72
    v_and_b32 v129, 0xffff0000, v72
    v_cvt_pk_bf16_f32 v73, v130, v131
    v_lshlrev_b32 v130, 16, v73
    v_and_b32 v131, 0xffff0000, v73
    v_cvt_pk_bf16_f32 v74, v132, v133
    v_lshlrev_b32 v132, 16, v74
    v_and_b32 v133, 0xffff0000, v74
    v_cvt_pk_bf16_f32 v75, v134, v135
    v_lshlrev_b32 v134, 16, v75
    v_and_b32 v135, 0xffff0000, v75
    v_pk_add_f32 v[128:129], v[128:129], v[32:33]
    v_pk_add_f32 v[130:131], v[130:131], v[34:35]
    v_pk_add_f32 v[132:133], v[132:133], v[36:37]
    v_pk_add_f32 v[134:135], v[134:135], v[38:39]
    v_cvt_pk_bf16_f32 v84, v128, v129
    v_cvt_pk_bf16_f32 v85, v130, v131
    v_cvt_pk_bf16_f32 v86, v132, v133
    v_cvt_pk_bf16_f32 v87, v134, v135
    s_mov_b32 s64, 0x10000
    buffer_store_dwordx4 v[84:87], v10, s[28:31], s64 offen sc1
    ds_write_b128 v15, v[84:87] offset:4096
    v_pk_mul_f32 v[136:137], v[136:137], v[40:41]
    v_pk_mul_f32 v[138:139], v[138:139], v[42:43]
    v_pk_mul_f32 v[140:141], v[140:141], v[44:45]
    v_pk_mul_f32 v[142:143], v[142:143], v[46:47]
    v_cvt_pk_bf16_f32 v72, v136, v137
    v_lshlrev_b32 v136, 16, v72
    v_and_b32 v137, 0xffff0000, v72
    v_cvt_pk_bf16_f32 v73, v138, v139
    v_lshlrev_b32 v138, 16, v73
    v_and_b32 v139, 0xffff0000, v73
    v_cvt_pk_bf16_f32 v74, v140, v141
    v_lshlrev_b32 v140, 16, v74
    v_and_b32 v141, 0xffff0000, v74
    v_cvt_pk_bf16_f32 v75, v142, v143
    v_lshlrev_b32 v142, 16, v75
    v_and_b32 v143, 0xffff0000, v75
    v_pk_add_f32 v[136:137], v[136:137], v[32:33]
    v_pk_add_f32 v[138:139], v[138:139], v[34:35]
    v_pk_add_f32 v[140:141], v[140:141], v[36:37]
    v_pk_add_f32 v[142:143], v[142:143], v[38:39]
    v_cvt_pk_bf16_f32 v88, v136, v137
    v_cvt_pk_bf16_f32 v89, v138, v139
    v_cvt_pk_bf16_f32 v90, v140, v141
    v_cvt_pk_bf16_f32 v91, v142, v143
    s_mov_b32 s64, 0x20000
    buffer_store_dwordx4 v[88:91], v10, s[28:31], s64 offen sc1
    ds_write_b128 v15, v[88:91] offset:8192
    v_pk_mul_f32 v[144:145], v[144:145], v[40:41]
    v_pk_mul_f32 v[146:147], v[146:147], v[42:43]
    v_pk_mul_f32 v[148:149], v[148:149], v[44:45]
    v_pk_mul_f32 v[150:151], v[150:151], v[46:47]
    v_cvt_pk_bf16_f32 v72, v144, v145
    v_lshlrev_b32 v144, 16, v72
    v_and_b32 v145, 0xffff0000, v72
    v_cvt_pk_bf16_f32 v73, v146, v147
    v_lshlrev_b32 v146, 16, v73
    v_and_b32 v147, 0xffff0000, v73
    v_cvt_pk_bf16_f32 v74, v148, v149
    v_lshlrev_b32 v148, 16, v74
    v_and_b32 v149, 0xffff0000, v74
    v_cvt_pk_bf16_f32 v75, v150, v151
    v_lshlrev_b32 v150, 16, v75
    v_and_b32 v151, 0xffff0000, v75
    v_pk_add_f32 v[144:145], v[144:145], v[32:33]
    v_pk_add_f32 v[146:147], v[146:147], v[34:35]
    v_pk_add_f32 v[148:149], v[148:149], v[36:37]
    v_pk_add_f32 v[150:151], v[150:151], v[38:39]
    v_cvt_pk_bf16_f32 v92, v144, v145
    v_cvt_pk_bf16_f32 v93, v146, v147
    v_cvt_pk_bf16_f32 v94, v148, v149
    v_cvt_pk_bf16_f32 v95, v150, v151
    s_mov_b32 s64, 0x30000
    buffer_store_dwordx4 v[92:95], v10, s[28:31], s64 offen sc1
    ds_write_b128 v15, v[92:95] offset:12288
    v_pk_mul_f32 v[152:153], v[152:153], v[40:41]
    v_pk_mul_f32 v[154:155], v[154:155], v[42:43]
    v_pk_mul_f32 v[156:157], v[156:157], v[44:45]
    v_pk_mul_f32 v[158:159], v[158:159], v[46:47]
    v_cvt_pk_bf16_f32 v72, v152, v153
    v_lshlrev_b32 v152, 16, v72
    v_and_b32 v153, 0xffff0000, v72
    v_cvt_pk_bf16_f32 v73, v154, v155
    v_lshlrev_b32 v154, 16, v73
    v_and_b32 v155, 0xffff0000, v73
    v_cvt_pk_bf16_f32 v74, v156, v157
    v_lshlrev_b32 v156, 16, v74
    v_and_b32 v157, 0xffff0000, v74
    v_cvt_pk_bf16_f32 v75, v158, v159
    v_lshlrev_b32 v158, 16, v75
    v_and_b32 v159, 0xffff0000, v75
    v_pk_add_f32 v[152:153], v[152:153], v[32:33]
    v_pk_add_f32 v[154:155], v[154:155], v[34:35]
    v_pk_add_f32 v[156:157], v[156:157], v[36:37]
    v_pk_add_f32 v[158:159], v[158:159], v[38:39]
    v_cvt_pk_bf16_f32 v96, v152, v153
    v_cvt_pk_bf16_f32 v97, v154, v155
    v_cvt_pk_bf16_f32 v98, v156, v157
    v_cvt_pk_bf16_f32 v99, v158, v159
    buffer_store_dwordx4 v[96:99], v11, s[28:31], 0 offen sc1
    ds_write_b128 v19, v[96:99] offset:0
    s_waitcnt lgkmcnt(0)
    s_waitcnt vmcnt(5)
    s_barrier
    s_and_b32 s57, s58, 15
    s_lshr_b64 s[58:59], s[58:59], 4
    s_lshl_b32 s56, s57, 11
    s_mul_i32 s57, s57, 0x60000
    s_add_u32 m0, s53, s74
    s_nop 0
    buffer_load_dwordx4 v187, s[32:35], s57 offen offset:0 lds
    buffer_load_dwordx4 v188, s[32:35], s57 offen offset:1024 lds
    buffer_load_dwordx4 v189, s[32:35], s57 offen offset:2048 lds
    buffer_load_dwordx4 v190, s[32:35], s57 offen offset:3072 lds
    s_add_u32 m0, s53, s75
    s_nop 0
    buffer_load_dwordx4 v191, s[32:35], s57 offen offset:0 lds
    buffer_load_dwordx4 v192, s[32:35], s57 offen offset:1024 lds
    s_add_u32 s53, s53, 49152
    s_cmp_ge_u32 s53, 147456
    s_cselect_b32 s53, 0, s53
    s_mov_b32 s53, 0
    s_bfe_u32 s66, s2, 0x30003
    s_lshr_b32 s55, s2, 6
    s_add_u32 s66, s66, s55
    s_and_b32 s66, s66, 3
    s_mov_b32 s58, 0x76453210
    s_mov_b32 s59, 0xfecdba89
    s_cmp_eq_u32 s66, 1
    s_cselect_b32 s58, 0x75643120, s58
    s_cselect_b32 s59, 0xfdecb9a8, s59
    s_cmp_eq_u32 s66, 2
    s_cselect_b32 s58, 0x67542310, s58
    s_cselect_b32 s59, 0xefdcab98, s59
    s_cmp_eq_u32 s66, 3
    s_cselect_b32 s58, 0x86534210, s58
    s_cselect_b32 s59, 0xfedbca97, s59
    s_and_b32 s66, s48, 15
    s_lshl_b32 s55, s66, 2
    s_lshr_b64 s[56:57], s[58:59], s55
    s_and_b32 s55, s56, 15
    s_lshl_b32 s55, s55, 2
    s_lshl_b64 s[56:57], 15, s55
    s_andn2_b64 s[58:59], s[58:59], s[56:57]
    s_or_b32 s58, s58, s66
    s_waitcnt vmcnt(6)
    s_mov_b64 exec, 1
    ds_add_rtn_u32 v245, v5, v2
    s_mov_b64 exec, -1
    s_mov_b32 s1, s0
    s_lshl_b32 s64, s48, 2
    s_waitcnt lgkmcnt(0)
    v_readfirstlane_b32 s3, v245
    s_nop 3
    s_cmp_lg_u32 s3, 3
    s_cbranch_scc1 M_p1_ok
    s_atomic_swap s0, s[62:63], s64 offset:0
    s_atomic_swap s0, s[62:63], s64 offset:128
    s_atomic_swap s0, s[62:63], s64 offset:256
    s_atomic_swap s0, s[62:63], s64 offset:384
    s_mov_b32 s3, 0x40000
M_p1_chk:
    s_load_dwordx16 s[80:95], s[62:63], s68 glc
    s_sub_u32 s3, s3, 1
    s_cbranch_scc1 M_p1_ok
M_p1_c2:
    s_waitcnt lgkmcnt(0)
    s_xor_b64 s[80:81], s[80:81], s[0:1]
    s_xor_b64 s[82:83], s[82:83], s[0:1]
    s_xor_b64 s[84:85], s[84:85], s[0:1]
    s_xor_b64 s[86:87], s[86:87], s[0:1]
    s_xor_b64 s[88:89], s[88:89], s[0:1]
    s_xor_b64 s[90:91], s[90:91], s[0:1]
    s_xor_b64 s[92:93], s[92:93], s[0:1]
    s_xor_b64 s[94:95], s[94:95], s[0:1]
    s_or_b64 s[80:81], s[80:81], s[82:83]
    s_or_b64 s[84:85], s[84:85], s[86:87]
    s_or_b64 s[88:89], s[88:89], s[90:91]
    s_or_b64 s[92:93], s[92:93], s[94:95]
    s_or_b64 s[80:81], s[80:81], s[84:85]
    s_or_b64 s[88:89], s[88:89], s[92:93]
    s_or_b64 s[80:81], s[80:81], s[88:89]
    s_cbranch_scc1 M_p1_chk
M_p1_ok:
    s_barrier
    s_and_b32 s57, s58, 15
    s_lshr_b64 s[58:59], s[58:59], 4
    s_lshl_b32 s56, s57, 11
    s_mul_i32 s57, s57, 0x60000
    s_add_u32 s53, s53, 49152
    s_cmp_ge_u32 s53, 147456
    s_cselect_b32 s53, 0, s53
    s_and_b32 s57, s58, 15
    s_lshr_b64 s[58:59], s[58:59], 4
    s_lshl_b32 s56, s57, 11
    s_mul_i32 s57, s57, 0x60000
    s_add_u32 m0, s53, s72
    s_nop 0
    buffer_load_dwordx4 v184, s[28:31], s56 offen offset:0 sc1 lds
    buffer_load_dwordx4 v184, s[28:31], s56 offen offset:1024 sc1 lds
    buffer_load_dwordx4 v185, s[28:31], s56 offen offset:2048 sc1 lds
    buffer_load_dwordx4 v185, s[28:31], s56 offen offset:3072 sc1 lds
    s_add_u32 m0, s53, s73
    s_mov_b32 exec_hi, 0
    buffer_load_dwordx4 v186, s[28:31], s56 offen offset:0 sc1 lds
    s_mov_b32 exec_hi, -1
    s_add_u32 s53, s53, 49152
    s_cmp_ge_u32 s53, 147456
    s_cselect_b32 s53, 0, s53
    s_and_b32 s57, s58, 15
    s_lshr_b64 s[58:59], s[58:59], 4
    s_lshl_b32 s56, s57, 11
    s_mul_i32 s57, s57, 0x60000
    s_add_u32 m0, s53, s74
    s_nop 0
    buffer_load_dwordx4 v187, s[32:35], s57 offen offset:0 lds
    buffer_load_dwordx4 v188, s[32:35], s57 offen offset:1024 lds
    buffer_load_dwordx4 v189, s[32:35], s57 offen offset:2048 lds
    buffer_load_dwordx4 v190, s[32:35], s57 offen offset:3072 lds
    s_add_u32 m0, s53, s75
    s_nop 0
    buffer_load_dwordx4 v191, s[32:35], s57 offen offset:0 lds
    buffer_load_dwordx4 v192, s[32:35], s57 offen offset:1024 lds
    s_add_u32 m0, s53, s72
    s_nop 0
    buffer_load_dwordx4 v184, s[28:31], s56 offen offset:0 sc1 lds
    buffer_load_dwordx4 v184, s[28:31], s56 offen offset:1024 sc1 lds
    buffer_load_dwordx4 v185, s[28:31], s56 offen offset:2048 sc1 lds
    buffer_load_dwordx4 v185, s[28:31], s56 offen offset:3072 sc1 lds
    s_add_u32 m0, s53, s73
    s_mov_b32 exec_hi, 0
    buffer_load_dwordx4 v186, s[28:31], s56 offen offset:0 sc1 lds
    s_mov_b32 exec_hi, -1
    s_add_u32 s53, s53, 49152
    s_cmp_ge_u32 s53, 147456
    s_cselect_b32 s53, 0, s53
    v_mov_b32 v6, -1
    v_mov_b32 v7, -1
    s_mov_b32 exec_hi, 0
    buffer_store_dwordx2 v[6:7], v195, s[28:31], 0 offen sc1
    s_mov_b32 exec_hi, -1
    s_mov_b32 s40, s18
    s_mov_b32 s41, s19
    s_mov_b32 s42, 0x800
    s_mov_b32 s43, 0x20000
    buffer_load_ushort v24, v18, s[40:43], 0 offen offset:0
    buffer_load_ushort v25, v18, s[40:43], 0 offen offset:64
    buffer_load_ushort v26, v18, s[40:43], 0 offen offset:128
    buffer_load_ushort v27, v18, s[40:43], 0 offen offset:192
    buffer_load_ushort v28, v18, s[40:43], 0 offen offset:256
    buffer_load_ushort v29, v18, s[40:43], 0 offen offset:320
    buffer_load_ushort v30, v18, s[40:43], 0 offen offset:384
    buffer_load_ushort v31, v18, s[40:43], 0 offen offset:448
    s_movk_i32 s54, 1
M_Q_loop0:
    s_waitcnt vmcnt(20)
    s_barrier
    s_and_b32 s57, s58, 15
    s_lshr_b64 s[58:59], s[58:59], 4
    s_lshl_b32 s56, s57, 11
    s_mul_i32 s57, s57, 0x60000
    s_add_u32 m0, s53, s74
    s_nop 0
    buffer_load_dwordx4 v187, s[32:35], s57 offen offset:0 lds
    buffer_load_dwordx4 v188, s[32:35], s57 offen offset:1024 lds
    buffer_load_dwordx4 v189, s[32:35], s57 offen offset:2048 lds
    buffer_load_dwordx4 v190, s[32:35], s57 offen offset:3072 lds
    s_add_u32 m0, s53, s75
    s_nop 0
    buffer_load_dwordx4 v191, s[32:35], s57 offen offset:0 lds
    buffer_load_dwordx4 v192, s[32:35], s57 offen offset:1024 lds
    s_add_u32 m0, s53, s72
    s_nop 0
    buffer_load_dwordx4 v184, s[28:31], s56 offen offset:0 sc1 lds
    buffer_load_dwordx4 v184, s[28:31], s56 offen offset:1024 sc1 lds
    buffer_load_dwordx4 v185, s[28:31], s56 offen offset:2048 sc1 lds
    buffer_load_dwordx4 v185, s[28:31], s56 offen offset:3072 sc1 lds
    s_add_u32 m0, s53, s73
    s_mov_b32 exec_hi, 0
    buffer_load_dwordx4 v186, s[28:31], s56 offen offset:0 sc1 lds
    s_mov_b32 exec_hi, -1
    s_add_u32 s53, s53, 49152
    s_cmp_ge_u32 s53, 147456
    s_cselect_b32 s53, 0, s53
    s_sub_u32 s54, s54, 1
    s_cbranch_scc0 M_Q_loop0
    s_movk_i32 s54, 9
M_Q_loop1:
    s_waitcnt vmcnt(11)
    s_barrier
    s_and_b32 s57, s58, 15
    s_lshr_b64 s[58:59], s[58:59], 4
    s_lshl_b32 s56, s57, 11
    s_mul_i32 s57, s57, 0x60000
    s_add_u32 m0, s53, s74
    s_nop 0
    buffer_load_dwordx4 v187, s[32:35], s57 offen offset:0 lds
    buffer_load_dwordx4 v188, s[32:35], s57 offen offset:1024 lds
    buffer_load_dwordx4 v189, s[32:35], s57 offen offset:2048 lds
    buffer_load_dwordx4 v190, s[32:35], s57 offen offset:3072 lds
    s_add_u32 m0, s53, s75
    s_nop 0
    buffer_load_dwordx4 v191, s[32:35], s57 offen offset:0 lds
    buffer_load_dwordx4 v192, s[32:35], s57 offen offset:1024 lds
    s_add_u32 m0, s53, s72
    s_nop 0
    buffer_load_dwordx4 v184, s[28:31], s56 offen offset:0 sc1 lds
    buffer_load_dwordx4 v184, s[28:31], s56 offen offset:1024 sc1 lds
    buffer_load_dwordx4 v185, s[28:31], s56 offen offset:2048 sc1 lds
    buffer_load_dwordx4 v185, s[28:31], s56 offen offset:3072 sc1 lds
    s_add_u32 m0, s53, s73
    s_mov_b32 exec_hi, 0
    buffer_load_dwordx4 v186, s[28:31], s56 offen offset:0 sc1 lds
    s_mov_b32 exec_hi, -1
    s_add_u32 s53, s53, 49152
    s_cmp_ge_u32 s53, 147456
    s_cselect_b32 s53, 0, s53
    s_sub_u32 s54, s54, 1
    s_cbranch_scc0 M_Q_loop1
    s_waitcnt vmcnt(11)
    s_barrier
    s_and_b32 s57, s58, 15
    s_lshr_b64 s[58:59], s[58:59], 4
    s_lshl_b32 s56, s57, 11
    s_mul_i32 s57, s57, 0x60000
    s_add_u32 m0, s53, s74
    s_nop 0
    buffer_load_dwordx4 v187, s[32:35], s57 offen offset:0 lds
    buffer_load_dwordx4 v188, s[32:35], s57 offen offset:1024 lds
    buffer_load_dwordx4 v189, s[32:35], s57 offen offset:2048 lds
    buffer_load_dwordx4 v190, s[32:35], s57 offen offset:3072 lds
    s_add_u32 m0, s53, s75
    s_nop 0
    buffer_load_dwordx4 v191, s[32:35], s57 offen offset:0 lds
    buffer_load_dwordx4 v192, s[32:35], s57 offen offset:1024 lds
    s_add_u32 m0, s53, s72
    s_nop 0
    buffer_load_dwordx4 v184, s[28:31], s56 offen offset:0 sc1 lds
    buffer_load_dwordx4 v184, s[28:31], s56 offen offset:1024 sc1 lds
    buffer_load_dwordx4 v185, s[28:31], s56 offen offset:2048 sc1 lds
    buffer_load_dwordx4 v185, s[28:31], s56 offen offset:3072 sc1 lds
    s_add_u32 m0, s53, s73
    s_mov_b32 exec_hi, 0
    buffer_load_dwordx4 v186, s[28:31], s56 offen offset:0 sc1 lds
    s_mov_b32 exec_hi, -1
    s_add_u32 s53, s53, 49152
    s_cmp_ge_u32 s53, 147456
    s_cselect_b32 s53, 0, s53
    s_mov_b32 s64, 0x0
    buffer_load_dwordx4 v[32:35], v17, s[36:39], s64 offen
    s_mov_b32 s64, 0x60000
    buffer_load_dwordx4 v[36:39], v17, s[36:39], s64 offen
    s_mov_b32 s64, 0xc0000
    buffer_load_dwordx4 v[40:43], v17, s[36:39], s64 offen
    s_mov_b32 s64, 0x120000
    buffer_load_dwordx4 v[44:47], v17, s[36:39], s64 offen
    s_mov_b32 s64, 0x180000
    buffer_load_dwordx4 v[48:51], v17, s[36:39], s64 offen
    s_mov_b32 s64, 0x1e0000
    buffer_load_dwordx4 v[52:55], v17, s[36:39], s64 offen
    s_mov_b32 s64, 0x240000
    buffer_load_dwordx4 v[56:59], v17, s[36:39], s64 offen
    s_mov_b32 s64, 0x2a0000
    buffer_load_dwordx4 v[60:63], v17, s[36:39], s64 offen
    s_lshl_b32 s60, s44, 12
    s_add_u32 s61, s60, 147456
    s_add_u32 s53, s60, 49152
    s_lshl_b32 s70, s44, 11
    s_sub_u32 s70, 16384, s70
    s_bfe_u32 s66, s2, 0x30003
    s_lshr_b32 s55, s2, 6
    s_add_u32 s66, s66, s55
    s_and_b32 s66, s66, 3
    s_mov_b32 s58, 0x76453210
    s_mov_b32 s59, 0xfecdba89
    s_cmp_eq_u32 s66, 1
    s_cselect_b32 s58, 0x75643120, s58
    s_cselect_b32 s59, 0xfdecb9a8, s59
    s_cmp_eq_u32 s66, 2
    s_cselect_b32 s58, 0x67542310, s58
    s_cselect_b32 s59, 0xefdcab98, s59
    s_cmp_eq_u32 s66, 3
    s_cselect_b32 s58, 0x86534210, s58
    s_cselect_b32 s59, 0xfedbca97, s59
    s_mov_b32 s32, s8
    s_mov_b32 s33, s9
    s_mov_b32 s34, 0x200000
    s_mov_b32 s35, 0x20000
    s_waitcnt vmcnt(19)
    s_barrier
    s_waitcnt vmcnt(8)
    s_barrier
    s_barrier
    s_and_b32 s57, s58, 15
    s_lshr_b64 s[58:59], s[58:59], 4
    s_lshl_b32 s56, s57, 11
    s_mul_i32 s57, s57, 0x20000
    s_add_u32 m0, s53, s70
    s_nop 0
    buffer_load_dwordx4 v193, s[32:35], s57 offen offset:0 lds
    buffer_load_dwordx4 v194, s[32:35], s57 offen offset:1024 lds
    s_add_u32 s53, s53, 24576
    s_cmp_ge_u32 s53, s61
    s_cselect_b32 s53, s60, s53
    s_and_b32 s57, s58, 15
    s_lshr_b64 s[58:59], s[58:59], 4
    s_lshl_b32 s56, s57, 11
    s_mul_i32 s57, s57, 0x20000
    s_add_u32 m0, s53, s70
    s_nop 0
    buffer_load_dwordx4 v193, s[32:35], s57 offen offset:0 lds
    buffer_load_dwordx4 v194, s[32:35], s57 offen offset:1024 lds
    s_add_u32 s53, s53, 24576
    s_cmp_ge_u32 s53, s61
    s_cselect_b32 s53, s60, s53
    s_mov_b32 s40, s8
    s_mov_b32 s41, s9
    s_mov_b32 s42, 0x200000
    s_mov_b32 s43, 0x20000
    s_mov_b32 s64, 0x0
    buffer_load_dword v244, v243, s[40:43], s64 offen
    v_lshlrev_b32 v24, 16, v24
    v_lshlrev_b32 v25, 16, v25
    v_lshlrev_b32 v26, 16, v26
    v_lshlrev_b32 v27, 16, v27
    v_lshlrev_b32 v28, 16, v28
    v_lshlrev_b32 v29, 16, v29
    v_lshlrev_b32 v30, 16, v30
    v_lshlrev_b32 v31, 16, v31
    v_mul_f32 v72, 0xbfb8aa3b, v24
    v_mul_f32 v73, 0xbfb8aa3b, v25
    v_mul_f32 v74, 0xbfb8aa3b, v26
    v_mul_f32 v75, 0xbfb8aa3b, v27
    v_mul_f32 v76, 0xbfb8aa3b, v28
    v_mul_f32 v77, 0xbfb8aa3b, v29
    v_mul_f32 v78, 0xbfb8aa3b, v30
    v_mul_f32 v79, 0xbfb8aa3b, v31
    v_exp_f32 v72, v72
    v_exp_f32 v73, v73
    v_exp_f32 v74, v74
    v_exp_f32 v75, v75
    v_exp_f32 v76, v76
    v_exp_f32 v77, v77
    v_exp_f32 v78, v78
    v_exp_f32 v79, v79
    v_add_f32 v72, 1.0, v72
    v_add_f32 v73, 1.0, v73
    v_add_f32 v74, 1.0, v74
    v_add_f32 v75, 1.0, v75
    v_add_f32 v76, 1.0, v76
    v_add_f32 v77, 1.0, v77
    v_add_f32 v78, 1.0, v78
    v_add_f32 v79, 1.0, v79
    v_rcp_f32 v72, v72
    v_rcp_f32 v73, v73
    v_rcp_f32 v74, v74
    v_rcp_f32 v75, v75
    v_rcp_f32 v76, v76
    v_rcp_f32 v77, v77
    v_rcp_f32 v78, v78
    v_rcp_f32 v79, v79
    v_mul_f32 v24, v24, v72
    v_mul_f32 v25, v25, v73
    v_mul_f32 v26, v26, v74
    v_mul_f32 v27, v27, v75
    v_mul_f32 v28, v28, v76
    v_mul_f32 v29, v29, v77
    v_mul_f32 v30, v30, v78
    v_mul_f32 v31, v31, v79
    v_cvt_pk_bf16_f32 v72, v24, v24
    v_lshlrev_b32 v24, 16, v72
    v_cvt_pk_bf16_f32 v73, v25, v25
    v_lshlrev_b32 v25, 16, v73
    v_cvt_pk_bf16_f32 v74, v26, v26
    v_lshlrev_b32 v26, 16, v74
    v_cvt_pk_bf16_f32 v75, v27, v27
    v_lshlrev_b32 v27, 16, v75
    v_cvt_pk_bf16_f32 v76, v28, v28
    v_lshlrev_b32 v28, 16, v76
    v_cvt_pk_bf16_f32 v77, v29, v29
    v_lshlrev_b32 v29, 16, v77
    v_cvt_pk_bf16_f32 v78, v30, v30
    v_lshlrev_b32 v30, 16, v78
    v_cvt_pk_bf16_f32 v79, v31, v31
    v_lshlrev_b32 v31, 16, v79
    s_waitcnt vmcnt(12)
    v_lshlrev_b32 v72, 16, v32
    v_and_b32 v73, 0xffff0000, v32
    v_lshlrev_b32 v74, 16, v33
    v_and_b32 v75, 0xffff0000, v33
    v_lshlrev_b32 v76, 16, v34
    v_and_b32 v77, 0xffff0000, v34
    v_lshlrev_b32 v78, 16, v35
    v_and_b32 v79, 0xffff0000, v35
    v_mul_f32 v64, v24, v72
    v_mul_f32 v65, v24, v73
    v_mul_f32 v66, v24, v74
    v_mul_f32 v67, v24, v75
    v_mul_f32 v68, v24, v76
    v_mul_f32 v69, v24, v77
    v_mul_f32 v70, v24, v78
    v_mul_f32 v71, v24, v79
    s_waitcnt vmcnt(11)
    v_lshlrev_b32 v72, 16, v36
    v_and_b32 v73, 0xffff0000, v36
    v_lshlrev_b32 v74, 16, v37
    v_and_b32 v75, 0xffff0000, v37
    v_lshlrev_b32 v76, 16, v38
    v_and_b32 v77, 0xffff0000, v38
    v_lshlrev_b32 v78, 16, v39
    v_and_b32 v79, 0xffff0000, v39
    v_fmac_f32 v64, v25, v72
    v_fmac_f32 v65, v25, v73
    v_fmac_f32 v66, v25, v74
    v_fmac_f32 v67, v25, v75
    v_fmac_f32 v68, v25, v76
    v_fmac_f32 v69, v25, v77
    v_fmac_f32 v70, v25, v78
    v_fmac_f32 v71, v25, v79
    s_waitcnt vmcnt(10)
    v_lshlrev_b32 v72, 16, v40
    v_and_b32 v73, 0xffff0000, v40
    v_lshlrev_b32 v74, 16, v41
    v_and_b32 v75, 0xffff0000, v41
    v_lshlrev_b32 v76, 16, v42
    v_and_b32 v77, 0xffff0000, v42
    v_lshlrev_b32 v78, 16, v43
    v_and_b32 v79, 0xffff0000, v43
    v_fmac_f32 v64, v26, v72
    v_fmac_f32 v65, v26, v73
    v_fmac_f32 v66, v26, v74
    v_fmac_f32 v67, v26, v75
    v_fmac_f32 v68, v26, v76
    v_fmac_f32 v69, v26, v77
    v_fmac_f32 v70, v26, v78
    v_fmac_f32 v71, v26, v79
    s_waitcnt vmcnt(9)
    v_lshlrev_b32 v72, 16, v44
    v_and_b32 v73, 0xffff0000, v44
    v_lshlrev_b32 v74, 16, v45
    v_and_b32 v75, 0xffff0000, v45
    v_lshlrev_b32 v76, 16, v46
    v_and_b32 v77, 0xffff0000, v46
    v_lshlrev_b32 v78, 16, v47
    v_and_b32 v79, 0xffff0000, v47
    v_fmac_f32 v64, v27, v72
    v_fmac_f32 v65, v27, v73
    v_fmac_f32 v66, v27, v74
    v_fmac_f32 v67, v27, v75
    v_fmac_f32 v68, v27, v76
    v_fmac_f32 v69, v27, v77
    v_fmac_f32 v70, v27, v78
    v_fmac_f32 v71, v27, v79
    s_waitcnt vmcnt(8)
    v_lshlrev_b32 v72, 16, v48
    v_and_b32 v73, 0xffff0000, v48
    v_lshlrev_b32 v74, 16, v49
    v_and_b32 v75, 0xffff0000, v49
    v_lshlrev_b32 v76, 16, v50
    v_and_b32 v77, 0xffff0000, v50
    v_lshlrev_b32 v78, 16, v51
    v_and_b32 v79, 0xffff0000, v51
    v_fmac_f32 v64, v28, v72
    v_fmac_f32 v65, v28, v73
    v_fmac_f32 v66, v28, v74
    v_fmac_f32 v67, v28, v75
    v_fmac_f32 v68, v28, v76
    v_fmac_f32 v69, v28, v77
    v_fmac_f32 v70, v28, v78
    v_fmac_f32 v71, v28, v79
    s_waitcnt vmcnt(7)
    v_lshlrev_b32 v72, 16, v52
    v_and_b32 v73, 0xffff0000, v52
    v_lshlrev_b32 v74, 16, v53
    v_and_b32 v75, 0xffff0000, v53
    v_lshlrev_b32 v76, 16, v54
    v_and_b32 v77, 0xffff0000, v54
    v_lshlrev_b32 v78, 16, v55
    v_and_b32 v79, 0xffff0000, v55
    v_fmac_f32 v64, v29, v72
    v_fmac_f32 v65, v29, v73
    v_fmac_f32 v66, v29, v74
    v_fmac_f32 v67, v29, v75
    v_fmac_f32 v68, v29, v76
    v_fmac_f32 v69, v29, v77
    v_fmac_f32 v70, v29, v78
    v_fmac_f32 v71, v29, v79
    s_waitcnt vmcnt(6)
    v_lshlrev_b32 v72, 16, v56
    v_and_b32 v73, 0xffff0000, v56
    v_lshlrev_b32 v74, 16, v57
    v_and_b32 v75, 0xffff0000, v57
    v_lshlrev_b32 v76, 16, v58
    v_and_b32 v77, 0xffff0000, v58
    v_lshlrev_b32 v78, 16, v59
    v_and_b32 v79, 0xffff0000, v59
    v_fmac_f32 v64, v30, v72
    v_fmac_f32 v65, v30, v73
    v_fmac_f32 v66, v30, v74
    v_fmac_f32 v67, v30, v75
    v_fmac_f32 v68, v30, v76
    v_fmac_f32 v69, v30, v77
    v_fmac_f32 v70, v30, v78
    v_fmac_f32 v71, v30, v79
    s_waitcnt vmcnt(5)
    v_lshlrev_b32 v72, 16, v60
    v_and_b32 v73, 0xffff0000, v60
    v_lshlrev_b32 v74, 16, v61
    v_and_b32 v75, 0xffff0000, v61
    v_lshlrev_b32 v76, 16, v62
    v_and_b32 v77, 0xffff0000, v62
    v_lshlrev_b32 v78, 16, v63
    v_and_b32 v79, 0xffff0000, v63
    v_fmac_f32 v64, v31, v72
    v_fmac_f32 v65, v31, v73
    v_fmac_f32 v66, v31, v74
    v_fmac_f32 v67, v31, v75
    v_fmac_f32 v68, v31, v76
    v_fmac_f32 v69, v31, v77
    v_fmac_f32 v70, v31, v78
    v_fmac_f32 v71, v31, v79
    v_add_f32_dpp v64, v64, v64 row_ror:8 row_mask:0xf bank_mask:0xf
    v_add_f32_dpp v65, v65, v65 row_ror:8 row_mask:0xf bank_mask:0xf
    v_add_f32_dpp v66, v66, v66 row_ror:8 row_mask:0xf bank_mask:0xf
    v_add_f32_dpp v67, v67, v67 row_ror:8 row_mask:0xf bank_mask:0xf
    v_add_f32_dpp v68, v68, v68 row_ror:8 row_mask:0xf bank_mask:0xf
    v_add_f32_dpp v69, v69, v69 row_ror:8 row_mask:0xf bank_mask:0xf
    v_add_f32_dpp v70, v70, v70 row_ror:8 row_mask:0xf bank_mask:0xf
    v_add_f32_dpp v71, v71, v71 row_ror:8 row_mask:0xf bank_mask:0xf
    v_mov_b32 v72, v64
    v_mov_b32 v73, v65
    v_mov_b32 v74, v66
    v_mov_b32 v75, v67
    v_mov_b32 v76, v68
    v_mov_b32 v77, v69
    v_mov_b32 v78, v70
    v_mov_b32 v79, v71
    v_permlane32_swap_b32 v64, v72
    v_permlane32_swap_b32 v65, v73
    v_permlane32_swap_b32 v66, v74
    v_permlane32_swap_b32 v67, v75
    v_permlane32_swap_b32 v68, v76
    v_permlane32_swap_b32 v69, v77
    v_permlane32_swap_b32 v70, v78
    v_permlane32_swap_b32 v71, v79
    v_add_f32 v64, v64, v72
    v_add_f32 v65, v65, v73
    v_add_f32 v66, v66, v74
    v_add_f32 v67, v67, v75
    v_add_f32 v68, v68, v76
    v_add_f32 v69, v69, v77
    v_add_f32 v70, v70, v78
    v_add_f32 v71, v71, v79
    v_mov_b32 v72, v64
    v_mov_b32 v73, v65
    v_mov_b32 v74, v66
    v_mov_b32 v75, v67
    v_mov_b32 v76, v68
    v_mov_b32 v77, v69
    v_mov_b32 v78, v70
    v_mov_b32 v79, v71
    v_permlane16_swap_b32 v64, v72
    v_permlane16_swap_b32 v65, v73
    v_permlane16_swap_b32 v66, v74
    v_permlane16_swap_b32 v67, v75
    v_permlane16_swap_b32 v68, v76
    v_permlane16_swap_b32 v69, v77
    v_permlane16_swap_b32 v70, v78
    v_permlane16_swap_b32 v71, v79
    v_add_f32 v64, v64, v72
    v_add_f32 v65, v65, v73
    v_add_f32 v66, v66, v74
    v_add_f32 v67, v67, v75
    v_add_f32 v68, v68, v76
    v_add_f32 v69, v69, v77
    v_add_f32 v70, v70, v78
    v_add_f32 v71, v71, v79
    s_lshl_b32 s64, s44, 8
    s_add_u32 s64, s64, 147456
    v_and_b32 v72, 7, v0
    v_lshl_add_u32 v72, v72, 5, s64
    ds_write_b128 v72, v[64:67]
    ds_write_b128 v72, v[68:71] offset:16
    v_mov_b32 v73, 148480
    v_mov_b32 v74, 1
    s_waitcnt lgkmcnt(0)
    s_mov_b64 exec, 1
    ds_add_rtn_u32 v75, v73, v74
    s_mov_b64 exec, -1
    v_add_u32 v73, 147456, v234
    s_waitcnt lgkmcnt(0)
    ds_read_b32 v64, v73 offset:0
    ds_read_b32 v65, v73 offset:256
    ds_read_b32 v66, v73 offset:512
    ds_read_b32 v67, v73 offset:768
    v_readfirstlane_b32 s64, v75
    s_nop 3
    s_cmp_eq_u32 s64, 3
    s_cselect_b32 s76, s76, 0x80000000
    v_lshl_add_u32 v72, v1, 3, s76
    s_waitcnt lgkmcnt(0)
    v_add_f32 v64, v64, v65
    v_add_f32 v66, v66, v67
    v_add_f32 v64, v64, v66
    v_mov_b32 v65, s0
    buffer_store_dwordx2 v[64:65], v72, s[28:31], 0 offen sc1
    s_mov_b32 s40, s4
    s_mov_b32 s41, s5
    s_mov_b32 s42, 0x400000
    s_mov_b32 s43, 0x20000
    s_mov_b32 s64, 0x8000
    buffer_load_dwordx4 v[88:91], v196, s[40:43], 0 offen offset:0
    buffer_load_dwordx4 v[92:95], v196, s[40:43], 0 offen offset:64
    buffer_load_dwordx4 v[96:99], v196, s[40:43], s64 offen offset:0
    buffer_load_dwordx4 v[100:103], v196, s[40:43], s64 offen offset:64
    s_and_b32 s57, s58, 15
    s_lshr_b64 s[58:59], s[58:59], 4
    s_lshl_b32 s56, s57, 11
    s_mul_i32 s57, s57, 0x20000
    s_add_u32 m0, s53, s70
    s_nop 0
    buffer_load_dwordx4 v193, s[32:35], s57 offen offset:0 lds
    buffer_load_dwordx4 v194, s[32:35], s57 offen offset:1024 lds
    s_add_u32 s53, s53, 24576
    s_cmp_ge_u32 s53, s61
    s_cselect_b32 s53, s60, s53
    s_and_b32 s57, s58, 15
    s_lshr_b64 s[58:59], s[58:59], 4
    s_lshl_b32 s56, s57, 11
    s_mul_i32 s57, s57, 0x20000
    s_add_u32 m0, s53, s70
    s_nop 0
    buffer_load_dwordx4 v193, s[32:35], s57 offen offset:0 lds
    buffer_load_dwordx4 v194, s[32:35], s57 offen offset:1024 lds
    s_add_u32 s53, s53, 24576
    s_cmp_ge_u32 s53, s61
    s_cselect_b32 s53, s60, s53
    s_and_b32 s57, s58, 15
    s_lshr_b64 s[58:59], s[58:59], 4
    s_lshl_b32 s56, s57, 11
    s_mul_i32 s57, s57, 0x20000
    s_add_u32 m0, s53, s70
    s_nop 0
    buffer_load_dwordx4 v193, s[32:35], s57 offen offset:0 lds
    buffer_load_dwordx4 v194, s[32:35], s57 offen offset:1024 lds
    s_add_u32 s53, s53, 24576
    s_cmp_ge_u32 s53, s61
    s_cselect_b32 s53, s60, s53
    s_and_b32 s57, s58, 15
    s_lshr_b64 s[58:59], s[58:59], 4
    s_lshl_b32 s56, s57, 11
    s_mul_i32 s57, s57, 0x20000
    s_add_u32 m0, s53, s70
    s_nop 0
    buffer_load_dwordx4 v193, s[32:35], s57 offen offset:0 lds
    buffer_load_dwordx4 v194, s[32:35], s57 offen offset:1024 lds
    s_add_u32 s53, s53, 24576
    s_cmp_ge_u32 s53, s61
    s_cselect_b32 s53, s60, s53
    s_lshl_b32 s60, s44, 12
    s_add_u32 s61, s60, 147456
    s_add_u32 s53, s60, 0
    s_bfe_u32 s66, s2, 0x30003
    s_lshr_b32 s55, s2, 6
    s_add_u32 s66, s66, s55
    s_and_b32 s66, s66, 3
    s_mov_b32 s58, 0x76453210
    s_mov_b32 s59, 0xfecdba89
    s_cmp_eq_u32 s66, 1
    s_cselect_b32 s58, 0x75643120, s58
    s_cselect_b32 s59, 0xfdecb9a8, s59
    s_cmp_eq_u32 s66, 2
    s_cselect_b32 s58, 0x67542310, s58
    s_cselect_b32 s59, 0xefdcab98, s59
    s_cmp_eq_u32 s66, 3
    s_cselect_b32 s58, 0x86534210, s58
    s_cselect_b32 s59, 0xfedbca97, s59
    s_and_b32 s66, s48, 15
    s_lshl_b32 s55, s66, 2
    s_lshr_b64 s[56:57], s[58:59], s55
    s_and_b32 s55, s56, 15
    s_lshl_b32 s55, s55, 2
    s_lshl_b64 s[56:57], 15, s55
    s_andn2_b64 s[58:59], s[58:59], s[56:57]
    s_or_b32 s58, s58, s66
    s_mov_b32 s32, s12
    s_mov_b32 s33, s13
    s_mov_b32 s34, 0x700000
    s_mov_b32 s35, 0x20000
    s_mov_b32 s36, s14
    s_mov_b32 s37, s15
    s_mov_b32 s38, 0x700000
    s_mov_b32 s39, 0x20000
    s_mov_b32 s72, 0xb00000
    s_mov_b32 s74, 0x1000000
    s_mov_b32 s73, 0xb08000
    s_mov_b32 s75, 0x1008000
    s_lshl_b32 s76, s48, 8
    s_waitcnt vmcnt(8)
    v_permlane16_swap_b32 v88, v90
    v_permlane16_swap_b32 v89, v91
    v_permlane16_swap_b32 v92, v94
    v_permlane16_swap_b32 v93, v95
    v_permlane16_swap_b32 v96, v98
    v_permlane16_swap_b32 v97, v99
    v_permlane16_swap_b32 v100, v102
    v_permlane16_swap_b32 v101, v103
    v_lshlrev_b32 v104, 16, v88
    v_and_b32 v105, 0xffff0000, v88
    v_lshlrev_b32 v106, 16, v89
    v_and_b32 v107, 0xffff0000, v89
    v_lshlrev_b32 v108, 16, v90
    v_and_b32 v109, 0xffff0000, v90
    v_lshlrev_b32 v110, 16, v91
    v_and_b32 v111, 0xffff0000, v91
    v_lshlrev_b32 v112, 16, v92
    v_and_b32 v113, 0xffff0000, v92
    v_lshlrev_b32 v114, 16, v93
    v_and_b32 v115, 0xffff0000, v93
    v_lshlrev_b32 v116, 16, v94
    v_and_b32 v117, 0xffff0000, v94
    v_lshlrev_b32 v118, 16, v95
    v_and_b32 v119, 0xffff0000, v95
    v_lshlrev_b32 v120, 16, v96
    v_and_b32 v121, 0xffff0000, v96
    v_lshlrev_b32 v122, 16, v97
    v_and_b32 v123, 0xffff0000, v97
    v_lshlrev_b32 v124, 16, v98
    v_and_b32 v125, 0xffff0000, v98
    v_lshlrev_b32 v126, 16, v99
    v_and_b32 v127, 0xffff0000, v99
    v_lshlrev_b32 v128, 16, v100
    v_and_b32 v129, 0xffff0000, v100
    v_lshlrev_b32 v130, 16, v101
    v_and_b32 v131, 0xffff0000, v101
    v_lshlrev_b32 v132, 16, v102
    v_and_b32 v133, 0xffff0000, v102
    v_lshlrev_b32 v134, 16, v103
    v_and_b32 v135, 0xffff0000, v103
    s_setprio 2
    s_barrier
    s_barrier
    ds_read_b128 v[40:43], v232 offset:0
    ds_read_b64_tr_b16 v[48:49], v235 offset:0
    ds_read_b64_tr_b16 v[50:51], v235 offset:2048
    ds_read_b64_tr_b16 v[52:53], v236 offset:0
    ds_read_b64_tr_b16 v[54:55], v236 offset:2048
    ds_read_b64_tr_b16 v[56:57], v237 offset:0
    ds_read_b64_tr_b16 v[58:59], v237 offset:2048
    ds_read_b64_tr_b16 v[60:61], v238 offset:0
    ds_read_b64_tr_b16 v[62:63], v238 offset:2048
    ds_read_b128 v[44:47], v232 offset:2048
    s_add_u32 s52, s52, 24576
    s_cmp_ge_u32 s52, 147456
    s_cselect_b32 s52, 0, s52
    s_waitcnt lgkmcnt(0)
    v_mfma_f32_16x16x32_bf16 v[8:11], v[48:51], v[40:43], 0
    ds_read_b128 v[64:67], v232 offset:1024
    ds_read_b64_tr_b16 v[72:73], v235 offset:4096
    v_mfma_f32_16x16x32_bf16 v[12:15], v[52:55], v[40:43], 0
    ds_read_b64_tr_b16 v[74:75], v235 offset:6144
    ds_read_b64_tr_b16 v[76:77], v236 offset:4096
    v_mfma_f32_16x16x32_bf16 v[16:19], v[56:59], v[40:43], 0
    ds_read_b64_tr_b16 v[78:79], v236 offset:6144
    ds_read_b64_tr_b16 v[80:81], v237 offset:4096
    v_mfma_f32_16x16x32_bf16 v[20:23], v[60:63], v[40:43], 0
    ds_read_b64_tr_b16 v[82:83], v237 offset:6144
    ds_read_b64_tr_b16 v[84:85], v238 offset:4096
    v_mfma_f32_16x16x32_bf16 v[24:27], v[48:51], v[44:47], 0
    ds_read_b64_tr_b16 v[86:87], v238 offset:6144
    ds_read_b128 v[68:71], v232 offset:3072
    v_mfma_f32_16x16x32_bf16 v[28:31], v[52:55], v[44:47], 0
    v_add_u32 v232, s52, v233
    v_add_u32 v235, s52, v239
    v_mfma_f32_16x16x32_bf16 v[32:35], v[56:59], v[44:47], 0
    v_add_u32 v236, s52, v240
    v_add_u32 v237, s52, v241
    v_mfma_f32_16x16x32_bf16 v[36:39], v[60:63], v[44:47], 0
    v_add_u32 v238, s52, v242
    s_waitcnt lgkmcnt(0)
    v_mfma_f32_16x16x32_bf16 v[8:11], v[72:75], v[64:67], v[8:11]
    s_barrier
    v_mfma_f32_16x16x32_bf16 v[12:15], v[76:79], v[64:67], v[12:15]
    ds_read_b128 v[40:43], v232 offset:0
    ds_read_b64_tr_b16 v[48:49], v235 offset:0
    ds_read_b64_tr_b16 v[50:51], v235 offset:2048
    v_mfma_f32_16x16x32_bf16 v[16:19], v[80:83], v[64:67], v[16:19]
    ds_read_b64_tr_b16 v[52:53], v236 offset:0
    ds_read_b64_tr_b16 v[54:55], v236 offset:2048
    v_mfma_f32_16x16x32_bf16 v[20:23], v[84:87], v[64:67], v[20:23]
    ds_read_b64_tr_b16 v[56:57], v237 offset:0
    ds_read_b64_tr_b16 v[58:59], v237 offset:2048
    ds_read_b64_tr_b16 v[60:61], v238 offset:0
    v_mfma_f32_16x16x32_bf16 v[24:27], v[72:75], v[68:71], v[24:27]
    ds_read_b64_tr_b16 v[62:63], v238 offset:2048
    ds_read_b128 v[44:47], v232 offset:2048
    v_mfma_f32_16x16x32_bf16 v[28:31], v[76:79], v[68:71], v[28:31]
    v_mfma_f32_16x16x32_bf16 v[32:35], v[80:83], v[68:71], v[32:35]
    s_add_u32 s52, s52, 24576
    s_cmp_ge_u32 s52, 147456
    s_cselect_b32 s52, 0, s52
    v_mfma_f32_16x16x32_bf16 v[36:39], v[84:87], v[68:71], v[36:39]
    s_waitcnt lgkmcnt(0)
    v_mfma_f32_16x16x32_bf16 v[8:11], v[48:51], v[40:43], v[8:11]
    ds_read_b128 v[64:67], v232 offset:1024
    ds_read_b64_tr_b16 v[72:73], v235 offset:4096
    v_mfma_f32_16x16x32_bf16 v[12:15], v[52:55], v[40:43], v[12:15]
    ds_read_b64_tr_b16 v[74:75], v235 offset:6144
    ds_read_b64_tr_b16 v[76:77], v236 offset:4096
    v_mfma_f32_16x16x32_bf16 v[16:19], v[56:59], v[40:43], v[16:19]
    ds_read_b64_tr_b16 v[78:79], v236 offset:6144
    ds_read_b64_tr_b16 v[80:81], v237 offset:4096
    v_mfma_f32_16x16x32_bf16 v[20:23], v[60:63], v[40:43], v[20:23]
    ds_read_b64_tr_b16 v[82:83], v237 offset:6144
    ds_read_b64_tr_b16 v[84:85], v238 offset:4096
    v_mfma_f32_16x16x32_bf16 v[24:27], v[48:51], v[44:47], v[24:27]
    ds_read_b64_tr_b16 v[86:87], v238 offset:6144
    ds_read_b128 v[68:71], v232 offset:3072
    v_mfma_f32_16x16x32_bf16 v[28:31], v[52:55], v[44:47], v[28:31]
    v_add_u32 v232, s52, v233
    v_add_u32 v235, s52, v239
    v_mfma_f32_16x16x32_bf16 v[32:35], v[56:59], v[44:47], v[32:35]
    v_add_u32 v236, s52, v240
    v_add_u32 v237, s52, v241
    v_mfma_f32_16x16x32_bf16 v[36:39], v[60:63], v[44:47], v[36:39]
    v_add_u32 v238, s52, v242
    s_waitcnt lgkmcnt(0)
    v_mfma_f32_16x16x32_bf16 v[8:11], v[72:75], v[64:67], v[8:11]
    s_waitcnt vmcnt(6)
    s_barrier
    v_mfma_f32_16x16x32_bf16 v[12:15], v[76:79], v[64:67], v[12:15]
    ds_read_b128 v[40:43], v232 offset:0
    ds_read_b64_tr_b16 v[48:49], v235 offset:0
    ds_read_b64_tr_b16 v[50:51], v235 offset:2048
    v_mfma_f32_16x16x32_bf16 v[16:19], v[80:83], v[64:67], v[16:19]
    ds_read_b64_tr_b16 v[52:53], v236 offset:0
    ds_read_b64_tr_b16 v[54:55], v236 offset:2048
    v_mfma_f32_16x16x32_bf16 v[20:23], v[84:87], v[64:67], v[20:23]
    ds_read_b64_tr_b16 v[56:57], v237 offset:0
    ds_read_b64_tr_b16 v[58:59], v237 offset:2048
    ds_read_b64_tr_b16 v[60:61], v238 offset:0
    v_mfma_f32_16x16x32_bf16 v[24:27], v[72:75], v[68:71], v[24:27]
    ds_read_b64_tr_b16 v[62:63], v238 offset:2048
    ds_read_b128 v[44:47], v232 offset:2048
    v_mfma_f32_16x16x32_bf16 v[28:31], v[76:79], v[68:71], v[28:31]
    v_mfma_f32_16x16x32_bf16 v[32:35], v[80:83], v[68:71], v[32:35]
    s_add_u32 s52, s52, 24576
    s_cmp_ge_u32 s52, 147456
    s_cselect_b32 s52, 0, s52
    v_mfma_f32_16x16x32_bf16 v[36:39], v[84:87], v[68:71], v[36:39]
    s_waitcnt lgkmcnt(0)
    v_mfma_f32_16x16x32_bf16 v[8:11], v[48:51], v[40:43], v[8:11]
    ds_read_b128 v[64:67], v232 offset:1024
    ds_read_b64_tr_b16 v[72:73], v235 offset:4096
    v_mfma_f32_16x16x32_bf16 v[12:15], v[52:55], v[40:43], v[12:15]
    ds_read_b64_tr_b16 v[74:75], v235 offset:6144
    ds_read_b64_tr_b16 v[76:77], v236 offset:4096
    v_mfma_f32_16x16x32_bf16 v[16:19], v[56:59], v[40:43], v[16:19]
    ds_read_b64_tr_b16 v[78:79], v236 offset:6144
    ds_read_b64_tr_b16 v[80:81], v237 offset:4096
    v_mfma_f32_16x16x32_bf16 v[20:23], v[60:63], v[40:43], v[20:23]
    ds_read_b64_tr_b16 v[82:83], v237 offset:6144
    ds_read_b64_tr_b16 v[84:85], v238 offset:4096
    v_mfma_f32_16x16x32_bf16 v[24:27], v[48:51], v[44:47], v[24:27]
    ds_read_b64_tr_b16 v[86:87], v238 offset:6144
    ds_read_b128 v[68:71], v232 offset:3072
    v_mfma_f32_16x16x32_bf16 v[28:31], v[52:55], v[44:47], v[28:31]
    v_add_u32 v232, s52, v233
    v_add_u32 v235, s52, v239
    v_mfma_f32_16x16x32_bf16 v[32:35], v[56:59], v[44:47], v[32:35]
    v_add_u32 v236, s52, v240
    v_add_u32 v237, s52, v241
    v_mfma_f32_16x16x32_bf16 v[36:39], v[60:63], v[44:47], v[36:39]
    v_add_u32 v238, s52, v242
    s_waitcnt lgkmcnt(0)
    v_mfma_f32_16x16x32_bf16 v[8:11], v[72:75], v[64:67], v[8:11]
    s_waitcnt vmcnt(4)
    s_barrier
    v_mfma_f32_16x16x32_bf16 v[12:15], v[76:79], v[64:67], v[12:15]
    ds_read_b128 v[40:43], v232 offset:0
    ds_read_b64_tr_b16 v[48:49], v235 offset:0
    ds_read_b64_tr_b16 v[50:51], v235 offset:2048
    v_mfma_f32_16x16x32_bf16 v[16:19], v[80:83], v[64:67], v[16:19]
    ds_read_b64_tr_b16 v[52:53], v236 offset:0
    ds_read_b64_tr_b16 v[54:55], v236 offset:2048
    v_mfma_f32_16x16x32_bf16 v[20:23], v[84:87], v[64:67], v[20:23]
    ds_read_b64_tr_b16 v[56:57], v237 offset:0
    ds_read_b64_tr_b16 v[58:59], v237 offset:2048
    ds_read_b64_tr_b16 v[60:61], v238 offset:0
    v_mfma_f32_16x16x32_bf16 v[24:27], v[72:75], v[68:71], v[24:27]
    ds_read_b64_tr_b16 v[62:63], v238 offset:2048
    ds_read_b128 v[44:47], v232 offset:2048
    v_mfma_f32_16x16x32_bf16 v[28:31], v[76:79], v[68:71], v[28:31]
    v_mfma_f32_16x16x32_bf16 v[32:35], v[80:83], v[68:71], v[32:35]
    s_add_u32 s52, s52, 24576
    s_cmp_ge_u32 s52, 147456
    s_cselect_b32 s52, 0, s52
    v_mfma_f32_16x16x32_bf16 v[36:39], v[84:87], v[68:71], v[36:39]
    s_waitcnt lgkmcnt(0)
    v_mfma_f32_16x16x32_bf16 v[8:11], v[48:51], v[40:43], v[8:11]
    ds_read_b128 v[64:67], v232 offset:1024
    ds_read_b64_tr_b16 v[72:73], v235 offset:4096
    v_mfma_f32_16x16x32_bf16 v[12:15], v[52:55], v[40:43], v[12:15]
    ds_read_b64_tr_b16 v[74:75], v235 offset:6144
    ds_read_b64_tr_b16 v[76:77], v236 offset:4096
    v_mfma_f32_16x16x32_bf16 v[16:19], v[56:59], v[40:43], v[16:19]
    ds_read_b64_tr_b16 v[78:79], v236 offset:6144
    ds_read_b64_tr_b16 v[80:81], v237 offset:4096
    v_mfma_f32_16x16x32_bf16 v[20:23], v[60:63], v[40:43], v[20:23]
    ds_read_b64_tr_b16 v[82:83], v237 offset:6144
    ds_read_b64_tr_b16 v[84:85], v238 offset:4096
    v_mfma_f32_16x16x32_bf16 v[24:27], v[48:51], v[44:47], v[24:27]
    ds_read_b64_tr_b16 v[86:87], v238 offset:6144
    ds_read_b128 v[68:71], v232 offset:3072
    v_mfma_f32_16x16x32_bf16 v[28:31], v[52:55], v[44:47], v[28:31]
    v_add_u32 v232, s52, v233
    v_add_u32 v235, s52, v239
    v_mfma_f32_16x16x32_bf16 v[32:35], v[56:59], v[44:47], v[32:35]
    v_add_u32 v236, s52, v240
    v_add_u32 v237, s52, v241
    v_mfma_f32_16x16x32_bf16 v[36:39], v[60:63], v[44:47], v[36:39]
    v_add_u32 v238, s52, v242
    s_waitcnt lgkmcnt(0)
    v_mfma_f32_16x16x32_bf16 v[8:11], v[72:75], v[64:67], v[8:11]
    s_waitcnt vmcnt(2)
    s_barrier
    v_mfma_f32_16x16x32_bf16 v[12:15], v[76:79], v[64:67], v[12:15]
    ds_read_b128 v[40:43], v232 offset:0
    ds_read_b64_tr_b16 v[48:49], v235 offset:0
    ds_read_b64_tr_b16 v[50:51], v235 offset:2048
    v_mfma_f32_16x16x32_bf16 v[16:19], v[80:83], v[64:67], v[16:19]
    ds_read_b64_tr_b16 v[52:53], v236 offset:0
    ds_read_b64_tr_b16 v[54:55], v236 offset:2048
    v_mfma_f32_16x16x32_bf16 v[20:23], v[84:87], v[64:67], v[20:23]
    ds_read_b64_tr_b16 v[56:57], v237 offset:0
    ds_read_b64_tr_b16 v[58:59], v237 offset:2048
    ds_read_b64_tr_b16 v[60:61], v238 offset:0
    v_mfma_f32_16x16x32_bf16 v[24:27], v[72:75], v[68:71], v[24:27]
    ds_read_b64_tr_b16 v[62:63], v238 offset:2048
    ds_read_b128 v[44:47], v232 offset:2048
    v_mfma_f32_16x16x32_bf16 v[28:31], v[76:79], v[68:71], v[28:31]
    v_mfma_f32_16x16x32_bf16 v[32:35], v[80:83], v[68:71], v[32:35]
    s_add_u32 s52, s52, 24576
    s_cmp_ge_u32 s52, 147456
    s_cselect_b32 s52, 0, s52
    v_mfma_f32_16x16x32_bf16 v[36:39], v[84:87], v[68:71], v[36:39]
    s_waitcnt lgkmcnt(0)
    v_mfma_f32_16x16x32_bf16 v[8:11], v[48:51], v[40:43], v[8:11]
    ds_read_b128 v[64:67], v232 offset:1024
    ds_read_b64_tr_b16 v[72:73], v235 offset:4096
    v_mfma_f32_16x16x32_bf16 v[12:15], v[52:55], v[40:43], v[12:15]
    ds_read_b64_tr_b16 v[74:75], v235 offset:6144
    ds_read_b64_tr_b16 v[76:77], v236 offset:4096
    v_mfma_f32_16x16x32_bf16 v[16:19], v[56:59], v[40:43], v[16:19]
    ds_read_b64_tr_b16 v[78:79], v236 offset:6144
    ds_read_b64_tr_b16 v[80:81], v237 offset:4096
    v_mfma_f32_16x16x32_bf16 v[20:23], v[60:63], v[40:43], v[20:23]
    ds_read_b64_tr_b16 v[82:83], v237 offset:6144
    ds_read_b64_tr_b16 v[84:85], v238 offset:4096
    v_mfma_f32_16x16x32_bf16 v[24:27], v[48:51], v[44:47], v[24:27]
    ds_read_b64_tr_b16 v[86:87], v238 offset:6144
    ds_read_b128 v[68:71], v232 offset:3072
    v_mfma_f32_16x16x32_bf16 v[28:31], v[52:55], v[44:47], v[28:31]
    v_add_u32 v232, s52, v233
    v_add_u32 v235, s52, v239
    v_mfma_f32_16x16x32_bf16 v[32:35], v[56:59], v[44:47], v[32:35]
    v_add_u32 v236, s52, v240
    v_add_u32 v237, s52, v241
    v_mfma_f32_16x16x32_bf16 v[36:39], v[60:63], v[44:47], v[36:39]
    v_add_u32 v238, s52, v242
    s_waitcnt lgkmcnt(0)
    v_mfma_f32_16x16x32_bf16 v[8:11], v[72:75], v[64:67], v[8:11]
    s_waitcnt vmcnt(0)
    s_barrier
    v_mfma_f32_16x16x32_bf16 v[12:15], v[76:79], v[64:67], v[12:15]
    ds_read_b128 v[40:43], v232 offset:0
    ds_read_b64_tr_b16 v[48:49], v235 offset:0
    ds_read_b64_tr_b16 v[50:51], v235 offset:2048
    v_mfma_f32_16x16x32_bf16 v[16:19], v[80:83], v[64:67], v[16:19]
    ds_read_b64_tr_b16 v[52:53], v236 offset:0
    ds_read_b64_tr_b16 v[54:55], v236 offset:2048
    v_mfma_f32_16x16x32_bf16 v[20:23], v[84:87], v[64:67], v[20:23]
    ds_read_b64_tr_b16 v[56:57], v237 offset:0
    ds_read_b64_tr_b16 v[58:59], v237 offset:2048
    ds_read_b64_tr_b16 v[60:61], v238 offset:0
    v_mfma_f32_16x16x32_bf16 v[24:27], v[72:75], v[68:71], v[24:27]
    ds_read_b64_tr_b16 v[62:63], v238 offset:2048
    ds_read_b128 v[44:47], v232 offset:2048
    v_mfma_f32_16x16x32_bf16 v[28:31], v[76:79], v[68:71], v[28:31]
    v_mfma_f32_16x16x32_bf16 v[32:35], v[80:83], v[68:71], v[32:35]
    s_add_u32 s52, s52, 24576
    s_cmp_ge_u32 s52, 147456
    s_cselect_b32 s52, 0, s52
    v_mfma_f32_16x16x32_bf16 v[36:39], v[84:87], v[68:71], v[36:39]
    s_waitcnt lgkmcnt(0)
    v_mfma_f32_16x16x32_bf16 v[8:11], v[48:51], v[40:43], v[8:11]
    ds_read_b128 v[64:67], v232 offset:1024
    ds_read_b64_tr_b16 v[72:73], v235 offset:4096
    v_mfma_f32_16x16x32_bf16 v[12:15], v[52:55], v[40:43], v[12:15]
    ds_read_b64_tr_b16 v[74:75], v235 offset:6144
    ds_read_b64_tr_b16 v[76:77], v236 offset:4096
    v_mfma_f32_16x16x32_bf16 v[16:19], v[56:59], v[40:43], v[16:19]
    ds_read_b64_tr_b16 v[78:79], v236 offset:6144
    ds_read_b64_tr_b16 v[80:81], v237 offset:4096
    v_mfma_f32_16x16x32_bf16 v[20:23], v[60:63], v[40:43], v[20:23]
    ds_read_b64_tr_b16 v[82:83], v237 offset:6144
    ds_read_b64_tr_b16 v[84:85], v238 offset:4096
    v_mfma_f32_16x16x32_bf16 v[24:27], v[48:51], v[44:47], v[24:27]
    s_movk_i32 s54, 6
M_Q_loop2:
    ds_read_b64_tr_b16 v[86:87], v238 offset:6144
    ds_read_b128 v[68:71], v232 offset:3072
    v_mfma_f32_16x16x32_bf16 v[28:31], v[52:55], v[44:47], v[28:31]
    v_add_u32 v232, s52, v233
    v_add_u32 v235, s52, v239
    v_mfma_f32_16x16x32_bf16 v[32:35], v[56:59], v[44:47], v[32:35]
    v_add_u32 v236, s52, v240
    v_add_u32 v237, s52, v241
    v_mfma_f32_16x16x32_bf16 v[36:39], v[60:63], v[44:47], v[36:39]
    v_add_u32 v238, s52, v242
    s_waitcnt lgkmcnt(0)
    v_mfma_f32_16x16x32_bf16 v[8:11], v[72:75], v[64:67], v[8:11]
    s_barrier
    v_mfma_f32_16x16x32_bf16 v[12:15], v[76:79], v[64:67], v[12:15]
    ds_read_b128 v[40:43], v232 offset:0
    ds_read_b64_tr_b16 v[48:49], v235 offset:0
    ds_read_b64_tr_b16 v[50:51], v235 offset:2048
    v_mfma_f32_16x16x32_bf16 v[16:19], v[80:83], v[64:67], v[16:19]
    ds_read_b64_tr_b16 v[52:53], v236 offset:0
    ds_read_b64_tr_b16 v[54:55], v236 offset:2048
    v_mfma_f32_16x16x32_bf16 v[20:23], v[84:87], v[64:67], v[20:23]
    ds_read_b64_tr_b16 v[56:57], v237 offset:0
    ds_read_b64_tr_b16 v[58:59], v237 offset:2048
    ds_read_b64_tr_b16 v[60:61], v238 offset:0
    v_mfma_f32_16x16x32_bf16 v[24:27], v[72:75], v[68:71], v[24:27]
    ds_read_b64_tr_b16 v[62:63], v238 offset:2048
    ds_read_b128 v[44:47], v232 offset:2048
    v_mfma_f32_16x16x32_bf16 v[28:31], v[76:79], v[68:71], v[28:31]
    v_mfma_f32_16x16x32_bf16 v[32:35], v[80:83], v[68:71], v[32:35]
    s_add_u32 s52, s52, 24576
    s_cmp_ge_u32 s52, 147456
    s_cselect_b32 s52, 0, s52
    v_mfma_f32_16x16x32_bf16 v[36:39], v[84:87], v[68:71], v[36:39]
    s_waitcnt lgkmcnt(0)
    v_mfma_f32_16x16x32_bf16 v[8:11], v[48:51], v[40:43], v[8:11]
    ds_read_b128 v[64:67], v232 offset:1024
    ds_read_b64_tr_b16 v[72:73], v235 offset:4096
    v_mfma_f32_16x16x32_bf16 v[12:15], v[52:55], v[40:43], v[12:15]
    ds_read_b64_tr_b16 v[74:75], v235 offset:6144
    ds_read_b64_tr_b16 v[76:77], v236 offset:4096
    v_mfma_f32_16x16x32_bf16 v[16:19], v[56:59], v[40:43], v[16:19]
    ds_read_b64_tr_b16 v[78:79], v236 offset:6144
    ds_read_b64_tr_b16 v[80:81], v237 offset:4096
    v_mfma_f32_16x16x32_bf16 v[20:23], v[60:63], v[40:43], v[20:23]
    s_sub_u32 s54, s54, 1
    ds_read_b64_tr_b16 v[82:83], v237 offset:6144
    ds_read_b64_tr_b16 v[84:85], v238 offset:4096
    v_mfma_f32_16x16x32_bf16 v[24:27], v[48:51], v[44:47], v[24:27]
    s_cbranch_scc0 M_Q_loop2
    ds_read_b64_tr_b16 v[86:87], v238 offset:6144
    ds_read_b128 v[68:71], v232 offset:3072
    v_mfma_f32_16x16x32_bf16 v[28:31], v[52:55], v[44:47], v[28:31]
    v_add_u32 v232, s52, v233
    v_add_u32 v235, s52, v239
    v_mfma_f32_16x16x32_bf16 v[32:35], v[56:59], v[44:47], v[32:35]
    v_add_u32 v236, s52, v240
    v_add_u32 v237, s52, v241
    v_mfma_f32_16x16x32_bf16 v[36:39], v[60:63], v[44:47], v[36:39]
    v_add_u32 v238, s52, v242
    s_waitcnt lgkmcnt(0)
    v_mfma_f32_16x16x32_bf16 v[8:11], v[72:75], v[64:67], v[8:11]
    s_barrier
    v_mfma_f32_16x16x32_bf16 v[12:15], v[76:79], v[64:67], v[12:15]
    ds_read_b128 v[40:43], v232 offset:0
    ds_read_b64_tr_b16 v[48:49], v235 offset:0
    ds_read_b64_tr_b16 v[50:51], v235 offset:2048
    v_mfma_f32_16x16x32_bf16 v[16:19], v[80:83], v[64:67], v[16:19]
    ds_read_b64_tr_b16 v[52:53], v236 offset:0
    ds_read_b64_tr_b16 v[54:55], v236 offset:2048
    v_mfma_f32_16x16x32_bf16 v[20:23], v[84:87], v[64:67], v[20:23]
    ds_read_b64_tr_b16 v[56:57], v237 offset:0
    ds_read_b64_tr_b16 v[58:59], v237 offset:2048
    ds_read_b64_tr_b16 v[60:61], v238 offset:0
    v_mfma_f32_16x16x32_bf16 v[24:27], v[72:75], v[68:71], v[24:27]
    ds_read_b64_tr_b16 v[62:63], v238 offset:2048
    ds_read_b128 v[44:47], v232 offset:2048
    v_mfma_f32_16x16x32_bf16 v[28:31], v[76:79], v[68:71], v[28:31]
    v_mfma_f32_16x16x32_bf16 v[32:35], v[80:83], v[68:71], v[32:35]
    s_add_u32 s52, s52, 24576
    s_cmp_ge_u32 s52, 147456
    s_cselect_b32 s52, 0, s52
    v_mfma_f32_16x16x32_bf16 v[36:39], v[84:87], v[68:71], v[36:39]
    s_waitcnt lgkmcnt(0)
    v_mfma_f32_16x16x32_bf16 v[8:11], v[48:51], v[40:43], v[8:11]
    ds_read_b128 v[64:67], v232 offset:1024
    ds_read_b64_tr_b16 v[72:73], v235 offset:4096
    v_mfma_f32_16x16x32_bf16 v[12:15], v[52:55], v[40:43], v[12:15]
    ds_read_b64_tr_b16 v[74:75], v235 offset:6144
    ds_read_b64_tr_b16 v[76:77], v236 offset:4096
    ds_read_b128 v[136:139], v199 offset:0
    v_mfma_f32_16x16x32_bf16 v[16:19], v[56:59], v[40:43], v[16:19]
    ds_read_b64_tr_b16 v[78:79], v236 offset:6144
    ds_read_b64_tr_b16 v[80:81], v237 offset:4096
    ds_read_b128 v[140:143], v199 offset:64
    v_mfma_f32_16x16x32_bf16 v[20:23], v[60:63], v[40:43], v[20:23]
    ds_read_b64_tr_b16 v[82:83], v237 offset:6144
    ds_read_b64_tr_b16 v[84:85], v238 offset:4096
    v_mfma_f32_16x16x32_bf16 v[24:27], v[48:51], v[44:47], v[24:27]
    ds_read_b64_tr_b16 v[86:87], v238 offset:6144
    ds_read_b128 v[68:71], v232 offset:3072
    ds_read_b128 v[144:147], v199 offset:128
    v_mfma_f32_16x16x32_bf16 v[28:31], v[52:55], v[44:47], v[28:31]
    v_add_u32 v232, s52, v233
    v_add_u32 v235, s52, v239
    v_mfma_f32_16x16x32_bf16 v[32:35], v[56:59], v[44:47], v[32:35]
    v_add_u32 v236, s52, v240
    v_add_u32 v237, s52, v241
    ds_read_b128 v[148:151], v199 offset:192
    v_mfma_f32_16x16x32_bf16 v[36:39], v[60:63], v[44:47], v[36:39]
    v_add_u32 v238, s52, v242
    s_waitcnt lgkmcnt(0)
    v_mfma_f32_16x16x32_bf16 v[8:11], v[72:75], v[64:67], v[8:11]
    s_barrier
    v_mfma_f32_16x16x32_bf16 v[12:15], v[76:79], v[64:67], v[12:15]
    ds_read_b128 v[40:43], v232 offset:0
    ds_read_b64_tr_b16 v[48:49], v235 offset:0
    ds_read_b64_tr_b16 v[50:51], v235 offset:2048
    ds_read_b128 v[152:155], v199 offset:256
    v_mfma_f32_16x16x32_bf16 v[16:19], v[80:83], v[64:67], v[16:19]
    ds_read_b64_tr_b16 v[52:53], v236 offset:0
    ds_read_b64_tr_b16 v[54:55], v236 offset:2048
    ds_read_b128 v[156:159], v199 offset:320
    v_mfma_f32_16x16x32_bf16 v[20:23], v[84:87], v[64:67], v[20:23]
    ds_read_b64_tr_b16 v[56:57], v237 offset:0
    ds_read_b64_tr_b16 v[58:59], v237 offset:2048
    ds_read_b64_tr_b16 v[60:61], v238 offset:0
    v_mfma_f32_16x16x32_bf16 v[24:27], v[72:75], v[68:71], v[24:27]
    ds_read_b64_tr_b16 v[62:63], v238 offset:2048
    ds_read_b128 v[44:47], v232 offset:2048
    ds_read_b128 v[160:163], v199 offset:384
    v_mfma_f32_16x16x32_bf16 v[28:31], v[76:79], v[68:71], v[28:31]
    v_mfma_f32_16x16x32_bf16 v[32:35], v[80:83], v[68:71], v[32:35]
    s_add_u32 s52, s52, 24576
    s_cmp_ge_u32 s52, 147456
    s_cselect_b32 s52, 0, s52
    ds_read_b128 v[164:167], v199 offset:448
    v_mfma_f32_16x16x32_bf16 v[36:39], v[84:87], v[68:71], v[36:39]
    s_waitcnt lgkmcnt(0)
    v_mfma_f32_16x16x32_bf16 v[8:11], v[48:51], v[40:43], v[8:11]
    ds_read_b128 v[64:67], v232 offset:1024
    ds_read_b64_tr_b16 v[72:73], v235 offset:4096
    v_mfma_f32_16x16x32_bf16 v[12:15], v[52:55], v[40:43], v[12:15]
    ds_read_b64_tr_b16 v[74:75], v235 offset:6144
    ds_read_b64_tr_b16 v[76:77], v236 offset:4096
    ds_read_b128 v[168:171], v199 offset:512
    v_mfma_f32_16x16x32_bf16 v[16:19], v[56:59], v[40:43], v[16:19]
    ds_read_b64_tr_b16 v[78:79], v236 offset:6144
    ds_read_b64_tr_b16 v[80:81], v237 offset:4096
    ds_read_b128 v[172:175], v199 offset:576
    v_mfma_f32_16x16x32_bf16 v[20:23], v[60:63], v[40:43], v[20:23]
    ds_read_b64_tr_b16 v[82:83], v237 offset:6144
    ds_read_b64_tr_b16 v[84:85], v238 offset:4096
    v_mfma_f32_16x16x32_bf16 v[24:27], v[48:51], v[44:47], v[24:27]
    ds_read_b64_tr_b16 v[86:87], v238 offset:6144
    ds_read_b128 v[68:71], v232 offset:3072
    ds_read_b128 v[176:179], v199 offset:640
    v_mfma_f32_16x16x32_bf16 v[28:31], v[52:55], v[44:47], v[28:31]
    v_add_u32 v232, s52, v233
    v_add_u32 v235, s52, v239
    v_mfma_f32_16x16x32_bf16 v[32:35], v[56:59], v[44:47], v[32:35]
    v_add_u32 v236, s52, v240
    v_add_u32 v237, s52, v241
    ds_read_b128 v[180:183], v199 offset:704
    v_mfma_f32_16x16x32_bf16 v[36:39], v[60:63], v[44:47], v[36:39]
    v_add_u32 v238, s52, v242
    s_waitcnt lgkmcnt(0)
    v_mfma_f32_16x16x32_bf16 v[8:11], v[72:75], v[64:67], v[8:11]
    s_barrier
    v_mfma_f32_16x16x32_bf16 v[12:15], v[76:79], v[64:67], v[12:15]
    ds_read_b128 v[40:43], v232 offset:0
    ds_read_b64_tr_b16 v[48:49], v235 offset:0
    ds_read_b64_tr_b16 v[50:51], v235 offset:2048
    v_mfma_f32_16x16x32_bf16 v[16:19], v[80:83], v[64:67], v[16:19]
    ds_read_b64_tr_b16 v[52:53], v236 offset:0
    ds_read_b64_tr_b16 v[54:55], v236 offset:2048
    v_mfma_f32_16x16x32_bf16 v[20:23], v[84:87], v[64:67], v[20:23]
    ds_read_b64_tr_b16 v[56:57], v237 offset:0
    ds_read_b64_tr_b16 v[58:59], v237 offset:2048
    ds_read_b64_tr_b16 v[60:61], v238 offset:0
    v_mfma_f32_16x16x32_bf16 v[24:27], v[72:75], v[68:71], v[24:27]
    ds_read_b64_tr_b16 v[62:63], v238 offset:2048
    ds_read_b128 v[44:47], v232 offset:2048
    v_mfma_f32_16x16x32_bf16 v[28:31], v[76:79], v[68:71], v[28:31]
    v_mfma_f32_16x16x32_bf16 v[32:35], v[80:83], v[68:71], v[32:35]
    s_add_u32 s52, s52, 24576
    s_cmp_ge_u32 s52, 147456
    s_cselect_b32 s52, 0, s52
    v_mfma_f32_16x16x32_bf16 v[36:39], v[84:87], v[68:71], v[36:39]
    s_waitcnt lgkmcnt(0)
    v_mfma_f32_16x16x32_bf16 v[8:11], v[48:51], v[40:43], v[8:11]
    ds_read_b128 v[64:67], v232 offset:1024
    ds_read_b64_tr_b16 v[72:73], v235 offset:4096
    v_mfma_f32_16x16x32_bf16 v[12:15], v[52:55], v[40:43], v[12:15]
    ds_read_b64_tr_b16 v[74:75], v235 offset:6144
    ds_read_b64_tr_b16 v[76:77], v236 offset:4096
    v_mfma_f32_16x16x32_bf16 v[16:19], v[56:59], v[40:43], v[16:19]
    ds_read_b64_tr_b16 v[78:79], v236 offset:6144
    ds_read_b64_tr_b16 v[80:81], v237 offset:4096
    v_mfma_f32_16x16x32_bf16 v[20:23], v[60:63], v[40:43], v[20:23]
    ds_read_b64_tr_b16 v[82:83], v237 offset:6144
    ds_read_b64_tr_b16 v[84:85], v238 offset:4096
    v_mfma_f32_16x16x32_bf16 v[24:27], v[48:51], v[44:47], v[24:27]
    ds_read_b64_tr_b16 v[86:87], v238 offset:6144
    ds_read_b128 v[68:71], v232 offset:3072
    v_mfma_f32_16x16x32_bf16 v[28:31], v[52:55], v[44:47], v[28:31]
    v_mfma_f32_16x16x32_bf16 v[32:35], v[56:59], v[44:47], v[32:35]
    v_mfma_f32_16x16x32_bf16 v[36:39], v[60:63], v[44:47], v[36:39]
    s_waitcnt lgkmcnt(0)
    v_mfma_f32_16x16x32_bf16 v[8:11], v[72:75], v[64:67], v[8:11]
    s_barrier
    v_mfma_f32_16x16x32_bf16 v[12:15], v[76:79], v[64:67], v[12:15]
    v_mfma_f32_16x16x32_bf16 v[16:19], v[80:83], v[64:67], v[16:19]
    v_mfma_f32_16x16x32_bf16 v[20:23], v[84:87], v[64:67], v[20:23]
    v_mfma_f32_16x16x32_bf16 v[24:27], v[72:75], v[68:71], v[24:27]
    v_mfma_f32_16x16x32_bf16 v[28:31], v[76:79], v[68:71], v[28:31]
    v_mfma_f32_16x16x32_bf16 v[32:35], v[80:83], v[68:71], v[32:35]
    v_mfma_f32_16x16x32_bf16 v[36:39], v[84:87], v[68:71], v[36:39]
    v_pk_fma_f32 v[104:105], v[8:9], v[136:137], v[104:105]
    v_pk_fma_f32 v[106:107], v[10:11], v[138:139], v[106:107]
    v_pk_fma_f32 v[108:109], v[12:13], v[140:141], v[108:109]
    v_pk_fma_f32 v[110:111], v[14:15], v[142:143], v[110:111]
    v_pk_fma_f32 v[112:113], v[16:17], v[144:145], v[112:113]
    v_pk_fma_f32 v[114:115], v[18:19], v[146:147], v[114:115]
    v_pk_fma_f32 v[116:117], v[20:21], v[148:149], v[116:117]
    v_pk_fma_f32 v[118:119], v[22:23], v[150:151], v[118:119]
    v_pk_fma_f32 v[120:121], v[24:25], v[136:137], v[120:121]
    v_pk_fma_f32 v[122:123], v[26:27], v[138:139], v[122:123]
    v_pk_fma_f32 v[124:125], v[28:29], v[140:141], v[124:125]
    v_pk_fma_f32 v[126:127], v[30:31], v[142:143], v[126:127]
    v_pk_fma_f32 v[128:129], v[32:33], v[144:145], v[128:129]
    v_pk_fma_f32 v[130:131], v[34:35], v[146:147], v[130:131]
    v_pk_fma_f32 v[132:133], v[36:37], v[148:149], v[132:133]
    v_pk_fma_f32 v[134:135], v[38:39], v[150:151], v[134:135]
    v_cvt_pk_bf16_f32 v88, v104, v105
    v_cvt_pk_bf16_f32 v89, v106, v107
    v_cvt_pk_bf16_f32 v90, v108, v109
    v_cvt_pk_bf16_f32 v91, v110, v111
    v_cvt_pk_bf16_f32 v92, v112, v113
    v_cvt_pk_bf16_f32 v93, v114, v115
    v_cvt_pk_bf16_f32 v94, v116, v117
    v_cvt_pk_bf16_f32 v95, v118, v119
    v_cvt_pk_bf16_f32 v96, v120, v121
    v_cvt_pk_bf16_f32 v97, v122, v123
    v_cvt_pk_bf16_f32 v98, v124, v125
    v_cvt_pk_bf16_f32 v99, v126, v127
    v_cvt_pk_bf16_f32 v100, v128, v129
    v_cvt_pk_bf16_f32 v101, v130, v131
    v_cvt_pk_bf16_f32 v102, v132, v133
    v_cvt_pk_bf16_f32 v103, v134, v135
    v_lshlrev_b32 v104, 16, v88
    v_and_b32 v105, 0xffff0000, v88
    v_lshlrev_b32 v106, 16, v89
    v_and_b32 v107, 0xffff0000, v89
    v_lshlrev_b32 v108, 16, v90
    v_and_b32 v109, 0xffff0000, v90
    v_lshlrev_b32 v110, 16, v91
    v_and_b32 v111, 0xffff0000, v91
    v_lshlrev_b32 v112, 16, v92
    v_and_b32 v113, 0xffff0000, v92
    v_lshlrev_b32 v114, 16, v93
    v_and_b32 v115, 0xffff0000, v93
    v_lshlrev_b32 v116, 16, v94
    v_and_b32 v117, 0xffff0000, v94
    v_lshlrev_b32 v118, 16, v95
    v_and_b32 v119, 0xffff0000, v95
    v_lshlrev_b32 v120, 16, v96
    v_and_b32 v121, 0xffff0000, v96
    v_lshlrev_b32 v122, 16, v97
    v_and_b32 v123, 0xffff0000, v97
    v_lshlrev_b32 v124, 16, v98
    v_and_b32 v125, 0xffff0000, v98
    v_lshlrev_b32 v126, 16, v99
    v_and_b32 v127, 0xffff0000, v99
    v_lshlrev_b32 v128, 16, v100
    v_and_b32 v129, 0xffff0000, v100
    v_lshlrev_b32 v130, 16, v101
    v_and_b32 v131, 0xffff0000, v101
    v_lshlrev_b32 v132, 16, v102
    v_and_b32 v133, 0xffff0000, v102
    v_lshlrev_b32 v134, 16, v103
    v_and_b32 v135, 0xffff0000, v103
    v_pk_add_f32 v[40:41], v[104:105], v[106:107]
    v_pk_mul_f32 v[44:45], v[104:105], v[104:105]
    v_pk_add_f32 v[42:43], v[120:121], v[122:123]
    v_pk_mul_f32 v[46:47], v[120:121], v[120:121]
    v_pk_fma_f32 v[44:45], v[106:107], v[106:107], v[44:45]
    v_pk_fma_f32 v[46:47], v[122:123], v[122:123], v[46:47]
    v_pk_add_f32 v[40:41], v[40:41], v[108:109]
    v_pk_fma_f32 v[44:45], v[108:109], v[108:109], v[44:45]
    v_pk_add_f32 v[42:43], v[42:43], v[124:125]
    v_pk_fma_f32 v[46:47], v[124:125], v[124:125], v[46:47]
    v_pk_add_f32 v[40:41], v[40:41], v[110:111]
    v_pk_fma_f32 v[44:45], v[110:111], v[110:111], v[44:45]
    v_pk_add_f32 v[42:43], v[42:43], v[126:127]
    v_pk_fma_f32 v[46:47], v[126:127], v[126:127], v[46:47]
    v_pk_add_f32 v[40:41], v[40:41], v[112:113]
    v_pk_fma_f32 v[44:45], v[112:113], v[112:113], v[44:45]
    v_pk_add_f32 v[42:43], v[42:43], v[128:129]
    v_pk_fma_f32 v[46:47], v[128:129], v[128:129], v[46:47]
    v_pk_add_f32 v[40:41], v[40:41], v[114:115]
    v_pk_fma_f32 v[44:45], v[114:115], v[114:115], v[44:45]
    v_pk_add_f32 v[42:43], v[42:43], v[130:131]
    v_pk_fma_f32 v[46:47], v[130:131], v[130:131], v[46:47]
    v_pk_add_f32 v[40:41], v[40:41], v[116:117]
    v_pk_fma_f32 v[44:45], v[116:117], v[116:117], v[44:45]
    v_pk_add_f32 v[42:43], v[42:43], v[132:133]
    v_pk_fma_f32 v[46:47], v[132:133], v[132:133], v[46:47]
    v_pk_add_f32 v[40:41], v[40:41], v[118:119]
    v_pk_fma_f32 v[44:45], v[118:119], v[118:119], v[44:45]
    v_pk_add_f32 v[42:43], v[42:43], v[134:135]
    v_pk_fma_f32 v[46:47], v[134:135], v[134:135], v[46:47]
    v_add_f32 v40, v40, v41
    v_add_f32 v42, v42, v43
    v_add_f32 v44, v44, v45
    v_add_f32 v46, v46, v47
    v_permlane16_swap_b32 v40, v42
    s_nop 0
    v_permlane16_swap_b32 v44, v46
    v_add_f32 v48, v40, v42
    v_add_f32 v49, v44, v46
    v_mov_b32 v50, v48
    v_mov_b32 v51, v49
    s_nop 0
    v_permlane32_swap_b32 v48, v50
    v_permlane32_swap_b32 v49, v51
    v_add_f32 v48, v48, v50
    v_add_f32 v49, v49, v51
    s_mov_b32 exec_hi, 0
    buffer_store_dwordx2 v[48:49], v195, s[28:31], 0 offen sc1
    s_mov_b32 exec_hi, -1
    buffer_store_dwordx4 v[88:91], v197, s[28:31], s72 offen offset:0 sc1
    buffer_store_dwordx4 v[92:95], v197, s[28:31], s72 offen offset:1024 sc1
    buffer_store_dwordx4 v[96:99], v197, s[28:31], s73 offen offset:0 sc1
    buffer_store_dwordx4 v[100:103], v197, s[28:31], s73 offen offset:1024 sc1
    s_waitcnt vmcnt(0)
    buffer_load_dwordx2 v[56:57], v198, s[28:31], 0 offen offset:0 sc1
    buffer_load_dwordx2 v[58:59], v198, s[28:31], 0 offen offset:512 sc1
    buffer_load_dwordx2 v[60:61], v198, s[28:31], 0 offen offset:1024 sc1
    buffer_load_dwordx2 v[62:63], v198, s[28:31], 0 offen offset:1536 sc1
    buffer_load_dwordx2 v[64:65], v198, s[28:31], 0 offen offset:2048 sc1
    buffer_load_dwordx2 v[66:67], v198, s[28:31], 0 offen offset:2560 sc1
    buffer_load_dwordx2 v[68:69], v198, s[28:31], 0 offen offset:3072 sc1
    buffer_load_dwordx2 v[70:71], v198, s[28:31], 0 offen offset:3584 sc1
    s_waitcnt vmcnt(0)
    s_mov_b32 s3, 0x40000
M_sp_chk:
    v_cmp_eq_u32 s[80:81], -1, v57
    v_cmp_eq_u32 s[82:83], -1, v59
    v_cmp_eq_u32 s[84:85], -1, v61
    v_cmp_eq_u32 s[86:87], -1, v63
    v_cmp_eq_u32 s[88:89], -1, v65
    v_cmp_eq_u32 s[90:91], -1, v67
    v_cmp_eq_u32 s[92:93], -1, v69
    v_cmp_eq_u32 s[94:95], -1, v71
    v_max3_u32 v52, v57, v59, v61
    v_max3_u32 v53, v63, v65, v67
    v_max3_u32 v52, v52, v69, v71
    v_max_u32 v52, v52, v53
    v_cmp_eq_u32 vcc, -1, v52
    s_nop 4
    s_cbranch_vccz M_sp_ok
    s_sub_u32 s3, s3, 1
    s_cbranch_scc1 M_sp_ok
    s_mov_b64 exec, s[80:81]
    buffer_load_dwordx2 v[56:57], v198, s[28:31], 0 offen offset:0 sc1
    s_mov_b64 exec, s[82:83]
    buffer_load_dwordx2 v[58:59], v198, s[28:31], 0 offen offset:512 sc1
    s_mov_b64 exec, s[84:85]
    buffer_load_dwordx2 v[60:61], v198, s[28:31], 0 offen offset:1024 sc1
    s_mov_b64 exec, s[86:87]
    buffer_load_dwordx2 v[62:63], v198, s[28:31], 0 offen offset:1536 sc1
    s_mov_b64 exec, s[88:89]
    buffer_load_dwordx2 v[64:65], v198, s[28:31], 0 offen offset:2048 sc1
    s_mov_b64 exec, s[90:91]
    buffer_load_dwordx2 v[66:67], v198, s[28:31], 0 offen offset:2560 sc1
    s_mov_b64 exec, s[92:93]
    buffer_load_dwordx2 v[68:69], v198, s[28:31], 0 offen offset:3072 sc1
    s_mov_b64 exec, s[94:95]
    buffer_load_dwordx2 v[70:71], v198, s[28:31], 0 offen offset:3584 sc1
    s_mov_b64 exec, -1
    s_waitcnt vmcnt(0)
    s_branch M_sp_chk
M_sp_ok:
    v_pk_add_f32 v[56:57], v[56:57], v[58:59]
    v_pk_add_f32 v[60:61], v[60:61], v[62:63]
    v_pk_add_f32 v[64:65], v[64:65], v[66:67]
    v_pk_add_f32 v[68:69], v[68:69], v[70:71]
    v_pk_add_f32 v[56:57], v[56:57], v[60:61]
    v_pk_add_f32 v[64:65], v[64:65], v[68:69]
    v_pk_add_f32 v[56:57], v[56:57], v[64:65]
    v_mov_b32 v50, v56
    v_mov_b32 v51, v57
    s_nop 0
    v_permlane32_swap_b32 v56, v50
    v_permlane32_swap_b32 v57, v51
    v_add_f32 v56, v56, v50
    v_add_f32 v57, v57, v51
    v_mul_f32 v56, 0x3a800000, v56
    v_mul_f32 v57, 0x3a800000, v57
    v_fma_f32 v57, -v56, v56, v57
    v_max_f32 v57, 0, v57
    v_cvt_pk_bf16_f32 v50, v56, v57
    v_lshlrev_b32 v56, 16, v50
    v_and_b32 v57, 0xffff0000, v50
    v_add_f32 v57, 0x3727c5ac, v57
    v_cvt_pk_bf16_f32 v50, v57, v57
    v_lshlrev_b32 v57, 16, v50
    v_sqrt_f32 v57, v57
    s_nop 0
    v_cvt_pk_bf16_f32 v50, v57, v57
    v_lshlrev_b32 v57, 16, v50
    v_rcp_f32 v40, v57
    s_nop 0
    v_mul_f32 v44, -v56, v40
    v_mov_b32 v42, v40
    v_mov_b32 v46, v44
    s_nop 0
    v_permlane16_swap_b32 v40, v42
    v_permlane16_swap_b32 v44, v46
    v_pk_fma_f32 v[104:105], v[104:105], v[40:41], v[44:45] op_sel_hi:[1,0,0]
    v_pk_fma_f32 v[106:107], v[106:107], v[40:41], v[44:45] op_sel_hi:[1,0,0]
    v_pk_fma_f32 v[108:109], v[108:109], v[40:41], v[44:45] op_sel_hi:[1,0,0]
    v_pk_fma_f32 v[110:111], v[110:111], v[40:41], v[44:45] op_sel_hi:[1,0,0]
    v_pk_fma_f32 v[112:113], v[112:113], v[40:41], v[44:45] op_sel_hi:[1,0,0]
    v_pk_fma_f32 v[114:115], v[114:115], v[40:41], v[44:45] op_sel_hi:[1,0,0]
    v_pk_fma_f32 v[116:117], v[116:117], v[40:41], v[44:45] op_sel_hi:[1,0,0]
    v_pk_fma_f32 v[118:119], v[118:119], v[40:41], v[44:45] op_sel_hi:[1,0,0]
    v_pk_fma_f32 v[104:105], v[104:105], v[168:169], v[152:153]
    v_pk_fma_f32 v[106:107], v[106:107], v[170:171], v[154:155]
    v_pk_fma_f32 v[108:109], v[108:109], v[172:173], v[156:157]
    v_pk_fma_f32 v[110:111], v[110:111], v[174:175], v[158:159]
    v_pk_fma_f32 v[112:113], v[112:113], v[176:177], v[160:161]
    v_pk_fma_f32 v[114:115], v[114:115], v[178:179], v[162:163]
    v_pk_fma_f32 v[116:117], v[116:117], v[180:181], v[164:165]
    v_pk_fma_f32 v[118:119], v[118:119], v[182:183], v[166:167]
    v_cvt_pk_bf16_f32 v72, v104, v105
    v_cvt_pk_bf16_f32 v73, v106, v107
    v_cvt_pk_bf16_f32 v74, v108, v109
    v_cvt_pk_bf16_f32 v75, v110, v111
    buffer_store_dwordx4 v[72:75], v197, s[28:31], s74 offen offset:0 sc1
    ds_write_b128 v233, v[72:75] offset:0
    v_cvt_pk_bf16_f32 v76, v112, v113
    v_cvt_pk_bf16_f32 v77, v114, v115
    v_cvt_pk_bf16_f32 v78, v116, v117
    v_cvt_pk_bf16_f32 v79, v118, v119
    buffer_store_dwordx4 v[76:79], v197, s[28:31], s74 offen offset:1024 sc1
    ds_write_b128 v233, v[76:79] offset:1024
    v_pk_fma_f32 v[120:121], v[120:121], v[42:43], v[46:47] op_sel_hi:[1,0,0]
    v_pk_fma_f32 v[122:123], v[122:123], v[42:43], v[46:47] op_sel_hi:[1,0,0]
    v_pk_fma_f32 v[124:125], v[124:125], v[42:43], v[46:47] op_sel_hi:[1,0,0]
    v_pk_fma_f32 v[126:127], v[126:127], v[42:43], v[46:47] op_sel_hi:[1,0,0]
    v_pk_fma_f32 v[128:129], v[128:129], v[42:43], v[46:47] op_sel_hi:[1,0,0]
    v_pk_fma_f32 v[130:131], v[130:131], v[42:43], v[46:47] op_sel_hi:[1,0,0]
    v_pk_fma_f32 v[132:133], v[132:133], v[42:43], v[46:47] op_sel_hi:[1,0,0]
    v_pk_fma_f32 v[134:135], v[134:135], v[42:43], v[46:47] op_sel_hi:[1,0,0]
    v_pk_fma_f32 v[120:121], v[120:121], v[168:169], v[152:153]
    v_pk_fma_f32 v[122:123], v[122:123], v[170:171], v[154:155]
    v_pk_fma_f32 v[124:125], v[124:125], v[172:173], v[156:157]
    v_pk_fma_f32 v[126:127], v[126:127], v[174:175], v[158:159]
    v_pk_fma_f32 v[128:129], v[128:129], v[176:177], v[160:161]
    v_pk_fma_f32 v[130:131], v[130:131], v[178:179], v[162:163]
    v_pk_fma_f32 v[132:133], v[132:133], v[180:181], v[164:165]
    v_pk_fma_f32 v[134:135], v[134:135], v[182:183], v[166:167]
    v_cvt_pk_bf16_f32 v80, v120, v121
    v_cvt_pk_bf16_f32 v81, v122, v123
    v_cvt_pk_bf16_f32 v82, v124, v125
    v_cvt_pk_bf16_f32 v83, v126, v127
    buffer_store_dwordx4 v[80:83], v197, s[28:31], s75 offen offset:0 sc1
    ds_write_b128 v233, v[80:83] offset:2048
    v_cvt_pk_bf16_f32 v84, v128, v129
    v_cvt_pk_bf16_f32 v85, v130, v131
    v_cvt_pk_bf16_f32 v86, v132, v133
    v_cvt_pk_bf16_f32 v87, v134, v135
    buffer_store_dwordx4 v[84:87], v197, s[28:31], s75 offen offset:1024 sc1
    ds_write_b128 v233, v[84:87] offset:3072
    s_waitcnt lgkmcnt(0)
    s_barrier
    s_and_b32 s57, s58, 15
    s_lshr_b64 s[58:59], s[58:59], 4
    s_lshl_b32 s56, s57, 11
    s_mul_i32 s57, s57, 0x70000
    s_add_u32 s53, s53, 49152
    s_cmp_ge_u32 s53, s61
    s_cselect_b32 s53, s60, s53
    s_and_b32 s57, s58, 15
    s_lshr_b64 s[58:59], s[58:59], 4
    s_lshl_b32 s56, s57, 11
    s_mul_i32 s57, s57, 0x70000
    s_add_u32 m0, s53, 16384
    s_nop 0
    buffer_load_dwordx4 v208, s[32:35], s57 offen offset:0 lds
    buffer_load_dwordx4 v209, s[32:35], s57 offen offset:1024 lds
    buffer_load_dwordx4 v210, s[32:35], s57 offen offset:2048 lds
    buffer_load_dwordx4 v211, s[32:35], s57 offen offset:3072 lds
    s_add_u32 m0, s53, 32768
    s_nop 0
    buffer_load_dwordx4 v208, s[36:39], s57 offen offset:0 lds
    buffer_load_dwordx4 v209, s[36:39], s57 offen offset:1024 lds
    buffer_load_dwordx4 v210, s[36:39], s57 offen offset:2048 lds
    buffer_load_dwordx4 v211, s[36:39], s57 offen offset:3072 lds
    s_add_u32 s53, s53, 49152
    s_cmp_ge_u32 s53, s61
    s_cselect_b32 s53, s60, s53
    s_lshl_b32 s60, s44, 12
    s_add_u32 s61, s60, 147456
    s_add_u32 s53, s60, 0
    s_bfe_u32 s66, s2, 0x30003
    s_lshr_b32 s55, s2, 6
    s_add_u32 s66, s66, s55
    s_and_b32 s66, s66, 3
    s_mov_b32 s58, 0x76453210
    s_mov_b32 s59, 0xfecdba89
    s_cmp_eq_u32 s66, 1
    s_cselect_b32 s58, 0x75643120, s58
    s_cselect_b32 s59, 0xfdecb9a8, s59
    s_cmp_eq_u32 s66, 2
    s_cselect_b32 s58, 0x67542310, s58
    s_cselect_b32 s59, 0xefdcab98, s59
    s_cmp_eq_u32 s66, 3
    s_cselect_b32 s58, 0x86534210, s58
    s_cselect_b32 s59, 0xfedbca97, s59
    s_and_b32 s66, s48, 15
    s_lshl_b32 s55, s66, 2
    s_lshr_b64 s[56:57], s[58:59], s55
    s_and_b32 s55, s56, 15
    s_lshl_b32 s55, s55, 2
    s_lshl_b64 s[56:57], 15, s55
    s_andn2_b64 s[58:59], s[58:59], s[56:57]
    s_or_b32 s58, s58, s66
    s_mov_b32 s32, s12
    s_mov_b32 s33, s13
    s_mov_b32 s34, 0x700000
    s_mov_b32 s35, 0x20000
    s_mov_b32 s36, s14
    s_mov_b32 s37, s15
    s_mov_b32 s38, 0x700000
    s_mov_b32 s39, 0x20000
    s_lshl_b32 s68, s47, 9
    s_add_u32 s68, s68, 0x56000
    s_add_u32 s62, s26, s68
    s_addc_u32 s63, s27, 0
    s_lshr_b32 s68, s48, 2
    s_lshl_b32 s68, s68, 7
    v_mov_b32 v2, 1
    v_mov_b32 v5, 148488
    s_waitcnt vmcnt(8)
    s_mov_b64 exec, 1
    ds_add_rtn_u32 v245, v5, v2
    s_mov_b64 exec, -1
    s_mov_b32 s1, s0
    s_lshl_b32 s64, s48, 2
    s_waitcnt lgkmcnt(0)
    v_readfirstlane_b32 s3, v245
    s_nop 3
    s_cmp_lg_u32 s3, 3
    s_cbranch_scc1 M_ph_ok
    s_atomic_swap s0, s[62:63], s64 offset:0
    s_atomic_swap s0, s[62:63], s64 offset:128
    s_atomic_swap s0, s[62:63], s64 offset:256
    s_atomic_swap s0, s[62:63], s64 offset:384
    s_mov_b32 s3, 0x40000
M_ph_chk:
    s_load_dwordx16 s[80:95], s[62:63], s68 glc
    s_sub_u32 s3, s3, 1
    s_cbranch_scc1 M_ph_ok
M_ph_c2:
    s_waitcnt lgkmcnt(0)
    s_xor_b64 s[80:81], s[80:81], s[0:1]
    s_xor_b64 s[82:83], s[82:83], s[0:1]
    s_xor_b64 s[84:85], s[84:85], s[0:1]
    s_xor_b64 s[86:87], s[86:87], s[0:1]
    s_xor_b64 s[88:89], s[88:89], s[0:1]
    s_xor_b64 s[90:91], s[90:91], s[0:1]
    s_xor_b64 s[92:93], s[92:93], s[0:1]
    s_xor_b64 s[94:95], s[94:95], s[0:1]
    s_or_b64 s[80:81], s[80:81], s[82:83]
    s_or_b64 s[84:85], s[84:85], s[86:87]
    s_or_b64 s[88:89], s[88:89], s[90:91]
    s_or_b64 s[92:93], s[92:93], s[94:95]
    s_or_b64 s[80:81], s[80:81], s[84:85]
    s_or_b64 s[88:89], s[88:89], s[92:93]
    s_or_b64 s[80:81], s[80:81], s[88:89]
    s_cbranch_scc1 M_ph_chk
M_ph_ok:
    s_barrier
    s_setprio 0
    s_and_b32 s57, s58, 15
    s_lshr_b64 s[58:59], s[58:59], 4
    s_lshl_b32 s56, s57, 11
    s_mul_i32 s57, s57, 0x70000
    s_add_u32 s53, s53, 49152
    s_cmp_ge_u32 s53, s61
    s_cselect_b32 s53, s60, s53
    s_and_b32 s57, s58, 15
    s_lshr_b64 s[58:59], s[58:59], 4
    s_lshl_b32 s56, s57, 11
    s_mul_i32 s57, s57, 0x70000
    s_mov_b32 m0, s53
    s_nop 0
    buffer_load_dwordx4 v206, s[28:31], s56 offen offset:0 sc1 lds
    buffer_load_dwordx4 v206, s[28:31], s56 offen offset:1024 sc1 lds
    buffer_load_dwordx4 v207, s[28:31], s56 offen offset:2048 sc1 lds
    buffer_load_dwordx4 v207, s[28:31], s56 offen offset:3072 sc1 lds
    s_add_u32 s53, s53, 49152
    s_cmp_ge_u32 s53, s61
    s_cselect_b32 s53, s60, s53
    s_and_b32 s57, s58, 15
    s_lshr_b64 s[58:59], s[58:59], 4
    s_lshl_b32 s56, s57, 11
    s_mul_i32 s57, s57, 0x70000
    s_add_u32 m0, s53, 16384
    s_nop 0
    buffer_load_dwordx4 v208, s[32:35], s57 offen offset:0 lds
    buffer_load_dwordx4 v209, s[32:35], s57 offen offset:1024 lds
    buffer_load_dwordx4 v210, s[32:35], s57 offen offset:2048 lds
    buffer_load_dwordx4 v211, s[32:35], s57 offen offset:3072 lds
    s_add_u32 m0, s53, 32768
    s_nop 0
    buffer_load_dwordx4 v208, s[36:39], s57 offen offset:0 lds
    buffer_load_dwordx4 v209, s[36:39], s57 offen offset:1024 lds
    buffer_load_dwordx4 v210, s[36:39], s57 offen offset:2048 lds
    buffer_load_dwordx4 v211, s[36:39], s57 offen offset:3072 lds
    s_mov_b32 m0, s53
    s_nop 0
    buffer_load_dwordx4 v206, s[28:31], s56 offen offset:0 sc1 lds
    buffer_load_dwordx4 v206, s[28:31], s56 offen offset:1024 sc1 lds
    buffer_load_dwordx4 v207, s[28:31], s56 offen offset:2048 sc1 lds
    buffer_load_dwordx4 v207, s[28:31], s56 offen offset:3072 sc1 lds
    s_add_u32 s53, s53, 49152
    s_cmp_ge_u32 s53, s61
    s_cselect_b32 s53, s60, s53
    s_lshl_b32 s64, s45, 13
    v_lshl_add_u32 v233, v1, 4, s64
    v_lshrrev_b32 v2, 2, v1
    v_lshlrev_b32 v4, 8, v2
    v_and_b32 v5, 3, v1
    v_lshl_add_u32 v4, v5, 3, v4
    v_add_u32 v4, 16384, v4
    v_and_b32 v2, 7, v2
    s_lshl_b32 s64, s46, 2
    v_xor_b32 v2, s64, v2
    v_xor_b32 v3, 0, v2
    v_lshl_add_u32 v239, v3, 5, v4
    v_xor_b32 v3, 1, v2
    v_lshl_add_u32 v240, v3, 5, v4
    v_xor_b32 v3, 2, v2
    v_lshl_add_u32 v241, v3, 5, v4
    v_xor_b32 v3, 3, v2
    v_lshl_add_u32 v242, v3, 5, v4
    s_mov_b32 s52, 49152
    v_add_u32 v232, s52, v233
    v_add_u32 v235, s52, v239
    v_add_u32 v236, s52, v240
    v_add_u32 v237, s52, v241
    v_add_u32 v238, s52, v242
    s_lshl_b32 s64, s2, 2
    s_add_u32 s64, s64, s44
    s_mul_i32 s64, s64, 7168
    s_add_u32 s64, s64, 5248
    s_add_u32 s10, s12, s64
    s_addc_u32 s11, s13, 0
    s_add_u32 s24, s14, s64
    s_addc_u32 s25, s15, 0
    s_movk_i32 s54, 12
M_Q_loop3:
    s_waitcnt vmcnt(12)
    s_barrier
    s_and_b32 s57, s58, 15
    s_lshr_b64 s[58:59], s[58:59], 4
    s_lshl_b32 s56, s57, 11
    s_mul_i32 s57, s57, 0x70000
    s_add_u32 m0, s53, 16384
    s_nop 0
    buffer_load_dwordx4 v208, s[32:35], s57 offen offset:0 lds
    buffer_load_dwordx4 v209, s[32:35], s57 offen offset:1024 lds
    buffer_load_dwordx4 v210, s[32:35], s57 offen offset:2048 lds
    buffer_load_dwordx4 v211, s[32:35], s57 offen offset:3072 lds
    s_add_u32 m0, s53, 32768
    s_nop 0
    buffer_load_dwordx4 v208, s[36:39], s57 offen offset:0 lds
    buffer_load_dwordx4 v209, s[36:39], s57 offen offset:1024 lds
    buffer_load_dwordx4 v210, s[36:39], s57 offen offset:2048 lds
    buffer_load_dwordx4 v211, s[36:39], s57 offen offset:3072 lds
    s_mov_b32 m0, s53
    s_nop 0
    buffer_load_dwordx4 v206, s[28:31], s56 offen offset:0 sc1 lds
    buffer_load_dwordx4 v206, s[28:31], s56 offen offset:1024 sc1 lds
    buffer_load_dwordx4 v207, s[28:31], s56 offen offset:2048 sc1 lds
    buffer_load_dwordx4 v207, s[28:31], s56 offen offset:3072 sc1 lds
    s_add_u32 s53, s53, 49152
    s_cmp_ge_u32 s53, s61
    s_cselect_b32 s53, s60, s53
    s_sub_u32 s54, s54, 1
    s_cbranch_scc0 M_Q_loop3
    s_waitcnt vmcnt(12)
    s_barrier
    s_bfe_u32 s66, s2, 0x30003
    s_lshr_b32 s55, s2, 6
    s_add_u32 s66, s66, s55
    s_mul_i32 s55, s66, 11
    s_lshr_b32 s55, s55, 5
    s_mul_i32 s55, s55, 3
    s_sub_u32 s66, s66, s55
    s_mov_b32 s58, 0x67534201
    s_mov_b32 s59, 0xfecdb9a8
    s_cmp_eq_u32 s66, 1
    s_cselect_b32 s58, 0x86453120, s58
    s_cselect_b32 s59, 0xfdecab97, s59
    s_cmp_eq_u32 s66, 2
    s_cselect_b32 s58, 0x75642310, s58
    s_cselect_b32 s59, 0xefdbca89, s59
    v_or_b32 v206, s69, v206
    v_or_b32 v207, s69, v207
    s_and_b32 s57, s58, 15
    s_lshr_b64 s[58:59], s[58:59], 4
    s_lshl_b32 s56, s57, 11
    s_mul_i32 s57, s57, 0x70000
    s_add_u32 m0, s53, 16384
    s_nop 0
    buffer_load_dwordx4 v212, s[32:35], s57 offen offset:0 lds
    buffer_load_dwordx4 v213, s[32:35], s57 offen offset:1024 lds
    buffer_load_dwordx4 v214, s[32:35], s57 offen offset:2048 lds
    buffer_load_dwordx4 v215, s[32:35], s57 offen offset:3072 lds
    s_add_u32 m0, s53, 32768
    s_nop 0
    buffer_load_dwordx4 v212, s[36:39], s57 offen offset:0 lds
    buffer_load_dwordx4 v213, s[36:39], s57 offen offset:1024 lds
    buffer_load_dwordx4 v214, s[36:39], s57 offen offset:2048 lds
    buffer_load_dwordx4 v215, s[36:39], s57 offen offset:3072 lds
    s_mov_b32 m0, s53
    s_nop 0
    buffer_load_dwordx4 v206, s[28:31], s56 offen offset:0 sc1 lds
    buffer_load_dwordx4 v206, s[28:31], s56 offen offset:1024 sc1 lds
    buffer_load_dwordx4 v207, s[28:31], s56 offen offset:2048 sc1 lds
    buffer_load_dwordx4 v207, s[28:31], s56 offen offset:3072 sc1 lds
    s_add_u32 s53, s53, 49152
    s_cmp_ge_u32 s53, s61
    s_cselect_b32 s53, s60, s53
    s_waitcnt vmcnt(12)
    s_barrier
    s_and_b32 s57, s58, 15
    s_lshr_b64 s[58:59], s[58:59], 4
    s_lshl_b32 s56, s57, 11
    s_mul_i32 s57, s57, 0x70000
    s_add_u32 m0, s53, 16384
    s_nop 0
    buffer_load_dwordx4 v212, s[32:35], s57 offen offset:0 lds
    buffer_load_dwordx4 v213, s[32:35], s57 offen offset:1024 lds
    buffer_load_dwordx4 v214, s[32:35], s57 offen offset:2048 lds
    buffer_load_dwordx4 v215, s[32:35], s57 offen offset:3072 lds
    s_add_u32 m0, s53, 32768
    s_nop 0
    buffer_load_dwordx4 v212, s[36:39], s57 offen offset:0 lds
    buffer_load_dwordx4 v213, s[36:39], s57 offen offset:1024 lds
    buffer_load_dwordx4 v214, s[36:39], s57 offen offset:2048 lds
    buffer_load_dwordx4 v215, s[36:39], s57 offen offset:3072 lds
    s_mov_b32 m0, s53
    s_nop 0
    buffer_load_dwordx4 v206, s[28:31], s56 offen offset:0 sc1 lds
    buffer_load_dwordx4 v206, s[28:31], s56 offen offset:1024 sc1 lds
    buffer_load_dwordx4 v207, s[28:31], s56 offen offset:2048 sc1 lds
    buffer_load_dwordx4 v207, s[28:31], s56 offen offset:3072 sc1 lds
    s_add_u32 s53, s53, 49152
    s_cmp_ge_u32 s53, s61
    s_cselect_b32 s53, s60, s53
    s_waitcnt vmcnt(12)
    s_barrier
    s_cmp_lg_u32 s69, 0
    s_cbranch_scc1 M_Qidle
    ds_read_b128 v[136:139], v232 offset:0
    ds_read_b64_tr_b16 v[152:153], v235 offset:0
    ds_read_b64_tr_b16 v[154:155], v235 offset:4096
    ds_read_b64_tr_b16 v[156:157], v236 offset:0
    ds_read_b64_tr_b16 v[158:159], v236 offset:4096
    ds_read_b64_tr_b16 v[160:161], v237 offset:0
    ds_read_b64_tr_b16 v[162:163], v237 offset:4096
    ds_read_b64_tr_b16 v[164:165], v238 offset:0
    ds_read_b64_tr_b16 v[166:167], v238 offset:4096
    ds_read_b64_tr_b16 v[168:169], v235 offset:16384
    ds_read_b64_tr_b16 v[170:171], v235 offset:20480
    ds_read_b64_tr_b16 v[172:173], v236 offset:16384
    ds_read_b64_tr_b16 v[174:175], v236 offset:20480
    ds_read_b64_tr_b16 v[176:177], v237 offset:16384
    ds_read_b64_tr_b16 v[178:179], v237 offset:20480
    ds_read_b64_tr_b16 v[180:181], v238 offset:16384
    ds_read_b64_tr_b16 v[182:183], v238 offset:20480
    ds_read_b128 v[140:143], v232 offset:2048
    ds_read_b128 v[144:147], v232 offset:4096
    ds_read_b128 v[148:151], v232 offset:6144
    s_and_b32 s57, s58, 15
    s_lshr_b64 s[58:59], s[58:59], 4
    s_lshl_b32 s56, s57, 11
    s_mul_i32 s57, s57, 0x70000
    s_add_u32 m0, s53, 16384
    s_nop 0
    buffer_load_dwordx4 v212, s[32:35], s57 offen offset:0 lds
    buffer_load_dwordx4 v213, s[32:35], s57 offen offset:1024 lds
    buffer_load_dwordx4 v214, s[32:35], s57 offen offset:2048 lds
    buffer_load_dwordx4 v215, s[32:35], s57 offen offset:3072 lds
    s_add_u32 m0, s53, 32768
    s_nop 0
    buffer_load_dwordx4 v212, s[36:39], s57 offen offset:0 lds
    buffer_load_dwordx4 v213, s[36:39], s57 offen offset:1024 lds
    buffer_load_dwordx4 v214, s[36:39], s57 offen offset:2048 lds
    buffer_load_dwordx4 v215, s[36:39], s57 offen offset:3072 lds
    s_mov_b32 m0, s53
    s_nop 0
    buffer_load_dwordx4 v206, s[28:31], s56 offen offset:0 sc1 lds
    buffer_load_dwordx4 v206, s[28:31], s56 offen offset:1024 sc1 lds
    buffer_load_dwordx4 v207, s[28:31], s56 offen offset:2048 sc1 lds
    buffer_load_dwordx4 v207, s[28:31], s56 offen offset:3072 sc1 lds
    s_add_u32 s53, s53, 49152
    s_cmp_ge_u32 s53, s61
    s_cselect_b32 s53, s60, s53
    s_setprio 2
    s_add_u32 s52, s52, 49152
    s_cmp_ge_u32 s52, 147456
    s_cselect_b32 s52, 0, s52
    s_waitcnt lgkmcnt(0)
    v_mfma_f32_16x16x32_bf16 v[8:11], v[152:155], v[136:139], 0
    ds_read_b128 v[184:187], v232 offset:1024
    v_mfma_f32_16x16x32_bf16 v[12:15], v[156:159], v[136:139], 0
    ds_read_b64_tr_b16 v[200:201], v235 offset:8192
    v_mfma_f32_16x16x32_bf16 v[16:19], v[160:163], v[136:139], 0
    ds_read_b64_tr_b16 v[202:203], v235 offset:12288
    v_mfma_f32_16x16x32_bf16 v[20:23], v[164:167], v[136:139], 0
    ds_read_b64_tr_b16 v[204:205], v236 offset:8192
    v_mfma_f32_16x16x32_bf16 v[24:27], v[168:171], v[136:139], 0
    v_mfma_f32_16x16x32_bf16 v[28:31], v[172:175], v[136:139], 0
    ds_read_b64_tr_b16 v[206:207], v236 offset:12288
    v_mfma_f32_16x16x32_bf16 v[32:35], v[176:179], v[136:139], 0
    ds_read_b64_tr_b16 v[208:209], v237 offset:8192
    v_mfma_f32_16x16x32_bf16 v[36:39], v[180:183], v[136:139], 0
    ds_read_b64_tr_b16 v[210:211], v237 offset:12288
    v_mfma_f32_16x16x32_bf16 v[40:43], v[152:155], v[140:143], 0
    ds_read_b64_tr_b16 v[212:213], v238 offset:8192
    v_mfma_f32_16x16x32_bf16 v[44:47], v[156:159], v[140:143], 0
    v_mfma_f32_16x16x32_bf16 v[48:51], v[160:163], v[140:143], 0
    ds_read_b64_tr_b16 v[214:215], v238 offset:12288
    v_mfma_f32_16x16x32_bf16 v[52:55], v[164:167], v[140:143], 0
    ds_read_b64_tr_b16 v[216:217], v235 offset:24576
    v_mfma_f32_16x16x32_bf16 v[56:59], v[168:171], v[140:143], 0
    ds_read_b64_tr_b16 v[218:219], v235 offset:28672
    v_mfma_f32_16x16x32_bf16 v[60:63], v[172:175], v[140:143], 0
    ds_read_b64_tr_b16 v[220:221], v236 offset:24576
    v_mfma_f32_16x16x32_bf16 v[64:67], v[176:179], v[140:143], 0
    v_mfma_f32_16x16x32_bf16 v[68:71], v[180:183], v[140:143], 0
    ds_read_b64_tr_b16 v[222:223], v236 offset:28672
    v_mfma_f32_16x16x32_bf16 v[72:75], v[152:155], v[144:147], 0
    ds_read_b64_tr_b16 v[224:225], v237 offset:24576
    v_mfma_f32_16x16x32_bf16 v[76:79], v[156:159], v[144:147], 0
    ds_read_b64_tr_b16 v[226:227], v237 offset:28672
    v_mfma_f32_16x16x32_bf16 v[80:83], v[160:163], v[144:147], 0
    ds_read_b64_tr_b16 v[228:229], v238 offset:24576
    v_mfma_f32_16x16x32_bf16 v[84:87], v[164:167], v[144:147], 0
    v_mfma_f32_16x16x32_bf16 v[88:91], v[168:171], v[144:147], 0
    ds_read_b64_tr_b16 v[230:231], v238 offset:28672
    v_mfma_f32_16x16x32_bf16 v[92:95], v[172:175], v[144:147], 0
    ds_read_b128 v[188:191], v232 offset:3072
    v_mfma_f32_16x16x32_bf16 v[96:99], v[176:179], v[144:147], 0
    ds_read_b128 v[192:195], v232 offset:5120
    v_mfma_f32_16x16x32_bf16 v[100:103], v[180:183], v[144:147], 0
    ds_read_b128 v[196:199], v232 offset:7168
    v_mfma_f32_16x16x32_bf16 v[104:107], v[152:155], v[148:151], 0
    v_mfma_f32_16x16x32_bf16 v[108:111], v[156:159], v[148:151], 0
    v_add_u32 v232, s52, v233
    v_mfma_f32_16x16x32_bf16 v[112:115], v[160:163], v[148:151], 0
    v_add_u32 v235, s52, v239
    v_mfma_f32_16x16x32_bf16 v[116:119], v[164:167], v[148:151], 0
    v_add_u32 v236, s52, v240
    v_mfma_f32_16x16x32_bf16 v[120:123], v[168:171], v[148:151], 0
    v_mfma_f32_16x16x32_bf16 v[124:127], v[172:175], v[148:151], 0
    v_add_u32 v237, s52, v241
    v_mfma_f32_16x16x32_bf16 v[128:131], v[176:179], v[148:151], 0
    v_add_u32 v238, s52, v242
    v_mfma_f32_16x16x32_bf16 v[132:135], v[180:183], v[148:151], 0
    s_waitcnt lgkmcnt(0)
    v_mfma_f32_16x16x32_bf16 v[8:11], v[200:203], v[184:187], v[8:11]
    s_waitcnt vmcnt(12)
    s_barrier
    v_mfma_f32_16x16x32_bf16 v[12:15], v[204:207], v[184:187], v[12:15]
    ds_read_b128 v[136:139], v232 offset:0
    v_mfma_f32_16x16x32_bf16 v[16:19], v[208:211], v[184:187], v[16:19]
    ds_read_b64_tr_b16 v[152:153], v235 offset:0
    v_mfma_f32_16x16x32_bf16 v[20:23], v[212:215], v[184:187], v[20:23]
    ds_read_b64_tr_b16 v[154:155], v235 offset:4096
    v_mfma_f32_16x16x32_bf16 v[24:27], v[216:219], v[184:187], v[24:27]
    ds_read_b64_tr_b16 v[156:157], v236 offset:0
    v_mfma_f32_16x16x32_bf16 v[28:31], v[220:223], v[184:187], v[28:31]
    ds_read_b64_tr_b16 v[158:159], v236 offset:4096
    v_mfma_f32_16x16x32_bf16 v[32:35], v[224:227], v[184:187], v[32:35]
    v_mfma_f32_16x16x32_bf16 v[36:39], v[228:231], v[184:187], v[36:39]
    ds_read_b64_tr_b16 v[160:161], v237 offset:0
    v_mfma_f32_16x16x32_bf16 v[40:43], v[200:203], v[188:191], v[40:43]
    ds_read_b64_tr_b16 v[162:163], v237 offset:4096
    v_mfma_f32_16x16x32_bf16 v[44:47], v[204:207], v[188:191], v[44:47]
    ds_read_b64_tr_b16 v[164:165], v238 offset:0
    v_mfma_f32_16x16x32_bf16 v[48:51], v[208:211], v[188:191], v[48:51]
    ds_read_b64_tr_b16 v[166:167], v238 offset:4096
    v_mfma_f32_16x16x32_bf16 v[52:55], v[212:215], v[188:191], v[52:55]
    ds_read_b64_tr_b16 v[168:169], v235 offset:16384
    v_mfma_f32_16x16x32_bf16 v[56:59], v[216:219], v[188:191], v[56:59]
    v_mfma_f32_16x16x32_bf16 v[60:63], v[220:223], v[188:191], v[60:63]
    ds_read_b64_tr_b16 v[170:171], v235 offset:20480
    v_mfma_f32_16x16x32_bf16 v[64:67], v[224:227], v[188:191], v[64:67]
    ds_read_b64_tr_b16 v[172:173], v236 offset:16384
    v_mfma_f32_16x16x32_bf16 v[68:71], v[228:231], v[188:191], v[68:71]
    ds_read_b64_tr_b16 v[174:175], v236 offset:20480
    v_mfma_f32_16x16x32_bf16 v[72:75], v[200:203], v[192:195], v[72:75]
    ds_read_b64_tr_b16 v[176:177], v237 offset:16384
    v_mfma_f32_16x16x32_bf16 v[76:79], v[204:207], v[192:195], v[76:79]
    ds_read_b64_tr_b16 v[178:179], v237 offset:20480
    v_mfma_f32_16x16x32_bf16 v[80:83], v[208:211], v[192:195], v[80:83]
    v_mfma_f32_16x16x32_bf16 v[84:87], v[212:215], v[192:195], v[84:87]
    ds_read_b64_tr_b16 v[180:181], v238 offset:16384
    v_mfma_f32_16x16x32_bf16 v[88:91], v[216:219], v[192:195], v[88:91]
    ds_read_b64_tr_b16 v[182:183], v238 offset:20480
    v_mfma_f32_16x16x32_bf16 v[92:95], v[220:223], v[192:195], v[92:95]
    ds_read_b128 v[140:143], v232 offset:2048
    v_mfma_f32_16x16x32_bf16 v[96:99], v[224:227], v[192:195], v[96:99]
    ds_read_b128 v[144:147], v232 offset:4096
    v_mfma_f32_16x16x32_bf16 v[100:103], v[228:231], v[192:195], v[100:103]
    ds_read_b128 v[148:151], v232 offset:6144
    v_mfma_f32_16x16x32_bf16 v[104:107], v[200:203], v[196:199], v[104:107]
    v_mfma_f32_16x16x32_bf16 v[108:111], v[204:207], v[196:199], v[108:111]
    v_mfma_f32_16x16x32_bf16 v[112:115], v[208:211], v[196:199], v[112:115]
    v_mfma_f32_16x16x32_bf16 v[116:119], v[212:215], v[196:199], v[116:119]
    v_mfma_f32_16x16x32_bf16 v[120:123], v[216:219], v[196:199], v[120:123]
    v_mfma_f32_16x16x32_bf16 v[124:127], v[220:223], v[196:199], v[124:127]
    v_mfma_f32_16x16x32_bf16 v[128:131], v[224:227], v[196:199], v[128:131]
    s_add_u32 s52, s52, 49152
    s_cmp_ge_u32 s52, 147456
    s_cselect_b32 s52, 0, s52
    v_mfma_f32_16x16x32_bf16 v[132:135], v[228:231], v[196:199], v[132:135]
    s_waitcnt lgkmcnt(0)
    v_mfma_f32_16x16x32_bf16 v[8:11], v[152:155], v[136:139], v[8:11]
    ds_read_b128 v[184:187], v232 offset:1024
    v_mfma_f32_16x16x32_bf16 v[12:15], v[156:159], v[136:139], v[12:15]
    ds_read_b64_tr_b16 v[200:201], v235 offset:8192
    v_mfma_f32_16x16x32_bf16 v[16:19], v[160:163], v[136:139], v[16:19]
    ds_read_b64_tr_b16 v[202:203], v235 offset:12288
    v_mfma_f32_16x16x32_bf16 v[20:23], v[164:167], v[136:139], v[20:23]
    ds_read_b64_tr_b16 v[204:205], v236 offset:8192
    v_mfma_f32_16x16x32_bf16 v[24:27], v[168:171], v[136:139], v[24:27]
    v_mfma_f32_16x16x32_bf16 v[28:31], v[172:175], v[136:139], v[28:31]
    ds_read_b64_tr_b16 v[206:207], v236 offset:12288
    v_mfma_f32_16x16x32_bf16 v[32:35], v[176:179], v[136:139], v[32:35]
    ds_read_b64_tr_b16 v[208:209], v237 offset:8192
    v_mfma_f32_16x16x32_bf16 v[36:39], v[180:183], v[136:139], v[36:39]
    ds_read_b64_tr_b16 v[210:211], v237 offset:12288
    v_mfma_f32_16x16x32_bf16 v[40:43], v[152:155], v[140:143], v[40:43]
    ds_read_b64_tr_b16 v[212:213], v238 offset:8192
    v_mfma_f32_16x16x32_bf16 v[44:47], v[156:159], v[140:143], v[44:47]
    v_mfma_f32_16x16x32_bf16 v[48:51], v[160:163], v[140:143], v[48:51]
    ds_read_b64_tr_b16 v[214:215], v238 offset:12288
    v_mfma_f32_16x16x32_bf16 v[52:55], v[164:167], v[140:143], v[52:55]
    ds_read_b64_tr_b16 v[216:217], v235 offset:24576
    v_mfma_f32_16x16x32_bf16 v[56:59], v[168:171], v[140:143], v[56:59]
    ds_read_b64_tr_b16 v[218:219], v235 offset:28672
    v_mfma_f32_16x16x32_bf16 v[60:63], v[172:175], v[140:143], v[60:63]
    ds_read_b64_tr_b16 v[220:221], v236 offset:24576
    v_mfma_f32_16x16x32_bf16 v[64:67], v[176:179], v[140:143], v[64:67]
    v_mfma_f32_16x16x32_bf16 v[68:71], v[180:183], v[140:143], v[68:71]
    ds_read_b64_tr_b16 v[222:223], v236 offset:28672
    v_mfma_f32_16x16x32_bf16 v[72:75], v[152:155], v[144:147], v[72:75]
    ds_read_b64_tr_b16 v[224:225], v237 offset:24576
    v_mfma_f32_16x16x32_bf16 v[76:79], v[156:159], v[144:147], v[76:79]
    ds_read_b64_tr_b16 v[226:227], v237 offset:28672
    v_mfma_f32_16x16x32_bf16 v[80:83], v[160:163], v[144:147], v[80:83]
    ds_read_b64_tr_b16 v[228:229], v238 offset:24576
    v_mfma_f32_16x16x32_bf16 v[84:87], v[164:167], v[144:147], v[84:87]
    v_mfma_f32_16x16x32_bf16 v[88:91], v[168:171], v[144:147], v[88:91]
    ds_read_b64_tr_b16 v[230:231], v238 offset:28672
    v_mfma_f32_16x16x32_bf16 v[92:95], v[172:175], v[144:147], v[92:95]
    ds_read_b128 v[188:191], v232 offset:3072
    v_mfma_f32_16x16x32_bf16 v[96:99], v[176:179], v[144:147], v[96:99]
    ds_read_b128 v[192:195], v232 offset:5120
    v_mfma_f32_16x16x32_bf16 v[100:103], v[180:183], v[144:147], v[100:103]
    ds_read_b128 v[196:199], v232 offset:7168
    v_mfma_f32_16x16x32_bf16 v[104:107], v[152:155], v[148:151], v[104:107]
    v_mfma_f32_16x16x32_bf16 v[108:111], v[156:159], v[148:151], v[108:111]
    v_add_u32 v232, s52, v233
    v_mfma_f32_16x16x32_bf16 v[112:115], v[160:163], v[148:151], v[112:115]
    v_add_u32 v235, s52, v239
    v_mfma_f32_16x16x32_bf16 v[116:119], v[164:167], v[148:151], v[116:119]
    v_add_u32 v236, s52, v240
    v_mfma_f32_16x16x32_bf16 v[120:123], v[168:171], v[148:151], v[120:123]
    v_mfma_f32_16x16x32_bf16 v[124:127], v[172:175], v[148:151], v[124:127]
    v_add_u32 v237, s52, v241
    v_mfma_f32_16x16x32_bf16 v[128:131], v[176:179], v[148:151], v[128:131]
    v_add_u32 v238, s52, v242
    v_mfma_f32_16x16x32_bf16 v[132:135], v[180:183], v[148:151], v[132:135]
    s_waitcnt lgkmcnt(0)
    v_mfma_f32_16x16x32_bf16 v[8:11], v[200:203], v[184:187], v[8:11]
    s_waitcnt vmcnt(0)
    s_barrier
    v_mfma_f32_16x16x32_bf16 v[12:15], v[204:207], v[184:187], v[12:15]
    ds_read_b128 v[136:139], v232 offset:0
    v_mfma_f32_16x16x32_bf16 v[16:19], v[208:211], v[184:187], v[16:19]
    ds_read_b64_tr_b16 v[152:153], v235 offset:0
    v_mfma_f32_16x16x32_bf16 v[20:23], v[212:215], v[184:187], v[20:23]
    ds_read_b64_tr_b16 v[154:155], v235 offset:4096
    v_mfma_f32_16x16x32_bf16 v[24:27], v[216:219], v[184:187], v[24:27]
    ds_read_b64_tr_b16 v[156:157], v236 offset:0
    v_mfma_f32_16x16x32_bf16 v[28:31], v[220:223], v[184:187], v[28:31]
    ds_read_b64_tr_b16 v[158:159], v236 offset:4096
    v_mfma_f32_16x16x32_bf16 v[32:35], v[224:227], v[184:187], v[32:35]
    v_mfma_f32_16x16x32_bf16 v[36:39], v[228:231], v[184:187], v[36:39]
    ds_read_b64_tr_b16 v[160:161], v237 offset:0
    v_mfma_f32_16x16x32_bf16 v[40:43], v[200:203], v[188:191], v[40:43]
    ds_read_b64_tr_b16 v[162:163], v237 offset:4096
    v_mfma_f32_16x16x32_bf16 v[44:47], v[204:207], v[188:191], v[44:47]
    ds_read_b64_tr_b16 v[164:165], v238 offset:0
    v_mfma_f32_16x16x32_bf16 v[48:51], v[208:211], v[188:191], v[48:51]
    ds_read_b64_tr_b16 v[166:167], v238 offset:4096
    v_mfma_f32_16x16x32_bf16 v[52:55], v[212:215], v[188:191], v[52:55]
    ds_read_b64_tr_b16 v[168:169], v235 offset:16384
    v_mfma_f32_16x16x32_bf16 v[56:59], v[216:219], v[188:191], v[56:59]
    v_mfma_f32_16x16x32_bf16 v[60:63], v[220:223], v[188:191], v[60:63]
    ds_read_b64_tr_b16 v[170:171], v235 offset:20480
    v_mfma_f32_16x16x32_bf16 v[64:67], v[224:227], v[188:191], v[64:67]
    ds_read_b64_tr_b16 v[172:173], v236 offset:16384
    v_mfma_f32_16x16x32_bf16 v[68:71], v[228:231], v[188:191], v[68:71]
    ds_read_b64_tr_b16 v[174:175], v236 offset:20480
    v_mfma_f32_16x16x32_bf16 v[72:75], v[200:203], v[192:195], v[72:75]
    ds_read_b64_tr_b16 v[176:177], v237 offset:16384
    v_mfma_f32_16x16x32_bf16 v[76:79], v[204:207], v[192:195], v[76:79]
    ds_read_b64_tr_b16 v[178:179], v237 offset:20480
    v_mfma_f32_16x16x32_bf16 v[80:83], v[208:211], v[192:195], v[80:83]
    v_mfma_f32_16x16x32_bf16 v[84:87], v[212:215], v[192:195], v[84:87]
    ds_read_b64_tr_b16 v[180:181], v238 offset:16384
    v_mfma_f32_16x16x32_bf16 v[88:91], v[216:219], v[192:195], v[88:91]
    ds_read_b64_tr_b16 v[182:183], v238 offset:20480
    v_mfma_f32_16x16x32_bf16 v[92:95], v[220:223], v[192:195], v[92:95]
    ds_read_b128 v[140:143], v232 offset:2048
    v_mfma_f32_16x16x32_bf16 v[96:99], v[224:227], v[192:195], v[96:99]
    ds_read_b128 v[144:147], v232 offset:4096
    v_mfma_f32_16x16x32_bf16 v[100:103], v[228:231], v[192:195], v[100:103]
    ds_read_b128 v[148:151], v232 offset:6144
    v_mfma_f32_16x16x32_bf16 v[104:107], v[200:203], v[196:199], v[104:107]
    v_mfma_f32_16x16x32_bf16 v[108:111], v[204:207], v[196:199], v[108:111]
    v_mfma_f32_16x16x32_bf16 v[112:115], v[208:211], v[196:199], v[112:115]
    v_mfma_f32_16x16x32_bf16 v[116:119], v[212:215], v[196:199], v[116:119]
    v_mfma_f32_16x16x32_bf16 v[120:123], v[216:219], v[196:199], v[120:123]
    v_mfma_f32_16x16x32_bf16 v[124:127], v[220:223], v[196:199], v[124:127]
    v_mfma_f32_16x16x32_bf16 v[128:131], v[224:227], v[196:199], v[128:131]
    s_add_u32 s52, s52, 49152
    s_cmp_ge_u32 s52, 147456
    s_cselect_b32 s52, 0, s52
    v_mfma_f32_16x16x32_bf16 v[132:135], v[228:231], v[196:199], v[132:135]
    s_waitcnt lgkmcnt(0)
    v_mfma_f32_16x16x32_bf16 v[8:11], v[152:155], v[136:139], v[8:11]
    ds_read_b128 v[184:187], v232 offset:1024
    v_mfma_f32_16x16x32_bf16 v[12:15], v[156:159], v[136:139], v[12:15]
    ds_read_b64_tr_b16 v[200:201], v235 offset:8192
    v_mfma_f32_16x16x32_bf16 v[16:19], v[160:163], v[136:139], v[16:19]
    ds_read_b64_tr_b16 v[202:203], v235 offset:12288
    v_mfma_f32_16x16x32_bf16 v[20:23], v[164:167], v[136:139], v[20:23]
    ds_read_b64_tr_b16 v[204:205], v236 offset:8192
    v_mfma_f32_16x16x32_bf16 v[24:27], v[168:171], v[136:139], v[24:27]
    v_mfma_f32_16x16x32_bf16 v[28:31], v[172:175], v[136:139], v[28:31]
    ds_read_b64_tr_b16 v[206:207], v236 offset:12288
    v_mfma_f32_16x16x32_bf16 v[32:35], v[176:179], v[136:139], v[32:35]
    ds_read_b64_tr_b16 v[208:209], v237 offset:8192
    v_mfma_f32_16x16x32_bf16 v[36:39], v[180:183], v[136:139], v[36:39]
    ds_read_b64_tr_b16 v[210:211], v237 offset:12288
    v_mfma_f32_16x16x32_bf16 v[40:43], v[152:155], v[140:143], v[40:43]
    ds_read_b64_tr_b16 v[212:213], v238 offset:8192
    v_mfma_f32_16x16x32_bf16 v[44:47], v[156:159], v[140:143], v[44:47]
    v_mfma_f32_16x16x32_bf16 v[48:51], v[160:163], v[140:143], v[48:51]
    ds_read_b64_tr_b16 v[214:215], v238 offset:12288
    v_mfma_f32_16x16x32_bf16 v[52:55], v[164:167], v[140:143], v[52:55]
    ds_read_b64_tr_b16 v[216:217], v235 offset:24576
    v_mfma_f32_16x16x32_bf16 v[56:59], v[168:171], v[140:143], v[56:59]
    ds_read_b64_tr_b16 v[218:219], v235 offset:28672
    v_mfma_f32_16x16x32_bf16 v[60:63], v[172:175], v[140:143], v[60:63]
    ds_read_b64_tr_b16 v[220:221], v236 offset:24576
    v_mfma_f32_16x16x32_bf16 v[64:67], v[176:179], v[140:143], v[64:67]
    v_mfma_f32_16x16x32_bf16 v[68:71], v[180:183], v[140:143], v[68:71]
    ds_read_b64_tr_b16 v[222:223], v236 offset:28672
    v_mfma_f32_16x16x32_bf16 v[72:75], v[152:155], v[144:147], v[72:75]
    s_movk_i32 s54, 12
M_Q_loop4:
    ds_read_b64_tr_b16 v[224:225], v237 offset:24576
    v_mfma_f32_16x16x32_bf16 v[76:79], v[156:159], v[144:147], v[76:79]
    ds_read_b64_tr_b16 v[226:227], v237 offset:28672
    v_mfma_f32_16x16x32_bf16 v[80:83], v[160:163], v[144:147], v[80:83]
    ds_read_b64_tr_b16 v[228:229], v238 offset:24576
    v_mfma_f32_16x16x32_bf16 v[84:87], v[164:167], v[144:147], v[84:87]
    v_mfma_f32_16x16x32_bf16 v[88:91], v[168:171], v[144:147], v[88:91]
    ds_read_b64_tr_b16 v[230:231], v238 offset:28672
    v_mfma_f32_16x16x32_bf16 v[92:95], v[172:175], v[144:147], v[92:95]
    ds_read_b128 v[188:191], v232 offset:3072
    v_mfma_f32_16x16x32_bf16 v[96:99], v[176:179], v[144:147], v[96:99]
    ds_read_b128 v[192:195], v232 offset:5120
    v_mfma_f32_16x16x32_bf16 v[100:103], v[180:183], v[144:147], v[100:103]
    ds_read_b128 v[196:199], v232 offset:7168
    v_mfma_f32_16x16x32_bf16 v[104:107], v[152:155], v[148:151], v[104:107]
    v_mfma_f32_16x16x32_bf16 v[108:111], v[156:159], v[148:151], v[108:111]
    v_add_u32 v232, s52, v233
    v_mfma_f32_16x16x32_bf16 v[112:115], v[160:163], v[148:151], v[112:115]
    v_add_u32 v235, s52, v239
    v_mfma_f32_16x16x32_bf16 v[116:119], v[164:167], v[148:151], v[116:119]
    v_add_u32 v236, s52, v240
    v_mfma_f32_16x16x32_bf16 v[120:123], v[168:171], v[148:151], v[120:123]
    v_mfma_f32_16x16x32_bf16 v[124:127], v[172:175], v[148:151], v[124:127]
    v_add_u32 v237, s52, v241
    v_mfma_f32_16x16x32_bf16 v[128:131], v[176:179], v[148:151], v[128:131]
    v_add_u32 v238, s52, v242
    v_mfma_f32_16x16x32_bf16 v[132:135], v[180:183], v[148:151], v[132:135]
    s_waitcnt lgkmcnt(0)
    v_mfma_f32_16x16x32_bf16 v[8:11], v[200:203], v[184:187], v[8:11]
    s_barrier
    v_mfma_f32_16x16x32_bf16 v[12:15], v[204:207], v[184:187], v[12:15]
    ds_read_b128 v[136:139], v232 offset:0
    v_mfma_f32_16x16x32_bf16 v[16:19], v[208:211], v[184:187], v[16:19]
    ds_read_b64_tr_b16 v[152:153], v235 offset:0
    v_mfma_f32_16x16x32_bf16 v[20:23], v[212:215], v[184:187], v[20:23]
    ds_read_b64_tr_b16 v[154:155], v235 offset:4096
    v_mfma_f32_16x16x32_bf16 v[24:27], v[216:219], v[184:187], v[24:27]
    ds_read_b64_tr_b16 v[156:157], v236 offset:0
    v_mfma_f32_16x16x32_bf16 v[28:31], v[220:223], v[184:187], v[28:31]
    ds_read_b64_tr_b16 v[158:159], v236 offset:4096
    v_mfma_f32_16x16x32_bf16 v[32:35], v[224:227], v[184:187], v[32:35]
    v_mfma_f32_16x16x32_bf16 v[36:39], v[228:231], v[184:187], v[36:39]
    ds_read_b64_tr_b16 v[160:161], v237 offset:0
    v_mfma_f32_16x16x32_bf16 v[40:43], v[200:203], v[188:191], v[40:43]
    ds_read_b64_tr_b16 v[162:163], v237 offset:4096
    v_mfma_f32_16x16x32_bf16 v[44:47], v[204:207], v[188:191], v[44:47]
    ds_read_b64_tr_b16 v[164:165], v238 offset:0
    v_mfma_f32_16x16x32_bf16 v[48:51], v[208:211], v[188:191], v[48:51]
    ds_read_b64_tr_b16 v[166:167], v238 offset:4096
    v_mfma_f32_16x16x32_bf16 v[52:55], v[212:215], v[188:191], v[52:55]
    ds_read_b64_tr_b16 v[168:169], v235 offset:16384
    v_mfma_f32_16x16x32_bf16 v[56:59], v[216:219], v[188:191], v[56:59]
    v_mfma_f32_16x16x32_bf16 v[60:63], v[220:223], v[188:191], v[60:63]
    ds_read_b64_tr_b16 v[170:171], v235 offset:20480
    v_mfma_f32_16x16x32_bf16 v[64:67], v[224:227], v[188:191], v[64:67]
    ds_read_b64_tr_b16 v[172:173], v236 offset:16384
    v_mfma_f32_16x16x32_bf16 v[68:71], v[228:231], v[188:191], v[68:71]
    ds_read_b64_tr_b16 v[174:175], v236 offset:20480
    v_mfma_f32_16x16x32_bf16 v[72:75], v[200:203], v[192:195], v[72:75]
    ds_read_b64_tr_b16 v[176:177], v237 offset:16384
    v_mfma_f32_16x16x32_bf16 v[76:79], v[204:207], v[192:195], v[76:79]
    ds_read_b64_tr_b16 v[178:179], v237 offset:20480
    v_mfma_f32_16x16x32_bf16 v[80:83], v[208:211], v[192:195], v[80:83]
    v_mfma_f32_16x16x32_bf16 v[84:87], v[212:215], v[192:195], v[84:87]
    ds_read_b64_tr_b16 v[180:181], v238 offset:16384
    v_mfma_f32_16x16x32_bf16 v[88:91], v[216:219], v[192:195], v[88:91]
    ds_read_b64_tr_b16 v[182:183], v238 offset:20480
    v_mfma_f32_16x16x32_bf16 v[92:95], v[220:223], v[192:195], v[92:95]
    ds_read_b128 v[140:143], v232 offset:2048
    v_mfma_f32_16x16x32_bf16 v[96:99], v[224:227], v[192:195], v[96:99]
    ds_read_b128 v[144:147], v232 offset:4096
    v_mfma_f32_16x16x32_bf16 v[100:103], v[228:231], v[192:195], v[100:103]
    ds_read_b128 v[148:151], v232 offset:6144
    v_mfma_f32_16x16x32_bf16 v[104:107], v[200:203], v[196:199], v[104:107]
    v_mfma_f32_16x16x32_bf16 v[108:111], v[204:207], v[196:199], v[108:111]
    v_mfma_f32_16x16x32_bf16 v[112:115], v[208:211], v[196:199], v[112:115]
    v_mfma_f32_16x16x32_bf16 v[116:119], v[212:215], v[196:199], v[116:119]
    v_mfma_f32_16x16x32_bf16 v[120:123], v[216:219], v[196:199], v[120:123]
    v_mfma_f32_16x16x32_bf16 v[124:127], v[220:223], v[196:199], v[124:127]
    v_mfma_f32_16x16x32_bf16 v[128:131], v[224:227], v[196:199], v[128:131]
    s_add_u32 s52, s52, 49152
    s_cmp_ge_u32 s52, 147456
    s_cselect_b32 s52, 0, s52
    v_mfma_f32_16x16x32_bf16 v[132:135], v[228:231], v[196:199], v[132:135]
    s_waitcnt lgkmcnt(0)
    v_mfma_f32_16x16x32_bf16 v[8:11], v[152:155], v[136:139], v[8:11]
    ds_read_b128 v[184:187], v232 offset:1024
    v_mfma_f32_16x16x32_bf16 v[12:15], v[156:159], v[136:139], v[12:15]
    ds_read_b64_tr_b16 v[200:201], v235 offset:8192
    v_mfma_f32_16x16x32_bf16 v[16:19], v[160:163], v[136:139], v[16:19]
    ds_read_b64_tr_b16 v[202:203], v235 offset:12288
    v_mfma_f32_16x16x32_bf16 v[20:23], v[164:167], v[136:139], v[20:23]
    ds_read_b64_tr_b16 v[204:205], v236 offset:8192
    v_mfma_f32_16x16x32_bf16 v[24:27], v[168:171], v[136:139], v[24:27]
    v_mfma_f32_16x16x32_bf16 v[28:31], v[172:175], v[136:139], v[28:31]
    ds_read_b64_tr_b16 v[206:207], v236 offset:12288
    v_mfma_f32_16x16x32_bf16 v[32:35], v[176:179], v[136:139], v[32:35]
    ds_read_b64_tr_b16 v[208:209], v237 offset:8192
    v_mfma_f32_16x16x32_bf16 v[36:39], v[180:183], v[136:139], v[36:39]
    ds_read_b64_tr_b16 v[210:211], v237 offset:12288
    v_mfma_f32_16x16x32_bf16 v[40:43], v[152:155], v[140:143], v[40:43]
    ds_read_b64_tr_b16 v[212:213], v238 offset:8192
    v_mfma_f32_16x16x32_bf16 v[44:47], v[156:159], v[140:143], v[44:47]
    v_mfma_f32_16x16x32_bf16 v[48:51], v[160:163], v[140:143], v[48:51]
    ds_read_b64_tr_b16 v[214:215], v238 offset:12288
    v_mfma_f32_16x16x32_bf16 v[52:55], v[164:167], v[140:143], v[52:55]
    ds_read_b64_tr_b16 v[216:217], v235 offset:24576
    v_mfma_f32_16x16x32_bf16 v[56:59], v[168:171], v[140:143], v[56:59]
    ds_read_b64_tr_b16 v[218:219], v235 offset:28672
    v_mfma_f32_16x16x32_bf16 v[60:63], v[172:175], v[140:143], v[60:63]
    ds_read_b64_tr_b16 v[220:221], v236 offset:24576
    v_mfma_f32_16x16x32_bf16 v[64:67], v[176:179], v[140:143], v[64:67]
    v_mfma_f32_16x16x32_bf16 v[68:71], v[180:183], v[140:143], v[68:71]
    s_sub_u32 s54, s54, 1
    ds_read_b64_tr_b16 v[222:223], v236 offset:28672
    v_mfma_f32_16x16x32_bf16 v[72:75], v[152:155], v[144:147], v[72:75]
    s_cbranch_scc0 M_Q_loop4
    ds_read_b64_tr_b16 v[224:225], v237 offset:24576
    v_mfma_f32_16x16x32_bf16 v[76:79], v[156:159], v[144:147], v[76:79]
    ds_read_b64_tr_b16 v[226:227], v237 offset:28672
    v_mfma_f32_16x16x32_bf16 v[80:83], v[160:163], v[144:147], v[80:83]
    ds_read_b64_tr_b16 v[228:229], v238 offset:24576
    v_mfma_f32_16x16x32_bf16 v[84:87], v[164:167], v[144:147], v[84:87]
    v_mfma_f32_16x16x32_bf16 v[88:91], v[168:171], v[144:147], v[88:91]
    ds_read_b64_tr_b16 v[230:231], v238 offset:28672
    v_mfma_f32_16x16x32_bf16 v[92:95], v[172:175], v[144:147], v[92:95]
    ds_read_b128 v[188:191], v232 offset:3072
    v_mfma_f32_16x16x32_bf16 v[96:99], v[176:179], v[144:147], v[96:99]
    ds_read_b128 v[192:195], v232 offset:5120
    v_mfma_f32_16x16x32_bf16 v[100:103], v[180:183], v[144:147], v[100:103]
    ds_read_b128 v[196:199], v232 offset:7168
    v_mfma_f32_16x16x32_bf16 v[104:107], v[152:155], v[148:151], v[104:107]
    v_mfma_f32_16x16x32_bf16 v[108:111], v[156:159], v[148:151], v[108:111]
    v_mfma_f32_16x16x32_bf16 v[112:115], v[160:163], v[148:151], v[112:115]
    v_mfma_f32_16x16x32_bf16 v[116:119], v[164:167], v[148:151], v[116:119]
    v_mfma_f32_16x16x32_bf16 v[120:123], v[168:171], v[148:151], v[120:123]
    v_mfma_f32_16x16x32_bf16 v[124:127], v[172:175], v[148:151], v[124:127]
    v_mfma_f32_16x16x32_bf16 v[128:131], v[176:179], v[148:151], v[128:131]
    v_mfma_f32_16x16x32_bf16 v[132:135], v[180:183], v[148:151], v[132:135]
    s_waitcnt lgkmcnt(0)
    v_mfma_f32_16x16x32_bf16 v[8:11], v[200:203], v[184:187], v[8:11]
    s_barrier
    v_mfma_f32_16x16x32_bf16 v[12:15], v[204:207], v[184:187], v[12:15]
    v_mfma_f32_16x16x32_bf16 v[16:19], v[208:211], v[184:187], v[16:19]
    v_mfma_f32_16x16x32_bf16 v[20:23], v[212:215], v[184:187], v[20:23]
    v_mfma_f32_16x16x32_bf16 v[24:27], v[216:219], v[184:187], v[24:27]
    v_mfma_f32_16x16x32_bf16 v[28:31], v[220:223], v[184:187], v[28:31]
    v_mfma_f32_16x16x32_bf16 v[32:35], v[224:227], v[184:187], v[32:35]
    v_mfma_f32_16x16x32_bf16 v[36:39], v[228:231], v[184:187], v[36:39]
    v_mfma_f32_16x16x32_bf16 v[40:43], v[200:203], v[188:191], v[40:43]
    v_mfma_f32_16x16x32_bf16 v[44:47], v[204:207], v[188:191], v[44:47]
    v_mfma_f32_16x16x32_bf16 v[48:51], v[208:211], v[188:191], v[48:51]
    v_mfma_f32_16x16x32_bf16 v[52:55], v[212:215], v[188:191], v[52:55]
    v_mfma_f32_16x16x32_bf16 v[56:59], v[216:219], v[188:191], v[56:59]
    v_mfma_f32_16x16x32_bf16 v[60:63], v[220:223], v[188:191], v[60:63]
    v_mfma_f32_16x16x32_bf16 v[64:67], v[224:227], v[188:191], v[64:67]
    v_mfma_f32_16x16x32_bf16 v[68:71], v[228:231], v[188:191], v[68:71]
    v_mfma_f32_16x16x32_bf16 v[72:75], v[200:203], v[192:195], v[72:75]
    v_mfma_f32_16x16x32_bf16 v[76:79], v[204:207], v[192:195], v[76:79]
    v_mfma_f32_16x16x32_bf16 v[80:83], v[208:211], v[192:195], v[80:83]
    v_mfma_f32_16x16x32_bf16 v[84:87], v[212:215], v[192:195], v[84:87]
    v_mfma_f32_16x16x32_bf16 v[88:91], v[216:219], v[192:195], v[88:91]
    v_mfma_f32_16x16x32_bf16 v[92:95], v[220:223], v[192:195], v[92:95]
    v_mfma_f32_16x16x32_bf16 v[96:99], v[224:227], v[192:195], v[96:99]
    v_mfma_f32_16x16x32_bf16 v[100:103], v[228:231], v[192:195], v[100:103]
    v_mfma_f32_16x16x32_bf16 v[104:107], v[200:203], v[196:199], v[104:107]
    v_mfma_f32_16x16x32_bf16 v[108:111], v[204:207], v[196:199], v[108:111]
    v_mfma_f32_16x16x32_bf16 v[112:115], v[208:211], v[196:199], v[112:115]
    v_mfma_f32_16x16x32_bf16 v[116:119], v[212:215], v[196:199], v[116:119]
    v_mfma_f32_16x16x32_bf16 v[120:123], v[216:219], v[196:199], v[120:123]
    v_mfma_f32_16x16x32_bf16 v[124:127], v[220:223], v[196:199], v[124:127]
    v_mfma_f32_16x16x32_bf16 v[128:131], v[224:227], v[196:199], v[128:131]
    v_mfma_f32_16x16x32_bf16 v[132:135], v[228:231], v[196:199], v[132:135]
M_Qjoin:
    s_setprio 0
    s_lshl_b32 s60, s44, 12
    s_add_u32 s61, s60, 147456
    s_add_u32 s53, s60, 98304
    s_bfe_u32 s66, s2, 0x30003
    s_lshr_b32 s55, s2, 6
    s_add_u32 s66, s66, s55
    s_and_b32 s66, s66, 3
    s_mov_b32 s58, 0x31076453
    s_mov_b32 s59, 0x542
    s_cmp_eq_u32 s66, 1
    s_cselect_b32 s58, 0x20175643, s58
    s_cselect_b32 s59, 0x534, s59
    s_cmp_eq_u32 s66, 2
    s_cselect_b32 s58, 0x21067542, s58
    s_cselect_b32 s59, 0x453, s59
    s_cmp_eq_u32 s66, 3
    s_cselect_b32 s58, 0x20176534, s58
    s_cselect_b32 s59, 0x543, s59
    s_lshl_b32 s55, s49, 3
    s_mov_b32 s32, s16
    s_mov_b32 s33, s17
    s_mov_b32 s34, 0x700000
    s_mov_b32 s35, 0x20000
    s_add_u32 s36, s16, 0x100
    s_addc_u32 s37, s17, 0
    s_mov_b32 s38, 0x6fff00
    s_mov_b32 s39, 0x20000
    s_lshr_b32 s62, s48, 2
    s_sub_u32 s62, s48, s62
    s_add_u32 s62, s62, 16
    s_lshl_b32 s70, s62, 12
    s_lshl_b32 s64, s47, 3
    s_lshl_b32 s65, s45, 2
    s_add_u32 s64, s64, s65
    s_mul_i32 s64, s64, 114688
    s_add_u32 s64, s64, s70
    s_lshl_b32 s65, s46, 11
    s_add_u32 s64, s64, s65
    s_add_u32 s64, s64, 0x1500000
    s_or_b32 s64, s64, s69
    v_lshl_add_u32 v198, v1, 4, s64
    v_mul_f32 v24, v8, v24
    v_exp_f32 v216, -v8
    v_mul_f32 v25, v9, v25
    v_exp_f32 v217, -v9
    v_mul_f32 v26, v10, v26
    v_exp_f32 v218, -v10
    v_mul_f32 v27, v11, v27
    v_exp_f32 v219, -v11
    v_mul_f32 v28, v12, v28
    v_exp_f32 v220, -v12
    v_mul_f32 v29, v13, v29
    v_exp_f32 v221, -v13
    v_mul_f32 v30, v14, v30
    v_exp_f32 v222, -v14
    v_mul_f32 v31, v15, v31
    v_exp_f32 v223, -v15
    v_fma_f32 v216, v216, s67, s67
    v_fma_f32 v217, v217, s67, s67
    v_rcp_f32 v216, v216
    v_fma_f32 v218, v218, s67, s67
    v_rcp_f32 v217, v217
    v_fma_f32 v219, v219, s67, s67
    v_rcp_f32 v218, v218
    v_fma_f32 v220, v220, s67, s67
    v_rcp_f32 v219, v219
    v_fma_f32 v221, v221, s67, s67
    v_rcp_f32 v220, v220
    v_fma_f32 v222, v222, s67, s67
    v_rcp_f32 v221, v221
    v_fma_f32 v223, v223, s67, s67
    v_rcp_f32 v222, v222
    v_rcp_f32 v223, v223
    v_mul_f32 v24, v24, v216
    v_mul_f32 v25, v25, v217
    v_mul_f32 v26, v26, v218
    v_mul_f32 v27, v27, v219
    v_mul_f32 v28, v28, v220
    v_mul_f32 v29, v29, v221
    v_mul_f32 v30, v30, v222
    v_mul_f32 v31, v31, v223
    s_barrier
    s_and_b32 s57, s58, 15
    s_lshr_b64 s[58:59], s[58:59], 4
    s_add_u32 s57, s57, s55
    s_lshl_b32 s56, s57, 11
    s_mul_i32 s57, s57, 0x20000
    s_add_u32 m0, s53, 16384
    s_nop 0
    buffer_load_dwordx4 v248, s[32:35], s57 offen offset:0 lds
    v_cvt_pk_bf16_f32 v200, v24, v25
    v_cvt_pk_bf16_f32 v201, v26, v27
    v_cvt_pk_bf16_f32 v202, v28, v29
    v_cvt_pk_bf16_f32 v203, v30, v31
    buffer_load_dwordx4 v249, s[32:35], s57 offen offset:1024 lds
    v_mul_f32 v32, v16, v32
    v_exp_f32 v224, -v16
    v_mul_f32 v33, v17, v33
    v_exp_f32 v225, -v17
    v_mul_f32 v34, v18, v34
    buffer_load_dwordx4 v250, s[32:35], s57 offen offset:2048 lds
    v_exp_f32 v226, -v18
    v_mul_f32 v35, v19, v35
    v_exp_f32 v227, -v19
    v_mul_f32 v36, v20, v36
    v_exp_f32 v228, -v20
    v_mul_f32 v37, v21, v37
    buffer_load_dwordx4 v251, s[32:35], s57 offen offset:3072 lds
    v_exp_f32 v229, -v21
    v_mul_f32 v38, v22, v38
    v_exp_f32 v230, -v22
    v_mul_f32 v39, v23, v39
    s_add_u32 m0, s53, 32768
    s_nop 0
    buffer_load_dwordx4 v248, s[36:39], s57 offen offset:0 lds
    v_exp_f32 v231, -v23
    v_fma_f32 v224, v224, s67, s67
    v_fma_f32 v225, v225, s67, s67
    v_rcp_f32 v224, v224
    v_fma_f32 v226, v226, s67, s67
    v_rcp_f32 v225, v225
    buffer_load_dwordx4 v249, s[36:39], s57 offen offset:1024 lds
    v_fma_f32 v227, v227, s67, s67
    v_rcp_f32 v226, v226
    v_fma_f32 v228, v228, s67, s67
    v_rcp_f32 v227, v227
    v_fma_f32 v229, v229, s67, s67
    v_rcp_f32 v228, v228
    buffer_load_dwordx4 v250, s[36:39], s57 offen offset:2048 lds
    v_fma_f32 v230, v230, s67, s67
    v_rcp_f32 v229, v229
    v_fma_f32 v231, v231, s67, s67
    v_rcp_f32 v230, v230
    buffer_load_dwordx4 v251, s[36:39], s57 offen offset:3072 lds
    v_rcp_f32 v231, v231
    v_mul_f32 v32, v32, v224
    v_mul_f32 v33, v33, v225
    v_mul_f32 v34, v34, v226
    v_mul_f32 v35, v35, v227
    v_mul_f32 v36, v36, v228
    s_mov_b32 m0, s53
    s_nop 0
    buffer_load_dwordx4 v246, s[28:31], s56 offen offset:0 sc1 lds
    v_mul_f32 v37, v37, v229
    v_mul_f32 v38, v38, v230
    v_mul_f32 v39, v39, v231
    v_cvt_pk_bf16_f32 v204, v32, v33
    v_cvt_pk_bf16_f32 v205, v34, v35
    v_cvt_pk_bf16_f32 v206, v36, v37
    buffer_load_dwordx4 v246, s[28:31], s56 offen offset:1024 sc1 lds
    v_cvt_pk_bf16_f32 v207, v38, v39
    v_mul_f32 v56, v40, v56
    v_exp_f32 v216, -v40
    v_mul_f32 v57, v41, v57
    buffer_load_dwordx4 v247, s[28:31], s56 offen offset:2048 sc1 lds
    v_exp_f32 v217, -v41
    v_mul_f32 v58, v42, v58
    v_exp_f32 v218, -v42
    v_mul_f32 v59, v43, v59
    buffer_load_dwordx4 v247, s[28:31], s56 offen offset:3072 sc1 lds
    v_exp_f32 v219, -v43
    v_mul_f32 v60, v44, v60
    v_exp_f32 v220, -v44
    v_mul_f32 v61, v45, v61
    v_exp_f32 v221, -v45
    v_mul_f32 v62, v46, v62
    s_add_u32 s53, s53, 49152
    s_cmp_ge_u32 s53, s61
    s_cselect_b32 s53, s60, s53
    buffer_store_dwordx4 v[200:203], v198, s[28:31], 0 offen offset:0 sc1
    buffer_store_dwordx4 v[204:207], v198, s[28:31], 0 offen offset:1024 sc1
    v_add_u32 v198, 114688, v198
    s_barrier
    s_and_b32 s57, s58, 15
    s_lshr_b64 s[58:59], s[58:59], 4
    s_add_u32 s57, s57, s55
    s_lshl_b32 s56, s57, 11
    s_mul_i32 s57, s57, 0x20000
    s_add_u32 m0, s53, 16384
    s_nop 0
    buffer_load_dwordx4 v248, s[32:35], s57 offen offset:0 lds
    v_exp_f32 v222, -v46
    v_mul_f32 v63, v47, v63
    v_exp_f32 v223, -v47
    v_fma_f32 v216, v216, s67, s67
    v_fma_f32 v217, v217, s67, s67
    v_rcp_f32 v216, v216
    buffer_load_dwordx4 v249, s[32:35], s57 offen offset:1024 lds
    v_fma_f32 v218, v218, s67, s67
    v_rcp_f32 v217, v217
    v_fma_f32 v219, v219, s67, s67
    v_rcp_f32 v218, v218
    buffer_load_dwordx4 v250, s[32:35], s57 offen offset:2048 lds
    v_fma_f32 v220, v220, s67, s67
    v_rcp_f32 v219, v219
    v_fma_f32 v221, v221, s67, s67
    v_rcp_f32 v220, v220
    v_fma_f32 v222, v222, s67, s67
    v_rcp_f32 v221, v221
    buffer_load_dwordx4 v251, s[32:35], s57 offen offset:3072 lds
    v_fma_f32 v223, v223, s67, s67
    v_rcp_f32 v222, v222
    v_rcp_f32 v223, v223
    v_mul_f32 v56, v56, v216
    v_mul_f32 v57, v57, v217
    v_mul_f32 v58, v58, v218
    s_add_u32 m0, s53, 32768
    s_nop 0
    buffer_load_dwordx4 v248, s[36:39], s57 offen offset:0 lds
    v_mul_f32 v59, v59, v219
    v_mul_f32 v60, v60, v220
    v_mul_f32 v61, v61, v221
    v_mul_f32 v62, v62, v222
    buffer_load_dwordx4 v249, s[36:39], s57 offen offset:1024 lds
    v_mul_f32 v63, v63, v223
    v_cvt_pk_bf16_f32 v208, v56, v57
    v_cvt_pk_bf16_f32 v209, v58, v59
    v_cvt_pk_bf16_f32 v210, v60, v61
    v_cvt_pk_bf16_f32 v211, v62, v63
    buffer_load_dwordx4 v250, s[36:39], s57 offen offset:2048 lds
    v_mul_f32 v64, v48, v64
    v_exp_f32 v224, -v48
    v_mul_f32 v65, v49, v65
    v_exp_f32 v225, -v49
    v_mul_f32 v66, v50, v66
    v_exp_f32 v226, -v50
    buffer_load_dwordx4 v251, s[36:39], s57 offen offset:3072 lds
    v_mul_f32 v67, v51, v67
    v_exp_f32 v227, -v51
    v_mul_f32 v68, v52, v68
    v_exp_f32 v228, -v52
    v_mul_f32 v69, v53, v69
    v_exp_f32 v229, -v53
    s_mov_b32 m0, s53
    s_nop 0
    buffer_load_dwordx4 v246, s[28:31], s56 offen offset:0 sc1 lds
    v_mul_f32 v70, v54, v70
    v_exp_f32 v230, -v54
    v_mul_f32 v71, v55, v71
    v_exp_f32 v231, -v55
    buffer_load_dwordx4 v246, s[28:31], s56 offen offset:1024 sc1 lds
    v_fma_f32 v224, v224, s67, s67
    v_fma_f32 v225, v225, s67, s67
    v_rcp_f32 v224, v224
    v_fma_f32 v226, v226, s67, s67
    v_rcp_f32 v225, v225
    v_fma_f32 v227, v227, s67, s67
    buffer_load_dwordx4 v247, s[28:31], s56 offen offset:2048 sc1 lds
    v_rcp_f32 v226, v226
    v_fma_f32 v228, v228, s67, s67
    v_rcp_f32 v227, v227
    v_fma_f32 v229, v229, s67, s67
    v_rcp_f32 v228, v228
    v_fma_f32 v230, v230, s67, s67
    buffer_load_dwordx4 v247, s[28:31], s56 offen offset:3072 sc1 lds
    v_rcp_f32 v229, v229
    v_fma_f32 v231, v231, s67, s67
    v_rcp_f32 v230, v230
    v_rcp_f32 v231, v231
    s_add_u32 s53, s53, 49152
    s_cmp_ge_u32 s53, s61
    s_cselect_b32 s53, s60, s53
    buffer_store_dwordx4 v[208:211], v198, s[28:31], 0 offen offset:0 sc1
    s_waitcnt vmcnt(15)
    s_barrier
    s_and_b32 s57, s58, 15
    s_lshr_b64 s[58:59], s[58:59], 4
    s_add_u32 s57, s57, s55
    s_lshl_b32 s56, s57, 11
    s_mul_i32 s57, s57, 0x20000
    s_add_u32 m0, s53, 16384
    s_nop 0
    buffer_load_dwordx4 v248, s[32:35], s57 offen offset:0 lds
    v_mul_f32 v64, v64, v224
    v_mul_f32 v65, v65, v225
    v_mul_f32 v66, v66, v226
    v_mul_f32 v67, v67, v227
    v_mul_f32 v68, v68, v228
    v_mul_f32 v69, v69, v229
    buffer_load_dwordx4 v249, s[32:35], s57 offen offset:1024 lds
    v_mul_f32 v70, v70, v230
    v_mul_f32 v71, v71, v231
    v_cvt_pk_bf16_f32 v212, v64, v65
    v_cvt_pk_bf16_f32 v213, v66, v67
    v_cvt_pk_bf16_f32 v214, v68, v69
    v_cvt_pk_bf16_f32 v215, v70, v71
    buffer_load_dwordx4 v250, s[32:35], s57 offen offset:2048 lds
    v_mul_f32 v88, v72, v88
    v_exp_f32 v216, -v72
    buffer_load_dwordx4 v251, s[32:35], s57 offen offset:3072 lds
    v_mul_f32 v89, v73, v89
    v_exp_f32 v217, -v73
    v_mul_f32 v90, v74, v90
    v_exp_f32 v218, -v74
    v_mul_f32 v91, v75, v91
    v_exp_f32 v219, -v75
    s_add_u32 m0, s53, 32768
    s_nop 0
    buffer_load_dwordx4 v248, s[36:39], s57 offen offset:0 lds
    v_mul_f32 v92, v76, v92
    v_exp_f32 v220, -v76
    v_mul_f32 v93, v77, v93
    v_exp_f32 v221, -v77
    v_mul_f32 v94, v78, v94
    v_exp_f32 v222, -v78
    buffer_load_dwordx4 v249, s[36:39], s57 offen offset:1024 lds
    v_mul_f32 v95, v79, v95
    v_exp_f32 v223, -v79
    v_fma_f32 v216, v216, s67, s67
    v_fma_f32 v217, v217, s67, s67
    v_rcp_f32 v216, v216
    v_fma_f32 v218, v218, s67, s67
    buffer_load_dwordx4 v250, s[36:39], s57 offen offset:2048 lds
    v_rcp_f32 v217, v217
    v_fma_f32 v219, v219, s67, s67
    v_rcp_f32 v218, v218
    v_fma_f32 v220, v220, s67, s67
    buffer_load_dwordx4 v251, s[36:39], s57 offen offset:3072 lds
    v_rcp_f32 v219, v219
    v_fma_f32 v221, v221, s67, s67
    v_rcp_f32 v220, v220
    v_fma_f32 v222, v222, s67, s67
    v_rcp_f32 v221, v221
    v_fma_f32 v223, v223, s67, s67
    s_mov_b32 m0, s53
    s_nop 0
    buffer_load_dwordx4 v246, s[28:31], s56 offen offset:0 sc1 lds
    v_rcp_f32 v222, v222
    v_rcp_f32 v223, v223
    v_mul_f32 v88, v88, v216
    v_mul_f32 v89, v89, v217
    v_mul_f32 v90, v90, v218
    v_mul_f32 v91, v91, v219
    buffer_load_dwordx4 v246, s[28:31], s56 offen offset:1024 sc1 lds
    v_mul_f32 v92, v92, v220
    v_mul_f32 v93, v93, v221
    v_mul_f32 v94, v94, v222
    v_mul_f32 v95, v95, v223
    buffer_load_dwordx4 v247, s[28:31], s56 offen offset:2048 sc1 lds
    v_cvt_pk_bf16_f32 v200, v88, v89
    v_cvt_pk_bf16_f32 v201, v90, v91
    v_cvt_pk_bf16_f32 v202, v92, v93
    v_cvt_pk_bf16_f32 v203, v94, v95
    v_mul_f32 v96, v80, v96
    buffer_load_dwordx4 v247, s[28:31], s56 offen offset:3072 sc1 lds
    v_exp_f32 v224, -v80
    v_mul_f32 v97, v81, v97
    v_exp_f32 v225, -v81
    v_mul_f32 v98, v82, v98
    v_exp_f32 v226, -v82
    v_mul_f32 v99, v83, v99
    s_add_u32 s53, s53, 49152
    s_cmp_ge_u32 s53, s61
    s_cselect_b32 s53, s60, s53
    buffer_store_dwordx4 v[212:215], v198, s[28:31], 0 offen offset:1024 sc1
    v_add_u32 v198, 114688, v198
    buffer_store_dwordx4 v[200:203], v198, s[28:31], 0 offen offset:0 sc1
    s_waitcnt vmcnt(15)
    s_barrier
    s_and_b32 s57, s58, 15
    s_lshr_b64 s[58:59], s[58:59], 4
    s_add_u32 s57, s57, s55
    s_lshl_b32 s56, s57, 11
    s_mul_i32 s57, s57, 0x20000
    s_add_u32 m0, s53, 16384
    s_nop 0
    buffer_load_dwordx4 v248, s[32:35], s57 offen offset:0 lds
    v_exp_f32 v227, -v83
    v_mul_f32 v100, v84, v100
    v_exp_f32 v228, -v84
    v_mul_f32 v101, v85, v101
    buffer_load_dwordx4 v249, s[32:35], s57 offen offset:1024 lds
    v_exp_f32 v229, -v85
    v_mul_f32 v102, v86, v102
    v_exp_f32 v230, -v86
    v_mul_f32 v103, v87, v103
    v_exp_f32 v231, -v87
    v_fma_f32 v224, v224, s67, s67
    buffer_load_dwordx4 v250, s[32:35], s57 offen offset:2048 lds
    v_fma_f32 v225, v225, s67, s67
    v_rcp_f32 v224, v224
    v_fma_f32 v226, v226, s67, s67
    v_rcp_f32 v225, v225
    v_fma_f32 v227, v227, s67, s67
    v_rcp_f32 v226, v226
    buffer_load_dwordx4 v251, s[32:35], s57 offen offset:3072 lds
    v_fma_f32 v228, v228, s67, s67
    v_rcp_f32 v227, v227
    v_fma_f32 v229, v229, s67, s67
    v_rcp_f32 v228, v228
    v_fma_f32 v230, v230, s67, s67
    v_rcp_f32 v229, v229
    s_add_u32 m0, s53, 32768
    s_nop 0
    buffer_load_dwordx4 v248, s[36:39], s57 offen offset:0 lds
    v_fma_f32 v231, v231, s67, s67
    v_rcp_f32 v230, v230
    v_rcp_f32 v231, v231
    v_mul_f32 v96, v96, v224
    buffer_load_dwordx4 v249, s[36:39], s57 offen offset:1024 lds
    v_mul_f32 v97, v97, v225
    v_mul_f32 v98, v98, v226
    v_mul_f32 v99, v99, v227
    v_mul_f32 v100, v100, v228
    v_mul_f32 v101, v101, v229
    v_mul_f32 v102, v102, v230
    buffer_load_dwordx4 v250, s[36:39], s57 offen offset:2048 lds
    v_mul_f32 v103, v103, v231
    v_cvt_pk_bf16_f32 v204, v96, v97
    v_cvt_pk_bf16_f32 v205, v98, v99
    v_cvt_pk_bf16_f32 v206, v100, v101
    v_cvt_pk_bf16_f32 v207, v102, v103
    buffer_load_dwordx4 v251, s[36:39], s57 offen offset:3072 lds
    v_mul_f32 v120, v104, v120
    v_exp_f32 v216, -v104
    v_mul_f32 v121, v105, v121
    s_mov_b32 m0, s53
    s_nop 0
    buffer_load_dwordx4 v246, s[28:31], s56 offen offset:0 sc1 lds
    v_exp_f32 v217, -v105
    v_mul_f32 v122, v106, v122
    v_exp_f32 v218, -v106
    v_mul_f32 v123, v107, v123
    v_exp_f32 v219, -v107
    v_mul_f32 v124, v108, v124
    buffer_load_dwordx4 v246, s[28:31], s56 offen offset:1024 sc1 lds
    v_exp_f32 v220, -v108
    v_mul_f32 v125, v109, v125
    v_exp_f32 v221, -v109
    v_mul_f32 v126, v110, v126
    v_exp_f32 v222, -v110
    v_mul_f32 v127, v111, v127
    buffer_load_dwordx4 v247, s[28:31], s56 offen offset:2048 sc1 lds
    v_exp_f32 v223, -v111
    v_fma_f32 v216, v216, s67, s67
    v_fma_f32 v217, v217, s67, s67
    v_rcp_f32 v216, v216
    buffer_load_dwordx4 v247, s[28:31], s56 offen offset:3072 sc1 lds
    v_fma_f32 v218, v218, s67, s67
    v_rcp_f32 v217, v217
    v_fma_f32 v219, v219, s67, s67
    v_rcp_f32 v218, v218
    v_fma_f32 v220, v220, s67, s67
    v_rcp_f32 v219, v219
    s_add_u32 s53, s53, 49152
    s_cmp_ge_u32 s53, s61
    s_cselect_b32 s53, s60, s53
    buffer_store_dwordx4 v[204:207], v198, s[28:31], 0 offen offset:1024 sc1
    v_add_u32 v198, 114688, v198
    s_waitcnt vmcnt(15)
    s_barrier
    s_and_b32 s57, s58, 15
    s_lshr_b64 s[58:59], s[58:59], 4
    s_add_u32 s57, s57, s55
    s_lshl_b32 s56, s57, 11
    s_mul_i32 s57, s57, 0x20000
    s_add_u32 m0, s53, 16384
    s_nop 0
    buffer_load_dwordx4 v248, s[32:35], s57 offen offset:0 lds
    v_fma_f32 v221, v221, s67, s67
    v_rcp_f32 v220, v220
    v_fma_f32 v222, v222, s67, s67
    v_rcp_f32 v221, v221
    v_fma_f32 v223, v223, s67, s67
    v_rcp_f32 v222, v222
    buffer_load_dwordx4 v249, s[32:35], s57 offen offset:1024 lds
    v_rcp_f32 v223, v223
    v_mul_f32 v120, v120, v216
    v_mul_f32 v121, v121, v217
    v_mul_f32 v122, v122, v218
    v_mul_f32 v123, v123, v219
    v_mul_f32 v124, v124, v220
    buffer_load_dwordx4 v250, s[32:35], s57 offen offset:2048 lds
    v_mul_f32 v125, v125, v221
    v_mul_f32 v126, v126, v222
    v_mul_f32 v127, v127, v223
    v_cvt_pk_bf16_f32 v208, v120, v121
    buffer_load_dwordx4 v251, s[32:35], s57 offen offset:3072 lds
    v_cvt_pk_bf16_f32 v209, v122, v123
    v_cvt_pk_bf16_f32 v210, v124, v125
    v_cvt_pk_bf16_f32 v211, v126, v127
    v_mul_f32 v128, v112, v128
    v_exp_f32 v224, -v112
    s_add_u32 m0, s53, 32768
    s_nop 0
    buffer_load_dwordx4 v248, s[36:39], s57 offen offset:0 lds
    v_mul_f32 v129, v113, v129
    v_exp_f32 v225, -v113
    v_mul_f32 v130, v114, v130
    v_exp_f32 v226, -v114
    v_mul_f32 v131, v115, v131
    v_exp_f32 v227, -v115
    buffer_load_dwordx4 v249, s[36:39], s57 offen offset:1024 lds
    v_mul_f32 v132, v116, v132
    v_exp_f32 v228, -v116
    v_mul_f32 v133, v117, v133
    v_exp_f32 v229, -v117
    buffer_load_dwordx4 v250, s[36:39], s57 offen offset:2048 lds
    v_mul_f32 v134, v118, v134
    v_exp_f32 v230, -v118
    v_mul_f32 v135, v119, v135
    v_exp_f32 v231, -v119
    v_fma_f32 v224, v224, s67, s67
    v_fma_f32 v225, v225, s67, s67
    buffer_load_dwordx4 v251, s[36:39], s57 offen offset:3072 lds
    v_rcp_f32 v224, v224
    v_fma_f32 v226, v226, s67, s67
    v_rcp_f32 v225, v225
    v_fma_f32 v227, v227, s67, s67
    v_rcp_f32 v226, v226
    v_fma_f32 v228, v228, s67, s67
    s_mov_b32 m0, s53
    s_nop 0
    buffer_load_dwordx4 v246, s[28:31], s56 offen offset:0 sc1 lds
    v_rcp_f32 v227, v227
    v_fma_f32 v229, v229, s67, s67
    v_rcp_f32 v228, v228
    v_fma_f32 v230, v230, s67, s67
    buffer_load_dwordx4 v246, s[28:31], s56 offen offset:1024 sc1 lds
    v_rcp_f32 v229, v229
    v_fma_f32 v231, v231, s67, s67
    v_rcp_f32 v230, v230
    v_rcp_f32 v231, v231
    v_mul_f32 v128, v128, v224
    v_mul_f32 v129, v129, v225
    buffer_load_dwordx4 v247, s[28:31], s56 offen offset:2048 sc1 lds
    v_mul_f32 v130, v130, v226
    v_mul_f32 v131, v131, v227
    v_mul_f32 v132, v132, v228
    v_mul_f32 v133, v133, v229
    v_mul_f32 v134, v134, v230
    v_mul_f32 v135, v135, v231
    buffer_load_dwordx4 v247, s[28:31], s56 offen offset:3072 sc1 lds
    v_cvt_pk_bf16_f32 v212, v128, v129
    v_cvt_pk_bf16_f32 v213, v130, v131
    v_cvt_pk_bf16_f32 v214, v132, v133
    v_cvt_pk_bf16_f32 v215, v134, v135
    s_add_u32 s53, s53, 49152
    s_cmp_ge_u32 s53, s61
    s_cselect_b32 s53, s60, s53
    buffer_store_dwordx4 v[208:211], v198, s[28:31], 0 offen offset:0 sc1
    buffer_store_dwordx4 v[212:215], v198, s[28:31], 0 offen offset:1024 sc1
    s_waitcnt vmcnt(15)
    s_barrier
    s_mul_i32 s55, s49, 6
    s_add_u32 s55, s55, 32
    s_lshl_b32 s66, s51, 1
    s_and_b32 s57, s58, 15
    s_lshr_b64 s[58:59], s[58:59], 4
    s_add_u32 s57, s57, s66
    s_sub_u32 s56, s57, 6
    s_cselect_b32 s57, s57, s56
    s_add_u32 s57, s57, s55
    s_lshl_b32 s56, s57, 11
    s_mul_i32 s57, s57, 0x20000
    s_add_u32 m0, s53, 16384
    s_nop 0
    buffer_load_dwordx4 v248, s[32:35], s57 offen offset:0 lds
    buffer_load_dwordx4 v249, s[32:35], s57 offen offset:1024 lds
    buffer_load_dwordx4 v250, s[32:35], s57 offen offset:2048 lds
    buffer_load_dwordx4 v251, s[32:35], s57 offen offset:3072 lds
    s_add_u32 m0, s53, 32768
    s_nop 0
    buffer_load_dwordx4 v248, s[36:39], s57 offen offset:0 lds
    buffer_load_dwordx4 v249, s[36:39], s57 offen offset:1024 lds
    buffer_load_dwordx4 v250, s[36:39], s57 offen offset:2048 lds
    buffer_load_dwordx4 v251, s[36:39], s57 offen offset:3072 lds
    s_mov_b32 s62, s53
    s_mov_b32 s63, s56
    s_add_u32 s53, s53, 49152
    s_cmp_ge_u32 s53, s61
    s_cselect_b32 s53, s60, s53
    s_lshl_b32 s64, s47, 9
    s_lshl_b32 s65, s49, 7
    s_add_u32 s64, s64, s65
    s_lshl_b32 s65, s51, 4
    s_add_u32 s64, s64, s65
    s_lshl_b32 s65, s44, 2
    s_add_u32 s64, s64, s65
    s_add_u32 s64, s64, 0x52000
    v_mov_b32 v2, s0
    s_waitcnt vmcnt(8)
    s_mov_b64 exec, 1
    buffer_store_dword v2, v234, s[28:31], s64 offen sc1
    s_mov_b64 exec, -1
    s_barrier
    s_cmp_eq_u32 s69, 0
    s_cbranch_scc1 M_pi_ok
    s_lshl_b32 s68, s47, 2
    s_add_u32 s68, s68, s49
    s_lshl_b32 s68, s68, 7
    s_add_u32 s68, s68, 0x52000
    v_min_u32 v234, 44, v234
    v_mov_b32 v245, 0
    v_xor_b32 v245, -1, v2
    s_mov_b32 s3, 0x40000
M_pi_chk:
    v_cmp_ne_u32 vcc, s0, v245
    s_nop 4
    s_cbranch_vccz M_pi_ok
    s_sub_u32 s3, s3, 1
    s_cbranch_scc1 M_pi_ok
    s_sleep 12
    buffer_load_dword v245, v234, s[28:31], s68 offen sc1
    s_waitcnt vmcnt(0)
    s_branch M_pi_chk
M_pi_ok:
    s_mov_b32 m0, s62
    s_nop 0
    buffer_load_dwordx4 v246, s[28:31], s63 offen offset:0 sc1 lds
    buffer_load_dwordx4 v246, s[28:31], s63 offen offset:1024 sc1 lds
    buffer_load_dwordx4 v247, s[28:31], s63 offen offset:2048 sc1 lds
    buffer_load_dwordx4 v247, s[28:31], s63 offen offset:3072 sc1 lds
    s_and_b32 s57, s58, 15
    s_lshr_b64 s[58:59], s[58:59], 4
    s_add_u32 s57, s57, s66
    s_sub_u32 s56, s57, 6
    s_cselect_b32 s57, s57, s56
    s_add_u32 s57, s57, s55
    s_lshl_b32 s56, s57, 11
    s_mul_i32 s57, s57, 0x20000
    s_add_u32 m0, s53, 16384
    s_nop 0
    buffer_load_dwordx4 v248, s[32:35], s57 offen offset:0 lds
    buffer_load_dwordx4 v249, s[32:35], s57 offen offset:1024 lds
    buffer_load_dwordx4 v250, s[32:35], s57 offen offset:2048 lds
    buffer_load_dwordx4 v251, s[32:35], s57 offen offset:3072 lds
    s_add_u32 m0, s53, 32768
    s_nop 0
    buffer_load_dwordx4 v248, s[36:39], s57 offen offset:0 lds
    buffer_load_dwordx4 v249, s[36:39], s57 offen offset:1024 lds
    buffer_load_dwordx4 v250, s[36:39], s57 offen offset:2048 lds
    buffer_load_dwordx4 v251, s[36:39], s57 offen offset:3072 lds
    s_mov_b32 m0, s53
    s_nop 0
    buffer_load_dwordx4 v246, s[28:31], s56 offen offset:0 sc1 lds
    buffer_load_dwordx4 v246, s[28:31], s56 offen offset:1024 sc1 lds
    buffer_load_dwordx4 v247, s[28:31], s56 offen offset:2048 sc1 lds
    buffer_load_dwordx4 v247, s[28:31], s56 offen offset:3072 sc1 lds
    s_add_u32 s53, s53, 49152
    s_cmp_ge_u32 s53, s61
    s_cselect_b32 s53, s60, s53
    s_waitcnt vmcnt(12)
    s_barrier
    s_and_b32 s57, s58, 15
    s_lshr_b64 s[58:59], s[58:59], 4
    s_add_u32 s57, s57, s66
    s_sub_u32 s56, s57, 6
    s_cselect_b32 s57, s57, s56
    s_add_u32 s57, s57, s55
    s_lshl_b32 s56, s57, 11
    s_mul_i32 s57, s57, 0x20000
    s_add_u32 m0, s53, 16384
    s_nop 0
    buffer_load_dwordx4 v248, s[32:35], s57 offen offset:0 lds
    buffer_load_dwordx4 v249, s[32:35], s57 offen offset:1024 lds
    buffer_load_dwordx4 v250, s[32:35], s57 offen offset:2048 lds
    buffer_load_dwordx4 v251, s[32:35], s57 offen offset:3072 lds
    s_add_u32 m0, s53, 32768
    s_nop 0
    buffer_load_dwordx4 v248, s[36:39], s57 offen offset:0 lds
    buffer_load_dwordx4 v249, s[36:39], s57 offen offset:1024 lds
    buffer_load_dwordx4 v250, s[36:39], s57 offen offset:2048 lds
    buffer_load_dwordx4 v251, s[36:39], s57 offen offset:3072 lds
    s_mov_b32 s62, s53
    s_mov_b32 s63, s56
    s_add_u32 s53, s53, 49152
    s_cmp_ge_u32 s53, s61
    s_cselect_b32 s53, s60, s53
    s_lshl_b32 s68, s47, 2
    s_add_u32 s68, s68, s49
    s_lshl_b32 s68, s68, 7
    s_add_u32 s68, s68, 0x52000
    v_min_u32 v234, 44, v234
    buffer_load_dword v245, v234, s[28:31], s68 offen sc1
    s_waitcnt vmcnt(9)
    s_barrier
    s_waitcnt vmcnt(0)
    s_mov_b32 s3, 0x40000
M_pb_chk:
    v_cmp_ne_u32 vcc, s0, v245
    s_nop 4
    s_cbranch_vccz M_pb_ok
    s_sub_u32 s3, s3, 1
    s_cbranch_scc1 M_pb_ok
    s_sleep 2
    s_cmp_eq_u32 s69, 0
    s_cbranch_scc1 M_pb_rl
    s_sleep 48
M_pb_rl:
    buffer_load_dword v245, v234, s[28:31], s68 offen sc1
    s_waitcnt vmcnt(0)
    s_branch M_pb_chk
M_pb_ok:
    s_mov_b32 m0, s62
    s_nop 0
    buffer_load_dwordx4 v246, s[28:31], s63 offen offset:0 sc1 lds
    buffer_load_dwordx4 v246, s[28:31], s63 offen offset:1024 sc1 lds
    buffer_load_dwordx4 v247, s[28:31], s63 offen offset:2048 sc1 lds
    buffer_load_dwordx4 v247, s[28:31], s63 offen offset:3072 sc1 lds
    s_and_b32 s57, s58, 15
    s_lshr_b64 s[58:59], s[58:59], 4
    s_add_u32 s57, s57, s66
    s_sub_u32 s56, s57, 6
    s_cselect_b32 s57, s57, s56
    s_add_u32 s57, s57, s55
    s_lshl_b32 s56, s57, 11
    s_mul_i32 s57, s57, 0x20000
    s_add_u32 m0, s53, 16384
    s_nop 0
    buffer_load_dwordx4 v248, s[32:35], s57 offen offset:0 lds
    buffer_load_dwordx4 v249, s[32:35], s57 offen offset:1024 lds
    buffer_load_dwordx4 v250, s[32:35], s57 offen offset:2048 lds
    buffer_load_dwordx4 v251, s[32:35], s57 offen offset:3072 lds
    s_add_u32 m0, s53, 32768
    s_nop 0
    buffer_load_dwordx4 v248, s[36:39], s57 offen offset:0 lds
    buffer_load_dwordx4 v249, s[36:39], s57 offen offset:1024 lds
    buffer_load_dwordx4 v250, s[36:39], s57 offen offset:2048 lds
    buffer_load_dwordx4 v251, s[36:39], s57 offen offset:3072 lds
    s_mov_b32 m0, s53
    s_nop 0
    buffer_load_dwordx4 v246, s[28:31], s56 offen offset:0 sc1 lds
    buffer_load_dwordx4 v246, s[28:31], s56 offen offset:1024 sc1 lds
    buffer_load_dwordx4 v247, s[28:31], s56 offen offset:2048 sc1 lds
    buffer_load_dwordx4 v247, s[28:31], s56 offen offset:3072 sc1 lds
    s_add_u32 s53, s53, 49152
    s_cmp_ge_u32 s53, s61
    s_cselect_b32 s53, s60, s53
    s_movk_i32 s54, 1
M_Q_loop5:
    s_waitcnt vmcnt(12)
    s_barrier
    s_and_b32 s57, s58, 15
    s_lshr_b64 s[58:59], s[58:59], 4
    s_add_u32 s57, s57, s66
    s_sub_u32 s56, s57, 6
    s_cselect_b32 s57, s57, s56
    s_add_u32 s57, s57, s55
    s_lshl_b32 s56, s57, 11
    s_mul_i32 s57, s57, 0x20000
    s_add_u32 m0, s53, 16384
    s_nop 0
    buffer_load_dwordx4 v248, s[32:35], s57 offen offset:0 lds
    buffer_load_dwordx4 v249, s[32:35], s57 offen offset:1024 lds
    buffer_load_dwordx4 v250, s[32:35], s57 offen offset:2048 lds
    buffer_load_dwordx4 v251, s[32:35], s57 offen offset:3072 lds
    s_add_u32 m0, s53, 32768
    s_nop 0
    buffer_load_dwordx4 v248, s[36:39], s57 offen offset:0 lds
    buffer_load_dwordx4 v249, s[36:39], s57 offen offset:1024 lds
    buffer_load_dwordx4 v250, s[36:39], s57 offen offset:2048 lds
    buffer_load_dwordx4 v251, s[36:39], s57 offen offset:3072 lds
    s_mov_b32 m0, s53
    s_nop 0
    buffer_load_dwordx4 v246, s[28:31], s56 offen offset:0 sc1 lds
    buffer_load_dwordx4 v246, s[28:31], s56 offen offset:1024 sc1 lds
    buffer_load_dwordx4 v247, s[28:31], s56 offen offset:2048 sc1 lds
    buffer_load_dwordx4 v247, s[28:31], s56 offen offset:3072 sc1 lds
    s_add_u32 s53, s53, 49152
    s_cmp_ge_u32 s53, s61
    s_cselect_b32 s53, s60, s53
    s_sub_u32 s54, s54, 1
    s_cbranch_scc0 M_Q_loop5
    s_waitcnt vmcnt(12)
    s_barrier
    s_waitcnt vmcnt(0)
    s_barrier
    s_branch M_fin
M_Qidle:
    s_waitcnt vmcnt(0)
    s_barrier
    v_and_b32 v2, 255, v0
    s_and_b32 s64, s2, 63
    s_lshl_b32 s64, s64, 8
    v_add_lshl_u32 v243, v2, s64, 6
    s_waitcnt vmcnt(0)
    s_barrier
    s_barrier
    s_barrier
    s_branch M_Qjoin
M_fin:
M_end:
    s_endpgm

.section .rodata,"a"
.p2align 6
.amdhsa_kernel adaLN_cond__sliding_local_dilated__glu_gated_swiglu__prompt_kernel
  .amdhsa_next_free_vgpr 252
  .amdhsa_next_free_sgpr 102
  .amdhsa_accum_offset 252
  .amdhsa_group_segment_fixed_size 0
  .amdhsa_kernarg_size 96
  .amdhsa_user_sgpr_count 2
  .amdhsa_user_sgpr_kernarg_segment_ptr 1
  .amdhsa_system_sgpr_workgroup_id_x 1
  .amdhsa_float_denorm_mode_32 3
.end_amdhsa_kernel
```

```asm
; @launch grid=(256,1,1) block=(512,1,1) lds=163840
.amdgcn_target "amdgcn-amd-amdhsa--gfx950"
.text
.globl adaLN_cond__sliding_local_dilated__glu_gated_swiglu__prompt_kernel
.p2align 8
.type adaLN_cond__sliding_local_dilated__glu_gated_swiglu__prompt_kernel,@function
adaLN_cond__sliding_local_dilated__glu_gated_swiglu__prompt_kernel:
    s_cmp_ge_u32 s2, 256
    s_cbranch_scc1 M_end
    s_load_dwordx16 s[4:19], s[0:1], 0
    s_load_dwordx8 s[20:27], s[0:1], 64
    v_lshrrev_b32 v2, 6, v0
    v_and_b32 v1, 63, v0
    v_readfirstlane_b32 s44, v2
    s_and_b32 s47, s2, 1
    s_lshl_b32 s47, s47, 3
    s_bfe_u32 s64, s2, 0x30003
    s_add_u32 s47, s47, s64
    s_and_b32 s48, s2, 6
    s_lshl_b32 s48, s48, 1
    s_lshr_b32 s64, s2, 6
    s_add_u32 s48, s48, s64
    s_getpc_b64 s[28:29]
M_pc:
    s_lshr_b32 s64, s2, 3
    s_lshl_b32 s64, s64, 3
    s_add_u32 s64, s64, s44
    s_lshl_b32 s64, s64, 8
    v_lshl_add_u32 v2, v1, 7, s64
    v_min_u32 v2, M_end-M_pc, v2
    s_mov_b64 exec, 3
    global_load_dword v244, v2, s[28:29]
    s_mov_b64 exec, -1
    s_cmp_lt_u32 s44, 4
    s_cbranch_scc1 M_P
    s_setprio 0
    s_sub_u32 s44, s44, 4
    s_lshl_b32 s62, s47, 4
    s_add_u32 s62, s62, s48
    s_lshl_b32 s62, s62, 2
    s_add_u32 s62, s62, s44
    s_lshl_b32 s64, s62, 12
    v_lshl_add_u32 v2, v1, 4, s64
    v_lshlrev_b32 v3, 2, v1
    v_add_u32 v3, 148480, v3
    v_mov_b32 v4, 0
    ds_write_b32 v3, v4
    s_waitcnt lgkmcnt(0)
    s_load_dword s0, s[26:27], 0
    s_mov_b32 s40, s4
    s_mov_b32 s41, s5
    s_mov_b32 s42, 0x400000
    s_mov_b32 s43, 0x20000
    buffer_load_dwordx4 v[104:107], v2, s[40:43], 0 offen offset:0
    buffer_load_dwordx4 v[108:111], v2, s[40:43], 0 offen offset:1024
    buffer_load_dwordx4 v[112:115], v2, s[40:43], 0 offen offset:2048
    buffer_load_dwordx4 v[116:119], v2, s[40:43], 0 offen offset:3072
    s_barrier
    s_branch M_Q
M_P:
    s_lshr_b32 s70, s47, 1
    s_lshl_b32 s70, s70, 7
    s_and_b32 s71, s47, 1
    s_lshl_b32 s71, s71, 4
    s_add_u32 s71, s71, s48
    s_lshl_b32 s71, s71, 7
    v_lshrrev_b32 v48, 3, v0
    v_add_u32 v48, s70, v48
    v_lshlrev_b32 v9, 1, v48
    s_movk_i32 s64, 12288
    v_mul_lo_u32 v48, s64, v48
    v_and_b32 v8, 7, v0
    v_lshl_add_u32 v48, v8, 4, v48
    v_add_u32 v8, s71, v48
    s_waitcnt lgkmcnt(0)
    s_load_dword s0, s[26:27], 0
    s_mov_b32 s40, s18
    s_mov_b32 s41, s19
    s_mov_b32 s42, 0x800
    s_mov_b32 s43, 0x20000
    s_mov_b32 s36, s20
    s_mov_b32 s37, s21
    s_mov_b32 s38, 0xc00000
    s_mov_b32 s39, 0x20000
    s_barrier
    buffer_load_ushort v20, v9, s[40:43], 0 offen offset:0
    buffer_load_ushort v21, v9, s[40:43], 0 offen offset:64
    buffer_load_ushort v22, v9, s[40:43], 0 offen offset:128
    buffer_load_ushort v23, v9, s[40:43], 0 offen offset:192
    s_mov_b32 s64, 0x0
    buffer_load_dwordx4 v[24:27], v8, s[36:39], s64 offen
    s_mov_b32 s64, 0x60000
    buffer_load_dwordx4 v[28:31], v8, s[36:39], s64 offen
    s_mov_b32 s64, 0xc0000
    buffer_load_dwordx4 v[32:35], v8, s[36:39], s64 offen
    s_mov_b32 s64, 0x120000
    buffer_load_dwordx4 v[36:39], v8, s[36:39], s64 offen
    s_mov_b32 s28, s26
    s_mov_b32 s29, s27
    s_mov_b32 s30, 0x3100000
    s_mov_b32 s31, 0x20000
    s_lshl_b32 s64, s48, 13
    s_add_u32 s64, s64, 0x30000
    s_lshl_b32 s65, s47, 9
    s_add_u32 s62, s64, s65
    s_lshl_b32 s65, s44, 9
    s_add_u32 s64, s64, s65
    v_lshl_add_u32 v16, v1, 3, s64
    s_lshl_b32 s64, s44, 7
    s_add_u32 s64, s64, s62
    v_lshl_add_u32 v2, v1, 2, s64
    s_lshl_b32 s64, s47, 4
    s_add_u32 s64, s64, s48
    s_lshl_b32 s64, s64, 7
    s_add_u32 s64, s64, 0x10000
    v_writelane_b32 v2, s64, 4
    s_mov_b64 exec, 31
    buffer_load_dword v244, v2, s[28:31], 0 offen sc1
    s_mov_b64 exec, -1
    s_lshr_b32 s45, s44, 1
    s_and_b32 s46, s44, 1
    s_lshr_b32 s49, s48, 2
    s_and_b32 s51, s48, 3
    s_cmp_ge_u32 s2, 192
    s_cselect_b32 s69, 0x80000000, 0
    s_mov_b32 s67, 0x40053526
    v_lshlrev_b32 v234, 2, v1
    s_setprio 2
    s_waitcnt vmcnt(5)
    v_lshlrev_b32 v20, 16, v20
    v_lshlrev_b32 v21, 16, v21
    v_lshlrev_b32 v22, 16, v22
    v_lshlrev_b32 v23, 16, v23
    v_mul_f32 v48, 0xbfb8aa3b, v20
    v_mul_f32 v49, 0xbfb8aa3b, v21
    v_mul_f32 v50, 0xbfb8aa3b, v22
    v_mul_f32 v51, 0xbfb8aa3b, v23
    v_exp_f32 v48, v48
    v_exp_f32 v49, v49
    v_exp_f32 v50, v50
    v_exp_f32 v51, v51
    v_add_f32 v48, 1.0, v48
    v_add_f32 v49, 1.0, v49
    v_add_f32 v50, 1.0, v50
    v_add_f32 v51, 1.0, v51
    v_rcp_f32 v48, v48
    v_rcp_f32 v49, v49
    v_rcp_f32 v50, v50
    v_rcp_f32 v51, v51
    v_mul_f32 v20, v20, v48
    v_mul_f32 v21, v21, v49
    v_mul_f32 v22, v22, v50
    v_mul_f32 v23, v23, v51
    v_cvt_pk_bf16_f32 v48, v20, v20
    v_lshlrev_b32 v20, 16, v48
    v_cvt_pk_bf16_f32 v49, v21, v21
    v_lshlrev_b32 v21, 16, v49
    v_cvt_pk_bf16_f32 v50, v22, v22
    v_lshlrev_b32 v22, 16, v50
    v_cvt_pk_bf16_f32 v51, v23, v23
    v_lshlrev_b32 v23, 16, v51
    s_waitcnt vmcnt(4)
    v_lshlrev_b32 v48, 16, v24
    v_and_b32 v49, 0xffff0000, v24
    v_lshlrev_b32 v50, 16, v25
    v_and_b32 v51, 0xffff0000, v25
    v_lshlrev_b32 v52, 16, v26
    v_and_b32 v53, 0xffff0000, v26
    v_lshlrev_b32 v54, 16, v27
    v_and_b32 v55, 0xffff0000, v27
    v_mul_f32 v40, v20, v48
    v_mul_f32 v41, v20, v49
    v_mul_f32 v42, v20, v50
    v_mul_f32 v43, v20, v51
    v_mul_f32 v44, v20, v52
    v_mul_f32 v45, v20, v53
    v_mul_f32 v46, v20, v54
    v_mul_f32 v47, v20, v55
    s_waitcnt vmcnt(3)
    v_lshlrev_b32 v48, 16, v28
    v_and_b32 v49, 0xffff0000, v28
    v_lshlrev_b32 v50, 16, v29
    v_and_b32 v51, 0xffff0000, v29
    v_lshlrev_b32 v52, 16, v30
    v_and_b32 v53, 0xffff0000, v30
    v_lshlrev_b32 v54, 16, v31
    v_and_b32 v55, 0xffff0000, v31
    v_fmac_f32 v40, v21, v48
    v_fmac_f32 v41, v21, v49
    v_fmac_f32 v42, v21, v50
    v_fmac_f32 v43, v21, v51
    v_fmac_f32 v44, v21, v52
    v_fmac_f32 v45, v21, v53
    v_fmac_f32 v46, v21, v54
    v_fmac_f32 v47, v21, v55
    s_waitcnt vmcnt(2)
    v_lshlrev_b32 v48, 16, v32
    v_and_b32 v49, 0xffff0000, v32
    v_lshlrev_b32 v50, 16, v33
    v_and_b32 v51, 0xffff0000, v33
    v_lshlrev_b32 v52, 16, v34
    v_and_b32 v53, 0xffff0000, v34
    v_lshlrev_b32 v54, 16, v35
    v_and_b32 v55, 0xffff0000, v35
    v_fmac_f32 v40, v22, v48
    v_fmac_f32 v41, v22, v49
    v_fmac_f32 v42, v22, v50
    v_fmac_f32 v43, v22, v51
    v_fmac_f32 v44, v22, v52
    v_fmac_f32 v45, v22, v53
    v_fmac_f32 v46, v22, v54
    v_fmac_f32 v47, v22, v55
    s_waitcnt vmcnt(1)
    v_lshlrev_b32 v48, 16, v36
    v_and_b32 v49, 0xffff0000, v36
    v_lshlrev_b32 v50, 16, v37
    v_and_b32 v51, 0xffff0000, v37
    v_lshlrev_b32 v52, 16, v38
    v_and_b32 v53, 0xffff0000, v38
    v_lshlrev_b32 v54, 16, v39
    v_and_b32 v55, 0xffff0000, v39
    v_fmac_f32 v40, v23, v48
    v_fmac_f32 v41, v23, v49
    v_fmac_f32 v42, v23, v50
    v_fmac_f32 v43, v23, v51
    v_fmac_f32 v44, v23, v52
    v_fmac_f32 v45, v23, v53
    v_fmac_f32 v46, v23, v54
    v_fmac_f32 v47, v23, v55
    v_add_f32_dpp v40, v40, v40 row_ror:8 row_mask:0xf bank_mask:0xf
    v_add_f32_dpp v41, v41, v41 row_ror:8 row_mask:0xf bank_mask:0xf
    v_add_f32_dpp v42, v42, v42 row_ror:8 row_mask:0xf bank_mask:0xf
    v_add_f32_dpp v43, v43, v43 row_ror:8 row_mask:0xf bank_mask:0xf
    v_add_f32_dpp v44, v44, v44 row_ror:8 row_mask:0xf bank_mask:0xf
    v_add_f32_dpp v45, v45, v45 row_ror:8 row_mask:0xf bank_mask:0xf
    v_add_f32_dpp v46, v46, v46 row_ror:8 row_mask:0xf bank_mask:0xf
    v_add_f32_dpp v47, v47, v47 row_ror:8 row_mask:0xf bank_mask:0xf
    v_mov_b32 v48, v40
    v_mov_b32 v49, v41
    v_mov_b32 v50, v42
    v_mov_b32 v51, v43
    v_mov_b32 v52, v44
    v_mov_b32 v53, v45
    v_mov_b32 v54, v46
    v_mov_b32 v55, v47
    v_permlane32_swap_b32 v40, v48
    v_permlane32_swap_b32 v41, v49
    v_permlane32_swap_b32 v42, v50
    v_permlane32_swap_b32 v43, v51
    v_permlane32_swap_b32 v44, v52
    v_permlane32_swap_b32 v45, v53
    v_permlane32_swap_b32 v46, v54
    v_permlane32_swap_b32 v47, v55
    v_add_f32 v40, v40, v48
    v_add_f32 v41, v41, v49
    v_add_f32 v42, v42, v50
    v_add_f32 v43, v43, v51
    v_add_f32 v44, v44, v52
    v_add_f32 v45, v45, v53
    v_add_f32 v46, v46, v54
    v_add_f32 v47, v47, v55
    v_mov_b32 v48, v40
    v_mov_b32 v49, v41
    v_mov_b32 v50, v42
    v_mov_b32 v51, v43
    v_mov_b32 v52, v44
    v_mov_b32 v53, v45
    v_mov_b32 v54, v46
    v_mov_b32 v55, v47
    v_permlane16_swap_b32 v40, v48
    v_permlane16_swap_b32 v41, v49
    v_permlane16_swap_b32 v42, v50
    v_permlane16_swap_b32 v43, v51
    v_permlane16_swap_b32 v44, v52
    v_permlane16_swap_b32 v45, v53
    v_permlane16_swap_b32 v46, v54
    v_permlane16_swap_b32 v47, v55
    v_add_f32 v40, v40, v48
    v_add_f32 v41, v41, v49
    v_add_f32 v42, v42, v50
    v_add_f32 v43, v43, v51
    v_add_f32 v44, v44, v52
    v_add_f32 v45, v45, v53
    v_add_f32 v46, v46, v54
    v_add_f32 v47, v47, v55
    s_lshl_b32 s64, s44, 8
    s_add_u32 s64, s64, 147456
    v_and_b32 v48, 7, v0
    v_lshl_add_u32 v48, v48, 5, s64
    ds_write_b128 v48, v[40:43]
    ds_write_b128 v48, v[44:47] offset:16
    v_mov_b32 v49, 148492
    v_mov_b32 v50, 1
    s_waitcnt lgkmcnt(0)
    s_add_u32 s0, s0, 1
    s_mov_b64 exec, 1
    ds_add_rtn_u32 v51, v49, v50
    s_mov_b64 exec, -1
    v_add_u32 v49, 147456, v234
    s_waitcnt lgkmcnt(0)
    ds_read_b32 v40, v49 offset:0
    ds_read_b32 v41, v49 offset:256
    ds_read_b32 v42, v49 offset:512
    ds_read_b32 v43, v49 offset:768
    v_readfirstlane_b32 s64, v51
    s_nop 3
    s_cmp_eq_u32 s64, 3
    s_cselect_b32 s62, s62, 0x80000000
    v_lshl_add_u32 v48, v1, 3, s62
    s_waitcnt lgkmcnt(0)
    v_add_f32 v40, v40, v41
    v_add_f32 v42, v42, v43
    v_add_f32 v40, v40, v42
    v_mov_b32 v41, s0
    buffer_store_dwordx2 v[40:41], v48, s[28:31], 0 offen sc1
    s_mov_b32 s52, 0
    s_lshl_b32 s64, s45, 13
    v_lshl_add_u32 v233, v1, 4, s64
    v_lshrrev_b32 v3, 4, v1
    v_bfe_u32 v2, v1, 2, 2
    v_lshl_add_u32 v4, v3, 3, v2
    v_mul_u32_u24 v4, 384, v4
    v_and_b32 v5, 3, v1
    v_lshl_add_u32 v4, v5, 3, v4
    v_add_u32 v4, 18432, v4
    v_bfe_u32 v2, v1, 3, 2
    s_lshl_b32 s64, s46, 1
    s_or_b32 s64, s64, s45
    v_xor_b32 v2, s64, v2
    v_lshlrev_b32 v242, 4, v1
    v_lshl_add_u32 v239, v2, 5, v4
    v_xor_b32 v2, 1, v2
    v_lshl_add_u32 v240, v2, 5, v4
    v_and_b32 v2, 15, v1
    v_and_b32 v4, 1, v1
    v_cmp_eq_u32 s[72:73], 1, v4
    v_lshl_add_u32 v3, v3, 2, v4
    v_cmp_le_u32 s[74:75], v3, v2
    v_add_u32 v3, 2, v3
    v_cmp_le_u32 s[76:77], v3, v2
    v_mov_b32 v5, 0x0c0c0c0c
    v_mov_b32 v2, 0x0c0c0100
    v_mov_b32 v3, 0x01000c0c
    v_cndmask_b32 v2, v2, v3, s[72:73]
    v_cndmask_b32 v216, v2, v5, s[74:75]
    v_cndmask_b32 v218, v5, v2, s[74:75]
    v_mov_b32 v2, 0x0c0c0302
    v_mov_b32 v3, 0x03020c0c
    v_cndmask_b32 v2, v2, v3, s[72:73]
    v_cndmask_b32 v217, v2, v5, s[76:77]
    v_cndmask_b32 v219, v5, v2, s[76:77]
    s_mul_i32 s64, s44, 3072
    s_add_u32 s64, s64, 151552
    v_lshl_add_u32 v220, v1, 3, s64
    s_cmp_eq_u32 s45, 0
    s_cselect_b32 s64, 0, -5120
    v_add_u32 v221, s64, v220
    s_movk_i32 s64, 6144
    s_cselect_b32 s64, s64, -5632
    v_add_u32 v222, s64, v220
    s_lshl_b32 s64, s47, 1
    s_add_u32 s64, s64, s45
    s_cmp_eq_u32 s64, 0
    s_cselect_b64 s[78:79], s[74:75], -1
    s_cselect_b64 s[80:81], s[76:77], -1
    s_mul_i32 s64, s64, 131072
    s_lshl_b32 s65, s48, 11
    s_add_u32 s64, s64, s65
    s_lshl_b32 s65, s46, 10
    s_add_u32 s64, s64, s65
    s_add_u32 s64, s64, 0x600000
    v_lshl_add_u32 v237, v1, 4, s64
    s_lshl_b32 s64, s2, 8
    v_add_lshl_u32 v243, v0, s64, 5
    s_lshl_b32 s64, s47, 3
    s_lshl_b32 s65, s44, 1
    s_add_u32 s64, s64, s65
    s_mul_i32 s64, s64, 32768
    s_add_u32 s64, s64, 0x600000
    v_lshl_add_u32 v208, v1, 4, s64
    v_add_u32 v209, 30720, v208
    v_lshrrev_b32 v3, 3, v1
    s_lshl_b32 s64, s44, 4
    v_add_lshl_u32 v2, v3, s64, 11
    s_lshl_b32 s64, s48, 7
    v_add_u32 v2, s64, v2
    v_and_b32 v3, 6, v3
    v_and_b32 v4, 7, v1
    v_xor_b32 v3, v3, v4
    v_lshl_add_u32 v210, v3, 4, v2
    v_add_u32 v211, 15360, v210
    s_lshl_b32 s65, s48, 8
    v_lshrrev_b32 v3, 4, v1
    s_lshl_b32 s64, s44, 4
    v_add_u32 v2, s64, v3
    s_movk_i32 s64, 7168
    v_mul_u32_u24 v2, s64, v2
    v_add_u32 v2, s65, v2
    v_lshlrev_b32 v3, 1, v3
    v_and_b32 v4, 15, v1
    v_xor_b32 v3, v3, v4
    v_lshl_add_u32 v212, v3, 4, v2
    v_add_u32 v214, 55296, v212
    v_xor_b32 v3, 8, v3
    v_lshl_add_u32 v213, v3, 4, v2
    v_add_u32 v213, 27648, v213
    v_add_u32 v215, 55296, v213
    v_add_u32 v232, s52, v233
    v_add_u32 v235, s52, v239
    v_add_u32 v236, s52, v240
    v_add_u32 v238, s52, v242
    s_lshl_b32 s60, s44, 12
    s_add_u32 s61, s60, 147456
    s_add_u32 s53, s60, 49152
    s_lshl_b32 s70, s44, 11
    s_sub_u32 s70, 16384, s70
    s_bfe_u32 s66, s2, 0x30003
    s_lshr_b32 s55, s2, 6
    s_add_u32 s66, s66, s55
    s_and_b32 s66, s66, 3
    s_mov_b32 s58, 0x76453210
    s_mov_b32 s59, 0xfecdba89
    s_cmp_eq_u32 s66, 1
    s_cselect_b32 s58, 0x75643120, s58
    s_cselect_b32 s59, 0xfdecb9a8, s59
    s_cmp_eq_u32 s66, 2
    s_cselect_b32 s58, 0x67542310, s58
    s_cselect_b32 s59, 0xefdcab98, s59
    s_cmp_eq_u32 s66, 3
    s_cselect_b32 s58, 0x86534210, s58
    s_cselect_b32 s59, 0xfedbca97, s59
    s_mov_b32 s32, s8
    s_mov_b32 s33, s9
    s_mov_b32 s34, 0x200000
    s_mov_b32 s35, 0x20000
    s_cmp_ge_u32 s44, 2
    s_cbranch_scc1 M_spf
    s_movk_i32 s63, 4096
    buffer_load_dwordx2 v[88:89], v16, s[28:31], 0 offen offset:0 sc1
    buffer_load_dwordx2 v[90:91], v16, s[28:31], 0 offen offset:1024 sc1
    buffer_load_dwordx2 v[92:93], v16, s[28:31], 0 offen offset:2048 sc1
    buffer_load_dwordx2 v[94:95], v16, s[28:31], 0 offen offset:3072 sc1
    buffer_load_dwordx2 v[96:97], v16, s[28:31], s63 offen offset:0 sc1
    buffer_load_dwordx2 v[98:99], v16, s[28:31], s63 offen offset:1024 sc1
    buffer_load_dwordx2 v[100:101], v16, s[28:31], s63 offen offset:2048 sc1
    buffer_load_dwordx2 v[102:103], v16, s[28:31], s63 offen offset:3072 sc1
    s_waitcnt vmcnt(0)
    s_mov_b32 s3, 0x40000
M_pt_chk:
    v_xor_b32 v48, s0, v89
    v_xor_b32 v49, s0, v91
    v_xor_b32 v50, s0, v93
    v_xor_b32 v51, s0, v95
    v_xor_b32 v52, s0, v97
    v_xor_b32 v53, s0, v99
    v_xor_b32 v54, s0, v101
    v_xor_b32 v55, s0, v103
    v_or3_b32 v48, v48, v49, v50
    v_or3_b32 v48, v48, v51, v52
    v_or3_b32 v48, v48, v53, v54
    v_or_b32 v48, v48, v55
    v_cmp_ne_u32 vcc, 0, v48
    s_nop 4
    s_cbranch_vccz M_pt_ok
    s_sub_u32 s3, s3, 1
    s_cbranch_scc1 M_pt_ok
    v_cmp_ne_u32 vcc, s0, v89
    s_nop 4
    s_mov_b64 exec, vcc
    buffer_load_dwordx2 v[88:89], v16, s[28:31], 0 offen offset:0 sc1
    s_mov_b64 exec, -1
    v_cmp_ne_u32 vcc, s0, v91
    s_nop 4
    s_mov_b64 exec, vcc
    buffer_load_dwordx2 v[90:91], v16, s[28:31], 0 offen offset:1024 sc1
    s_mov_b64 exec, -1
    v_cmp_ne_u32 vcc, s0, v93
    s_nop 4
    s_mov_b64 exec, vcc
    buffer_load_dwordx2 v[92:93], v16, s[28:31], 0 offen offset:2048 sc1
    s_mov_b64 exec, -1
    v_cmp_ne_u32 vcc, s0, v95
    s_nop 4
    s_mov_b64 exec, vcc
    buffer_load_dwordx2 v[94:95], v16, s[28:31], 0 offen offset:3072 sc1
    s_mov_b64 exec, -1
    v_cmp_ne_u32 vcc, s0, v97
    s_nop 4
    s_mov_b64 exec, vcc
    buffer_load_dwordx2 v[96:97], v16, s[28:31], s63 offen offset:0 sc1
    s_mov_b64 exec, -1
    v_cmp_ne_u32 vcc, s0, v99
    s_nop 4
    s_mov_b64 exec, vcc
    buffer_load_dwordx2 v[98:99], v16, s[28:31], s63 offen offset:1024 sc1
    s_mov_b64 exec, -1
    v_cmp_ne_u32 vcc, s0, v101
    s_nop 4
    s_mov_b64 exec, vcc
    buffer_load_dwordx2 v[100:101], v16, s[28:31], s63 offen offset:2048 sc1
    s_mov_b64 exec, -1
    v_cmp_ne_u32 vcc, s0, v103
    s_nop 4
    s_mov_b64 exec, vcc
    buffer_load_dwordx2 v[102:103], v16, s[28:31], s63 offen offset:3072 sc1
    s_mov_b64 exec, -1
    s_waitcnt vmcnt(0)
    s_branch M_pt_chk
M_pt_ok:
    v_add_f32 v88, v88, v90
    v_add_f32 v92, v92, v94
    v_add_f32 v96, v96, v98
    v_add_f32 v100, v100, v102
    v_add_f32 v88, v88, v92
    v_add_f32 v96, v96, v100
    v_add_f32 v88, v88, v96
    v_cvt_pk_bf16_f32 v89, v88, v88
    v_lshlrev_b32 v88, 16, v89
    s_cmp_eq_u32 s46, 1
    s_cselect_b32 s64, 1.0, 0
    v_add_f32 v88, s64, v88
    v_cvt_pk_bf16_f32 v89, v88, v88
    v_lshlrev_b32 v88, 16, v89
    s_lshl_b32 s64, s44, 8
    s_add_u32 s64, s64, 149504
    v_add_u32 v2, s64, v234
    ds_write_b32 v2, v88
    s_waitcnt lgkmcnt(0)
    s_branch M_tbl
M_spf:
    s_lshl_b32 s64, s47, 2
    s_add_u32 s64, s64, s49
    s_lshl_b32 s64, s64, 7
    s_load_dword s99, s[26:27], s64 offset:0x58000
    s_load_dword s99, s[26:27], s64 offset:0x54000
    s_load_dword s99, s[26:27], s64 offset:0x56000
    s_load_dword s99, s[26:27], s64 offset:0x50000
    s_load_dword s99, s[26:27], s64 offset:0x52000
    s_lshl_b32 s64, s2, 1
    s_add_u32 s64, s64, s46
    s_mul_i32 s65, s64, 12288
    s_add_u32 s56, s6, s65
    s_addc_u32 s57, s7, 0
    s_load_dword s99, s[56:57], 384
    s_load_dword s99, s[56:57], 448
    s_load_dword s99, s[56:57], 1408
    s_load_dword s99, s[56:57], 1472
    s_load_dword s99, s[56:57], 2432
    s_load_dword s99, s[56:57], 2496
    s_load_dword s99, s[56:57], 3456
    s_load_dword s99, s[56:57], 3520
    s_load_dword s99, s[56:57], 4480
    s_load_dword s99, s[56:57], 4544
    s_load_dword s99, s[56:57], 5504
    s_load_dword s99, s[56:57], 5568
    s_load_dword s99, s[56:57], 6528
    s_load_dword s99, s[56:57], 6592
    s_load_dword s99, s[56:57], 7552
    s_load_dword s99, s[56:57], 7616
    s_load_dword s99, s[56:57], 8576
    s_load_dword s99, s[56:57], 8640
    s_load_dword s99, s[56:57], 9600
    s_load_dword s99, s[56:57], 9664
    s_load_dword s99, s[56:57], 10624
    s_load_dword s99, s[56:57], 10688
    s_load_dword s99, s[56:57], 11648
    s_load_dword s99, s[56:57], 11712
M_tbl:
    s_barrier
    s_or_b32 s64, s2, s44
    s_cmp_eq_u32 s64, 0
    s_cselect_b32 s64, 0, 0x80000000
    v_mov_b32 v2, s64
    v_mov_b32 v3, s0
    s_barrier
    ds_read_b128 v[136:139], v232 offset:8192
    ds_read_b64_tr_b16 v[148:149], v235 offset:128
    ds_read_b64_tr_b16 v[150:151], v235 offset:1664
    ds_read_b64_tr_b16 v[152:153], v236 offset:128
    ds_read_b64_tr_b16 v[154:155], v236 offset:1664
    ds_read_b64_tr_b16 v[156:157], v235 offset:256
    ds_read_b64_tr_b16 v[158:159], v235 offset:1792
    ds_read_b64_tr_b16 v[160:161], v236 offset:256
    ds_read_b64_tr_b16 v[162:163], v236 offset:1792
    ds_read_b64_tr_b16 v[140:141], v235 offset:0
    ds_read_b64_tr_b16 v[142:143], v235 offset:1536
    ds_read_b64_tr_b16 v[144:145], v236 offset:0
    ds_read_b64_tr_b16 v[146:147], v236 offset:1536
    ds_read_b128 v[120:123], v238 offset:0
    ds_read_b128 v[124:127], v232 offset:2048
    ds_read_b128 v[128:131], v232 offset:4096
    ds_read_b128 v[132:135], v232 offset:6144
    s_add_u32 s52, s52, 49152
    s_cmp_ge_u32 s52, 147456
    s_cselect_b32 s52, 0, s52
    s_waitcnt lgkmcnt(0)
    v_mfma_f32_16x16x32_bf16 v[72:75], v[148:151], v[136:139], 0
    ds_read_b128 v[180:183], v232 offset:9216
    v_mfma_f32_16x16x32_bf16 v[76:79], v[152:155], v[136:139], 0
    ds_read_b64_tr_b16 v[192:193], v235 offset:12416
    v_mfma_f32_16x16x32_bf16 v[112:115], v[136:139], v[156:159], 0
    ds_read_b64_tr_b16 v[194:195], v235 offset:13952
    v_mfma_f32_16x16x32_bf16 v[116:119], v[136:139], v[160:163], 0
    ds_read_b64_tr_b16 v[196:197], v236 offset:12416
    v_mfma_f32_16x16x32_bf16 v[32:35], v[140:143], v[136:139], 0
    ds_read_b64_tr_b16 v[198:199], v236 offset:13952
    v_mfma_f32_16x16x32_bf16 v[36:39], v[144:147], v[136:139], 0
    ds_read_b64_tr_b16 v[200:201], v235 offset:12544
    v_mfma_f32_16x16x32_bf16 v[40:43], v[148:151], v[120:123], 0
    v_mfma_f32_16x16x32_bf16 v[80:83], v[120:123], v[156:159], 0
    ds_read_b64_tr_b16 v[202:203], v235 offset:14080
    v_mfma_f32_16x16x32_bf16 v[48:51], v[148:151], v[124:127], 0
    ds_read_b64_tr_b16 v[204:205], v236 offset:12544
    v_mfma_f32_16x16x32_bf16 v[52:55], v[152:155], v[124:127], 0
    ds_read_b64_tr_b16 v[206:207], v236 offset:14080
    v_mfma_f32_16x16x32_bf16 v[88:91], v[124:127], v[156:159], 0
    ds_read_b64_tr_b16 v[184:185], v235 offset:12288
    v_mfma_f32_16x16x32_bf16 v[92:95], v[124:127], v[160:163], 0
    ds_read_b64_tr_b16 v[186:187], v235 offset:13824
    v_mfma_f32_16x16x32_bf16 v[8:11], v[140:143], v[124:127], 0
    ds_read_b64_tr_b16 v[188:189], v236 offset:12288
    v_mfma_f32_16x16x32_bf16 v[12:15], v[144:147], v[124:127], 0
    v_mfma_f32_16x16x32_bf16 v[56:59], v[148:151], v[128:131], 0
    ds_read_b64_tr_b16 v[190:191], v236 offset:13824
    v_mfma_f32_16x16x32_bf16 v[60:63], v[152:155], v[128:131], 0
    ds_read_b128 v[164:167], v238 offset:1024
    v_mfma_f32_16x16x32_bf16 v[96:99], v[128:131], v[156:159], 0
    ds_read_b128 v[168:171], v232 offset:3072
    v_mfma_f32_16x16x32_bf16 v[100:103], v[128:131], v[160:163], 0
    ds_read_b128 v[172:175], v232 offset:5120
    v_mfma_f32_16x16x32_bf16 v[16:19], v[140:143], v[128:131], 0
    ds_read_b128 v[176:179], v232 offset:7168
    v_mfma_f32_16x16x32_bf16 v[20:23], v[144:147], v[128:131], 0
    v_mfma_f32_16x16x32_bf16 v[64:67], v[148:151], v[132:135], 0
    v_add_u32 v232, s52, v233
    v_mfma_f32_16x16x32_bf16 v[68:71], v[152:155], v[132:135], 0
    v_add_u32 v235, s52, v239
    v_mfma_f32_16x16x32_bf16 v[104:107], v[132:135], v[156:159], 0
    v_mfma_f32_16x16x32_bf16 v[108:111], v[132:135], v[160:163], 0
    v_add_u32 v236, s52, v240
    v_mfma_f32_16x16x32_bf16 v[24:27], v[140:143], v[132:135], 0
    v_add_u32 v238, s52, v242
    v_mfma_f32_16x16x32_bf16 v[28:31], v[144:147], v[132:135], 0
    s_waitcnt lgkmcnt(0)
    v_mfma_f32_16x16x32_bf16 v[72:75], v[192:195], v[180:183], v[72:75]
    v_mfma_f32_16x16x32_bf16 v[76:79], v[196:199], v[180:183], v[76:79]
    v_mfma_f32_16x16x32_bf16 v[112:115], v[180:183], v[200:203], v[112:115]
    v_mfma_f32_16x16x32_bf16 v[116:119], v[180:183], v[204:207], v[116:119]
    v_mfma_f32_16x16x32_bf16 v[32:35], v[184:187], v[180:183], v[32:35]
    v_mfma_f32_16x16x32_bf16 v[36:39], v[188:191], v[180:183], v[36:39]
    v_mfma_f32_16x16x32_bf16 v[40:43], v[192:195], v[164:167], v[40:43]
    v_mfma_f32_16x16x32_bf16 v[80:83], v[164:167], v[200:203], v[80:83]
    v_mfma_f32_16x16x32_bf16 v[48:51], v[192:195], v[168:171], v[48:51]
    v_mfma_f32_16x16x32_bf16 v[52:55], v[196:199], v[168:171], v[52:55]
    v_mfma_f32_16x16x32_bf16 v[88:91], v[168:171], v[200:203], v[88:91]
    v_mfma_f32_16x16x32_bf16 v[92:95], v[168:171], v[204:207], v[92:95]
    v_mfma_f32_16x16x32_bf16 v[8:11], v[184:187], v[168:171], v[8:11]
    v_mfma_f32_16x16x32_bf16 v[12:15], v[188:191], v[168:171], v[12:15]
    v_mfma_f32_16x16x32_bf16 v[56:59], v[192:195], v[172:175], v[56:59]
    v_mfma_f32_16x16x32_bf16 v[60:63], v[196:199], v[172:175], v[60:63]
    v_mfma_f32_16x16x32_bf16 v[96:99], v[172:175], v[200:203], v[96:99]
    v_mfma_f32_16x16x32_bf16 v[100:103], v[172:175], v[204:207], v[100:103]
    v_mfma_f32_16x16x32_bf16 v[16:19], v[184:187], v[172:175], v[16:19]
    v_mfma_f32_16x16x32_bf16 v[20:23], v[188:191], v[172:175], v[20:23]
    v_mfma_f32_16x16x32_bf16 v[64:67], v[192:195], v[176:179], v[64:67]
    v_mfma_f32_16x16x32_bf16 v[68:71], v[196:199], v[176:179], v[68:71]
    v_mfma_f32_16x16x32_bf16 v[104:107], v[176:179], v[200:203], v[104:107]
    v_mfma_f32_16x16x32_bf16 v[108:111], v[176:179], v[204:207], v[108:111]
    v_mfma_f32_16x16x32_bf16 v[24:27], v[184:187], v[176:179], v[24:27]
    v_mfma_f32_16x16x32_bf16 v[28:31], v[188:191], v[176:179], v[28:31]
    s_barrier
    s_mov_b64 exec, 1
    buffer_store_dword v3, v2, s[28:31], 0 offen sc1
    s_mov_b64 exec, -1
    s_barrier
    ds_read_b128 v[136:139], v232 offset:8192
    ds_read_b64_tr_b16 v[148:149], v235 offset:128
    ds_read_b64_tr_b16 v[150:151], v235 offset:1664
    ds_read_b64_tr_b16 v[152:153], v236 offset:128
    ds_read_b64_tr_b16 v[154:155], v236 offset:1664
    ds_read_b64_tr_b16 v[156:157], v235 offset:256
    ds_read_b64_tr_b16 v[158:159], v235 offset:1792
    ds_read_b64_tr_b16 v[160:161], v236 offset:256
    ds_read_b64_tr_b16 v[162:163], v236 offset:1792
    ds_read_b64_tr_b16 v[140:141], v235 offset:0
    ds_read_b64_tr_b16 v[142:143], v235 offset:1536
    ds_read_b64_tr_b16 v[144:145], v236 offset:0
    ds_read_b64_tr_b16 v[146:147], v236 offset:1536
    ds_read_b128 v[120:123], v238 offset:0
    ds_read_b128 v[124:127], v232 offset:2048
    ds_read_b128 v[128:131], v232 offset:4096
    ds_read_b128 v[132:135], v232 offset:6144
    s_add_u32 s52, s52, 49152
    s_cmp_ge_u32 s52, 147456
    s_cselect_b32 s52, 0, s52
    s_waitcnt lgkmcnt(0)
    v_mfma_f32_16x16x32_bf16 v[72:75], v[148:151], v[136:139], v[72:75]
    ds_read_b128 v[180:183], v232 offset:9216
    v_mfma_f32_16x16x32_bf16 v[76:79], v[152:155], v[136:139], v[76:79]
    ds_read_b64_tr_b16 v[192:193], v235 offset:12416
    v_mfma_f32_16x16x32_bf16 v[112:115], v[136:139], v[156:159], v[112:115]
    ds_read_b64_tr_b16 v[194:195], v235 offset:13952
    v_mfma_f32_16x16x32_bf16 v[116:119], v[136:139], v[160:163], v[116:119]
    ds_read_b64_tr_b16 v[196:197], v236 offset:12416
    v_mfma_f32_16x16x32_bf16 v[32:35], v[140:143], v[136:139], v[32:35]
    ds_read_b64_tr_b16 v[198:199], v236 offset:13952
    v_mfma_f32_16x16x32_bf16 v[36:39], v[144:147], v[136:139], v[36:39]
    ds_read_b64_tr_b16 v[200:201], v235 offset:12544
    v_mfma_f32_16x16x32_bf16 v[40:43], v[148:151], v[120:123], v[40:43]
    v_mfma_f32_16x16x32_bf16 v[80:83], v[120:123], v[156:159], v[80:83]
    ds_read_b64_tr_b16 v[202:203], v235 offset:14080
    v_mfma_f32_16x16x32_bf16 v[48:51], v[148:151], v[124:127], v[48:51]
    ds_read_b64_tr_b16 v[204:205], v236 offset:12544
    v_mfma_f32_16x16x32_bf16 v[52:55], v[152:155], v[124:127], v[52:55]
    ds_read_b64_tr_b16 v[206:207], v236 offset:14080
    v_mfma_f32_16x16x32_bf16 v[88:91], v[124:127], v[156:159], v[88:91]
    ds_read_b64_tr_b16 v[184:185], v235 offset:12288
    v_mfma_f32_16x16x32_bf16 v[92:95], v[124:127], v[160:163], v[92:95]
    ds_read_b64_tr_b16 v[186:187], v235 offset:13824
    v_mfma_f32_16x16x32_bf16 v[8:11], v[140:143], v[124:127], v[8:11]
    ds_read_b64_tr_b16 v[188:189], v236 offset:12288
    v_mfma_f32_16x16x32_bf16 v[12:15], v[144:147], v[124:127], v[12:15]
    s_movk_i32 s54, 13
M_P_loop0:
    v_mfma_f32_16x16x32_bf16 v[56:59], v[148:151], v[128:131], v[56:59]
    ds_read_b64_tr_b16 v[190:191], v236 offset:13824
    v_mfma_f32_16x16x32_bf16 v[60:63], v[152:155], v[128:131], v[60:63]
    ds_read_b128 v[164:167], v238 offset:1024
    v_mfma_f32_16x16x32_bf16 v[96:99], v[128:131], v[156:159], v[96:99]
    ds_read_b128 v[168:171], v232 offset:3072
    v_mfma_f32_16x16x32_bf16 v[100:103], v[128:131], v[160:163], v[100:103]
    ds_read_b128 v[172:175], v232 offset:5120
    v_mfma_f32_16x16x32_bf16 v[16:19], v[140:143], v[128:131], v[16:19]
    ds_read_b128 v[176:179], v232 offset:7168
    v_mfma_f32_16x16x32_bf16 v[20:23], v[144:147], v[128:131], v[20:23]
    v_mfma_f32_16x16x32_bf16 v[64:67], v[148:151], v[132:135], v[64:67]
    v_add_u32 v232, s52, v233
    v_mfma_f32_16x16x32_bf16 v[68:71], v[152:155], v[132:135], v[68:71]
    v_add_u32 v235, s52, v239
    v_mfma_f32_16x16x32_bf16 v[104:107], v[132:135], v[156:159], v[104:107]
    v_mfma_f32_16x16x32_bf16 v[108:111], v[132:135], v[160:163], v[108:111]
    v_add_u32 v236, s52, v240
    v_mfma_f32_16x16x32_bf16 v[24:27], v[140:143], v[132:135], v[24:27]
    v_add_u32 v238, s52, v242
    v_mfma_f32_16x16x32_bf16 v[28:31], v[144:147], v[132:135], v[28:31]
    s_waitcnt lgkmcnt(0)
    v_mfma_f32_16x16x32_bf16 v[72:75], v[192:195], v[180:183], v[72:75]
    s_barrier
    v_mfma_f32_16x16x32_bf16 v[76:79], v[196:199], v[180:183], v[76:79]
    ds_read_b128 v[136:139], v232 offset:8192
    v_mfma_f32_16x16x32_bf16 v[112:115], v[180:183], v[200:203], v[112:115]
    ds_read_b64_tr_b16 v[148:149], v235 offset:128
    v_mfma_f32_16x16x32_bf16 v[116:119], v[180:183], v[204:207], v[116:119]
    ds_read_b64_tr_b16 v[150:151], v235 offset:1664
    v_mfma_f32_16x16x32_bf16 v[32:35], v[184:187], v[180:183], v[32:35]
    ds_read_b64_tr_b16 v[152:153], v236 offset:128
    v_mfma_f32_16x16x32_bf16 v[36:39], v[188:191], v[180:183], v[36:39]
    ds_read_b64_tr_b16 v[154:155], v236 offset:1664
    v_mfma_f32_16x16x32_bf16 v[40:43], v[192:195], v[164:167], v[40:43]
    ds_read_b64_tr_b16 v[156:157], v235 offset:256
    v_mfma_f32_16x16x32_bf16 v[80:83], v[164:167], v[200:203], v[80:83]
    ds_read_b64_tr_b16 v[158:159], v235 offset:1792
    v_mfma_f32_16x16x32_bf16 v[48:51], v[192:195], v[168:171], v[48:51]
    ds_read_b64_tr_b16 v[160:161], v236 offset:256
    v_mfma_f32_16x16x32_bf16 v[52:55], v[196:199], v[168:171], v[52:55]
    ds_read_b64_tr_b16 v[162:163], v236 offset:1792
    v_mfma_f32_16x16x32_bf16 v[88:91], v[168:171], v[200:203], v[88:91]
    v_mfma_f32_16x16x32_bf16 v[92:95], v[168:171], v[204:207], v[92:95]
    ds_read_b64_tr_b16 v[140:141], v235 offset:0
    v_mfma_f32_16x16x32_bf16 v[8:11], v[184:187], v[168:171], v[8:11]
    ds_read_b64_tr_b16 v[142:143], v235 offset:1536
    v_mfma_f32_16x16x32_bf16 v[12:15], v[188:191], v[168:171], v[12:15]
    ds_read_b64_tr_b16 v[144:145], v236 offset:0
    v_mfma_f32_16x16x32_bf16 v[56:59], v[192:195], v[172:175], v[56:59]
    ds_read_b64_tr_b16 v[146:147], v236 offset:1536
    v_mfma_f32_16x16x32_bf16 v[60:63], v[196:199], v[172:175], v[60:63]
    ds_read_b128 v[120:123], v238 offset:0
    v_mfma_f32_16x16x32_bf16 v[96:99], v[172:175], v[200:203], v[96:99]
    ds_read_b128 v[124:127], v232 offset:2048
    v_mfma_f32_16x16x32_bf16 v[100:103], v[172:175], v[204:207], v[100:103]
    ds_read_b128 v[128:131], v232 offset:4096
    v_mfma_f32_16x16x32_bf16 v[16:19], v[184:187], v[172:175], v[16:19]
    ds_read_b128 v[132:135], v232 offset:6144
    v_mfma_f32_16x16x32_bf16 v[20:23], v[188:191], v[172:175], v[20:23]
    v_mfma_f32_16x16x32_bf16 v[64:67], v[192:195], v[176:179], v[64:67]
    v_mfma_f32_16x16x32_bf16 v[68:71], v[196:199], v[176:179], v[68:71]
    v_mfma_f32_16x16x32_bf16 v[104:107], v[176:179], v[200:203], v[104:107]
    v_mfma_f32_16x16x32_bf16 v[108:111], v[176:179], v[204:207], v[108:111]
    v_mfma_f32_16x16x32_bf16 v[24:27], v[184:187], v[176:179], v[24:27]
    s_add_u32 s52, s52, 49152
    s_cmp_ge_u32 s52, 147456
    s_cselect_b32 s52, 0, s52
    v_mfma_f32_16x16x32_bf16 v[28:31], v[188:191], v[176:179], v[28:31]
    s_waitcnt lgkmcnt(0)
    v_mfma_f32_16x16x32_bf16 v[72:75], v[148:151], v[136:139], v[72:75]
    ds_read_b128 v[180:183], v232 offset:9216
    v_mfma_f32_16x16x32_bf16 v[76:79], v[152:155], v[136:139], v[76:79]
    ds_read_b64_tr_b16 v[192:193], v235 offset:12416
    v_mfma_f32_16x16x32_bf16 v[112:115], v[136:139], v[156:159], v[112:115]
    ds_read_b64_tr_b16 v[194:195], v235 offset:13952
    v_mfma_f32_16x16x32_bf16 v[116:119], v[136:139], v[160:163], v[116:119]
    ds_read_b64_tr_b16 v[196:197], v236 offset:12416
    v_mfma_f32_16x16x32_bf16 v[32:35], v[140:143], v[136:139], v[32:35]
    ds_read_b64_tr_b16 v[198:199], v236 offset:13952
    v_mfma_f32_16x16x32_bf16 v[36:39], v[144:147], v[136:139], v[36:39]
    ds_read_b64_tr_b16 v[200:201], v235 offset:12544
    v_mfma_f32_16x16x32_bf16 v[40:43], v[148:151], v[120:123], v[40:43]
    v_mfma_f32_16x16x32_bf16 v[80:83], v[120:123], v[156:159], v[80:83]
    ds_read_b64_tr_b16 v[202:203], v235 offset:14080
    v_mfma_f32_16x16x32_bf16 v[48:51], v[148:151], v[124:127], v[48:51]
    ds_read_b64_tr_b16 v[204:205], v236 offset:12544
    v_mfma_f32_16x16x32_bf16 v[52:55], v[152:155], v[124:127], v[52:55]
    ds_read_b64_tr_b16 v[206:207], v236 offset:14080
    v_mfma_f32_16x16x32_bf16 v[88:91], v[124:127], v[156:159], v[88:91]
    ds_read_b64_tr_b16 v[184:185], v235 offset:12288
    v_mfma_f32_16x16x32_bf16 v[92:95], v[124:127], v[160:163], v[92:95]
    ds_read_b64_tr_b16 v[186:187], v235 offset:13824
    v_mfma_f32_16x16x32_bf16 v[8:11], v[140:143], v[124:127], v[8:11]
    s_sub_u32 s54, s54, 1
    ds_read_b64_tr_b16 v[188:189], v236 offset:12288
    v_mfma_f32_16x16x32_bf16 v[12:15], v[144:147], v[124:127], v[12:15]
    s_cbranch_scc0 M_P_loop0
    v_mfma_f32_16x16x32_bf16 v[56:59], v[148:151], v[128:131], v[56:59]
    ds_read_b64_tr_b16 v[190:191], v236 offset:13824
    v_mfma_f32_16x16x32_bf16 v[60:63], v[152:155], v[128:131], v[60:63]
    ds_read_b128 v[164:167], v238 offset:1024
    v_mfma_f32_16x16x32_bf16 v[96:99], v[128:131], v[156:159], v[96:99]
    ds_read_b128 v[168:171], v232 offset:3072
    v_mfma_f32_16x16x32_bf16 v[100:103], v[128:131], v[160:163], v[100:103]
    ds_read_b128 v[172:175], v232 offset:5120
    v_mfma_f32_16x16x32_bf16 v[16:19], v[140:143], v[128:131], v[16:19]
    ds_read_b128 v[176:179], v232 offset:7168
    v_mfma_f32_16x16x32_bf16 v[20:23], v[144:147], v[128:131], v[20:23]
    v_mfma_f32_16x16x32_bf16 v[64:67], v[148:151], v[132:135], v[64:67]
    v_mfma_f32_16x16x32_bf16 v[68:71], v[152:155], v[132:135], v[68:71]
    v_mfma_f32_16x16x32_bf16 v[104:107], v[132:135], v[156:159], v[104:107]
    v_mfma_f32_16x16x32_bf16 v[108:111], v[132:135], v[160:163], v[108:111]
    v_mfma_f32_16x16x32_bf16 v[24:27], v[140:143], v[132:135], v[24:27]
    v_mfma_f32_16x16x32_bf16 v[28:31], v[144:147], v[132:135], v[28:31]
    s_waitcnt lgkmcnt(0)
    v_mfma_f32_16x16x32_bf16 v[72:75], v[192:195], v[180:183], v[72:75]
    s_barrier
    v_mfma_f32_16x16x32_bf16 v[76:79], v[196:199], v[180:183], v[76:79]
    v_mfma_f32_16x16x32_bf16 v[112:115], v[180:183], v[200:203], v[112:115]
    v_mfma_f32_16x16x32_bf16 v[116:119], v[180:183], v[204:207], v[116:119]
    v_mfma_f32_16x16x32_bf16 v[32:35], v[184:187], v[180:183], v[32:35]
    v_mfma_f32_16x16x32_bf16 v[36:39], v[188:191], v[180:183], v[36:39]
    v_mfma_f32_16x16x32_bf16 v[40:43], v[192:195], v[164:167], v[40:43]
    v_mfma_f32_16x16x32_bf16 v[80:83], v[164:167], v[200:203], v[80:83]
    v_cvt_pk_bf16_f32 v136, v72, v73
    v_cvt_pk_bf16_f32 v137, v74, v75
    v_mfma_f32_16x16x32_bf16 v[48:51], v[192:195], v[168:171], v[48:51]
    ds_write_b64 v220, v[136:137] offset:512
    v_cvt_pk_bf16_f32 v138, v76, v77
    v_mfma_f32_16x16x32_bf16 v[52:55], v[196:199], v[168:171], v[52:55]
    v_cvt_pk_bf16_f32 v139, v78, v79
    ds_write_b64 v220, v[138:139] offset:1024
    v_mfma_f32_16x16x32_bf16 v[88:91], v[168:171], v[200:203], v[88:91]
    v_cvt_pk_bf16_f32 v226, v112, v113
    v_cvt_pk_bf16_f32 v227, v114, v115
    v_mfma_f32_16x16x32_bf16 v[92:95], v[168:171], v[204:207], v[92:95]
    ds_write_b64 v220, v[226:227] offset:2048
    v_cvt_pk_bf16_f32 v228, v116, v117
    v_mfma_f32_16x16x32_bf16 v[8:11], v[184:187], v[168:171], v[8:11]
    v_cvt_pk_bf16_f32 v229, v118, v119
    ds_write_b64 v220, v[228:229] offset:2560
    v_mfma_f32_16x16x32_bf16 v[12:15], v[188:191], v[168:171], v[12:15]
    v_cvt_pk_bf16_f32 v120, v40, v41
    v_cvt_pk_bf16_f32 v121, v42, v43
    v_mfma_f32_16x16x32_bf16 v[56:59], v[192:195], v[172:175], v[56:59]
    ds_write_b64 v220, v[120:121]
    v_cvt_pk_bf16_f32 v224, v80, v81
    v_mfma_f32_16x16x32_bf16 v[60:63], v[196:199], v[172:175], v[60:63]
    v_cvt_pk_bf16_f32 v225, v82, v83
    ds_write_b64 v220, v[224:225] offset:1536
    v_mfma_f32_16x16x32_bf16 v[96:99], v[172:175], v[200:203], v[96:99]
    v_cvt_pk_bf16_f32 v152, v32, v33
    v_cvt_pk_bf16_f32 v153, v34, v35
    v_mfma_f32_16x16x32_bf16 v[100:103], v[172:175], v[204:207], v[100:103]
    v_cvt_pk_bf16_f32 v154, v36, v37
    v_cvt_pk_bf16_f32 v155, v38, v39
    v_mfma_f32_16x16x32_bf16 v[16:19], v[184:187], v[172:175], v[16:19]
    v_cvt_pk_bf16_f32 v124, v48, v49
    v_cvt_pk_bf16_f32 v125, v50, v51
    v_mfma_f32_16x16x32_bf16 v[20:23], v[188:191], v[172:175], v[20:23]
    v_cvt_pk_bf16_f32 v126, v52, v53
    v_cvt_pk_bf16_f32 v127, v54, v55
    v_mfma_f32_16x16x32_bf16 v[64:67], v[192:195], v[176:179], v[64:67]
    v_cvt_pk_bf16_f32 v140, v8, v9
    v_cvt_pk_bf16_f32 v141, v10, v11
    v_mfma_f32_16x16x32_bf16 v[68:71], v[196:199], v[176:179], v[68:71]
    v_cvt_pk_bf16_f32 v142, v12, v13
    v_cvt_pk_bf16_f32 v143, v14, v15
    v_mfma_f32_16x16x32_bf16 v[104:107], v[176:179], v[200:203], v[104:107]
    v_cvt_pk_bf16_f32 v128, v56, v57
    v_cvt_pk_bf16_f32 v129, v58, v59
    v_mfma_f32_16x16x32_bf16 v[108:111], v[176:179], v[204:207], v[108:111]
    v_cvt_pk_bf16_f32 v130, v60, v61
    v_cvt_pk_bf16_f32 v131, v62, v63
    v_mfma_f32_16x16x32_bf16 v[24:27], v[184:187], v[176:179], v[24:27]
    v_cvt_pk_bf16_f32 v144, v16, v17
    v_cvt_pk_bf16_f32 v145, v18, v19
    v_mfma_f32_16x16x32_bf16 v[28:31], v[188:191], v[176:179], v[28:31]
    s_waitcnt lgkmcnt(0)
    s_barrier
    ds_read_b64 v[120:121], v221
    ds_read_b64 v[122:123], v222
    v_cvt_pk_bf16_f32 v146, v20, v21
    v_cvt_pk_bf16_f32 v147, v22, v23
    v_cvt_pk_bf16_f32 v132, v64, v65
    v_cvt_pk_bf16_f32 v133, v66, v67
    v_cvt_pk_bf16_f32 v134, v68, v69
    v_cvt_pk_bf16_f32 v135, v70, v71
    v_cvt_pk_bf16_f32 v148, v24, v25
    v_cvt_pk_bf16_f32 v149, v26, v27
    v_cvt_pk_bf16_f32 v150, v28, v29
    v_cvt_pk_bf16_f32 v151, v30, v31
    ds_read_b64 v[156:157], v221 offset:1536
    ds_read_b64 v[166:167], v222 offset:1536
    v_mfma_f32_16x16x32_bf16 v[36:39], v[136:139], v[152:155], 0
    v_mfma_f32_16x16x32_bf16 v[32:35], v[132:135], v[152:155], 0
    v_mfma_f32_16x16x32_bf16 v[20:23], v[128:131], v[144:147], 0
    v_mfma_f32_16x16x32_bf16 v[16:19], v[124:127], v[144:147], 0
    v_mfma_f32_16x16x32_bf16 v[28:31], v[132:135], v[148:151], 0
    v_mfma_f32_16x16x32_bf16 v[24:27], v[128:131], v[148:151], 0
    v_mfma_f32_16x16x32_bf16 v[12:15], v[124:127], v[140:143], 0
    s_waitcnt lgkmcnt(0)
    v_mfma_f32_16x16x32_bf16 v[8:11], v[120:123], v[140:143], 0
    v_cvt_pk_bf16_f32 v158, v88, v89
    v_cvt_pk_bf16_f32 v159, v90, v91
    v_cvt_pk_bf16_f32 v168, v92, v93
    v_cvt_pk_bf16_f32 v169, v94, v95
    v_cvt_pk_bf16_f32 v160, v96, v97
    v_cvt_pk_bf16_f32 v161, v98, v99
    v_cvt_pk_bf16_f32 v170, v100, v101
    v_cvt_pk_bf16_f32 v171, v102, v103
    v_cvt_pk_bf16_f32 v162, v104, v105
    v_cvt_pk_bf16_f32 v163, v106, v107
    v_cvt_pk_bf16_f32 v172, v108, v109
    v_cvt_pk_bf16_f32 v173, v110, v111
    v_cvt_pk_bf16_f32 v164, v112, v113
    v_cvt_pk_bf16_f32 v165, v114, v115
    v_cvt_pk_bf16_f32 v174, v116, v117
    v_cvt_pk_bf16_f32 v175, v118, v119
    s_mov_b32 s64, 0x3e8293ee
    v_mov_b32 v5, 0xf149f2ca
    v_cndmask_b32 v32, v32, v33, s[72:73]
    v_cndmask_b32 v34, v34, v35, s[72:73]
    v_cndmask_b32 v36, v36, v37, s[72:73]
    v_cndmask_b32 v38, v38, v39, s[72:73]
    v_cndmask_b32 v16, v16, v17, s[72:73]
    v_cndmask_b32 v18, v18, v19, s[72:73]
    v_cndmask_b32 v20, v20, v21, s[72:73]
    v_cndmask_b32 v22, v22, v23, s[72:73]
    v_cndmask_b32 v24, v24, v25, s[72:73]
    v_cndmask_b32 v26, v26, v27, s[72:73]
    v_cndmask_b32 v28, v28, v29, s[72:73]
    v_cndmask_b32 v30, v30, v31, s[72:73]
    v_cndmask_b32 v8, v8, v9, s[72:73]
    v_cndmask_b32 v10, v10, v11, s[72:73]
    v_cndmask_b32 v12, v12, v13, s[72:73]
    v_cndmask_b32 v14, v14, v15, s[72:73]
    v_cndmask_b32 v8, v5, v8, s[78:79]
    v_cndmask_b32 v10, v5, v10, s[80:81]
    v_cndmask_b32 v32, v32, v36, s[74:75]
    v_cndmask_b32 v33, v34, v38, s[76:77]
    v_cndmask_b32 v16, v16, v20, s[74:75]
    v_cndmask_b32 v17, v18, v22, s[76:77]
    v_cndmask_b32 v24, v24, v28, s[74:75]
    v_cndmask_b32 v25, v26, v30, s[76:77]
    v_cndmask_b32 v8, v8, v12, s[74:75]
    v_cndmask_b32 v9, v10, v14, s[76:77]
    v_max_f32 v192, v8, v9
    v_max_f32 v193, v16, v17
    v_max_f32 v194, v24, v25
    v_max_f32 v195, v32, v33
    v_mov_b32 v196, v192
    v_mov_b32 v197, v193
    v_mov_b32 v198, v194
    v_mov_b32 v199, v195
    v_permlane32_swap_b32 v192, v196
    v_permlane32_swap_b32 v193, v197
    v_permlane32_swap_b32 v194, v198
    v_permlane32_swap_b32 v195, v199
    v_max_f32 v192, v192, v196
    v_max_f32 v193, v193, v197
    v_max_f32 v194, v194, v198
    v_max_f32 v195, v195, v199
    v_mov_b32 v196, v192
    v_mov_b32 v197, v193
    v_mov_b32 v198, v194
    v_mov_b32 v199, v195
    v_permlane16_swap_b32 v192, v196
    v_permlane16_swap_b32 v193, v197
    v_permlane16_swap_b32 v194, v198
    v_permlane16_swap_b32 v195, v199
    v_max_f32 v192, v192, v196
    v_max_f32 v193, v193, v197
    v_max_f32 v194, v194, v198
    v_max_f32 v195, v195, v199
    v_mul_f32 v192, s64, v192
    v_mul_f32 v193, s64, v193
    v_mul_f32 v194, s64, v194
    v_mul_f32 v195, s64, v195
    v_fma_f32 v8, v8, s64, -v192
    v_fma_f32 v9, v9, s64, -v192
    v_fma_f32 v16, v16, s64, -v193
    v_fma_f32 v17, v17, s64, -v193
    v_fma_f32 v24, v24, s64, -v194
    v_fma_f32 v25, v25, s64, -v194
    v_fma_f32 v32, v32, s64, -v195
    v_fma_f32 v33, v33, s64, -v195
    v_exp_f32 v8, v8
    v_exp_f32 v9, v9
    v_exp_f32 v16, v16
    v_exp_f32 v17, v17
    v_exp_f32 v24, v24
    v_exp_f32 v25, v25
    v_exp_f32 v32, v32
    v_exp_f32 v33, v33
    v_add_f32 v192, v8, v9
    v_add_f32 v193, v16, v17
    v_add_f32 v194, v24, v25
    v_add_f32 v195, v32, v33
    v_mov_b32 v196, v192
    v_mov_b32 v197, v193
    v_mov_b32 v198, v194
    v_mov_b32 v199, v195
    v_permlane32_swap_b32 v192, v196
    v_permlane32_swap_b32 v193, v197
    v_permlane32_swap_b32 v194, v198
    v_permlane32_swap_b32 v195, v199
    v_add_f32 v192, v192, v196
    v_add_f32 v193, v193, v197
    v_add_f32 v194, v194, v198
    v_add_f32 v195, v195, v199
    v_mov_b32 v196, v192
    v_mov_b32 v197, v193
    v_mov_b32 v198, v194
    v_mov_b32 v199, v195
    v_permlane16_swap_b32 v192, v196
    v_permlane16_swap_b32 v193, v197
    v_permlane16_swap_b32 v194, v198
    v_permlane16_swap_b32 v195, v199
    v_add_f32 v192, v192, v196
    v_add_f32 v193, v193, v197
    v_add_f32 v194, v194, v198
    v_add_f32 v195, v195, v199
    v_rcp_f32 v192, v192
    v_rcp_f32 v193, v193
    v_rcp_f32 v194, v194
    v_rcp_f32 v195, v195
    v_mul_f32 v8, v8, v192
    v_mul_f32 v9, v9, v192
    v_mul_f32 v16, v16, v193
    v_mul_f32 v17, v17, v193
    v_mul_f32 v24, v24, v194
    v_mul_f32 v25, v25, v194
    v_mul_f32 v32, v32, v195
    v_mul_f32 v33, v33, v195
    v_cvt_pk_bf16_f32 v196, v8, v9
    v_cvt_pk_bf16_f32 v197, v16, v17
    v_cvt_pk_bf16_f32 v198, v24, v25
    v_cvt_pk_bf16_f32 v199, v32, v33
    v_perm_b32 v176, v196, v196, v216
    v_perm_b32 v177, v196, v196, v217
    v_perm_b32 v178, v196, v196, v218
    v_perm_b32 v179, v196, v196, v219
    v_perm_b32 v180, v197, v197, v216
    v_perm_b32 v181, v197, v197, v217
    v_perm_b32 v182, v197, v197, v218
    v_perm_b32 v183, v197, v197, v219
    v_perm_b32 v184, v198, v198, v216
    v_perm_b32 v185, v198, v198, v217
    v_perm_b32 v186, v198, v198, v218
    v_perm_b32 v187, v198, v198, v219
    v_perm_b32 v188, v199, v199, v216
    v_perm_b32 v189, v199, v199, v217
    v_perm_b32 v190, v199, v199, v218
    v_perm_b32 v191, v199, v199, v219
    v_mfma_f32_16x16x32_bf16 v[40:43], v[156:159], v[176:179], 0
    v_mfma_f32_16x16x32_bf16 v[44:47], v[166:169], v[176:179], 0
    v_mfma_f32_16x16x32_bf16 v[48:51], v[158:161], v[180:183], 0
    v_mfma_f32_16x16x32_bf16 v[52:55], v[168:171], v[180:183], 0
    v_mfma_f32_16x16x32_bf16 v[56:59], v[160:163], v[184:187], 0
    v_mfma_f32_16x16x32_bf16 v[60:63], v[170:173], v[184:187], 0
    v_mfma_f32_16x16x32_bf16 v[64:67], v[162:165], v[188:191], 0
    v_mfma_f32_16x16x32_bf16 v[68:71], v[172:175], v[188:191], 0
    s_mov_b32 s72, 0x0
    s_mov_b32 s73, 0x8000
    s_mov_b32 s74, 0x10000
    s_mov_b32 s75, 0x18000
    s_cmp_lg_u32 s45, 0
    s_cbranch_scc1 M_osw
    v_cvt_pk_bf16_f32 v120, v40, v41
    v_cvt_pk_bf16_f32 v121, v42, v43
    v_cvt_pk_bf16_f32 v122, v44, v45
    v_cvt_pk_bf16_f32 v123, v46, v47
    buffer_store_dwordx4 v[120:123], v237, s[28:31], s72 offen sc1
    v_cvt_pk_bf16_f32 v124, v48, v49
    v_cvt_pk_bf16_f32 v125, v50, v51
    v_cvt_pk_bf16_f32 v126, v52, v53
    v_cvt_pk_bf16_f32 v127, v54, v55
    buffer_store_dwordx4 v[124:127], v237, s[28:31], s73 offen sc1
    v_cvt_pk_bf16_f32 v128, v56, v57
    v_cvt_pk_bf16_f32 v129, v58, v59
    v_cvt_pk_bf16_f32 v130, v60, v61
    v_cvt_pk_bf16_f32 v131, v62, v63
    buffer_store_dwordx4 v[128:131], v237, s[28:31], s74 offen sc1
    v_cvt_pk_bf16_f32 v132, v64, v65
    v_cvt_pk_bf16_f32 v133, v66, v67
    v_cvt_pk_bf16_f32 v134, v68, v69
    v_cvt_pk_bf16_f32 v135, v70, v71
    buffer_store_dwordx4 v[132:135], v237, s[28:31], s75 offen sc1
    s_branch M_osd
M_osw:
    s_nop 3
    v_cvt_pk_bf16_f32 v122, v40, v41
    v_cvt_pk_bf16_f32 v123, v42, v43
    v_cvt_pk_bf16_f32 v120, v44, v45
    v_cvt_pk_bf16_f32 v121, v46, v47
    buffer_store_dwordx4 v[120:123], v237, s[28:31], s72 offen sc1
    v_cvt_pk_bf16_f32 v126, v48, v49
    v_cvt_pk_bf16_f32 v127, v50, v51
    v_cvt_pk_bf16_f32 v124, v52, v53
    v_cvt_pk_bf16_f32 v125, v54, v55
    buffer_store_dwordx4 v[124:127], v237, s[28:31], s73 offen sc1
    v_cvt_pk_bf16_f32 v130, v56, v57
    v_cvt_pk_bf16_f32 v131, v58, v59
    v_cvt_pk_bf16_f32 v128, v60, v61
    v_cvt_pk_bf16_f32 v129, v62, v63
    buffer_store_dwordx4 v[128:131], v237, s[28:31], s74 offen sc1
    v_cvt_pk_bf16_f32 v134, v64, v65
    v_cvt_pk_bf16_f32 v135, v66, v67
    v_cvt_pk_bf16_f32 v132, v68, v69
    v_cvt_pk_bf16_f32 v133, v70, v71
    buffer_store_dwordx4 v[132:135], v237, s[28:31], s75 offen sc1
M_osd:
    s_lshl_b32 s64, s44, 13
    s_lshl_b32 s65, s48, 9
    s_add_u32 s64, s64, s65
    s_add_u32 s64, s64, 0xa0000
    v_lshl_add_u32 v200, v1, 3, s64
    s_mov_b32 s76, 0
    s_mov_b32 s77, 32768
    s_mov_b32 s78, 65536
    s_mov_b32 s79, 98304
    s_lshl_b32 s68, s47, 9
    s_add_u32 s68, s68, 0x54000
    s_add_u32 s62, s26, s68
    s_addc_u32 s63, s27, 0
    s_lshr_b32 s68, s48, 2
    s_lshl_b32 s68, s68, 7
    v_mov_b32 v2, 1
    v_mov_b32 v5, 148484
    s_waitcnt vmcnt(0)
    s_mov_b64 exec, 1
    ds_add_rtn_u32 v245, v5, v2
    s_mov_b64 exec, -1
    s_mov_b32 s1, s0
    s_lshl_b32 s64, s48, 2
    s_waitcnt lgkmcnt(0)
    v_readfirstlane_b32 s3, v245
    s_nop 3
    s_cmp_lg_u32 s3, 3
    s_cbranch_scc1 M_po_ok
    s_atomic_swap s0, s[62:63], s64 offset:0
    s_atomic_swap s0, s[62:63], s64 offset:128
    s_atomic_swap s0, s[62:63], s64 offset:256
    s_atomic_swap s0, s[62:63], s64 offset:384
    s_mov_b32 s3, 0x40000
M_po_chk:
    s_load_dwordx16 s[80:95], s[62:63], s68 glc
    s_sub_u32 s3, s3, 1
    s_cbranch_scc1 M_po_ok
M_po_c2:
    s_waitcnt lgkmcnt(0)
    s_xor_b64 s[80:81], s[80:81], s[0:1]
    s_xor_b64 s[82:83], s[82:83], s[0:1]
    s_xor_b64 s[84:85], s[84:85], s[0:1]
    s_xor_b64 s[86:87], s[86:87], s[0:1]
    s_xor_b64 s[88:89], s[88:89], s[0:1]
    s_xor_b64 s[90:91], s[90:91], s[0:1]
    s_xor_b64 s[92:93], s[92:93], s[0:1]
    s_xor_b64 s[94:95], s[94:95], s[0:1]
    s_or_b64 s[80:81], s[80:81], s[82:83]
    s_or_b64 s[84:85], s[84:85], s[86:87]
    s_or_b64 s[88:89], s[88:89], s[90:91]
    s_or_b64 s[92:93], s[92:93], s[94:95]
    s_or_b64 s[80:81], s[80:81], s[84:85]
    s_or_b64 s[88:89], s[88:89], s[92:93]
    s_or_b64 s[80:81], s[80:81], s[88:89]
    s_cbranch_scc1 M_po_chk
M_po_ok:
    s_barrier
    s_setprio 0
    s_and_b32 s57, s58, 15
    s_lshr_b64 s[58:59], s[58:59], 4
    s_lshl_b32 s56, s57, 11
    s_mul_i32 s57, s57, 0x20000
    s_mov_b32 m0, s53
    s_nop 0
    buffer_load_dwordx4 v208, s[28:31], s56 offen offset:0 sc1 lds
    buffer_load_dwordx4 v208, s[28:31], s56 offen offset:1024 sc1 lds
    buffer_load_dwordx4 v209, s[28:31], s56 offen offset:2048 sc1 lds
    buffer_load_dwordx4 v209, s[28:31], s56 offen offset:3072 sc1 lds
    s_add_u32 s53, s53, 24576
    s_cmp_ge_u32 s53, s61
    s_cselect_b32 s53, s60, s53
    s_and_b32 s57, s58, 15
    s_lshr_b64 s[58:59], s[58:59], 4
    s_lshl_b32 s56, s57, 11
    s_mul_i32 s57, s57, 0x20000
    s_mov_b32 m0, s53
    s_nop 0
    buffer_load_dwordx4 v208, s[28:31], s56 offen offset:0 sc1 lds
    buffer_load_dwordx4 v208, s[28:31], s56 offen offset:1024 sc1 lds
    buffer_load_dwordx4 v209, s[28:31], s56 offen offset:2048 sc1 lds
    buffer_load_dwordx4 v209, s[28:31], s56 offen offset:3072 sc1 lds
    s_add_u32 s53, s53, 24576
    s_cmp_ge_u32 s53, s61
    s_cselect_b32 s53, s60, s53
    s_and_b32 s57, s58, 15
    s_lshr_b64 s[58:59], s[58:59], 4
    s_lshl_b32 s56, s57, 11
    s_mul_i32 s57, s57, 0x20000
    s_mov_b32 m0, s53
    s_nop 0
    buffer_load_dwordx4 v208, s[28:31], s56 offen offset:0 sc1 lds
    buffer_load_dwordx4 v208, s[28:31], s56 offen offset:1024 sc1 lds
    buffer_load_dwordx4 v209, s[28:31], s56 offen offset:2048 sc1 lds
    buffer_load_dwordx4 v209, s[28:31], s56 offen offset:3072 sc1 lds
    s_add_u32 s53, s53, 24576
    s_cmp_ge_u32 s53, s61
    s_cselect_b32 s53, s60, s53
    s_and_b32 s57, s58, 15
    s_lshr_b64 s[58:59], s[58:59], 4
    s_lshl_b32 s56, s57, 11
    s_mul_i32 s57, s57, 0x20000
    s_mov_b32 m0, s53
    s_nop 0
    buffer_load_dwordx4 v208, s[28:31], s56 offen offset:0 sc1 lds
    buffer_load_dwordx4 v208, s[28:31], s56 offen offset:1024 sc1 lds
    buffer_load_dwordx4 v209, s[28:31], s56 offen offset:2048 sc1 lds
    buffer_load_dwordx4 v209, s[28:31], s56 offen offset:3072 sc1 lds
    s_add_u32 s53, s53, 24576
    s_cmp_ge_u32 s53, s61
    s_cselect_b32 s53, s60, s53
    buffer_load_dwordx2 v[192:193], v200, s[28:31], s76 offen sc1
    buffer_load_dwordx2 v[194:195], v200, s[28:31], s77 offen sc1
    buffer_load_dwordx2 v[196:197], v200, s[28:31], s78 offen sc1
    buffer_load_dwordx2 v[198:199], v200, s[28:31], s79 offen sc1
    s_lshl_b32 s64, s45, 13
    v_lshl_add_u32 v233, v1, 4, s64
    v_lshrrev_b32 v2, 2, v1
    v_lshlrev_b32 v4, 8, v2
    v_and_b32 v5, 3, v1
    v_lshl_add_u32 v4, v5, 3, v4
    v_add_u32 v4, 16384, v4
    v_and_b32 v2, 7, v2
    s_lshl_b32 s64, s46, 2
    v_xor_b32 v2, s64, v2
    v_xor_b32 v3, 0, v2
    v_lshl_add_u32 v239, v3, 5, v4
    v_xor_b32 v3, 1, v2
    v_lshl_add_u32 v240, v3, 5, v4
    v_xor_b32 v3, 2, v2
    v_lshl_add_u32 v241, v3, 5, v4
    v_xor_b32 v3, 3, v2
    v_lshl_add_u32 v242, v3, 5, v4
    s_lshl_b32 s64, s2, 2
    s_add_u32 s64, s64, s44
    s_mul_i32 s64, s64, 7168
    s_add_u32 s64, s64, 5248
    s_add_u32 s10, s12, s64
    s_addc_u32 s11, s13, 0
    s_add_u32 s24, s14, s64
    s_addc_u32 s25, s15, 0
    s_mov_b32 s52, 0
    v_add_u32 v232, s52, v233
    v_add_u32 v235, s52, v239
    v_add_u32 v236, s52, v240
    v_add_u32 v237, s52, v241
    v_add_u32 v238, s52, v242
    s_movk_i32 s54, 1
M_P_loop1:
    s_waitcnt vmcnt(16)
    s_barrier
    s_and_b32 s57, s58, 15
    s_lshr_b64 s[58:59], s[58:59], 4
    s_lshl_b32 s56, s57, 11
    s_mul_i32 s57, s57, 0x20000
    s_mov_b32 m0, s53
    s_nop 0
    buffer_load_dwordx4 v208, s[28:31], s56 offen offset:0 sc1 lds
    buffer_load_dwordx4 v208, s[28:31], s56 offen offset:1024 sc1 lds
    buffer_load_dwordx4 v209, s[28:31], s56 offen offset:2048 sc1 lds
    buffer_load_dwordx4 v209, s[28:31], s56 offen offset:3072 sc1 lds
    s_add_u32 s53, s53, 24576
    s_cmp_ge_u32 s53, s61
    s_cselect_b32 s53, s60, s53
    s_sub_u32 s54, s54, 1
    s_cbranch_scc0 M_P_loop1
    s_waitcnt vmcnt(16)
    s_barrier
    s_and_b32 s57, s58, 15
    s_lshr_b64 s[58:59], s[58:59], 4
    s_lshl_b32 s56, s57, 11
    s_mul_i32 s57, s57, 0x20000
    s_add_u32 m0, s53, s70
    s_nop 0
    buffer_load_dwordx4 v210, s[32:35], s57 offen offset:0 lds
    buffer_load_dwordx4 v211, s[32:35], s57 offen offset:1024 lds
    s_mov_b32 m0, s53
    s_nop 0
    buffer_load_dwordx4 v208, s[28:31], s56 offen offset:0 sc1 lds
    buffer_load_dwordx4 v208, s[28:31], s56 offen offset:1024 sc1 lds
    buffer_load_dwordx4 v209, s[28:31], s56 offen offset:2048 sc1 lds
    buffer_load_dwordx4 v209, s[28:31], s56 offen offset:3072 sc1 lds
    s_add_u32 s53, s53, 24576
    s_cmp_ge_u32 s53, s61
    s_cselect_b32 s53, s60, s53
    s_waitcnt vmcnt(18)
    s_barrier
    s_and_b32 s57, s58, 15
    s_lshr_b64 s[58:59], s[58:59], 4
    s_lshl_b32 s56, s57, 11
    s_mul_i32 s57, s57, 0x20000
    s_add_u32 m0, s53, s70
    s_nop 0
    buffer_load_dwordx4 v210, s[32:35], s57 offen offset:0 lds
    buffer_load_dwordx4 v211, s[32:35], s57 offen offset:1024 lds
    s_mov_b32 m0, s53
    s_nop 0
    buffer_load_dwordx4 v208, s[28:31], s56 offen offset:0 sc1 lds
    buffer_load_dwordx4 v208, s[28:31], s56 offen offset:1024 sc1 lds
    buffer_load_dwordx4 v209, s[28:31], s56 offen offset:2048 sc1 lds
    buffer_load_dwordx4 v209, s[28:31], s56 offen offset:3072 sc1 lds
    s_add_u32 s53, s53, 24576
    s_cmp_ge_u32 s53, s61
    s_cselect_b32 s53, s60, s53
    s_waitcnt vmcnt(20)
    s_mov_b32 s3, 0x40000
M_tb_chk:
    v_xor_b32 v2, s0, v193
    v_xor_b32 v3, s0, v195
    v_xor_b32 v4, s0, v197
    v_xor_b32 v5, s0, v199
    v_or3_b32 v2, v2, v3, v4
    v_or_b32 v2, v2, v5
    v_cmp_ne_u32 vcc, 0, v2
    s_nop 4
    s_cbranch_vccz M_tb_ok
    s_sub_u32 s3, s3, 1
    s_cbranch_scc1 M_tb_ok
    s_sleep 1
    buffer_load_dwordx2 v[192:193], v200, s[28:31], s76 offen sc1
    buffer_load_dwordx2 v[194:195], v200, s[28:31], s77 offen sc1
    buffer_load_dwordx2 v[196:197], v200, s[28:31], s78 offen sc1
    buffer_load_dwordx2 v[198:199], v200, s[28:31], s79 offen sc1
    s_waitcnt vmcnt(0)
    s_branch M_tb_chk
M_tb_ok:
    v_add_f32 v192, v192, v194
    v_add_f32 v196, v196, v198
    v_add_f32 v192, v192, v196
    v_cvt_pk_bf16_f32 v193, v192, v192
    v_lshlrev_b32 v192, 16, v193
    s_cmp_eq_u32 s44, 2
    s_cselect_b32 s64, 1.0, 0
    v_add_f32 v192, s64, v192
    v_cvt_pk_bf16_f32 v193, v192, v192
    v_lshlrev_b32 v192, 16, v193
    s_cmp_lg_u32 s45, s46
    s_cselect_b32 s64, 0x3fb8aa3b, 1.0
    v_mul_f32 v192, s64, v192
    s_lshl_b32 s64, s44, 8
    s_add_u32 s64, s64, 149504
    v_add_u32 v2, s64, v234
    ds_write_b32 v2, v192
    s_lshl_b32 s64, s47, 12
    s_lshl_b32 s65, s48, 8
    s_add_u32 s64, s64, s65
    s_add_u32 s64, s64, 0xc0000
    s_cmp_eq_u32 s44, 3
    s_cselect_b32 s64, s64, 0x80000000
    v_add_u32 v2, s64, v234
    buffer_store_dword v192, v2, s[28:31], 0 offen sc1
    s_waitcnt lgkmcnt(0)
    s_waitcnt vmcnt(17)
    s_barrier
    s_and_b32 s57, s58, 15
    s_lshr_b64 s[58:59], s[58:59], 4
    s_lshl_b32 s56, s57, 11
    s_mul_i32 s57, s57, 0x20000
    s_add_u32 m0, s53, s70
    s_nop 0
    buffer_load_dwordx4 v210, s[32:35], s57 offen offset:0 lds
    buffer_load_dwordx4 v211, s[32:35], s57 offen offset:1024 lds
    s_mov_b32 m0, s53
    s_nop 0
    buffer_load_dwordx4 v208, s[28:31], s56 offen offset:0 sc1 lds
    buffer_load_dwordx4 v208, s[28:31], s56 offen offset:1024 sc1 lds
    buffer_load_dwordx4 v209, s[28:31], s56 offen offset:2048 sc1 lds
    buffer_load_dwordx4 v209, s[28:31], s56 offen offset:3072 sc1 lds
    s_add_u32 s53, s53, 24576
    s_cmp_ge_u32 s53, s61
    s_cselect_b32 s53, s60, s53
    s_movk_i32 s54, 2
M_P_loop2:
    s_waitcnt vmcnt(19)
    s_barrier
    s_and_b32 s57, s58, 15
    s_lshr_b64 s[58:59], s[58:59], 4
    s_lshl_b32 s56, s57, 11
    s_mul_i32 s57, s57, 0x20000
    s_add_u32 m0, s53, s70
    s_nop 0
    buffer_load_dwordx4 v210, s[32:35], s57 offen offset:0 lds
    buffer_load_dwordx4 v211, s[32:35], s57 offen offset:1024 lds
    s_mov_b32 m0, s53
    s_nop 0
    buffer_load_dwordx4 v208, s[28:31], s56 offen offset:0 sc1 lds
    buffer_load_dwordx4 v208, s[28:31], s56 offen offset:1024 sc1 lds
    buffer_load_dwordx4 v209, s[28:31], s56 offen offset:2048 sc1 lds
    buffer_load_dwordx4 v209, s[28:31], s56 offen offset:3072 sc1 lds
    s_add_u32 s53, s53, 24576
    s_cmp_ge_u32 s53, s61
    s_cselect_b32 s53, s60, s53
    s_sub_u32 s54, s54, 1
    s_cbranch_scc0 M_P_loop2
    s_movk_i32 s54, 3
M_P_loop3:
    s_waitcnt vmcnt(18)
    s_barrier
    s_and_b32 s57, s58, 15
    s_lshr_b64 s[58:59], s[58:59], 4
    s_lshl_b32 s56, s57, 11
    s_mul_i32 s57, s57, 0x20000
    s_add_u32 m0, s53, s70
    s_nop 0
    buffer_load_dwordx4 v210, s[32:35], s57 offen offset:0 lds
    buffer_load_dwordx4 v211, s[32:35], s57 offen offset:1024 lds
    s_mov_b32 m0, s53
    s_nop 0
    buffer_load_dwordx4 v208, s[28:31], s56 offen offset:0 sc1 lds
    buffer_load_dwordx4 v208, s[28:31], s56 offen offset:1024 sc1 lds
    buffer_load_dwordx4 v209, s[28:31], s56 offen offset:2048 sc1 lds
    buffer_load_dwordx4 v209, s[28:31], s56 offen offset:3072 sc1 lds
    s_add_u32 s53, s53, 24576
    s_cmp_ge_u32 s53, s61
    s_cselect_b32 s53, s60, s53
    s_sub_u32 s54, s54, 1
    s_cbranch_scc0 M_P_loop3
    s_waitcnt vmcnt(18)
    s_barrier
    s_lshl_b32 s60, s44, 12
    s_add_u32 s61, s60, 147456
    s_add_u32 s53, s60, 0
    s_bfe_u32 s66, s2, 0x30003
    s_lshr_b32 s55, s2, 6
    s_add_u32 s66, s66, s55
    s_and_b32 s66, s66, 3
    s_mov_b32 s58, 0x76453210
    s_mov_b32 s59, 0xfecdba89
    s_cmp_eq_u32 s66, 1
    s_cselect_b32 s58, 0x75643120, s58
    s_cselect_b32 s59, 0xfdecb9a8, s59
    s_cmp_eq_u32 s66, 2
    s_cselect_b32 s58, 0x67542310, s58
    s_cselect_b32 s59, 0xefdcab98, s59
    s_cmp_eq_u32 s66, 3
    s_cselect_b32 s58, 0x86534210, s58
    s_cselect_b32 s59, 0xfedbca97, s59
    s_and_b32 s66, s48, 15
    s_lshl_b32 s55, s66, 2
    s_lshr_b64 s[56:57], s[58:59], s55
    s_and_b32 s55, s56, 15
    s_lshl_b32 s55, s55, 2
    s_lshl_b64 s[56:57], 15, s55
    s_andn2_b64 s[58:59], s[58:59], s[56:57]
    s_or_b32 s58, s58, s66
    s_mov_b32 s32, s12
    s_mov_b32 s33, s13
    s_mov_b32 s34, 0x700000
    s_mov_b32 s35, 0x20000
    s_mov_b32 s36, s14
    s_mov_b32 s37, s15
    s_mov_b32 s38, 0x700000
    s_mov_b32 s39, 0x20000
    s_and_b32 s57, s58, 15
    s_lshr_b64 s[58:59], s[58:59], 4
    s_lshl_b32 s56, s57, 11
    s_mul_i32 s57, s57, 0x70000
    s_add_u32 m0, s53, 16384
    s_nop 0
    buffer_load_dwordx4 v212, s[32:35], s57 offen offset:0 lds
    buffer_load_dwordx4 v213, s[32:35], s57 offen offset:1024 lds
    s_waitcnt vmcnt(14)
    s_barrier
    buffer_load_dwordx4 v214, s[32:35], s57 offen offset:2048 lds
    buffer_load_dwordx4 v215, s[32:35], s57 offen offset:3072 lds
    s_add_u32 m0, s53, 32768
    s_nop 0
    buffer_load_dwordx4 v212, s[36:39], s57 offen offset:0 lds
    s_waitcnt vmcnt(11)
    s_barrier
    buffer_load_dwordx4 v213, s[36:39], s57 offen offset:1024 lds
    buffer_load_dwordx4 v214, s[36:39], s57 offen offset:2048 lds
    buffer_load_dwordx4 v215, s[36:39], s57 offen offset:3072 lds
    s_waitcnt vmcnt(8)
    s_barrier
    s_add_u32 s53, s53, 49152
    s_cmp_ge_u32 s53, s61
    s_cselect_b32 s53, s60, s53
    s_barrier
    s_setprio 2
    s_waitcnt vmcnt(0)
    s_barrier
    ds_read_b128 v[136:139], v232 offset:0
    ds_read_b64_tr_b16 v[152:153], v235 offset:0
    ds_read_b64_tr_b16 v[154:155], v235 offset:4096
    ds_read_b64_tr_b16 v[156:157], v236 offset:0
    ds_read_b64_tr_b16 v[158:159], v236 offset:4096
    ds_read_b64_tr_b16 v[160:161], v237 offset:0
    ds_read_b64_tr_b16 v[162:163], v237 offset:4096
    ds_read_b64_tr_b16 v[164:165], v238 offset:0
    ds_read_b64_tr_b16 v[166:167], v238 offset:4096
    ds_read_b64_tr_b16 v[168:169], v235 offset:16384
    ds_read_b64_tr_b16 v[170:171], v235 offset:20480
    ds_read_b64_tr_b16 v[172:173], v236 offset:16384
    ds_read_b64_tr_b16 v[174:175], v236 offset:20480
    ds_read_b64_tr_b16 v[176:177], v237 offset:16384
    ds_read_b64_tr_b16 v[178:179], v237 offset:20480
    ds_read_b64_tr_b16 v[180:181], v238 offset:16384
    ds_read_b64_tr_b16 v[182:183], v238 offset:20480
    ds_read_b128 v[140:143], v232 offset:2048
    ds_read_b128 v[144:147], v232 offset:4096
    ds_read_b128 v[148:151], v232 offset:6144
    s_add_u32 s52, s52, 49152
    s_cmp_ge_u32 s52, 147456
    s_cselect_b32 s52, 0, s52
    s_waitcnt lgkmcnt(0)
    v_mfma_f32_16x16x32_bf16 v[8:11], v[152:155], v[136:139], 0
    ds_read_b128 v[184:187], v232 offset:1024
    v_mfma_f32_16x16x32_bf16 v[12:15], v[156:159], v[136:139], 0
    ds_read_b64_tr_b16 v[200:201], v235 offset:8192
    v_mfma_f32_16x16x32_bf16 v[16:19], v[160:163], v[136:139], 0
    ds_read_b64_tr_b16 v[202:203], v235 offset:12288
    v_mfma_f32_16x16x32_bf16 v[20:23], v[164:167], v[136:139], 0
    ds_read_b64_tr_b16 v[204:205], v236 offset:8192
    v_mfma_f32_16x16x32_bf16 v[24:27], v[168:171], v[136:139], 0
    v_mfma_f32_16x16x32_bf16 v[28:31], v[172:175], v[136:139], 0
    ds_read_b64_tr_b16 v[206:207], v236 offset:12288
    v_mfma_f32_16x16x32_bf16 v[32:35], v[176:179], v[136:139], 0
    ds_read_b64_tr_b16 v[208:209], v237 offset:8192
    v_mfma_f32_16x16x32_bf16 v[36:39], v[180:183], v[136:139], 0
    ds_read_b64_tr_b16 v[210:211], v237 offset:12288
    v_mfma_f32_16x16x32_bf16 v[40:43], v[152:155], v[140:143], 0
    ds_read_b64_tr_b16 v[212:213], v238 offset:8192
    v_mfma_f32_16x16x32_bf16 v[44:47], v[156:159], v[140:143], 0
    v_mfma_f32_16x16x32_bf16 v[48:51], v[160:163], v[140:143], 0
    ds_read_b64_tr_b16 v[214:215], v238 offset:12288
    v_mfma_f32_16x16x32_bf16 v[52:55], v[164:167], v[140:143], 0
    ds_read_b64_tr_b16 v[216:217], v235 offset:24576
    v_mfma_f32_16x16x32_bf16 v[56:59], v[168:171], v[140:143], 0
    ds_read_b64_tr_b16 v[218:219], v235 offset:28672
    v_mfma_f32_16x16x32_bf16 v[60:63], v[172:175], v[140:143], 0
    ds_read_b64_tr_b16 v[220:221], v236 offset:24576
    v_mfma_f32_16x16x32_bf16 v[64:67], v[176:179], v[140:143], 0
    v_mfma_f32_16x16x32_bf16 v[68:71], v[180:183], v[140:143], 0
    ds_read_b64_tr_b16 v[222:223], v236 offset:28672
    v_mfma_f32_16x16x32_bf16 v[72:75], v[152:155], v[144:147], 0
    ds_read_b64_tr_b16 v[224:225], v237 offset:24576
    v_mfma_f32_16x16x32_bf16 v[76:79], v[156:159], v[144:147], 0
    ds_read_b64_tr_b16 v[226:227], v237 offset:28672
    v_mfma_f32_16x16x32_bf16 v[80:83], v[160:163], v[144:147], 0
    ds_read_b64_tr_b16 v[228:229], v238 offset:24576
    v_mfma_f32_16x16x32_bf16 v[84:87], v[164:167], v[144:147], 0
    v_mfma_f32_16x16x32_bf16 v[88:91], v[168:171], v[144:147], 0
    ds_read_b64_tr_b16 v[230:231], v238 offset:28672
    v_mfma_f32_16x16x32_bf16 v[92:95], v[172:175], v[144:147], 0
    ds_read_b128 v[188:191], v232 offset:3072
    v_mfma_f32_16x16x32_bf16 v[96:99], v[176:179], v[144:147], 0
    ds_read_b128 v[192:195], v232 offset:5120
    v_mfma_f32_16x16x32_bf16 v[100:103], v[180:183], v[144:147], 0
    ds_read_b128 v[196:199], v232 offset:7168
    v_mfma_f32_16x16x32_bf16 v[104:107], v[152:155], v[148:151], 0
    v_mfma_f32_16x16x32_bf16 v[108:111], v[156:159], v[148:151], 0
    v_add_u32 v232, s52, v233
    v_mfma_f32_16x16x32_bf16 v[112:115], v[160:163], v[148:151], 0
    v_add_u32 v235, s52, v239
    v_mfma_f32_16x16x32_bf16 v[116:119], v[164:167], v[148:151], 0
    v_add_u32 v236, s52, v240
    v_mfma_f32_16x16x32_bf16 v[120:123], v[168:171], v[148:151], 0
    v_mfma_f32_16x16x32_bf16 v[124:127], v[172:175], v[148:151], 0
    v_add_u32 v237, s52, v241
    v_mfma_f32_16x16x32_bf16 v[128:131], v[176:179], v[148:151], 0
    v_add_u32 v238, s52, v242
    v_mfma_f32_16x16x32_bf16 v[132:135], v[180:183], v[148:151], 0
    s_waitcnt lgkmcnt(0)
    v_mfma_f32_16x16x32_bf16 v[8:11], v[200:203], v[184:187], v[8:11]
    v_mfma_f32_16x16x32_bf16 v[12:15], v[204:207], v[184:187], v[12:15]
    v_mfma_f32_16x16x32_bf16 v[16:19], v[208:211], v[184:187], v[16:19]
    v_mfma_f32_16x16x32_bf16 v[20:23], v[212:215], v[184:187], v[20:23]
    v_mfma_f32_16x16x32_bf16 v[24:27], v[216:219], v[184:187], v[24:27]
    v_mfma_f32_16x16x32_bf16 v[28:31], v[220:223], v[184:187], v[28:31]
    v_mfma_f32_16x16x32_bf16 v[32:35], v[224:227], v[184:187], v[32:35]
    v_mfma_f32_16x16x32_bf16 v[36:39], v[228:231], v[184:187], v[36:39]
    v_mfma_f32_16x16x32_bf16 v[40:43], v[200:203], v[188:191], v[40:43]
    v_mfma_f32_16x16x32_bf16 v[44:47], v[204:207], v[188:191], v[44:47]
    v_mfma_f32_16x16x32_bf16 v[48:51], v[208:211], v[188:191], v[48:51]
    v_mfma_f32_16x16x32_bf16 v[52:55], v[212:215], v[188:191], v[52:55]
    v_mfma_f32_16x16x32_bf16 v[56:59], v[216:219], v[188:191], v[56:59]
    v_mfma_f32_16x16x32_bf16 v[60:63], v[220:223], v[188:191], v[60:63]
    v_mfma_f32_16x16x32_bf16 v[64:67], v[224:227], v[188:191], v[64:67]
    v_mfma_f32_16x16x32_bf16 v[68:71], v[228:231], v[188:191], v[68:71]
    v_mfma_f32_16x16x32_bf16 v[72:75], v[200:203], v[192:195], v[72:75]
    v_mfma_f32_16x16x32_bf16 v[76:79], v[204:207], v[192:195], v[76:79]
    v_mfma_f32_16x16x32_bf16 v[80:83], v[208:211], v[192:195], v[80:83]
    v_mfma_f32_16x16x32_bf16 v[84:87], v[212:215], v[192:195], v[84:87]
    v_mfma_f32_16x16x32_bf16 v[88:91], v[216:219], v[192:195], v[88:91]
    v_mfma_f32_16x16x32_bf16 v[92:95], v[220:223], v[192:195], v[92:95]
    v_mfma_f32_16x16x32_bf16 v[96:99], v[224:227], v[192:195], v[96:99]
    v_mfma_f32_16x16x32_bf16 v[100:103], v[228:231], v[192:195], v[100:103]
    v_mfma_f32_16x16x32_bf16 v[104:107], v[200:203], v[196:199], v[104:107]
    v_mfma_f32_16x16x32_bf16 v[108:111], v[204:207], v[196:199], v[108:111]
    v_mfma_f32_16x16x32_bf16 v[112:115], v[208:211], v[196:199], v[112:115]
    v_mfma_f32_16x16x32_bf16 v[116:119], v[212:215], v[196:199], v[116:119]
    v_mfma_f32_16x16x32_bf16 v[120:123], v[216:219], v[196:199], v[120:123]
    v_mfma_f32_16x16x32_bf16 v[124:127], v[220:223], v[196:199], v[124:127]
    v_mfma_f32_16x16x32_bf16 v[128:131], v[224:227], v[196:199], v[128:131]
    v_mfma_f32_16x16x32_bf16 v[132:135], v[228:231], v[196:199], v[132:135]
    s_barrier
    s_barrier
    ds_read_b128 v[136:139], v232 offset:0
    ds_read_b64_tr_b16 v[152:153], v235 offset:0
    ds_read_b64_tr_b16 v[154:155], v235 offset:4096
    ds_read_b64_tr_b16 v[156:157], v236 offset:0
    ds_read_b64_tr_b16 v[158:159], v236 offset:4096
    ds_read_b64_tr_b16 v[160:161], v237 offset:0
    ds_read_b64_tr_b16 v[162:163], v237 offset:4096
    ds_read_b64_tr_b16 v[164:165], v238 offset:0
    ds_read_b64_tr_b16 v[166:167], v238 offset:4096
    ds_read_b64_tr_b16 v[168:169], v235 offset:16384
    ds_read_b64_tr_b16 v[170:171], v235 offset:20480
    ds_read_b64_tr_b16 v[172:173], v236 offset:16384
    ds_read_b64_tr_b16 v[174:175], v236 offset:20480
    ds_read_b64_tr_b16 v[176:177], v237 offset:16384
    ds_read_b64_tr_b16 v[178:179], v237 offset:20480
    ds_read_b64_tr_b16 v[180:181], v238 offset:16384
    ds_read_b64_tr_b16 v[182:183], v238 offset:20480
    ds_read_b128 v[140:143], v232 offset:2048
    ds_read_b128 v[144:147], v232 offset:4096
    ds_read_b128 v[148:151], v232 offset:6144
    s_add_u32 s52, s52, 49152
    s_cmp_ge_u32 s52, 147456
    s_cselect_b32 s52, 0, s52
    s_waitcnt lgkmcnt(0)
    v_mfma_f32_16x16x32_bf16 v[8:11], v[152:155], v[136:139], v[8:11]
    ds_read_b128 v[184:187], v232 offset:1024
    v_mfma_f32_16x16x32_bf16 v[12:15], v[156:159], v[136:139], v[12:15]
    ds_read_b64_tr_b16 v[200:201], v235 offset:8192
    v_mfma_f32_16x16x32_bf16 v[16:19], v[160:163], v[136:139], v[16:19]
    ds_read_b64_tr_b16 v[202:203], v235 offset:12288
    v_mfma_f32_16x16x32_bf16 v[20:23], v[164:167], v[136:139], v[20:23]
    ds_read_b64_tr_b16 v[204:205], v236 offset:8192
    v_mfma_f32_16x16x32_bf16 v[24:27], v[168:171], v[136:139], v[24:27]
    v_mfma_f32_16x16x32_bf16 v[28:31], v[172:175], v[136:139], v[28:31]
    ds_read_b64_tr_b16 v[206:207], v236 offset:12288
    v_mfma_f32_16x16x32_bf16 v[32:35], v[176:179], v[136:139], v[32:35]
    ds_read_b64_tr_b16 v[208:209], v237 offset:8192
    v_mfma_f32_16x16x32_bf16 v[36:39], v[180:183], v[136:139], v[36:39]
    ds_read_b64_tr_b16 v[210:211], v237 offset:12288
    v_mfma_f32_16x16x32_bf16 v[40:43], v[152:155], v[140:143], v[40:43]
    ds_read_b64_tr_b16 v[212:213], v238 offset:8192
    v_mfma_f32_16x16x32_bf16 v[44:47], v[156:159], v[140:143], v[44:47]
    v_mfma_f32_16x16x32_bf16 v[48:51], v[160:163], v[140:143], v[48:51]
    ds_read_b64_tr_b16 v[214:215], v238 offset:12288
    v_mfma_f32_16x16x32_bf16 v[52:55], v[164:167], v[140:143], v[52:55]
    ds_read_b64_tr_b16 v[216:217], v235 offset:24576
    v_mfma_f32_16x16x32_bf16 v[56:59], v[168:171], v[140:143], v[56:59]
    ds_read_b64_tr_b16 v[218:219], v235 offset:28672
    v_mfma_f32_16x16x32_bf16 v[60:63], v[172:175], v[140:143], v[60:63]
    ds_read_b64_tr_b16 v[220:221], v236 offset:24576
    v_mfma_f32_16x16x32_bf16 v[64:67], v[176:179], v[140:143], v[64:67]
    v_mfma_f32_16x16x32_bf16 v[68:71], v[180:183], v[140:143], v[68:71]
    ds_read_b64_tr_b16 v[222:223], v236 offset:28672
    v_mfma_f32_16x16x32_bf16 v[72:75], v[152:155], v[144:147], v[72:75]
    s_movk_i32 s54, 13
M_P_loop4:
    ds_read_b64_tr_b16 v[224:225], v237 offset:24576
    v_mfma_f32_16x16x32_bf16 v[76:79], v[156:159], v[144:147], v[76:79]
    ds_read_b64_tr_b16 v[226:227], v237 offset:28672
    v_mfma_f32_16x16x32_bf16 v[80:83], v[160:163], v[144:147], v[80:83]
    ds_read_b64_tr_b16 v[228:229], v238 offset:24576
    v_mfma_f32_16x16x32_bf16 v[84:87], v[164:167], v[144:147], v[84:87]
    v_mfma_f32_16x16x32_bf16 v[88:91], v[168:171], v[144:147], v[88:91]
    ds_read_b64_tr_b16 v[230:231], v238 offset:28672
    v_mfma_f32_16x16x32_bf16 v[92:95], v[172:175], v[144:147], v[92:95]
    ds_read_b128 v[188:191], v232 offset:3072
    v_mfma_f32_16x16x32_bf16 v[96:99], v[176:179], v[144:147], v[96:99]
    ds_read_b128 v[192:195], v232 offset:5120
    v_mfma_f32_16x16x32_bf16 v[100:103], v[180:183], v[144:147], v[100:103]
    ds_read_b128 v[196:199], v232 offset:7168
    v_mfma_f32_16x16x32_bf16 v[104:107], v[152:155], v[148:151], v[104:107]
    v_mfma_f32_16x16x32_bf16 v[108:111], v[156:159], v[148:151], v[108:111]
    v_add_u32 v232, s52, v233
    v_mfma_f32_16x16x32_bf16 v[112:115], v[160:163], v[148:151], v[112:115]
    v_add_u32 v235, s52, v239
    v_mfma_f32_16x16x32_bf16 v[116:119], v[164:167], v[148:151], v[116:119]
    v_add_u32 v236, s52, v240
    v_mfma_f32_16x16x32_bf16 v[120:123], v[168:171], v[148:151], v[120:123]
    v_mfma_f32_16x16x32_bf16 v[124:127], v[172:175], v[148:151], v[124:127]
    v_add_u32 v237, s52, v241
    v_mfma_f32_16x16x32_bf16 v[128:131], v[176:179], v[148:151], v[128:131]
    v_add_u32 v238, s52, v242
    v_mfma_f32_16x16x32_bf16 v[132:135], v[180:183], v[148:151], v[132:135]
    s_waitcnt lgkmcnt(0)
    v_mfma_f32_16x16x32_bf16 v[8:11], v[200:203], v[184:187], v[8:11]
    s_barrier
    v_mfma_f32_16x16x32_bf16 v[12:15], v[204:207], v[184:187], v[12:15]
    ds_read_b128 v[136:139], v232 offset:0
    v_mfma_f32_16x16x32_bf16 v[16:19], v[208:211], v[184:187], v[16:19]
    ds_read_b64_tr_b16 v[152:153], v235 offset:0
    v_mfma_f32_16x16x32_bf16 v[20:23], v[212:215], v[184:187], v[20:23]
    ds_read_b64_tr_b16 v[154:155], v235 offset:4096
    v_mfma_f32_16x16x32_bf16 v[24:27], v[216:219], v[184:187], v[24:27]
    ds_read_b64_tr_b16 v[156:157], v236 offset:0
    v_mfma_f32_16x16x32_bf16 v[28:31], v[220:223], v[184:187], v[28:31]
    ds_read_b64_tr_b16 v[158:159], v236 offset:4096
    v_mfma_f32_16x16x32_bf16 v[32:35], v[224:227], v[184:187], v[32:35]
    v_mfma_f32_16x16x32_bf16 v[36:39], v[228:231], v[184:187], v[36:39]
    ds_read_b64_tr_b16 v[160:161], v237 offset:0
    v_mfma_f32_16x16x32_bf16 v[40:43], v[200:203], v[188:191], v[40:43]
    ds_read_b64_tr_b16 v[162:163], v237 offset:4096
    v_mfma_f32_16x16x32_bf16 v[44:47], v[204:207], v[188:191], v[44:47]
    ds_read_b64_tr_b16 v[164:165], v238 offset:0
    v_mfma_f32_16x16x32_bf16 v[48:51], v[208:211], v[188:191], v[48:51]
    ds_read_b64_tr_b16 v[166:167], v238 offset:4096
    v_mfma_f32_16x16x32_bf16 v[52:55], v[212:215], v[188:191], v[52:55]
    ds_read_b64_tr_b16 v[168:169], v235 offset:16384
    v_mfma_f32_16x16x32_bf16 v[56:59], v[216:219], v[188:191], v[56:59]
    v_mfma_f32_16x16x32_bf16 v[60:63], v[220:223], v[188:191], v[60:63]
    ds_read_b64_tr_b16 v[170:171], v235 offset:20480
    v_mfma_f32_16x16x32_bf16 v[64:67], v[224:227], v[188:191], v[64:67]
    ds_read_b64_tr_b16 v[172:173], v236 offset:16384
    v_mfma_f32_16x16x32_bf16 v[68:71], v[228:231], v[188:191], v[68:71]
    ds_read_b64_tr_b16 v[174:175], v236 offset:20480
    v_mfma_f32_16x16x32_bf16 v[72:75], v[200:203], v[192:195], v[72:75]
    ds_read_b64_tr_b16 v[176:177], v237 offset:16384
    v_mfma_f32_16x16x32_bf16 v[76:79], v[204:207], v[192:195], v[76:79]
    ds_read_b64_tr_b16 v[178:179], v237 offset:20480
    v_mfma_f32_16x16x32_bf16 v[80:83], v[208:211], v[192:195], v[80:83]
    v_mfma_f32_16x16x32_bf16 v[84:87], v[212:215], v[192:195], v[84:87]
    ds_read_b64_tr_b16 v[180:181], v238 offset:16384
    v_mfma_f32_16x16x32_bf16 v[88:91], v[216:219], v[192:195], v[88:91]
    ds_read_b64_tr_b16 v[182:183], v238 offset:20480
    v_mfma_f32_16x16x32_bf16 v[92:95], v[220:223], v[192:195], v[92:95]
    ds_read_b128 v[140:143], v232 offset:2048
    v_mfma_f32_16x16x32_bf16 v[96:99], v[224:227], v[192:195], v[96:99]
    ds_read_b128 v[144:147], v232 offset:4096
    v_mfma_f32_16x16x32_bf16 v[100:103], v[228:231], v[192:195], v[100:103]
    ds_read_b128 v[148:151], v232 offset:6144
    v_mfma_f32_16x16x32_bf16 v[104:107], v[200:203], v[196:199], v[104:107]
    v_mfma_f32_16x16x32_bf16 v[108:111], v[204:207], v[196:199], v[108:111]
    v_mfma_f32_16x16x32_bf16 v[112:115], v[208:211], v[196:199], v[112:115]
    v_mfma_f32_16x16x32_bf16 v[116:119], v[212:215], v[196:199], v[116:119]
    v_mfma_f32_16x16x32_bf16 v[120:123], v[216:219], v[196:199], v[120:123]
    v_mfma_f32_16x16x32_bf16 v[124:127], v[220:223], v[196:199], v[124:127]
    v_mfma_f32_16x16x32_bf16 v[128:131], v[224:227], v[196:199], v[128:131]
    s_add_u32 s52, s52, 49152
    s_cmp_ge_u32 s52, 147456
    s_cselect_b32 s52, 0, s52
    v_mfma_f32_16x16x32_bf16 v[132:135], v[228:231], v[196:199], v[132:135]
    s_waitcnt lgkmcnt(0)
    v_mfma_f32_16x16x32_bf16 v[8:11], v[152:155], v[136:139], v[8:11]
    ds_read_b128 v[184:187], v232 offset:1024
    v_mfma_f32_16x16x32_bf16 v[12:15], v[156:159], v[136:139], v[12:15]
    ds_read_b64_tr_b16 v[200:201], v235 offset:8192
    v_mfma_f32_16x16x32_bf16 v[16:19], v[160:163], v[136:139], v[16:19]
    ds_read_b64_tr_b16 v[202:203], v235 offset:12288
    v_mfma_f32_16x16x32_bf16 v[20:23], v[164:167], v[136:139], v[20:23]
    ds_read_b64_tr_b16 v[204:205], v236 offset:8192
    v_mfma_f32_16x16x32_bf16 v[24:27], v[168:171], v[136:139], v[24:27]
    v_mfma_f32_16x16x32_bf16 v[28:31], v[172:175], v[136:139], v[28:31]
    ds_read_b64_tr_b16 v[206:207], v236 offset:12288
    v_mfma_f32_16x16x32_bf16 v[32:35], v[176:179], v[136:139], v[32:35]
    ds_read_b64_tr_b16 v[208:209], v237 offset:8192
    v_mfma_f32_16x16x32_bf16 v[36:39], v[180:183], v[136:139], v[36:39]
    ds_read_b64_tr_b16 v[210:211], v237 offset:12288
    v_mfma_f32_16x16x32_bf16 v[40:43], v[152:155], v[140:143], v[40:43]
    ds_read_b64_tr_b16 v[212:213], v238 offset:8192
    v_mfma_f32_16x16x32_bf16 v[44:47], v[156:159], v[140:143], v[44:47]
    v_mfma_f32_16x16x32_bf16 v[48:51], v[160:163], v[140:143], v[48:51]
    ds_read_b64_tr_b16 v[214:215], v238 offset:12288
    v_mfma_f32_16x16x32_bf16 v[52:55], v[164:167], v[140:143], v[52:55]
    ds_read_b64_tr_b16 v[216:217], v235 offset:24576
    v_mfma_f32_16x16x32_bf16 v[56:59], v[168:171], v[140:143], v[56:59]
    ds_read_b64_tr_b16 v[218:219], v235 offset:28672
    v_mfma_f32_16x16x32_bf16 v[60:63], v[172:175], v[140:143], v[60:63]
    ds_read_b64_tr_b16 v[220:221], v236 offset:24576
    v_mfma_f32_16x16x32_bf16 v[64:67], v[176:179], v[140:143], v[64:67]
    v_mfma_f32_16x16x32_bf16 v[68:71], v[180:183], v[140:143], v[68:71]
    s_sub_u32 s54, s54, 1
    ds_read_b64_tr_b16 v[222:223], v236 offset:28672
    v_mfma_f32_16x16x32_bf16 v[72:75], v[152:155], v[144:147], v[72:75]
    s_cbranch_scc0 M_P_loop4
    ds_read_b64_tr_b16 v[224:225], v237 offset:24576
    v_mfma_f32_16x16x32_bf16 v[76:79], v[156:159], v[144:147], v[76:79]
    ds_read_b64_tr_b16 v[226:227], v237 offset:28672
    v_mfma_f32_16x16x32_bf16 v[80:83], v[160:163], v[144:147], v[80:83]
    ds_read_b64_tr_b16 v[228:229], v238 offset:24576
    v_mfma_f32_16x16x32_bf16 v[84:87], v[164:167], v[144:147], v[84:87]
    v_mfma_f32_16x16x32_bf16 v[88:91], v[168:171], v[144:147], v[88:91]
    ds_read_b64_tr_b16 v[230:231], v238 offset:28672
    v_mfma_f32_16x16x32_bf16 v[92:95], v[172:175], v[144:147], v[92:95]
    ds_read_b128 v[188:191], v232 offset:3072
    v_mfma_f32_16x16x32_bf16 v[96:99], v[176:179], v[144:147], v[96:99]
    ds_read_b128 v[192:195], v232 offset:5120
    v_mfma_f32_16x16x32_bf16 v[100:103], v[180:183], v[144:147], v[100:103]
    ds_read_b128 v[196:199], v232 offset:7168
    v_mfma_f32_16x16x32_bf16 v[104:107], v[152:155], v[148:151], v[104:107]
    v_mfma_f32_16x16x32_bf16 v[108:111], v[156:159], v[148:151], v[108:111]
    v_mfma_f32_16x16x32_bf16 v[112:115], v[160:163], v[148:151], v[112:115]
    v_mfma_f32_16x16x32_bf16 v[116:119], v[164:167], v[148:151], v[116:119]
    v_mfma_f32_16x16x32_bf16 v[120:123], v[168:171], v[148:151], v[120:123]
    v_mfma_f32_16x16x32_bf16 v[124:127], v[172:175], v[148:151], v[124:127]
    v_mfma_f32_16x16x32_bf16 v[128:131], v[176:179], v[148:151], v[128:131]
    v_mfma_f32_16x16x32_bf16 v[132:135], v[180:183], v[148:151], v[132:135]
    s_waitcnt lgkmcnt(0)
    v_mfma_f32_16x16x32_bf16 v[8:11], v[200:203], v[184:187], v[8:11]
    s_barrier
    v_mfma_f32_16x16x32_bf16 v[12:15], v[204:207], v[184:187], v[12:15]
    v_mfma_f32_16x16x32_bf16 v[16:19], v[208:211], v[184:187], v[16:19]
    v_mfma_f32_16x16x32_bf16 v[20:23], v[212:215], v[184:187], v[20:23]
    v_mfma_f32_16x16x32_bf16 v[24:27], v[216:219], v[184:187], v[24:27]
    v_mfma_f32_16x16x32_bf16 v[28:31], v[220:223], v[184:187], v[28:31]
    v_mfma_f32_16x16x32_bf16 v[32:35], v[224:227], v[184:187], v[32:35]
    v_mfma_f32_16x16x32_bf16 v[36:39], v[228:231], v[184:187], v[36:39]
    v_mfma_f32_16x16x32_bf16 v[40:43], v[200:203], v[188:191], v[40:43]
    v_mfma_f32_16x16x32_bf16 v[44:47], v[204:207], v[188:191], v[44:47]
    v_mfma_f32_16x16x32_bf16 v[48:51], v[208:211], v[188:191], v[48:51]
    v_mfma_f32_16x16x32_bf16 v[52:55], v[212:215], v[188:191], v[52:55]
    v_mfma_f32_16x16x32_bf16 v[56:59], v[216:219], v[188:191], v[56:59]
    v_mfma_f32_16x16x32_bf16 v[60:63], v[220:223], v[188:191], v[60:63]
    v_mfma_f32_16x16x32_bf16 v[64:67], v[224:227], v[188:191], v[64:67]
    v_mfma_f32_16x16x32_bf16 v[68:71], v[228:231], v[188:191], v[68:71]
    v_mfma_f32_16x16x32_bf16 v[72:75], v[200:203], v[192:195], v[72:75]
    v_mfma_f32_16x16x32_bf16 v[76:79], v[204:207], v[192:195], v[76:79]
    v_mfma_f32_16x16x32_bf16 v[80:83], v[208:211], v[192:195], v[80:83]
    v_mfma_f32_16x16x32_bf16 v[84:87], v[212:215], v[192:195], v[84:87]
    v_mfma_f32_16x16x32_bf16 v[88:91], v[216:219], v[192:195], v[88:91]
    v_mfma_f32_16x16x32_bf16 v[92:95], v[220:223], v[192:195], v[92:95]
    v_mfma_f32_16x16x32_bf16 v[96:99], v[224:227], v[192:195], v[96:99]
    v_mfma_f32_16x16x32_bf16 v[100:103], v[228:231], v[192:195], v[100:103]
    v_mfma_f32_16x16x32_bf16 v[104:107], v[200:203], v[196:199], v[104:107]
    v_mfma_f32_16x16x32_bf16 v[108:111], v[204:207], v[196:199], v[108:111]
    v_mfma_f32_16x16x32_bf16 v[112:115], v[208:211], v[196:199], v[112:115]
    v_mfma_f32_16x16x32_bf16 v[116:119], v[212:215], v[196:199], v[116:119]
    v_mfma_f32_16x16x32_bf16 v[120:123], v[216:219], v[196:199], v[120:123]
    v_mfma_f32_16x16x32_bf16 v[124:127], v[220:223], v[196:199], v[124:127]
    v_mfma_f32_16x16x32_bf16 v[128:131], v[224:227], v[196:199], v[128:131]
    v_mfma_f32_16x16x32_bf16 v[132:135], v[228:231], v[196:199], v[132:135]
    s_setprio 0
    s_cmp_lg_u32 s69, 0
    s_cbranch_scc1 M_Pidle
    s_lshl_b32 s64, s47, 3
    s_lshl_b32 s65, s44, 1
    s_add_u32 s64, s64, s65
    s_mul_i32 s64, s64, 32768
    s_add_u32 s64, s64, 0x1000000
    v_lshl_add_u32 v184, v1, 4, s64
    v_add_u32 v185, 30720, v184
    s_lshr_b32 s65, s48, 2
    s_sub_u32 s65, s48, s65
    s_add_u32 s65, s65, 16
    s_lshl_b32 s65, s65, 8
    s_or_b32 s65, s65, s69
    v_lshrrev_b32 v3, 4, v1
    s_lshl_b32 s64, s44, 4
    v_add_u32 v2, s64, v3
    s_movk_i32 s64, 7168
    v_mul_u32_u24 v2, s64, v2
    v_add_u32 v2, s65, v2
    v_lshlrev_b32 v3, 1, v3
    v_and_b32 v4, 15, v1
    v_xor_b32 v3, v3, v4
    v_lshl_add_u32 v188, v3, 4, v2
    v_add_u32 v190, 55296, v188
    v_xor_b32 v3, 8, v3
    v_lshl_add_u32 v189, v3, 4, v2
    v_add_u32 v189, 27648, v189
    v_add_u32 v191, 55296, v189
    s_lshl_b32 s60, s44, 12
    s_add_u32 s61, s60, 147456
    s_add_u32 s53, s60, 49152
    s_bfe_u32 s66, s2, 0x30003
    s_lshr_b32 s55, s2, 6
    s_add_u32 s66, s66, s55
    s_mul_i32 s55, s66, 11
    s_lshr_b32 s55, s55, 5
    s_mul_i32 s55, s55, 3
    s_sub_u32 s66, s66, s55
    s_mov_b32 s58, 0x9a867534
    s_mov_b32 s59, 0xfecdb
    s_cmp_eq_u32 s66, 1
    s_cselect_b32 s58, 0xb9786453, s58
    s_cselect_b32 s59, 0xfdeca, s59
    s_cmp_eq_u32 s66, 2
    s_cselect_b32 s58, 0xa8975642, s58
    s_cselect_b32 s59, 0xefdbc, s59
    s_mov_b32 s32, s12
    s_mov_b32 s33, s13
    s_mov_b32 s34, 0x700000
    s_mov_b32 s35, 0x20000
    s_mov_b32 s36, s14
    s_mov_b32 s37, s15
    s_mov_b32 s38, 0x700000
    s_mov_b32 s39, 0x20000
    s_lshl_b32 s70, s48, 12
    s_lshl_b32 s64, s47, 3
    s_lshl_b32 s65, s45, 2
    s_add_u32 s64, s64, s65
    s_mul_i32 s64, s64, 114688
    s_add_u32 s64, s64, s70
    s_lshl_b32 s65, s46, 11
    s_add_u32 s64, s64, s65
    s_add_u32 s64, s64, 0x1500000
    v_lshl_add_u32 v198, v1, 4, s64
    v_mul_f32 v24, v8, v24
    v_exp_f32 v216, -v8
    v_mul_f32 v25, v9, v25
    v_exp_f32 v217, -v9
    v_mul_f32 v26, v10, v26
    v_exp_f32 v218, -v10
    v_mul_f32 v27, v11, v27
    v_exp_f32 v219, -v11
    v_mul_f32 v28, v12, v28
    v_exp_f32 v220, -v12
    v_mul_f32 v29, v13, v29
    v_exp_f32 v221, -v13
    v_mul_f32 v30, v14, v30
    v_exp_f32 v222, -v14
    v_mul_f32 v31, v15, v31
    v_exp_f32 v223, -v15
    s_barrier
    s_and_b32 s57, s58, 15
    s_lshr_b64 s[58:59], s[58:59], 4
    s_lshl_b32 s56, s57, 11
    s_mul_i32 s57, s57, 0x70000
    s_add_u32 m0, s53, 16384
    s_nop 0
    buffer_load_dwordx4 v188, s[32:35], s57 offen offset:0 lds
    v_fma_f32 v216, v216, s67, s67
    v_fma_f32 v217, v217, s67, s67
    v_rcp_f32 v216, v216
    v_fma_f32 v218, v218, s67, s67
    buffer_load_dwordx4 v189, s[32:35], s57 offen offset:1024 lds
    v_rcp_f32 v217, v217
    v_fma_f32 v219, v219, s67, s67
    v_rcp_f32 v218, v218
    v_fma_f32 v220, v220, s67, s67
    buffer_load_dwordx4 v190, s[32:35], s57 offen offset:2048 lds
    v_rcp_f32 v219, v219
    v_fma_f32 v221, v221, s67, s67
    v_rcp_f32 v220, v220
    v_fma_f32 v222, v222, s67, s67
    buffer_load_dwordx4 v191, s[32:35], s57 offen offset:3072 lds
    v_rcp_f32 v221, v221
    v_fma_f32 v223, v223, s67, s67
    v_rcp_f32 v222, v222
    v_rcp_f32 v223, v223
    s_add_u32 m0, s53, 32768
    s_nop 0
    buffer_load_dwordx4 v188, s[36:39], s57 offen offset:0 lds
    v_mul_f32 v24, v24, v216
    v_mul_f32 v25, v25, v217
    v_mul_f32 v26, v26, v218
    v_mul_f32 v27, v27, v219
    buffer_load_dwordx4 v189, s[36:39], s57 offen offset:1024 lds
    v_mul_f32 v28, v28, v220
    v_mul_f32 v29, v29, v221
    v_mul_f32 v30, v30, v222
    v_mul_f32 v31, v31, v223
    buffer_load_dwordx4 v190, s[36:39], s57 offen offset:2048 lds
    v_cvt_pk_bf16_f32 v200, v24, v25
    v_cvt_pk_bf16_f32 v201, v26, v27
    v_cvt_pk_bf16_f32 v202, v28, v29
    v_cvt_pk_bf16_f32 v203, v30, v31
    buffer_load_dwordx4 v191, s[36:39], s57 offen offset:3072 lds
    v_mul_f32 v32, v16, v32
    v_exp_f32 v224, -v16
    v_mul_f32 v33, v17, v33
    s_mov_b32 m0, s53
    s_nop 0
    buffer_load_dwordx4 v184, s[28:31], s56 offen offset:0 sc1 lds
    v_exp_f32 v225, -v17
    v_mul_f32 v34, v18, v34
    v_exp_f32 v226, -v18
    v_mul_f32 v35, v19, v35
    buffer_load_dwordx4 v184, s[28:31], s56 offen offset:1024 sc1 lds
    v_exp_f32 v227, -v19
    v_mul_f32 v36, v20, v36
    v_exp_f32 v228, -v20
    v_mul_f32 v37, v21, v37
    buffer_load_dwordx4 v185, s[28:31], s56 offen offset:2048 sc1 lds
    v_exp_f32 v229, -v21
    v_mul_f32 v38, v22, v38
    v_exp_f32 v230, -v22
    v_mul_f32 v39, v23, v39
    buffer_load_dwordx4 v185, s[28:31], s56 offen offset:3072 sc1 lds
    v_exp_f32 v231, -v23
    v_fma_f32 v224, v224, s67, s67
    v_fma_f32 v225, v225, s67, s67
    v_rcp_f32 v224, v224
    s_add_u32 s53, s53, 49152
    s_cmp_ge_u32 s53, s61
    s_cselect_b32 s53, s60, s53
    buffer_store_dwordx4 v[200:203], v198, s[28:31], 0 offen offset:0 sc1
    s_barrier
    s_and_b32 s57, s58, 15
    s_lshr_b64 s[58:59], s[58:59], 4
    s_lshl_b32 s56, s57, 11
    s_mul_i32 s57, s57, 0x70000
    s_add_u32 m0, s53, 16384
    s_nop 0
    buffer_load_dwordx4 v188, s[32:35], s57 offen offset:0 lds
    v_fma_f32 v226, v226, s67, s67
    v_rcp_f32 v225, v225
    v_fma_f32 v227, v227, s67, s67
    v_rcp_f32 v226, v226
    buffer_load_dwordx4 v189, s[32:35], s57 offen offset:1024 lds
    v_fma_f32 v228, v228, s67, s67
    v_rcp_f32 v227, v227
    v_fma_f32 v229, v229, s67, s67
    v_rcp_f32 v228, v228
    buffer_load_dwordx4 v190, s[32:35], s57 offen offset:2048 lds
    v_fma_f32 v230, v230, s67, s67
    v_rcp_f32 v229, v229
    v_fma_f32 v231, v231, s67, s67
    v_rcp_f32 v230, v230
    buffer_load_dwordx4 v191, s[32:35], s57 offen offset:3072 lds
    v_rcp_f32 v231, v231
    v_mul_f32 v32, v32, v224
    v_mul_f32 v33, v33, v225
    v_mul_f32 v34, v34, v226
    s_add_u32 m0, s53, 32768
    s_nop 0
    buffer_load_dwordx4 v188, s[36:39], s57 offen offset:0 lds
    v_mul_f32 v35, v35, v227
    v_mul_f32 v36, v36, v228
    v_mul_f32 v37, v37, v229
    v_mul_f32 v38, v38, v230
    buffer_load_dwordx4 v189, s[36:39], s57 offen offset:1024 lds
    v_mul_f32 v39, v39, v231
    v_cvt_pk_bf16_f32 v204, v32, v33
    v_cvt_pk_bf16_f32 v205, v34, v35
    v_cvt_pk_bf16_f32 v206, v36, v37
    buffer_load_dwordx4 v190, s[36:39], s57 offen offset:2048 lds
    v_cvt_pk_bf16_f32 v207, v38, v39
    v_mul_f32 v56, v40, v56
    buffer_load_dwordx4 v191, s[36:39], s57 offen offset:3072 lds
    v_exp_f32 v216, -v40
    v_mul_f32 v57, v41, v57
    v_exp_f32 v217, -v41
    v_mul_f32 v58, v42, v58
    s_mov_b32 m0, s53
    s_nop 0
    buffer_load_dwordx4 v184, s[28:31], s56 offen offset:0 sc1 lds
    v_exp_f32 v218, -v42
    v_mul_f32 v59, v43, v59
    v_exp_f32 v219, -v43
    v_mul_f32 v60, v44, v60
    buffer_load_dwordx4 v184, s[28:31], s56 offen offset:1024 sc1 lds
    v_exp_f32 v220, -v44
    v_mul_f32 v61, v45, v61
    v_exp_f32 v221, -v45
    v_mul_f32 v62, v46, v62
    buffer_load_dwordx4 v185, s[28:31], s56 offen offset:2048 sc1 lds
    v_exp_f32 v222, -v46
    v_mul_f32 v63, v47, v63
    v_exp_f32 v223, -v47
    v_fma_f32 v216, v216, s67, s67
    buffer_load_dwordx4 v185, s[28:31], s56 offen offset:3072 sc1 lds
    v_fma_f32 v217, v217, s67, s67
    v_rcp_f32 v216, v216
    v_fma_f32 v218, v218, s67, s67
    v_rcp_f32 v217, v217
    s_add_u32 s53, s53, 49152
    s_cmp_ge_u32 s53, s61
    s_cselect_b32 s53, s60, s53
    buffer_store_dwordx4 v[204:207], v198, s[28:31], 0 offen offset:1024 sc1
    v_add_u32 v198, 114688, v198
    s_waitcnt vmcnt(14)
    s_barrier
    s_and_b32 s57, s58, 15
    s_lshr_b64 s[58:59], s[58:59], 4
    s_lshl_b32 s56, s57, 11
    s_mul_i32 s57, s57, 0x70000
    s_add_u32 m0, s53, 16384
    s_nop 0
    buffer_load_dwordx4 v188, s[32:35], s57 offen offset:0 lds
    v_fma_f32 v219, v219, s67, s67
    v_rcp_f32 v218, v218
    v_fma_f32 v220, v220, s67, s67
    v_rcp_f32 v219, v219
    buffer_load_dwordx4 v189, s[32:35], s57 offen offset:1024 lds
    v_fma_f32 v221, v221, s67, s67
    v_rcp_f32 v220, v220
    v_fma_f32 v222, v222, s67, s67
    v_rcp_f32 v221, v221
    buffer_load_dwordx4 v190, s[32:35], s57 offen offset:2048 lds
    v_fma_f32 v223, v223, s67, s67
    v_rcp_f32 v222, v222
    v_rcp_f32 v223, v223
    v_mul_f32 v56, v56, v216
    buffer_load_dwordx4 v191, s[32:35], s57 offen offset:3072 lds
    v_mul_f32 v57, v57, v217
    v_mul_f32 v58, v58, v218
    v_mul_f32 v59, v59, v219
    v_mul_f32 v60, v60, v220
    s_add_u32 m0, s53, 32768
    s_nop 0
    buffer_load_dwordx4 v188, s[36:39], s57 offen offset:0 lds
    v_mul_f32 v61, v61, v221
    v_mul_f32 v62, v62, v222
    v_mul_f32 v63, v63, v223
    v_cvt_pk_bf16_f32 v208, v56, v57
    buffer_load_dwordx4 v189, s[36:39], s57 offen offset:1024 lds
    v_cvt_pk_bf16_f32 v209, v58, v59
    v_cvt_pk_bf16_f32 v210, v60, v61
    v_cvt_pk_bf16_f32 v211, v62, v63
    buffer_load_dwordx4 v190, s[36:39], s57 offen offset:2048 lds
    v_mul_f32 v64, v48, v64
    v_exp_f32 v224, -v48
    v_mul_f32 v65, v49, v65
    v_exp_f32 v225, -v49
    buffer_load_dwordx4 v191, s[36:39], s57 offen offset:3072 lds
    v_mul_f32 v66, v50, v66
    v_exp_f32 v226, -v50
    v_mul_f32 v67, v51, v67
    v_exp_f32 v227, -v51
    s_mov_b32 m0, s53
    s_nop 0
    buffer_load_dwordx4 v184, s[28:31], s56 offen offset:0 sc1 lds
    v_mul_f32 v68, v52, v68
    v_exp_f32 v228, -v52
    v_mul_f32 v69, v53, v69
    v_exp_f32 v229, -v53
    buffer_load_dwordx4 v184, s[28:31], s56 offen offset:1024 sc1 lds
    v_mul_f32 v70, v54, v70
    v_exp_f32 v230, -v54
    v_mul_f32 v71, v55, v71
    v_exp_f32 v231, -v55
    buffer_load_dwordx4 v185, s[28:31], s56 offen offset:2048 sc1 lds
    v_fma_f32 v224, v224, s67, s67
    v_fma_f32 v225, v225, s67, s67
    v_rcp_f32 v224, v224
    v_fma_f32 v226, v226, s67, s67
    buffer_load_dwordx4 v185, s[28:31], s56 offen offset:3072 sc1 lds
    v_rcp_f32 v225, v225
    v_fma_f32 v227, v227, s67, s67
    v_rcp_f32 v226, v226
    v_fma_f32 v228, v228, s67, s67
    s_add_u32 s53, s53, 49152
    s_cmp_ge_u32 s53, s61
    s_cselect_b32 s53, s60, s53
    buffer_store_dwordx4 v[208:211], v198, s[28:31], 0 offen offset:0 sc1
    s_waitcnt vmcnt(14)
    s_barrier
    s_and_b32 s57, s58, 15
    s_lshr_b64 s[58:59], s[58:59], 4
    s_lshl_b32 s56, s57, 11
    s_mul_i32 s57, s57, 0x70000
    s_add_u32 m0, s53, 16384
    s_nop 0
    buffer_load_dwordx4 v188, s[32:35], s57 offen offset:0 lds
    v_rcp_f32 v227, v227
    v_fma_f32 v229, v229, s67, s67
    v_rcp_f32 v228, v228
    v_fma_f32 v230, v230, s67, s67
    buffer_load_dwordx4 v189, s[32:35], s57 offen offset:1024 lds
    v_rcp_f32 v229, v229
    v_fma_f32 v231, v231, s67, s67
    v_rcp_f32 v230, v230
    v_rcp_f32 v231, v231
    buffer_load_dwordx4 v190, s[32:35], s57 offen offset:2048 lds
    v_mul_f32 v64, v64, v224
    v_mul_f32 v65, v65, v225
    v_mul_f32 v66, v66, v226
    v_mul_f32 v67, v67, v227
    buffer_load_dwordx4 v191, s[32:35], s57 offen offset:3072 lds
    v_mul_f32 v68, v68, v228
    v_mul_f32 v69, v69, v229
    v_mul_f32 v70, v70, v230
    v_mul_f32 v71, v71, v231
    s_add_u32 m0, s53, 32768
    s_nop 0
    buffer_load_dwordx4 v188, s[36:39], s57 offen offset:0 lds
    v_cvt_pk_bf16_f32 v212, v64, v65
    v_cvt_pk_bf16_f32 v213, v66, v67
    v_cvt_pk_bf16_f32 v214, v68, v69
    v_cvt_pk_bf16_f32 v215, v70, v71
    buffer_load_dwordx4 v189, s[36:39], s57 offen offset:1024 lds
    v_mul_f32 v88, v72, v88
    v_exp_f32 v216, -v72
    buffer_load_dwordx4 v190, s[36:39], s57 offen offset:2048 lds
    v_mul_f32 v89, v73, v89
    v_exp_f32 v217, -v73
    v_mul_f32 v90, v74, v90
    v_exp_f32 v218, -v74
    buffer_load_dwordx4 v191, s[36:39], s57 offen offset:3072 lds
    v_mul_f32 v91, v75, v91
    v_exp_f32 v219, -v75
    v_mul_f32 v92, v76, v92
    v_exp_f32 v220, -v76
    s_mov_b32 m0, s53
    s_nop 0
    buffer_load_dwordx4 v184, s[28:31], s56 offen offset:0 sc1 lds
    v_mul_f32 v93, v77, v93
    v_exp_f32 v221, -v77
    v_mul_f32 v94, v78, v94
    v_exp_f32 v222, -v78
    buffer_load_dwordx4 v184, s[28:31], s56 offen offset:1024 sc1 lds
    v_mul_f32 v95, v79, v95
    v_exp_f32 v223, -v79
    v_fma_f32 v216, v216, s67, s67
    v_fma_f32 v217, v217, s67, s67
    buffer_load_dwordx4 v185, s[28:31], s56 offen offset:2048 sc1 lds
    v_rcp_f32 v216, v216
    v_fma_f32 v218, v218, s67, s67
    v_rcp_f32 v217, v217
    v_fma_f32 v219, v219, s67, s67
    buffer_load_dwordx4 v185, s[28:31], s56 offen offset:3072 sc1 lds
    v_rcp_f32 v218, v218
    v_fma_f32 v220, v220, s67, s67
    v_rcp_f32 v219, v219
    v_fma_f32 v221, v221, s67, s67
    s_add_u32 s53, s53, 49152
    s_cmp_ge_u32 s53, s61
    s_cselect_b32 s53, s60, s53
    buffer_store_dwordx4 v[212:215], v198, s[28:31], 0 offen offset:1024 sc1
    v_add_u32 v198, 114688, v198
    s_waitcnt vmcnt(14)
    s_barrier
    s_and_b32 s57, s58, 15
    s_lshr_b64 s[58:59], s[58:59], 4
    s_lshl_b32 s56, s57, 11
    s_mul_i32 s57, s57, 0x70000
    s_add_u32 m0, s53, 16384
    s_nop 0
    buffer_load_dwordx4 v188, s[32:35], s57 offen offset:0 lds
    v_rcp_f32 v220, v220
    v_fma_f32 v222, v222, s67, s67
    v_rcp_f32 v221, v221
    v_fma_f32 v223, v223, s67, s67
    buffer_load_dwordx4 v189, s[32:35], s57 offen offset:1024 lds
    v_rcp_f32 v222, v222
    v_rcp_f32 v223, v223
    v_mul_f32 v88, v88, v216
    v_mul_f32 v89, v89, v217
    buffer_load_dwordx4 v190, s[32:35], s57 offen offset:2048 lds
    v_mul_f32 v90, v90, v218
    v_mul_f32 v91, v91, v219
    v_mul_f32 v92, v92, v220
    v_mul_f32 v93, v93, v221
    buffer_load_dwordx4 v191, s[32:35], s57 offen offset:3072 lds
    v_mul_f32 v94, v94, v222
    v_mul_f32 v95, v95, v223
    v_cvt_pk_bf16_f32 v200, v88, v89
    v_cvt_pk_bf16_f32 v201, v90, v91
    s_add_u32 m0, s53, 32768
    s_nop 0
    buffer_load_dwordx4 v188, s[36:39], s57 offen offset:0 lds
    v_cvt_pk_bf16_f32 v202, v92, v93
    v_cvt_pk_bf16_f32 v203, v94, v95
    v_mul_f32 v96, v80, v96
    buffer_load_dwordx4 v189, s[36:39], s57 offen offset:1024 lds
    v_exp_f32 v224, -v80
    v_mul_f32 v97, v81, v97
    v_exp_f32 v225, -v81
    v_mul_f32 v98, v82, v98
    buffer_load_dwordx4 v190, s[36:39], s57 offen offset:2048 lds
    v_exp_f32 v226, -v82
    v_mul_f32 v99, v83, v99
    v_exp_f32 v227, -v83
    v_mul_f32 v100, v84, v100
    buffer_load_dwordx4 v191, s[36:39], s57 offen offset:3072 lds
    v_exp_f32 v228, -v84
    v_mul_f32 v101, v85, v101
    v_exp_f32 v229, -v85
    v_mul_f32 v102, v86, v102
    s_mov_b32 m0, s53
    s_nop 0
    buffer_load_dwordx4 v184, s[28:31], s56 offen offset:0 sc1 lds
    v_exp_f32 v230, -v86
    v_mul_f32 v103, v87, v103
    v_exp_f32 v231, -v87
    v_fma_f32 v224, v224, s67, s67
    buffer_load_dwordx4 v184, s[28:31], s56 offen offset:1024 sc1 lds
    v_fma_f32 v225, v225, s67, s67
    v_rcp_f32 v224, v224
    v_fma_f32 v226, v226, s67, s67
    v_rcp_f32 v225, v225
    buffer_load_dwordx4 v185, s[28:31], s56 offen offset:2048 sc1 lds
    v_fma_f32 v227, v227, s67, s67
    v_rcp_f32 v226, v226
    v_fma_f32 v228, v228, s67, s67
    v_rcp_f32 v227, v227
    buffer_load_dwordx4 v185, s[28:31], s56 offen offset:3072 sc1 lds
    v_fma_f32 v229, v229, s67, s67
    v_rcp_f32 v228, v228
    v_fma_f32 v230, v230, s67, s67
    v_rcp_f32 v229, v229
    s_add_u32 s53, s53, 49152
    s_cmp_ge_u32 s53, s61
    s_cselect_b32 s53, s60, s53
    buffer_store_dwordx4 v[200:203], v198, s[28:31], 0 offen offset:0 sc1
    s_waitcnt vmcnt(14)
    s_barrier
    s_and_b32 s57, s58, 15
    s_lshr_b64 s[58:59], s[58:59], 4
    s_lshl_b32 s56, s57, 11
    s_mul_i32 s57, s57, 0x70000
    s_add_u32 m0, s53, 16384
    s_nop 0
    buffer_load_dwordx4 v188, s[32:35], s57 offen offset:0 lds
    v_fma_f32 v231, v231, s67, s67
    v_rcp_f32 v230, v230
    v_rcp_f32 v231, v231
    v_mul_f32 v96, v96, v224
    buffer_load_dwordx4 v189, s[32:35], s57 offen offset:1024 lds
    v_mul_f32 v97, v97, v225
    v_mul_f32 v98, v98, v226
    v_mul_f32 v99, v99, v227
    v_mul_f32 v100, v100, v228
    buffer_load_dwordx4 v190, s[32:35], s57 offen offset:2048 lds
    v_mul_f32 v101, v101, v229
    v_mul_f32 v102, v102, v230
    v_mul_f32 v103, v103, v231
    v_cvt_pk_bf16_f32 v204, v96, v97
    buffer_load_dwordx4 v191, s[32:35], s57 offen offset:3072 lds
    v_cvt_pk_bf16_f32 v205, v98, v99
    v_cvt_pk_bf16_f32 v206, v100, v101
    v_cvt_pk_bf16_f32 v207, v102, v103
    s_add_u32 m0, s53, 32768
    s_nop 0
    buffer_load_dwordx4 v188, s[36:39], s57 offen offset:0 lds
    v_mul_f32 v120, v104, v120
    v_exp_f32 v216, -v104
    v_mul_f32 v121, v105, v121
    buffer_load_dwordx4 v189, s[36:39], s57 offen offset:1024 lds
    v_exp_f32 v217, -v105
    v_mul_f32 v122, v106, v122
    v_exp_f32 v218, -v106
    v_mul_f32 v123, v107, v123
    buffer_load_dwordx4 v190, s[36:39], s57 offen offset:2048 lds
    v_exp_f32 v219, -v107
    v_mul_f32 v124, v108, v124
    v_exp_f32 v220, -v108
    v_mul_f32 v125, v109, v125
    buffer_load_dwordx4 v191, s[36:39], s57 offen offset:3072 lds
    v_exp_f32 v221, -v109
    v_mul_f32 v126, v110, v126
    v_exp_f32 v222, -v110
    v_mul_f32 v127, v111, v127
    s_mov_b32 m0, s53
    s_nop 0
    buffer_load_dwordx4 v184, s[28:31], s56 offen offset:0 sc1 lds
    v_exp_f32 v223, -v111
    v_fma_f32 v216, v216, s67, s67
    v_fma_f32 v217, v217, s67, s67
    v_rcp_f32 v216, v216
    buffer_load_dwordx4 v184, s[28:31], s56 offen offset:1024 sc1 lds
    v_fma_f32 v218, v218, s67, s67
    v_rcp_f32 v217, v217
    v_fma_f32 v219, v219, s67, s67
    v_rcp_f32 v218, v218
    buffer_load_dwordx4 v185, s[28:31], s56 offen offset:2048 sc1 lds
    v_fma_f32 v220, v220, s67, s67
    v_rcp_f32 v219, v219
    v_fma_f32 v221, v221, s67, s67
    v_rcp_f32 v220, v220
    buffer_load_dwordx4 v185, s[28:31], s56 offen offset:3072 sc1 lds
    v_fma_f32 v222, v222, s67, s67
    v_rcp_f32 v221, v221
    v_fma_f32 v223, v223, s67, s67
    v_rcp_f32 v222, v222
    s_add_u32 s53, s53, 49152
    s_cmp_ge_u32 s53, s61
    s_cselect_b32 s53, s60, s53
    buffer_store_dwordx4 v[204:207], v198, s[28:31], 0 offen offset:1024 sc1
    v_add_u32 v198, 114688, v198
    s_waitcnt vmcnt(14)
    s_barrier
    s_and_b32 s57, s58, 15
    s_lshr_b64 s[58:59], s[58:59], 4
    s_lshl_b32 s56, s57, 11
    s_mul_i32 s57, s57, 0x70000
    s_add_u32 m0, s53, 16384
    s_nop 0
    buffer_load_dwordx4 v188, s[32:35], s57 offen offset:0 lds
    v_rcp_f32 v223, v223
    v_mul_f32 v120, v120, v216
    v_mul_f32 v121, v121, v217
    v_mul_f32 v122, v122, v218
    buffer_load_dwordx4 v189, s[32:35], s57 offen offset:1024 lds
    v_mul_f32 v123, v123, v219
    v_mul_f32 v124, v124, v220
    v_mul_f32 v125, v125, v221
    v_mul_f32 v126, v126, v222
    buffer_load_dwordx4 v190, s[32:35], s57 offen offset:2048 lds
    v_mul_f32 v127, v127, v223
    v_cvt_pk_bf16_f32 v208, v120, v121
    v_cvt_pk_bf16_f32 v209, v122, v123
    v_cvt_pk_bf16_f32 v210, v124, v125
    buffer_load_dwordx4 v191, s[32:35], s57 offen offset:3072 lds
    v_cvt_pk_bf16_f32 v211, v126, v127
    v_mul_f32 v128, v112, v128
    v_exp_f32 v224, -v112
    s_add_u32 m0, s53, 32768
    s_nop 0
    buffer_load_dwordx4 v188, s[36:39], s57 offen offset:0 lds
    v_mul_f32 v129, v113, v129
    v_exp_f32 v225, -v113
    v_mul_f32 v130, v114, v130
    v_exp_f32 v226, -v114
    buffer_load_dwordx4 v189, s[36:39], s57 offen offset:1024 lds
    v_mul_f32 v131, v115, v131
    v_exp_f32 v227, -v115
    v_mul_f32 v132, v116, v132
    v_exp_f32 v228, -v116
    buffer_load_dwordx4 v190, s[36:39], s57 offen offset:2048 lds
    v_mul_f32 v133, v117, v133
    v_exp_f32 v229, -v117
    v_mul_f32 v134, v118, v134
    v_exp_f32 v230, -v118
    buffer_load_dwordx4 v191, s[36:39], s57 offen offset:3072 lds
    v_mul_f32 v135, v119, v135
    v_exp_f32 v231, -v119
    v_fma_f32 v224, v224, s67, s67
    v_fma_f32 v225, v225, s67, s67
    s_mov_b32 m0, s53
    s_nop 0
    buffer_load_dwordx4 v184, s[28:31], s56 offen offset:0 sc1 lds
    v_rcp_f32 v224, v224
    v_fma_f32 v226, v226, s67, s67
    v_rcp_f32 v225, v225
    v_fma_f32 v227, v227, s67, s67
    buffer_load_dwordx4 v184, s[28:31], s56 offen offset:1024 sc1 lds
    v_rcp_f32 v226, v226
    v_fma_f32 v228, v228, s67, s67
    v_rcp_f32 v227, v227
    v_fma_f32 v229, v229, s67, s67
    buffer_load_dwordx4 v185, s[28:31], s56 offen offset:2048 sc1 lds
    v_rcp_f32 v228, v228
    v_fma_f32 v230, v230, s67, s67
    v_rcp_f32 v229, v229
    v_fma_f32 v231, v231, s67, s67
    buffer_load_dwordx4 v185, s[28:31], s56 offen offset:3072 sc1 lds
    v_rcp_f32 v230, v230
    v_rcp_f32 v231, v231
    v_mul_f32 v128, v128, v224
    v_mul_f32 v129, v129, v225
    s_add_u32 s53, s53, 49152
    s_cmp_ge_u32 s53, s61
    s_cselect_b32 s53, s60, s53
    buffer_store_dwordx4 v[208:211], v198, s[28:31], 0 offen offset:0 sc1
    s_waitcnt vmcnt(14)
    s_barrier
    s_and_b32 s57, s58, 15
    s_lshr_b64 s[58:59], s[58:59], 4
    s_lshl_b32 s56, s57, 11
    s_mul_i32 s57, s57, 0x70000
    s_add_u32 m0, s53, 16384
    s_nop 0
    buffer_load_dwordx4 v188, s[32:35], s57 offen offset:0 lds
    v_mul_f32 v130, v130, v226
    v_mul_f32 v131, v131, v227
    v_mul_f32 v132, v132, v228
    v_mul_f32 v133, v133, v229
    buffer_load_dwordx4 v189, s[32:35], s57 offen offset:1024 lds
    v_mul_f32 v134, v134, v230
    v_mul_f32 v135, v135, v231
    v_cvt_pk_bf16_f32 v212, v128, v129
    v_cvt_pk_bf16_f32 v213, v130, v131
    buffer_load_dwordx4 v190, s[32:35], s57 offen offset:2048 lds
    v_cvt_pk_bf16_f32 v214, v132, v133
    v_cvt_pk_bf16_f32 v215, v134, v135
    buffer_load_dwordx4 v191, s[32:35], s57 offen offset:3072 lds
    s_add_u32 m0, s53, 32768
    s_nop 0
    buffer_load_dwordx4 v188, s[36:39], s57 offen offset:0 lds
    buffer_load_dwordx4 v189, s[36:39], s57 offen offset:1024 lds
    buffer_load_dwordx4 v190, s[36:39], s57 offen offset:2048 lds
    buffer_load_dwordx4 v191, s[36:39], s57 offen offset:3072 lds
    s_mov_b32 m0, s53
    s_nop 0
    buffer_load_dwordx4 v184, s[28:31], s56 offen offset:0 sc1 lds
    buffer_load_dwordx4 v184, s[28:31], s56 offen offset:1024 sc1 lds
    buffer_load_dwordx4 v185, s[28:31], s56 offen offset:2048 sc1 lds
    buffer_load_dwordx4 v185, s[28:31], s56 offen offset:3072 sc1 lds
    s_add_u32 s53, s53, 49152
    s_cmp_ge_u32 s53, s61
    s_cselect_b32 s53, s60, s53
    buffer_store_dwordx4 v[212:215], v198, s[28:31], 0 offen offset:1024 sc1
    s_waitcnt vmcnt(14)
    s_barrier
    s_and_b32 s57, s58, 15
    s_lshr_b64 s[58:59], s[58:59], 4
    s_lshl_b32 s56, s57, 11
    s_mul_i32 s57, s57, 0x70000
    s_add_u32 m0, s53, 16384
    s_nop 0
    buffer_load_dwordx4 v188, s[32:35], s57 offen offset:0 lds
    buffer_load_dwordx4 v189, s[32:35], s57 offen offset:1024 lds
    buffer_load_dwordx4 v190, s[32:35], s57 offen offset:2048 lds
    buffer_load_dwordx4 v191, s[32:35], s57 offen offset:3072 lds
    s_add_u32 m0, s53, 32768
    s_nop 0
    buffer_load_dwordx4 v188, s[36:39], s57 offen offset:0 lds
    buffer_load_dwordx4 v189, s[36:39], s57 offen offset:1024 lds
    buffer_load_dwordx4 v190, s[36:39], s57 offen offset:2048 lds
    buffer_load_dwordx4 v191, s[36:39], s57 offen offset:3072 lds
    s_mov_b32 m0, s53
    s_nop 0
    buffer_load_dwordx4 v184, s[28:31], s56 offen offset:0 sc1 lds
    buffer_load_dwordx4 v184, s[28:31], s56 offen offset:1024 sc1 lds
    buffer_load_dwordx4 v185, s[28:31], s56 offen offset:2048 sc1 lds
    buffer_load_dwordx4 v185, s[28:31], s56 offen offset:3072 sc1 lds
    s_add_u32 s53, s53, 49152
    s_cmp_ge_u32 s53, s61
    s_cselect_b32 s53, s60, s53
    s_lshl_b32 s64, s47, 9
    s_lshl_b32 s65, s49, 7
    s_add_u32 s64, s64, s65
    s_lshl_b32 s65, s51, 4
    s_add_u32 s64, s64, s65
    s_lshl_b32 s65, s44, 2
    s_add_u32 s64, s64, s65
    s_add_u32 s64, s64, 0x50000
    v_mov_b32 v2, s0
    s_waitcnt vmcnt(12)
    s_mov_b64 exec, 1
    buffer_store_dword v2, v234, s[28:31], s64 offen sc1
    s_mov_b64 exec, -1
    s_lshl_b32 s65, s44, 1
    s_xor_b32 s65, s65, s49
    s_lshl_b32 s64, s47, 3
    s_add_u32 s64, s64, s65
    s_mul_i32 s64, s64, 114688
    s_add_u32 s64, s64, 0x1500000
    v_lshl_add_u32 v192, v1, 4, s64
    s_lshl_b32 s65, s44, 1
    s_or_b32 s65, s65, 1
    s_xor_b32 s65, s65, s49
    s_lshl_b32 s64, s47, 3
    s_add_u32 s64, s64, s65
    s_mul_i32 s64, s64, 114688
    s_add_u32 s64, s64, 0x14ff800
    v_lshl_add_u32 v193, v1, 4, s64
    s_lshl_b32 s65, s51, 9
    v_lshrrev_b32 v3, 4, v1
    s_lshl_b32 s64, s44, 4
    v_add_u32 v2, s64, v3
    s_movk_i32 s64, 2048
    v_mul_u32_u24 v2, s64, v2
    v_add_u32 v2, s65, v2
    v_lshlrev_b32 v3, 1, v3
    v_and_b32 v4, 15, v1
    v_xor_b32 v3, v3, v4
    v_lshl_add_u32 v194, v3, 4, v2
    v_add_u32 v196, 14336, v194
    v_xor_b32 v3, 8, v3
    v_lshl_add_u32 v195, v3, 4, v2
    v_add_u32 v195, 7168, v195
    v_add_u32 v197, 14336, v195
    s_barrier
    s_and_b32 s57, s58, 15
    s_lshr_b64 s[58:59], s[58:59], 4
    s_lshl_b32 s56, s57, 11
    s_mul_i32 s57, s57, 0x70000
    s_add_u32 m0, s53, 16384
    s_nop 0
    buffer_load_dwordx4 v188, s[32:35], s57 offen offset:0 lds
    buffer_load_dwordx4 v189, s[32:35], s57 offen offset:1024 lds
    buffer_load_dwordx4 v190, s[32:35], s57 offen offset:2048 lds
    buffer_load_dwordx4 v191, s[32:35], s57 offen offset:3072 lds
    s_add_u32 m0, s53, 32768
    s_nop 0
    buffer_load_dwordx4 v188, s[36:39], s57 offen offset:0 lds
    buffer_load_dwordx4 v189, s[36:39], s57 offen offset:1024 lds
    buffer_load_dwordx4 v190, s[36:39], s57 offen offset:2048 lds
    buffer_load_dwordx4 v191, s[36:39], s57 offen offset:3072 lds
    s_mov_b32 m0, s53
    s_nop 0
    buffer_load_dwordx4 v184, s[28:31], s56 offen offset:0 sc1 lds
    buffer_load_dwordx4 v184, s[28:31], s56 offen offset:1024 sc1 lds
    buffer_load_dwordx4 v185, s[28:31], s56 offen offset:2048 sc1 lds
    buffer_load_dwordx4 v185, s[28:31], s56 offen offset:3072 sc1 lds
    s_add_u32 s53, s53, 49152
    s_cmp_ge_u32 s53, s61
    s_cselect_b32 s53, s60, s53
    s_waitcnt vmcnt(13)
    s_barrier
    s_and_b32 s57, s58, 15
    s_lshr_b64 s[58:59], s[58:59], 4
    s_lshl_b32 s56, s57, 11
    s_mul_i32 s57, s57, 0x70000
    s_add_u32 m0, s53, 16384
    s_nop 0
    buffer_load_dwordx4 v188, s[32:35], s57 offen offset:0 lds
    buffer_load_dwordx4 v189, s[32:35], s57 offen offset:1024 lds
    buffer_load_dwordx4 v190, s[32:35], s57 offen offset:2048 lds
    buffer_load_dwordx4 v191, s[32:35], s57 offen offset:3072 lds
    s_add_u32 m0, s53, 32768
    s_nop 0
    buffer_load_dwordx4 v188, s[36:39], s57 offen offset:0 lds
    buffer_load_dwordx4 v189, s[36:39], s57 offen offset:1024 lds
    buffer_load_dwordx4 v190, s[36:39], s57 offen offset:2048 lds
    buffer_load_dwordx4 v191, s[36:39], s57 offen offset:3072 lds
    s_mov_b32 m0, s53
    s_nop 0
    buffer_load_dwordx4 v184, s[28:31], s56 offen offset:0 sc1 lds
    buffer_load_dwordx4 v184, s[28:31], s56 offen offset:1024 sc1 lds
    buffer_load_dwordx4 v185, s[28:31], s56 offen offset:2048 sc1 lds
    buffer_load_dwordx4 v185, s[28:31], s56 offen offset:3072 sc1 lds
    s_add_u32 s53, s53, 49152
    s_cmp_ge_u32 s53, s61
    s_cselect_b32 s53, s60, s53
    s_waitcnt vmcnt(12)
    s_barrier
    s_and_b32 s57, s58, 15
    s_lshr_b64 s[58:59], s[58:59], 4
    s_lshl_b32 s56, s57, 11
    s_mul_i32 s57, s57, 0x70000
    s_add_u32 m0, s53, 16384
    s_nop 0
    buffer_load_dwordx4 v188, s[32:35], s57 offen offset:0 lds
    buffer_load_dwordx4 v189, s[32:35], s57 offen offset:1024 lds
    buffer_load_dwordx4 v190, s[32:35], s57 offen offset:2048 lds
    buffer_load_dwordx4 v191, s[32:35], s57 offen offset:3072 lds
    s_add_u32 m0, s53, 32768
    s_nop 0
    buffer_load_dwordx4 v188, s[36:39], s57 offen offset:0 lds
    buffer_load_dwordx4 v189, s[36:39], s57 offen offset:1024 lds
    buffer_load_dwordx4 v190, s[36:39], s57 offen offset:2048 lds
    buffer_load_dwordx4 v191, s[36:39], s57 offen offset:3072 lds
    s_mov_b32 m0, s53
    s_nop 0
    buffer_load_dwordx4 v184, s[28:31], s56 offen offset:0 sc1 lds
    buffer_load_dwordx4 v184, s[28:31], s56 offen offset:1024 sc1 lds
    buffer_load_dwordx4 v185, s[28:31], s56 offen offset:2048 sc1 lds
    buffer_load_dwordx4 v185, s[28:31], s56 offen offset:3072 sc1 lds
    s_add_u32 s53, s53, 49152
    s_cmp_ge_u32 s53, s61
    s_cselect_b32 s53, s60, s53
    s_waitcnt vmcnt(12)
    s_barrier
    s_lshl_b32 s68, s47, 2
    s_add_u32 s68, s68, s49
    s_lshl_b32 s68, s68, 7
    s_add_u32 s68, s68, 0x50000
    v_min_u32 v234, 60, v234
    buffer_load_dword v245, v234, s[28:31], s68 offen sc1
    s_and_b32 s57, s58, 15
    s_lshr_b64 s[58:59], s[58:59], 4
    s_lshl_b32 s56, s57, 11
    s_mul_i32 s57, s57, 0x70000
    s_add_u32 m0, s53, 16384
    s_nop 0
    buffer_load_dwordx4 v188, s[32:35], s57 offen offset:0 lds
    buffer_load_dwordx4 v189, s[32:35], s57 offen offset:1024 lds
    buffer_load_dwordx4 v190, s[32:35], s57 offen offset:2048 lds
    buffer_load_dwordx4 v191, s[32:35], s57 offen offset:3072 lds
    s_add_u32 m0, s53, 32768
    s_nop 0
    buffer_load_dwordx4 v188, s[36:39], s57 offen offset:0 lds
    buffer_load_dwordx4 v189, s[36:39], s57 offen offset:1024 lds
    buffer_load_dwordx4 v190, s[36:39], s57 offen offset:2048 lds
    buffer_load_dwordx4 v191, s[36:39], s57 offen offset:3072 lds
    s_mov_b32 m0, s53
    s_nop 0
    buffer_load_dwordx4 v184, s[28:31], s56 offen offset:0 sc1 lds
    buffer_load_dwordx4 v184, s[28:31], s56 offen offset:1024 sc1 lds
    buffer_load_dwordx4 v185, s[28:31], s56 offen offset:2048 sc1 lds
    buffer_load_dwordx4 v185, s[28:31], s56 offen offset:3072 sc1 lds
    s_add_u32 s53, s53, 49152
    s_cmp_ge_u32 s53, s61
    s_cselect_b32 s53, s60, s53
    s_waitcnt vmcnt(13)
    s_barrier
M_Pjoin:
    s_waitcnt vmcnt(12)
    s_mov_b32 s3, 0x40000
M_pa_chk:
    v_cmp_ne_u32 vcc, s0, v245
    s_nop 4
    s_cbranch_vccz M_pa_ok
    s_sub_u32 s3, s3, 1
    s_cbranch_scc1 M_pa_ok
    s_sleep 4
    s_cmp_eq_u32 s69, 0
    s_cbranch_scc1 M_pa_rl
    s_sleep 48
M_pa_rl:
    buffer_load_dword v245, v234, s[28:31], s68 offen sc1
    s_waitcnt vmcnt(0)
    s_branch M_pa_chk
M_pa_ok:
    s_lshl_b32 s60, s44, 12
    s_add_u32 s61, s60, 147456
    s_add_u32 s53, s60, 98304
    s_bfe_u32 s66, s2, 0x30003
    s_lshr_b32 s55, s2, 6
    s_add_u32 s66, s66, s55
    s_and_b32 s66, s66, 3
    s_mov_b32 s58, 0x76453201
    s_mov_b32 s59, 0x542310
    s_cmp_eq_u32 s66, 1
    s_cselect_b32 s58, 0x75643120, s58
    s_cselect_b32 s59, 0x534201, s59
    s_cmp_eq_u32 s66, 2
    s_cselect_b32 s58, 0x67542310, s58
    s_cselect_b32 s59, 0x453210, s59
    s_cmp_eq_u32 s66, 3
    s_cselect_b32 s58, 0x76534210, s58
    s_cselect_b32 s59, 0x543201, s59
    s_lshl_b32 s55, s49, 3
    s_mov_b32 s32, s16
    s_mov_b32 s33, s17
    s_mov_b32 s34, 0x700000
    s_mov_b32 s35, 0x20000
    s_add_u32 s36, s16, 0x100
    s_addc_u32 s37, s17, 0
    s_mov_b32 s38, 0x6fff00
    s_mov_b32 s39, 0x20000
    s_and_b32 s57, s58, 15
    s_lshr_b64 s[58:59], s[58:59], 4
    s_add_u32 s57, s57, s55
    s_lshl_b32 s56, s57, 11
    s_mul_i32 s57, s57, 0x20000
    s_add_u32 m0, s53, 16384
    s_nop 0
    buffer_load_dwordx4 v194, s[32:35], s57 offen offset:0 lds
    buffer_load_dwordx4 v195, s[32:35], s57 offen offset:1024 lds
    buffer_load_dwordx4 v196, s[32:35], s57 offen offset:2048 lds
    buffer_load_dwordx4 v197, s[32:35], s57 offen offset:3072 lds
    s_add_u32 m0, s53, 32768
    s_nop 0
    buffer_load_dwordx4 v194, s[36:39], s57 offen offset:0 lds
    buffer_load_dwordx4 v195, s[36:39], s57 offen offset:1024 lds
    buffer_load_dwordx4 v196, s[36:39], s57 offen offset:2048 lds
    buffer_load_dwordx4 v197, s[36:39], s57 offen offset:3072 lds
    s_mov_b32 m0, s53
    s_nop 0
    buffer_load_dwordx4 v192, s[28:31], s56 offen offset:0 sc1 lds
    buffer_load_dwordx4 v192, s[28:31], s56 offen offset:1024 sc1 lds
    buffer_load_dwordx4 v193, s[28:31], s56 offen offset:2048 sc1 lds
    buffer_load_dwordx4 v193, s[28:31], s56 offen offset:3072 sc1 lds
    s_add_u32 s53, s53, 49152
    s_cmp_ge_u32 s53, s61
    s_cselect_b32 s53, s60, s53
    s_lshl_b32 s70, s47, 1
    s_add_u32 s70, s70, s45
    s_lshl_b32 s70, s70, 2
    s_add_u32 s70, s70, s49
    s_lshl_b32 s71, s51, 2
    s_add_u32 s71, s71, s46
    s_lshl_b32 s64, s70, 15
    s_lshl_b32 s65, s71, 7
    s_add_u32 s64, s64, s65
    v_and_b32 v2, 15, v1
    v_lshl_add_u32 v2, v2, 11, s64
    v_bfe_u32 v3, v1, 4, 1
    v_lshl_add_u32 v2, v3, 5, v2
    v_lshrrev_b32 v3, 5, v1
    v_lshl_add_u32 v246, v3, 4, v2
    s_mul_i32 s64, s70, 32768
    s_lshl_b32 s65, s71, 11
    s_add_u32 s64, s64, s65
    s_add_u32 s64, s64, 0xb00000
    v_lshl_add_u32 v248, v1, 4, s64
    s_lshl_b32 s64, s47, 12
    s_lshl_b32 s65, s71, 8
    s_add_u32 s64, s64, s65
    s_add_u32 s64, s64, 0xc0000
    v_and_b32 v2, 48, v1
    v_add_u32 v247, s64, v2
    v_lshlrev_b32 v249, 4, v1
    s_xor_b32 s64, s48, 0
    s_lshl_b32 s65, s47, 4
    s_add_u32 s64, s64, s65
    s_lshl_b32 s64, s64, 2
    s_add_u32 s64, s64, s44
    s_lshl_b32 s72, s64, 12
    s_lshl_b32 s76, s64, 9
    s_add_u32 s76, s76, 0x3000000
    s_xor_b32 s64, s48, 4
    s_lshl_b32 s65, s47, 4
    s_add_u32 s64, s64, s65
    s_lshl_b32 s64, s64, 2
    s_add_u32 s64, s64, s44
    s_lshl_b32 s73, s64, 12
    s_add_u32 s73, s73, 0x2400000
    s_lshl_b32 s77, s64, 9
    s_add_u32 s77, s77, 0x3000000
    s_xor_b32 s64, s48, 8
    s_lshl_b32 s65, s47, 4
    s_add_u32 s64, s64, s65
    s_lshl_b32 s64, s64, 2
    s_add_u32 s64, s64, s44
    s_lshl_b32 s74, s64, 12
    s_add_u32 s74, s74, 0x2800000
    s_lshl_b32 s78, s64, 9
    s_add_u32 s78, s78, 0x3000080
    s_xor_b32 s64, s48, 12
    s_lshl_b32 s65, s47, 4
    s_add_u32 s64, s64, s65
    s_lshl_b32 s64, s64, 2
    s_add_u32 s64, s64, s44
    s_lshl_b32 s75, s64, 12
    s_add_u32 s75, s75, 0x2c00000
    s_lshl_b32 s79, s64, 9
    s_add_u32 s79, s79, 0x3000100
    s_add_u32 s80, s72, 0x2400000
    s_add_u32 s81, s72, 0x2800000
    s_add_u32 s82, s72, 0x2c00000
    s_movk_i32 s83, 4096
    s_add_u32 s62, s26, s76
    s_addc_u32 s63, s27, 0
    s_load_dword s99, s[62:63], 0 glc
    s_load_dword s99, s[62:63], 128 glc
    s_load_dword s99, s[62:63], 256 glc
    s_mov_b32 s52, 98304
    s_waitcnt vmcnt(12)
    s_barrier
    s_and_b32 s57, s58, 15
    s_lshr_b64 s[58:59], s[58:59], 4
    s_add_u32 s57, s57, s55
    s_lshl_b32 s56, s57, 11
    s_mul_i32 s57, s57, 0x20000
    s_add_u32 m0, s53, 16384
    s_nop 0
    buffer_load_dwordx4 v194, s[32:35], s57 offen offset:0 lds
    buffer_load_dwordx4 v195, s[32:35], s57 offen offset:1024 lds
    buffer_load_dwordx4 v196, s[32:35], s57 offen offset:2048 lds
    buffer_load_dwordx4 v197, s[32:35], s57 offen offset:3072 lds
    s_add_u32 m0, s53, 32768
    s_nop 0
    buffer_load_dwordx4 v194, s[36:39], s57 offen offset:0 lds
    buffer_load_dwordx4 v195, s[36:39], s57 offen offset:1024 lds
    buffer_load_dwordx4 v196, s[36:39], s57 offen offset:2048 lds
    buffer_load_dwordx4 v197, s[36:39], s57 offen offset:3072 lds
    s_mov_b32 m0, s53
    s_nop 0
    buffer_load_dwordx4 v192, s[28:31], s56 offen offset:0 sc1 lds
    buffer_load_dwordx4 v192, s[28:31], s56 offen offset:1024 sc1 lds
    buffer_load_dwordx4 v193, s[28:31], s56 offen offset:2048 sc1 lds
    buffer_load_dwordx4 v193, s[28:31], s56 offen offset:3072 sc1 lds
    s_add_u32 s53, s53, 49152
    s_cmp_ge_u32 s53, s61
    s_cselect_b32 s53, s60, s53
    v_add_u32 v232, s52, v233
    v_add_u32 v235, s52, v239
    v_add_u32 v236, s52, v240
    v_add_u32 v237, s52, v241
    v_add_u32 v238, s52, v242
    s_mov_b32 s40, s22
    s_mov_b32 s41, s23
    s_mov_b32 s42, 0x400000
    s_mov_b32 s43, 0x20000
    s_waitcnt vmcnt(12)
    s_barrier
    ds_read_b128 v[140:143], v232 offset:2048
    ds_read_b64_tr_b16 v[152:153], v235 offset:0
    ds_read_b64_tr_b16 v[154:155], v235 offset:4096
    ds_read_b64_tr_b16 v[156:157], v236 offset:0
    ds_read_b64_tr_b16 v[158:159], v236 offset:4096
    ds_read_b64_tr_b16 v[160:161], v237 offset:0
    ds_read_b64_tr_b16 v[162:163], v237 offset:4096
    ds_read_b64_tr_b16 v[164:165], v238 offset:0
    ds_read_b64_tr_b16 v[166:167], v238 offset:4096
    ds_read_b64_tr_b16 v[168:169], v235 offset:16384
    ds_read_b64_tr_b16 v[170:171], v235 offset:20480
    ds_read_b64_tr_b16 v[172:173], v236 offset:16384
    ds_read_b64_tr_b16 v[174:175], v236 offset:20480
    ds_read_b64_tr_b16 v[176:177], v237 offset:16384
    ds_read_b64_tr_b16 v[178:179], v237 offset:20480
    ds_read_b64_tr_b16 v[180:181], v238 offset:16384
    ds_read_b64_tr_b16 v[182:183], v238 offset:20480
    ds_read_b128 v[144:147], v232 offset:4096
    ds_read_b128 v[148:151], v232 offset:6144
    ds_read_b128 v[136:139], v232 offset:0
    s_and_b32 s57, s58, 15
    s_lshr_b64 s[58:59], s[58:59], 4
    s_add_u32 s57, s57, s55
    s_lshl_b32 s56, s57, 11
    s_mul_i32 s57, s57, 0x20000
    s_add_u32 m0, s53, 16384
    s_nop 0
    buffer_load_dwordx4 v194, s[32:35], s57 offen offset:0 lds
    buffer_load_dwordx4 v195, s[32:35], s57 offen offset:1024 lds
    buffer_load_dwordx4 v196, s[32:35], s57 offen offset:2048 lds
    buffer_load_dwordx4 v197, s[32:35], s57 offen offset:3072 lds
    s_add_u32 m0, s53, 32768
    s_nop 0
    buffer_load_dwordx4 v194, s[36:39], s57 offen offset:0 lds
    buffer_load_dwordx4 v195, s[36:39], s57 offen offset:1024 lds
    buffer_load_dwordx4 v196, s[36:39], s57 offen offset:2048 lds
    buffer_load_dwordx4 v197, s[36:39], s57 offen offset:3072 lds
    s_mov_b32 m0, s53
    s_nop 0
    buffer_load_dwordx4 v192, s[28:31], s56 offen offset:0 sc1 lds
    buffer_load_dwordx4 v192, s[28:31], s56 offen offset:1024 sc1 lds
    buffer_load_dwordx4 v193, s[28:31], s56 offen offset:2048 sc1 lds
    buffer_load_dwordx4 v193, s[28:31], s56 offen offset:3072 sc1 lds
    s_add_u32 s53, s53, 49152
    s_cmp_ge_u32 s53, s61
    s_cselect_b32 s53, s60, s53
    s_setprio 2
    s_add_u32 s52, s52, 49152
    s_cmp_ge_u32 s52, 147456
    s_cselect_b32 s52, 0, s52
    s_waitcnt lgkmcnt(0)
    v_mfma_f32_16x16x32_bf16 v[40:43], v[152:155], v[140:143], 0
    ds_read_b128 v[188:191], v232 offset:3072
    v_mfma_f32_16x16x32_bf16 v[44:47], v[156:159], v[140:143], 0
    ds_read_b64_tr_b16 v[200:201], v235 offset:8192
    v_mfma_f32_16x16x32_bf16 v[48:51], v[160:163], v[140:143], 0
    ds_read_b64_tr_b16 v[202:203], v235 offset:12288
    v_mfma_f32_16x16x32_bf16 v[52:55], v[164:167], v[140:143], 0
    ds_read_b64_tr_b16 v[204:205], v236 offset:8192
    v_mfma_f32_16x16x32_bf16 v[56:59], v[168:171], v[140:143], 0
    v_mfma_f32_16x16x32_bf16 v[60:63], v[172:175], v[140:143], 0
    ds_read_b64_tr_b16 v[206:207], v236 offset:12288
    v_mfma_f32_16x16x32_bf16 v[64:67], v[176:179], v[140:143], 0
    ds_read_b64_tr_b16 v[208:209], v237 offset:8192
    v_mfma_f32_16x16x32_bf16 v[68:71], v[180:183], v[140:143], 0
    ds_read_b64_tr_b16 v[210:211], v237 offset:12288
    v_mfma_f32_16x16x32_bf16 v[72:75], v[152:155], v[144:147], 0
    ds_read_b64_tr_b16 v[212:213], v238 offset:8192
    v_mfma_f32_16x16x32_bf16 v[76:79], v[156:159], v[144:147], 0
    v_mfma_f32_16x16x32_bf16 v[80:83], v[160:163], v[144:147], 0
    ds_read_b64_tr_b16 v[214:215], v238 offset:12288
    v_mfma_f32_16x16x32_bf16 v[84:87], v[164:167], v[144:147], 0
    ds_read_b64_tr_b16 v[216:217], v235 offset:24576
    v_mfma_f32_16x16x32_bf16 v[88:91], v[168:171], v[144:147], 0
    ds_read_b64_tr_b16 v[218:219], v235 offset:28672
    v_mfma_f32_16x16x32_bf16 v[92:95], v[172:175], v[144:147], 0
    ds_read_b64_tr_b16 v[220:221], v236 offset:24576
    v_mfma_f32_16x16x32_bf16 v[96:99], v[176:179], v[144:147], 0
    v_mfma_f32_16x16x32_bf16 v[100:103], v[180:183], v[144:147], 0
    ds_read_b64_tr_b16 v[222:223], v236 offset:28672
    v_mfma_f32_16x16x32_bf16 v[104:107], v[152:155], v[148:151], 0
    ds_read_b64_tr_b16 v[224:225], v237 offset:24576
    v_mfma_f32_16x16x32_bf16 v[108:111], v[156:159], v[148:151], 0
    ds_read_b64_tr_b16 v[226:227], v237 offset:28672
    v_mfma_f32_16x16x32_bf16 v[112:115], v[160:163], v[148:151], 0
    ds_read_b64_tr_b16 v[228:229], v238 offset:24576
    v_mfma_f32_16x16x32_bf16 v[116:119], v[164:167], v[148:151], 0
    v_mfma_f32_16x16x32_bf16 v[120:123], v[168:171], v[148:151], 0
    ds_read_b64_tr_b16 v[230:231], v238 offset:28672
    v_mfma_f32_16x16x32_bf16 v[124:127], v[172:175], v[148:151], 0
    ds_read_b128 v[192:195], v232 offset:5120
    v_mfma_f32_16x16x32_bf16 v[128:131], v[176:179], v[148:151], 0
    ds_read_b128 v[196:199], v232 offset:7168
    v_mfma_f32_16x16x32_bf16 v[132:135], v[180:183], v[148:151], 0
    ds_read_b128 v[184:187], v232 offset:1024
    v_mfma_f32_16x16x32_bf16 v[8:11], v[152:155], v[136:139], 0
    v_mfma_f32_16x16x32_bf16 v[12:15], v[156:159], v[136:139], 0
    v_add_u32 v232, s52, v233
    v_mfma_f32_16x16x32_bf16 v[16:19], v[160:163], v[136:139], 0
    v_add_u32 v235, s52, v239
    v_mfma_f32_16x16x32_bf16 v[20:23], v[164:167], v[136:139], 0
    v_add_u32 v236, s52, v240
    v_mfma_f32_16x16x32_bf16 v[24:27], v[168:171], v[136:139], 0
    v_mfma_f32_16x16x32_bf16 v[28:31], v[172:175], v[136:139], 0
    v_add_u32 v237, s52, v241
    v_mfma_f32_16x16x32_bf16 v[32:35], v[176:179], v[136:139], 0
    v_add_u32 v238, s52, v242
    v_mfma_f32_16x16x32_bf16 v[36:39], v[180:183], v[136:139], 0
    s_waitcnt lgkmcnt(0)
    v_mfma_f32_16x16x32_bf16 v[40:43], v[200:203], v[188:191], v[40:43]
    s_waitcnt vmcnt(12)
    s_barrier
    v_mfma_f32_16x16x32_bf16 v[44:47], v[204:207], v[188:191], v[44:47]
    ds_read_b128 v[140:143], v232 offset:2048
    v_mfma_f32_16x16x32_bf16 v[48:51], v[208:211], v[188:191], v[48:51]
    ds_read_b64_tr_b16 v[152:153], v235 offset:0
    v_mfma_f32_16x16x32_bf16 v[52:55], v[212:215], v[188:191], v[52:55]
    ds_read_b64_tr_b16 v[154:155], v235 offset:4096
    v_mfma_f32_16x16x32_bf16 v[56:59], v[216:219], v[188:191], v[56:59]
    ds_read_b64_tr_b16 v[156:157], v236 offset:0
    v_mfma_f32_16x16x32_bf16 v[60:63], v[220:223], v[188:191], v[60:63]
    ds_read_b64_tr_b16 v[158:159], v236 offset:4096
    v_mfma_f32_16x16x32_bf16 v[64:67], v[224:227], v[188:191], v[64:67]
    v_mfma_f32_16x16x32_bf16 v[68:71], v[228:231], v[188:191], v[68:71]
    ds_read_b64_tr_b16 v[160:161], v237 offset:0
    v_mfma_f32_16x16x32_bf16 v[72:75], v[200:203], v[192:195], v[72:75]
    ds_read_b64_tr_b16 v[162:163], v237 offset:4096
    v_mfma_f32_16x16x32_bf16 v[76:79], v[204:207], v[192:195], v[76:79]
    ds_read_b64_tr_b16 v[164:165], v238 offset:0
    v_mfma_f32_16x16x32_bf16 v[80:83], v[208:211], v[192:195], v[80:83]
    ds_read_b64_tr_b16 v[166:167], v238 offset:4096
    v_mfma_f32_16x16x32_bf16 v[84:87], v[212:215], v[192:195], v[84:87]
    ds_read_b64_tr_b16 v[168:169], v235 offset:16384
    v_mfma_f32_16x16x32_bf16 v[88:91], v[216:219], v[192:195], v[88:91]
    v_mfma_f32_16x16x32_bf16 v[92:95], v[220:223], v[192:195], v[92:95]
    ds_read_b64_tr_b16 v[170:171], v235 offset:20480
    v_mfma_f32_16x16x32_bf16 v[96:99], v[224:227], v[192:195], v[96:99]
    ds_read_b64_tr_b16 v[172:173], v236 offset:16384
    v_mfma_f32_16x16x32_bf16 v[100:103], v[228:231], v[192:195], v[100:103]
    ds_read_b64_tr_b16 v[174:175], v236 offset:20480
    v_mfma_f32_16x16x32_bf16 v[104:107], v[200:203], v[196:199], v[104:107]
    ds_read_b64_tr_b16 v[176:177], v237 offset:16384
    v_mfma_f32_16x16x32_bf16 v[108:111], v[204:207], v[196:199], v[108:111]
    ds_read_b64_tr_b16 v[178:179], v237 offset:20480
    v_mfma_f32_16x16x32_bf16 v[112:115], v[208:211], v[196:199], v[112:115]
    v_mfma_f32_16x16x32_bf16 v[116:119], v[212:215], v[196:199], v[116:119]
    ds_read_b64_tr_b16 v[180:181], v238 offset:16384
    v_mfma_f32_16x16x32_bf16 v[120:123], v[216:219], v[196:199], v[120:123]
    ds_read_b64_tr_b16 v[182:183], v238 offset:20480
    v_mfma_f32_16x16x32_bf16 v[124:127], v[220:223], v[196:199], v[124:127]
    ds_read_b128 v[144:147], v232 offset:4096
    v_mfma_f32_16x16x32_bf16 v[128:131], v[224:227], v[196:199], v[128:131]
    ds_read_b128 v[148:151], v232 offset:6144
    v_mfma_f32_16x16x32_bf16 v[132:135], v[228:231], v[196:199], v[132:135]
    ds_read_b128 v[136:139], v232 offset:0
    v_mfma_f32_16x16x32_bf16 v[8:11], v[200:203], v[184:187], v[8:11]
    v_mfma_f32_16x16x32_bf16 v[12:15], v[204:207], v[184:187], v[12:15]
    v_mfma_f32_16x16x32_bf16 v[16:19], v[208:211], v[184:187], v[16:19]
    v_mfma_f32_16x16x32_bf16 v[20:23], v[212:215], v[184:187], v[20:23]
    v_mfma_f32_16x16x32_bf16 v[24:27], v[216:219], v[184:187], v[24:27]
    v_mfma_f32_16x16x32_bf16 v[28:31], v[220:223], v[184:187], v[28:31]
    v_mfma_f32_16x16x32_bf16 v[32:35], v[224:227], v[184:187], v[32:35]
    s_add_u32 s52, s52, 49152
    s_cmp_ge_u32 s52, 147456
    s_cselect_b32 s52, 0, s52
    v_mfma_f32_16x16x32_bf16 v[36:39], v[228:231], v[184:187], v[36:39]
    s_waitcnt lgkmcnt(0)
    v_mfma_f32_16x16x32_bf16 v[40:43], v[152:155], v[140:143], v[40:43]
    ds_read_b128 v[188:191], v232 offset:3072
    v_mfma_f32_16x16x32_bf16 v[44:47], v[156:159], v[140:143], v[44:47]
    ds_read_b64_tr_b16 v[200:201], v235 offset:8192
    v_mfma_f32_16x16x32_bf16 v[48:51], v[160:163], v[140:143], v[48:51]
    ds_read_b64_tr_b16 v[202:203], v235 offset:12288
    v_mfma_f32_16x16x32_bf16 v[52:55], v[164:167], v[140:143], v[52:55]
    ds_read_b64_tr_b16 v[204:205], v236 offset:8192
    v_mfma_f32_16x16x32_bf16 v[56:59], v[168:171], v[140:143], v[56:59]
    v_mfma_f32_16x16x32_bf16 v[60:63], v[172:175], v[140:143], v[60:63]
    ds_read_b64_tr_b16 v[206:207], v236 offset:12288
    v_mfma_f32_16x16x32_bf16 v[64:67], v[176:179], v[140:143], v[64:67]
    ds_read_b64_tr_b16 v[208:209], v237 offset:8192
    v_mfma_f32_16x16x32_bf16 v[68:71], v[180:183], v[140:143], v[68:71]
    ds_read_b64_tr_b16 v[210:211], v237 offset:12288
    v_mfma_f32_16x16x32_bf16 v[72:75], v[152:155], v[144:147], v[72:75]
    ds_read_b64_tr_b16 v[212:213], v238 offset:8192
    v_mfma_f32_16x16x32_bf16 v[76:79], v[156:159], v[144:147], v[76:79]
    v_mfma_f32_16x16x32_bf16 v[80:83], v[160:163], v[144:147], v[80:83]
    ds_read_b64_tr_b16 v[214:215], v238 offset:12288
    v_mfma_f32_16x16x32_bf16 v[84:87], v[164:167], v[144:147], v[84:87]
    ds_read_b64_tr_b16 v[216:217], v235 offset:24576
    v_mfma_f32_16x16x32_bf16 v[88:91], v[168:171], v[144:147], v[88:91]
    ds_read_b64_tr_b16 v[218:219], v235 offset:28672
    v_mfma_f32_16x16x32_bf16 v[92:95], v[172:175], v[144:147], v[92:95]
    ds_read_b64_tr_b16 v[220:221], v236 offset:24576
    v_mfma_f32_16x16x32_bf16 v[96:99], v[176:179], v[144:147], v[96:99]
    v_mfma_f32_16x16x32_bf16 v[100:103], v[180:183], v[144:147], v[100:103]
    ds_read_b64_tr_b16 v[222:223], v236 offset:28672
    v_mfma_f32_16x16x32_bf16 v[104:107], v[152:155], v[148:151], v[104:107]
    ds_read_b64_tr_b16 v[224:225], v237 offset:24576
    v_mfma_f32_16x16x32_bf16 v[108:111], v[156:159], v[148:151], v[108:111]
    ds_read_b64_tr_b16 v[226:227], v237 offset:28672
    v_mfma_f32_16x16x32_bf16 v[112:115], v[160:163], v[148:151], v[112:115]
    ds_read_b64_tr_b16 v[228:229], v238 offset:24576
    v_mfma_f32_16x16x32_bf16 v[116:119], v[164:167], v[148:151], v[116:119]
    v_mfma_f32_16x16x32_bf16 v[120:123], v[168:171], v[148:151], v[120:123]
    ds_read_b64_tr_b16 v[230:231], v238 offset:28672
    v_mfma_f32_16x16x32_bf16 v[124:127], v[172:175], v[148:151], v[124:127]
    ds_read_b128 v[192:195], v232 offset:5120
    v_mfma_f32_16x16x32_bf16 v[128:131], v[176:179], v[148:151], v[128:131]
    ds_read_b128 v[196:199], v232 offset:7168
    v_mfma_f32_16x16x32_bf16 v[132:135], v[180:183], v[148:151], v[132:135]
    ds_read_b128 v[184:187], v232 offset:1024
    v_mfma_f32_16x16x32_bf16 v[8:11], v[152:155], v[136:139], v[8:11]
    v_mfma_f32_16x16x32_bf16 v[12:15], v[156:159], v[136:139], v[12:15]
    v_add_u32 v232, s52, v233
    v_mfma_f32_16x16x32_bf16 v[16:19], v[160:163], v[136:139], v[16:19]
    v_add_u32 v235, s52, v239
    v_mfma_f32_16x16x32_bf16 v[20:23], v[164:167], v[136:139], v[20:23]
    v_add_u32 v236, s52, v240
    v_mfma_f32_16x16x32_bf16 v[24:27], v[168:171], v[136:139], v[24:27]
    v_mfma_f32_16x16x32_bf16 v[28:31], v[172:175], v[136:139], v[28:31]
    v_add_u32 v237, s52, v241
    v_mfma_f32_16x16x32_bf16 v[32:35], v[176:179], v[136:139], v[32:35]
    v_add_u32 v238, s52, v242
    v_mfma_f32_16x16x32_bf16 v[36:39], v[180:183], v[136:139], v[36:39]
    s_waitcnt lgkmcnt(0)
    v_mfma_f32_16x16x32_bf16 v[40:43], v[200:203], v[188:191], v[40:43]
    s_waitcnt vmcnt(0)
    s_barrier
    v_mfma_f32_16x16x32_bf16 v[44:47], v[204:207], v[188:191], v[44:47]
    ds_read_b128 v[140:143], v232 offset:2048
    v_mfma_f32_16x16x32_bf16 v[48:51], v[208:211], v[188:191], v[48:51]
    ds_read_b64_tr_b16 v[152:153], v235 offset:0
    v_mfma_f32_16x16x32_bf16 v[52:55], v[212:215], v[188:191], v[52:55]
    ds_read_b64_tr_b16 v[154:155], v235 offset:4096
    v_mfma_f32_16x16x32_bf16 v[56:59], v[216:219], v[188:191], v[56:59]
    ds_read_b64_tr_b16 v[156:157], v236 offset:0
    v_mfma_f32_16x16x32_bf16 v[60:63], v[220:223], v[188:191], v[60:63]
    ds_read_b64_tr_b16 v[158:159], v236 offset:4096
    v_mfma_f32_16x16x32_bf16 v[64:67], v[224:227], v[188:191], v[64:67]
    v_mfma_f32_16x16x32_bf16 v[68:71], v[228:231], v[188:191], v[68:71]
    ds_read_b64_tr_b16 v[160:161], v237 offset:0
    v_mfma_f32_16x16x32_bf16 v[72:75], v[200:203], v[192:195], v[72:75]
    ds_read_b64_tr_b16 v[162:163], v237 offset:4096
    v_mfma_f32_16x16x32_bf16 v[76:79], v[204:207], v[192:195], v[76:79]
    ds_read_b64_tr_b16 v[164:165], v238 offset:0
    v_mfma_f32_16x16x32_bf16 v[80:83], v[208:211], v[192:195], v[80:83]
    ds_read_b64_tr_b16 v[166:167], v238 offset:4096
    v_mfma_f32_16x16x32_bf16 v[84:87], v[212:215], v[192:195], v[84:87]
    ds_read_b64_tr_b16 v[168:169], v235 offset:16384
    v_mfma_f32_16x16x32_bf16 v[88:91], v[216:219], v[192:195], v[88:91]
    v_mfma_f32_16x16x32_bf16 v[92:95], v[220:223], v[192:195], v[92:95]
    ds_read_b64_tr_b16 v[170:171], v235 offset:20480
    v_mfma_f32_16x16x32_bf16 v[96:99], v[224:227], v[192:195], v[96:99]
    ds_read_b64_tr_b16 v[172:173], v236 offset:16384
    v_mfma_f32_16x16x32_bf16 v[100:103], v[228:231], v[192:195], v[100:103]
    ds_read_b64_tr_b16 v[174:175], v236 offset:20480
    v_mfma_f32_16x16x32_bf16 v[104:107], v[200:203], v[196:199], v[104:107]
    ds_read_b64_tr_b16 v[176:177], v237 offset:16384
    v_mfma_f32_16x16x32_bf16 v[108:111], v[204:207], v[196:199], v[108:111]
    ds_read_b64_tr_b16 v[178:179], v237 offset:20480
    v_mfma_f32_16x16x32_bf16 v[112:115], v[208:211], v[196:199], v[112:115]
    v_mfma_f32_16x16x32_bf16 v[116:119], v[212:215], v[196:199], v[116:119]
    ds_read_b64_tr_b16 v[180:181], v238 offset:16384
    v_mfma_f32_16x16x32_bf16 v[120:123], v[216:219], v[196:199], v[120:123]
    ds_read_b64_tr_b16 v[182:183], v238 offset:20480
    v_mfma_f32_16x16x32_bf16 v[124:127], v[220:223], v[196:199], v[124:127]
    ds_read_b128 v[144:147], v232 offset:4096
    v_mfma_f32_16x16x32_bf16 v[128:131], v[224:227], v[196:199], v[128:131]
    ds_read_b128 v[148:151], v232 offset:6144
    v_mfma_f32_16x16x32_bf16 v[132:135], v[228:231], v[196:199], v[132:135]
    ds_read_b128 v[136:139], v232 offset:0
    v_mfma_f32_16x16x32_bf16 v[8:11], v[200:203], v[184:187], v[8:11]
    v_mfma_f32_16x16x32_bf16 v[12:15], v[204:207], v[184:187], v[12:15]
    v_mfma_f32_16x16x32_bf16 v[16:19], v[208:211], v[184:187], v[16:19]
    v_mfma_f32_16x16x32_bf16 v[20:23], v[212:215], v[184:187], v[20:23]
    v_mfma_f32_16x16x32_bf16 v[24:27], v[216:219], v[184:187], v[24:27]
    v_mfma_f32_16x16x32_bf16 v[28:31], v[220:223], v[184:187], v[28:31]
    v_mfma_f32_16x16x32_bf16 v[32:35], v[224:227], v[184:187], v[32:35]
    s_add_u32 s52, s52, 49152
    s_cmp_ge_u32 s52, 147456
    s_cselect_b32 s52, 0, s52
    v_mfma_f32_16x16x32_bf16 v[36:39], v[228:231], v[184:187], v[36:39]
    s_waitcnt lgkmcnt(0)
    v_mfma_f32_16x16x32_bf16 v[40:43], v[152:155], v[140:143], v[40:43]
    ds_read_b128 v[188:191], v232 offset:3072
    v_mfma_f32_16x16x32_bf16 v[44:47], v[156:159], v[140:143], v[44:47]
    ds_read_b64_tr_b16 v[200:201], v235 offset:8192
    v_mfma_f32_16x16x32_bf16 v[48:51], v[160:163], v[140:143], v[48:51]
    ds_read_b64_tr_b16 v[202:203], v235 offset:12288
    v_mfma_f32_16x16x32_bf16 v[52:55], v[164:167], v[140:143], v[52:55]
    ds_read_b64_tr_b16 v[204:205], v236 offset:8192
    v_mfma_f32_16x16x32_bf16 v[56:59], v[168:171], v[140:143], v[56:59]
    v_mfma_f32_16x16x32_bf16 v[60:63], v[172:175], v[140:143], v[60:63]
    ds_read_b64_tr_b16 v[206:207], v236 offset:12288
    v_mfma_f32_16x16x32_bf16 v[64:67], v[176:179], v[140:143], v[64:67]
    ds_read_b64_tr_b16 v[208:209], v237 offset:8192
    v_mfma_f32_16x16x32_bf16 v[68:71], v[180:183], v[140:143], v[68:71]
    ds_read_b64_tr_b16 v[210:211], v237 offset:12288
    v_mfma_f32_16x16x32_bf16 v[72:75], v[152:155], v[144:147], v[72:75]
    ds_read_b64_tr_b16 v[212:213], v238 offset:8192
    v_mfma_f32_16x16x32_bf16 v[76:79], v[156:159], v[144:147], v[76:79]
    v_mfma_f32_16x16x32_bf16 v[80:83], v[160:163], v[144:147], v[80:83]
    ds_read_b64_tr_b16 v[214:215], v238 offset:12288
    v_mfma_f32_16x16x32_bf16 v[84:87], v[164:167], v[144:147], v[84:87]
    ds_read_b64_tr_b16 v[216:217], v235 offset:24576
    v_mfma_f32_16x16x32_bf16 v[88:91], v[168:171], v[144:147], v[88:91]
    ds_read_b64_tr_b16 v[218:219], v235 offset:28672
    v_mfma_f32_16x16x32_bf16 v[92:95], v[172:175], v[144:147], v[92:95]
    ds_read_b64_tr_b16 v[220:221], v236 offset:24576
    v_mfma_f32_16x16x32_bf16 v[96:99], v[176:179], v[144:147], v[96:99]
    v_mfma_f32_16x16x32_bf16 v[100:103], v[180:183], v[144:147], v[100:103]
    ds_read_b64_tr_b16 v[222:223], v236 offset:28672
    v_mfma_f32_16x16x32_bf16 v[104:107], v[152:155], v[148:151], v[104:107]
    s_movk_i32 s54, 7
M_P_loop5:
    ds_read_b64_tr_b16 v[224:225], v237 offset:24576
    v_mfma_f32_16x16x32_bf16 v[108:111], v[156:159], v[148:151], v[108:111]
    ds_read_b64_tr_b16 v[226:227], v237 offset:28672
    v_mfma_f32_16x16x32_bf16 v[112:115], v[160:163], v[148:151], v[112:115]
    ds_read_b64_tr_b16 v[228:229], v238 offset:24576
    v_mfma_f32_16x16x32_bf16 v[116:119], v[164:167], v[148:151], v[116:119]
    v_mfma_f32_16x16x32_bf16 v[120:123], v[168:171], v[148:151], v[120:123]
    ds_read_b64_tr_b16 v[230:231], v238 offset:28672
    v_mfma_f32_16x16x32_bf16 v[124:127], v[172:175], v[148:151], v[124:127]
    ds_read_b128 v[192:195], v232 offset:5120
    v_mfma_f32_16x16x32_bf16 v[128:131], v[176:179], v[148:151], v[128:131]
    ds_read_b128 v[196:199], v232 offset:7168
    v_mfma_f32_16x16x32_bf16 v[132:135], v[180:183], v[148:151], v[132:135]
    ds_read_b128 v[184:187], v232 offset:1024
    v_mfma_f32_16x16x32_bf16 v[8:11], v[152:155], v[136:139], v[8:11]
    v_mfma_f32_16x16x32_bf16 v[12:15], v[156:159], v[136:139], v[12:15]
    v_add_u32 v232, s52, v233
    v_mfma_f32_16x16x32_bf16 v[16:19], v[160:163], v[136:139], v[16:19]
    v_add_u32 v235, s52, v239
    v_mfma_f32_16x16x32_bf16 v[20:23], v[164:167], v[136:139], v[20:23]
    v_add_u32 v236, s52, v240
    v_mfma_f32_16x16x32_bf16 v[24:27], v[168:171], v[136:139], v[24:27]
    v_mfma_f32_16x16x32_bf16 v[28:31], v[172:175], v[136:139], v[28:31]
    v_add_u32 v237, s52, v241
    v_mfma_f32_16x16x32_bf16 v[32:35], v[176:179], v[136:139], v[32:35]
    v_add_u32 v238, s52, v242
    v_mfma_f32_16x16x32_bf16 v[36:39], v[180:183], v[136:139], v[36:39]
    s_waitcnt lgkmcnt(0)
    v_mfma_f32_16x16x32_bf16 v[40:43], v[200:203], v[188:191], v[40:43]
    s_barrier
    v_mfma_f32_16x16x32_bf16 v[44:47], v[204:207], v[188:191], v[44:47]
    ds_read_b128 v[140:143], v232 offset:2048
    v_mfma_f32_16x16x32_bf16 v[48:51], v[208:211], v[188:191], v[48:51]
    ds_read_b64_tr_b16 v[152:153], v235 offset:0
    v_mfma_f32_16x16x32_bf16 v[52:55], v[212:215], v[188:191], v[52:55]
    ds_read_b64_tr_b16 v[154:155], v235 offset:4096
    v_mfma_f32_16x16x32_bf16 v[56:59], v[216:219], v[188:191], v[56:59]
    ds_read_b64_tr_b16 v[156:157], v236 offset:0
    v_mfma_f32_16x16x32_bf16 v[60:63], v[220:223], v[188:191], v[60:63]
    ds_read_b64_tr_b16 v[158:159], v236 offset:4096
    v_mfma_f32_16x16x32_bf16 v[64:67], v[224:227], v[188:191], v[64:67]
    v_mfma_f32_16x16x32_bf16 v[68:71], v[228:231], v[188:191], v[68:71]
    ds_read_b64_tr_b16 v[160:161], v237 offset:0
    v_mfma_f32_16x16x32_bf16 v[72:75], v[200:203], v[192:195], v[72:75]
    ds_read_b64_tr_b16 v[162:163], v237 offset:4096
    v_mfma_f32_16x16x32_bf16 v[76:79], v[204:207], v[192:195], v[76:79]
    ds_read_b64_tr_b16 v[164:165], v238 offset:0
    v_mfma_f32_16x16x32_bf16 v[80:83], v[208:211], v[192:195], v[80:83]
    ds_read_b64_tr_b16 v[166:167], v238 offset:4096
    v_mfma_f32_16x16x32_bf16 v[84:87], v[212:215], v[192:195], v[84:87]
    ds_read_b64_tr_b16 v[168:169], v235 offset:16384
    v_mfma_f32_16x16x32_bf16 v[88:91], v[216:219], v[192:195], v[88:91]
    v_mfma_f32_16x16x32_bf16 v[92:95], v[220:223], v[192:195], v[92:95]
    ds_read_b64_tr_b16 v[170:171], v235 offset:20480
    v_mfma_f32_16x16x32_bf16 v[96:99], v[224:227], v[192:195], v[96:99]
    ds_read_b64_tr_b16 v[172:173], v236 offset:16384
    v_mfma_f32_16x16x32_bf16 v[100:103], v[228:231], v[192:195], v[100:103]
    ds_read_b64_tr_b16 v[174:175], v236 offset:20480
    v_mfma_f32_16x16x32_bf16 v[104:107], v[200:203], v[196:199], v[104:107]
    ds_read_b64_tr_b16 v[176:177], v237 offset:16384
    v_mfma_f32_16x16x32_bf16 v[108:111], v[204:207], v[196:199], v[108:111]
    ds_read_b64_tr_b16 v[178:179], v237 offset:20480
    v_mfma_f32_16x16x32_bf16 v[112:115], v[208:211], v[196:199], v[112:115]
    v_mfma_f32_16x16x32_bf16 v[116:119], v[212:215], v[196:199], v[116:119]
    ds_read_b64_tr_b16 v[180:181], v238 offset:16384
    v_mfma_f32_16x16x32_bf16 v[120:123], v[216:219], v[196:199], v[120:123]
    ds_read_b64_tr_b16 v[182:183], v238 offset:20480
    v_mfma_f32_16x16x32_bf16 v[124:127], v[220:223], v[196:199], v[124:127]
    ds_read_b128 v[144:147], v232 offset:4096
    v_mfma_f32_16x16x32_bf16 v[128:131], v[224:227], v[196:199], v[128:131]
    ds_read_b128 v[148:151], v232 offset:6144
    v_mfma_f32_16x16x32_bf16 v[132:135], v[228:231], v[196:199], v[132:135]
    ds_read_b128 v[136:139], v232 offset:0
    v_mfma_f32_16x16x32_bf16 v[8:11], v[200:203], v[184:187], v[8:11]
    v_mfma_f32_16x16x32_bf16 v[12:15], v[204:207], v[184:187], v[12:15]
    v_mfma_f32_16x16x32_bf16 v[16:19], v[208:211], v[184:187], v[16:19]
    v_mfma_f32_16x16x32_bf16 v[20:23], v[212:215], v[184:187], v[20:23]
    v_mfma_f32_16x16x32_bf16 v[24:27], v[216:219], v[184:187], v[24:27]
    v_mfma_f32_16x16x32_bf16 v[28:31], v[220:223], v[184:187], v[28:31]
    v_mfma_f32_16x16x32_bf16 v[32:35], v[224:227], v[184:187], v[32:35]
    s_add_u32 s52, s52, 49152
    s_cmp_ge_u32 s52, 147456
    s_cselect_b32 s52, 0, s52
    v_mfma_f32_16x16x32_bf16 v[36:39], v[228:231], v[184:187], v[36:39]
    s_waitcnt lgkmcnt(0)
    v_mfma_f32_16x16x32_bf16 v[40:43], v[152:155], v[140:143], v[40:43]
    ds_read_b128 v[188:191], v232 offset:3072
    v_mfma_f32_16x16x32_bf16 v[44:47], v[156:159], v[140:143], v[44:47]
    ds_read_b64_tr_b16 v[200:201], v235 offset:8192
    v_mfma_f32_16x16x32_bf16 v[48:51], v[160:163], v[140:143], v[48:51]
    ds_read_b64_tr_b16 v[202:203], v235 offset:12288
    v_mfma_f32_16x16x32_bf16 v[52:55], v[164:167], v[140:143], v[52:55]
    ds_read_b64_tr_b16 v[204:205], v236 offset:8192
    v_mfma_f32_16x16x32_bf16 v[56:59], v[168:171], v[140:143], v[56:59]
    v_mfma_f32_16x16x32_bf16 v[60:63], v[172:175], v[140:143], v[60:63]
    ds_read_b64_tr_b16 v[206:207], v236 offset:12288
    v_mfma_f32_16x16x32_bf16 v[64:67], v[176:179], v[140:143], v[64:67]
    ds_read_b64_tr_b16 v[208:209], v237 offset:8192
    v_mfma_f32_16x16x32_bf16 v[68:71], v[180:183], v[140:143], v[68:71]
    ds_read_b64_tr_b16 v[210:211], v237 offset:12288
    v_mfma_f32_16x16x32_bf16 v[72:75], v[152:155], v[144:147], v[72:75]
    ds_read_b64_tr_b16 v[212:213], v238 offset:8192
    v_mfma_f32_16x16x32_bf16 v[76:79], v[156:159], v[144:147], v[76:79]
    v_mfma_f32_16x16x32_bf16 v[80:83], v[160:163], v[144:147], v[80:83]
    ds_read_b64_tr_b16 v[214:215], v238 offset:12288
    v_mfma_f32_16x16x32_bf16 v[84:87], v[164:167], v[144:147], v[84:87]
    ds_read_b64_tr_b16 v[216:217], v235 offset:24576
    v_mfma_f32_16x16x32_bf16 v[88:91], v[168:171], v[144:147], v[88:91]
    ds_read_b64_tr_b16 v[218:219], v235 offset:28672
    v_mfma_f32_16x16x32_bf16 v[92:95], v[172:175], v[144:147], v[92:95]
    ds_read_b64_tr_b16 v[220:221], v236 offset:24576
    v_mfma_f32_16x16x32_bf16 v[96:99], v[176:179], v[144:147], v[96:99]
    v_mfma_f32_16x16x32_bf16 v[100:103], v[180:183], v[144:147], v[100:103]
    s_sub_u32 s54, s54, 1
    ds_read_b64_tr_b16 v[222:223], v236 offset:28672
    v_mfma_f32_16x16x32_bf16 v[104:107], v[152:155], v[148:151], v[104:107]
    s_cbranch_scc0 M_P_loop5
    ds_read_b64_tr_b16 v[224:225], v237 offset:24576
    v_mfma_f32_16x16x32_bf16 v[108:111], v[156:159], v[148:151], v[108:111]
    ds_read_b64_tr_b16 v[226:227], v237 offset:28672
    v_mfma_f32_16x16x32_bf16 v[112:115], v[160:163], v[148:151], v[112:115]
    ds_read_b64_tr_b16 v[228:229], v238 offset:24576
    v_mfma_f32_16x16x32_bf16 v[116:119], v[164:167], v[148:151], v[116:119]
    v_mfma_f32_16x16x32_bf16 v[120:123], v[168:171], v[148:151], v[120:123]
    ds_read_b64_tr_b16 v[230:231], v238 offset:28672
    v_mfma_f32_16x16x32_bf16 v[124:127], v[172:175], v[148:151], v[124:127]
    ds_read_b128 v[192:195], v232 offset:5120
    v_mfma_f32_16x16x32_bf16 v[128:131], v[176:179], v[148:151], v[128:131]
    ds_read_b128 v[196:199], v232 offset:7168
    v_mfma_f32_16x16x32_bf16 v[132:135], v[180:183], v[148:151], v[132:135]
    ds_read_b128 v[184:187], v232 offset:1024
    v_mfma_f32_16x16x32_bf16 v[8:11], v[152:155], v[136:139], v[8:11]
    v_mfma_f32_16x16x32_bf16 v[12:15], v[156:159], v[136:139], v[12:15]
    v_add_u32 v232, s52, v233
    v_mfma_f32_16x16x32_bf16 v[16:19], v[160:163], v[136:139], v[16:19]
    v_add_u32 v235, s52, v239
    v_mfma_f32_16x16x32_bf16 v[20:23], v[164:167], v[136:139], v[20:23]
    v_add_u32 v236, s52, v240
    v_mfma_f32_16x16x32_bf16 v[24:27], v[168:171], v[136:139], v[24:27]
    v_mfma_f32_16x16x32_bf16 v[28:31], v[172:175], v[136:139], v[28:31]
    v_add_u32 v237, s52, v241
    v_mfma_f32_16x16x32_bf16 v[32:35], v[176:179], v[136:139], v[32:35]
    v_add_u32 v238, s52, v242
    v_mfma_f32_16x16x32_bf16 v[36:39], v[180:183], v[136:139], v[36:39]
    s_waitcnt lgkmcnt(0)
    v_mfma_f32_16x16x32_bf16 v[40:43], v[200:203], v[188:191], v[40:43]
    s_barrier
    v_mfma_f32_16x16x32_bf16 v[44:47], v[204:207], v[188:191], v[44:47]
    ds_read_b128 v[140:143], v232 offset:2048
    v_mfma_f32_16x16x32_bf16 v[48:51], v[208:211], v[188:191], v[48:51]
    ds_read_b64_tr_b16 v[152:153], v235 offset:0
    v_mfma_f32_16x16x32_bf16 v[52:55], v[212:215], v[188:191], v[52:55]
    ds_read_b64_tr_b16 v[154:155], v235 offset:4096
    v_mfma_f32_16x16x32_bf16 v[56:59], v[216:219], v[188:191], v[56:59]
    v_mfma_f32_16x16x32_bf16 v[60:63], v[220:223], v[188:191], v[60:63]
    ds_read_b64_tr_b16 v[156:157], v236 offset:0
    v_mfma_f32_16x16x32_bf16 v[64:67], v[224:227], v[188:191], v[64:67]
    ds_read_b64_tr_b16 v[158:159], v236 offset:4096
    v_mfma_f32_16x16x32_bf16 v[68:71], v[228:231], v[188:191], v[68:71]
    ds_read_b64_tr_b16 v[160:161], v237 offset:0
    v_mfma_f32_16x16x32_bf16 v[72:75], v[200:203], v[192:195], v[72:75]
    v_mfma_f32_16x16x32_bf16 v[76:79], v[204:207], v[192:195], v[76:79]
    ds_read_b64_tr_b16 v[162:163], v237 offset:4096
    v_mfma_f32_16x16x32_bf16 v[80:83], v[208:211], v[192:195], v[80:83]
    ds_read_b64_tr_b16 v[164:165], v238 offset:0
    v_mfma_f32_16x16x32_bf16 v[84:87], v[212:215], v[192:195], v[84:87]
    ds_read_b64_tr_b16 v[166:167], v238 offset:4096
    v_mfma_f32_16x16x32_bf16 v[88:91], v[216:219], v[192:195], v[88:91]
    v_mfma_f32_16x16x32_bf16 v[92:95], v[220:223], v[192:195], v[92:95]
    ds_read_b64_tr_b16 v[168:169], v235 offset:16384
    v_mfma_f32_16x16x32_bf16 v[96:99], v[224:227], v[192:195], v[96:99]
    ds_read_b64_tr_b16 v[170:171], v235 offset:20480
    v_mfma_f32_16x16x32_bf16 v[100:103], v[228:231], v[192:195], v[100:103]
    ds_read_b64_tr_b16 v[172:173], v236 offset:16384
    v_mfma_f32_16x16x32_bf16 v[104:107], v[200:203], v[196:199], v[104:107]
    v_mfma_f32_16x16x32_bf16 v[108:111], v[204:207], v[196:199], v[108:111]
    ds_read_b64_tr_b16 v[174:175], v236 offset:20480
    v_mfma_f32_16x16x32_bf16 v[112:115], v[208:211], v[196:199], v[112:115]
    ds_read_b64_tr_b16 v[176:177], v237 offset:16384
    v_mfma_f32_16x16x32_bf16 v[116:119], v[212:215], v[196:199], v[116:119]
    ds_read_b64_tr_b16 v[178:179], v237 offset:20480
    v_mfma_f32_16x16x32_bf16 v[120:123], v[216:219], v[196:199], v[120:123]
    v_mfma_f32_16x16x32_bf16 v[124:127], v[220:223], v[196:199], v[124:127]
    ds_read_b64_tr_b16 v[180:181], v238 offset:16384
    v_mfma_f32_16x16x32_bf16 v[128:131], v[224:227], v[196:199], v[128:131]
    ds_read_b64_tr_b16 v[182:183], v238 offset:20480
    v_mfma_f32_16x16x32_bf16 v[132:135], v[228:231], v[196:199], v[132:135]
    ds_read_b128 v[144:147], v232 offset:4096
    v_mfma_f32_16x16x32_bf16 v[8:11], v[200:203], v[184:187], v[8:11]
    v_mfma_f32_16x16x32_bf16 v[12:15], v[204:207], v[184:187], v[12:15]
    v_mfma_f32_16x16x32_bf16 v[16:19], v[208:211], v[184:187], v[16:19]
    v_mfma_f32_16x16x32_bf16 v[20:23], v[212:215], v[184:187], v[20:23]
    v_mfma_f32_16x16x32_bf16 v[24:27], v[216:219], v[184:187], v[24:27]
    v_mfma_f32_16x16x32_bf16 v[28:31], v[220:223], v[184:187], v[28:31]
    v_mfma_f32_16x16x32_bf16 v[32:35], v[224:227], v[184:187], v[32:35]
    s_add_u32 s52, s52, 49152
    s_cmp_ge_u32 s52, 147456
    s_cselect_b32 s52, 0, s52
    v_mfma_f32_16x16x32_bf16 v[36:39], v[228:231], v[184:187], v[36:39]
    s_waitcnt lgkmcnt(0)
    v_mfma_f32_16x16x32_bf16 v[40:43], v[152:155], v[140:143], v[40:43]
    ds_read_b128 v[188:191], v232 offset:3072
    ds_read_b64_tr_b16 v[200:201], v235 offset:8192
    v_mfma_f32_16x16x32_bf16 v[44:47], v[156:159], v[140:143], v[44:47]
    ds_read_b64_tr_b16 v[202:203], v235 offset:12288
    v_mfma_f32_16x16x32_bf16 v[48:51], v[160:163], v[140:143], v[48:51]
    ds_read_b64_tr_b16 v[204:205], v236 offset:8192
    ds_read_b64_tr_b16 v[206:207], v236 offset:12288
    v_mfma_f32_16x16x32_bf16 v[52:55], v[164:167], v[140:143], v[52:55]
    ds_read_b64_tr_b16 v[208:209], v237 offset:8192
    v_mfma_f32_16x16x32_bf16 v[56:59], v[168:171], v[140:143], v[56:59]
    ds_read_b64_tr_b16 v[210:211], v237 offset:12288
    ds_read_b64_tr_b16 v[212:213], v238 offset:8192
    v_mfma_f32_16x16x32_bf16 v[60:63], v[172:175], v[140:143], v[60:63]
    ds_read_b64_tr_b16 v[214:215], v238 offset:12288
    v_mfma_f32_16x16x32_bf16 v[64:67], v[176:179], v[140:143], v[64:67]
    ds_read_b64_tr_b16 v[216:217], v235 offset:24576
    ds_read_b64_tr_b16 v[218:219], v235 offset:28672
    v_mfma_f32_16x16x32_bf16 v[68:71], v[180:183], v[140:143], v[68:71]
    ds_read_b64_tr_b16 v[220:221], v236 offset:24576
    v_mfma_f32_16x16x32_bf16 v[72:75], v[152:155], v[144:147], v[72:75]
    s_movk_i32 s54, 1
M_P_loop6:
    ds_read_b64_tr_b16 v[222:223], v236 offset:28672
    ds_read_b64_tr_b16 v[224:225], v237 offset:24576
    v_mfma_f32_16x16x32_bf16 v[76:79], v[156:159], v[144:147], v[76:79]
    ds_read_b64_tr_b16 v[226:227], v237 offset:28672
    v_mfma_f32_16x16x32_bf16 v[80:83], v[160:163], v[144:147], v[80:83]
    ds_read_b64_tr_b16 v[228:229], v238 offset:24576
    ds_read_b64_tr_b16 v[230:231], v238 offset:28672
    v_mfma_f32_16x16x32_bf16 v[84:87], v[164:167], v[144:147], v[84:87]
    ds_read_b128 v[192:195], v232 offset:5120
    v_mfma_f32_16x16x32_bf16 v[88:91], v[168:171], v[144:147], v[88:91]
    v_add_u32 v232, s52, v233
    v_add_u32 v235, s52, v239
    v_mfma_f32_16x16x32_bf16 v[92:95], v[172:175], v[144:147], v[92:95]
    v_add_u32 v236, s52, v240
    v_mfma_f32_16x16x32_bf16 v[96:99], v[176:179], v[144:147], v[96:99]
    v_add_u32 v237, s52, v241
    v_mfma_f32_16x16x32_bf16 v[100:103], v[180:183], v[144:147], v[100:103]
    v_add_u32 v238, s52, v242
    s_waitcnt lgkmcnt(0)
    v_mfma_f32_16x16x32_bf16 v[40:43], v[200:203], v[188:191], v[40:43]
    s_barrier
    v_mfma_f32_16x16x32_bf16 v[44:47], v[204:207], v[188:191], v[44:47]
    ds_read_b128 v[140:143], v232 offset:2048
    ds_read_b64_tr_b16 v[152:153], v235 offset:0
    v_mfma_f32_16x16x32_bf16 v[48:51], v[208:211], v[188:191], v[48:51]
    ds_read_b64_tr_b16 v[154:155], v235 offset:4096
    ds_read_b64_tr_b16 v[156:157], v236 offset:0
    v_mfma_f32_16x16x32_bf16 v[52:55], v[212:215], v[188:191], v[52:55]
    ds_read_b64_tr_b16 v[158:159], v236 offset:4096
    v_mfma_f32_16x16x32_bf16 v[56:59], v[216:219], v[188:191], v[56:59]
    ds_read_b64_tr_b16 v[160:161], v237 offset:0
    ds_read_b64_tr_b16 v[162:163], v237 offset:4096
    v_mfma_f32_16x16x32_bf16 v[60:63], v[220:223], v[188:191], v[60:63]
    ds_read_b64_tr_b16 v[164:165], v238 offset:0
    ds_read_b64_tr_b16 v[166:167], v238 offset:4096
    v_mfma_f32_16x16x32_bf16 v[64:67], v[224:227], v[188:191], v[64:67]
    ds_read_b64_tr_b16 v[168:169], v235 offset:16384
    v_mfma_f32_16x16x32_bf16 v[68:71], v[228:231], v[188:191], v[68:71]
    ds_read_b64_tr_b16 v[170:171], v235 offset:20480
    ds_read_b64_tr_b16 v[172:173], v236 offset:16384
    v_mfma_f32_16x16x32_bf16 v[72:75], v[200:203], v[192:195], v[72:75]
    ds_read_b64_tr_b16 v[174:175], v236 offset:20480
    ds_read_b64_tr_b16 v[176:177], v237 offset:16384
    v_mfma_f32_16x16x32_bf16 v[76:79], v[204:207], v[192:195], v[76:79]
    ds_read_b64_tr_b16 v[178:179], v237 offset:20480
    v_mfma_f32_16x16x32_bf16 v[80:83], v[208:211], v[192:195], v[80:83]
    ds_read_b64_tr_b16 v[180:181], v238 offset:16384
    ds_read_b64_tr_b16 v[182:183], v238 offset:20480
    v_mfma_f32_16x16x32_bf16 v[84:87], v[212:215], v[192:195], v[84:87]
    ds_read_b128 v[144:147], v232 offset:4096
    v_mfma_f32_16x16x32_bf16 v[88:91], v[216:219], v[192:195], v[88:91]
    v_mfma_f32_16x16x32_bf16 v[92:95], v[220:223], v[192:195], v[92:95]
    v_mfma_f32_16x16x32_bf16 v[96:99], v[224:227], v[192:195], v[96:99]
    s_add_u32 s52, s52, 49152
    s_cmp_ge_u32 s52, 147456
    s_cselect_b32 s52, 0, s52
    v_mfma_f32_16x16x32_bf16 v[100:103], v[228:231], v[192:195], v[100:103]
    s_waitcnt lgkmcnt(0)
    v_mfma_f32_16x16x32_bf16 v[40:43], v[152:155], v[140:143], v[40:43]
    ds_read_b128 v[188:191], v232 offset:3072
    ds_read_b64_tr_b16 v[200:201], v235 offset:8192
    v_mfma_f32_16x16x32_bf16 v[44:47], v[156:159], v[140:143], v[44:47]
    ds_read_b64_tr_b16 v[202:203], v235 offset:12288
    v_mfma_f32_16x16x32_bf16 v[48:51], v[160:163], v[140:143], v[48:51]
    ds_read_b64_tr_b16 v[204:205], v236 offset:8192
    ds_read_b64_tr_b16 v[206:207], v236 offset:12288
    v_mfma_f32_16x16x32_bf16 v[52:55], v[164:167], v[140:143], v[52:55]
    ds_read_b64_tr_b16 v[208:209], v237 offset:8192
    v_mfma_f32_16x16x32_bf16 v[56:59], v[168:171], v[140:143], v[56:59]
    ds_read_b64_tr_b16 v[210:211], v237 offset:12288
    ds_read_b64_tr_b16 v[212:213], v238 offset:8192
    v_mfma_f32_16x16x32_bf16 v[60:63], v[172:175], v[140:143], v[60:63]
    ds_read_b64_tr_b16 v[214:215], v238 offset:12288
    v_mfma_f32_16x16x32_bf16 v[64:67], v[176:179], v[140:143], v[64:67]
    ds_read_b64_tr_b16 v[216:217], v235 offset:24576
    ds_read_b64_tr_b16 v[218:219], v235 offset:28672
    v_mfma_f32_16x16x32_bf16 v[68:71], v[180:183], v[140:143], v[68:71]
    s_sub_u32 s54, s54, 1
    ds_read_b64_tr_b16 v[220:221], v236 offset:24576
    v_mfma_f32_16x16x32_bf16 v[72:75], v[152:155], v[144:147], v[72:75]
    s_cbranch_scc0 M_P_loop6
    ds_read_b64_tr_b16 v[222:223], v236 offset:28672
    ds_read_b64_tr_b16 v[224:225], v237 offset:24576
    v_mfma_f32_16x16x32_bf16 v[76:79], v[156:159], v[144:147], v[76:79]
    ds_read_b64_tr_b16 v[226:227], v237 offset:28672
    v_mfma_f32_16x16x32_bf16 v[80:83], v[160:163], v[144:147], v[80:83]
    ds_read_b64_tr_b16 v[228:229], v238 offset:24576
    ds_read_b64_tr_b16 v[230:231], v238 offset:28672
    v_mfma_f32_16x16x32_bf16 v[84:87], v[164:167], v[144:147], v[84:87]
    ds_read_b128 v[192:195], v232 offset:5120
    v_mfma_f32_16x16x32_bf16 v[88:91], v[168:171], v[144:147], v[88:91]
    v_mfma_f32_16x16x32_bf16 v[92:95], v[172:175], v[144:147], v[92:95]
    v_mfma_f32_16x16x32_bf16 v[96:99], v[176:179], v[144:147], v[96:99]
    v_mfma_f32_16x16x32_bf16 v[100:103], v[180:183], v[144:147], v[100:103]
    s_waitcnt lgkmcnt(0)
    v_mfma_f32_16x16x32_bf16 v[40:43], v[200:203], v[188:191], v[40:43]
    v_add_u32 v232, 49152, v233
    v_add_u32 v235, 49152, v239
    v_mfma_f32_16x16x32_bf16 v[44:47], v[204:207], v[188:191], v[44:47]
    v_add_u32 v236, 49152, v240
    v_add_u32 v237, 49152, v241
    v_mfma_f32_16x16x32_bf16 v[48:51], v[208:211], v[188:191], v[48:51]
    v_add_u32 v238, 49152, v242
    v_mfma_f32_16x16x32_bf16 v[52:55], v[212:215], v[188:191], v[52:55]
    ds_read_b128 v[148:151], v232 offset:6144
    ds_read_b64_tr_b16 v[152:153], v235 offset:0
    v_mfma_f32_16x16x32_bf16 v[56:59], v[216:219], v[188:191], v[56:59]
    ds_read_b64_tr_b16 v[154:155], v235 offset:4096
    v_mfma_f32_16x16x32_bf16 v[60:63], v[220:223], v[188:191], v[60:63]
    ds_read_b64_tr_b16 v[156:157], v236 offset:0
    ds_read_b64_tr_b16 v[158:159], v236 offset:4096
    v_mfma_f32_16x16x32_bf16 v[64:67], v[224:227], v[188:191], v[64:67]
    ds_read_b64_tr_b16 v[160:161], v237 offset:0
    v_mfma_f32_16x16x32_bf16 v[68:71], v[228:231], v[188:191], v[68:71]
    ds_read_b64_tr_b16 v[162:163], v237 offset:4096
    ds_read_b64_tr_b16 v[164:165], v238 offset:0
    v_mfma_f32_16x16x32_bf16 v[72:75], v[200:203], v[192:195], v[72:75]
    ds_read_b64_tr_b16 v[166:167], v238 offset:4096
    ds_read_b64_tr_b16 v[168:169], v235 offset:16384
    v_mfma_f32_16x16x32_bf16 v[76:79], v[204:207], v[192:195], v[76:79]
    ds_read_b64_tr_b16 v[170:171], v235 offset:20480
    v_mfma_f32_16x16x32_bf16 v[80:83], v[208:211], v[192:195], v[80:83]
    ds_read_b64_tr_b16 v[172:173], v236 offset:16384
    ds_read_b64_tr_b16 v[174:175], v236 offset:20480
    v_mfma_f32_16x16x32_bf16 v[84:87], v[212:215], v[192:195], v[84:87]
    ds_read_b64_tr_b16 v[176:177], v237 offset:16384
    v_cvt_pk_bf16_f32 v40, v40, v41
    v_cvt_pk_bf16_f32 v41, v42, v43
    v_mfma_f32_16x16x32_bf16 v[88:91], v[216:219], v[192:195], v[88:91]
    ds_read_b64_tr_b16 v[178:179], v237 offset:20480
    ds_read_b64_tr_b16 v[180:181], v238 offset:16384
    v_cvt_pk_bf16_f32 v42, v44, v45
    v_cvt_pk_bf16_f32 v43, v46, v47
    v_mfma_f32_16x16x32_bf16 v[92:95], v[220:223], v[192:195], v[92:95]
    ds_read_b64_tr_b16 v[182:183], v238 offset:20480
    buffer_store_dwordx4 v[40:43], v249, s[28:31], s73 offen offset:0 sc1
    v_cvt_pk_bf16_f32 v48, v48, v49
    v_mfma_f32_16x16x32_bf16 v[96:99], v[224:227], v[192:195], v[96:99]
    v_cvt_pk_bf16_f32 v49, v50, v51
    v_cvt_pk_bf16_f32 v50, v52, v53
    v_mfma_f32_16x16x32_bf16 v[100:103], v[228:231], v[192:195], v[100:103]
    v_cvt_pk_bf16_f32 v51, v54, v55
    buffer_store_dwordx4 v[48:51], v249, s[28:31], s73 offen offset:1024 sc1
    s_waitcnt lgkmcnt(14)
    v_mfma_f32_16x16x32_bf16 v[104:107], v[152:155], v[148:151], v[104:107]
    ds_read_b128 v[196:199], v232 offset:7168
    ds_read_b64_tr_b16 v[200:201], v235 offset:8192
    v_cvt_pk_bf16_f32 v56, v56, v57
    s_waitcnt lgkmcnt(14)
    v_mfma_f32_16x16x32_bf16 v[108:111], v[156:159], v[148:151], v[108:111]
    ds_read_b64_tr_b16 v[202:203], v235 offset:12288
    ds_read_b64_tr_b16 v[204:205], v236 offset:8192
    v_cvt_pk_bf16_f32 v57, v58, v59
    s_waitcnt lgkmcnt(14)
    v_mfma_f32_16x16x32_bf16 v[112:115], v[160:163], v[148:151], v[112:115]
    ds_read_b64_tr_b16 v[206:207], v236 offset:12288
    ds_read_b64_tr_b16 v[208:209], v237 offset:8192
    v_cvt_pk_bf16_f32 v58, v60, v61
    s_waitcnt lgkmcnt(14)
    v_mfma_f32_16x16x32_bf16 v[116:119], v[164:167], v[148:151], v[116:119]
    ds_read_b64_tr_b16 v[210:211], v237 offset:12288
    ds_read_b64_tr_b16 v[212:213], v238 offset:8192
    v_cvt_pk_bf16_f32 v59, v62, v63
    s_waitcnt lgkmcnt(14)
    v_mfma_f32_16x16x32_bf16 v[120:123], v[168:171], v[148:151], v[120:123]
    ds_read_b64_tr_b16 v[214:215], v238 offset:12288
    ds_read_b64_tr_b16 v[216:217], v235 offset:24576
    buffer_store_dwordx4 v[56:59], v249, s[28:31], s73 offen offset:2048 sc1
    s_waitcnt lgkmcnt(14)
    v_mfma_f32_16x16x32_bf16 v[124:127], v[172:175], v[148:151], v[124:127]
    ds_read_b64_tr_b16 v[218:219], v235 offset:28672
    ds_read_b64_tr_b16 v[220:221], v236 offset:24576
    v_cvt_pk_bf16_f32 v64, v64, v65
    s_waitcnt lgkmcnt(14)
    v_mfma_f32_16x16x32_bf16 v[128:131], v[176:179], v[148:151], v[128:131]
    ds_read_b64_tr_b16 v[222:223], v236 offset:28672
    ds_read_b64_tr_b16 v[224:225], v237 offset:24576
    v_cvt_pk_bf16_f32 v65, v66, v67
    s_waitcnt lgkmcnt(14)
    v_mfma_f32_16x16x32_bf16 v[132:135], v[180:183], v[148:151], v[132:135]
    ds_read_b64_tr_b16 v[226:227], v237 offset:28672
    ds_read_b64_tr_b16 v[228:229], v238 offset:24576
    ds_read_b64_tr_b16 v[230:231], v238 offset:28672
    v_cvt_pk_bf16_f32 v66, v68, v69
    s_waitcnt lgkmcnt(14)
    v_mfma_f32_16x16x32_bf16 v[104:107], v[200:203], v[196:199], v[104:107]
    v_add_u32 v232, 98304, v233
    v_add_u32 v235, 98304, v239
    v_cvt_pk_bf16_f32 v67, v70, v71
    s_waitcnt lgkmcnt(12)
    v_mfma_f32_16x16x32_bf16 v[108:111], v[204:207], v[196:199], v[108:111]
    v_add_u32 v236, 98304, v240
    v_add_u32 v237, 98304, v241
    v_add_u32 v238, 98304, v242
    buffer_store_dwordx4 v[64:67], v249, s[28:31], s73 offen offset:3072 sc1
    s_waitcnt lgkmcnt(10)
    v_mfma_f32_16x16x32_bf16 v[112:115], v[208:211], v[196:199], v[112:115]
    ds_read_b128 v[148:151], v232 offset:6144
    ds_read_b64_tr_b16 v[152:153], v235 offset:0
    ds_read_b64_tr_b16 v[154:155], v235 offset:4096
    v_cvt_pk_bf16_f32 v72, v72, v73
    s_waitcnt lgkmcnt(11)
    v_mfma_f32_16x16x32_bf16 v[116:119], v[212:215], v[196:199], v[116:119]
    ds_read_b64_tr_b16 v[156:157], v236 offset:0
    ds_read_b64_tr_b16 v[158:159], v236 offset:4096
    ds_read_b64_tr_b16 v[160:161], v237 offset:0
    v_cvt_pk_bf16_f32 v73, v74, v75
    s_waitcnt lgkmcnt(12)
    v_mfma_f32_16x16x32_bf16 v[120:123], v[216:219], v[196:199], v[120:123]
    ds_read_b64_tr_b16 v[162:163], v237 offset:4096
    ds_read_b64_tr_b16 v[164:165], v238 offset:0
    v_cvt_pk_bf16_f32 v74, v76, v77
    s_waitcnt lgkmcnt(12)
    v_mfma_f32_16x16x32_bf16 v[124:127], v[220:223], v[196:199], v[124:127]
    ds_read_b64_tr_b16 v[166:167], v238 offset:4096
    ds_read_b64_tr_b16 v[168:169], v235 offset:16384
    ds_read_b64_tr_b16 v[170:171], v235 offset:20480
    v_cvt_pk_bf16_f32 v75, v78, v79
    s_waitcnt lgkmcnt(13)
    v_mfma_f32_16x16x32_bf16 v[128:131], v[224:227], v[196:199], v[128:131]
    ds_read_b64_tr_b16 v[172:173], v236 offset:16384
    ds_read_b64_tr_b16 v[174:175], v236 offset:20480
    ds_read_b64_tr_b16 v[176:177], v237 offset:16384
    buffer_store_dwordx4 v[72:75], v249, s[28:31], s74 offen offset:0 sc1
    s_waitcnt lgkmcnt(14)
    v_mfma_f32_16x16x32_bf16 v[132:135], v[228:231], v[196:199], v[132:135]
    ds_read_b64_tr_b16 v[178:179], v237 offset:20480
    ds_read_b64_tr_b16 v[180:181], v238 offset:16384
    ds_read_b64_tr_b16 v[182:183], v238 offset:20480
    v_cvt_pk_bf16_f32 v80, v80, v81
    s_waitcnt lgkmcnt(14)
    v_mfma_f32_16x16x32_bf16 v[104:107], v[152:155], v[148:151], v[104:107]
    ds_read_b128 v[196:199], v232 offset:7168
    ds_read_b64_tr_b16 v[200:201], v235 offset:8192
    v_cvt_pk_bf16_f32 v81, v82, v83
    s_waitcnt lgkmcnt(14)
    v_mfma_f32_16x16x32_bf16 v[108:111], v[156:159], v[148:151], v[108:111]
    ds_read_b64_tr_b16 v[202:203], v235 offset:12288
    ds_read_b64_tr_b16 v[204:205], v236 offset:8192
    v_cvt_pk_bf16_f32 v82, v84, v85
    s_waitcnt lgkmcnt(14)
    v_mfma_f32_16x16x32_bf16 v[112:115], v[160:163], v[148:151], v[112:115]
    ds_read_b64_tr_b16 v[206:207], v236 offset:12288
    ds_read_b64_tr_b16 v[208:209], v237 offset:8192
    v_cvt_pk_bf16_f32 v83, v86, v87
    s_waitcnt lgkmcnt(14)
    v_mfma_f32_16x16x32_bf16 v[116:119], v[164:167], v[148:151], v[116:119]
    ds_read_b64_tr_b16 v[210:211], v237 offset:12288
    ds_read_b64_tr_b16 v[212:213], v238 offset:8192
    buffer_store_dwordx4 v[80:83], v249, s[28:31], s74 offen offset:1024 sc1
    s_waitcnt lgkmcnt(14)
    v_mfma_f32_16x16x32_bf16 v[120:123], v[168:171], v[148:151], v[120:123]
    ds_read_b64_tr_b16 v[214:215], v238 offset:12288
    ds_read_b64_tr_b16 v[216:217], v235 offset:24576
    v_cvt_pk_bf16_f32 v88, v88, v89
    s_waitcnt lgkmcnt(14)
    v_mfma_f32_16x16x32_bf16 v[124:127], v[172:175], v[148:151], v[124:127]
    ds_read_b64_tr_b16 v[218:219], v235 offset:28672
    ds_read_b64_tr_b16 v[220:221], v236 offset:24576
    v_cvt_pk_bf16_f32 v89, v90, v91
    s_waitcnt lgkmcnt(14)
    v_mfma_f32_16x16x32_bf16 v[128:131], v[176:179], v[148:151], v[128:131]
    ds_read_b64_tr_b16 v[222:223], v236 offset:28672
    ds_read_b64_tr_b16 v[224:225], v237 offset:24576
    v_cvt_pk_bf16_f32 v90, v92, v93
    s_waitcnt lgkmcnt(14)
    v_mfma_f32_16x16x32_bf16 v[132:135], v[180:183], v[148:151], v[132:135]
    ds_read_b64_tr_b16 v[226:227], v237 offset:28672
    ds_read_b64_tr_b16 v[228:229], v238 offset:24576
    ds_read_b64_tr_b16 v[230:231], v238 offset:28672
    v_cvt_pk_bf16_f32 v91, v94, v95
    s_waitcnt lgkmcnt(14)
    v_mfma_f32_16x16x32_bf16 v[104:107], v[200:203], v[196:199], v[104:107]
    v_add_u32 v232, 0, v233
    v_add_u32 v235, 0, v239
    buffer_store_dwordx4 v[88:91], v249, s[28:31], s74 offen offset:2048 sc1
    s_waitcnt lgkmcnt(12)
    v_mfma_f32_16x16x32_bf16 v[108:111], v[204:207], v[196:199], v[108:111]
    v_add_u32 v236, 0, v240
    v_add_u32 v237, 0, v241
    v_add_u32 v238, 0, v242
    v_cvt_pk_bf16_f32 v96, v96, v97
    s_waitcnt lgkmcnt(10)
    v_mfma_f32_16x16x32_bf16 v[112:115], v[208:211], v[196:199], v[112:115]
    ds_read_b128 v[148:151], v232 offset:6144
    ds_read_b64_tr_b16 v[152:153], v235 offset:0
    ds_read_b64_tr_b16 v[154:155], v235 offset:4096
    v_cvt_pk_bf16_f32 v97, v98, v99
    s_waitcnt lgkmcnt(11)
    v_mfma_f32_16x16x32_bf16 v[116:119], v[212:215], v[196:199], v[116:119]
    ds_read_b64_tr_b16 v[156:157], v236 offset:0
    ds_read_b64_tr_b16 v[158:159], v236 offset:4096
    ds_read_b64_tr_b16 v[160:161], v237 offset:0
    v_cvt_pk_bf16_f32 v98, v100, v101
    s_waitcnt lgkmcnt(12)
    v_mfma_f32_16x16x32_bf16 v[120:123], v[216:219], v[196:199], v[120:123]
    ds_read_b64_tr_b16 v[162:163], v237 offset:4096
    ds_read_b64_tr_b16 v[164:165], v238 offset:0
    v_cvt_pk_bf16_f32 v99, v102, v103
    s_waitcnt lgkmcnt(12)
    v_mfma_f32_16x16x32_bf16 v[124:127], v[220:223], v[196:199], v[124:127]
    ds_read_b64_tr_b16 v[166:167], v238 offset:4096
    ds_read_b64_tr_b16 v[168:169], v235 offset:16384
    ds_read_b64_tr_b16 v[170:171], v235 offset:20480
    buffer_store_dwordx4 v[96:99], v249, s[28:31], s74 offen offset:3072 sc1
    s_waitcnt lgkmcnt(13)
    v_mfma_f32_16x16x32_bf16 v[128:131], v[224:227], v[196:199], v[128:131]
    ds_read_b64_tr_b16 v[172:173], v236 offset:16384
    ds_read_b64_tr_b16 v[174:175], v236 offset:20480
    ds_read_b64_tr_b16 v[176:177], v237 offset:16384
    s_waitcnt lgkmcnt(14)
    v_mfma_f32_16x16x32_bf16 v[132:135], v[228:231], v[196:199], v[132:135]
    ds_read_b64_tr_b16 v[178:179], v237 offset:20480
    ds_read_b64_tr_b16 v[180:181], v238 offset:16384
    ds_read_b64_tr_b16 v[182:183], v238 offset:20480
    s_waitcnt lgkmcnt(14)
    v_mfma_f32_16x16x32_bf16 v[104:107], v[152:155], v[148:151], v[104:107]
    ds_read_b128 v[196:199], v232 offset:7168
    ds_read_b64_tr_b16 v[200:201], v235 offset:8192
    s_waitcnt lgkmcnt(14)
    v_mfma_f32_16x16x32_bf16 v[108:111], v[156:159], v[148:151], v[108:111]
    ds_read_b64_tr_b16 v[202:203], v235 offset:12288
    ds_read_b64_tr_b16 v[204:205], v236 offset:8192
    s_waitcnt lgkmcnt(14)
    v_mfma_f32_16x16x32_bf16 v[112:115], v[160:163], v[148:151], v[112:115]
    ds_read_b64_tr_b16 v[206:207], v236 offset:12288
    ds_read_b64_tr_b16 v[208:209], v237 offset:8192
    s_waitcnt lgkmcnt(14)
    v_mfma_f32_16x16x32_bf16 v[116:119], v[164:167], v[148:151], v[116:119]
    ds_read_b64_tr_b16 v[210:211], v237 offset:12288
    ds_read_b64_tr_b16 v[212:213], v238 offset:8192
    s_waitcnt lgkmcnt(14)
    v_mfma_f32_16x16x32_bf16 v[120:123], v[168:171], v[148:151], v[120:123]
    ds_read_b64_tr_b16 v[214:215], v238 offset:12288
    ds_read_b64_tr_b16 v[216:217], v235 offset:24576
    s_waitcnt lgkmcnt(14)
    v_mfma_f32_16x16x32_bf16 v[124:127], v[172:175], v[148:151], v[124:127]
    ds_read_b64_tr_b16 v[218:219], v235 offset:28672
    ds_read_b64_tr_b16 v[220:221], v236 offset:24576
    s_waitcnt lgkmcnt(14)
    v_mfma_f32_16x16x32_bf16 v[128:131], v[176:179], v[148:151], v[128:131]
    ds_read_b64_tr_b16 v[222:223], v236 offset:28672
    ds_read_b64_tr_b16 v[224:225], v237 offset:24576
    s_waitcnt lgkmcnt(14)
    v_mfma_f32_16x16x32_bf16 v[132:135], v[180:183], v[148:151], v[132:135]
    ds_read_b64_tr_b16 v[226:227], v237 offset:28672
    ds_read_b64_tr_b16 v[228:229], v238 offset:24576
    ds_read_b64_tr_b16 v[230:231], v238 offset:28672
    s_waitcnt lgkmcnt(14)
    v_mfma_f32_16x16x32_bf16 v[104:107], v[200:203], v[196:199], v[104:107]
    v_add_u32 v232, 49152, v233
    v_add_u32 v235, 49152, v239
    s_waitcnt lgkmcnt(12)
    v_mfma_f32_16x16x32_bf16 v[108:111], v[204:207], v[196:199], v[108:111]
    v_add_u32 v236, 49152, v240
    v_add_u32 v237, 49152, v241
    v_add_u32 v238, 49152, v242
    s_waitcnt lgkmcnt(10)
    v_mfma_f32_16x16x32_bf16 v[112:115], v[208:211], v[196:199], v[112:115]
    ds_read_b128 v[136:139], v232 offset:0
    ds_read_b64_tr_b16 v[152:153], v235 offset:0
    ds_read_b64_tr_b16 v[154:155], v235 offset:4096
    s_waitcnt lgkmcnt(11)
    v_mfma_f32_16x16x32_bf16 v[116:119], v[212:215], v[196:199], v[116:119]
    ds_read_b64_tr_b16 v[156:157], v236 offset:0
    ds_read_b64_tr_b16 v[158:159], v236 offset:4096
    ds_read_b64_tr_b16 v[160:161], v237 offset:0
    s_waitcnt lgkmcnt(12)
    v_mfma_f32_16x16x32_bf16 v[120:123], v[216:219], v[196:199], v[120:123]
    ds_read_b64_tr_b16 v[162:163], v237 offset:4096
    ds_read_b64_tr_b16 v[164:165], v238 offset:0
    s_waitcnt lgkmcnt(12)
    v_mfma_f32_16x16x32_bf16 v[124:127], v[220:223], v[196:199], v[124:127]
    ds_read_b64_tr_b16 v[166:167], v238 offset:4096
    ds_read_b64_tr_b16 v[168:169], v235 offset:16384
    ds_read_b64_tr_b16 v[170:171], v235 offset:20480
    s_waitcnt lgkmcnt(13)
    v_mfma_f32_16x16x32_bf16 v[128:131], v[224:227], v[196:199], v[128:131]
    ds_read_b64_tr_b16 v[172:173], v236 offset:16384
    ds_read_b64_tr_b16 v[174:175], v236 offset:20480
    ds_read_b64_tr_b16 v[176:177], v237 offset:16384
    s_waitcnt lgkmcnt(14)
    v_mfma_f32_16x16x32_bf16 v[132:135], v[228:231], v[196:199], v[132:135]
    ds_read_b64_tr_b16 v[178:179], v237 offset:20480
    ds_read_b64_tr_b16 v[180:181], v238 offset:16384
    ds_read_b64_tr_b16 v[182:183], v238 offset:20480
    s_waitcnt lgkmcnt(14)
    v_mfma_f32_16x16x32_bf16 v[8:11], v[152:155], v[136:139], v[8:11]
    ds_read_b128 v[184:187], v232 offset:1024
    ds_read_b64_tr_b16 v[200:201], v235 offset:8192
    v_cvt_pk_bf16_f32 v104, v104, v105
    v_cvt_pk_bf16_f32 v105, v106, v107
    s_waitcnt lgkmcnt(14)
    v_mfma_f32_16x16x32_bf16 v[12:15], v[156:159], v[136:139], v[12:15]
    ds_read_b64_tr_b16 v[202:203], v235 offset:12288
    ds_read_b64_tr_b16 v[204:205], v236 offset:8192
    v_cvt_pk_bf16_f32 v106, v108, v109
    v_cvt_pk_bf16_f32 v107, v110, v111
    s_waitcnt lgkmcnt(14)
    v_mfma_f32_16x16x32_bf16 v[16:19], v[160:163], v[136:139], v[16:19]
    ds_read_b64_tr_b16 v[206:207], v236 offset:12288
    ds_read_b64_tr_b16 v[208:209], v237 offset:8192
    buffer_store_dwordx4 v[104:107], v249, s[28:31], s75 offen offset:0 sc1
    v_cvt_pk_bf16_f32 v112, v112, v113
    s_waitcnt lgkmcnt(14)
    v_mfma_f32_16x16x32_bf16 v[20:23], v[164:167], v[136:139], v[20:23]
    ds_read_b64_tr_b16 v[210:211], v237 offset:12288
    ds_read_b64_tr_b16 v[212:213], v238 offset:8192
    v_cvt_pk_bf16_f32 v113, v114, v115
    v_cvt_pk_bf16_f32 v114, v116, v117
    s_waitcnt lgkmcnt(14)
    v_mfma_f32_16x16x32_bf16 v[24:27], v[168:171], v[136:139], v[24:27]
    ds_read_b64_tr_b16 v[214:215], v238 offset:12288
    ds_read_b64_tr_b16 v[216:217], v235 offset:24576
    v_cvt_pk_bf16_f32 v115, v118, v119
    buffer_store_dwordx4 v[112:115], v249, s[28:31], s75 offen offset:1024 sc1
    s_waitcnt lgkmcnt(14)
    v_mfma_f32_16x16x32_bf16 v[28:31], v[172:175], v[136:139], v[28:31]
    ds_read_b64_tr_b16 v[218:219], v235 offset:28672
    ds_read_b64_tr_b16 v[220:221], v236 offset:24576
    v_cvt_pk_bf16_f32 v120, v120, v121
    v_cvt_pk_bf16_f32 v121, v122, v123
    s_waitcnt lgkmcnt(14)
    v_mfma_f32_16x16x32_bf16 v[32:35], v[176:179], v[136:139], v[32:35]
    ds_read_b64_tr_b16 v[222:223], v236 offset:28672
    ds_read_b64_tr_b16 v[224:225], v237 offset:24576
    v_cvt_pk_bf16_f32 v122, v124, v125
    v_cvt_pk_bf16_f32 v123, v126, v127
    s_waitcnt lgkmcnt(14)
    v_mfma_f32_16x16x32_bf16 v[36:39], v[180:183], v[136:139], v[36:39]
    ds_read_b64_tr_b16 v[226:227], v237 offset:28672
    ds_read_b64_tr_b16 v[228:229], v238 offset:24576
    ds_read_b64_tr_b16 v[230:231], v238 offset:28672
    buffer_store_dwordx4 v[120:123], v249, s[28:31], s75 offen offset:2048 sc1
    v_cvt_pk_bf16_f32 v128, v128, v129
    s_waitcnt lgkmcnt(14)
    v_mfma_f32_16x16x32_bf16 v[8:11], v[200:203], v[184:187], v[8:11]
    v_add_u32 v232, 98304, v233
    v_add_u32 v235, 98304, v239
    v_cvt_pk_bf16_f32 v129, v130, v131
    v_cvt_pk_bf16_f32 v130, v132, v133
    s_waitcnt lgkmcnt(12)
    v_mfma_f32_16x16x32_bf16 v[12:15], v[204:207], v[184:187], v[12:15]
    v_add_u32 v236, 98304, v240
    v_add_u32 v237, 98304, v241
    v_add_u32 v238, 98304, v242
    v_cvt_pk_bf16_f32 v131, v134, v135
    buffer_store_dwordx4 v[128:131], v249, s[28:31], s75 offen offset:3072 sc1
    s_waitcnt lgkmcnt(10)
    v_mfma_f32_16x16x32_bf16 v[16:19], v[208:211], v[184:187], v[16:19]
    ds_read_b128 v[136:139], v232 offset:0
    ds_read_b64_tr_b16 v[152:153], v235 offset:0
    ds_read_b64_tr_b16 v[154:155], v235 offset:4096
    buffer_load_dwordx4 v[44:47], v248, s[28:31], 0 offen offset:0 sc1
    buffer_load_dwordx4 v[52:55], v248, s[28:31], 0 offen offset:1024 sc1
    s_waitcnt lgkmcnt(11)
    v_mfma_f32_16x16x32_bf16 v[20:23], v[212:215], v[184:187], v[20:23]
    ds_read_b64_tr_b16 v[156:157], v236 offset:0
    ds_read_b64_tr_b16 v[158:159], v236 offset:4096
    ds_read_b64_tr_b16 v[160:161], v237 offset:0
    buffer_load_dwordx4 v[60:63], v248, s[28:31], s83 offen offset:0 sc1
    buffer_load_dwordx4 v[68:71], v248, s[28:31], s83 offen offset:1024 sc1
    s_waitcnt lgkmcnt(12)
    v_mfma_f32_16x16x32_bf16 v[24:27], v[216:219], v[184:187], v[24:27]
    ds_read_b64_tr_b16 v[162:163], v237 offset:4096
    ds_read_b64_tr_b16 v[164:165], v238 offset:0
    buffer_load_dwordx4 v[76:79], v247, s[28:31], 0 offen offset:0 sc1
    buffer_load_dwordx4 v[84:87], v247, s[28:31], 0 offen offset:64 sc1
    s_waitcnt lgkmcnt(12)
    v_mfma_f32_16x16x32_bf16 v[28:31], v[220:223], v[184:187], v[28:31]
    ds_read_b64_tr_b16 v[166:167], v238 offset:4096
    ds_read_b64_tr_b16 v[168:169], v235 offset:16384
    ds_read_b64_tr_b16 v[170:171], v235 offset:20480
    buffer_load_dwordx4 v[92:95], v247, s[28:31], 0 offen offset:128 sc1
    buffer_load_dwordx4 v[100:103], v247, s[28:31], 0 offen offset:192 sc1
    s_waitcnt lgkmcnt(13)
    v_mfma_f32_16x16x32_bf16 v[32:35], v[224:227], v[184:187], v[32:35]
    ds_read_b64_tr_b16 v[172:173], v236 offset:16384
    ds_read_b64_tr_b16 v[174:175], v236 offset:20480
    ds_read_b64_tr_b16 v[176:177], v237 offset:16384
    buffer_load_dwordx4 v[108:111], v247, s[28:31], 0 offen offset:512 sc1
    buffer_load_dwordx4 v[116:119], v247, s[28:31], 0 offen offset:576 sc1
    s_waitcnt lgkmcnt(14)
    v_mfma_f32_16x16x32_bf16 v[36:39], v[228:231], v[184:187], v[36:39]
    ds_read_b64_tr_b16 v[178:179], v237 offset:20480
    ds_read_b64_tr_b16 v[180:181], v238 offset:16384
    ds_read_b64_tr_b16 v[182:183], v238 offset:20480
    buffer_load_dwordx4 v[124:127], v247, s[28:31], 0 offen offset:640 sc1
    buffer_load_dwordx4 v[132:135], v247, s[28:31], 0 offen offset:704 sc1
    s_waitcnt lgkmcnt(14)
    v_mfma_f32_16x16x32_bf16 v[8:11], v[152:155], v[136:139], v[8:11]
    ds_read_b128 v[184:187], v232 offset:1024
    ds_read_b64_tr_b16 v[200:201], v235 offset:8192
    s_waitcnt lgkmcnt(14)
    v_mfma_f32_16x16x32_bf16 v[12:15], v[156:159], v[136:139], v[12:15]
    ds_read_b64_tr_b16 v[202:203], v235 offset:12288
    ds_read_b64_tr_b16 v[204:205], v236 offset:8192
    s_waitcnt lgkmcnt(14)
    v_mfma_f32_16x16x32_bf16 v[16:19], v[160:163], v[136:139], v[16:19]
    ds_read_b64_tr_b16 v[206:207], v236 offset:12288
    ds_read_b64_tr_b16 v[208:209], v237 offset:8192
    s_waitcnt lgkmcnt(14)
    v_mfma_f32_16x16x32_bf16 v[20:23], v[164:167], v[136:139], v[20:23]
    ds_read_b64_tr_b16 v[210:211], v237 offset:12288
    ds_read_b64_tr_b16 v[212:213], v238 offset:8192
    s_waitcnt lgkmcnt(14)
    v_mfma_f32_16x16x32_bf16 v[24:27], v[168:171], v[136:139], v[24:27]
    ds_read_b64_tr_b16 v[214:215], v238 offset:12288
    ds_read_b64_tr_b16 v[216:217], v235 offset:24576
    s_waitcnt lgkmcnt(14)
    v_mfma_f32_16x16x32_bf16 v[28:31], v[172:175], v[136:139], v[28:31]
    ds_read_b64_tr_b16 v[218:219], v235 offset:28672
    ds_read_b64_tr_b16 v[220:221], v236 offset:24576
    s_waitcnt lgkmcnt(14)
    v_mfma_f32_16x16x32_bf16 v[32:35], v[176:179], v[136:139], v[32:35]
    ds_read_b64_tr_b16 v[222:223], v236 offset:28672
    ds_read_b64_tr_b16 v[224:225], v237 offset:24576
    s_waitcnt lgkmcnt(14)
    v_mfma_f32_16x16x32_bf16 v[36:39], v[180:183], v[136:139], v[36:39]
    ds_read_b64_tr_b16 v[226:227], v237 offset:28672
    ds_read_b64_tr_b16 v[228:229], v238 offset:24576
    ds_read_b64_tr_b16 v[230:231], v238 offset:28672
    s_waitcnt lgkmcnt(14)
    v_mfma_f32_16x16x32_bf16 v[8:11], v[200:203], v[184:187], v[8:11]
    v_add_u32 v232, 0, v233
    v_add_u32 v235, 0, v239
    s_waitcnt lgkmcnt(12)
    v_mfma_f32_16x16x32_bf16 v[12:15], v[204:207], v[184:187], v[12:15]
    v_add_u32 v236, 0, v240
    v_add_u32 v237, 0, v241
    v_add_u32 v238, 0, v242
    s_waitcnt lgkmcnt(10)
    v_mfma_f32_16x16x32_bf16 v[16:19], v[208:211], v[184:187], v[16:19]
    ds_read_b128 v[136:139], v232 offset:0
    ds_read_b64_tr_b16 v[152:153], v235 offset:0
    ds_read_b64_tr_b16 v[154:155], v235 offset:4096
    s_waitcnt lgkmcnt(11)
    v_mfma_f32_16x16x32_bf16 v[20:23], v[212:215], v[184:187], v[20:23]
    ds_read_b64_tr_b16 v[156:157], v236 offset:0
    ds_read_b64_tr_b16 v[158:159], v236 offset:4096
    ds_read_b64_tr_b16 v[160:161], v237 offset:0
    s_waitcnt lgkmcnt(12)
    v_mfma_f32_16x16x32_bf16 v[24:27], v[216:219], v[184:187], v[24:27]
    ds_read_b64_tr_b16 v[162:163], v237 offset:4096
    ds_read_b64_tr_b16 v[164:165], v238 offset:0
    s_waitcnt lgkmcnt(12)
    v_mfma_f32_16x16x32_bf16 v[28:31], v[220:223], v[184:187], v[28:31]
    ds_read_b64_tr_b16 v[166:167], v238 offset:4096
    ds_read_b64_tr_b16 v[168:169], v235 offset:16384
    ds_read_b64_tr_b16 v[170:171], v235 offset:20480
    s_waitcnt lgkmcnt(13)
    v_mfma_f32_16x16x32_bf16 v[32:35], v[224:227], v[184:187], v[32:35]
    ds_read_b64_tr_b16 v[172:173], v236 offset:16384
    ds_read_b64_tr_b16 v[174:175], v236 offset:20480
    ds_read_b64_tr_b16 v[176:177], v237 offset:16384
    s_waitcnt lgkmcnt(14)
    v_mfma_f32_16x16x32_bf16 v[36:39], v[228:231], v[184:187], v[36:39]
    ds_read_b64_tr_b16 v[178:179], v237 offset:20480
    ds_read_b64_tr_b16 v[180:181], v238 offset:16384
    ds_read_b64_tr_b16 v[182:183], v238 offset:20480
    s_waitcnt lgkmcnt(14)
    v_mfma_f32_16x16x32_bf16 v[8:11], v[152:155], v[136:139], v[8:11]
    ds_read_b128 v[184:187], v232 offset:1024
    ds_read_b64_tr_b16 v[200:201], v235 offset:8192
    s_waitcnt lgkmcnt(14)
    v_mfma_f32_16x16x32_bf16 v[12:15], v[156:159], v[136:139], v[12:15]
    ds_read_b64_tr_b16 v[202:203], v235 offset:12288
    ds_read_b64_tr_b16 v[204:205], v236 offset:8192
    s_waitcnt lgkmcnt(14)
    v_mfma_f32_16x16x32_bf16 v[16:19], v[160:163], v[136:139], v[16:19]
    ds_read_b64_tr_b16 v[206:207], v236 offset:12288
    ds_read_b64_tr_b16 v[208:209], v237 offset:8192
    s_waitcnt lgkmcnt(14)
    v_mfma_f32_16x16x32_bf16 v[20:23], v[164:167], v[136:139], v[20:23]
    ds_read_b64_tr_b16 v[210:211], v237 offset:12288
    ds_read_b64_tr_b16 v[212:213], v238 offset:8192
    s_waitcnt lgkmcnt(14)
    v_mfma_f32_16x16x32_bf16 v[24:27], v[168:171], v[136:139], v[24:27]
    ds_read_b64_tr_b16 v[214:215], v238 offset:12288
    ds_read_b64_tr_b16 v[216:217], v235 offset:24576
    s_waitcnt lgkmcnt(14)
    v_mfma_f32_16x16x32_bf16 v[28:31], v[172:175], v[136:139], v[28:31]
    ds_read_b64_tr_b16 v[218:219], v235 offset:28672
    ds_read_b64_tr_b16 v[220:221], v236 offset:24576
    s_waitcnt lgkmcnt(14)
    v_mfma_f32_16x16x32_bf16 v[32:35], v[176:179], v[136:139], v[32:35]
    ds_read_b64_tr_b16 v[222:223], v236 offset:28672
    ds_read_b64_tr_b16 v[224:225], v237 offset:24576
    s_waitcnt lgkmcnt(14)
    v_mfma_f32_16x16x32_bf16 v[36:39], v[180:183], v[136:139], v[36:39]
    ds_read_b64_tr_b16 v[226:227], v237 offset:28672
    ds_read_b64_tr_b16 v[228:229], v238 offset:24576
    ds_read_b64_tr_b16 v[230:231], v238 offset:28672
    s_waitcnt lgkmcnt(14)
    v_mfma_f32_16x16x32_bf16 v[8:11], v[200:203], v[184:187], v[8:11]
    s_waitcnt lgkmcnt(12)
    v_mfma_f32_16x16x32_bf16 v[12:15], v[204:207], v[184:187], v[12:15]
    s_waitcnt lgkmcnt(10)
    v_mfma_f32_16x16x32_bf16 v[16:19], v[208:211], v[184:187], v[16:19]
    s_waitcnt lgkmcnt(8)
    v_mfma_f32_16x16x32_bf16 v[20:23], v[212:215], v[184:187], v[20:23]
    s_waitcnt lgkmcnt(6)
    v_mfma_f32_16x16x32_bf16 v[24:27], v[216:219], v[184:187], v[24:27]
    s_waitcnt lgkmcnt(4)
    v_mfma_f32_16x16x32_bf16 v[28:31], v[220:223], v[184:187], v[28:31]
    s_waitcnt lgkmcnt(2)
    v_mfma_f32_16x16x32_bf16 v[32:35], v[224:227], v[184:187], v[32:35]
    s_waitcnt lgkmcnt(0)
    v_mfma_f32_16x16x32_bf16 v[36:39], v[228:231], v[184:187], v[36:39]
    s_waitcnt vmcnt(20)
    s_atomic_swap s0, s[26:27], s77
    s_waitcnt vmcnt(16)
    s_atomic_swap s0, s[26:27], s78
    s_waitcnt vmcnt(12)
    s_atomic_swap s0, s[26:27], s79
    s_mov_b32 s3, 0x40000
    s_mov_b32 s88, 0
M_fchk:
    s_load_dword s84, s[62:63], 0 glc
    s_load_dword s85, s[62:63], 128 glc
    s_load_dword s86, s[62:63], 256 glc
    s_sub_u32 s3, s3, 1
    s_cbranch_scc1 M_fgo
    s_waitcnt lgkmcnt(0)
    s_cmp_lg_u32 s84, s0
    s_cbranch_scc1 M_fn0
    s_bitcmp1_b32 s88, 0
    s_cbranch_scc1 M_fn0
    s_bitset1_b32 s88, 0
    buffer_load_dwordx4 v[184:187], v249, s[28:31], s80 offen offset:0 sc1
    buffer_load_dwordx4 v[196:199], v249, s[28:31], s80 offen offset:1024 sc1
    buffer_load_dwordx4 v[208:211], v249, s[28:31], s80 offen offset:2048 sc1
    buffer_load_dwordx4 v[220:223], v249, s[28:31], s80 offen offset:3072 sc1
M_fn0:
    s_cmp_lg_u32 s85, s0
    s_cbranch_scc1 M_fn1
    s_bitcmp1_b32 s88, 1
    s_cbranch_scc1 M_fn1
    s_bitset1_b32 s88, 1
    buffer_load_dwordx4 v[188:191], v249, s[28:31], s81 offen offset:0 sc1
    buffer_load_dwordx4 v[200:203], v249, s[28:31], s81 offen offset:1024 sc1
    buffer_load_dwordx4 v[212:215], v249, s[28:31], s81 offen offset:2048 sc1
    buffer_load_dwordx4 v[224:227], v249, s[28:31], s81 offen offset:3072 sc1
M_fn1:
    s_cmp_lg_u32 s86, s0
    s_cbranch_scc1 M_fn2
    s_bitcmp1_b32 s88, 2
    s_cbranch_scc1 M_fn2
    s_bitset1_b32 s88, 2
    buffer_load_dwordx4 v[192:195], v249, s[28:31], s82 offen offset:0 sc1
    buffer_load_dwordx4 v[204:207], v249, s[28:31], s82 offen offset:1024 sc1
    buffer_load_dwordx4 v[216:219], v249, s[28:31], s82 offen offset:2048 sc1
    buffer_load_dwordx4 v[228:231], v249, s[28:31], s82 offen offset:3072 sc1
M_fn2:
    s_cmp_lg_u32 s88, 7
    s_cbranch_scc1 M_fchk
M_fgo:
    s_movk_i32 s88, 16384
    s_waitcnt vmcnt(3)
    v_lshlrev_b32 v160, 16, v44
    v_and_b32 v161, 0xffff0000, v44
    v_lshlrev_b32 v162, 16, v45
    v_and_b32 v163, 0xffff0000, v45
    v_lshlrev_b32 v164, 16, v46
    v_and_b32 v165, 0xffff0000, v46
    v_lshlrev_b32 v166, 16, v47
    v_and_b32 v167, 0xffff0000, v47
    v_lshlrev_b32 v136, 16, v184
    v_and_b32 v137, 0xffff0000, v184
    v_lshlrev_b32 v138, 16, v185
    v_and_b32 v139, 0xffff0000, v185
    v_lshlrev_b32 v140, 16, v186
    v_and_b32 v141, 0xffff0000, v186
    v_lshlrev_b32 v142, 16, v187
    v_and_b32 v143, 0xffff0000, v187
    v_lshlrev_b32 v144, 16, v188
    v_and_b32 v145, 0xffff0000, v188
    v_lshlrev_b32 v146, 16, v189
    v_and_b32 v147, 0xffff0000, v189
    v_lshlrev_b32 v148, 16, v190
    v_and_b32 v149, 0xffff0000, v190
    v_lshlrev_b32 v150, 16, v191
    v_and_b32 v151, 0xffff0000, v191
    v_lshlrev_b32 v152, 16, v192
    v_and_b32 v153, 0xffff0000, v192
    v_lshlrev_b32 v154, 16, v193
    v_and_b32 v155, 0xffff0000, v193
    v_lshlrev_b32 v156, 16, v194
    v_and_b32 v157, 0xffff0000, v194
    v_lshlrev_b32 v158, 16, v195
    v_and_b32 v159, 0xffff0000, v195
    v_pk_add_f32 v[8:9], v[8:9], v[136:137]
    v_pk_add_f32 v[144:145], v[144:145], v[152:153]
    v_pk_add_f32 v[10:11], v[10:11], v[138:139]
    v_pk_add_f32 v[146:147], v[146:147], v[154:155]
    v_pk_add_f32 v[12:13], v[12:13], v[140:141]
    v_pk_add_f32 v[148:149], v[148:149], v[156:157]
    v_pk_add_f32 v[14:15], v[14:15], v[142:143]
    v_pk_add_f32 v[150:151], v[150:151], v[158:159]
    v_pk_add_f32 v[8:9], v[8:9], v[144:145]
    v_pk_add_f32 v[10:11], v[10:11], v[146:147]
    v_pk_add_f32 v[12:13], v[12:13], v[148:149]
    v_pk_add_f32 v[14:15], v[14:15], v[150:151]
    v_pk_fma_f32 v[8:9], v[8:9], v[76:77], v[160:161]
    v_pk_fma_f32 v[10:11], v[10:11], v[78:79], v[162:163]
    v_pk_fma_f32 v[12:13], v[12:13], v[84:85], v[164:165]
    v_pk_fma_f32 v[14:15], v[14:15], v[86:87], v[166:167]
    v_cvt_pk_bf16_f32 v44, v8, v9
    v_cvt_pk_bf16_f32 v45, v10, v11
    v_cvt_pk_bf16_f32 v46, v12, v13
    v_cvt_pk_bf16_f32 v47, v14, v15
    s_nop 0
    v_permlane16_swap_b32 v44, v46
    v_permlane16_swap_b32 v45, v47
    buffer_store_dwordx4 v[44:47], v246, s[40:43], 0 offen offset:0
    s_waitcnt vmcnt(3)
    v_lshlrev_b32 v160, 16, v52
    v_and_b32 v161, 0xffff0000, v52
    v_lshlrev_b32 v162, 16, v53
    v_and_b32 v163, 0xffff0000, v53
    v_lshlrev_b32 v164, 16, v54
    v_and_b32 v165, 0xffff0000, v54
    v_lshlrev_b32 v166, 16, v55
    v_and_b32 v167, 0xffff0000, v55
    v_lshlrev_b32 v136, 16, v196
    v_and_b32 v137, 0xffff0000, v196
    v_lshlrev_b32 v138, 16, v197
    v_and_b32 v139, 0xffff0000, v197
    v_lshlrev_b32 v140, 16, v198
    v_and_b32 v141, 0xffff0000, v198
    v_lshlrev_b32 v142, 16, v199
    v_and_b32 v143, 0xffff0000, v199
    v_lshlrev_b32 v144, 16, v200
    v_and_b32 v145, 0xffff0000, v200
    v_lshlrev_b32 v146, 16, v201
    v_and_b32 v147, 0xffff0000, v201
    v_lshlrev_b32 v148, 16, v202
    v_and_b32 v149, 0xffff0000, v202
    v_lshlrev_b32 v150, 16, v203
    v_and_b32 v151, 0xffff0000, v203
    v_lshlrev_b32 v152, 16, v204
    v_and_b32 v153, 0xffff0000, v204
    v_lshlrev_b32 v154, 16, v205
    v_and_b32 v155, 0xffff0000, v205
    v_lshlrev_b32 v156, 16, v206
    v_and_b32 v157, 0xffff0000, v206
    v_lshlrev_b32 v158, 16, v207
    v_and_b32 v159, 0xffff0000, v207
    v_pk_add_f32 v[16:17], v[16:17], v[136:137]
    v_pk_add_f32 v[144:145], v[144:145], v[152:153]
    v_pk_add_f32 v[18:19], v[18:19], v[138:139]
    v_pk_add_f32 v[146:147], v[146:147], v[154:155]
    v_pk_add_f32 v[20:21], v[20:21], v[140:141]
    v_pk_add_f32 v[148:149], v[148:149], v[156:157]
    v_pk_add_f32 v[22:23], v[22:23], v[142:143]
    v_pk_add_f32 v[150:151], v[150:151], v[158:159]
    v_pk_add_f32 v[16:17], v[16:17], v[144:145]
    v_pk_add_f32 v[18:19], v[18:19], v[146:147]
    v_pk_add_f32 v[20:21], v[20:21], v[148:149]
    v_pk_add_f32 v[22:23], v[22:23], v[150:151]
    v_pk_fma_f32 v[16:17], v[16:17], v[92:93], v[160:161]
    v_pk_fma_f32 v[18:19], v[18:19], v[94:95], v[162:163]
    v_pk_fma_f32 v[20:21], v[20:21], v[100:101], v[164:165]
    v_pk_fma_f32 v[22:23], v[22:23], v[102:103], v[166:167]
    v_cvt_pk_bf16_f32 v52, v16, v17
    v_cvt_pk_bf16_f32 v53, v18, v19
    v_cvt_pk_bf16_f32 v54, v20, v21
    v_cvt_pk_bf16_f32 v55, v22, v23
    s_nop 0
    v_permlane16_swap_b32 v52, v54
    v_permlane16_swap_b32 v53, v55
    buffer_store_dwordx4 v[52:55], v246, s[40:43], 0 offen offset:64
    s_waitcnt vmcnt(3)
    v_lshlrev_b32 v160, 16, v60
    v_and_b32 v161, 0xffff0000, v60
    v_lshlrev_b32 v162, 16, v61
    v_and_b32 v163, 0xffff0000, v61
    v_lshlrev_b32 v164, 16, v62
    v_and_b32 v165, 0xffff0000, v62
    v_lshlrev_b32 v166, 16, v63
    v_and_b32 v167, 0xffff0000, v63
    v_lshlrev_b32 v136, 16, v208
    v_and_b32 v137, 0xffff0000, v208
    v_lshlrev_b32 v138, 16, v209
    v_and_b32 v139, 0xffff0000, v209
    v_lshlrev_b32 v140, 16, v210
    v_and_b32 v141, 0xffff0000, v210
    v_lshlrev_b32 v142, 16, v211
    v_and_b32 v143, 0xffff0000, v211
    v_lshlrev_b32 v144, 16, v212
    v_and_b32 v145, 0xffff0000, v212
    v_lshlrev_b32 v146, 16, v213
    v_and_b32 v147, 0xffff0000, v213
    v_lshlrev_b32 v148, 16, v214
    v_and_b32 v149, 0xffff0000, v214
    v_lshlrev_b32 v150, 16, v215
    v_and_b32 v151, 0xffff0000, v215
    v_lshlrev_b32 v152, 16, v216
    v_and_b32 v153, 0xffff0000, v216
    v_lshlrev_b32 v154, 16, v217
    v_and_b32 v155, 0xffff0000, v217
    v_lshlrev_b32 v156, 16, v218
    v_and_b32 v157, 0xffff0000, v218
    v_lshlrev_b32 v158, 16, v219
    v_and_b32 v159, 0xffff0000, v219
    v_pk_add_f32 v[24:25], v[24:25], v[136:137]
    v_pk_add_f32 v[144:145], v[144:145], v[152:153]
    v_pk_add_f32 v[26:27], v[26:27], v[138:139]
    v_pk_add_f32 v[146:147], v[146:147], v[154:155]
    v_pk_add_f32 v[28:29], v[28:29], v[140:141]
    v_pk_add_f32 v[148:149], v[148:149], v[156:157]
    v_pk_add_f32 v[30:31], v[30:31], v[142:143]
    v_pk_add_f32 v[150:151], v[150:151], v[158:159]
    v_pk_add_f32 v[24:25], v[24:25], v[144:145]
    v_pk_add_f32 v[26:27], v[26:27], v[146:147]
    v_pk_add_f32 v[28:29], v[28:29], v[148:149]
    v_pk_add_f32 v[30:31], v[30:31], v[150:151]
    v_pk_fma_f32 v[24:25], v[24:25], v[108:109], v[160:161]
    v_pk_fma_f32 v[26:27], v[26:27], v[110:111], v[162:163]
    v_pk_fma_f32 v[28:29], v[28:29], v[116:117], v[164:165]
    v_pk_fma_f32 v[30:31], v[30:31], v[118:119], v[166:167]
    v_cvt_pk_bf16_f32 v60, v24, v25
    v_cvt_pk_bf16_f32 v61, v26, v27
    v_cvt_pk_bf16_f32 v62, v28, v29
    v_cvt_pk_bf16_f32 v63, v30, v31
    s_nop 0
    v_permlane16_swap_b32 v60, v62
    v_permlane16_swap_b32 v61, v63
    buffer_store_dwordx4 v[60:63], v246, s[40:43], 0 offen offset:256
    s_waitcnt vmcnt(3)
    v_lshlrev_b32 v160, 16, v68
    v_and_b32 v161, 0xffff0000, v68
    v_lshlrev_b32 v162, 16, v69
    v_and_b32 v163, 0xffff0000, v69
    v_lshlrev_b32 v164, 16, v70
    v_and_b32 v165, 0xffff0000, v70
    v_lshlrev_b32 v166, 16, v71
    v_and_b32 v167, 0xffff0000, v71
    v_lshlrev_b32 v136, 16, v220
    v_and_b32 v137, 0xffff0000, v220
    v_lshlrev_b32 v138, 16, v221
    v_and_b32 v139, 0xffff0000, v221
    v_lshlrev_b32 v140, 16, v222
    v_and_b32 v141, 0xffff0000, v222
    v_lshlrev_b32 v142, 16, v223
    v_and_b32 v143, 0xffff0000, v223
    v_lshlrev_b32 v144, 16, v224
    v_and_b32 v145, 0xffff0000, v224
    v_lshlrev_b32 v146, 16, v225
    v_and_b32 v147, 0xffff0000, v225
    v_lshlrev_b32 v148, 16, v226
    v_and_b32 v149, 0xffff0000, v226
    v_lshlrev_b32 v150, 16, v227
    v_and_b32 v151, 0xffff0000, v227
    v_lshlrev_b32 v152, 16, v228
    v_and_b32 v153, 0xffff0000, v228
    v_lshlrev_b32 v154, 16, v229
    v_and_b32 v155, 0xffff0000, v229
    v_lshlrev_b32 v156, 16, v230
    v_and_b32 v157, 0xffff0000, v230
    v_lshlrev_b32 v158, 16, v231
    v_and_b32 v159, 0xffff0000, v231
    v_pk_add_f32 v[32:33], v[32:33], v[136:137]
    v_pk_add_f32 v[144:145], v[144:145], v[152:153]
    v_pk_add_f32 v[34:35], v[34:35], v[138:139]
    v_pk_add_f32 v[146:147], v[146:147], v[154:155]
    v_pk_add_f32 v[36:37], v[36:37], v[140:141]
    v_pk_add_f32 v[148:149], v[148:149], v[156:157]
    v_pk_add_f32 v[38:39], v[38:39], v[142:143]
    v_pk_add_f32 v[150:151], v[150:151], v[158:159]
    v_pk_add_f32 v[32:33], v[32:33], v[144:145]
    v_pk_add_f32 v[34:35], v[34:35], v[146:147]
    v_pk_add_f32 v[36:37], v[36:37], v[148:149]
    v_pk_add_f32 v[38:39], v[38:39], v[150:151]
    v_pk_fma_f32 v[32:33], v[32:33], v[124:125], v[160:161]
    v_pk_fma_f32 v[34:35], v[34:35], v[126:127], v[162:163]
    v_pk_fma_f32 v[36:37], v[36:37], v[132:133], v[164:165]
    v_pk_fma_f32 v[38:39], v[38:39], v[134:135], v[166:167]
    v_cvt_pk_bf16_f32 v68, v32, v33
    v_cvt_pk_bf16_f32 v69, v34, v35
    v_cvt_pk_bf16_f32 v70, v36, v37
    v_cvt_pk_bf16_f32 v71, v38, v39
    s_nop 0
    v_permlane16_swap_b32 v68, v70
    v_permlane16_swap_b32 v69, v71
    buffer_store_dwordx4 v[68:71], v246, s[40:43], 0 offen offset:320
    s_branch M_fin
M_Pidle:
    s_nop 7
    s_barrier
    s_lshl_b32 s70, s48, 12
    s_lshl_b32 s64, s47, 3
    s_lshl_b32 s65, s45, 2
    s_add_u32 s64, s64, s65
    s_mul_i32 s64, s64, 114688
    s_add_u32 s64, s64, s70
    s_lshl_b32 s65, s46, 11
    s_add_u32 s64, s64, s65
    s_add_u32 s64, s64, 0x1500000
    v_lshl_add_u32 v198, v1, 4, s64
    v_mul_f32 v24, v8, v24
    v_exp_f32 v216, -v8
    v_mul_f32 v25, v9, v25
    v_exp_f32 v217, -v9
    v_mul_f32 v26, v10, v26
    v_exp_f32 v218, -v10
    v_mul_f32 v27, v11, v27
    v_exp_f32 v219, -v11
    v_mul_f32 v28, v12, v28
    v_exp_f32 v220, -v12
    v_mul_f32 v29, v13, v29
    v_exp_f32 v221, -v13
    v_mul_f32 v30, v14, v30
    v_exp_f32 v222, -v14
    v_mul_f32 v31, v15, v31
    v_exp_f32 v223, -v15
    v_fma_f32 v216, v216, s67, s67
    v_fma_f32 v217, v217, s67, s67
    v_rcp_f32 v216, v216
    v_fma_f32 v218, v218, s67, s67
    v_rcp_f32 v217, v217
    v_fma_f32 v219, v219, s67, s67
    v_rcp_f32 v218, v218
    v_fma_f32 v220, v220, s67, s67
    v_rcp_f32 v219, v219
    v_fma_f32 v221, v221, s67, s67
    v_rcp_f32 v220, v220
    v_fma_f32 v222, v222, s67, s67
    v_rcp_f32 v221, v221
    v_fma_f32 v223, v223, s67, s67
    v_rcp_f32 v222, v222
    v_rcp_f32 v223, v223
    v_mul_f32 v24, v24, v216
    v_mul_f32 v25, v25, v217
    v_mul_f32 v26, v26, v218
    v_mul_f32 v27, v27, v219
    v_mul_f32 v28, v28, v220
    v_mul_f32 v29, v29, v221
    v_mul_f32 v30, v30, v222
    v_mul_f32 v31, v31, v223
    v_cvt_pk_bf16_f32 v200, v24, v25
    v_cvt_pk_bf16_f32 v201, v26, v27
    v_cvt_pk_bf16_f32 v202, v28, v29
    v_cvt_pk_bf16_f32 v203, v30, v31
    buffer_store_dwordx4 v[200:203], v198, s[28:31], 0 offen offset:0 sc1
    v_mul_f32 v32, v16, v32
    v_exp_f32 v224, -v16
    v_mul_f32 v33, v17, v33
    v_exp_f32 v225, -v17
    v_mul_f32 v34, v18, v34
    v_exp_f32 v226, -v18
    v_mul_f32 v35, v19, v35
    v_exp_f32 v227, -v19
    v_mul_f32 v36, v20, v36
    v_exp_f32 v228, -v20
    v_mul_f32 v37, v21, v37
    v_exp_f32 v229, -v21
    v_mul_f32 v38, v22, v38
    v_exp_f32 v230, -v22
    v_mul_f32 v39, v23, v39
    v_exp_f32 v231, -v23
    v_fma_f32 v224, v224, s67, s67
    v_fma_f32 v225, v225, s67, s67
    v_rcp_f32 v224, v224
    v_fma_f32 v226, v226, s67, s67
    v_rcp_f32 v225, v225
    v_fma_f32 v227, v227, s67, s67
    v_rcp_f32 v226, v226
    v_fma_f32 v228, v228, s67, s67
    v_rcp_f32 v227, v227
    v_fma_f32 v229, v229, s67, s67
    v_rcp_f32 v228, v228
    v_fma_f32 v230, v230, s67, s67
    v_rcp_f32 v229, v229
    v_fma_f32 v231, v231, s67, s67
    v_rcp_f32 v230, v230
    v_rcp_f32 v231, v231
    v_mul_f32 v32, v32, v224
    v_mul_f32 v33, v33, v225
    v_mul_f32 v34, v34, v226
    v_mul_f32 v35, v35, v227
    v_mul_f32 v36, v36, v228
    v_mul_f32 v37, v37, v229
    v_mul_f32 v38, v38, v230
    v_mul_f32 v39, v39, v231
    v_cvt_pk_bf16_f32 v204, v32, v33
    v_cvt_pk_bf16_f32 v205, v34, v35
    v_cvt_pk_bf16_f32 v206, v36, v37
    v_cvt_pk_bf16_f32 v207, v38, v39
    buffer_store_dwordx4 v[204:207], v198, s[28:31], 0 offen offset:1024 sc1
    v_add_u32 v198, 114688, v198
    v_mul_f32 v56, v40, v56
    v_exp_f32 v216, -v40
    v_mul_f32 v57, v41, v57
    v_exp_f32 v217, -v41
    v_mul_f32 v58, v42, v58
    v_exp_f32 v218, -v42
    v_mul_f32 v59, v43, v59
    v_exp_f32 v219, -v43
    v_mul_f32 v60, v44, v60
    v_exp_f32 v220, -v44
    v_mul_f32 v61, v45, v61
    v_exp_f32 v221, -v45
    v_mul_f32 v62, v46, v62
    v_exp_f32 v222, -v46
    v_mul_f32 v63, v47, v63
    v_exp_f32 v223, -v47
    v_fma_f32 v216, v216, s67, s67
    v_fma_f32 v217, v217, s67, s67
    v_rcp_f32 v216, v216
    v_fma_f32 v218, v218, s67, s67
    v_rcp_f32 v217, v217
    v_fma_f32 v219, v219, s67, s67
    v_rcp_f32 v218, v218
    v_fma_f32 v220, v220, s67, s67
    v_rcp_f32 v219, v219
    v_fma_f32 v221, v221, s67, s67
    v_rcp_f32 v220, v220
    v_fma_f32 v222, v222, s67, s67
    v_rcp_f32 v221, v221
    v_fma_f32 v223, v223, s67, s67
    v_rcp_f32 v222, v222
    v_rcp_f32 v223, v223
    v_mul_f32 v56, v56, v216
    v_mul_f32 v57, v57, v217
    v_mul_f32 v58, v58, v218
    v_mul_f32 v59, v59, v219
    v_mul_f32 v60, v60, v220
    v_mul_f32 v61, v61, v221
    v_mul_f32 v62, v62, v222
    v_mul_f32 v63, v63, v223
    v_cvt_pk_bf16_f32 v208, v56, v57
    v_cvt_pk_bf16_f32 v209, v58, v59
    v_cvt_pk_bf16_f32 v210, v60, v61
    v_cvt_pk_bf16_f32 v211, v62, v63
    buffer_store_dwordx4 v[208:211], v198, s[28:31], 0 offen offset:0 sc1
    v_mul_f32 v64, v48, v64
    v_exp_f32 v224, -v48
    v_mul_f32 v65, v49, v65
    v_exp_f32 v225, -v49
    v_mul_f32 v66, v50, v66
    v_exp_f32 v226, -v50
    v_mul_f32 v67, v51, v67
    v_exp_f32 v227, -v51
    v_mul_f32 v68, v52, v68
    v_exp_f32 v228, -v52
    v_mul_f32 v69, v53, v69
    v_exp_f32 v229, -v53
    v_mul_f32 v70, v54, v70
    v_exp_f32 v230, -v54
    v_mul_f32 v71, v55, v71
    v_exp_f32 v231, -v55
    v_fma_f32 v224, v224, s67, s67
    v_fma_f32 v225, v225, s67, s67
    v_rcp_f32 v224, v224
    v_fma_f32 v226, v226, s67, s67
    v_rcp_f32 v225, v225
    v_fma_f32 v227, v227, s67, s67
    v_rcp_f32 v226, v226
    v_fma_f32 v228, v228, s67, s67
    v_rcp_f32 v227, v227
    v_fma_f32 v229, v229, s67, s67
    v_rcp_f32 v228, v228
    v_fma_f32 v230, v230, s67, s67
    v_rcp_f32 v229, v229
    v_fma_f32 v231, v231, s67, s67
    v_rcp_f32 v230, v230
    v_rcp_f32 v231, v231
    v_mul_f32 v64, v64, v224
    v_mul_f32 v65, v65, v225
    v_mul_f32 v66, v66, v226
    v_mul_f32 v67, v67, v227
    v_mul_f32 v68, v68, v228
    v_mul_f32 v69, v69, v229
    v_mul_f32 v70, v70, v230
    v_mul_f32 v71, v71, v231
    v_cvt_pk_bf16_f32 v212, v64, v65
    v_cvt_pk_bf16_f32 v213, v66, v67
    v_cvt_pk_bf16_f32 v214, v68, v69
    v_cvt_pk_bf16_f32 v215, v70, v71
    buffer_store_dwordx4 v[212:215], v198, s[28:31], 0 offen offset:1024 sc1
    v_add_u32 v198, 114688, v198
    v_mul_f32 v88, v72, v88
    v_exp_f32 v216, -v72
    v_mul_f32 v89, v73, v89
    v_exp_f32 v217, -v73
    v_mul_f32 v90, v74, v90
    v_exp_f32 v218, -v74
    v_mul_f32 v91, v75, v91
    v_exp_f32 v219, -v75
    v_mul_f32 v92, v76, v92
    v_exp_f32 v220, -v76
    v_mul_f32 v93, v77, v93
    v_exp_f32 v221, -v77
    v_mul_f32 v94, v78, v94
    v_exp_f32 v222, -v78
    v_mul_f32 v95, v79, v95
    v_exp_f32 v223, -v79
    v_fma_f32 v216, v216, s67, s67
    v_fma_f32 v217, v217, s67, s67
    v_rcp_f32 v216, v216
    v_fma_f32 v218, v218, s67, s67
    v_rcp_f32 v217, v217
    v_fma_f32 v219, v219, s67, s67
    v_rcp_f32 v218, v218
    v_fma_f32 v220, v220, s67, s67
    v_rcp_f32 v219, v219
    v_fma_f32 v221, v221, s67, s67
    v_rcp_f32 v220, v220
    v_fma_f32 v222, v222, s67, s67
    v_rcp_f32 v221, v221
    v_fma_f32 v223, v223, s67, s67
    v_rcp_f32 v222, v222
    v_rcp_f32 v223, v223
    v_mul_f32 v88, v88, v216
    v_mul_f32 v89, v89, v217
    v_mul_f32 v90, v90, v218
    v_mul_f32 v91, v91, v219
    v_mul_f32 v92, v92, v220
    v_mul_f32 v93, v93, v221
    v_mul_f32 v94, v94, v222
    v_mul_f32 v95, v95, v223
    v_cvt_pk_bf16_f32 v200, v88, v89
    v_cvt_pk_bf16_f32 v201, v90, v91
    v_cvt_pk_bf16_f32 v202, v92, v93
    v_cvt_pk_bf16_f32 v203, v94, v95
    buffer_store_dwordx4 v[200:203], v198, s[28:31], 0 offen offset:0 sc1
    v_mul_f32 v96, v80, v96
    v_exp_f32 v224, -v80
    v_mul_f32 v97, v81, v97
    v_exp_f32 v225, -v81
    v_mul_f32 v98, v82, v98
    v_exp_f32 v226, -v82
    v_mul_f32 v99, v83, v99
    v_exp_f32 v227, -v83
    v_mul_f32 v100, v84, v100
    v_exp_f32 v228, -v84
    v_mul_f32 v101, v85, v101
    v_exp_f32 v229, -v85
    v_mul_f32 v102, v86, v102
    v_exp_f32 v230, -v86
    v_mul_f32 v103, v87, v103
    v_exp_f32 v231, -v87
    v_fma_f32 v224, v224, s67, s67
    v_fma_f32 v225, v225, s67, s67
    v_rcp_f32 v224, v224
    v_fma_f32 v226, v226, s67, s67
    v_rcp_f32 v225, v225
    v_fma_f32 v227, v227, s67, s67
    v_rcp_f32 v226, v226
    v_fma_f32 v228, v228, s67, s67
    v_rcp_f32 v227, v227
    v_fma_f32 v229, v229, s67, s67
    v_rcp_f32 v228, v228
    v_fma_f32 v230, v230, s67, s67
    v_rcp_f32 v229, v229
    v_fma_f32 v231, v231, s67, s67
    v_rcp_f32 v230, v230
    v_rcp_f32 v231, v231
    v_mul_f32 v96, v96, v224
    v_mul_f32 v97, v97, v225
    v_mul_f32 v98, v98, v226
    v_mul_f32 v99, v99, v227
    v_mul_f32 v100, v100, v228
    v_mul_f32 v101, v101, v229
    v_mul_f32 v102, v102, v230
    v_mul_f32 v103, v103, v231
    v_cvt_pk_bf16_f32 v204, v96, v97
    v_cvt_pk_bf16_f32 v205, v98, v99
    v_cvt_pk_bf16_f32 v206, v100, v101
    v_cvt_pk_bf16_f32 v207, v102, v103
    buffer_store_dwordx4 v[204:207], v198, s[28:31], 0 offen offset:1024 sc1
    v_add_u32 v198, 114688, v198
    v_mul_f32 v120, v104, v120
    v_exp_f32 v216, -v104
    v_mul_f32 v121, v105, v121
    v_exp_f32 v217, -v105
    v_mul_f32 v122, v106, v122
    v_exp_f32 v218, -v106
    v_mul_f32 v123, v107, v123
    v_exp_f32 v219, -v107
    v_mul_f32 v124, v108, v124
    v_exp_f32 v220, -v108
    v_mul_f32 v125, v109, v125
    v_exp_f32 v221, -v109
    v_mul_f32 v126, v110, v126
    v_exp_f32 v222, -v110
    v_mul_f32 v127, v111, v127
    v_exp_f32 v223, -v111
    v_fma_f32 v216, v216, s67, s67
    v_fma_f32 v217, v217, s67, s67
    v_rcp_f32 v216, v216
    v_fma_f32 v218, v218, s67, s67
    v_rcp_f32 v217, v217
    v_fma_f32 v219, v219, s67, s67
    v_rcp_f32 v218, v218
    v_fma_f32 v220, v220, s67, s67
    v_rcp_f32 v219, v219
    v_fma_f32 v221, v221, s67, s67
    v_rcp_f32 v220, v220
    v_fma_f32 v222, v222, s67, s67
    v_rcp_f32 v221, v221
    v_fma_f32 v223, v223, s67, s67
    v_rcp_f32 v222, v222
    v_rcp_f32 v223, v223
    v_mul_f32 v120, v120, v216
    v_mul_f32 v121, v121, v217
    v_mul_f32 v122, v122, v218
    v_mul_f32 v123, v123, v219
    v_mul_f32 v124, v124, v220
    v_mul_f32 v125, v125, v221
    v_mul_f32 v126, v126, v222
    v_mul_f32 v127, v127, v223
    v_cvt_pk_bf16_f32 v208, v120, v121
    v_cvt_pk_bf16_f32 v209, v122, v123
    v_cvt_pk_bf16_f32 v210, v124, v125
    v_cvt_pk_bf16_f32 v211, v126, v127
    buffer_store_dwordx4 v[208:211], v198, s[28:31], 0 offen offset:0 sc1
    v_mul_f32 v128, v112, v128
    v_exp_f32 v224, -v112
    v_mul_f32 v129, v113, v129
    v_exp_f32 v225, -v113
    v_mul_f32 v130, v114, v130
    v_exp_f32 v226, -v114
    v_mul_f32 v131, v115, v131
    v_exp_f32 v227, -v115
    v_mul_f32 v132, v116, v132
    v_exp_f32 v228, -v116
    v_mul_f32 v133, v117, v133
    v_exp_f32 v229, -v117
    v_mul_f32 v134, v118, v134
    v_exp_f32 v230, -v118
    v_mul_f32 v135, v119, v135
    v_exp_f32 v231, -v119
    v_fma_f32 v224, v224, s67, s67
    v_fma_f32 v225, v225, s67, s67
    v_rcp_f32 v224, v224
    v_fma_f32 v226, v226, s67, s67
    v_rcp_f32 v225, v225
    v_fma_f32 v227, v227, s67, s67
    v_rcp_f32 v226, v226
    v_fma_f32 v228, v228, s67, s67
    v_rcp_f32 v227, v227
    v_fma_f32 v229, v229, s67, s67
    v_rcp_f32 v228, v228
    v_fma_f32 v230, v230, s67, s67
    v_rcp_f32 v229, v229
    v_fma_f32 v231, v231, s67, s67
    v_rcp_f32 v230, v230
    v_rcp_f32 v231, v231
    v_mul_f32 v128, v128, v224
    v_mul_f32 v129, v129, v225
    v_mul_f32 v130, v130, v226
    v_mul_f32 v131, v131, v227
    v_mul_f32 v132, v132, v228
    v_mul_f32 v133, v133, v229
    v_mul_f32 v134, v134, v230
    v_mul_f32 v135, v135, v231
    v_cvt_pk_bf16_f32 v212, v128, v129
    v_cvt_pk_bf16_f32 v213, v130, v131
    v_cvt_pk_bf16_f32 v214, v132, v133
    v_cvt_pk_bf16_f32 v215, v134, v135
    buffer_store_dwordx4 v[212:215], v198, s[28:31], 0 offen offset:1024 sc1
    s_lshl_b32 s65, s44, 1
    s_xor_b32 s65, s65, s49
    s_lshl_b32 s64, s47, 3
    s_add_u32 s64, s64, s65
    s_mul_i32 s64, s64, 114688
    s_add_u32 s64, s64, 0x1500000
    v_lshl_add_u32 v192, v1, 4, s64
    s_lshl_b32 s65, s44, 1
    s_or_b32 s65, s65, 1
    s_xor_b32 s65, s65, s49
    s_lshl_b32 s64, s47, 3
    s_add_u32 s64, s64, s65
    s_mul_i32 s64, s64, 114688
    s_add_u32 s64, s64, 0x14ff800
    v_lshl_add_u32 v193, v1, 4, s64
    s_lshl_b32 s65, s51, 9
    v_lshrrev_b32 v3, 4, v1
    s_lshl_b32 s64, s44, 4
    v_add_u32 v2, s64, v3
    s_movk_i32 s64, 2048
    v_mul_u32_u24 v2, s64, v2
    v_add_u32 v2, s65, v2
    v_lshlrev_b32 v3, 1, v3
    v_and_b32 v4, 15, v1
    v_xor_b32 v3, v3, v4
    v_lshl_add_u32 v194, v3, 4, v2
    v_add_u32 v196, 14336, v194
    v_xor_b32 v3, 8, v3
    v_lshl_add_u32 v195, v3, 4, v2
    v_add_u32 v195, 7168, v195
    v_add_u32 v197, 14336, v195
    s_lshl_b32 s64, s47, 9
    s_lshl_b32 s65, s49, 7
    s_add_u32 s64, s64, s65
    s_lshl_b32 s65, s51, 4
    s_add_u32 s64, s64, s65
    s_lshl_b32 s65, s44, 2
    s_add_u32 s64, s64, s65
    s_add_u32 s64, s64, 0x50000
    v_mov_b32 v2, s0
    s_waitcnt vmcnt(0)
    s_mov_b64 exec, 1
    buffer_store_dword v2, v234, s[28:31], s64 offen sc1
    s_mov_b64 exec, -1
    s_barrier
    s_lshl_b32 s68, s47, 2
    s_add_u32 s68, s68, s49
    s_lshl_b32 s68, s68, 7
    s_add_u32 s68, s68, 0x50000
    v_min_u32 v234, 60, v234
    buffer_load_dword v245, v234, s[28:31], s68 offen sc1
    s_waitcnt vmcnt(0)
    s_branch M_Pjoin
M_Q:
    v_and_b32 v2, 7, v1
    s_lshl_b32 s64, s44, 3
    v_add_u32 v2, s64, v2
    v_lshrrev_b32 v3, 3, v1
    v_lshlrev_b32 v14, 5, v3
    v_add_u32 v14, 149504, v14
    s_lshl_b32 s64, s48, 7
    v_lshl_add_u32 v4, v3, 4, s64
    s_lshl_b32 s70, s47, 7
    v_add_u32 v12, s70, v2
    v_lshl_add_u32 v8, v12, 11, v4
    s_max_u32 s70, s70, 16
    s_sub_u32 s70, s70, 16
    v_and_b32 v5, 15, v2
    v_add_u32 v13, s70, v5
    v_lshl_add_u32 v9, v13, 11, v4
    v_and_b32 v4, 7, v2
    v_lshlrev_b32 v4, 3, v4
    v_add_u32 v4, 0x10000, v4
    v_lshrrev_b32 v12, 3, v12
    v_lshl_add_u32 v12, v12, 7, v4
    v_lshrrev_b32 v13, 3, v13
    v_lshl_add_u32 v13, v13, 7, v4
    v_lshlrev_b32 v3, 8, v3
    v_lshl_add_u32 v3, v5, 4, v3
    s_mul_i32 s64, s47, 294912
    s_lshl_b32 s65, s48, 11
    s_add_u32 s64, s64, s65
    s_add_u32 s64, s64, 0x100000
    s_cmp_ge_u32 s44, 2
    s_cselect_b32 s65, 0x80000000, s64
    v_add_u32 v11, s65, v3
    s_cselect_b32 s65, 32768, 0
    s_add_u32 s64, s64, s65
    s_add_u32 s64, s64, 32768
    v_add_u32 v10, s64, v3
    v_mov_b32 v19, v3
    s_lshr_b32 s64, s44, 1
    s_lshl_b32 s64, s64, 11
    s_add_u32 s64, s64, 2048
    v_add_u32 v15, s64, v3
    s_mov_b32 s28, s26
    s_mov_b32 s29, s27
    s_mov_b32 s30, 0x3100000
    s_mov_b32 s31, 0x20000
    s_waitcnt vmcnt(0)
    v_lshlrev_b32 v120, 16, v104
    v_and_b32 v121, 0xffff0000, v104
    v_lshlrev_b32 v122, 16, v105
    v_and_b32 v123, 0xffff0000, v105
    v_lshlrev_b32 v124, 16, v106
    v_and_b32 v125, 0xffff0000, v106
    v_lshlrev_b32 v126, 16, v107
    v_and_b32 v127, 0xffff0000, v107
    v_lshlrev_b32 v128, 16, v108
    v_and_b32 v129, 0xffff0000, v108
    v_lshlrev_b32 v130, 16, v109
    v_and_b32 v131, 0xffff0000, v109
    v_lshlrev_b32 v132, 16, v110
    v_and_b32 v133, 0xffff0000, v110
    v_lshlrev_b32 v134, 16, v111
    v_and_b32 v135, 0xffff0000, v111
    v_lshlrev_b32 v136, 16, v112
    v_and_b32 v137, 0xffff0000, v112
    v_lshlrev_b32 v138, 16, v113
    v_and_b32 v139, 0xffff0000, v113
    v_lshlrev_b32 v140, 16, v114
    v_and_b32 v141, 0xffff0000, v114
    v_lshlrev_b32 v142, 16, v115
    v_and_b32 v143, 0xffff0000, v115
    v_lshlrev_b32 v144, 16, v116
    v_and_b32 v145, 0xffff0000, v116
    v_lshlrev_b32 v146, 16, v117
    v_and_b32 v147, 0xffff0000, v117
    v_lshlrev_b32 v148, 16, v118
    v_and_b32 v149, 0xffff0000, v118
    v_lshlrev_b32 v150, 16, v119
    v_and_b32 v151, 0xffff0000, v119
    v_pk_add_f32 v[104:105], v[120:121], v[122:123]
    v_pk_mul_f32 v[108:109], v[120:121], v[120:121]
    v_pk_add_f32 v[106:107], v[136:137], v[138:139]
    v_pk_mul_f32 v[110:111], v[136:137], v[136:137]
    v_pk_fma_f32 v[108:109], v[122:123], v[122:123], v[108:109]
    v_pk_fma_f32 v[110:111], v[138:139], v[138:139], v[110:111]
    v_pk_add_f32 v[104:105], v[104:105], v[124:125]
    v_pk_fma_f32 v[108:109], v[124:125], v[124:125], v[108:109]
    v_pk_add_f32 v[106:107], v[106:107], v[140:141]
    v_pk_fma_f32 v[110:111], v[140:141], v[140:141], v[110:111]
    v_pk_add_f32 v[104:105], v[104:105], v[126:127]
    v_pk_fma_f32 v[108:109], v[126:127], v[126:127], v[108:109]
    v_pk_add_f32 v[106:107], v[106:107], v[142:143]
    v_pk_fma_f32 v[110:111], v[142:143], v[142:143], v[110:111]
    v_pk_add_f32 v[104:105], v[104:105], v[128:129]
    v_pk_fma_f32 v[108:109], v[128:129], v[128:129], v[108:109]
    v_pk_add_f32 v[106:107], v[106:107], v[144:145]
    v_pk_fma_f32 v[110:111], v[144:145], v[144:145], v[110:111]
    v_pk_add_f32 v[104:105], v[104:105], v[130:131]
    v_pk_fma_f32 v[108:109], v[130:131], v[130:131], v[108:109]
    v_pk_add_f32 v[106:107], v[106:107], v[146:147]
    v_pk_fma_f32 v[110:111], v[146:147], v[146:147], v[110:111]
    v_pk_add_f32 v[104:105], v[104:105], v[132:133]
    v_pk_fma_f32 v[108:109], v[132:133], v[132:133], v[108:109]
    v_pk_add_f32 v[106:107], v[106:107], v[148:149]
    v_pk_fma_f32 v[110:111], v[148:149], v[148:149], v[110:111]
    v_pk_add_f32 v[104:105], v[104:105], v[134:135]
    v_pk_fma_f32 v[108:109], v[134:135], v[134:135], v[108:109]
    v_pk_add_f32 v[106:107], v[106:107], v[150:151]
    v_pk_fma_f32 v[110:111], v[150:151], v[150:151], v[110:111]
    v_add_f32 v152, v104, v105
    v_add_f32 v153, v108, v109
    v_add_f32 v156, v106, v107
    v_add_f32 v157, v110, v111
    v_add_f32_dpp v152, v152, v152 quad_perm:[1,0,3,2] row_mask:0xf bank_mask:0xf
    v_add_f32_dpp v153, v153, v153 quad_perm:[1,0,3,2] row_mask:0xf bank_mask:0xf
    v_add_f32_dpp v156, v156, v156 quad_perm:[1,0,3,2] row_mask:0xf bank_mask:0xf
    v_add_f32_dpp v157, v157, v157 quad_perm:[1,0,3,2] row_mask:0xf bank_mask:0xf
    v_add_f32_dpp v152, v152, v152 quad_perm:[2,3,0,1] row_mask:0xf bank_mask:0xf
    v_add_f32_dpp v153, v153, v153 quad_perm:[2,3,0,1] row_mask:0xf bank_mask:0xf
    v_add_f32_dpp v156, v156, v156 quad_perm:[2,3,0,1] row_mask:0xf bank_mask:0xf
    v_add_f32_dpp v157, v157, v157 quad_perm:[2,3,0,1] row_mask:0xf bank_mask:0xf
    v_add_f32_dpp v152, v152, v152 row_half_mirror row_mask:0xf bank_mask:0xf
    v_add_f32_dpp v153, v153, v153 row_half_mirror row_mask:0xf bank_mask:0xf
    v_add_f32_dpp v156, v156, v156 row_half_mirror row_mask:0xf bank_mask:0xf
    v_add_f32_dpp v157, v157, v157 row_half_mirror row_mask:0xf bank_mask:0xf
    v_add_f32_dpp v152, v152, v152 row_mirror row_mask:0xf bank_mask:0xf
    v_add_f32_dpp v153, v153, v153 row_mirror row_mask:0xf bank_mask:0xf
    v_add_f32_dpp v156, v156, v156 row_mirror row_mask:0xf bank_mask:0xf
    v_add_f32_dpp v157, v157, v157 row_mirror row_mask:0xf bank_mask:0xf
    v_mov_b32 v154, v152
    v_mov_b32 v155, v153
    v_mov_b32 v158, v156
    v_mov_b32 v159, v157
    v_permlane32_swap_b32 v152, v154
    v_permlane32_swap_b32 v153, v155
    v_permlane32_swap_b32 v156, v158
    v_permlane32_swap_b32 v157, v159
    v_add_f32 v152, v152, v154
    v_add_f32 v153, v153, v155
    v_add_f32 v156, v156, v158
    v_add_f32 v157, v157, v159
    v_mov_b32 v154, v152
    v_mov_b32 v155, v153
    v_mov_b32 v158, v156
    v_mov_b32 v159, v157
    v_permlane16_swap_b32 v152, v154
    v_permlane16_swap_b32 v153, v155
    v_permlane16_swap_b32 v156, v158
    v_permlane16_swap_b32 v157, v159
    v_add_f32 v152, v152, v154
    v_add_f32 v153, v153, v155
    v_add_f32 v156, v156, v158
    v_add_f32 v157, v157, v159
    v_mul_f32 v152, 0x3a800000, v152
    v_mul_f32 v153, 0x3a800000, v153
    v_mul_f32 v156, 0x3a800000, v156
    v_mul_f32 v157, 0x3a800000, v157
    v_fma_f32 v153, -v152, v152, v153
    v_fma_f32 v157, -v156, v156, v157
    v_max_f32 v153, 0, v153
    v_max_f32 v157, 0, v157
    v_cvt_pk_bf16_f32 v154, v152, v153
    v_lshlrev_b32 v152, 16, v154
    v_and_b32 v153, 0xffff0000, v154
    v_cvt_pk_bf16_f32 v158, v156, v157
    v_lshlrev_b32 v156, 16, v158
    v_and_b32 v157, 0xffff0000, v158
    v_add_f32 v153, 0x3727c5ac, v153
    v_add_f32 v157, 0x3727c5ac, v157
    v_cvt_pk_bf16_f32 v154, v153, v153
    v_lshlrev_b32 v153, 16, v154
    v_cvt_pk_bf16_f32 v158, v157, v157
    v_lshlrev_b32 v157, 16, v158
    v_sqrt_f32 v153, v153
    v_sqrt_f32 v157, v157
    v_cvt_pk_bf16_f32 v154, v153, v153
    v_lshlrev_b32 v153, 16, v154
    v_cvt_pk_bf16_f32 v158, v157, v157
    v_lshlrev_b32 v157, 16, v158
    s_waitcnt lgkmcnt(0)
    s_add_u32 s0, s0, 1
    v_lshrrev_b32 v153, 16, v153
    v_or_b32 v160, v152, v153
    v_mov_b32 v161, s0
    v_lshrrev_b32 v157, 16, v157
    v_or_b32 v162, v156, v157
    v_mov_b32 v163, s0
    s_lshl_b32 s64, s44, 4
    s_add_u32 s64, s64, 150528
    v_mov_b32 v2, s64
    v_mov_b32 v3, 148500
    v_mov_b32 v4, 1
    s_mov_b64 exec, 1
    ds_write_b128 v2, v[160:163]
    ds_add_rtn_u32 v5, v3, v4
    s_mov_b64 exec, 0xf
    v_and_b32 v2, 3, v1
    v_lshlrev_b32 v2, 4, v2
    v_add_u32 v3, 150528, v2
    ds_read_b128 v[164:167], v3
    v_lshrrev_b32 v4, 2, v1
    v_lshl_add_u32 v2, v4, 15, v2
    s_lshr_b32 s64, s62, 2
    s_lshl_b32 s64, s64, 7
    s_add_u32 s64, s64, 0x10000
    s_waitcnt lgkmcnt(0)
    v_readfirstlane_b32 s65, v5
    s_nop 3
    s_cmp_eq_u32 s65, 3
    s_cselect_b32 s64, s64, 0x80000000
    v_add_u32 v2, s64, v2
    buffer_store_dwordx4 v[164:167], v2, s[28:31], 0 offen sc1
    s_mov_b64 exec, -1
    s_mov_b32 s64, 0x0
    buffer_load_dwordx4 v[80:83], v8, s[40:43], s64 offen
    s_mov_b32 s64, 0x10000
    buffer_load_dwordx4 v[84:87], v8, s[40:43], s64 offen
    s_mov_b32 s64, 0x20000
    buffer_load_dwordx4 v[88:91], v8, s[40:43], s64 offen
    s_mov_b32 s64, 0x30000
    buffer_load_dwordx4 v[92:95], v8, s[40:43], s64 offen
    buffer_load_dwordx4 v[96:99], v9, s[40:43], 0 offen
    s_mov_b32 s53, 0
    s_lshl_b32 s72, s44, 12
    s_add_u32 s72, s72, 2048
    s_lshl_b32 s73, s44, 9
    s_mul_i32 s74, s44, 6144
    s_add_u32 s74, s74, 18432
    s_add_u32 s75, s74, 4096
    s_bfe_u32 s66, s2, 0x30003
    s_lshr_b32 s55, s2, 6
    s_add_u32 s66, s66, s55
    s_and_b32 s66, s66, 3
    s_mov_b32 s58, 0x76453210
    s_mov_b32 s59, 0xfecdba89
    s_cmp_eq_u32 s66, 1
    s_cselect_b32 s58, 0x75643120, s58
    s_cselect_b32 s59, 0xfdecb9a8, s59
    s_cmp_eq_u32 s66, 2
    s_cselect_b32 s58, 0x67542310, s58
    s_cselect_b32 s59, 0xefdcab98, s59
    s_cmp_eq_u32 s66, 3
    s_cselect_b32 s58, 0x86534210, s58
    s_cselect_b32 s59, 0xfedbca97, s59
    s_and_b32 s66, s48, 15
    s_lshl_b32 s55, s66, 2
    s_lshr_b64 s[56:57], s[58:59], s55
    s_and_b32 s55, s56, 15
    s_lshl_b32 s55, s55, 2
    s_lshl_b64 s[56:57], 15, s55
    s_andn2_b64 s[58:59], s[58:59], s[56:57]
    s_or_b32 s58, s58, s66
    s_lshl_b32 s65, s48, 7
    s_mul_i32 s64, s44, 98304
    s_add_u32 s65, s65, s64
    s_movk_i32 s64, 6144
    v_add_u32 v2, 0, v1
    v_mul_u32_u24 v3, 0xab, v2
    v_lshrrev_b32 v3, 12, v3
    v_mul_u32_u24 v4, 24, v3
    v_sub_u32 v2, v2, v4
    v_and_b32 v4, 2, v3
    v_lshrrev_b32 v5, 3, v3
    v_lshl_or_b32 v4, v5, 2, v4
    v_xor_b32 v2, v2, v4
    v_mul_u32_u24 v3, s64, v3
    v_lshrrev_b32 v4, 3, v2
    v_lshl_add_u32 v3, v4, 11, v3
    v_and_b32 v2, 7, v2
    v_lshl_add_u32 v3, v2, 4, v3
    v_add_u32 v187, s65, v3
    v_add_u32 v2, 64, v1
    v_mul_u32_u24 v3, 0xab, v2
    v_lshrrev_b32 v3, 12, v3
    v_mul_u32_u24 v4, 24, v3
    v_sub_u32 v2, v2, v4
    v_and_b32 v4, 2, v3
    v_lshrrev_b32 v5, 3, v3
    v_lshl_or_b32 v4, v5, 2, v4
    v_xor_b32 v2, v2, v4
    v_mul_u32_u24 v3, s64, v3
    v_lshrrev_b32 v4, 3, v2
    v_lshl_add_u32 v3, v4, 11, v3
    v_and_b32 v2, 7, v2
    v_lshl_add_u32 v3, v2, 4, v3
    v_subrev_u32 v3, 1024, v3
    v_add_u32 v188, s65, v3
    v_add_u32 v2, 128, v1
    v_mul_u32_u24 v3, 0xab, v2
    v_lshrrev_b32 v3, 12, v3
    v_mul_u32_u24 v4, 24, v3
    v_sub_u32 v2, v2, v4
    v_and_b32 v4, 2, v3
    v_lshrrev_b32 v5, 3, v3
    v_lshl_or_b32 v4, v5, 2, v4
    v_xor_b32 v2, v2, v4
    v_mul_u32_u24 v3, s64, v3
    v_lshrrev_b32 v4, 3, v2
    v_lshl_add_u32 v3, v4, 11, v3
    v_and_b32 v2, 7, v2
    v_lshl_add_u32 v3, v2, 4, v3
    v_subrev_u32 v3, 2048, v3
    v_add_u32 v189, s65, v3
    v_add_u32 v2, 192, v1
    v_mul_u32_u24 v3, 0xab, v2
    v_lshrrev_b32 v3, 12, v3
    v_mul_u32_u24 v4, 24, v3
    v_sub_u32 v2, v2, v4
    v_and_b32 v4, 2, v3
    v_lshrrev_b32 v5, 3, v3
    v_lshl_or_b32 v4, v5, 2, v4
    v_xor_b32 v2, v2, v4
    v_mul_u32_u24 v3, s64, v3
    v_lshrrev_b32 v4, 3, v2
    v_lshl_add_u32 v3, v4, 11, v3
    v_and_b32 v2, 7, v2
    v_lshl_add_u32 v3, v2, 4, v3
    v_subrev_u32 v3, 3072, v3
    v_add_u32 v190, s65, v3
    v_add_u32 v2, 256, v1
    v_mul_u32_u24 v3, 0xab, v2
    v_lshrrev_b32 v3, 12, v3
    v_mul_u32_u24 v4, 24, v3
    v_sub_u32 v2, v2, v4
    v_and_b32 v4, 2, v3
    v_lshrrev_b32 v5, 3, v3
    v_lshl_or_b32 v4, v5, 2, v4
    v_xor_b32 v2, v2, v4
    v_mul_u32_u24 v3, s64, v3
    v_lshrrev_b32 v4, 3, v2
    v_lshl_add_u32 v3, v4, 11, v3
    v_and_b32 v2, 7, v2
    v_lshl_add_u32 v3, v2, 4, v3
    v_add_u32 v191, s65, v3
    v_add_u32 v2, 320, v1
    v_mul_u32_u24 v3, 0xab, v2
    v_lshrrev_b32 v3, 12, v3
    v_mul_u32_u24 v4, 24, v3
    v_sub_u32 v2, v2, v4
    v_and_b32 v4, 2, v3
    v_lshrrev_b32 v5, 3, v3
    v_lshl_or_b32 v4, v5, 2, v4
    v_xor_b32 v2, v2, v4
    v_mul_u32_u24 v3, s64, v3
    v_lshrrev_b32 v4, 3, v2
    v_lshl_add_u32 v3, v4, 11, v3
    v_and_b32 v2, 7, v2
    v_lshl_add_u32 v3, v2, 4, v3
    v_subrev_u32 v3, 1024, v3
    v_add_u32 v192, s65, v3
    s_mul_i32 s64, s47, 294912
    s_add_u32 s64, s64, 0x100000
    s_add_u32 s65, s64, s73
    v_lshl_add_u32 v186, v1, 4, s65
    s_mul_i32 s65, s44, 65536
    s_add_u32 s64, s64, s65
    s_add_u32 s64, s64, 32768
    v_lshl_add_u32 v184, v1, 4, s64
    v_add_u32 v185, 30720, v184
    s_mov_b32 s32, s6
    s_mov_b32 s33, s7
    s_mov_b32 s34, 0x600000
    s_mov_b32 s35, 0x20000
    s_lshr_b32 s45, s44, 1
    s_and_b32 s46, s44, 1
    s_lshr_b32 s49, s48, 2
    s_and_b32 s51, s48, 3
    s_cmp_ge_u32 s2, 192
    s_cselect_b32 s69, 0x80000000, 0
    s_mov_b32 s67, 0x40053526
    v_lshlrev_b32 v234, 2, v1
    v_lshrrev_b32 v3, 3, v1
    s_lshl_b32 s64, s44, 4
    v_add_lshl_u32 v2, v3, s64, 11
    s_lshl_b32 s64, s48, 7
    v_add_u32 v2, s64, v2
    v_and_b32 v3, 6, v3
    v_and_b32 v4, 7, v1
    v_xor_b32 v3, v3, v4
    v_lshl_add_u32 v193, v3, 4, v2
    v_add_u32 v194, 15360, v193
    s_lshl_b32 s64, s47, 3
    s_lshl_b32 s65, s44, 1
    s_add_u32 s64, s64, s65
    s_mul_i32 s64, s64, 32768
    s_add_u32 s64, s64, 0x1000000
    v_lshl_add_u32 v206, v1, 4, s64
    v_add_u32 v207, 30720, v206
    s_lshl_b32 s65, s48, 8
    v_lshrrev_b32 v3, 4, v1
    s_lshl_b32 s64, s44, 4
    v_add_u32 v2, s64, v3
    s_movk_i32 s64, 7168
    v_mul_u32_u24 v2, s64, v2
    v_add_u32 v2, s65, v2
    v_lshlrev_b32 v3, 1, v3
    v_and_b32 v4, 15, v1
    v_xor_b32 v3, v3, v4
    v_lshl_add_u32 v208, v3, 4, v2
    v_add_u32 v210, 55296, v208
    v_xor_b32 v3, 8, v3
    v_lshl_add_u32 v209, v3, 4, v2
    v_add_u32 v209, 27648, v209
    v_add_u32 v211, 55296, v209
    s_lshr_b32 s65, s48, 2
    s_sub_u32 s65, s48, s65
    s_add_u32 s65, s65, 16
    s_lshl_b32 s65, s65, 8
    s_or_b32 s65, s65, s69
    v_lshrrev_b32 v3, 4, v1
    s_lshl_b32 s64, s44, 4
    v_add_u32 v2, s64, v3
    s_movk_i32 s64, 7168
    v_mul_u32_u24 v2, s64, v2
    v_add_u32 v2, s65, v2
    v_lshlrev_b32 v3, 1, v3
    v_and_b32 v4, 15, v1
    v_xor_b32 v3, v3, v4
    v_lshl_add_u32 v212, v3, 4, v2
    v_add_u32 v214, 55296, v212
    v_xor_b32 v3, 8, v3
    v_lshl_add_u32 v213, v3, 4, v2
    v_add_u32 v213, 27648, v213
    v_add_u32 v215, 55296, v213
    s_lshl_b32 s65, s44, 1
    s_xor_b32 s65, s65, s49
    s_lshl_b32 s64, s47, 3
    s_add_u32 s64, s64, s65
    s_mul_i32 s64, s64, 114688
    s_add_u32 s64, s64, 0x1500000
    v_lshl_add_u32 v246, v1, 4, s64
    s_lshl_b32 s65, s44, 1
    s_or_b32 s65, s65, 1
    s_xor_b32 s65, s65, s49
    s_lshl_b32 s64, s47, 3
    s_add_u32 s64, s64, s65
    s_mul_i32 s64, s64, 114688
    s_add_u32 s64, s64, 0x14ff800
    v_lshl_add_u32 v247, v1, 4, s64
    s_lshl_b32 s65, s51, 9
    v_lshrrev_b32 v3, 4, v1
    s_lshl_b32 s64, s44, 4
    v_add_u32 v2, s64, v3
    s_movk_i32 s64, 2048
    v_mul_u32_u24 v2, s64, v2
    v_add_u32 v2, s65, v2
    v_lshlrev_b32 v3, 1, v3
    v_and_b32 v4, 15, v1
    v_xor_b32 v3, v3, v4
    v_lshl_add_u32 v248, v3, 4, v2
    v_add_u32 v250, 14336, v248
    v_xor_b32 v3, 8, v3
    v_lshl_add_u32 v249, v3, 4, v2
    v_add_u32 v249, 7168, v249
    v_add_u32 v251, 14336, v249
    s_lshl_b32 s64, s44, 12
    v_lshl_add_u32 v233, v1, 4, s64
    v_lshrrev_b32 v2, 2, v1
    v_lshlrev_b32 v4, 7, v2
    v_and_b32 v5, 3, v1
    v_lshl_add_u32 v4, v5, 3, v4
    v_add_u32 v4, 16384, v4
    v_bfe_u32 v2, v1, 3, 2
    v_xor_b32 v3, 0, v2
    v_lshl_add_u32 v239, v3, 5, v4
    v_xor_b32 v3, 1, v2
    v_lshl_add_u32 v240, v3, 5, v4
    v_xor_b32 v3, 2, v2
    v_lshl_add_u32 v241, v3, 5, v4
    v_xor_b32 v3, 3, v2
    v_lshl_add_u32 v242, v3, 5, v4
    s_mov_b32 s52, 49152
    v_add_u32 v232, s52, v233
    v_add_u32 v235, s52, v239
    v_add_u32 v236, s52, v240
    v_add_u32 v237, s52, v241
    v_add_u32 v238, s52, v242
    s_lshl_b32 s70, s47, 2
    s_add_u32 s70, s70, s44
    s_lshl_b32 s64, s70, 16
    s_lshl_b32 s65, s48, 7
    s_add_u32 s64, s64, s65
    v_and_b32 v2, 15, v1
    v_lshl_add_u32 v2, v2, 11, s64
    v_bfe_u32 v3, v1, 4, 1
    v_lshl_add_u32 v2, v3, 5, v2
    v_lshrrev_b32 v3, 5, v1
    v_lshl_add_u32 v196, v3, 4, v2
    s_mul_i32 s64, s70, 65536
    s_lshl_b32 s65, s48, 11
    s_add_u32 s64, s64, s65
    v_lshl_add_u32 v197, v1, 4, s64
    s_lshl_b32 s64, s70, 12
    s_add_u32 s64, s64, 0x60000
    v_lshl_add_u32 v198, v1, 3, s64
    v_lshrrev_b32 v2, 5, v1
    s_mov_b32 s64, 0x3ff00
    v_mad_u32_u24 v195, v2, s64, v198
    s_lshl_b32 s64, s48, 8
    v_add_u32 v195, s64, v195
    v_and_b32 v2, 48, v1
    v_add_u32 v199, 149504, v2
    v_mov_b32 v72, 148480
    v_mov_b32 v73, 0
    v_and_b32 v16, 255, v0
    s_lshr_b32 s76, s2, 6
    s_lshl_b32 s77, s76, 8
    s_and_b32 s78, s2, 63
    s_lshl_b32 s79, s78, 7
    s_add_u32 s79, s79, 4096
    s_lshl_b32 s76, s76, 15
    s_lshl_b32 s78, s78, 9
    s_add_u32 s76, s76, s78
    s_add_u32 s76, s76, 0xa0000
    v_lshrrev_b32 v72, 3, v16
    v_add_u32 v72, s77, v72
    v_lshlrev_b32 v18, 1, v72
    s_movk_i32 s64, 12288
    v_mul_lo_u32 v72, s64, v72
    v_and_b32 v17, 7, v0
    v_lshl_add_u32 v72, v17, 4, v72
    v_add_u32 v17, s79, v72
    s_lshl_b32 s64, s2, 8
    v_add_lshl_u32 v243, v16, s64, 5
    s_mov_b32 s36, s20
    s_mov_b32 s37, s21
    s_mov_b32 s38, 0xc00000
    s_mov_b32 s39, 0x20000
    s_lshl_b32 s64, s2, 2
    s_add_u32 s64, s64, s44
    s_mul_i32 s64, s64, 7168
    s_add_u32 s64, s64, 4096
    s_add_u32 s10, s12, s64
    s_addc_u32 s11, s13, 0
    s_add_u32 s24, s14, s64
    s_addc_u32 s25, s15, 0
    buffer_load_dwordx2 v[168:169], v12, s[28:31], 0 offen offset:0 sc1
    buffer_load_dwordx2 v[170:171], v12, s[28:31], 0 offen offset:512 sc1
    buffer_load_dwordx2 v[172:173], v12, s[28:31], 0 offen offset:1024 sc1
    buffer_load_dwordx2 v[174:175], v12, s[28:31], 0 offen offset:1536 sc1
    buffer_load_dwordx2 v[176:177], v13, s[28:31], 0 offen sc1
    s_waitcnt vmcnt(5)
    v_lshlrev_b32 v120, 16, v80
    v_and_b32 v121, 0xffff0000, v80
    v_lshlrev_b32 v122, 16, v81
    v_and_b32 v123, 0xffff0000, v81
    v_lshlrev_b32 v124, 16, v82
    v_and_b32 v125, 0xffff0000, v82
    v_lshlrev_b32 v126, 16, v83
    v_and_b32 v127, 0xffff0000, v83
    v_lshlrev_b32 v128, 16, v84
    v_and_b32 v129, 0xffff0000, v84
    v_lshlrev_b32 v130, 16, v85
    v_and_b32 v131, 0xffff0000, v85
    v_lshlrev_b32 v132, 16, v86
    v_and_b32 v133, 0xffff0000, v86
    v_lshlrev_b32 v134, 16, v87
    v_and_b32 v135, 0xffff0000, v87
    v_lshlrev_b32 v136, 16, v88
    v_and_b32 v137, 0xffff0000, v88
    v_lshlrev_b32 v138, 16, v89
    v_and_b32 v139, 0xffff0000, v89
    v_lshlrev_b32 v140, 16, v90
    v_and_b32 v141, 0xffff0000, v90
    v_lshlrev_b32 v142, 16, v91
    v_and_b32 v143, 0xffff0000, v91
    v_lshlrev_b32 v144, 16, v92
    v_and_b32 v145, 0xffff0000, v92
    v_lshlrev_b32 v146, 16, v93
    v_and_b32 v147, 0xffff0000, v93
    v_lshlrev_b32 v148, 16, v94
    v_and_b32 v149, 0xffff0000, v94
    v_lshlrev_b32 v150, 16, v95
    v_and_b32 v151, 0xffff0000, v95
    v_lshlrev_b32 v152, 16, v96
    v_and_b32 v153, 0xffff0000, v96
    v_lshlrev_b32 v154, 16, v97
    v_and_b32 v155, 0xffff0000, v97
    v_lshlrev_b32 v156, 16, v98
    v_and_b32 v157, 0xffff0000, v98
    v_lshlrev_b32 v158, 16, v99
    v_and_b32 v159, 0xffff0000, v99
    s_waitcnt vmcnt(0)
    s_mov_b32 s3, 0x40000
M_s1_chk:
    v_xor_b32 v72, s0, v169
    v_xor_b32 v73, s0, v171
    v_xor_b32 v74, s0, v173
    v_xor_b32 v75, s0, v175
    v_xor_b32 v76, s0, v177
    v_or3_b32 v72, v72, v73, v74
    v_or3_b32 v72, v72, v75, v76
    v_cmp_ne_u32 vcc, 0, v72
    s_nop 4
    s_cbranch_vccz M_s1_ok
    s_sub_u32 s3, s3, 1
    s_cbranch_scc1 M_s1_ok
    s_sleep 2
    v_cmp_ne_u32 vcc, s0, v169
    s_nop 4
    s_mov_b64 exec, vcc
    buffer_load_dwordx2 v[168:169], v12, s[28:31], 0 offen offset:0 sc1
    s_mov_b64 exec, -1
    v_cmp_ne_u32 vcc, s0, v171
    s_nop 4
    s_mov_b64 exec, vcc
    buffer_load_dwordx2 v[170:171], v12, s[28:31], 0 offen offset:512 sc1
    s_mov_b64 exec, -1
    v_cmp_ne_u32 vcc, s0, v173
    s_nop 4
    s_mov_b64 exec, vcc
    buffer_load_dwordx2 v[172:173], v12, s[28:31], 0 offen offset:1024 sc1
    s_mov_b64 exec, -1
    v_cmp_ne_u32 vcc, s0, v175
    s_nop 4
    s_mov_b64 exec, vcc
    buffer_load_dwordx2 v[174:175], v12, s[28:31], 0 offen offset:1536 sc1
    s_mov_b64 exec, -1
    v_cmp_ne_u32 vcc, s0, v177
    s_nop 4
    s_mov_b64 exec, vcc
    buffer_load_dwordx2 v[176:177], v13, s[28:31], 0 offen sc1
    s_mov_b64 exec, -1
    s_waitcnt vmcnt(0)
    s_branch M_s1_chk
M_s1_ok:
    v_lshlrev_b32 v169, 16, v168
    v_and_b32 v168, 0xffff0000, v168
    v_lshlrev_b32 v171, 16, v170
    v_and_b32 v170, 0xffff0000, v170
    v_lshlrev_b32 v173, 16, v172
    v_and_b32 v172, 0xffff0000, v172
    v_lshlrev_b32 v175, 16, v174
    v_and_b32 v174, 0xffff0000, v174
    v_lshlrev_b32 v177, 16, v176
    v_and_b32 v176, 0xffff0000, v176
    v_rcp_f32 v169, v169
    v_rcp_f32 v171, v171
    v_rcp_f32 v173, v173
    v_rcp_f32 v175, v175
    v_rcp_f32 v177, v177
    v_pk_add_f32 v[120:121], v[120:121], v[168:169] op_sel_hi:[1,0] neg_lo:[0,1] neg_hi:[0,1]
    v_pk_add_f32 v[122:123], v[122:123], v[168:169] op_sel_hi:[1,0] neg_lo:[0,1] neg_hi:[0,1]
    v_pk_add_f32 v[124:125], v[124:125], v[168:169] op_sel_hi:[1,0] neg_lo:[0,1] neg_hi:[0,1]
    v_pk_add_f32 v[126:127], v[126:127], v[168:169] op_sel_hi:[1,0] neg_lo:[0,1] neg_hi:[0,1]
    v_cvt_pk_bf16_f32 v72, v120, v121
    v_lshlrev_b32 v120, 16, v72
    v_and_b32 v121, 0xffff0000, v72
    v_cvt_pk_bf16_f32 v73, v122, v123
    v_lshlrev_b32 v122, 16, v73
    v_and_b32 v123, 0xffff0000, v73
    v_cvt_pk_bf16_f32 v74, v124, v125
    v_lshlrev_b32 v124, 16, v74
    v_and_b32 v125, 0xffff0000, v74
    v_cvt_pk_bf16_f32 v75, v126, v127
    v_lshlrev_b32 v126, 16, v75
    v_and_b32 v127, 0xffff0000, v75
    v_pk_mul_f32 v[120:121], v[120:121], v[168:169] op_sel:[0,1] op_sel_hi:[1,1]
    v_pk_mul_f32 v[122:123], v[122:123], v[168:169] op_sel:[0,1] op_sel_hi:[1,1]
    v_pk_mul_f32 v[124:125], v[124:125], v[168:169] op_sel:[0,1] op_sel_hi:[1,1]
    v_pk_mul_f32 v[126:127], v[126:127], v[168:169] op_sel:[0,1] op_sel_hi:[1,1]
    v_cvt_pk_bf16_f32 v72, v120, v121
    v_lshlrev_b32 v120, 16, v72
    v_and_b32 v121, 0xffff0000, v72
    v_cvt_pk_bf16_f32 v73, v122, v123
    v_lshlrev_b32 v122, 16, v73
    v_and_b32 v123, 0xffff0000, v73
    v_cvt_pk_bf16_f32 v74, v124, v125
    v_lshlrev_b32 v124, 16, v74
    v_and_b32 v125, 0xffff0000, v74
    v_cvt_pk_bf16_f32 v75, v126, v127
    v_lshlrev_b32 v126, 16, v75
    v_and_b32 v127, 0xffff0000, v75
    v_pk_add_f32 v[128:129], v[128:129], v[170:171] op_sel_hi:[1,0] neg_lo:[0,1] neg_hi:[0,1]
    v_pk_add_f32 v[130:131], v[130:131], v[170:171] op_sel_hi:[1,0] neg_lo:[0,1] neg_hi:[0,1]
    v_pk_add_f32 v[132:133], v[132:133], v[170:171] op_sel_hi:[1,0] neg_lo:[0,1] neg_hi:[0,1]
    v_pk_add_f32 v[134:135], v[134:135], v[170:171] op_sel_hi:[1,0] neg_lo:[0,1] neg_hi:[0,1]
    v_cvt_pk_bf16_f32 v72, v128, v129
    v_lshlrev_b32 v128, 16, v72
    v_and_b32 v129, 0xffff0000, v72
    v_cvt_pk_bf16_f32 v73, v130, v131
    v_lshlrev_b32 v130, 16, v73
    v_and_b32 v131, 0xffff0000, v73
    v_cvt_pk_bf16_f32 v74, v132, v133
    v_lshlrev_b32 v132, 16, v74
    v_and_b32 v133, 0xffff0000, v74
    v_cvt_pk_bf16_f32 v75, v134, v135
    v_lshlrev_b32 v134, 16, v75
    v_and_b32 v135, 0xffff0000, v75
    v_pk_mul_f32 v[128:129], v[128:129], v[170:171] op_sel:[0,1] op_sel_hi:[1,1]
    v_pk_mul_f32 v[130:131], v[130:131], v[170:171] op_sel:[0,1] op_sel_hi:[1,1]
    v_pk_mul_f32 v[132:133], v[132:133], v[170:171] op_sel:[0,1] op_sel_hi:[1,1]
    v_pk_mul_f32 v[134:135], v[134:135], v[170:171] op_sel:[0,1] op_sel_hi:[1,1]
    v_cvt_pk_bf16_f32 v72, v128, v129
    v_lshlrev_b32 v128, 16, v72
    v_and_b32 v129, 0xffff0000, v72
    v_cvt_pk_bf16_f32 v73, v130, v131
    v_lshlrev_b32 v130, 16, v73
    v_and_b32 v131, 0xffff0000, v73
    v_cvt_pk_bf16_f32 v74, v132, v133
    v_lshlrev_b32 v132, 16, v74
    v_and_b32 v133, 0xffff0000, v74
    v_cvt_pk_bf16_f32 v75, v134, v135
    v_lshlrev_b32 v134, 16, v75
    v_and_b32 v135, 0xffff0000, v75
    v_pk_add_f32 v[136:137], v[136:137], v[172:173] op_sel_hi:[1,0] neg_lo:[0,1] neg_hi:[0,1]
    v_pk_add_f32 v[138:139], v[138:139], v[172:173] op_sel_hi:[1,0] neg_lo:[0,1] neg_hi:[0,1]
    v_pk_add_f32 v[140:141], v[140:141], v[172:173] op_sel_hi:[1,0] neg_lo:[0,1] neg_hi:[0,1]
    v_pk_add_f32 v[142:143], v[142:143], v[172:173] op_sel_hi:[1,0] neg_lo:[0,1] neg_hi:[0,1]
    v_cvt_pk_bf16_f32 v72, v136, v137
    v_lshlrev_b32 v136, 16, v72
    v_and_b32 v137, 0xffff0000, v72
    v_cvt_pk_bf16_f32 v73, v138, v139
    v_lshlrev_b32 v138, 16, v73
    v_and_b32 v139, 0xffff0000, v73
    v_cvt_pk_bf16_f32 v74, v140, v141
    v_lshlrev_b32 v140, 16, v74
    v_and_b32 v141, 0xffff0000, v74
    v_cvt_pk_bf16_f32 v75, v142, v143
    v_lshlrev_b32 v142, 16, v75
    v_and_b32 v143, 0xffff0000, v75
    v_pk_mul_f32 v[136:137], v[136:137], v[172:173] op_sel:[0,1] op_sel_hi:[1,1]
    v_pk_mul_f32 v[138:139], v[138:139], v[172:173] op_sel:[0,1] op_sel_hi:[1,1]
    v_pk_mul_f32 v[140:141], v[140:141], v[172:173] op_sel:[0,1] op_sel_hi:[1,1]
    v_pk_mul_f32 v[142:143], v[142:143], v[172:173] op_sel:[0,1] op_sel_hi:[1,1]
    v_cvt_pk_bf16_f32 v72, v136, v137
    v_lshlrev_b32 v136, 16, v72
    v_and_b32 v137, 0xffff0000, v72
    v_cvt_pk_bf16_f32 v73, v138, v139
    v_lshlrev_b32 v138, 16, v73
    v_and_b32 v139, 0xffff0000, v73
    v_cvt_pk_bf16_f32 v74, v140, v141
    v_lshlrev_b32 v140, 16, v74
    v_and_b32 v141, 0xffff0000, v74
    v_cvt_pk_bf16_f32 v75, v142, v143
    v_lshlrev_b32 v142, 16, v75
    v_and_b32 v143, 0xffff0000, v75
    v_pk_add_f32 v[144:145], v[144:145], v[174:175] op_sel_hi:[1,0] neg_lo:[0,1] neg_hi:[0,1]
    v_pk_add_f32 v[146:147], v[146:147], v[174:175] op_sel_hi:[1,0] neg_lo:[0,1] neg_hi:[0,1]
    v_pk_add_f32 v[148:149], v[148:149], v[174:175] op_sel_hi:[1,0] neg_lo:[0,1] neg_hi:[0,1]
    v_pk_add_f32 v[150:151], v[150:151], v[174:175] op_sel_hi:[1,0] neg_lo:[0,1] neg_hi:[0,1]
    v_cvt_pk_bf16_f32 v72, v144, v145
    v_lshlrev_b32 v144, 16, v72
    v_and_b32 v145, 0xffff0000, v72
    v_cvt_pk_bf16_f32 v73, v146, v147
    v_lshlrev_b32 v146, 16, v73
    v_and_b32 v147, 0xffff0000, v73
    v_cvt_pk_bf16_f32 v74, v148, v149
    v_lshlrev_b32 v148, 16, v74
    v_and_b32 v149, 0xffff0000, v74
    v_cvt_pk_bf16_f32 v75, v150, v151
    v_lshlrev_b32 v150, 16, v75
    v_and_b32 v151, 0xffff0000, v75
    v_pk_mul_f32 v[144:145], v[144:145], v[174:175] op_sel:[0,1] op_sel_hi:[1,1]
    v_pk_mul_f32 v[146:147], v[146:147], v[174:175] op_sel:[0,1] op_sel_hi:[1,1]
    v_pk_mul_f32 v[148:149], v[148:149], v[174:175] op_sel:[0,1] op_sel_hi:[1,1]
    v_pk_mul_f32 v[150:151], v[150:151], v[174:175] op_sel:[0,1] op_sel_hi:[1,1]
    v_cvt_pk_bf16_f32 v72, v144, v145
    v_lshlrev_b32 v144, 16, v72
    v_and_b32 v145, 0xffff0000, v72
    v_cvt_pk_bf16_f32 v73, v146, v147
    v_lshlrev_b32 v146, 16, v73
    v_and_b32 v147, 0xffff0000, v73
    v_cvt_pk_bf16_f32 v74, v148, v149
    v_lshlrev_b32 v148, 16, v74
    v_and_b32 v149, 0xffff0000, v74
    v_cvt_pk_bf16_f32 v75, v150, v151
    v_lshlrev_b32 v150, 16, v75
    v_and_b32 v151, 0xffff0000, v75
    v_pk_add_f32 v[152:153], v[152:153], v[176:177] op_sel_hi:[1,0] neg_lo:[0,1] neg_hi:[0,1]
    v_pk_add_f32 v[154:155], v[154:155], v[176:177] op_sel_hi:[1,0] neg_lo:[0,1] neg_hi:[0,1]
    v_pk_add_f32 v[156:157], v[156:157], v[176:177] op_sel_hi:[1,0] neg_lo:[0,1] neg_hi:[0,1]
    v_pk_add_f32 v[158:159], v[158:159], v[176:177] op_sel_hi:[1,0] neg_lo:[0,1] neg_hi:[0,1]
    v_cvt_pk_bf16_f32 v72, v152, v153
    v_lshlrev_b32 v152, 16, v72
    v_and_b32 v153, 0xffff0000, v72
    v_cvt_pk_bf16_f32 v73, v154, v155
    v_lshlrev_b32 v154, 16, v73
    v_and_b32 v155, 0xffff0000, v73
    v_cvt_pk_bf16_f32 v74, v156, v157
    v_lshlrev_b32 v156, 16, v74
    v_and_b32 v157, 0xffff0000, v74
    v_cvt_pk_bf16_f32 v75, v158, v159
    v_lshlrev_b32 v158, 16, v75
    v_and_b32 v159, 0xffff0000, v75
    v_pk_mul_f32 v[152:153], v[152:153], v[176:177] op_sel:[0,1] op_sel_hi:[1,1]
    v_pk_mul_f32 v[154:155], v[154:155], v[176:177] op_sel:[0,1] op_sel_hi:[1,1]
    v_pk_mul_f32 v[156:157], v[156:157], v[176:177] op_sel:[0,1] op_sel_hi:[1,1]
    v_pk_mul_f32 v[158:159], v[158:159], v[176:177] op_sel:[0,1] op_sel_hi:[1,1]
    v_cvt_pk_bf16_f32 v72, v152, v153
    v_lshlrev_b32 v152, 16, v72
    v_and_b32 v153, 0xffff0000, v72
    v_cvt_pk_bf16_f32 v73, v154, v155
    v_lshlrev_b32 v154, 16, v73
    v_and_b32 v155, 0xffff0000, v73
    v_cvt_pk_bf16_f32 v74, v156, v157
    v_lshlrev_b32 v156, 16, v74
    v_and_b32 v157, 0xffff0000, v74
    v_cvt_pk_bf16_f32 v75, v158, v159
    v_lshlrev_b32 v158, 16, v75
    v_and_b32 v159, 0xffff0000, v75
    s_lshl_b32 s68, s47, 9
    s_add_u32 s68, s68, 0x58000
    s_add_u32 s62, s26, s68
    s_addc_u32 s63, s27, 0
    s_lshr_b32 s68, s48, 2
    s_lshl_b32 s68, s68, 7
    v_mov_b32 v2, 1
    v_mov_b32 v5, 148496
    s_and_b32 s57, s58, 15
    s_lshr_b64 s[58:59], s[58:59], 4
    s_lshl_b32 s56, s57, 11
    s_mul_i32 s57, s57, 0x60000
    s_add_u32 m0, s53, s74
    s_nop 0
    buffer_load_dwordx4 v187, s[32:35], s57 offen offset:0 lds
    buffer_load_dwordx4 v188, s[32:35], s57 offen offset:1024 lds
    buffer_load_dwordx4 v189, s[32:35], s57 offen offset:2048 lds
    buffer_load_dwordx4 v190, s[32:35], s57 offen offset:3072 lds
    s_add_u32 m0, s53, s75
    s_nop 0
    buffer_load_dwordx4 v191, s[32:35], s57 offen offset:0 lds
    buffer_load_dwordx4 v192, s[32:35], s57 offen offset:1024 lds
    s_add_u32 s53, s53, 49152
    s_cmp_ge_u32 s53, 147456
    s_cselect_b32 s53, 0, s53
    s_barrier
    ds_read_b128 v[32:35], v14 offset:0
    ds_read_b128 v[36:39], v14 offset:16
    ds_read_b128 v[40:43], v14 offset:256
    ds_read_b128 v[44:47], v14 offset:272
    s_waitcnt lgkmcnt(0)
    v_pk_mul_f32 v[120:121], v[120:121], v[40:41]
    v_pk_mul_f32 v[122:123], v[122:123], v[42:43]
    v_pk_mul_f32 v[124:125], v[124:125], v[44:45]
    v_pk_mul_f32 v[126:127], v[126:127], v[46:47]
    v_cvt_pk_bf16_f32 v72, v120, v121
    v_lshlrev_b32 v120, 16, v72
    v_and_b32 v121, 0xffff0000, v72
    v_cvt_pk_bf16_f32 v73, v122, v123
    v_lshlrev_b32 v122, 16, v73
    v_and_b32 v123, 0xffff0000, v73
    v_cvt_pk_bf16_f32 v74, v124, v125
    v_lshlrev_b32 v124, 16, v74
    v_and_b32 v125, 0xffff0000, v74
    v_cvt_pk_bf16_f32 v75, v126, v127
    v_lshlrev_b32 v126, 16, v75
    v_and_b32 v127, 0xffff0000, v75
    v_pk_add_f32 v[120:121], v[120:121], v[32:33]
    v_pk_add_f32 v[122:123], v[122:123], v[34:35]
    v_pk_add_f32 v[124:125], v[124:125], v[36:37]
    v_pk_add_f32 v[126:127], v[126:127], v[38:39]
    v_cvt_pk_bf16_f32 v80, v120, v121
    v_cvt_pk_bf16_f32 v81, v122, v123
    v_cvt_pk_bf16_f32 v82, v124, v125
    v_cvt_pk_bf16_f32 v83, v126, v127
    s_mov_b32 s64, 0x0
    buffer_store_dwordx4 v[80:83], v10, s[28:31], s64 offen sc1
    ds_write_b128 v15, v[80:83] offset:0
    v_pk_mul_f32 v[128:129], v[128:129], v[40:41]
    v_pk_mul_f32 v[130:131], v[130:131], v[42:43]
    v_pk_mul_f32 v[132:133], v[132:133], v[44:45]
    v_pk_mul_f32 v[134:135], v[134:135], v[46:47]
    v_cvt_pk_bf16_f32 v72, v128, v129
    v_lshlrev_b32 v128, 16, v72
    v_and_b32 v129, 0xffff0000, v72
    v_cvt_pk_bf16_f32 v73, v130, v131
    v_lshlrev_b32 v130, 16, v73
    v_and_b32 v131, 0xffff0000, v73
    v_cvt_pk_bf16_f32 v74, v132, v133
    v_lshlrev_b32 v132, 16, v74
    v_and_b32 v133, 0xffff0000, v74
    v_cvt_pk_bf16_f32 v75, v134, v135
    v_lshlrev_b32 v134, 16, v75
    v_and_b32 v135, 0xffff0000, v75
    v_pk_add_f32 v[128:129], v[128:129], v[32:33]
    v_pk_add_f32 v[130:131], v[130:131], v[34:35]
    v_pk_add_f32 v[132:133], v[132:133], v[36:37]
    v_pk_add_f32 v[134:135], v[134:135], v[38:39]
    v_cvt_pk_bf16_f32 v84, v128, v129
    v_cvt_pk_bf16_f32 v85, v130, v131
    v_cvt_pk_bf16_f32 v86, v132, v133
    v_cvt_pk_bf16_f32 v87, v134, v135
    s_mov_b32 s64, 0x10000
    buffer_store_dwordx4 v[84:87], v10, s[28:31], s64 offen sc1
    ds_write_b128 v15, v[84:87] offset:4096
    v_pk_mul_f32 v[136:137], v[136:137], v[40:41]
    v_pk_mul_f32 v[138:139], v[138:139], v[42:43]
    v_pk_mul_f32 v[140:141], v[140:141], v[44:45]
    v_pk_mul_f32 v[142:143], v[142:143], v[46:47]
    v_cvt_pk_bf16_f32 v72, v136, v137
    v_lshlrev_b32 v136, 16, v72
    v_and_b32 v137, 0xffff0000, v72
    v_cvt_pk_bf16_f32 v73, v138, v139
    v_lshlrev_b32 v138, 16, v73
    v_and_b32 v139, 0xffff0000, v73
    v_cvt_pk_bf16_f32 v74, v140, v141
    v_lshlrev_b32 v140, 16, v74
    v_and_b32 v141, 0xffff0000, v74
    v_cvt_pk_bf16_f32 v75, v142, v143
    v_lshlrev_b32 v142, 16, v75
    v_and_b32 v143, 0xffff0000, v75
    v_pk_add_f32 v[136:137], v[136:137], v[32:33]
    v_pk_add_f32 v[138:139], v[138:139], v[34:35]
    v_pk_add_f32 v[140:141], v[140:141], v[36:37]
    v_pk_add_f32 v[142:143], v[142:143], v[38:39]
    v_cvt_pk_bf16_f32 v88, v136, v137
    v_cvt_pk_bf16_f32 v89, v138, v139
    v_cvt_pk_bf16_f32 v90, v140, v141
    v_cvt_pk_bf16_f32 v91, v142, v143
    s_mov_b32 s64, 0x20000
    buffer_store_dwordx4 v[88:91], v10, s[28:31], s64 offen sc1
    ds_write_b128 v15, v[88:91] offset:8192
    v_pk_mul_f32 v[144:145], v[144:145], v[40:41]
    v_pk_mul_f32 v[146:147], v[146:147], v[42:43]
    v_pk_mul_f32 v[148:149], v[148:149], v[44:45]
    v_pk_mul_f32 v[150:151], v[150:151], v[46:47]
    v_cvt_pk_bf16_f32 v72, v144, v145
    v_lshlrev_b32 v144, 16, v72
    v_and_b32 v145, 0xffff0000, v72
    v_cvt_pk_bf16_f32 v73, v146, v147
    v_lshlrev_b32 v146, 16, v73
    v_and_b32 v147, 0xffff0000, v73
    v_cvt_pk_bf16_f32 v74, v148, v149
    v_lshlrev_b32 v148, 16, v74
    v_and_b32 v149, 0xffff0000, v74
    v_cvt_pk_bf16_f32 v75, v150, v151
    v_lshlrev_b32 v150, 16, v75
    v_and_b32 v151, 0xffff0000, v75
    v_pk_add_f32 v[144:145], v[144:145], v[32:33]
    v_pk_add_f32 v[146:147], v[146:147], v[34:35]
    v_pk_add_f32 v[148:149], v[148:149], v[36:37]
    v_pk_add_f32 v[150:151], v[150:151], v[38:39]
    v_cvt_pk_bf16_f32 v92, v144, v145
    v_cvt_pk_bf16_f32 v93, v146, v147
    v_cvt_pk_bf16_f32 v94, v148, v149
    v_cvt_pk_bf16_f32 v95, v150, v151
    s_mov_b32 s64, 0x30000
    buffer_store_dwordx4 v[92:95], v10, s[28:31], s64 offen sc1
    ds_write_b128 v15, v[92:95] offset:12288
    v_pk_mul_f32 v[152:153], v[152:153], v[40:41]
    v_pk_mul_f32 v[154:155], v[154:155], v[42:43]
    v_pk_mul_f32 v[156:157], v[156:157], v[44:45]
    v_pk_mul_f32 v[158:159], v[158:159], v[46:47]
    v_cvt_pk_bf16_f32 v72, v152, v153
    v_lshlrev_b32 v152, 16, v72
    v_and_b32 v153, 0xffff0000, v72
    v_cvt_pk_bf16_f32 v73, v154, v155
    v_lshlrev_b32 v154, 16, v73
    v_and_b32 v155, 0xffff0000, v73
    v_cvt_pk_bf16_f32 v74, v156, v157
    v_lshlrev_b32 v156, 16, v74
    v_and_b32 v157, 0xffff0000, v74
    v_cvt_pk_bf16_f32 v75, v158, v159
    v_lshlrev_b32 v158, 16, v75
    v_and_b32 v159, 0xffff0000, v75
    v_pk_add_f32 v[152:153], v[152:153], v[32:33]
    v_pk_add_f32 v[154:155], v[154:155], v[34:35]
    v_pk_add_f32 v[156:157], v[156:157], v[36:37]
    v_pk_add_f32 v[158:159], v[158:159], v[38:39]
    v_cvt_pk_bf16_f32 v96, v152, v153
    v_cvt_pk_bf16_f32 v97, v154, v155
    v_cvt_pk_bf16_f32 v98, v156, v157
    v_cvt_pk_bf16_f32 v99, v158, v159
    buffer_store_dwordx4 v[96:99], v11, s[28:31], 0 offen sc1
    ds_write_b128 v19, v[96:99] offset:0
    s_waitcnt lgkmcnt(0)
    s_waitcnt vmcnt(5)
    s_barrier
    s_and_b32 s57, s58, 15
    s_lshr_b64 s[58:59], s[58:59], 4
    s_lshl_b32 s56, s57, 11
    s_mul_i32 s57, s57, 0x60000
    s_add_u32 m0, s53, s74
    s_nop 0
    buffer_load_dwordx4 v187, s[32:35], s57 offen offset:0 lds
    buffer_load_dwordx4 v188, s[32:35], s57 offen offset:1024 lds
    buffer_load_dwordx4 v189, s[32:35], s57 offen offset:2048 lds
    buffer_load_dwordx4 v190, s[32:35], s57 offen offset:3072 lds
    s_add_u32 m0, s53, s75
    s_nop 0
    buffer_load_dwordx4 v191, s[32:35], s57 offen offset:0 lds
    buffer_load_dwordx4 v192, s[32:35], s57 offen offset:1024 lds
    s_add_u32 s53, s53, 49152
    s_cmp_ge_u32 s53, 147456
    s_cselect_b32 s53, 0, s53
    s_and_b32 s57, s58, 15
    s_lshr_b64 s[58:59], s[58:59], 4
    s_lshl_b32 s56, s57, 11
    s_mul_i32 s57, s57, 0x60000
    s_add_u32 m0, s53, s74
    s_nop 0
    buffer_load_dwordx4 v187, s[32:35], s57 offen offset:0 lds
    buffer_load_dwordx4 v188, s[32:35], s57 offen offset:1024 lds
    buffer_load_dwordx4 v189, s[32:35], s57 offen offset:2048 lds
    buffer_load_dwordx4 v190, s[32:35], s57 offen offset:3072 lds
    s_add_u32 m0, s53, s75
    s_nop 0
    buffer_load_dwordx4 v191, s[32:35], s57 offen offset:0 lds
    buffer_load_dwordx4 v192, s[32:35], s57 offen offset:1024 lds
    s_add_u32 s53, s53, 49152
    s_cmp_ge_u32 s53, 147456
    s_cselect_b32 s53, 0, s53
    s_mov_b32 s64, 0x0
    buffer_load_dwordx4 v[32:35], v17, s[36:39], s64 offen
    s_mov_b32 s64, 0x60000
    buffer_load_dwordx4 v[36:39], v17, s[36:39], s64 offen
    s_mov_b32 s64, 0xc0000
    buffer_load_dwordx4 v[40:43], v17, s[36:39], s64 offen
    s_mov_b32 s53, 0
    s_bfe_u32 s66, s2, 0x30003
    s_lshr_b32 s55, s2, 6
    s_add_u32 s66, s66, s55
    s_and_b32 s66, s66, 3
    s_mov_b32 s58, 0x76453210
    s_mov_b32 s59, 0xfecdba89
    s_cmp_eq_u32 s66, 1
    s_cselect_b32 s58, 0x75643120, s58
    s_cselect_b32 s59, 0xfdecb9a8, s59
    s_cmp_eq_u32 s66, 2
    s_cselect_b32 s58, 0x67542310, s58
    s_cselect_b32 s59, 0xefdcab98, s59
    s_cmp_eq_u32 s66, 3
    s_cselect_b32 s58, 0x86534210, s58
    s_cselect_b32 s59, 0xfedbca97, s59
    s_and_b32 s66, s48, 15
    s_lshl_b32 s55, s66, 2
    s_lshr_b64 s[56:57], s[58:59], s55
    s_and_b32 s55, s56, 15
    s_lshl_b32 s55, s55, 2
    s_lshl_b64 s[56:57], 15, s55
    s_andn2_b64 s[58:59], s[58:59], s[56:57]
    s_or_b32 s58, s58, s66
    s_waitcnt vmcnt(15)
    s_mov_b64 exec, 1
    ds_add_rtn_u32 v245, v5, v2
    s_mov_b64 exec, -1
    s_mov_b32 s1, s0
    s_lshl_b32 s64, s48, 2
    s_waitcnt lgkmcnt(0)
    v_readfirstlane_b32 s3, v245
    s_nop 3
    s_cmp_lg_u32 s3, 3
    s_cbranch_scc1 M_p1_ok
    s_atomic_swap s0, s[62:63], s64 offset:0
    s_atomic_swap s0, s[62:63], s64 offset:128
    s_atomic_swap s0, s[62:63], s64 offset:256
    s_atomic_swap s0, s[62:63], s64 offset:384
    s_mov_b32 s3, 0x40000
M_p1_chk:
    s_load_dwordx16 s[80:95], s[62:63], s68 glc
    s_sub_u32 s3, s3, 1
    s_cbranch_scc1 M_p1_ok
M_p1_c2:
    s_waitcnt lgkmcnt(0)
    s_xor_b64 s[80:81], s[80:81], s[0:1]
    s_xor_b64 s[82:83], s[82:83], s[0:1]
    s_xor_b64 s[84:85], s[84:85], s[0:1]
    s_xor_b64 s[86:87], s[86:87], s[0:1]
    s_xor_b64 s[88:89], s[88:89], s[0:1]
    s_xor_b64 s[90:91], s[90:91], s[0:1]
    s_xor_b64 s[92:93], s[92:93], s[0:1]
    s_xor_b64 s[94:95], s[94:95], s[0:1]
    s_or_b64 s[80:81], s[80:81], s[82:83]
    s_or_b64 s[84:85], s[84:85], s[86:87]
    s_or_b64 s[88:89], s[88:89], s[90:91]
    s_or_b64 s[92:93], s[92:93], s[94:95]
    s_or_b64 s[80:81], s[80:81], s[84:85]
    s_or_b64 s[88:89], s[88:89], s[92:93]
    s_or_b64 s[80:81], s[80:81], s[88:89]
    s_cbranch_scc1 M_p1_chk
M_p1_ok:
    s_barrier
    s_and_b32 s57, s58, 15
    s_lshr_b64 s[58:59], s[58:59], 4
    s_lshl_b32 s56, s57, 11
    s_mul_i32 s57, s57, 0x60000
    s_add_u32 s53, s53, 49152
    s_cmp_ge_u32 s53, 147456
    s_cselect_b32 s53, 0, s53
    s_and_b32 s57, s58, 15
    s_lshr_b64 s[58:59], s[58:59], 4
    s_lshl_b32 s56, s57, 11
    s_mul_i32 s57, s57, 0x60000
    s_add_u32 m0, s53, s72
    s_nop 0
    buffer_load_dwordx4 v184, s[28:31], s56 offen offset:0 sc1 lds
    buffer_load_dwordx4 v184, s[28:31], s56 offen offset:1024 sc1 lds
    buffer_load_dwordx4 v185, s[28:31], s56 offen offset:2048 sc1 lds
    buffer_load_dwordx4 v185, s[28:31], s56 offen offset:3072 sc1 lds
    s_add_u32 m0, s53, s73
    s_mov_b32 exec_hi, 0
    buffer_load_dwordx4 v186, s[28:31], s56 offen offset:0 sc1 lds
    s_mov_b32 exec_hi, -1
    s_add_u32 s53, s53, 49152
    s_cmp_ge_u32 s53, 147456
    s_cselect_b32 s53, 0, s53
    s_and_b32 s57, s58, 15
    s_lshr_b64 s[58:59], s[58:59], 4
    s_lshl_b32 s56, s57, 11
    s_mul_i32 s57, s57, 0x60000
    s_add_u32 m0, s53, s72
    s_nop 0
    buffer_load_dwordx4 v184, s[28:31], s56 offen offset:0 sc1 lds
    buffer_load_dwordx4 v184, s[28:31], s56 offen offset:1024 sc1 lds
    buffer_load_dwordx4 v185, s[28:31], s56 offen offset:2048 sc1 lds
    buffer_load_dwordx4 v185, s[28:31], s56 offen offset:3072 sc1 lds
    s_add_u32 m0, s53, s73
    s_mov_b32 exec_hi, 0
    buffer_load_dwordx4 v186, s[28:31], s56 offen offset:0 sc1 lds
    s_mov_b32 exec_hi, -1
    s_add_u32 s53, s53, 49152
    s_cmp_ge_u32 s53, 147456
    s_cselect_b32 s53, 0, s53
    v_mov_b32 v6, -1
    v_mov_b32 v7, -1
    s_mov_b32 exec_hi, 0
    buffer_store_dwordx2 v[6:7], v195, s[28:31], 0 offen sc1
    s_mov_b32 exec_hi, -1
    s_mov_b32 s40, s18
    s_mov_b32 s41, s19
    s_mov_b32 s42, 0x800
    s_mov_b32 s43, 0x20000
    buffer_load_ushort v24, v18, s[40:43], 0 offen offset:0
    buffer_load_ushort v25, v18, s[40:43], 0 offen offset:64
    buffer_load_ushort v26, v18, s[40:43], 0 offen offset:128
    buffer_load_ushort v27, v18, s[40:43], 0 offen offset:192
    buffer_load_ushort v28, v18, s[40:43], 0 offen offset:256
    buffer_load_ushort v29, v18, s[40:43], 0 offen offset:320
    buffer_load_ushort v30, v18, s[40:43], 0 offen offset:384
    buffer_load_ushort v31, v18, s[40:43], 0 offen offset:448
    s_waitcnt vmcnt(14)
    s_barrier
    s_and_b32 s57, s58, 15
    s_lshr_b64 s[58:59], s[58:59], 4
    s_lshl_b32 s56, s57, 11
    s_mul_i32 s57, s57, 0x60000
    s_add_u32 m0, s53, s74
    s_nop 0
    buffer_load_dwordx4 v187, s[32:35], s57 offen offset:0 lds
    buffer_load_dwordx4 v188, s[32:35], s57 offen offset:1024 lds
    buffer_load_dwordx4 v189, s[32:35], s57 offen offset:2048 lds
    buffer_load_dwordx4 v190, s[32:35], s57 offen offset:3072 lds
    s_add_u32 m0, s53, s75
    s_nop 0
    buffer_load_dwordx4 v191, s[32:35], s57 offen offset:0 lds
    buffer_load_dwordx4 v192, s[32:35], s57 offen offset:1024 lds
    s_add_u32 m0, s53, s72
    s_nop 0
    buffer_load_dwordx4 v184, s[28:31], s56 offen offset:0 sc1 lds
    buffer_load_dwordx4 v184, s[28:31], s56 offen offset:1024 sc1 lds
    buffer_load_dwordx4 v185, s[28:31], s56 offen offset:2048 sc1 lds
    buffer_load_dwordx4 v185, s[28:31], s56 offen offset:3072 sc1 lds
    s_add_u32 m0, s53, s73
    s_mov_b32 exec_hi, 0
    buffer_load_dwordx4 v186, s[28:31], s56 offen offset:0 sc1 lds
    s_mov_b32 exec_hi, -1
    s_add_u32 s53, s53, 49152
    s_cmp_ge_u32 s53, 147456
    s_cselect_b32 s53, 0, s53
    s_waitcnt vmcnt(20)
    s_barrier
    s_and_b32 s57, s58, 15
    s_lshr_b64 s[58:59], s[58:59], 4
    s_lshl_b32 s56, s57, 11
    s_mul_i32 s57, s57, 0x60000
    s_add_u32 m0, s53, s74
    s_nop 0
    buffer_load_dwordx4 v187, s[32:35], s57 offen offset:0 lds
    buffer_load_dwordx4 v188, s[32:35], s57 offen offset:1024 lds
    buffer_load_dwordx4 v189, s[32:35], s57 offen offset:2048 lds
    buffer_load_dwordx4 v190, s[32:35], s57 offen offset:3072 lds
    s_add_u32 m0, s53, s75
    s_nop 0
    buffer_load_dwordx4 v191, s[32:35], s57 offen offset:0 lds
    buffer_load_dwordx4 v192, s[32:35], s57 offen offset:1024 lds
    s_add_u32 m0, s53, s72
    s_nop 0
    buffer_load_dwordx4 v184, s[28:31], s56 offen offset:0 sc1 lds
    buffer_load_dwordx4 v184, s[28:31], s56 offen offset:1024 sc1 lds
    buffer_load_dwordx4 v185, s[28:31], s56 offen offset:2048 sc1 lds
    buffer_load_dwordx4 v185, s[28:31], s56 offen offset:3072 sc1 lds
    s_add_u32 m0, s53, s73
    s_mov_b32 exec_hi, 0
    buffer_load_dwordx4 v186, s[28:31], s56 offen offset:0 sc1 lds
    s_mov_b32 exec_hi, -1
    s_add_u32 s53, s53, 49152
    s_cmp_ge_u32 s53, 147456
    s_cselect_b32 s53, 0, s53
    s_movk_i32 s54, 9
M_Q_loop0:
    s_waitcnt vmcnt(11)
    s_barrier
    s_and_b32 s57, s58, 15
    s_lshr_b64 s[58:59], s[58:59], 4
    s_lshl_b32 s56, s57, 11
    s_mul_i32 s57, s57, 0x60000
    s_add_u32 m0, s53, s74
    s_nop 0
    buffer_load_dwordx4 v187, s[32:35], s57 offen offset:0 lds
    buffer_load_dwordx4 v188, s[32:35], s57 offen offset:1024 lds
    buffer_load_dwordx4 v189, s[32:35], s57 offen offset:2048 lds
    buffer_load_dwordx4 v190, s[32:35], s57 offen offset:3072 lds
    s_add_u32 m0, s53, s75
    s_nop 0
    buffer_load_dwordx4 v191, s[32:35], s57 offen offset:0 lds
    buffer_load_dwordx4 v192, s[32:35], s57 offen offset:1024 lds
    s_add_u32 m0, s53, s72
    s_nop 0
    buffer_load_dwordx4 v184, s[28:31], s56 offen offset:0 sc1 lds
    buffer_load_dwordx4 v184, s[28:31], s56 offen offset:1024 sc1 lds
    buffer_load_dwordx4 v185, s[28:31], s56 offen offset:2048 sc1 lds
    buffer_load_dwordx4 v185, s[28:31], s56 offen offset:3072 sc1 lds
    s_add_u32 m0, s53, s73
    s_mov_b32 exec_hi, 0
    buffer_load_dwordx4 v186, s[28:31], s56 offen offset:0 sc1 lds
    s_mov_b32 exec_hi, -1
    s_add_u32 s53, s53, 49152
    s_cmp_ge_u32 s53, 147456
    s_cselect_b32 s53, 0, s53
    s_sub_u32 s54, s54, 1
    s_cbranch_scc0 M_Q_loop0
    s_waitcnt vmcnt(11)
    s_barrier
    s_and_b32 s57, s58, 15
    s_lshr_b64 s[58:59], s[58:59], 4
    s_lshl_b32 s56, s57, 11
    s_mul_i32 s57, s57, 0x60000
    s_add_u32 m0, s53, s74
    s_nop 0
    buffer_load_dwordx4 v187, s[32:35], s57 offen offset:0 lds
    buffer_load_dwordx4 v188, s[32:35], s57 offen offset:1024 lds
    buffer_load_dwordx4 v189, s[32:35], s57 offen offset:2048 lds
    buffer_load_dwordx4 v190, s[32:35], s57 offen offset:3072 lds
    s_add_u32 m0, s53, s75
    s_nop 0
    buffer_load_dwordx4 v191, s[32:35], s57 offen offset:0 lds
    buffer_load_dwordx4 v192, s[32:35], s57 offen offset:1024 lds
    s_add_u32 m0, s53, s72
    s_nop 0
    buffer_load_dwordx4 v184, s[28:31], s56 offen offset:0 sc1 lds
    buffer_load_dwordx4 v184, s[28:31], s56 offen offset:1024 sc1 lds
    buffer_load_dwordx4 v185, s[28:31], s56 offen offset:2048 sc1 lds
    buffer_load_dwordx4 v185, s[28:31], s56 offen offset:3072 sc1 lds
    s_add_u32 m0, s53, s73
    s_mov_b32 exec_hi, 0
    buffer_load_dwordx4 v186, s[28:31], s56 offen offset:0 sc1 lds
    s_mov_b32 exec_hi, -1
    s_add_u32 s53, s53, 49152
    s_cmp_ge_u32 s53, 147456
    s_cselect_b32 s53, 0, s53
    s_lshl_b32 s60, s44, 12
    s_add_u32 s61, s60, 147456
    s_add_u32 s53, s60, 49152
    s_lshl_b32 s70, s44, 11
    s_sub_u32 s70, 16384, s70
    s_bfe_u32 s66, s2, 0x30003
    s_lshr_b32 s55, s2, 6
    s_add_u32 s66, s66, s55
    s_and_b32 s66, s66, 3
    s_mov_b32 s58, 0x76453210
    s_mov_b32 s59, 0xfecdba89
    s_cmp_eq_u32 s66, 1
    s_cselect_b32 s58, 0x75643120, s58
    s_cselect_b32 s59, 0xfdecb9a8, s59
    s_cmp_eq_u32 s66, 2
    s_cselect_b32 s58, 0x67542310, s58
    s_cselect_b32 s59, 0xefdcab98, s59
    s_cmp_eq_u32 s66, 3
    s_cselect_b32 s58, 0x86534210, s58
    s_cselect_b32 s59, 0xfedbca97, s59
    s_mov_b32 s32, s8
    s_mov_b32 s33, s9
    s_mov_b32 s34, 0x200000
    s_mov_b32 s35, 0x20000
    s_waitcnt vmcnt(11)
    s_barrier
    s_mov_b32 s40, s4
    s_mov_b32 s41, s5
    s_mov_b32 s42, 0x400000
    s_mov_b32 s43, 0x20000
    s_mov_b32 s64, 0x8000
    buffer_load_dwordx4 v[88:91], v196, s[40:43], 0 offen offset:0
    buffer_load_dwordx4 v[92:95], v196, s[40:43], 0 offen offset:64
    buffer_load_dwordx4 v[96:99], v196, s[40:43], s64 offen offset:0
    buffer_load_dwordx4 v[100:103], v196, s[40:43], s64 offen offset:64
    s_mov_b32 s64, 0x120000
    buffer_load_dwordx4 v[44:47], v17, s[36:39], s64 offen
    s_mov_b32 s64, 0x180000
    buffer_load_dwordx4 v[48:51], v17, s[36:39], s64 offen
    s_mov_b32 s64, 0x1e0000
    buffer_load_dwordx4 v[52:55], v17, s[36:39], s64 offen
    s_mov_b32 s64, 0x240000
    buffer_load_dwordx4 v[56:59], v17, s[36:39], s64 offen
    s_mov_b32 s64, 0x2a0000
    buffer_load_dwordx4 v[60:63], v17, s[36:39], s64 offen
    s_mov_b32 s40, s8
    s_mov_b32 s41, s9
    s_mov_b32 s42, 0x200000
    s_mov_b32 s43, 0x20000
    s_mov_b32 s64, 0x0
    buffer_load_dword v244, v243, s[40:43], s64 offen
    s_waitcnt vmcnt(10)
    s_barrier
    s_waitcnt vmcnt(6)
    v_permlane16_swap_b32 v88, v90
    v_permlane16_swap_b32 v89, v91
    v_permlane16_swap_b32 v92, v94
    v_permlane16_swap_b32 v93, v95
    v_permlane16_swap_b32 v96, v98
    v_permlane16_swap_b32 v97, v99
    v_permlane16_swap_b32 v100, v102
    v_permlane16_swap_b32 v101, v103
    v_lshlrev_b32 v104, 16, v88
    v_and_b32 v105, 0xffff0000, v88
    v_lshlrev_b32 v106, 16, v89
    v_and_b32 v107, 0xffff0000, v89
    v_lshlrev_b32 v108, 16, v90
    v_and_b32 v109, 0xffff0000, v90
    v_lshlrev_b32 v110, 16, v91
    v_and_b32 v111, 0xffff0000, v91
    v_lshlrev_b32 v112, 16, v92
    v_and_b32 v113, 0xffff0000, v92
    v_lshlrev_b32 v114, 16, v93
    v_and_b32 v115, 0xffff0000, v93
    v_lshlrev_b32 v116, 16, v94
    v_and_b32 v117, 0xffff0000, v94
    v_lshlrev_b32 v118, 16, v95
    v_and_b32 v119, 0xffff0000, v95
    v_lshlrev_b32 v120, 16, v96
    v_and_b32 v121, 0xffff0000, v96
    v_lshlrev_b32 v122, 16, v97
    v_and_b32 v123, 0xffff0000, v97
    v_lshlrev_b32 v124, 16, v98
    v_and_b32 v125, 0xffff0000, v98
    v_lshlrev_b32 v126, 16, v99
    v_and_b32 v127, 0xffff0000, v99
    v_lshlrev_b32 v128, 16, v100
    v_and_b32 v129, 0xffff0000, v100
    v_lshlrev_b32 v130, 16, v101
    v_and_b32 v131, 0xffff0000, v101
    v_lshlrev_b32 v132, 16, v102
    v_and_b32 v133, 0xffff0000, v102
    v_lshlrev_b32 v134, 16, v103
    v_and_b32 v135, 0xffff0000, v103
    s_barrier
    s_barrier
    s_and_b32 s57, s58, 15
    s_lshr_b64 s[58:59], s[58:59], 4
    s_lshl_b32 s56, s57, 11
    s_mul_i32 s57, s57, 0x20000
    s_add_u32 m0, s53, s70
    s_nop 0
    buffer_load_dwordx4 v193, s[32:35], s57 offen offset:0 lds
    buffer_load_dwordx4 v194, s[32:35], s57 offen offset:1024 lds
    s_add_u32 s53, s53, 24576
    s_cmp_ge_u32 s53, s61
    s_cselect_b32 s53, s60, s53
    s_and_b32 s57, s58, 15
    s_lshr_b64 s[58:59], s[58:59], 4
    s_lshl_b32 s56, s57, 11
    s_mul_i32 s57, s57, 0x20000
    s_add_u32 m0, s53, s70
    s_nop 0
    buffer_load_dwordx4 v193, s[32:35], s57 offen offset:0 lds
    buffer_load_dwordx4 v194, s[32:35], s57 offen offset:1024 lds
    s_add_u32 s53, s53, 24576
    s_cmp_ge_u32 s53, s61
    s_cselect_b32 s53, s60, s53
    s_and_b32 s57, s58, 15
    s_lshr_b64 s[58:59], s[58:59], 4
    s_lshl_b32 s56, s57, 11
    s_mul_i32 s57, s57, 0x20000
    s_add_u32 m0, s53, s70
    s_nop 0
    buffer_load_dwordx4 v193, s[32:35], s57 offen offset:0 lds
    buffer_load_dwordx4 v194, s[32:35], s57 offen offset:1024 lds
    s_add_u32 s53, s53, 24576
    s_cmp_ge_u32 s53, s61
    s_cselect_b32 s53, s60, s53
    s_and_b32 s57, s58, 15
    s_lshr_b64 s[58:59], s[58:59], 4
    s_lshl_b32 s56, s57, 11
    s_mul_i32 s57, s57, 0x20000
    s_add_u32 m0, s53, s70
    s_nop 0
    buffer_load_dwordx4 v193, s[32:35], s57 offen offset:0 lds
    buffer_load_dwordx4 v194, s[32:35], s57 offen offset:1024 lds
    s_add_u32 s53, s53, 24576
    s_cmp_ge_u32 s53, s61
    s_cselect_b32 s53, s60, s53
    s_and_b32 s57, s58, 15
    s_lshr_b64 s[58:59], s[58:59], 4
    s_lshl_b32 s56, s57, 11
    s_mul_i32 s57, s57, 0x20000
    s_add_u32 m0, s53, s70
    s_nop 0
    buffer_load_dwordx4 v193, s[32:35], s57 offen offset:0 lds
    buffer_load_dwordx4 v194, s[32:35], s57 offen offset:1024 lds
    s_add_u32 s53, s53, 24576
    s_cmp_ge_u32 s53, s61
    s_cselect_b32 s53, s60, s53
    s_and_b32 s57, s58, 15
    s_lshr_b64 s[58:59], s[58:59], 4
    s_lshl_b32 s56, s57, 11
    s_mul_i32 s57, s57, 0x20000
    s_add_u32 m0, s53, s70
    s_nop 0
    buffer_load_dwordx4 v193, s[32:35], s57 offen offset:0 lds
    buffer_load_dwordx4 v194, s[32:35], s57 offen offset:1024 lds
    s_add_u32 s53, s53, 24576
    s_cmp_ge_u32 s53, s61
    s_cselect_b32 s53, s60, s53
    v_lshlrev_b32 v24, 16, v24
    v_lshlrev_b32 v25, 16, v25
    v_lshlrev_b32 v26, 16, v26
    v_lshlrev_b32 v27, 16, v27
    v_lshlrev_b32 v28, 16, v28
    v_lshlrev_b32 v29, 16, v29
    v_lshlrev_b32 v30, 16, v30
    v_lshlrev_b32 v31, 16, v31
    v_mul_f32 v72, 0xbfb8aa3b, v24
    v_mul_f32 v73, 0xbfb8aa3b, v25
    v_mul_f32 v74, 0xbfb8aa3b, v26
    v_mul_f32 v75, 0xbfb8aa3b, v27
    v_mul_f32 v76, 0xbfb8aa3b, v28
    v_mul_f32 v77, 0xbfb8aa3b, v29
    v_mul_f32 v78, 0xbfb8aa3b, v30
    v_mul_f32 v79, 0xbfb8aa3b, v31
    v_exp_f32 v72, v72
    v_exp_f32 v73, v73
    v_exp_f32 v74, v74
    v_exp_f32 v75, v75
    v_exp_f32 v76, v76
    v_exp_f32 v77, v77
    v_exp_f32 v78, v78
    v_exp_f32 v79, v79
    v_add_f32 v72, 1.0, v72
    v_add_f32 v73, 1.0, v73
    v_add_f32 v74, 1.0, v74
    v_add_f32 v75, 1.0, v75
    v_add_f32 v76, 1.0, v76
    v_add_f32 v77, 1.0, v77
    v_add_f32 v78, 1.0, v78
    v_add_f32 v79, 1.0, v79
    v_rcp_f32 v72, v72
    v_rcp_f32 v73, v73
    v_rcp_f32 v74, v74
    v_rcp_f32 v75, v75
    v_rcp_f32 v76, v76
    v_rcp_f32 v77, v77
    v_rcp_f32 v78, v78
    v_rcp_f32 v79, v79
    v_mul_f32 v24, v24, v72
    v_mul_f32 v25, v25, v73
    v_mul_f32 v26, v26, v74
    v_mul_f32 v27, v27, v75
    v_mul_f32 v28, v28, v76
    v_mul_f32 v29, v29, v77
    v_mul_f32 v30, v30, v78
    v_mul_f32 v31, v31, v79
    v_cvt_pk_bf16_f32 v72, v24, v24
    v_lshlrev_b32 v24, 16, v72
    v_cvt_pk_bf16_f32 v73, v25, v25
    v_lshlrev_b32 v25, 16, v73
    v_cvt_pk_bf16_f32 v74, v26, v26
    v_lshlrev_b32 v26, 16, v74
    v_cvt_pk_bf16_f32 v75, v27, v27
    v_lshlrev_b32 v27, 16, v75
    v_cvt_pk_bf16_f32 v76, v28, v28
    v_lshlrev_b32 v28, 16, v76
    v_cvt_pk_bf16_f32 v77, v29, v29
    v_lshlrev_b32 v29, 16, v77
    v_cvt_pk_bf16_f32 v78, v30, v30
    v_lshlrev_b32 v30, 16, v78
    v_cvt_pk_bf16_f32 v79, v31, v31
    v_lshlrev_b32 v31, 16, v79
    v_lshlrev_b32 v72, 16, v32
    v_and_b32 v73, 0xffff0000, v32
    v_lshlrev_b32 v74, 16, v33
    v_and_b32 v75, 0xffff0000, v33
    v_lshlrev_b32 v76, 16, v34
    v_and_b32 v77, 0xffff0000, v34
    v_lshlrev_b32 v78, 16, v35
    v_and_b32 v79, 0xffff0000, v35
    v_mul_f32 v64, v24, v72
    v_mul_f32 v65, v24, v73
    v_mul_f32 v66, v24, v74
    v_mul_f32 v67, v24, v75
    v_mul_f32 v68, v24, v76
    v_mul_f32 v69, v24, v77
    v_mul_f32 v70, v24, v78
    v_mul_f32 v71, v24, v79
    v_lshlrev_b32 v72, 16, v36
    v_and_b32 v73, 0xffff0000, v36
    v_lshlrev_b32 v74, 16, v37
    v_and_b32 v75, 0xffff0000, v37
    v_lshlrev_b32 v76, 16, v38
    v_and_b32 v77, 0xffff0000, v38
    v_lshlrev_b32 v78, 16, v39
    v_and_b32 v79, 0xffff0000, v39
    v_fmac_f32 v64, v25, v72
    v_fmac_f32 v65, v25, v73
    v_fmac_f32 v66, v25, v74
    v_fmac_f32 v67, v25, v75
    v_fmac_f32 v68, v25, v76
    v_fmac_f32 v69, v25, v77
    v_fmac_f32 v70, v25, v78
    v_fmac_f32 v71, v25, v79
    v_lshlrev_b32 v72, 16, v40
    v_and_b32 v73, 0xffff0000, v40
    v_lshlrev_b32 v74, 16, v41
    v_and_b32 v75, 0xffff0000, v41
    v_lshlrev_b32 v76, 16, v42
    v_and_b32 v77, 0xffff0000, v42
    v_lshlrev_b32 v78, 16, v43
    v_and_b32 v79, 0xffff0000, v43
    v_fmac_f32 v64, v26, v72
    v_fmac_f32 v65, v26, v73
    v_fmac_f32 v66, v26, v74
    v_fmac_f32 v67, v26, v75
    v_fmac_f32 v68, v26, v76
    v_fmac_f32 v69, v26, v77
    v_fmac_f32 v70, v26, v78
    v_fmac_f32 v71, v26, v79
    s_waitcnt vmcnt(17)
    v_lshlrev_b32 v72, 16, v44
    v_and_b32 v73, 0xffff0000, v44
    v_lshlrev_b32 v74, 16, v45
    v_and_b32 v75, 0xffff0000, v45
    v_lshlrev_b32 v76, 16, v46
    v_and_b32 v77, 0xffff0000, v46
    v_lshlrev_b32 v78, 16, v47
    v_and_b32 v79, 0xffff0000, v47
    v_fmac_f32 v64, v27, v72
    v_fmac_f32 v65, v27, v73
    v_fmac_f32 v66, v27, v74
    v_fmac_f32 v67, v27, v75
    v_fmac_f32 v68, v27, v76
    v_fmac_f32 v69, v27, v77
    v_fmac_f32 v70, v27, v78
    v_fmac_f32 v71, v27, v79
    s_waitcnt vmcnt(16)
    v_lshlrev_b32 v72, 16, v48
    v_and_b32 v73, 0xffff0000, v48
    v_lshlrev_b32 v74, 16, v49
    v_and_b32 v75, 0xffff0000, v49
    v_lshlrev_b32 v76, 16, v50
    v_and_b32 v77, 0xffff0000, v50
    v_lshlrev_b32 v78, 16, v51
    v_and_b32 v79, 0xffff0000, v51
    v_fmac_f32 v64, v28, v72
    v_fmac_f32 v65, v28, v73
    v_fmac_f32 v66, v28, v74
    v_fmac_f32 v67, v28, v75
    v_fmac_f32 v68, v28, v76
    v_fmac_f32 v69, v28, v77
    v_fmac_f32 v70, v28, v78
    v_fmac_f32 v71, v28, v79
    s_waitcnt vmcnt(15)
    v_lshlrev_b32 v72, 16, v52
    v_and_b32 v73, 0xffff0000, v52
    v_lshlrev_b32 v74, 16, v53
    v_and_b32 v75, 0xffff0000, v53
    v_lshlrev_b32 v76, 16, v54
    v_and_b32 v77, 0xffff0000, v54
    v_lshlrev_b32 v78, 16, v55
    v_and_b32 v79, 0xffff0000, v55
    v_fmac_f32 v64, v29, v72
    v_fmac_f32 v65, v29, v73
    v_fmac_f32 v66, v29, v74
    v_fmac_f32 v67, v29, v75
    v_fmac_f32 v68, v29, v76
    v_fmac_f32 v69, v29, v77
    v_fmac_f32 v70, v29, v78
    v_fmac_f32 v71, v29, v79
    s_waitcnt vmcnt(14)
    v_lshlrev_b32 v72, 16, v56
    v_and_b32 v73, 0xffff0000, v56
    v_lshlrev_b32 v74, 16, v57
    v_and_b32 v75, 0xffff0000, v57
    v_lshlrev_b32 v76, 16, v58
    v_and_b32 v77, 0xffff0000, v58
    v_lshlrev_b32 v78, 16, v59
    v_and_b32 v79, 0xffff0000, v59
    v_fmac_f32 v64, v30, v72
    v_fmac_f32 v65, v30, v73
    v_fmac_f32 v66, v30, v74
    v_fmac_f32 v67, v30, v75
    v_fmac_f32 v68, v30, v76
    v_fmac_f32 v69, v30, v77
    v_fmac_f32 v70, v30, v78
    v_fmac_f32 v71, v30, v79
    s_waitcnt vmcnt(13)
    v_lshlrev_b32 v72, 16, v60
    v_and_b32 v73, 0xffff0000, v60
    v_lshlrev_b32 v74, 16, v61
    v_and_b32 v75, 0xffff0000, v61
    v_lshlrev_b32 v76, 16, v62
    v_and_b32 v77, 0xffff0000, v62
    v_lshlrev_b32 v78, 16, v63
    v_and_b32 v79, 0xffff0000, v63
    v_fmac_f32 v64, v31, v72
    v_fmac_f32 v65, v31, v73
    v_fmac_f32 v66, v31, v74
    v_fmac_f32 v67, v31, v75
    v_fmac_f32 v68, v31, v76
    v_fmac_f32 v69, v31, v77
    v_fmac_f32 v70, v31, v78
    v_fmac_f32 v71, v31, v79
    v_add_f32_dpp v64, v64, v64 row_ror:8 row_mask:0xf bank_mask:0xf
    v_add_f32_dpp v65, v65, v65 row_ror:8 row_mask:0xf bank_mask:0xf
    v_add_f32_dpp v66, v66, v66 row_ror:8 row_mask:0xf bank_mask:0xf
    v_add_f32_dpp v67, v67, v67 row_ror:8 row_mask:0xf bank_mask:0xf
    v_add_f32_dpp v68, v68, v68 row_ror:8 row_mask:0xf bank_mask:0xf
    v_add_f32_dpp v69, v69, v69 row_ror:8 row_mask:0xf bank_mask:0xf
    v_add_f32_dpp v70, v70, v70 row_ror:8 row_mask:0xf bank_mask:0xf
    v_add_f32_dpp v71, v71, v71 row_ror:8 row_mask:0xf bank_mask:0xf
    v_mov_b32 v72, v64
    v_mov_b32 v73, v65
    v_mov_b32 v74, v66
    v_mov_b32 v75, v67
    v_mov_b32 v76, v68
    v_mov_b32 v77, v69
    v_mov_b32 v78, v70
    v_mov_b32 v79, v71
    v_permlane32_swap_b32 v64, v72
    v_permlane32_swap_b32 v65, v73
    v_permlane32_swap_b32 v66, v74
    v_permlane32_swap_b32 v67, v75
    v_permlane32_swap_b32 v68, v76
    v_permlane32_swap_b32 v69, v77
    v_permlane32_swap_b32 v70, v78
    v_permlane32_swap_b32 v71, v79
    v_add_f32 v64, v64, v72
    v_add_f32 v65, v65, v73
    v_add_f32 v66, v66, v74
    v_add_f32 v67, v67, v75
    v_add_f32 v68, v68, v76
    v_add_f32 v69, v69, v77
    v_add_f32 v70, v70, v78
    v_add_f32 v71, v71, v79
    v_mov_b32 v72, v64
    v_mov_b32 v73, v65
    v_mov_b32 v74, v66
    v_mov_b32 v75, v67
    v_mov_b32 v76, v68
    v_mov_b32 v77, v69
    v_mov_b32 v78, v70
    v_mov_b32 v79, v71
    v_permlane16_swap_b32 v64, v72
    v_permlane16_swap_b32 v65, v73
    v_permlane16_swap_b32 v66, v74
    v_permlane16_swap_b32 v67, v75
    v_permlane16_swap_b32 v68, v76
    v_permlane16_swap_b32 v69, v77
    v_permlane16_swap_b32 v70, v78
    v_permlane16_swap_b32 v71, v79
    v_add_f32 v64, v64, v72
    v_add_f32 v65, v65, v73
    v_add_f32 v66, v66, v74
    v_add_f32 v67, v67, v75
    v_add_f32 v68, v68, v76
    v_add_f32 v69, v69, v77
    v_add_f32 v70, v70, v78
    v_add_f32 v71, v71, v79
    s_lshl_b32 s64, s44, 8
    s_add_u32 s64, s64, 147456
    v_and_b32 v72, 7, v0
    v_lshl_add_u32 v72, v72, 5, s64
    ds_write_b128 v72, v[64:67]
    ds_write_b128 v72, v[68:71] offset:16
    v_mov_b32 v73, 148480
    v_mov_b32 v74, 1
    s_waitcnt lgkmcnt(0)
    s_mov_b64 exec, 1
    ds_add_rtn_u32 v75, v73, v74
    s_mov_b64 exec, -1
    v_add_u32 v73, 147456, v234
    s_waitcnt lgkmcnt(0)
    ds_read_b32 v64, v73 offset:0
    ds_read_b32 v65, v73 offset:256
    ds_read_b32 v66, v73 offset:512
    ds_read_b32 v67, v73 offset:768
    v_readfirstlane_b32 s64, v75
    s_nop 3
    s_cmp_eq_u32 s64, 3
    s_cselect_b32 s76, s76, 0x80000000
    v_lshl_add_u32 v72, v1, 3, s76
    s_waitcnt lgkmcnt(0)
    v_add_f32 v64, v64, v65
    v_add_f32 v66, v66, v67
    v_add_f32 v64, v64, v66
    v_mov_b32 v65, s0
    buffer_store_dwordx2 v[64:65], v72, s[28:31], 0 offen sc1
    s_lshl_b32 s60, s44, 12
    s_add_u32 s61, s60, 147456
    s_add_u32 s53, s60, 0
    s_bfe_u32 s66, s2, 0x30003
    s_lshr_b32 s55, s2, 6
    s_add_u32 s66, s66, s55
    s_and_b32 s66, s66, 3
    s_mov_b32 s58, 0x76453210
    s_mov_b32 s59, 0xfecdba89
    s_cmp_eq_u32 s66, 1
    s_cselect_b32 s58, 0x75643120, s58
    s_cselect_b32 s59, 0xfdecb9a8, s59
    s_cmp_eq_u32 s66, 2
    s_cselect_b32 s58, 0x67542310, s58
    s_cselect_b32 s59, 0xefdcab98, s59
    s_cmp_eq_u32 s66, 3
    s_cselect_b32 s58, 0x86534210, s58
    s_cselect_b32 s59, 0xfedbca97, s59
    s_and_b32 s66, s48, 15
    s_lshl_b32 s55, s66, 2
    s_lshr_b64 s[56:57], s[58:59], s55
    s_and_b32 s55, s56, 15
    s_lshl_b32 s55, s55, 2
    s_lshl_b64 s[56:57], 15, s55
    s_andn2_b64 s[58:59], s[58:59], s[56:57]
    s_or_b32 s58, s58, s66
    s_mov_b32 s32, s12
    s_mov_b32 s33, s13
    s_mov_b32 s34, 0x700000
    s_mov_b32 s35, 0x20000
    s_mov_b32 s36, s14
    s_mov_b32 s37, s15
    s_mov_b32 s38, 0x700000
    s_mov_b32 s39, 0x20000
    s_mov_b32 s72, 0xb00000
    s_mov_b32 s74, 0x1000000
    s_mov_b32 s73, 0xb08000
    s_mov_b32 s75, 0x1008000
    s_lshl_b32 s76, s48, 8
    s_setprio 2
    s_barrier
    s_waitcnt vmcnt(11)
    s_barrier
    ds_read_b128 v[40:43], v232 offset:0
    ds_read_b64_tr_b16 v[48:49], v235 offset:0
    ds_read_b64_tr_b16 v[50:51], v235 offset:2048
    ds_read_b64_tr_b16 v[52:53], v236 offset:0
    ds_read_b64_tr_b16 v[54:55], v236 offset:2048
    ds_read_b64_tr_b16 v[56:57], v237 offset:0
    ds_read_b64_tr_b16 v[58:59], v237 offset:2048
    ds_read_b64_tr_b16 v[60:61], v238 offset:0
    ds_read_b64_tr_b16 v[62:63], v238 offset:2048
    ds_read_b128 v[44:47], v232 offset:2048
    s_add_u32 s52, s52, 24576
    s_cmp_ge_u32 s52, 147456
    s_cselect_b32 s52, 0, s52
    s_waitcnt lgkmcnt(0)
    v_mfma_f32_16x16x32_bf16 v[8:11], v[48:51], v[40:43], 0
    ds_read_b128 v[64:67], v232 offset:1024
    ds_read_b64_tr_b16 v[72:73], v235 offset:4096
    v_mfma_f32_16x16x32_bf16 v[12:15], v[52:55], v[40:43], 0
    ds_read_b64_tr_b16 v[74:75], v235 offset:6144
    ds_read_b64_tr_b16 v[76:77], v236 offset:4096
    v_mfma_f32_16x16x32_bf16 v[16:19], v[56:59], v[40:43], 0
    ds_read_b64_tr_b16 v[78:79], v236 offset:6144
    ds_read_b64_tr_b16 v[80:81], v237 offset:4096
    v_mfma_f32_16x16x32_bf16 v[20:23], v[60:63], v[40:43], 0
    ds_read_b64_tr_b16 v[82:83], v237 offset:6144
    ds_read_b64_tr_b16 v[84:85], v238 offset:4096
    v_mfma_f32_16x16x32_bf16 v[24:27], v[48:51], v[44:47], 0
    ds_read_b64_tr_b16 v[86:87], v238 offset:6144
    ds_read_b128 v[68:71], v232 offset:3072
    v_mfma_f32_16x16x32_bf16 v[28:31], v[52:55], v[44:47], 0
    v_add_u32 v232, s52, v233
    v_add_u32 v235, s52, v239
    v_mfma_f32_16x16x32_bf16 v[32:35], v[56:59], v[44:47], 0
    v_add_u32 v236, s52, v240
    v_add_u32 v237, s52, v241
    v_mfma_f32_16x16x32_bf16 v[36:39], v[60:63], v[44:47], 0
    v_add_u32 v238, s52, v242
    s_waitcnt lgkmcnt(0)
    v_mfma_f32_16x16x32_bf16 v[8:11], v[72:75], v[64:67], v[8:11]
    s_waitcnt vmcnt(9)
    s_barrier
    v_mfma_f32_16x16x32_bf16 v[12:15], v[76:79], v[64:67], v[12:15]
    ds_read_b128 v[40:43], v232 offset:0
    ds_read_b64_tr_b16 v[48:49], v235 offset:0
    ds_read_b64_tr_b16 v[50:51], v235 offset:2048
    v_mfma_f32_16x16x32_bf16 v[16:19], v[80:83], v[64:67], v[16:19]
    ds_read_b64_tr_b16 v[52:53], v236 offset:0
    ds_read_b64_tr_b16 v[54:55], v236 offset:2048
    v_mfma_f32_16x16x32_bf16 v[20:23], v[84:87], v[64:67], v[20:23]
    ds_read_b64_tr_b16 v[56:57], v237 offset:0
    ds_read_b64_tr_b16 v[58:59], v237 offset:2048
    ds_read_b64_tr_b16 v[60:61], v238 offset:0
    v_mfma_f32_16x16x32_bf16 v[24:27], v[72:75], v[68:71], v[24:27]
    ds_read_b64_tr_b16 v[62:63], v238 offset:2048
    ds_read_b128 v[44:47], v232 offset:2048
    v_mfma_f32_16x16x32_bf16 v[28:31], v[76:79], v[68:71], v[28:31]
    v_mfma_f32_16x16x32_bf16 v[32:35], v[80:83], v[68:71], v[32:35]
    s_add_u32 s52, s52, 24576
    s_cmp_ge_u32 s52, 147456
    s_cselect_b32 s52, 0, s52
    v_mfma_f32_16x16x32_bf16 v[36:39], v[84:87], v[68:71], v[36:39]
    s_waitcnt lgkmcnt(0)
    v_mfma_f32_16x16x32_bf16 v[8:11], v[48:51], v[40:43], v[8:11]
    ds_read_b128 v[64:67], v232 offset:1024
    ds_read_b64_tr_b16 v[72:73], v235 offset:4096
    v_mfma_f32_16x16x32_bf16 v[12:15], v[52:55], v[40:43], v[12:15]
    ds_read_b64_tr_b16 v[74:75], v235 offset:6144
    ds_read_b64_tr_b16 v[76:77], v236 offset:4096
    v_mfma_f32_16x16x32_bf16 v[16:19], v[56:59], v[40:43], v[16:19]
    ds_read_b64_tr_b16 v[78:79], v236 offset:6144
    ds_read_b64_tr_b16 v[80:81], v237 offset:4096
    v_mfma_f32_16x16x32_bf16 v[20:23], v[60:63], v[40:43], v[20:23]
    ds_read_b64_tr_b16 v[82:83], v237 offset:6144
    ds_read_b64_tr_b16 v[84:85], v238 offset:4096
    v_mfma_f32_16x16x32_bf16 v[24:27], v[48:51], v[44:47], v[24:27]
    ds_read_b64_tr_b16 v[86:87], v238 offset:6144
    ds_read_b128 v[68:71], v232 offset:3072
    v_mfma_f32_16x16x32_bf16 v[28:31], v[52:55], v[44:47], v[28:31]
    v_add_u32 v232, s52, v233
    v_add_u32 v235, s52, v239
    v_mfma_f32_16x16x32_bf16 v[32:35], v[56:59], v[44:47], v[32:35]
    v_add_u32 v236, s52, v240
    v_add_u32 v237, s52, v241
    v_mfma_f32_16x16x32_bf16 v[36:39], v[60:63], v[44:47], v[36:39]
    v_add_u32 v238, s52, v242
    s_waitcnt lgkmcnt(0)
    v_mfma_f32_16x16x32_bf16 v[8:11], v[72:75], v[64:67], v[8:11]
    s_waitcnt vmcnt(7)
    s_barrier
    v_mfma_f32_16x16x32_bf16 v[12:15], v[76:79], v[64:67], v[12:15]
    ds_read_b128 v[40:43], v232 offset:0
    ds_read_b64_tr_b16 v[48:49], v235 offset:0
    ds_read_b64_tr_b16 v[50:51], v235 offset:2048
    v_mfma_f32_16x16x32_bf16 v[16:19], v[80:83], v[64:67], v[16:19]
    ds_read_b64_tr_b16 v[52:53], v236 offset:0
    ds_read_b64_tr_b16 v[54:55], v236 offset:2048
    v_mfma_f32_16x16x32_bf16 v[20:23], v[84:87], v[64:67], v[20:23]
    ds_read_b64_tr_b16 v[56:57], v237 offset:0
    ds_read_b64_tr_b16 v[58:59], v237 offset:2048
    ds_read_b64_tr_b16 v[60:61], v238 offset:0
    v_mfma_f32_16x16x32_bf16 v[24:27], v[72:75], v[68:71], v[24:27]
    ds_read_b64_tr_b16 v[62:63], v238 offset:2048
    ds_read_b128 v[44:47], v232 offset:2048
    v_mfma_f32_16x16x32_bf16 v[28:31], v[76:79], v[68:71], v[28:31]
    v_mfma_f32_16x16x32_bf16 v[32:35], v[80:83], v[68:71], v[32:35]
    s_add_u32 s52, s52, 24576
    s_cmp_ge_u32 s52, 147456
    s_cselect_b32 s52, 0, s52
    v_mfma_f32_16x16x32_bf16 v[36:39], v[84:87], v[68:71], v[36:39]
    s_waitcnt lgkmcnt(0)
    v_mfma_f32_16x16x32_bf16 v[8:11], v[48:51], v[40:43], v[8:11]
    ds_read_b128 v[64:67], v232 offset:1024
    ds_read_b64_tr_b16 v[72:73], v235 offset:4096
    v_mfma_f32_16x16x32_bf16 v[12:15], v[52:55], v[40:43], v[12:15]
    ds_read_b64_tr_b16 v[74:75], v235 offset:6144
    ds_read_b64_tr_b16 v[76:77], v236 offset:4096
    v_mfma_f32_16x16x32_bf16 v[16:19], v[56:59], v[40:43], v[16:19]
    ds_read_b64_tr_b16 v[78:79], v236 offset:6144
    ds_read_b64_tr_b16 v[80:81], v237 offset:4096
    v_mfma_f32_16x16x32_bf16 v[20:23], v[60:63], v[40:43], v[20:23]
    ds_read_b64_tr_b16 v[82:83], v237 offset:6144
    ds_read_b64_tr_b16 v[84:85], v238 offset:4096
    v_mfma_f32_16x16x32_bf16 v[24:27], v[48:51], v[44:47], v[24:27]
    ds_read_b64_tr_b16 v[86:87], v238 offset:6144
    ds_read_b128 v[68:71], v232 offset:3072
    v_mfma_f32_16x16x32_bf16 v[28:31], v[52:55], v[44:47], v[28:31]
    v_add_u32 v232, s52, v233
    v_add_u32 v235, s52, v239
    v_mfma_f32_16x16x32_bf16 v[32:35], v[56:59], v[44:47], v[32:35]
    v_add_u32 v236, s52, v240
    v_add_u32 v237, s52, v241
    v_mfma_f32_16x16x32_bf16 v[36:39], v[60:63], v[44:47], v[36:39]
    v_add_u32 v238, s52, v242
    s_waitcnt lgkmcnt(0)
    v_mfma_f32_16x16x32_bf16 v[8:11], v[72:75], v[64:67], v[8:11]
    s_waitcnt vmcnt(5)
    s_barrier
    v_mfma_f32_16x16x32_bf16 v[12:15], v[76:79], v[64:67], v[12:15]
    ds_read_b128 v[40:43], v232 offset:0
    ds_read_b64_tr_b16 v[48:49], v235 offset:0
    ds_read_b64_tr_b16 v[50:51], v235 offset:2048
    v_mfma_f32_16x16x32_bf16 v[16:19], v[80:83], v[64:67], v[16:19]
    ds_read_b64_tr_b16 v[52:53], v236 offset:0
    ds_read_b64_tr_b16 v[54:55], v236 offset:2048
    v_mfma_f32_16x16x32_bf16 v[20:23], v[84:87], v[64:67], v[20:23]
    ds_read_b64_tr_b16 v[56:57], v237 offset:0
    ds_read_b64_tr_b16 v[58:59], v237 offset:2048
    ds_read_b64_tr_b16 v[60:61], v238 offset:0
    v_mfma_f32_16x16x32_bf16 v[24:27], v[72:75], v[68:71], v[24:27]
    ds_read_b64_tr_b16 v[62:63], v238 offset:2048
    ds_read_b128 v[44:47], v232 offset:2048
    v_mfma_f32_16x16x32_bf16 v[28:31], v[76:79], v[68:71], v[28:31]
    v_mfma_f32_16x16x32_bf16 v[32:35], v[80:83], v[68:71], v[32:35]
    s_add_u32 s52, s52, 24576
    s_cmp_ge_u32 s52, 147456
    s_cselect_b32 s52, 0, s52
    v_mfma_f32_16x16x32_bf16 v[36:39], v[84:87], v[68:71], v[36:39]
    s_waitcnt lgkmcnt(0)
    v_mfma_f32_16x16x32_bf16 v[8:11], v[48:51], v[40:43], v[8:11]
    ds_read_b128 v[64:67], v232 offset:1024
    ds_read_b64_tr_b16 v[72:73], v235 offset:4096
    v_mfma_f32_16x16x32_bf16 v[12:15], v[52:55], v[40:43], v[12:15]
    ds_read_b64_tr_b16 v[74:75], v235 offset:6144
    ds_read_b64_tr_b16 v[76:77], v236 offset:4096
    v_mfma_f32_16x16x32_bf16 v[16:19], v[56:59], v[40:43], v[16:19]
    ds_read_b64_tr_b16 v[78:79], v236 offset:6144
    ds_read_b64_tr_b16 v[80:81], v237 offset:4096
    v_mfma_f32_16x16x32_bf16 v[20:23], v[60:63], v[40:43], v[20:23]
    ds_read_b64_tr_b16 v[82:83], v237 offset:6144
    ds_read_b64_tr_b16 v[84:85], v238 offset:4096
    v_mfma_f32_16x16x32_bf16 v[24:27], v[48:51], v[44:47], v[24:27]
    ds_read_b64_tr_b16 v[86:87], v238 offset:6144
    ds_read_b128 v[68:71], v232 offset:3072
    v_mfma_f32_16x16x32_bf16 v[28:31], v[52:55], v[44:47], v[28:31]
    v_add_u32 v232, s52, v233
    v_add_u32 v235, s52, v239
    v_mfma_f32_16x16x32_bf16 v[32:35], v[56:59], v[44:47], v[32:35]
    v_add_u32 v236, s52, v240
    v_add_u32 v237, s52, v241
    v_mfma_f32_16x16x32_bf16 v[36:39], v[60:63], v[44:47], v[36:39]
    v_add_u32 v238, s52, v242
    s_waitcnt lgkmcnt(0)
    v_mfma_f32_16x16x32_bf16 v[8:11], v[72:75], v[64:67], v[8:11]
    s_waitcnt vmcnt(3)
    s_barrier
    v_mfma_f32_16x16x32_bf16 v[12:15], v[76:79], v[64:67], v[12:15]
    ds_read_b128 v[40:43], v232 offset:0
    ds_read_b64_tr_b16 v[48:49], v235 offset:0
    ds_read_b64_tr_b16 v[50:51], v235 offset:2048
    v_mfma_f32_16x16x32_bf16 v[16:19], v[80:83], v[64:67], v[16:19]
    ds_read_b64_tr_b16 v[52:53], v236 offset:0
    ds_read_b64_tr_b16 v[54:55], v236 offset:2048
    v_mfma_f32_16x16x32_bf16 v[20:23], v[84:87], v[64:67], v[20:23]
    ds_read_b64_tr_b16 v[56:57], v237 offset:0
    ds_read_b64_tr_b16 v[58:59], v237 offset:2048
    ds_read_b64_tr_b16 v[60:61], v238 offset:0
    v_mfma_f32_16x16x32_bf16 v[24:27], v[72:75], v[68:71], v[24:27]
    ds_read_b64_tr_b16 v[62:63], v238 offset:2048
    ds_read_b128 v[44:47], v232 offset:2048
    v_mfma_f32_16x16x32_bf16 v[28:31], v[76:79], v[68:71], v[28:31]
    v_mfma_f32_16x16x32_bf16 v[32:35], v[80:83], v[68:71], v[32:35]
    s_add_u32 s52, s52, 24576
    s_cmp_ge_u32 s52, 147456
    s_cselect_b32 s52, 0, s52
    v_mfma_f32_16x16x32_bf16 v[36:39], v[84:87], v[68:71], v[36:39]
    s_waitcnt lgkmcnt(0)
    v_mfma_f32_16x16x32_bf16 v[8:11], v[48:51], v[40:43], v[8:11]
    ds_read_b128 v[64:67], v232 offset:1024
    ds_read_b64_tr_b16 v[72:73], v235 offset:4096
    v_mfma_f32_16x16x32_bf16 v[12:15], v[52:55], v[40:43], v[12:15]
    ds_read_b64_tr_b16 v[74:75], v235 offset:6144
    ds_read_b64_tr_b16 v[76:77], v236 offset:4096
    v_mfma_f32_16x16x32_bf16 v[16:19], v[56:59], v[40:43], v[16:19]
    ds_read_b64_tr_b16 v[78:79], v236 offset:6144
    ds_read_b64_tr_b16 v[80:81], v237 offset:4096
    v_mfma_f32_16x16x32_bf16 v[20:23], v[60:63], v[40:43], v[20:23]
    ds_read_b64_tr_b16 v[82:83], v237 offset:6144
    ds_read_b64_tr_b16 v[84:85], v238 offset:4096
    v_mfma_f32_16x16x32_bf16 v[24:27], v[48:51], v[44:47], v[24:27]
    ds_read_b64_tr_b16 v[86:87], v238 offset:6144
    ds_read_b128 v[68:71], v232 offset:3072
    v_mfma_f32_16x16x32_bf16 v[28:31], v[52:55], v[44:47], v[28:31]
    v_add_u32 v232, s52, v233
    v_add_u32 v235, s52, v239
    v_mfma_f32_16x16x32_bf16 v[32:35], v[56:59], v[44:47], v[32:35]
    v_add_u32 v236, s52, v240
    v_add_u32 v237, s52, v241
    v_mfma_f32_16x16x32_bf16 v[36:39], v[60:63], v[44:47], v[36:39]
    v_add_u32 v238, s52, v242
    s_waitcnt lgkmcnt(0)
    v_mfma_f32_16x16x32_bf16 v[8:11], v[72:75], v[64:67], v[8:11]
    s_waitcnt vmcnt(1)
    s_barrier
    v_mfma_f32_16x16x32_bf16 v[12:15], v[76:79], v[64:67], v[12:15]
    ds_read_b128 v[40:43], v232 offset:0
    ds_read_b64_tr_b16 v[48:49], v235 offset:0
    ds_read_b64_tr_b16 v[50:51], v235 offset:2048
    v_mfma_f32_16x16x32_bf16 v[16:19], v[80:83], v[64:67], v[16:19]
    ds_read_b64_tr_b16 v[52:53], v236 offset:0
    ds_read_b64_tr_b16 v[54:55], v236 offset:2048
    v_mfma_f32_16x16x32_bf16 v[20:23], v[84:87], v[64:67], v[20:23]
    ds_read_b64_tr_b16 v[56:57], v237 offset:0
    ds_read_b64_tr_b16 v[58:59], v237 offset:2048
    ds_read_b64_tr_b16 v[60:61], v238 offset:0
    v_mfma_f32_16x16x32_bf16 v[24:27], v[72:75], v[68:71], v[24:27]
    ds_read_b64_tr_b16 v[62:63], v238 offset:2048
    ds_read_b128 v[44:47], v232 offset:2048
    v_mfma_f32_16x16x32_bf16 v[28:31], v[76:79], v[68:71], v[28:31]
    v_mfma_f32_16x16x32_bf16 v[32:35], v[80:83], v[68:71], v[32:35]
    s_add_u32 s52, s52, 24576
    s_cmp_ge_u32 s52, 147456
    s_cselect_b32 s52, 0, s52
    v_mfma_f32_16x16x32_bf16 v[36:39], v[84:87], v[68:71], v[36:39]
    s_waitcnt lgkmcnt(0)
    v_mfma_f32_16x16x32_bf16 v[8:11], v[48:51], v[40:43], v[8:11]
    ds_read_b128 v[64:67], v232 offset:1024
    ds_read_b64_tr_b16 v[72:73], v235 offset:4096
    v_mfma_f32_16x16x32_bf16 v[12:15], v[52:55], v[40:43], v[12:15]
    ds_read_b64_tr_b16 v[74:75], v235 offset:6144
    ds_read_b64_tr_b16 v[76:77], v236 offset:4096
    v_mfma_f32_16x16x32_bf16 v[16:19], v[56:59], v[40:43], v[16:19]
    ds_read_b64_tr_b16 v[78:79], v236 offset:6144
    ds_read_b64_tr_b16 v[80:81], v237 offset:4096
    v_mfma_f32_16x16x32_bf16 v[20:23], v[60:63], v[40:43], v[20:23]
    ds_read_b64_tr_b16 v[82:83], v237 offset:6144
    ds_read_b64_tr_b16 v[84:85], v238 offset:4096
    v_mfma_f32_16x16x32_bf16 v[24:27], v[48:51], v[44:47], v[24:27]
    s_movk_i32 s54, 6
M_Q_loop1:
    ds_read_b64_tr_b16 v[86:87], v238 offset:6144
    ds_read_b128 v[68:71], v232 offset:3072
    v_mfma_f32_16x16x32_bf16 v[28:31], v[52:55], v[44:47], v[28:31]
    v_add_u32 v232, s52, v233
    v_add_u32 v235, s52, v239
    v_mfma_f32_16x16x32_bf16 v[32:35], v[56:59], v[44:47], v[32:35]
    v_add_u32 v236, s52, v240
    v_add_u32 v237, s52, v241
    v_mfma_f32_16x16x32_bf16 v[36:39], v[60:63], v[44:47], v[36:39]
    v_add_u32 v238, s52, v242
    s_waitcnt lgkmcnt(0)
    v_mfma_f32_16x16x32_bf16 v[8:11], v[72:75], v[64:67], v[8:11]
    s_barrier
    v_mfma_f32_16x16x32_bf16 v[12:15], v[76:79], v[64:67], v[12:15]
    ds_read_b128 v[40:43], v232 offset:0
    ds_read_b64_tr_b16 v[48:49], v235 offset:0
    ds_read_b64_tr_b16 v[50:51], v235 offset:2048
    v_mfma_f32_16x16x32_bf16 v[16:19], v[80:83], v[64:67], v[16:19]
    ds_read_b64_tr_b16 v[52:53], v236 offset:0
    ds_read_b64_tr_b16 v[54:55], v236 offset:2048
    v_mfma_f32_16x16x32_bf16 v[20:23], v[84:87], v[64:67], v[20:23]
    ds_read_b64_tr_b16 v[56:57], v237 offset:0
    ds_read_b64_tr_b16 v[58:59], v237 offset:2048
    ds_read_b64_tr_b16 v[60:61], v238 offset:0
    v_mfma_f32_16x16x32_bf16 v[24:27], v[72:75], v[68:71], v[24:27]
    ds_read_b64_tr_b16 v[62:63], v238 offset:2048
    ds_read_b128 v[44:47], v232 offset:2048
    v_mfma_f32_16x16x32_bf16 v[28:31], v[76:79], v[68:71], v[28:31]
    v_mfma_f32_16x16x32_bf16 v[32:35], v[80:83], v[68:71], v[32:35]
    s_add_u32 s52, s52, 24576
    s_cmp_ge_u32 s52, 147456
    s_cselect_b32 s52, 0, s52
    v_mfma_f32_16x16x32_bf16 v[36:39], v[84:87], v[68:71], v[36:39]
    s_waitcnt lgkmcnt(0)
    v_mfma_f32_16x16x32_bf16 v[8:11], v[48:51], v[40:43], v[8:11]
    ds_read_b128 v[64:67], v232 offset:1024
    ds_read_b64_tr_b16 v[72:73], v235 offset:4096
    v_mfma_f32_16x16x32_bf16 v[12:15], v[52:55], v[40:43], v[12:15]
    ds_read_b64_tr_b16 v[74:75], v235 offset:6144
    ds_read_b64_tr_b16 v[76:77], v236 offset:4096
    v_mfma_f32_16x16x32_bf16 v[16:19], v[56:59], v[40:43], v[16:19]
    ds_read_b64_tr_b16 v[78:79], v236 offset:6144
    ds_read_b64_tr_b16 v[80:81], v237 offset:4096
    v_mfma_f32_16x16x32_bf16 v[20:23], v[60:63], v[40:43], v[20:23]
    s_sub_u32 s54, s54, 1
    ds_read_b64_tr_b16 v[82:83], v237 offset:6144
    ds_read_b64_tr_b16 v[84:85], v238 offset:4096
    v_mfma_f32_16x16x32_bf16 v[24:27], v[48:51], v[44:47], v[24:27]
    s_cbranch_scc0 M_Q_loop1
    ds_read_b64_tr_b16 v[86:87], v238 offset:6144
    ds_read_b128 v[68:71], v232 offset:3072
    v_mfma_f32_16x16x32_bf16 v[28:31], v[52:55], v[44:47], v[28:31]
    v_add_u32 v232, s52, v233
    v_add_u32 v235, s52, v239
    v_mfma_f32_16x16x32_bf16 v[32:35], v[56:59], v[44:47], v[32:35]
    v_add_u32 v236, s52, v240
    v_add_u32 v237, s52, v241
    v_mfma_f32_16x16x32_bf16 v[36:39], v[60:63], v[44:47], v[36:39]
    v_add_u32 v238, s52, v242
    s_waitcnt lgkmcnt(0)
    v_mfma_f32_16x16x32_bf16 v[8:11], v[72:75], v[64:67], v[8:11]
    s_barrier
    v_mfma_f32_16x16x32_bf16 v[12:15], v[76:79], v[64:67], v[12:15]
    ds_read_b128 v[40:43], v232 offset:0
    ds_read_b64_tr_b16 v[48:49], v235 offset:0
    ds_read_b64_tr_b16 v[50:51], v235 offset:2048
    v_mfma_f32_16x16x32_bf16 v[16:19], v[80:83], v[64:67], v[16:19]
    ds_read_b64_tr_b16 v[52:53], v236 offset:0
    ds_read_b64_tr_b16 v[54:55], v236 offset:2048
    v_mfma_f32_16x16x32_bf16 v[20:23], v[84:87], v[64:67], v[20:23]
    ds_read_b64_tr_b16 v[56:57], v237 offset:0
    ds_read_b64_tr_b16 v[58:59], v237 offset:2048
    ds_read_b64_tr_b16 v[60:61], v238 offset:0
    v_mfma_f32_16x16x32_bf16 v[24:27], v[72:75], v[68:71], v[24:27]
    ds_read_b64_tr_b16 v[62:63], v238 offset:2048
    ds_read_b128 v[44:47], v232 offset:2048
    v_mfma_f32_16x16x32_bf16 v[28:31], v[76:79], v[68:71], v[28:31]
    v_mfma_f32_16x16x32_bf16 v[32:35], v[80:83], v[68:71], v[32:35]
    s_add_u32 s52, s52, 24576
    s_cmp_ge_u32 s52, 147456
    s_cselect_b32 s52, 0, s52
    v_mfma_f32_16x16x32_bf16 v[36:39], v[84:87], v[68:71], v[36:39]
    s_waitcnt lgkmcnt(0)
    v_mfma_f32_16x16x32_bf16 v[8:11], v[48:51], v[40:43], v[8:11]
    ds_read_b128 v[64:67], v232 offset:1024
    ds_read_b64_tr_b16 v[72:73], v235 offset:4096
    v_mfma_f32_16x16x32_bf16 v[12:15], v[52:55], v[40:43], v[12:15]
    ds_read_b64_tr_b16 v[74:75], v235 offset:6144
    ds_read_b64_tr_b16 v[76:77], v236 offset:4096
    ds_read_b128 v[136:139], v199 offset:0
    v_mfma_f32_16x16x32_bf16 v[16:19], v[56:59], v[40:43], v[16:19]
    ds_read_b64_tr_b16 v[78:79], v236 offset:6144
    ds_read_b64_tr_b16 v[80:81], v237 offset:4096
    ds_read_b128 v[140:143], v199 offset:64
    v_mfma_f32_16x16x32_bf16 v[20:23], v[60:63], v[40:43], v[20:23]
    ds_read_b64_tr_b16 v[82:83], v237 offset:6144
    ds_read_b64_tr_b16 v[84:85], v238 offset:4096
    v_mfma_f32_16x16x32_bf16 v[24:27], v[48:51], v[44:47], v[24:27]
    ds_read_b64_tr_b16 v[86:87], v238 offset:6144
    ds_read_b128 v[68:71], v232 offset:3072
    ds_read_b128 v[144:147], v199 offset:128
    v_mfma_f32_16x16x32_bf16 v[28:31], v[52:55], v[44:47], v[28:31]
    v_add_u32 v232, s52, v233
    v_add_u32 v235, s52, v239
    v_mfma_f32_16x16x32_bf16 v[32:35], v[56:59], v[44:47], v[32:35]
    v_add_u32 v236, s52, v240
    v_add_u32 v237, s52, v241
    ds_read_b128 v[148:151], v199 offset:192
    v_mfma_f32_16x16x32_bf16 v[36:39], v[60:63], v[44:47], v[36:39]
    v_add_u32 v238, s52, v242
    s_waitcnt lgkmcnt(0)
    v_mfma_f32_16x16x32_bf16 v[8:11], v[72:75], v[64:67], v[8:11]
    s_barrier
    v_mfma_f32_16x16x32_bf16 v[12:15], v[76:79], v[64:67], v[12:15]
    ds_read_b128 v[40:43], v232 offset:0
    ds_read_b64_tr_b16 v[48:49], v235 offset:0
    ds_read_b64_tr_b16 v[50:51], v235 offset:2048
    ds_read_b128 v[152:155], v199 offset:256
    v_mfma_f32_16x16x32_bf16 v[16:19], v[80:83], v[64:67], v[16:19]
    ds_read_b64_tr_b16 v[52:53], v236 offset:0
    ds_read_b64_tr_b16 v[54:55], v236 offset:2048
    ds_read_b128 v[156:159], v199 offset:320
    v_mfma_f32_16x16x32_bf16 v[20:23], v[84:87], v[64:67], v[20:23]
    ds_read_b64_tr_b16 v[56:57], v237 offset:0
    ds_read_b64_tr_b16 v[58:59], v237 offset:2048
    ds_read_b64_tr_b16 v[60:61], v238 offset:0
    v_mfma_f32_16x16x32_bf16 v[24:27], v[72:75], v[68:71], v[24:27]
    ds_read_b64_tr_b16 v[62:63], v238 offset:2048
    ds_read_b128 v[44:47], v232 offset:2048
    ds_read_b128 v[160:163], v199 offset:384
    v_mfma_f32_16x16x32_bf16 v[28:31], v[76:79], v[68:71], v[28:31]
    v_mfma_f32_16x16x32_bf16 v[32:35], v[80:83], v[68:71], v[32:35]
    s_add_u32 s52, s52, 24576
    s_cmp_ge_u32 s52, 147456
    s_cselect_b32 s52, 0, s52
    ds_read_b128 v[164:167], v199 offset:448
    v_mfma_f32_16x16x32_bf16 v[36:39], v[84:87], v[68:71], v[36:39]
    s_waitcnt lgkmcnt(0)
    v_mfma_f32_16x16x32_bf16 v[8:11], v[48:51], v[40:43], v[8:11]
    ds_read_b128 v[64:67], v232 offset:1024
    ds_read_b64_tr_b16 v[72:73], v235 offset:4096
    v_mfma_f32_16x16x32_bf16 v[12:15], v[52:55], v[40:43], v[12:15]
    ds_read_b64_tr_b16 v[74:75], v235 offset:6144
    ds_read_b64_tr_b16 v[76:77], v236 offset:4096
    ds_read_b128 v[168:171], v199 offset:512
    v_mfma_f32_16x16x32_bf16 v[16:19], v[56:59], v[40:43], v[16:19]
    ds_read_b64_tr_b16 v[78:79], v236 offset:6144
    ds_read_b64_tr_b16 v[80:81], v237 offset:4096
    ds_read_b128 v[172:175], v199 offset:576
    v_mfma_f32_16x16x32_bf16 v[20:23], v[60:63], v[40:43], v[20:23]
    ds_read_b64_tr_b16 v[82:83], v237 offset:6144
    ds_read_b64_tr_b16 v[84:85], v238 offset:4096
    v_mfma_f32_16x16x32_bf16 v[24:27], v[48:51], v[44:47], v[24:27]
    ds_read_b64_tr_b16 v[86:87], v238 offset:6144
    ds_read_b128 v[68:71], v232 offset:3072
    ds_read_b128 v[176:179], v199 offset:640
    v_mfma_f32_16x16x32_bf16 v[28:31], v[52:55], v[44:47], v[28:31]
    v_add_u32 v232, s52, v233
    v_add_u32 v235, s52, v239
    v_mfma_f32_16x16x32_bf16 v[32:35], v[56:59], v[44:47], v[32:35]
    v_add_u32 v236, s52, v240
    v_add_u32 v237, s52, v241
    ds_read_b128 v[180:183], v199 offset:704
    v_mfma_f32_16x16x32_bf16 v[36:39], v[60:63], v[44:47], v[36:39]
    v_add_u32 v238, s52, v242
    s_waitcnt lgkmcnt(0)
    v_mfma_f32_16x16x32_bf16 v[8:11], v[72:75], v[64:67], v[8:11]
    s_barrier
    v_mfma_f32_16x16x32_bf16 v[12:15], v[76:79], v[64:67], v[12:15]
    ds_read_b128 v[40:43], v232 offset:0
    ds_read_b64_tr_b16 v[48:49], v235 offset:0
    ds_read_b64_tr_b16 v[50:51], v235 offset:2048
    v_mfma_f32_16x16x32_bf16 v[16:19], v[80:83], v[64:67], v[16:19]
    ds_read_b64_tr_b16 v[52:53], v236 offset:0
    ds_read_b64_tr_b16 v[54:55], v236 offset:2048
    v_mfma_f32_16x16x32_bf16 v[20:23], v[84:87], v[64:67], v[20:23]
    ds_read_b64_tr_b16 v[56:57], v237 offset:0
    ds_read_b64_tr_b16 v[58:59], v237 offset:2048
    ds_read_b64_tr_b16 v[60:61], v238 offset:0
    v_mfma_f32_16x16x32_bf16 v[24:27], v[72:75], v[68:71], v[24:27]
    ds_read_b64_tr_b16 v[62:63], v238 offset:2048
    ds_read_b128 v[44:47], v232 offset:2048
    v_mfma_f32_16x16x32_bf16 v[28:31], v[76:79], v[68:71], v[28:31]
    v_mfma_f32_16x16x32_bf16 v[32:35], v[80:83], v[68:71], v[32:35]
    s_add_u32 s52, s52, 24576
    s_cmp_ge_u32 s52, 147456
    s_cselect_b32 s52, 0, s52
    v_mfma_f32_16x16x32_bf16 v[36:39], v[84:87], v[68:71], v[36:39]
    s_waitcnt lgkmcnt(0)
    v_mfma_f32_16x16x32_bf16 v[8:11], v[48:51], v[40:43], v[8:11]
    ds_read_b128 v[64:67], v232 offset:1024
    ds_read_b64_tr_b16 v[72:73], v235 offset:4096
    v_mfma_f32_16x16x32_bf16 v[12:15], v[52:55], v[40:43], v[12:15]
    ds_read_b64_tr_b16 v[74:75], v235 offset:6144
    ds_read_b64_tr_b16 v[76:77], v236 offset:4096
    v_mfma_f32_16x16x32_bf16 v[16:19], v[56:59], v[40:43], v[16:19]
    ds_read_b64_tr_b16 v[78:79], v236 offset:6144
    ds_read_b64_tr_b16 v[80:81], v237 offset:4096
    v_mfma_f32_16x16x32_bf16 v[20:23], v[60:63], v[40:43], v[20:23]
    ds_read_b64_tr_b16 v[82:83], v237 offset:6144
    ds_read_b64_tr_b16 v[84:85], v238 offset:4096
    v_mfma_f32_16x16x32_bf16 v[24:27], v[48:51], v[44:47], v[24:27]
    ds_read_b64_tr_b16 v[86:87], v238 offset:6144
    ds_read_b128 v[68:71], v232 offset:3072
    v_mfma_f32_16x16x32_bf16 v[28:31], v[52:55], v[44:47], v[28:31]
    v_mfma_f32_16x16x32_bf16 v[32:35], v[56:59], v[44:47], v[32:35]
    v_mfma_f32_16x16x32_bf16 v[36:39], v[60:63], v[44:47], v[36:39]
    s_waitcnt lgkmcnt(0)
    v_mfma_f32_16x16x32_bf16 v[8:11], v[72:75], v[64:67], v[8:11]
    s_barrier
    v_mfma_f32_16x16x32_bf16 v[12:15], v[76:79], v[64:67], v[12:15]
    v_mfma_f32_16x16x32_bf16 v[16:19], v[80:83], v[64:67], v[16:19]
    v_mfma_f32_16x16x32_bf16 v[20:23], v[84:87], v[64:67], v[20:23]
    v_mfma_f32_16x16x32_bf16 v[24:27], v[72:75], v[68:71], v[24:27]
    v_mfma_f32_16x16x32_bf16 v[28:31], v[76:79], v[68:71], v[28:31]
    v_mfma_f32_16x16x32_bf16 v[32:35], v[80:83], v[68:71], v[32:35]
    v_mfma_f32_16x16x32_bf16 v[36:39], v[84:87], v[68:71], v[36:39]
    v_pk_fma_f32 v[104:105], v[8:9], v[136:137], v[104:105]
    v_pk_fma_f32 v[106:107], v[10:11], v[138:139], v[106:107]
    v_pk_fma_f32 v[108:109], v[12:13], v[140:141], v[108:109]
    v_pk_fma_f32 v[110:111], v[14:15], v[142:143], v[110:111]
    v_pk_fma_f32 v[112:113], v[16:17], v[144:145], v[112:113]
    v_pk_fma_f32 v[114:115], v[18:19], v[146:147], v[114:115]
    v_pk_fma_f32 v[116:117], v[20:21], v[148:149], v[116:117]
    v_pk_fma_f32 v[118:119], v[22:23], v[150:151], v[118:119]
    v_pk_fma_f32 v[120:121], v[24:25], v[136:137], v[120:121]
    v_pk_fma_f32 v[122:123], v[26:27], v[138:139], v[122:123]
    v_pk_fma_f32 v[124:125], v[28:29], v[140:141], v[124:125]
    v_pk_fma_f32 v[126:127], v[30:31], v[142:143], v[126:127]
    v_pk_fma_f32 v[128:129], v[32:33], v[144:145], v[128:129]
    v_pk_fma_f32 v[130:131], v[34:35], v[146:147], v[130:131]
    v_pk_fma_f32 v[132:133], v[36:37], v[148:149], v[132:133]
    v_pk_fma_f32 v[134:135], v[38:39], v[150:151], v[134:135]
    v_cvt_pk_bf16_f32 v88, v104, v105
    v_cvt_pk_bf16_f32 v89, v106, v107
    v_cvt_pk_bf16_f32 v90, v108, v109
    v_cvt_pk_bf16_f32 v91, v110, v111
    v_cvt_pk_bf16_f32 v92, v112, v113
    v_cvt_pk_bf16_f32 v93, v114, v115
    v_cvt_pk_bf16_f32 v94, v116, v117
    v_cvt_pk_bf16_f32 v95, v118, v119
    v_cvt_pk_bf16_f32 v96, v120, v121
    v_cvt_pk_bf16_f32 v97, v122, v123
    v_cvt_pk_bf16_f32 v98, v124, v125
    v_cvt_pk_bf16_f32 v99, v126, v127
    v_cvt_pk_bf16_f32 v100, v128, v129
    v_cvt_pk_bf16_f32 v101, v130, v131
    v_cvt_pk_bf16_f32 v102, v132, v133
    v_cvt_pk_bf16_f32 v103, v134, v135
    v_lshlrev_b32 v104, 16, v88
    v_and_b32 v105, 0xffff0000, v88
    v_lshlrev_b32 v106, 16, v89
    v_and_b32 v107, 0xffff0000, v89
    v_lshlrev_b32 v108, 16, v90
    v_and_b32 v109, 0xffff0000, v90
    v_lshlrev_b32 v110, 16, v91
    v_and_b32 v111, 0xffff0000, v91
    v_lshlrev_b32 v112, 16, v92
    v_and_b32 v113, 0xffff0000, v92
    v_lshlrev_b32 v114, 16, v93
    v_and_b32 v115, 0xffff0000, v93
    v_lshlrev_b32 v116, 16, v94
    v_and_b32 v117, 0xffff0000, v94
    v_lshlrev_b32 v118, 16, v95
    v_and_b32 v119, 0xffff0000, v95
    v_lshlrev_b32 v120, 16, v96
    v_and_b32 v121, 0xffff0000, v96
    v_lshlrev_b32 v122, 16, v97
    v_and_b32 v123, 0xffff0000, v97
    v_lshlrev_b32 v124, 16, v98
    v_and_b32 v125, 0xffff0000, v98
    v_lshlrev_b32 v126, 16, v99
    v_and_b32 v127, 0xffff0000, v99
    v_lshlrev_b32 v128, 16, v100
    v_and_b32 v129, 0xffff0000, v100
    v_lshlrev_b32 v130, 16, v101
    v_and_b32 v131, 0xffff0000, v101
    v_lshlrev_b32 v132, 16, v102
    v_and_b32 v133, 0xffff0000, v102
    v_lshlrev_b32 v134, 16, v103
    v_and_b32 v135, 0xffff0000, v103
    v_pk_add_f32 v[40:41], v[104:105], v[106:107]
    v_pk_mul_f32 v[44:45], v[104:105], v[104:105]
    v_pk_add_f32 v[42:43], v[120:121], v[122:123]
    v_pk_mul_f32 v[46:47], v[120:121], v[120:121]
    v_pk_fma_f32 v[44:45], v[106:107], v[106:107], v[44:45]
    v_pk_fma_f32 v[46:47], v[122:123], v[122:123], v[46:47]
    v_pk_add_f32 v[40:41], v[40:41], v[108:109]
    v_pk_fma_f32 v[44:45], v[108:109], v[108:109], v[44:45]
    v_pk_add_f32 v[42:43], v[42:43], v[124:125]
    v_pk_fma_f32 v[46:47], v[124:125], v[124:125], v[46:47]
    v_pk_add_f32 v[40:41], v[40:41], v[110:111]
    v_pk_fma_f32 v[44:45], v[110:111], v[110:111], v[44:45]
    v_pk_add_f32 v[42:43], v[42:43], v[126:127]
    v_pk_fma_f32 v[46:47], v[126:127], v[126:127], v[46:47]
    v_pk_add_f32 v[40:41], v[40:41], v[112:113]
    v_pk_fma_f32 v[44:45], v[112:113], v[112:113], v[44:45]
    v_pk_add_f32 v[42:43], v[42:43], v[128:129]
    v_pk_fma_f32 v[46:47], v[128:129], v[128:129], v[46:47]
    v_pk_add_f32 v[40:41], v[40:41], v[114:115]
    v_pk_fma_f32 v[44:45], v[114:115], v[114:115], v[44:45]
    v_pk_add_f32 v[42:43], v[42:43], v[130:131]
    v_pk_fma_f32 v[46:47], v[130:131], v[130:131], v[46:47]
    v_pk_add_f32 v[40:41], v[40:41], v[116:117]
    v_pk_fma_f32 v[44:45], v[116:117], v[116:117], v[44:45]
    v_pk_add_f32 v[42:43], v[42:43], v[132:133]
    v_pk_fma_f32 v[46:47], v[132:133], v[132:133], v[46:47]
    v_pk_add_f32 v[40:41], v[40:41], v[118:119]
    v_pk_fma_f32 v[44:45], v[118:119], v[118:119], v[44:45]
    v_pk_add_f32 v[42:43], v[42:43], v[134:135]
    v_pk_fma_f32 v[46:47], v[134:135], v[134:135], v[46:47]
    v_add_f32 v40, v40, v41
    v_add_f32 v42, v42, v43
    v_add_f32 v44, v44, v45
    v_add_f32 v46, v46, v47
    v_permlane16_swap_b32 v40, v42
    s_nop 0
    v_permlane16_swap_b32 v44, v46
    v_add_f32 v48, v40, v42
    v_add_f32 v49, v44, v46
    v_mov_b32 v50, v48
    v_mov_b32 v51, v49
    s_nop 0
    v_permlane32_swap_b32 v48, v50
    v_permlane32_swap_b32 v49, v51
    v_add_f32 v48, v48, v50
    v_add_f32 v49, v49, v51
    s_mov_b32 exec_hi, 0
    buffer_store_dwordx2 v[48:49], v195, s[28:31], 0 offen sc1
    s_mov_b32 exec_hi, -1
    buffer_store_dwordx4 v[88:91], v197, s[28:31], s72 offen offset:0 sc1
    buffer_store_dwordx4 v[92:95], v197, s[28:31], s72 offen offset:1024 sc1
    buffer_store_dwordx4 v[96:99], v197, s[28:31], s73 offen offset:0 sc1
    buffer_store_dwordx4 v[100:103], v197, s[28:31], s73 offen offset:1024 sc1
    s_waitcnt vmcnt(0)
    buffer_load_dwordx2 v[56:57], v198, s[28:31], 0 offen offset:0 sc1
    buffer_load_dwordx2 v[58:59], v198, s[28:31], 0 offen offset:512 sc1
    buffer_load_dwordx2 v[60:61], v198, s[28:31], 0 offen offset:1024 sc1
    buffer_load_dwordx2 v[62:63], v198, s[28:31], 0 offen offset:1536 sc1
    buffer_load_dwordx2 v[64:65], v198, s[28:31], 0 offen offset:2048 sc1
    buffer_load_dwordx2 v[66:67], v198, s[28:31], 0 offen offset:2560 sc1
    buffer_load_dwordx2 v[68:69], v198, s[28:31], 0 offen offset:3072 sc1
    buffer_load_dwordx2 v[70:71], v198, s[28:31], 0 offen offset:3584 sc1
    s_waitcnt vmcnt(0)
    s_mov_b32 s3, 0x40000
M_sp_chk:
    v_cmp_eq_u32 s[80:81], -1, v57
    v_cmp_eq_u32 s[82:83], -1, v59
    v_cmp_eq_u32 s[84:85], -1, v61
    v_cmp_eq_u32 s[86:87], -1, v63
    v_cmp_eq_u32 s[88:89], -1, v65
    v_cmp_eq_u32 s[90:91], -1, v67
    v_cmp_eq_u32 s[92:93], -1, v69
    v_cmp_eq_u32 s[94:95], -1, v71
    v_max3_u32 v52, v57, v59, v61
    v_max3_u32 v53, v63, v65, v67
    v_max3_u32 v52, v52, v69, v71
    v_max_u32 v52, v52, v53
    v_cmp_eq_u32 vcc, -1, v52
    s_nop 4
    s_cbranch_vccz M_sp_ok
    s_sub_u32 s3, s3, 1
    s_cbranch_scc1 M_sp_ok
    s_mov_b64 exec, s[80:81]
    buffer_load_dwordx2 v[56:57], v198, s[28:31], 0 offen offset:0 sc1
    s_mov_b64 exec, s[82:83]
    buffer_load_dwordx2 v[58:59], v198, s[28:31], 0 offen offset:512 sc1
    s_mov_b64 exec, s[84:85]
    buffer_load_dwordx2 v[60:61], v198, s[28:31], 0 offen offset:1024 sc1
    s_mov_b64 exec, s[86:87]
    buffer_load_dwordx2 v[62:63], v198, s[28:31], 0 offen offset:1536 sc1
    s_mov_b64 exec, s[88:89]
    buffer_load_dwordx2 v[64:65], v198, s[28:31], 0 offen offset:2048 sc1
    s_mov_b64 exec, s[90:91]
    buffer_load_dwordx2 v[66:67], v198, s[28:31], 0 offen offset:2560 sc1
    s_mov_b64 exec, s[92:93]
    buffer_load_dwordx2 v[68:69], v198, s[28:31], 0 offen offset:3072 sc1
    s_mov_b64 exec, s[94:95]
    buffer_load_dwordx2 v[70:71], v198, s[28:31], 0 offen offset:3584 sc1
    s_mov_b64 exec, -1
    s_waitcnt vmcnt(0)
    s_branch M_sp_chk
M_sp_ok:
    v_pk_add_f32 v[56:57], v[56:57], v[58:59]
    v_pk_add_f32 v[60:61], v[60:61], v[62:63]
    v_pk_add_f32 v[64:65], v[64:65], v[66:67]
    v_pk_add_f32 v[68:69], v[68:69], v[70:71]
    v_pk_add_f32 v[56:57], v[56:57], v[60:61]
    v_pk_add_f32 v[64:65], v[64:65], v[68:69]
    v_pk_add_f32 v[56:57], v[56:57], v[64:65]
    v_mov_b32 v50, v56
    v_mov_b32 v51, v57
    s_nop 0
    v_permlane32_swap_b32 v56, v50
    v_permlane32_swap_b32 v57, v51
    v_add_f32 v56, v56, v50
    v_add_f32 v57, v57, v51
    v_mul_f32 v56, 0x3a800000, v56
    v_mul_f32 v57, 0x3a800000, v57
    v_fma_f32 v57, -v56, v56, v57
    v_max_f32 v57, 0, v57
    v_cvt_pk_bf16_f32 v50, v56, v57
    v_lshlrev_b32 v56, 16, v50
    v_and_b32 v57, 0xffff0000, v50
    v_add_f32 v57, 0x3727c5ac, v57
    v_cvt_pk_bf16_f32 v50, v57, v57
    v_lshlrev_b32 v57, 16, v50
    v_sqrt_f32 v57, v57
    s_nop 0
    v_cvt_pk_bf16_f32 v50, v57, v57
    v_lshlrev_b32 v57, 16, v50
    v_rcp_f32 v40, v57
    s_nop 0
    v_mul_f32 v44, -v56, v40
    v_mov_b32 v42, v40
    v_mov_b32 v46, v44
    s_nop 0
    v_permlane16_swap_b32 v40, v42
    v_permlane16_swap_b32 v44, v46
    v_pk_fma_f32 v[104:105], v[104:105], v[40:41], v[44:45] op_sel_hi:[1,0,0]
    v_pk_fma_f32 v[106:107], v[106:107], v[40:41], v[44:45] op_sel_hi:[1,0,0]
    v_pk_fma_f32 v[108:109], v[108:109], v[40:41], v[44:45] op_sel_hi:[1,0,0]
    v_pk_fma_f32 v[110:111], v[110:111], v[40:41], v[44:45] op_sel_hi:[1,0,0]
    v_pk_fma_f32 v[112:113], v[112:113], v[40:41], v[44:45] op_sel_hi:[1,0,0]
    v_pk_fma_f32 v[114:115], v[114:115], v[40:41], v[44:45] op_sel_hi:[1,0,0]
    v_pk_fma_f32 v[116:117], v[116:117], v[40:41], v[44:45] op_sel_hi:[1,0,0]
    v_pk_fma_f32 v[118:119], v[118:119], v[40:41], v[44:45] op_sel_hi:[1,0,0]
    v_pk_fma_f32 v[104:105], v[104:105], v[168:169], v[152:153]
    v_pk_fma_f32 v[106:107], v[106:107], v[170:171], v[154:155]
    v_pk_fma_f32 v[108:109], v[108:109], v[172:173], v[156:157]
    v_pk_fma_f32 v[110:111], v[110:111], v[174:175], v[158:159]
    v_pk_fma_f32 v[112:113], v[112:113], v[176:177], v[160:161]
    v_pk_fma_f32 v[114:115], v[114:115], v[178:179], v[162:163]
    v_pk_fma_f32 v[116:117], v[116:117], v[180:181], v[164:165]
    v_pk_fma_f32 v[118:119], v[118:119], v[182:183], v[166:167]
    v_cvt_pk_bf16_f32 v72, v104, v105
    v_cvt_pk_bf16_f32 v73, v106, v107
    v_cvt_pk_bf16_f32 v74, v108, v109
    v_cvt_pk_bf16_f32 v75, v110, v111
    buffer_store_dwordx4 v[72:75], v197, s[28:31], s74 offen offset:0 sc1
    ds_write_b128 v233, v[72:75] offset:0
    v_cvt_pk_bf16_f32 v76, v112, v113
    v_cvt_pk_bf16_f32 v77, v114, v115
    v_cvt_pk_bf16_f32 v78, v116, v117
    v_cvt_pk_bf16_f32 v79, v118, v119
    buffer_store_dwordx4 v[76:79], v197, s[28:31], s74 offen offset:1024 sc1
    ds_write_b128 v233, v[76:79] offset:1024
    v_pk_fma_f32 v[120:121], v[120:121], v[42:43], v[46:47] op_sel_hi:[1,0,0]
    v_pk_fma_f32 v[122:123], v[122:123], v[42:43], v[46:47] op_sel_hi:[1,0,0]
    v_pk_fma_f32 v[124:125], v[124:125], v[42:43], v[46:47] op_sel_hi:[1,0,0]
    v_pk_fma_f32 v[126:127], v[126:127], v[42:43], v[46:47] op_sel_hi:[1,0,0]
    v_pk_fma_f32 v[128:129], v[128:129], v[42:43], v[46:47] op_sel_hi:[1,0,0]
    v_pk_fma_f32 v[130:131], v[130:131], v[42:43], v[46:47] op_sel_hi:[1,0,0]
    v_pk_fma_f32 v[132:133], v[132:133], v[42:43], v[46:47] op_sel_hi:[1,0,0]
    v_pk_fma_f32 v[134:135], v[134:135], v[42:43], v[46:47] op_sel_hi:[1,0,0]
    v_pk_fma_f32 v[120:121], v[120:121], v[168:169], v[152:153]
    v_pk_fma_f32 v[122:123], v[122:123], v[170:171], v[154:155]
    v_pk_fma_f32 v[124:125], v[124:125], v[172:173], v[156:157]
    v_pk_fma_f32 v[126:127], v[126:127], v[174:175], v[158:159]
    v_pk_fma_f32 v[128:129], v[128:129], v[176:177], v[160:161]
    v_pk_fma_f32 v[130:131], v[130:131], v[178:179], v[162:163]
    v_pk_fma_f32 v[132:133], v[132:133], v[180:181], v[164:165]
    v_pk_fma_f32 v[134:135], v[134:135], v[182:183], v[166:167]
    v_cvt_pk_bf16_f32 v80, v120, v121
    v_cvt_pk_bf16_f32 v81, v122, v123
    v_cvt_pk_bf16_f32 v82, v124, v125
    v_cvt_pk_bf16_f32 v83, v126, v127
    buffer_store_dwordx4 v[80:83], v197, s[28:31], s75 offen offset:0 sc1
    ds_write_b128 v233, v[80:83] offset:2048
    v_cvt_pk_bf16_f32 v84, v128, v129
    v_cvt_pk_bf16_f32 v85, v130, v131
    v_cvt_pk_bf16_f32 v86, v132, v133
    v_cvt_pk_bf16_f32 v87, v134, v135
    buffer_store_dwordx4 v[84:87], v197, s[28:31], s75 offen offset:1024 sc1
    ds_write_b128 v233, v[84:87] offset:3072
    s_waitcnt lgkmcnt(0)
    s_barrier
    s_and_b32 s57, s58, 15
    s_lshr_b64 s[58:59], s[58:59], 4
    s_lshl_b32 s56, s57, 11
    s_mul_i32 s57, s57, 0x70000
    s_add_u32 s53, s53, 49152
    s_cmp_ge_u32 s53, s61
    s_cselect_b32 s53, s60, s53
    s_and_b32 s57, s58, 15
    s_lshr_b64 s[58:59], s[58:59], 4
    s_lshl_b32 s56, s57, 11
    s_mul_i32 s57, s57, 0x70000
    s_add_u32 m0, s53, 16384
    s_nop 0
    buffer_load_dwordx4 v208, s[32:35], s57 offen offset:0 lds
    buffer_load_dwordx4 v209, s[32:35], s57 offen offset:1024 lds
    buffer_load_dwordx4 v210, s[32:35], s57 offen offset:2048 lds
    buffer_load_dwordx4 v211, s[32:35], s57 offen offset:3072 lds
    s_add_u32 m0, s53, 32768
    s_nop 0
    buffer_load_dwordx4 v208, s[36:39], s57 offen offset:0 lds
    buffer_load_dwordx4 v209, s[36:39], s57 offen offset:1024 lds
    buffer_load_dwordx4 v210, s[36:39], s57 offen offset:2048 lds
    buffer_load_dwordx4 v211, s[36:39], s57 offen offset:3072 lds
    s_add_u32 s53, s53, 49152
    s_cmp_ge_u32 s53, s61
    s_cselect_b32 s53, s60, s53
    s_lshl_b32 s60, s44, 12
    s_add_u32 s61, s60, 147456
    s_add_u32 s53, s60, 0
    s_bfe_u32 s66, s2, 0x30003
    s_lshr_b32 s55, s2, 6
    s_add_u32 s66, s66, s55
    s_and_b32 s66, s66, 3
    s_mov_b32 s58, 0x76453210
    s_mov_b32 s59, 0xfecdba89
    s_cmp_eq_u32 s66, 1
    s_cselect_b32 s58, 0x75643120, s58
    s_cselect_b32 s59, 0xfdecb9a8, s59
    s_cmp_eq_u32 s66, 2
    s_cselect_b32 s58, 0x67542310, s58
    s_cselect_b32 s59, 0xefdcab98, s59
    s_cmp_eq_u32 s66, 3
    s_cselect_b32 s58, 0x86534210, s58
    s_cselect_b32 s59, 0xfedbca97, s59
    s_and_b32 s66, s48, 15
    s_lshl_b32 s55, s66, 2
    s_lshr_b64 s[56:57], s[58:59], s55
    s_and_b32 s55, s56, 15
    s_lshl_b32 s55, s55, 2
    s_lshl_b64 s[56:57], 15, s55
    s_andn2_b64 s[58:59], s[58:59], s[56:57]
    s_or_b32 s58, s58, s66
    s_mov_b32 s32, s12
    s_mov_b32 s33, s13
    s_mov_b32 s34, 0x700000
    s_mov_b32 s35, 0x20000
    s_mov_b32 s36, s14
    s_mov_b32 s37, s15
    s_mov_b32 s38, 0x700000
    s_mov_b32 s39, 0x20000
    s_lshl_b32 s68, s47, 9
    s_add_u32 s68, s68, 0x56000
    s_add_u32 s62, s26, s68
    s_addc_u32 s63, s27, 0
    s_lshr_b32 s68, s48, 2
    s_lshl_b32 s68, s68, 7
    v_mov_b32 v2, 1
    v_mov_b32 v5, 148488
    s_waitcnt vmcnt(8)
    s_mov_b64 exec, 1
    ds_add_rtn_u32 v245, v5, v2
    s_mov_b64 exec, -1
    s_mov_b32 s1, s0
    s_lshl_b32 s64, s48, 2
    s_waitcnt lgkmcnt(0)
    v_readfirstlane_b32 s3, v245
    s_nop 3
    s_cmp_lg_u32 s3, 3
    s_cbranch_scc1 M_ph_ok
    s_atomic_swap s0, s[62:63], s64 offset:0
    s_atomic_swap s0, s[62:63], s64 offset:128
    s_atomic_swap s0, s[62:63], s64 offset:256
    s_atomic_swap s0, s[62:63], s64 offset:384
    s_mov_b32 s3, 0x40000
M_ph_chk:
    s_load_dwordx16 s[80:95], s[62:63], s68 glc
    s_sub_u32 s3, s3, 1
    s_cbranch_scc1 M_ph_ok
M_ph_c2:
    s_waitcnt lgkmcnt(0)
    s_xor_b64 s[80:81], s[80:81], s[0:1]
    s_xor_b64 s[82:83], s[82:83], s[0:1]
    s_xor_b64 s[84:85], s[84:85], s[0:1]
    s_xor_b64 s[86:87], s[86:87], s[0:1]
    s_xor_b64 s[88:89], s[88:89], s[0:1]
    s_xor_b64 s[90:91], s[90:91], s[0:1]
    s_xor_b64 s[92:93], s[92:93], s[0:1]
    s_xor_b64 s[94:95], s[94:95], s[0:1]
    s_or_b64 s[80:81], s[80:81], s[82:83]
    s_or_b64 s[84:85], s[84:85], s[86:87]
    s_or_b64 s[88:89], s[88:89], s[90:91]
    s_or_b64 s[92:93], s[92:93], s[94:95]
    s_or_b64 s[80:81], s[80:81], s[84:85]
    s_or_b64 s[88:89], s[88:89], s[92:93]
    s_or_b64 s[80:81], s[80:81], s[88:89]
    s_cbranch_scc1 M_ph_chk
M_ph_ok:
    s_barrier
    s_setprio 0
    s_and_b32 s57, s58, 15
    s_lshr_b64 s[58:59], s[58:59], 4
    s_lshl_b32 s56, s57, 11
    s_mul_i32 s57, s57, 0x70000
    s_add_u32 s53, s53, 49152
    s_cmp_ge_u32 s53, s61
    s_cselect_b32 s53, s60, s53
    s_and_b32 s57, s58, 15
    s_lshr_b64 s[58:59], s[58:59], 4
    s_lshl_b32 s56, s57, 11
    s_mul_i32 s57, s57, 0x70000
    s_mov_b32 m0, s53
    s_nop 0
    buffer_load_dwordx4 v206, s[28:31], s56 offen offset:0 sc1 lds
    buffer_load_dwordx4 v206, s[28:31], s56 offen offset:1024 sc1 lds
    buffer_load_dwordx4 v207, s[28:31], s56 offen offset:2048 sc1 lds
    buffer_load_dwordx4 v207, s[28:31], s56 offen offset:3072 sc1 lds
    s_add_u32 s53, s53, 49152
    s_cmp_ge_u32 s53, s61
    s_cselect_b32 s53, s60, s53
    s_and_b32 s57, s58, 15
    s_lshr_b64 s[58:59], s[58:59], 4
    s_lshl_b32 s56, s57, 11
    s_mul_i32 s57, s57, 0x70000
    s_add_u32 m0, s53, 16384
    s_nop 0
    buffer_load_dwordx4 v208, s[32:35], s57 offen offset:0 lds
    buffer_load_dwordx4 v209, s[32:35], s57 offen offset:1024 lds
    buffer_load_dwordx4 v210, s[32:35], s57 offen offset:2048 lds
    buffer_load_dwordx4 v211, s[32:35], s57 offen offset:3072 lds
    s_add_u32 m0, s53, 32768
    s_nop 0
    buffer_load_dwordx4 v208, s[36:39], s57 offen offset:0 lds
    buffer_load_dwordx4 v209, s[36:39], s57 offen offset:1024 lds
    buffer_load_dwordx4 v210, s[36:39], s57 offen offset:2048 lds
    buffer_load_dwordx4 v211, s[36:39], s57 offen offset:3072 lds
    s_mov_b32 m0, s53
    s_nop 0
    buffer_load_dwordx4 v206, s[28:31], s56 offen offset:0 sc1 lds
    buffer_load_dwordx4 v206, s[28:31], s56 offen offset:1024 sc1 lds
    buffer_load_dwordx4 v207, s[28:31], s56 offen offset:2048 sc1 lds
    buffer_load_dwordx4 v207, s[28:31], s56 offen offset:3072 sc1 lds
    s_add_u32 s53, s53, 49152
    s_cmp_ge_u32 s53, s61
    s_cselect_b32 s53, s60, s53
    s_lshl_b32 s64, s45, 13
    v_lshl_add_u32 v233, v1, 4, s64
    v_lshrrev_b32 v2, 2, v1
    v_lshlrev_b32 v4, 8, v2
    v_and_b32 v5, 3, v1
    v_lshl_add_u32 v4, v5, 3, v4
    v_add_u32 v4, 16384, v4
    v_and_b32 v2, 7, v2
    s_lshl_b32 s64, s46, 2
    v_xor_b32 v2, s64, v2
    v_xor_b32 v3, 0, v2
    v_lshl_add_u32 v239, v3, 5, v4
    v_xor_b32 v3, 1, v2
    v_lshl_add_u32 v240, v3, 5, v4
    v_xor_b32 v3, 2, v2
    v_lshl_add_u32 v241, v3, 5, v4
    v_xor_b32 v3, 3, v2
    v_lshl_add_u32 v242, v3, 5, v4
    s_mov_b32 s52, 49152
    v_add_u32 v232, s52, v233
    v_add_u32 v235, s52, v239
    v_add_u32 v236, s52, v240
    v_add_u32 v237, s52, v241
    v_add_u32 v238, s52, v242
    s_lshl_b32 s64, s2, 2
    s_add_u32 s64, s64, s44
    s_mul_i32 s64, s64, 7168
    s_add_u32 s64, s64, 5248
    s_add_u32 s10, s12, s64
    s_addc_u32 s11, s13, 0
    s_add_u32 s24, s14, s64
    s_addc_u32 s25, s15, 0
    s_movk_i32 s54, 10
M_Q_loop2:
    s_waitcnt vmcnt(12)
    s_barrier
    s_and_b32 s57, s58, 15
    s_lshr_b64 s[58:59], s[58:59], 4
    s_lshl_b32 s56, s57, 11
    s_mul_i32 s57, s57, 0x70000
    s_add_u32 m0, s53, 16384
    s_nop 0
    buffer_load_dwordx4 v208, s[32:35], s57 offen offset:0 lds
    buffer_load_dwordx4 v209, s[32:35], s57 offen offset:1024 lds
    buffer_load_dwordx4 v210, s[32:35], s57 offen offset:2048 lds
    buffer_load_dwordx4 v211, s[32:35], s57 offen offset:3072 lds
    s_add_u32 m0, s53, 32768
    s_nop 0
    buffer_load_dwordx4 v208, s[36:39], s57 offen offset:0 lds
    buffer_load_dwordx4 v209, s[36:39], s57 offen offset:1024 lds
    buffer_load_dwordx4 v210, s[36:39], s57 offen offset:2048 lds
    buffer_load_dwordx4 v211, s[36:39], s57 offen offset:3072 lds
    s_mov_b32 m0, s53
    s_nop 0
    buffer_load_dwordx4 v206, s[28:31], s56 offen offset:0 sc1 lds
    buffer_load_dwordx4 v206, s[28:31], s56 offen offset:1024 sc1 lds
    buffer_load_dwordx4 v207, s[28:31], s56 offen offset:2048 sc1 lds
    buffer_load_dwordx4 v207, s[28:31], s56 offen offset:3072 sc1 lds
    s_add_u32 s53, s53, 49152
    s_cmp_ge_u32 s53, s61
    s_cselect_b32 s53, s60, s53
    s_sub_u32 s54, s54, 1
    s_cbranch_scc0 M_Q_loop2
    s_waitcnt vmcnt(12)
    s_barrier
    s_mov_b64 exec, 1
    buffer_load_dword v244, v246, s[28:31], 0 offen sc1
    s_mov_b64 exec, -1
    s_and_b32 s57, s58, 15
    s_lshr_b64 s[58:59], s[58:59], 4
    s_lshl_b32 s56, s57, 11
    s_mul_i32 s57, s57, 0x70000
    s_add_u32 m0, s53, 16384
    s_nop 0
    buffer_load_dwordx4 v208, s[32:35], s57 offen offset:0 lds
    buffer_load_dwordx4 v209, s[32:35], s57 offen offset:1024 lds
    buffer_load_dwordx4 v210, s[32:35], s57 offen offset:2048 lds
    buffer_load_dwordx4 v211, s[32:35], s57 offen offset:3072 lds
    s_add_u32 m0, s53, 32768
    s_nop 0
    buffer_load_dwordx4 v208, s[36:39], s57 offen offset:0 lds
    buffer_load_dwordx4 v209, s[36:39], s57 offen offset:1024 lds
    buffer_load_dwordx4 v210, s[36:39], s57 offen offset:2048 lds
    buffer_load_dwordx4 v211, s[36:39], s57 offen offset:3072 lds
    s_mov_b32 m0, s53
    s_nop 0
    buffer_load_dwordx4 v206, s[28:31], s56 offen offset:0 sc1 lds
    buffer_load_dwordx4 v206, s[28:31], s56 offen offset:1024 sc1 lds
    buffer_load_dwordx4 v207, s[28:31], s56 offen offset:2048 sc1 lds
    buffer_load_dwordx4 v207, s[28:31], s56 offen offset:3072 sc1 lds
    s_add_u32 s53, s53, 49152
    s_cmp_ge_u32 s53, s61
    s_cselect_b32 s53, s60, s53
    s_waitcnt vmcnt(13)
    s_barrier
    s_and_b32 s57, s58, 15
    s_lshr_b64 s[58:59], s[58:59], 4
    s_lshl_b32 s56, s57, 11
    s_mul_i32 s57, s57, 0x70000
    s_add_u32 m0, s53, 16384
    s_nop 0
    buffer_load_dwordx4 v208, s[32:35], s57 offen offset:0 lds
    buffer_load_dwordx4 v209, s[32:35], s57 offen offset:1024 lds
    buffer_load_dwordx4 v210, s[32:35], s57 offen offset:2048 lds
    buffer_load_dwordx4 v211, s[32:35], s57 offen offset:3072 lds
    s_add_u32 m0, s53, 32768
    s_nop 0
    buffer_load_dwordx4 v208, s[36:39], s57 offen offset:0 lds
    buffer_load_dwordx4 v209, s[36:39], s57 offen offset:1024 lds
    buffer_load_dwordx4 v210, s[36:39], s57 offen offset:2048 lds
    buffer_load_dwordx4 v211, s[36:39], s57 offen offset:3072 lds
    s_mov_b32 m0, s53
    s_nop 0
    buffer_load_dwordx4 v206, s[28:31], s56 offen offset:0 sc1 lds
    buffer_load_dwordx4 v206, s[28:31], s56 offen offset:1024 sc1 lds
    buffer_load_dwordx4 v207, s[28:31], s56 offen offset:2048 sc1 lds
    buffer_load_dwordx4 v207, s[28:31], s56 offen offset:3072 sc1 lds
    s_add_u32 s53, s53, 49152
    s_cmp_ge_u32 s53, s61
    s_cselect_b32 s53, s60, s53
    s_waitcnt vmcnt(12)
    s_barrier
    s_bfe_u32 s66, s2, 0x30003
    s_lshr_b32 s55, s2, 6
    s_add_u32 s66, s66, s55
    s_mul_i32 s55, s66, 11
    s_lshr_b32 s55, s55, 5
    s_mul_i32 s55, s55, 3
    s_sub_u32 s66, s66, s55
    s_mov_b32 s58, 0x67534201
    s_mov_b32 s59, 0xfecdb9a8
    s_cmp_eq_u32 s66, 1
    s_cselect_b32 s58, 0x86453120, s58
    s_cselect_b32 s59, 0xfdecab97, s59
    s_cmp_eq_u32 s66, 2
    s_cselect_b32 s58, 0x75642310, s58
    s_cselect_b32 s59, 0xefdbca89, s59
    v_or_b32 v206, s69, v206
    v_or_b32 v207, s69, v207
    s_and_b32 s57, s58, 15
    s_lshr_b64 s[58:59], s[58:59], 4
    s_lshl_b32 s56, s57, 11
    s_mul_i32 s57, s57, 0x70000
    s_add_u32 m0, s53, 16384
    s_nop 0
    buffer_load_dwordx4 v212, s[32:35], s57 offen offset:0 lds
    buffer_load_dwordx4 v213, s[32:35], s57 offen offset:1024 lds
    buffer_load_dwordx4 v214, s[32:35], s57 offen offset:2048 lds
    buffer_load_dwordx4 v215, s[32:35], s57 offen offset:3072 lds
    s_add_u32 m0, s53, 32768
    s_nop 0
    buffer_load_dwordx4 v212, s[36:39], s57 offen offset:0 lds
    buffer_load_dwordx4 v213, s[36:39], s57 offen offset:1024 lds
    buffer_load_dwordx4 v214, s[36:39], s57 offen offset:2048 lds
    buffer_load_dwordx4 v215, s[36:39], s57 offen offset:3072 lds
    s_mov_b32 m0, s53
    s_nop 0
    buffer_load_dwordx4 v206, s[28:31], s56 offen offset:0 sc1 lds
    buffer_load_dwordx4 v206, s[28:31], s56 offen offset:1024 sc1 lds
    buffer_load_dwordx4 v207, s[28:31], s56 offen offset:2048 sc1 lds
    buffer_load_dwordx4 v207, s[28:31], s56 offen offset:3072 sc1 lds
    s_add_u32 s53, s53, 49152
    s_cmp_ge_u32 s53, s61
    s_cselect_b32 s53, s60, s53
    s_waitcnt vmcnt(12)
    s_barrier
    s_and_b32 s57, s58, 15
    s_lshr_b64 s[58:59], s[58:59], 4
    s_lshl_b32 s56, s57, 11
    s_mul_i32 s57, s57, 0x70000
    s_add_u32 m0, s53, 16384
    s_nop 0
    buffer_load_dwordx4 v212, s[32:35], s57 offen offset:0 lds
    buffer_load_dwordx4 v213, s[32:35], s57 offen offset:1024 lds
    buffer_load_dwordx4 v214, s[32:35], s57 offen offset:2048 lds
    buffer_load_dwordx4 v215, s[32:35], s57 offen offset:3072 lds
    s_add_u32 m0, s53, 32768
    s_nop 0
    buffer_load_dwordx4 v212, s[36:39], s57 offen offset:0 lds
    buffer_load_dwordx4 v213, s[36:39], s57 offen offset:1024 lds
    buffer_load_dwordx4 v214, s[36:39], s57 offen offset:2048 lds
    buffer_load_dwordx4 v215, s[36:39], s57 offen offset:3072 lds
    s_mov_b32 m0, s53
    s_nop 0
    buffer_load_dwordx4 v206, s[28:31], s56 offen offset:0 sc1 lds
    buffer_load_dwordx4 v206, s[28:31], s56 offen offset:1024 sc1 lds
    buffer_load_dwordx4 v207, s[28:31], s56 offen offset:2048 sc1 lds
    buffer_load_dwordx4 v207, s[28:31], s56 offen offset:3072 sc1 lds
    s_add_u32 s53, s53, 49152
    s_cmp_ge_u32 s53, s61
    s_cselect_b32 s53, s60, s53
    s_waitcnt vmcnt(12)
    s_barrier
    s_cmp_lg_u32 s69, 0
    s_cbranch_scc1 M_Qidle
    ds_read_b128 v[136:139], v232 offset:0
    ds_read_b64_tr_b16 v[152:153], v235 offset:0
    ds_read_b64_tr_b16 v[154:155], v235 offset:4096
    ds_read_b64_tr_b16 v[156:157], v236 offset:0
    ds_read_b64_tr_b16 v[158:159], v236 offset:4096
    ds_read_b64_tr_b16 v[160:161], v237 offset:0
    ds_read_b64_tr_b16 v[162:163], v237 offset:4096
    ds_read_b64_tr_b16 v[164:165], v238 offset:0
    ds_read_b64_tr_b16 v[166:167], v238 offset:4096
    ds_read_b64_tr_b16 v[168:169], v235 offset:16384
    ds_read_b64_tr_b16 v[170:171], v235 offset:20480
    ds_read_b64_tr_b16 v[172:173], v236 offset:16384
    ds_read_b64_tr_b16 v[174:175], v236 offset:20480
    ds_read_b64_tr_b16 v[176:177], v237 offset:16384
    ds_read_b64_tr_b16 v[178:179], v237 offset:20480
    ds_read_b64_tr_b16 v[180:181], v238 offset:16384
    ds_read_b64_tr_b16 v[182:183], v238 offset:20480
    ds_read_b128 v[140:143], v232 offset:2048
    ds_read_b128 v[144:147], v232 offset:4096
    ds_read_b128 v[148:151], v232 offset:6144
    s_and_b32 s57, s58, 15
    s_lshr_b64 s[58:59], s[58:59], 4
    s_lshl_b32 s56, s57, 11
    s_mul_i32 s57, s57, 0x70000
    s_add_u32 m0, s53, 16384
    s_nop 0
    buffer_load_dwordx4 v212, s[32:35], s57 offen offset:0 lds
    buffer_load_dwordx4 v213, s[32:35], s57 offen offset:1024 lds
    buffer_load_dwordx4 v214, s[32:35], s57 offen offset:2048 lds
    buffer_load_dwordx4 v215, s[32:35], s57 offen offset:3072 lds
    s_add_u32 m0, s53, 32768
    s_nop 0
    buffer_load_dwordx4 v212, s[36:39], s57 offen offset:0 lds
    buffer_load_dwordx4 v213, s[36:39], s57 offen offset:1024 lds
    buffer_load_dwordx4 v214, s[36:39], s57 offen offset:2048 lds
    buffer_load_dwordx4 v215, s[36:39], s57 offen offset:3072 lds
    s_mov_b32 m0, s53
    s_nop 0
    buffer_load_dwordx4 v206, s[28:31], s56 offen offset:0 sc1 lds
    buffer_load_dwordx4 v206, s[28:31], s56 offen offset:1024 sc1 lds
    buffer_load_dwordx4 v207, s[28:31], s56 offen offset:2048 sc1 lds
    buffer_load_dwordx4 v207, s[28:31], s56 offen offset:3072 sc1 lds
    s_add_u32 s53, s53, 49152
    s_cmp_ge_u32 s53, s61
    s_cselect_b32 s53, s60, s53
    s_setprio 2
    s_add_u32 s52, s52, 49152
    s_cmp_ge_u32 s52, 147456
    s_cselect_b32 s52, 0, s52
    s_waitcnt lgkmcnt(0)
    v_mfma_f32_16x16x32_bf16 v[8:11], v[152:155], v[136:139], 0
    ds_read_b128 v[184:187], v232 offset:1024
    v_mfma_f32_16x16x32_bf16 v[12:15], v[156:159], v[136:139], 0
    ds_read_b64_tr_b16 v[200:201], v235 offset:8192
    v_mfma_f32_16x16x32_bf16 v[16:19], v[160:163], v[136:139], 0
    ds_read_b64_tr_b16 v[202:203], v235 offset:12288
    v_mfma_f32_16x16x32_bf16 v[20:23], v[164:167], v[136:139], 0
    ds_read_b64_tr_b16 v[204:205], v236 offset:8192
    v_mfma_f32_16x16x32_bf16 v[24:27], v[168:171], v[136:139], 0
    v_mfma_f32_16x16x32_bf16 v[28:31], v[172:175], v[136:139], 0
    ds_read_b64_tr_b16 v[206:207], v236 offset:12288
    v_mfma_f32_16x16x32_bf16 v[32:35], v[176:179], v[136:139], 0
    ds_read_b64_tr_b16 v[208:209], v237 offset:8192
    v_mfma_f32_16x16x32_bf16 v[36:39], v[180:183], v[136:139], 0
    ds_read_b64_tr_b16 v[210:211], v237 offset:12288
    v_mfma_f32_16x16x32_bf16 v[40:43], v[152:155], v[140:143], 0
    ds_read_b64_tr_b16 v[212:213], v238 offset:8192
    v_mfma_f32_16x16x32_bf16 v[44:47], v[156:159], v[140:143], 0
    v_mfma_f32_16x16x32_bf16 v[48:51], v[160:163], v[140:143], 0
    ds_read_b64_tr_b16 v[214:215], v238 offset:12288
    v_mfma_f32_16x16x32_bf16 v[52:55], v[164:167], v[140:143], 0
    ds_read_b64_tr_b16 v[216:217], v235 offset:24576
    v_mfma_f32_16x16x32_bf16 v[56:59], v[168:171], v[140:143], 0
    ds_read_b64_tr_b16 v[218:219], v235 offset:28672
    v_mfma_f32_16x16x32_bf16 v[60:63], v[172:175], v[140:143], 0
    ds_read_b64_tr_b16 v[220:221], v236 offset:24576
    v_mfma_f32_16x16x32_bf16 v[64:67], v[176:179], v[140:143], 0
    v_mfma_f32_16x16x32_bf16 v[68:71], v[180:183], v[140:143], 0
    ds_read_b64_tr_b16 v[222:223], v236 offset:28672
    v_mfma_f32_16x16x32_bf16 v[72:75], v[152:155], v[144:147], 0
    ds_read_b64_tr_b16 v[224:225], v237 offset:24576
    v_mfma_f32_16x16x32_bf16 v[76:79], v[156:159], v[144:147], 0
    ds_read_b64_tr_b16 v[226:227], v237 offset:28672
    v_mfma_f32_16x16x32_bf16 v[80:83], v[160:163], v[144:147], 0
    ds_read_b64_tr_b16 v[228:229], v238 offset:24576
    v_mfma_f32_16x16x32_bf16 v[84:87], v[164:167], v[144:147], 0
    v_mfma_f32_16x16x32_bf16 v[88:91], v[168:171], v[144:147], 0
    ds_read_b64_tr_b16 v[230:231], v238 offset:28672
    v_mfma_f32_16x16x32_bf16 v[92:95], v[172:175], v[144:147], 0
    ds_read_b128 v[188:191], v232 offset:3072
    v_mfma_f32_16x16x32_bf16 v[96:99], v[176:179], v[144:147], 0
    ds_read_b128 v[192:195], v232 offset:5120
    v_mfma_f32_16x16x32_bf16 v[100:103], v[180:183], v[144:147], 0
    ds_read_b128 v[196:199], v232 offset:7168
    v_mfma_f32_16x16x32_bf16 v[104:107], v[152:155], v[148:151], 0
    v_mfma_f32_16x16x32_bf16 v[108:111], v[156:159], v[148:151], 0
    v_add_u32 v232, s52, v233
    v_mfma_f32_16x16x32_bf16 v[112:115], v[160:163], v[148:151], 0
    v_add_u32 v235, s52, v239
    v_mfma_f32_16x16x32_bf16 v[116:119], v[164:167], v[148:151], 0
    v_add_u32 v236, s52, v240
    v_mfma_f32_16x16x32_bf16 v[120:123], v[168:171], v[148:151], 0
    v_mfma_f32_16x16x32_bf16 v[124:127], v[172:175], v[148:151], 0
    v_add_u32 v237, s52, v241
    v_mfma_f32_16x16x32_bf16 v[128:131], v[176:179], v[148:151], 0
    v_add_u32 v238, s52, v242
    v_mfma_f32_16x16x32_bf16 v[132:135], v[180:183], v[148:151], 0
    s_waitcnt lgkmcnt(0)
    v_mfma_f32_16x16x32_bf16 v[8:11], v[200:203], v[184:187], v[8:11]
    s_waitcnt vmcnt(12)
    s_barrier
    v_mfma_f32_16x16x32_bf16 v[12:15], v[204:207], v[184:187], v[12:15]
    ds_read_b128 v[136:139], v232 offset:0
    v_mfma_f32_16x16x32_bf16 v[16:19], v[208:211], v[184:187], v[16:19]
    ds_read_b64_tr_b16 v[152:153], v235 offset:0
    v_mfma_f32_16x16x32_bf16 v[20:23], v[212:215], v[184:187], v[20:23]
    ds_read_b64_tr_b16 v[154:155], v235 offset:4096
    v_mfma_f32_16x16x32_bf16 v[24:27], v[216:219], v[184:187], v[24:27]
    ds_read_b64_tr_b16 v[156:157], v236 offset:0
    v_mfma_f32_16x16x32_bf16 v[28:31], v[220:223], v[184:187], v[28:31]
    ds_read_b64_tr_b16 v[158:159], v236 offset:4096
    v_mfma_f32_16x16x32_bf16 v[32:35], v[224:227], v[184:187], v[32:35]
    v_mfma_f32_16x16x32_bf16 v[36:39], v[228:231], v[184:187], v[36:39]
    ds_read_b64_tr_b16 v[160:161], v237 offset:0
    v_mfma_f32_16x16x32_bf16 v[40:43], v[200:203], v[188:191], v[40:43]
    ds_read_b64_tr_b16 v[162:163], v237 offset:4096
    v_mfma_f32_16x16x32_bf16 v[44:47], v[204:207], v[188:191], v[44:47]
    ds_read_b64_tr_b16 v[164:165], v238 offset:0
    v_mfma_f32_16x16x32_bf16 v[48:51], v[208:211], v[188:191], v[48:51]
    ds_read_b64_tr_b16 v[166:167], v238 offset:4096
    v_mfma_f32_16x16x32_bf16 v[52:55], v[212:215], v[188:191], v[52:55]
    ds_read_b64_tr_b16 v[168:169], v235 offset:16384
    v_mfma_f32_16x16x32_bf16 v[56:59], v[216:219], v[188:191], v[56:59]
    v_mfma_f32_16x16x32_bf16 v[60:63], v[220:223], v[188:191], v[60:63]
    ds_read_b64_tr_b16 v[170:171], v235 offset:20480
    v_mfma_f32_16x16x32_bf16 v[64:67], v[224:227], v[188:191], v[64:67]
    ds_read_b64_tr_b16 v[172:173], v236 offset:16384
    v_mfma_f32_16x16x32_bf16 v[68:71], v[228:231], v[188:191], v[68:71]
    ds_read_b64_tr_b16 v[174:175], v236 offset:20480
    v_mfma_f32_16x16x32_bf16 v[72:75], v[200:203], v[192:195], v[72:75]
    ds_read_b64_tr_b16 v[176:177], v237 offset:16384
    v_mfma_f32_16x16x32_bf16 v[76:79], v[204:207], v[192:195], v[76:79]
    ds_read_b64_tr_b16 v[178:179], v237 offset:20480
    v_mfma_f32_16x16x32_bf16 v[80:83], v[208:211], v[192:195], v[80:83]
    v_mfma_f32_16x16x32_bf16 v[84:87], v[212:215], v[192:195], v[84:87]
    ds_read_b64_tr_b16 v[180:181], v238 offset:16384
    v_mfma_f32_16x16x32_bf16 v[88:91], v[216:219], v[192:195], v[88:91]
    ds_read_b64_tr_b16 v[182:183], v238 offset:20480
    v_mfma_f32_16x16x32_bf16 v[92:95], v[220:223], v[192:195], v[92:95]
    ds_read_b128 v[140:143], v232 offset:2048
    v_mfma_f32_16x16x32_bf16 v[96:99], v[224:227], v[192:195], v[96:99]
    ds_read_b128 v[144:147], v232 offset:4096
    v_mfma_f32_16x16x32_bf16 v[100:103], v[228:231], v[192:195], v[100:103]
    ds_read_b128 v[148:151], v232 offset:6144
    v_mfma_f32_16x16x32_bf16 v[104:107], v[200:203], v[196:199], v[104:107]
    v_mfma_f32_16x16x32_bf16 v[108:111], v[204:207], v[196:199], v[108:111]
    v_mfma_f32_16x16x32_bf16 v[112:115], v[208:211], v[196:199], v[112:115]
    v_mfma_f32_16x16x32_bf16 v[116:119], v[212:215], v[196:199], v[116:119]
    v_mfma_f32_16x16x32_bf16 v[120:123], v[216:219], v[196:199], v[120:123]
    v_mfma_f32_16x16x32_bf16 v[124:127], v[220:223], v[196:199], v[124:127]
    v_mfma_f32_16x16x32_bf16 v[128:131], v[224:227], v[196:199], v[128:131]
    s_add_u32 s52, s52, 49152
    s_cmp_ge_u32 s52, 147456
    s_cselect_b32 s52, 0, s52
    v_mfma_f32_16x16x32_bf16 v[132:135], v[228:231], v[196:199], v[132:135]
    s_waitcnt lgkmcnt(0)
    v_mfma_f32_16x16x32_bf16 v[8:11], v[152:155], v[136:139], v[8:11]
    ds_read_b128 v[184:187], v232 offset:1024
    v_mfma_f32_16x16x32_bf16 v[12:15], v[156:159], v[136:139], v[12:15]
    ds_read_b64_tr_b16 v[200:201], v235 offset:8192
    v_mfma_f32_16x16x32_bf16 v[16:19], v[160:163], v[136:139], v[16:19]
    ds_read_b64_tr_b16 v[202:203], v235 offset:12288
    v_mfma_f32_16x16x32_bf16 v[20:23], v[164:167], v[136:139], v[20:23]
    ds_read_b64_tr_b16 v[204:205], v236 offset:8192
    v_mfma_f32_16x16x32_bf16 v[24:27], v[168:171], v[136:139], v[24:27]
    v_mfma_f32_16x16x32_bf16 v[28:31], v[172:175], v[136:139], v[28:31]
    ds_read_b64_tr_b16 v[206:207], v236 offset:12288
    v_mfma_f32_16x16x32_bf16 v[32:35], v[176:179], v[136:139], v[32:35]
    ds_read_b64_tr_b16 v[208:209], v237 offset:8192
    v_mfma_f32_16x16x32_bf16 v[36:39], v[180:183], v[136:139], v[36:39]
    ds_read_b64_tr_b16 v[210:211], v237 offset:12288
    v_mfma_f32_16x16x32_bf16 v[40:43], v[152:155], v[140:143], v[40:43]
    ds_read_b64_tr_b16 v[212:213], v238 offset:8192
    v_mfma_f32_16x16x32_bf16 v[44:47], v[156:159], v[140:143], v[44:47]
    v_mfma_f32_16x16x32_bf16 v[48:51], v[160:163], v[140:143], v[48:51]
    ds_read_b64_tr_b16 v[214:215], v238 offset:12288
    v_mfma_f32_16x16x32_bf16 v[52:55], v[164:167], v[140:143], v[52:55]
    ds_read_b64_tr_b16 v[216:217], v235 offset:24576
    v_mfma_f32_16x16x32_bf16 v[56:59], v[168:171], v[140:143], v[56:59]
    ds_read_b64_tr_b16 v[218:219], v235 offset:28672
    v_mfma_f32_16x16x32_bf16 v[60:63], v[172:175], v[140:143], v[60:63]
    ds_read_b64_tr_b16 v[220:221], v236 offset:24576
    v_mfma_f32_16x16x32_bf16 v[64:67], v[176:179], v[140:143], v[64:67]
    v_mfma_f32_16x16x32_bf16 v[68:71], v[180:183], v[140:143], v[68:71]
    ds_read_b64_tr_b16 v[222:223], v236 offset:28672
    v_mfma_f32_16x16x32_bf16 v[72:75], v[152:155], v[144:147], v[72:75]
    ds_read_b64_tr_b16 v[224:225], v237 offset:24576
    v_mfma_f32_16x16x32_bf16 v[76:79], v[156:159], v[144:147], v[76:79]
    ds_read_b64_tr_b16 v[226:227], v237 offset:28672
    v_mfma_f32_16x16x32_bf16 v[80:83], v[160:163], v[144:147], v[80:83]
    ds_read_b64_tr_b16 v[228:229], v238 offset:24576
    v_mfma_f32_16x16x32_bf16 v[84:87], v[164:167], v[144:147], v[84:87]
    v_mfma_f32_16x16x32_bf16 v[88:91], v[168:171], v[144:147], v[88:91]
    ds_read_b64_tr_b16 v[230:231], v238 offset:28672
    v_mfma_f32_16x16x32_bf16 v[92:95], v[172:175], v[144:147], v[92:95]
    ds_read_b128 v[188:191], v232 offset:3072
    v_mfma_f32_16x16x32_bf16 v[96:99], v[176:179], v[144:147], v[96:99]
    ds_read_b128 v[192:195], v232 offset:5120
    v_mfma_f32_16x16x32_bf16 v[100:103], v[180:183], v[144:147], v[100:103]
    ds_read_b128 v[196:199], v232 offset:7168
    v_mfma_f32_16x16x32_bf16 v[104:107], v[152:155], v[148:151], v[104:107]
    v_mfma_f32_16x16x32_bf16 v[108:111], v[156:159], v[148:151], v[108:111]
    v_add_u32 v232, s52, v233
    v_mfma_f32_16x16x32_bf16 v[112:115], v[160:163], v[148:151], v[112:115]
    v_add_u32 v235, s52, v239
    v_mfma_f32_16x16x32_bf16 v[116:119], v[164:167], v[148:151], v[116:119]
    v_add_u32 v236, s52, v240
    v_mfma_f32_16x16x32_bf16 v[120:123], v[168:171], v[148:151], v[120:123]
    v_mfma_f32_16x16x32_bf16 v[124:127], v[172:175], v[148:151], v[124:127]
    v_add_u32 v237, s52, v241
    v_mfma_f32_16x16x32_bf16 v[128:131], v[176:179], v[148:151], v[128:131]
    v_add_u32 v238, s52, v242
    v_mfma_f32_16x16x32_bf16 v[132:135], v[180:183], v[148:151], v[132:135]
    s_waitcnt lgkmcnt(0)
    v_mfma_f32_16x16x32_bf16 v[8:11], v[200:203], v[184:187], v[8:11]
    s_waitcnt vmcnt(0)
    s_barrier
    v_mfma_f32_16x16x32_bf16 v[12:15], v[204:207], v[184:187], v[12:15]
    ds_read_b128 v[136:139], v232 offset:0
    v_mfma_f32_16x16x32_bf16 v[16:19], v[208:211], v[184:187], v[16:19]
    ds_read_b64_tr_b16 v[152:153], v235 offset:0
    v_mfma_f32_16x16x32_bf16 v[20:23], v[212:215], v[184:187], v[20:23]
    ds_read_b64_tr_b16 v[154:155], v235 offset:4096
    v_mfma_f32_16x16x32_bf16 v[24:27], v[216:219], v[184:187], v[24:27]
    ds_read_b64_tr_b16 v[156:157], v236 offset:0
    v_mfma_f32_16x16x32_bf16 v[28:31], v[220:223], v[184:187], v[28:31]
    ds_read_b64_tr_b16 v[158:159], v236 offset:4096
    v_mfma_f32_16x16x32_bf16 v[32:35], v[224:227], v[184:187], v[32:35]
    v_mfma_f32_16x16x32_bf16 v[36:39], v[228:231], v[184:187], v[36:39]
    ds_read_b64_tr_b16 v[160:161], v237 offset:0
    v_mfma_f32_16x16x32_bf16 v[40:43], v[200:203], v[188:191], v[40:43]
    ds_read_b64_tr_b16 v[162:163], v237 offset:4096
    v_mfma_f32_16x16x32_bf16 v[44:47], v[204:207], v[188:191], v[44:47]
    ds_read_b64_tr_b16 v[164:165], v238 offset:0
    v_mfma_f32_16x16x32_bf16 v[48:51], v[208:211], v[188:191], v[48:51]
    ds_read_b64_tr_b16 v[166:167], v238 offset:4096
    v_mfma_f32_16x16x32_bf16 v[52:55], v[212:215], v[188:191], v[52:55]
    ds_read_b64_tr_b16 v[168:169], v235 offset:16384
    v_mfma_f32_16x16x32_bf16 v[56:59], v[216:219], v[188:191], v[56:59]
    v_mfma_f32_16x16x32_bf16 v[60:63], v[220:223], v[188:191], v[60:63]
    ds_read_b64_tr_b16 v[170:171], v235 offset:20480
    v_mfma_f32_16x16x32_bf16 v[64:67], v[224:227], v[188:191], v[64:67]
    ds_read_b64_tr_b16 v[172:173], v236 offset:16384
    v_mfma_f32_16x16x32_bf16 v[68:71], v[228:231], v[188:191], v[68:71]
    ds_read_b64_tr_b16 v[174:175], v236 offset:20480
    v_mfma_f32_16x16x32_bf16 v[72:75], v[200:203], v[192:195], v[72:75]
    ds_read_b64_tr_b16 v[176:177], v237 offset:16384
    v_mfma_f32_16x16x32_bf16 v[76:79], v[204:207], v[192:195], v[76:79]
    ds_read_b64_tr_b16 v[178:179], v237 offset:20480
    v_mfma_f32_16x16x32_bf16 v[80:83], v[208:211], v[192:195], v[80:83]
    v_mfma_f32_16x16x32_bf16 v[84:87], v[212:215], v[192:195], v[84:87]
    ds_read_b64_tr_b16 v[180:181], v238 offset:16384
    v_mfma_f32_16x16x32_bf16 v[88:91], v[216:219], v[192:195], v[88:91]
    ds_read_b64_tr_b16 v[182:183], v238 offset:20480
    v_mfma_f32_16x16x32_bf16 v[92:95], v[220:223], v[192:195], v[92:95]
    ds_read_b128 v[140:143], v232 offset:2048
    v_mfma_f32_16x16x32_bf16 v[96:99], v[224:227], v[192:195], v[96:99]
    ds_read_b128 v[144:147], v232 offset:4096
    v_mfma_f32_16x16x32_bf16 v[100:103], v[228:231], v[192:195], v[100:103]
    ds_read_b128 v[148:151], v232 offset:6144
    v_mfma_f32_16x16x32_bf16 v[104:107], v[200:203], v[196:199], v[104:107]
    v_mfma_f32_16x16x32_bf16 v[108:111], v[204:207], v[196:199], v[108:111]
    v_mfma_f32_16x16x32_bf16 v[112:115], v[208:211], v[196:199], v[112:115]
    v_mfma_f32_16x16x32_bf16 v[116:119], v[212:215], v[196:199], v[116:119]
    v_mfma_f32_16x16x32_bf16 v[120:123], v[216:219], v[196:199], v[120:123]
    v_mfma_f32_16x16x32_bf16 v[124:127], v[220:223], v[196:199], v[124:127]
    v_mfma_f32_16x16x32_bf16 v[128:131], v[224:227], v[196:199], v[128:131]
    s_add_u32 s52, s52, 49152
    s_cmp_ge_u32 s52, 147456
    s_cselect_b32 s52, 0, s52
    v_mfma_f32_16x16x32_bf16 v[132:135], v[228:231], v[196:199], v[132:135]
    s_waitcnt lgkmcnt(0)
    v_mfma_f32_16x16x32_bf16 v[8:11], v[152:155], v[136:139], v[8:11]
    ds_read_b128 v[184:187], v232 offset:1024
    v_mfma_f32_16x16x32_bf16 v[12:15], v[156:159], v[136:139], v[12:15]
    ds_read_b64_tr_b16 v[200:201], v235 offset:8192
    v_mfma_f32_16x16x32_bf16 v[16:19], v[160:163], v[136:139], v[16:19]
    ds_read_b64_tr_b16 v[202:203], v235 offset:12288
    v_mfma_f32_16x16x32_bf16 v[20:23], v[164:167], v[136:139], v[20:23]
    ds_read_b64_tr_b16 v[204:205], v236 offset:8192
    v_mfma_f32_16x16x32_bf16 v[24:27], v[168:171], v[136:139], v[24:27]
    v_mfma_f32_16x16x32_bf16 v[28:31], v[172:175], v[136:139], v[28:31]
    ds_read_b64_tr_b16 v[206:207], v236 offset:12288
    v_mfma_f32_16x16x32_bf16 v[32:35], v[176:179], v[136:139], v[32:35]
    ds_read_b64_tr_b16 v[208:209], v237 offset:8192
    v_mfma_f32_16x16x32_bf16 v[36:39], v[180:183], v[136:139], v[36:39]
    ds_read_b64_tr_b16 v[210:211], v237 offset:12288
    v_mfma_f32_16x16x32_bf16 v[40:43], v[152:155], v[140:143], v[40:43]
    ds_read_b64_tr_b16 v[212:213], v238 offset:8192
    v_mfma_f32_16x16x32_bf16 v[44:47], v[156:159], v[140:143], v[44:47]
    v_mfma_f32_16x16x32_bf16 v[48:51], v[160:163], v[140:143], v[48:51]
    ds_read_b64_tr_b16 v[214:215], v238 offset:12288
    v_mfma_f32_16x16x32_bf16 v[52:55], v[164:167], v[140:143], v[52:55]
    ds_read_b64_tr_b16 v[216:217], v235 offset:24576
    v_mfma_f32_16x16x32_bf16 v[56:59], v[168:171], v[140:143], v[56:59]
    ds_read_b64_tr_b16 v[218:219], v235 offset:28672
    v_mfma_f32_16x16x32_bf16 v[60:63], v[172:175], v[140:143], v[60:63]
    ds_read_b64_tr_b16 v[220:221], v236 offset:24576
    v_mfma_f32_16x16x32_bf16 v[64:67], v[176:179], v[140:143], v[64:67]
    v_mfma_f32_16x16x32_bf16 v[68:71], v[180:183], v[140:143], v[68:71]
    ds_read_b64_tr_b16 v[222:223], v236 offset:28672
    v_mfma_f32_16x16x32_bf16 v[72:75], v[152:155], v[144:147], v[72:75]
    s_movk_i32 s54, 12
M_Q_loop3:
    ds_read_b64_tr_b16 v[224:225], v237 offset:24576
    v_mfma_f32_16x16x32_bf16 v[76:79], v[156:159], v[144:147], v[76:79]
    ds_read_b64_tr_b16 v[226:227], v237 offset:28672
    v_mfma_f32_16x16x32_bf16 v[80:83], v[160:163], v[144:147], v[80:83]
    ds_read_b64_tr_b16 v[228:229], v238 offset:24576
    v_mfma_f32_16x16x32_bf16 v[84:87], v[164:167], v[144:147], v[84:87]
    v_mfma_f32_16x16x32_bf16 v[88:91], v[168:171], v[144:147], v[88:91]
    ds_read_b64_tr_b16 v[230:231], v238 offset:28672
    v_mfma_f32_16x16x32_bf16 v[92:95], v[172:175], v[144:147], v[92:95]
    ds_read_b128 v[188:191], v232 offset:3072
    v_mfma_f32_16x16x32_bf16 v[96:99], v[176:179], v[144:147], v[96:99]
    ds_read_b128 v[192:195], v232 offset:5120
    v_mfma_f32_16x16x32_bf16 v[100:103], v[180:183], v[144:147], v[100:103]
    ds_read_b128 v[196:199], v232 offset:7168
    v_mfma_f32_16x16x32_bf16 v[104:107], v[152:155], v[148:151], v[104:107]
    v_mfma_f32_16x16x32_bf16 v[108:111], v[156:159], v[148:151], v[108:111]
    v_add_u32 v232, s52, v233
    v_mfma_f32_16x16x32_bf16 v[112:115], v[160:163], v[148:151], v[112:115]
    v_add_u32 v235, s52, v239
    v_mfma_f32_16x16x32_bf16 v[116:119], v[164:167], v[148:151], v[116:119]
    v_add_u32 v236, s52, v240
    v_mfma_f32_16x16x32_bf16 v[120:123], v[168:171], v[148:151], v[120:123]
    v_mfma_f32_16x16x32_bf16 v[124:127], v[172:175], v[148:151], v[124:127]
    v_add_u32 v237, s52, v241
    v_mfma_f32_16x16x32_bf16 v[128:131], v[176:179], v[148:151], v[128:131]
    v_add_u32 v238, s52, v242
    v_mfma_f32_16x16x32_bf16 v[132:135], v[180:183], v[148:151], v[132:135]
    s_waitcnt lgkmcnt(0)
    v_mfma_f32_16x16x32_bf16 v[8:11], v[200:203], v[184:187], v[8:11]
    s_barrier
    v_mfma_f32_16x16x32_bf16 v[12:15], v[204:207], v[184:187], v[12:15]
    ds_read_b128 v[136:139], v232 offset:0
    v_mfma_f32_16x16x32_bf16 v[16:19], v[208:211], v[184:187], v[16:19]
    ds_read_b64_tr_b16 v[152:153], v235 offset:0
    v_mfma_f32_16x16x32_bf16 v[20:23], v[212:215], v[184:187], v[20:23]
    ds_read_b64_tr_b16 v[154:155], v235 offset:4096
    v_mfma_f32_16x16x32_bf16 v[24:27], v[216:219], v[184:187], v[24:27]
    ds_read_b64_tr_b16 v[156:157], v236 offset:0
    v_mfma_f32_16x16x32_bf16 v[28:31], v[220:223], v[184:187], v[28:31]
    ds_read_b64_tr_b16 v[158:159], v236 offset:4096
    v_mfma_f32_16x16x32_bf16 v[32:35], v[224:227], v[184:187], v[32:35]
    v_mfma_f32_16x16x32_bf16 v[36:39], v[228:231], v[184:187], v[36:39]
    ds_read_b64_tr_b16 v[160:161], v237 offset:0
    v_mfma_f32_16x16x32_bf16 v[40:43], v[200:203], v[188:191], v[40:43]
    ds_read_b64_tr_b16 v[162:163], v237 offset:4096
    v_mfma_f32_16x16x32_bf16 v[44:47], v[204:207], v[188:191], v[44:47]
    ds_read_b64_tr_b16 v[164:165], v238 offset:0
    v_mfma_f32_16x16x32_bf16 v[48:51], v[208:211], v[188:191], v[48:51]
    ds_read_b64_tr_b16 v[166:167], v238 offset:4096
    v_mfma_f32_16x16x32_bf16 v[52:55], v[212:215], v[188:191], v[52:55]
    ds_read_b64_tr_b16 v[168:169], v235 offset:16384
    v_mfma_f32_16x16x32_bf16 v[56:59], v[216:219], v[188:191], v[56:59]
    v_mfma_f32_16x16x32_bf16 v[60:63], v[220:223], v[188:191], v[60:63]
    ds_read_b64_tr_b16 v[170:171], v235 offset:20480
    v_mfma_f32_16x16x32_bf16 v[64:67], v[224:227], v[188:191], v[64:67]
    ds_read_b64_tr_b16 v[172:173], v236 offset:16384
    v_mfma_f32_16x16x32_bf16 v[68:71], v[228:231], v[188:191], v[68:71]
    ds_read_b64_tr_b16 v[174:175], v236 offset:20480
    v_mfma_f32_16x16x32_bf16 v[72:75], v[200:203], v[192:195], v[72:75]
    ds_read_b64_tr_b16 v[176:177], v237 offset:16384
    v_mfma_f32_16x16x32_bf16 v[76:79], v[204:207], v[192:195], v[76:79]
    ds_read_b64_tr_b16 v[178:179], v237 offset:20480
    v_mfma_f32_16x16x32_bf16 v[80:83], v[208:211], v[192:195], v[80:83]
    v_mfma_f32_16x16x32_bf16 v[84:87], v[212:215], v[192:195], v[84:87]
    ds_read_b64_tr_b16 v[180:181], v238 offset:16384
    v_mfma_f32_16x16x32_bf16 v[88:91], v[216:219], v[192:195], v[88:91]
    ds_read_b64_tr_b16 v[182:183], v238 offset:20480
    v_mfma_f32_16x16x32_bf16 v[92:95], v[220:223], v[192:195], v[92:95]
    ds_read_b128 v[140:143], v232 offset:2048
    v_mfma_f32_16x16x32_bf16 v[96:99], v[224:227], v[192:195], v[96:99]
    ds_read_b128 v[144:147], v232 offset:4096
    v_mfma_f32_16x16x32_bf16 v[100:103], v[228:231], v[192:195], v[100:103]
    ds_read_b128 v[148:151], v232 offset:6144
    v_mfma_f32_16x16x32_bf16 v[104:107], v[200:203], v[196:199], v[104:107]
    v_mfma_f32_16x16x32_bf16 v[108:111], v[204:207], v[196:199], v[108:111]
    v_mfma_f32_16x16x32_bf16 v[112:115], v[208:211], v[196:199], v[112:115]
    v_mfma_f32_16x16x32_bf16 v[116:119], v[212:215], v[196:199], v[116:119]
    v_mfma_f32_16x16x32_bf16 v[120:123], v[216:219], v[196:199], v[120:123]
    v_mfma_f32_16x16x32_bf16 v[124:127], v[220:223], v[196:199], v[124:127]
    v_mfma_f32_16x16x32_bf16 v[128:131], v[224:227], v[196:199], v[128:131]
    s_add_u32 s52, s52, 49152
    s_cmp_ge_u32 s52, 147456
    s_cselect_b32 s52, 0, s52
    v_mfma_f32_16x16x32_bf16 v[132:135], v[228:231], v[196:199], v[132:135]
    s_waitcnt lgkmcnt(0)
    v_mfma_f32_16x16x32_bf16 v[8:11], v[152:155], v[136:139], v[8:11]
    ds_read_b128 v[184:187], v232 offset:1024
    v_mfma_f32_16x16x32_bf16 v[12:15], v[156:159], v[136:139], v[12:15]
    ds_read_b64_tr_b16 v[200:201], v235 offset:8192
    v_mfma_f32_16x16x32_bf16 v[16:19], v[160:163], v[136:139], v[16:19]
    ds_read_b64_tr_b16 v[202:203], v235 offset:12288
    v_mfma_f32_16x16x32_bf16 v[20:23], v[164:167], v[136:139], v[20:23]
    ds_read_b64_tr_b16 v[204:205], v236 offset:8192
    v_mfma_f32_16x16x32_bf16 v[24:27], v[168:171], v[136:139], v[24:27]
    v_mfma_f32_16x16x32_bf16 v[28:31], v[172:175], v[136:139], v[28:31]
    ds_read_b64_tr_b16 v[206:207], v236 offset:12288
    v_mfma_f32_16x16x32_bf16 v[32:35], v[176:179], v[136:139], v[32:35]
    ds_read_b64_tr_b16 v[208:209], v237 offset:8192
    v_mfma_f32_16x16x32_bf16 v[36:39], v[180:183], v[136:139], v[36:39]
    ds_read_b64_tr_b16 v[210:211], v237 offset:12288
    v_mfma_f32_16x16x32_bf16 v[40:43], v[152:155], v[140:143], v[40:43]
    ds_read_b64_tr_b16 v[212:213], v238 offset:8192
    v_mfma_f32_16x16x32_bf16 v[44:47], v[156:159], v[140:143], v[44:47]
    v_mfma_f32_16x16x32_bf16 v[48:51], v[160:163], v[140:143], v[48:51]
    ds_read_b64_tr_b16 v[214:215], v238 offset:12288
    v_mfma_f32_16x16x32_bf16 v[52:55], v[164:167], v[140:143], v[52:55]
    ds_read_b64_tr_b16 v[216:217], v235 offset:24576
    v_mfma_f32_16x16x32_bf16 v[56:59], v[168:171], v[140:143], v[56:59]
    ds_read_b64_tr_b16 v[218:219], v235 offset:28672
    v_mfma_f32_16x16x32_bf16 v[60:63], v[172:175], v[140:143], v[60:63]
    ds_read_b64_tr_b16 v[220:221], v236 offset:24576
    v_mfma_f32_16x16x32_bf16 v[64:67], v[176:179], v[140:143], v[64:67]
    v_mfma_f32_16x16x32_bf16 v[68:71], v[180:183], v[140:143], v[68:71]
    s_sub_u32 s54, s54, 1
    ds_read_b64_tr_b16 v[222:223], v236 offset:28672
    v_mfma_f32_16x16x32_bf16 v[72:75], v[152:155], v[144:147], v[72:75]
    s_cbranch_scc0 M_Q_loop3
    ds_read_b64_tr_b16 v[224:225], v237 offset:24576
    v_mfma_f32_16x16x32_bf16 v[76:79], v[156:159], v[144:147], v[76:79]
    ds_read_b64_tr_b16 v[226:227], v237 offset:28672
    v_mfma_f32_16x16x32_bf16 v[80:83], v[160:163], v[144:147], v[80:83]
    ds_read_b64_tr_b16 v[228:229], v238 offset:24576
    v_mfma_f32_16x16x32_bf16 v[84:87], v[164:167], v[144:147], v[84:87]
    v_mfma_f32_16x16x32_bf16 v[88:91], v[168:171], v[144:147], v[88:91]
    ds_read_b64_tr_b16 v[230:231], v238 offset:28672
    v_mfma_f32_16x16x32_bf16 v[92:95], v[172:175], v[144:147], v[92:95]
    ds_read_b128 v[188:191], v232 offset:3072
    v_mfma_f32_16x16x32_bf16 v[96:99], v[176:179], v[144:147], v[96:99]
    ds_read_b128 v[192:195], v232 offset:5120
    v_mfma_f32_16x16x32_bf16 v[100:103], v[180:183], v[144:147], v[100:103]
    ds_read_b128 v[196:199], v232 offset:7168
    v_mfma_f32_16x16x32_bf16 v[104:107], v[152:155], v[148:151], v[104:107]
    v_mfma_f32_16x16x32_bf16 v[108:111], v[156:159], v[148:151], v[108:111]
    v_mfma_f32_16x16x32_bf16 v[112:115], v[160:163], v[148:151], v[112:115]
    v_mfma_f32_16x16x32_bf16 v[116:119], v[164:167], v[148:151], v[116:119]
    v_mfma_f32_16x16x32_bf16 v[120:123], v[168:171], v[148:151], v[120:123]
    v_mfma_f32_16x16x32_bf16 v[124:127], v[172:175], v[148:151], v[124:127]
    v_mfma_f32_16x16x32_bf16 v[128:131], v[176:179], v[148:151], v[128:131]
    v_mfma_f32_16x16x32_bf16 v[132:135], v[180:183], v[148:151], v[132:135]
    s_waitcnt lgkmcnt(0)
    v_mfma_f32_16x16x32_bf16 v[8:11], v[200:203], v[184:187], v[8:11]
    s_barrier
    v_mfma_f32_16x16x32_bf16 v[12:15], v[204:207], v[184:187], v[12:15]
    v_mfma_f32_16x16x32_bf16 v[16:19], v[208:211], v[184:187], v[16:19]
    v_mfma_f32_16x16x32_bf16 v[20:23], v[212:215], v[184:187], v[20:23]
    v_mfma_f32_16x16x32_bf16 v[24:27], v[216:219], v[184:187], v[24:27]
    v_mfma_f32_16x16x32_bf16 v[28:31], v[220:223], v[184:187], v[28:31]
    v_mfma_f32_16x16x32_bf16 v[32:35], v[224:227], v[184:187], v[32:35]
    v_mfma_f32_16x16x32_bf16 v[36:39], v[228:231], v[184:187], v[36:39]
    v_mfma_f32_16x16x32_bf16 v[40:43], v[200:203], v[188:191], v[40:43]
    v_mfma_f32_16x16x32_bf16 v[44:47], v[204:207], v[188:191], v[44:47]
    v_mfma_f32_16x16x32_bf16 v[48:51], v[208:211], v[188:191], v[48:51]
    v_mfma_f32_16x16x32_bf16 v[52:55], v[212:215], v[188:191], v[52:55]
    v_mfma_f32_16x16x32_bf16 v[56:59], v[216:219], v[188:191], v[56:59]
    v_mfma_f32_16x16x32_bf16 v[60:63], v[220:223], v[188:191], v[60:63]
    v_mfma_f32_16x16x32_bf16 v[64:67], v[224:227], v[188:191], v[64:67]
    v_mfma_f32_16x16x32_bf16 v[68:71], v[228:231], v[188:191], v[68:71]
    v_mfma_f32_16x16x32_bf16 v[72:75], v[200:203], v[192:195], v[72:75]
    v_mfma_f32_16x16x32_bf16 v[76:79], v[204:207], v[192:195], v[76:79]
    v_mfma_f32_16x16x32_bf16 v[80:83], v[208:211], v[192:195], v[80:83]
    v_mfma_f32_16x16x32_bf16 v[84:87], v[212:215], v[192:195], v[84:87]
    v_mfma_f32_16x16x32_bf16 v[88:91], v[216:219], v[192:195], v[88:91]
    v_mfma_f32_16x16x32_bf16 v[92:95], v[220:223], v[192:195], v[92:95]
    v_mfma_f32_16x16x32_bf16 v[96:99], v[224:227], v[192:195], v[96:99]
    v_mfma_f32_16x16x32_bf16 v[100:103], v[228:231], v[192:195], v[100:103]
    v_mfma_f32_16x16x32_bf16 v[104:107], v[200:203], v[196:199], v[104:107]
    v_mfma_f32_16x16x32_bf16 v[108:111], v[204:207], v[196:199], v[108:111]
    v_mfma_f32_16x16x32_bf16 v[112:115], v[208:211], v[196:199], v[112:115]
    v_mfma_f32_16x16x32_bf16 v[116:119], v[212:215], v[196:199], v[116:119]
    v_mfma_f32_16x16x32_bf16 v[120:123], v[216:219], v[196:199], v[120:123]
    v_mfma_f32_16x16x32_bf16 v[124:127], v[220:223], v[196:199], v[124:127]
    v_mfma_f32_16x16x32_bf16 v[128:131], v[224:227], v[196:199], v[128:131]
    v_mfma_f32_16x16x32_bf16 v[132:135], v[228:231], v[196:199], v[132:135]
M_Qjoin:
    s_setprio 0
    s_lshl_b32 s60, s44, 12
    s_add_u32 s61, s60, 147456
    s_add_u32 s53, s60, 98304
    s_bfe_u32 s66, s2, 0x30003
    s_lshr_b32 s55, s2, 6
    s_add_u32 s66, s66, s55
    s_and_b32 s66, s66, 3
    s_mov_b32 s58, 0x31076453
    s_mov_b32 s59, 0x542
    s_cmp_eq_u32 s66, 1
    s_cselect_b32 s58, 0x20175643, s58
    s_cselect_b32 s59, 0x534, s59
    s_cmp_eq_u32 s66, 2
    s_cselect_b32 s58, 0x21067542, s58
    s_cselect_b32 s59, 0x453, s59
    s_cmp_eq_u32 s66, 3
    s_cselect_b32 s58, 0x20176534, s58
    s_cselect_b32 s59, 0x543, s59
    s_lshl_b32 s55, s49, 3
    s_mov_b32 s32, s16
    s_mov_b32 s33, s17
    s_mov_b32 s34, 0x700000
    s_mov_b32 s35, 0x20000
    s_add_u32 s36, s16, 0x100
    s_addc_u32 s37, s17, 0
    s_mov_b32 s38, 0x6fff00
    s_mov_b32 s39, 0x20000
    s_lshr_b32 s62, s48, 2
    s_sub_u32 s62, s48, s62
    s_add_u32 s62, s62, 16
    s_lshl_b32 s70, s62, 12
    s_lshl_b32 s64, s47, 3
    s_lshl_b32 s65, s45, 2
    s_add_u32 s64, s64, s65
    s_mul_i32 s64, s64, 114688
    s_add_u32 s64, s64, s70
    s_lshl_b32 s65, s46, 11
    s_add_u32 s64, s64, s65
    s_add_u32 s64, s64, 0x1500000
    s_or_b32 s64, s64, s69
    v_lshl_add_u32 v198, v1, 4, s64
    v_mul_f32 v24, v8, v24
    v_exp_f32 v216, -v8
    v_mul_f32 v25, v9, v25
    v_exp_f32 v217, -v9
    v_mul_f32 v26, v10, v26
    v_exp_f32 v218, -v10
    v_mul_f32 v27, v11, v27
    v_exp_f32 v219, -v11
    v_mul_f32 v28, v12, v28
    v_exp_f32 v220, -v12
    v_mul_f32 v29, v13, v29
    v_exp_f32 v221, -v13
    v_mul_f32 v30, v14, v30
    v_exp_f32 v222, -v14
    v_mul_f32 v31, v15, v31
    v_exp_f32 v223, -v15
    v_fma_f32 v216, v216, s67, s67
    v_fma_f32 v217, v217, s67, s67
    v_rcp_f32 v216, v216
    v_fma_f32 v218, v218, s67, s67
    v_rcp_f32 v217, v217
    v_fma_f32 v219, v219, s67, s67
    v_rcp_f32 v218, v218
    v_fma_f32 v220, v220, s67, s67
    v_rcp_f32 v219, v219
    v_fma_f32 v221, v221, s67, s67
    v_rcp_f32 v220, v220
    v_fma_f32 v222, v222, s67, s67
    v_rcp_f32 v221, v221
    v_fma_f32 v223, v223, s67, s67
    v_rcp_f32 v222, v222
    v_rcp_f32 v223, v223
    v_mul_f32 v24, v24, v216
    v_mul_f32 v25, v25, v217
    v_mul_f32 v26, v26, v218
    v_mul_f32 v27, v27, v219
    v_mul_f32 v28, v28, v220
    v_mul_f32 v29, v29, v221
    v_mul_f32 v30, v30, v222
    v_mul_f32 v31, v31, v223
    s_barrier
    s_and_b32 s57, s58, 15
    s_lshr_b64 s[58:59], s[58:59], 4
    s_add_u32 s57, s57, s55
    s_lshl_b32 s56, s57, 11
    s_mul_i32 s57, s57, 0x20000
    s_add_u32 m0, s53, 16384
    s_nop 0
    buffer_load_dwordx4 v248, s[32:35], s57 offen offset:0 lds
    v_cvt_pk_bf16_f32 v200, v24, v25
    v_cvt_pk_bf16_f32 v201, v26, v27
    v_cvt_pk_bf16_f32 v202, v28, v29
    v_cvt_pk_bf16_f32 v203, v30, v31
    buffer_load_dwordx4 v249, s[32:35], s57 offen offset:1024 lds
    v_mul_f32 v32, v16, v32
    v_exp_f32 v224, -v16
    v_mul_f32 v33, v17, v33
    v_exp_f32 v225, -v17
    v_mul_f32 v34, v18, v34
    buffer_load_dwordx4 v250, s[32:35], s57 offen offset:2048 lds
    v_exp_f32 v226, -v18
    v_mul_f32 v35, v19, v35
    v_exp_f32 v227, -v19
    v_mul_f32 v36, v20, v36
    v_exp_f32 v228, -v20
    v_mul_f32 v37, v21, v37
    buffer_load_dwordx4 v251, s[32:35], s57 offen offset:3072 lds
    v_exp_f32 v229, -v21
    v_mul_f32 v38, v22, v38
    v_exp_f32 v230, -v22
    v_mul_f32 v39, v23, v39
    s_add_u32 m0, s53, 32768
    s_nop 0
    buffer_load_dwordx4 v248, s[36:39], s57 offen offset:0 lds
    v_exp_f32 v231, -v23
    v_fma_f32 v224, v224, s67, s67
    v_fma_f32 v225, v225, s67, s67
    v_rcp_f32 v224, v224
    v_fma_f32 v226, v226, s67, s67
    v_rcp_f32 v225, v225
    buffer_load_dwordx4 v249, s[36:39], s57 offen offset:1024 lds
    v_fma_f32 v227, v227, s67, s67
    v_rcp_f32 v226, v226
    v_fma_f32 v228, v228, s67, s67
    v_rcp_f32 v227, v227
    v_fma_f32 v229, v229, s67, s67
    v_rcp_f32 v228, v228
    buffer_load_dwordx4 v250, s[36:39], s57 offen offset:2048 lds
    v_fma_f32 v230, v230, s67, s67
    v_rcp_f32 v229, v229
    v_fma_f32 v231, v231, s67, s67
    v_rcp_f32 v230, v230
    buffer_load_dwordx4 v251, s[36:39], s57 offen offset:3072 lds
    v_rcp_f32 v231, v231
    v_mul_f32 v32, v32, v224
    v_mul_f32 v33, v33, v225
    v_mul_f32 v34, v34, v226
    v_mul_f32 v35, v35, v227
    v_mul_f32 v36, v36, v228
    s_mov_b32 m0, s53
    s_nop 0
    buffer_load_dwordx4 v246, s[28:31], s56 offen offset:0 sc1 lds
    v_mul_f32 v37, v37, v229
    v_mul_f32 v38, v38, v230
    v_mul_f32 v39, v39, v231
    v_cvt_pk_bf16_f32 v204, v32, v33
    v_cvt_pk_bf16_f32 v205, v34, v35
    v_cvt_pk_bf16_f32 v206, v36, v37
    buffer_load_dwordx4 v246, s[28:31], s56 offen offset:1024 sc1 lds
    v_cvt_pk_bf16_f32 v207, v38, v39
    v_mul_f32 v56, v40, v56
    v_exp_f32 v216, -v40
    v_mul_f32 v57, v41, v57
    buffer_load_dwordx4 v247, s[28:31], s56 offen offset:2048 sc1 lds
    v_exp_f32 v217, -v41
    v_mul_f32 v58, v42, v58
    v_exp_f32 v218, -v42
    v_mul_f32 v59, v43, v59
    buffer_load_dwordx4 v247, s[28:31], s56 offen offset:3072 sc1 lds
    v_exp_f32 v219, -v43
    v_mul_f32 v60, v44, v60
    v_exp_f32 v220, -v44
    v_mul_f32 v61, v45, v61
    v_exp_f32 v221, -v45
    v_mul_f32 v62, v46, v62
    s_add_u32 s53, s53, 49152
    s_cmp_ge_u32 s53, s61
    s_cselect_b32 s53, s60, s53
    buffer_store_dwordx4 v[200:203], v198, s[28:31], 0 offen offset:0 sc1
    buffer_store_dwordx4 v[204:207], v198, s[28:31], 0 offen offset:1024 sc1
    v_add_u32 v198, 114688, v198
    s_barrier
    s_and_b32 s57, s58, 15
    s_lshr_b64 s[58:59], s[58:59], 4
    s_add_u32 s57, s57, s55
    s_lshl_b32 s56, s57, 11
    s_mul_i32 s57, s57, 0x20000
    s_add_u32 m0, s53, 16384
    s_nop 0
    buffer_load_dwordx4 v248, s[32:35], s57 offen offset:0 lds
    v_exp_f32 v222, -v46
    v_mul_f32 v63, v47, v63
    v_exp_f32 v223, -v47
    v_fma_f32 v216, v216, s67, s67
    v_fma_f32 v217, v217, s67, s67
    v_rcp_f32 v216, v216
    buffer_load_dwordx4 v249, s[32:35], s57 offen offset:1024 lds
    v_fma_f32 v218, v218, s67, s67
    v_rcp_f32 v217, v217
    v_fma_f32 v219, v219, s67, s67
    v_rcp_f32 v218, v218
    buffer_load_dwordx4 v250, s[32:35], s57 offen offset:2048 lds
    v_fma_f32 v220, v220, s67, s67
    v_rcp_f32 v219, v219
    v_fma_f32 v221, v221, s67, s67
    v_rcp_f32 v220, v220
    v_fma_f32 v222, v222, s67, s67
    v_rcp_f32 v221, v221
    buffer_load_dwordx4 v251, s[32:35], s57 offen offset:3072 lds
    v_fma_f32 v223, v223, s67, s67
    v_rcp_f32 v222, v222
    v_rcp_f32 v223, v223
    v_mul_f32 v56, v56, v216
    v_mul_f32 v57, v57, v217
    v_mul_f32 v58, v58, v218
    s_add_u32 m0, s53, 32768
    s_nop 0
    buffer_load_dwordx4 v248, s[36:39], s57 offen offset:0 lds
    v_mul_f32 v59, v59, v219
    v_mul_f32 v60, v60, v220
    v_mul_f32 v61, v61, v221
    v_mul_f32 v62, v62, v222
    buffer_load_dwordx4 v249, s[36:39], s57 offen offset:1024 lds
    v_mul_f32 v63, v63, v223
    v_cvt_pk_bf16_f32 v208, v56, v57
    v_cvt_pk_bf16_f32 v209, v58, v59
    v_cvt_pk_bf16_f32 v210, v60, v61
    v_cvt_pk_bf16_f32 v211, v62, v63
    buffer_load_dwordx4 v250, s[36:39], s57 offen offset:2048 lds
    v_mul_f32 v64, v48, v64
    v_exp_f32 v224, -v48
    v_mul_f32 v65, v49, v65
    v_exp_f32 v225, -v49
    v_mul_f32 v66, v50, v66
    v_exp_f32 v226, -v50
    buffer_load_dwordx4 v251, s[36:39], s57 offen offset:3072 lds
    v_mul_f32 v67, v51, v67
    v_exp_f32 v227, -v51
    v_mul_f32 v68, v52, v68
    v_exp_f32 v228, -v52
    v_mul_f32 v69, v53, v69
    v_exp_f32 v229, -v53
    s_mov_b32 m0, s53
    s_nop 0
    buffer_load_dwordx4 v246, s[28:31], s56 offen offset:0 sc1 lds
    v_mul_f32 v70, v54, v70
    v_exp_f32 v230, -v54
    v_mul_f32 v71, v55, v71
    v_exp_f32 v231, -v55
    buffer_load_dwordx4 v246, s[28:31], s56 offen offset:1024 sc1 lds
    v_fma_f32 v224, v224, s67, s67
    v_fma_f32 v225, v225, s67, s67
    v_rcp_f32 v224, v224
    v_fma_f32 v226, v226, s67, s67
    v_rcp_f32 v225, v225
    v_fma_f32 v227, v227, s67, s67
    buffer_load_dwordx4 v247, s[28:31], s56 offen offset:2048 sc1 lds
    v_rcp_f32 v226, v226
    v_fma_f32 v228, v228, s67, s67
    v_rcp_f32 v227, v227
    v_fma_f32 v229, v229, s67, s67
    v_rcp_f32 v228, v228
    v_fma_f32 v230, v230, s67, s67
    buffer_load_dwordx4 v247, s[28:31], s56 offen offset:3072 sc1 lds
    v_rcp_f32 v229, v229
    v_fma_f32 v231, v231, s67, s67
    v_rcp_f32 v230, v230
    v_rcp_f32 v231, v231
    s_add_u32 s53, s53, 49152
    s_cmp_ge_u32 s53, s61
    s_cselect_b32 s53, s60, s53
    buffer_store_dwordx4 v[208:211], v198, s[28:31], 0 offen offset:0 sc1
    s_waitcnt vmcnt(15)
    s_barrier
    s_and_b32 s57, s58, 15
    s_lshr_b64 s[58:59], s[58:59], 4
    s_add_u32 s57, s57, s55
    s_lshl_b32 s56, s57, 11
    s_mul_i32 s57, s57, 0x20000
    s_add_u32 m0, s53, 16384
    s_nop 0
    buffer_load_dwordx4 v248, s[32:35], s57 offen offset:0 lds
    v_mul_f32 v64, v64, v224
    v_mul_f32 v65, v65, v225
    v_mul_f32 v66, v66, v226
    v_mul_f32 v67, v67, v227
    v_mul_f32 v68, v68, v228
    v_mul_f32 v69, v69, v229
    buffer_load_dwordx4 v249, s[32:35], s57 offen offset:1024 lds
    v_mul_f32 v70, v70, v230
    v_mul_f32 v71, v71, v231
    v_cvt_pk_bf16_f32 v212, v64, v65
    v_cvt_pk_bf16_f32 v213, v66, v67
    v_cvt_pk_bf16_f32 v214, v68, v69
    v_cvt_pk_bf16_f32 v215, v70, v71
    buffer_load_dwordx4 v250, s[32:35], s57 offen offset:2048 lds
    v_mul_f32 v88, v72, v88
    v_exp_f32 v216, -v72
    buffer_load_dwordx4 v251, s[32:35], s57 offen offset:3072 lds
    v_mul_f32 v89, v73, v89
    v_exp_f32 v217, -v73
    v_mul_f32 v90, v74, v90
    v_exp_f32 v218, -v74
    v_mul_f32 v91, v75, v91
    v_exp_f32 v219, -v75
    s_add_u32 m0, s53, 32768
    s_nop 0
    buffer_load_dwordx4 v248, s[36:39], s57 offen offset:0 lds
    v_mul_f32 v92, v76, v92
    v_exp_f32 v220, -v76
    v_mul_f32 v93, v77, v93
    v_exp_f32 v221, -v77
    v_mul_f32 v94, v78, v94
    v_exp_f32 v222, -v78
    buffer_load_dwordx4 v249, s[36:39], s57 offen offset:1024 lds
    v_mul_f32 v95, v79, v95
    v_exp_f32 v223, -v79
    v_fma_f32 v216, v216, s67, s67
    v_fma_f32 v217, v217, s67, s67
    v_rcp_f32 v216, v216
    v_fma_f32 v218, v218, s67, s67
    buffer_load_dwordx4 v250, s[36:39], s57 offen offset:2048 lds
    v_rcp_f32 v217, v217
    v_fma_f32 v219, v219, s67, s67
    v_rcp_f32 v218, v218
    v_fma_f32 v220, v220, s67, s67
    buffer_load_dwordx4 v251, s[36:39], s57 offen offset:3072 lds
    v_rcp_f32 v219, v219
    v_fma_f32 v221, v221, s67, s67
    v_rcp_f32 v220, v220
    v_fma_f32 v222, v222, s67, s67
    v_rcp_f32 v221, v221
    v_fma_f32 v223, v223, s67, s67
    s_mov_b32 m0, s53
    s_nop 0
    buffer_load_dwordx4 v246, s[28:31], s56 offen offset:0 sc1 lds
    v_rcp_f32 v222, v222
    v_rcp_f32 v223, v223
    v_mul_f32 v88, v88, v216
    v_mul_f32 v89, v89, v217
    v_mul_f32 v90, v90, v218
    v_mul_f32 v91, v91, v219
    buffer_load_dwordx4 v246, s[28:31], s56 offen offset:1024 sc1 lds
    v_mul_f32 v92, v92, v220
    v_mul_f32 v93, v93, v221
    v_mul_f32 v94, v94, v222
    v_mul_f32 v95, v95, v223
    buffer_load_dwordx4 v247, s[28:31], s56 offen offset:2048 sc1 lds
    v_cvt_pk_bf16_f32 v200, v88, v89
    v_cvt_pk_bf16_f32 v201, v90, v91
    v_cvt_pk_bf16_f32 v202, v92, v93
    v_cvt_pk_bf16_f32 v203, v94, v95
    v_mul_f32 v96, v80, v96
    buffer_load_dwordx4 v247, s[28:31], s56 offen offset:3072 sc1 lds
    v_exp_f32 v224, -v80
    v_mul_f32 v97, v81, v97
    v_exp_f32 v225, -v81
    v_mul_f32 v98, v82, v98
    v_exp_f32 v226, -v82
    v_mul_f32 v99, v83, v99
    s_add_u32 s53, s53, 49152
    s_cmp_ge_u32 s53, s61
    s_cselect_b32 s53, s60, s53
    buffer_store_dwordx4 v[212:215], v198, s[28:31], 0 offen offset:1024 sc1
    v_add_u32 v198, 114688, v198
    buffer_store_dwordx4 v[200:203], v198, s[28:31], 0 offen offset:0 sc1
    s_waitcnt vmcnt(15)
    s_barrier
    s_and_b32 s57, s58, 15
    s_lshr_b64 s[58:59], s[58:59], 4
    s_add_u32 s57, s57, s55
    s_lshl_b32 s56, s57, 11
    s_mul_i32 s57, s57, 0x20000
    s_add_u32 m0, s53, 16384
    s_nop 0
    buffer_load_dwordx4 v248, s[32:35], s57 offen offset:0 lds
    v_exp_f32 v227, -v83
    v_mul_f32 v100, v84, v100
    v_exp_f32 v228, -v84
    v_mul_f32 v101, v85, v101
    buffer_load_dwordx4 v249, s[32:35], s57 offen offset:1024 lds
    v_exp_f32 v229, -v85
    v_mul_f32 v102, v86, v102
    v_exp_f32 v230, -v86
    v_mul_f32 v103, v87, v103
    v_exp_f32 v231, -v87
    v_fma_f32 v224, v224, s67, s67
    buffer_load_dwordx4 v250, s[32:35], s57 offen offset:2048 lds
    v_fma_f32 v225, v225, s67, s67
    v_rcp_f32 v224, v224
    v_fma_f32 v226, v226, s67, s67
    v_rcp_f32 v225, v225
    v_fma_f32 v227, v227, s67, s67
    v_rcp_f32 v226, v226
    buffer_load_dwordx4 v251, s[32:35], s57 offen offset:3072 lds
    v_fma_f32 v228, v228, s67, s67
    v_rcp_f32 v227, v227
    v_fma_f32 v229, v229, s67, s67
    v_rcp_f32 v228, v228
    v_fma_f32 v230, v230, s67, s67
    v_rcp_f32 v229, v229
    s_add_u32 m0, s53, 32768
    s_nop 0
    buffer_load_dwordx4 v248, s[36:39], s57 offen offset:0 lds
    v_fma_f32 v231, v231, s67, s67
    v_rcp_f32 v230, v230
    v_rcp_f32 v231, v231
    v_mul_f32 v96, v96, v224
    buffer_load_dwordx4 v249, s[36:39], s57 offen offset:1024 lds
    v_mul_f32 v97, v97, v225
    v_mul_f32 v98, v98, v226
    v_mul_f32 v99, v99, v227
    v_mul_f32 v100, v100, v228
    v_mul_f32 v101, v101, v229
    v_mul_f32 v102, v102, v230
    buffer_load_dwordx4 v250, s[36:39], s57 offen offset:2048 lds
    v_mul_f32 v103, v103, v231
    v_cvt_pk_bf16_f32 v204, v96, v97
    v_cvt_pk_bf16_f32 v205, v98, v99
    v_cvt_pk_bf16_f32 v206, v100, v101
    v_cvt_pk_bf16_f32 v207, v102, v103
    buffer_load_dwordx4 v251, s[36:39], s57 offen offset:3072 lds
    v_mul_f32 v120, v104, v120
    v_exp_f32 v216, -v104
    v_mul_f32 v121, v105, v121
    s_mov_b32 m0, s53
    s_nop 0
    buffer_load_dwordx4 v246, s[28:31], s56 offen offset:0 sc1 lds
    v_exp_f32 v217, -v105
    v_mul_f32 v122, v106, v122
    v_exp_f32 v218, -v106
    v_mul_f32 v123, v107, v123
    v_exp_f32 v219, -v107
    v_mul_f32 v124, v108, v124
    buffer_load_dwordx4 v246, s[28:31], s56 offen offset:1024 sc1 lds
    v_exp_f32 v220, -v108
    v_mul_f32 v125, v109, v125
    v_exp_f32 v221, -v109
    v_mul_f32 v126, v110, v126
    v_exp_f32 v222, -v110
    v_mul_f32 v127, v111, v127
    buffer_load_dwordx4 v247, s[28:31], s56 offen offset:2048 sc1 lds
    v_exp_f32 v223, -v111
    v_fma_f32 v216, v216, s67, s67
    v_fma_f32 v217, v217, s67, s67
    v_rcp_f32 v216, v216
    buffer_load_dwordx4 v247, s[28:31], s56 offen offset:3072 sc1 lds
    v_fma_f32 v218, v218, s67, s67
    v_rcp_f32 v217, v217
    v_fma_f32 v219, v219, s67, s67
    v_rcp_f32 v218, v218
    v_fma_f32 v220, v220, s67, s67
    v_rcp_f32 v219, v219
    s_add_u32 s53, s53, 49152
    s_cmp_ge_u32 s53, s61
    s_cselect_b32 s53, s60, s53
    buffer_store_dwordx4 v[204:207], v198, s[28:31], 0 offen offset:1024 sc1
    v_add_u32 v198, 114688, v198
    s_waitcnt vmcnt(15)
    s_barrier
    s_and_b32 s57, s58, 15
    s_lshr_b64 s[58:59], s[58:59], 4
    s_add_u32 s57, s57, s55
    s_lshl_b32 s56, s57, 11
    s_mul_i32 s57, s57, 0x20000
    s_add_u32 m0, s53, 16384
    s_nop 0
    buffer_load_dwordx4 v248, s[32:35], s57 offen offset:0 lds
    v_fma_f32 v221, v221, s67, s67
    v_rcp_f32 v220, v220
    v_fma_f32 v222, v222, s67, s67
    v_rcp_f32 v221, v221
    v_fma_f32 v223, v223, s67, s67
    v_rcp_f32 v222, v222
    buffer_load_dwordx4 v249, s[32:35], s57 offen offset:1024 lds
    v_rcp_f32 v223, v223
    v_mul_f32 v120, v120, v216
    v_mul_f32 v121, v121, v217
    v_mul_f32 v122, v122, v218
    v_mul_f32 v123, v123, v219
    v_mul_f32 v124, v124, v220
    buffer_load_dwordx4 v250, s[32:35], s57 offen offset:2048 lds
    v_mul_f32 v125, v125, v221
    v_mul_f32 v126, v126, v222
    v_mul_f32 v127, v127, v223
    v_cvt_pk_bf16_f32 v208, v120, v121
    buffer_load_dwordx4 v251, s[32:35], s57 offen offset:3072 lds
    v_cvt_pk_bf16_f32 v209, v122, v123
    v_cvt_pk_bf16_f32 v210, v124, v125
    v_cvt_pk_bf16_f32 v211, v126, v127
    v_mul_f32 v128, v112, v128
    v_exp_f32 v224, -v112
    s_add_u32 m0, s53, 32768
    s_nop 0
    buffer_load_dwordx4 v248, s[36:39], s57 offen offset:0 lds
    v_mul_f32 v129, v113, v129
    v_exp_f32 v225, -v113
    v_mul_f32 v130, v114, v130
    v_exp_f32 v226, -v114
    v_mul_f32 v131, v115, v131
    v_exp_f32 v227, -v115
    buffer_load_dwordx4 v249, s[36:39], s57 offen offset:1024 lds
    v_mul_f32 v132, v116, v132
    v_exp_f32 v228, -v116
    v_mul_f32 v133, v117, v133
    v_exp_f32 v229, -v117
    buffer_load_dwordx4 v250, s[36:39], s57 offen offset:2048 lds
    v_mul_f32 v134, v118, v134
    v_exp_f32 v230, -v118
    v_mul_f32 v135, v119, v135
    v_exp_f32 v231, -v119
    v_fma_f32 v224, v224, s67, s67
    v_fma_f32 v225, v225, s67, s67
    buffer_load_dwordx4 v251, s[36:39], s57 offen offset:3072 lds
    v_rcp_f32 v224, v224
    v_fma_f32 v226, v226, s67, s67
    v_rcp_f32 v225, v225
    v_fma_f32 v227, v227, s67, s67
    v_rcp_f32 v226, v226
    v_fma_f32 v228, v228, s67, s67
    s_mov_b32 m0, s53
    s_nop 0
    buffer_load_dwordx4 v246, s[28:31], s56 offen offset:0 sc1 lds
    v_rcp_f32 v227, v227
    v_fma_f32 v229, v229, s67, s67
    v_rcp_f32 v228, v228
    v_fma_f32 v230, v230, s67, s67
    buffer_load_dwordx4 v246, s[28:31], s56 offen offset:1024 sc1 lds
    v_rcp_f32 v229, v229
    v_fma_f32 v231, v231, s67, s67
    v_rcp_f32 v230, v230
    v_rcp_f32 v231, v231
    v_mul_f32 v128, v128, v224
    v_mul_f32 v129, v129, v225
    buffer_load_dwordx4 v247, s[28:31], s56 offen offset:2048 sc1 lds
    v_mul_f32 v130, v130, v226
    v_mul_f32 v131, v131, v227
    v_mul_f32 v132, v132, v228
    v_mul_f32 v133, v133, v229
    v_mul_f32 v134, v134, v230
    v_mul_f32 v135, v135, v231
    buffer_load_dwordx4 v247, s[28:31], s56 offen offset:3072 sc1 lds
    v_cvt_pk_bf16_f32 v212, v128, v129
    v_cvt_pk_bf16_f32 v213, v130, v131
    v_cvt_pk_bf16_f32 v214, v132, v133
    v_cvt_pk_bf16_f32 v215, v134, v135
    s_add_u32 s53, s53, 49152
    s_cmp_ge_u32 s53, s61
    s_cselect_b32 s53, s60, s53
    buffer_store_dwordx4 v[208:211], v198, s[28:31], 0 offen offset:0 sc1
    buffer_store_dwordx4 v[212:215], v198, s[28:31], 0 offen offset:1024 sc1
    s_waitcnt vmcnt(15)
    s_barrier
    s_mul_i32 s55, s49, 6
    s_add_u32 s55, s55, 32
    s_lshl_b32 s66, s51, 1
    s_and_b32 s57, s58, 15
    s_lshr_b64 s[58:59], s[58:59], 4
    s_add_u32 s57, s57, s66
    s_sub_u32 s56, s57, 6
    s_cselect_b32 s57, s57, s56
    s_add_u32 s57, s57, s55
    s_lshl_b32 s56, s57, 11
    s_mul_i32 s57, s57, 0x20000
    s_add_u32 m0, s53, 16384
    s_nop 0
    buffer_load_dwordx4 v248, s[32:35], s57 offen offset:0 lds
    buffer_load_dwordx4 v249, s[32:35], s57 offen offset:1024 lds
    buffer_load_dwordx4 v250, s[32:35], s57 offen offset:2048 lds
    buffer_load_dwordx4 v251, s[32:35], s57 offen offset:3072 lds
    s_add_u32 m0, s53, 32768
    s_nop 0
    buffer_load_dwordx4 v248, s[36:39], s57 offen offset:0 lds
    buffer_load_dwordx4 v249, s[36:39], s57 offen offset:1024 lds
    buffer_load_dwordx4 v250, s[36:39], s57 offen offset:2048 lds
    buffer_load_dwordx4 v251, s[36:39], s57 offen offset:3072 lds
    s_mov_b32 s62, s53
    s_mov_b32 s63, s56
    s_add_u32 s53, s53, 49152
    s_cmp_ge_u32 s53, s61
    s_cselect_b32 s53, s60, s53
    s_lshl_b32 s64, s47, 9
    s_lshl_b32 s65, s49, 7
    s_add_u32 s64, s64, s65
    s_lshl_b32 s65, s51, 4
    s_add_u32 s64, s64, s65
    s_lshl_b32 s65, s44, 2
    s_add_u32 s64, s64, s65
    s_add_u32 s64, s64, 0x52000
    v_mov_b32 v2, s0
    s_waitcnt vmcnt(8)
    s_mov_b64 exec, 1
    buffer_store_dword v2, v234, s[28:31], s64 offen sc1
    s_mov_b64 exec, -1
    s_barrier
    s_cmp_eq_u32 s69, 0
    s_cbranch_scc1 M_pi_ok
    s_lshl_b32 s68, s47, 2
    s_add_u32 s68, s68, s49
    s_lshl_b32 s68, s68, 7
    s_add_u32 s68, s68, 0x52000
    v_min_u32 v234, 44, v234
    v_mov_b32 v245, 0
    v_xor_b32 v245, -1, v2
    s_mov_b32 s3, 0x40000
M_pi_chk:
    v_cmp_ne_u32 vcc, s0, v245
    s_nop 4
    s_cbranch_vccz M_pi_ok
    s_sub_u32 s3, s3, 1
    s_cbranch_scc1 M_pi_ok
    s_sleep 12
    buffer_load_dword v245, v234, s[28:31], s68 offen sc1
    s_waitcnt vmcnt(0)
    s_branch M_pi_chk
M_pi_ok:
    s_mov_b32 m0, s62
    s_nop 0
    buffer_load_dwordx4 v246, s[28:31], s63 offen offset:0 sc1 lds
    buffer_load_dwordx4 v246, s[28:31], s63 offen offset:1024 sc1 lds
    buffer_load_dwordx4 v247, s[28:31], s63 offen offset:2048 sc1 lds
    buffer_load_dwordx4 v247, s[28:31], s63 offen offset:3072 sc1 lds
    s_and_b32 s57, s58, 15
    s_lshr_b64 s[58:59], s[58:59], 4
    s_add_u32 s57, s57, s66
    s_sub_u32 s56, s57, 6
    s_cselect_b32 s57, s57, s56
    s_add_u32 s57, s57, s55
    s_lshl_b32 s56, s57, 11
    s_mul_i32 s57, s57, 0x20000
    s_add_u32 m0, s53, 16384
    s_nop 0
    buffer_load_dwordx4 v248, s[32:35], s57 offen offset:0 lds
    buffer_load_dwordx4 v249, s[32:35], s57 offen offset:1024 lds
    buffer_load_dwordx4 v250, s[32:35], s57 offen offset:2048 lds
    buffer_load_dwordx4 v251, s[32:35], s57 offen offset:3072 lds
    s_add_u32 m0, s53, 32768
    s_nop 0
    buffer_load_dwordx4 v248, s[36:39], s57 offen offset:0 lds
    buffer_load_dwordx4 v249, s[36:39], s57 offen offset:1024 lds
    buffer_load_dwordx4 v250, s[36:39], s57 offen offset:2048 lds
    buffer_load_dwordx4 v251, s[36:39], s57 offen offset:3072 lds
    s_mov_b32 s62, s53
    s_mov_b32 s63, s56
    s_add_u32 s53, s53, 49152
    s_cmp_ge_u32 s53, s61
    s_cselect_b32 s53, s60, s53
    s_waitcnt vmcnt(8)
    s_barrier
    s_mov_b32 m0, s62
    s_nop 0
    buffer_load_dwordx4 v246, s[28:31], s63 offen offset:0 sc1 lds
    buffer_load_dwordx4 v246, s[28:31], s63 offen offset:1024 sc1 lds
    buffer_load_dwordx4 v247, s[28:31], s63 offen offset:2048 sc1 lds
    buffer_load_dwordx4 v247, s[28:31], s63 offen offset:3072 sc1 lds
    s_and_b32 s57, s58, 15
    s_lshr_b64 s[58:59], s[58:59], 4
    s_add_u32 s57, s57, s66
    s_sub_u32 s56, s57, 6
    s_cselect_b32 s57, s57, s56
    s_add_u32 s57, s57, s55
    s_lshl_b32 s56, s57, 11
    s_mul_i32 s57, s57, 0x20000
    s_add_u32 m0, s53, 16384
    s_nop 0
    buffer_load_dwordx4 v248, s[32:35], s57 offen offset:0 lds
    buffer_load_dwordx4 v249, s[32:35], s57 offen offset:1024 lds
    buffer_load_dwordx4 v250, s[32:35], s57 offen offset:2048 lds
    buffer_load_dwordx4 v251, s[32:35], s57 offen offset:3072 lds
    s_add_u32 m0, s53, 32768
    s_nop 0
    buffer_load_dwordx4 v248, s[36:39], s57 offen offset:0 lds
    buffer_load_dwordx4 v249, s[36:39], s57 offen offset:1024 lds
    buffer_load_dwordx4 v250, s[36:39], s57 offen offset:2048 lds
    buffer_load_dwordx4 v251, s[36:39], s57 offen offset:3072 lds
    s_mov_b32 s62, s53
    s_mov_b32 s63, s56
    s_add_u32 s53, s53, 49152
    s_cmp_ge_u32 s53, s61
    s_cselect_b32 s53, s60, s53
    s_lshl_b32 s68, s47, 2
    s_add_u32 s68, s68, s49
    s_lshl_b32 s68, s68, 7
    s_add_u32 s68, s68, 0x52000
    v_min_u32 v234, 44, v234
    buffer_load_dword v245, v234, s[28:31], s68 offen sc1
    s_waitcnt vmcnt(9)
    s_barrier
    s_waitcnt vmcnt(0)
    s_mov_b32 s3, 0x40000
M_pb_chk:
    v_cmp_ne_u32 vcc, s0, v245
    s_nop 4
    s_cbranch_vccz M_pb_ok
    s_sub_u32 s3, s3, 1
    s_cbranch_scc1 M_pb_ok
    s_sleep 2
    s_cmp_eq_u32 s69, 0
    s_cbranch_scc1 M_pb_rl
    s_sleep 48
M_pb_rl:
    buffer_load_dword v245, v234, s[28:31], s68 offen sc1
    s_waitcnt vmcnt(0)
    s_branch M_pb_chk
M_pb_ok:
    s_mov_b32 m0, s62
    s_nop 0
    buffer_load_dwordx4 v246, s[28:31], s63 offen offset:0 sc1 lds
    buffer_load_dwordx4 v246, s[28:31], s63 offen offset:1024 sc1 lds
    buffer_load_dwordx4 v247, s[28:31], s63 offen offset:2048 sc1 lds
    buffer_load_dwordx4 v247, s[28:31], s63 offen offset:3072 sc1 lds
    s_and_b32 s57, s58, 15
    s_lshr_b64 s[58:59], s[58:59], 4
    s_add_u32 s57, s57, s66
    s_sub_u32 s56, s57, 6
    s_cselect_b32 s57, s57, s56
    s_add_u32 s57, s57, s55
    s_lshl_b32 s56, s57, 11
    s_mul_i32 s57, s57, 0x20000
    s_add_u32 m0, s53, 16384
    s_nop 0
    buffer_load_dwordx4 v248, s[32:35], s57 offen offset:0 lds
    buffer_load_dwordx4 v249, s[32:35], s57 offen offset:1024 lds
    buffer_load_dwordx4 v250, s[32:35], s57 offen offset:2048 lds
    buffer_load_dwordx4 v251, s[32:35], s57 offen offset:3072 lds
    s_add_u32 m0, s53, 32768
    s_nop 0
    buffer_load_dwordx4 v248, s[36:39], s57 offen offset:0 lds
    buffer_load_dwordx4 v249, s[36:39], s57 offen offset:1024 lds
    buffer_load_dwordx4 v250, s[36:39], s57 offen offset:2048 lds
    buffer_load_dwordx4 v251, s[36:39], s57 offen offset:3072 lds
    s_mov_b32 s62, s53
    s_mov_b32 s63, s56
    s_add_u32 s53, s53, 49152
    s_cmp_ge_u32 s53, s61
    s_cselect_b32 s53, s60, s53
    s_movk_i32 s54, 1
M_Q_loop4:
    s_waitcnt vmcnt(8)
    s_barrier
    s_mov_b32 m0, s62
    s_nop 0
    buffer_load_dwordx4 v246, s[28:31], s63 offen offset:0 sc1 lds
    buffer_load_dwordx4 v246, s[28:31], s63 offen offset:1024 sc1 lds
    buffer_load_dwordx4 v247, s[28:31], s63 offen offset:2048 sc1 lds
    buffer_load_dwordx4 v247, s[28:31], s63 offen offset:3072 sc1 lds
    s_and_b32 s57, s58, 15
    s_lshr_b64 s[58:59], s[58:59], 4
    s_add_u32 s57, s57, s66
    s_sub_u32 s56, s57, 6
    s_cselect_b32 s57, s57, s56
    s_add_u32 s57, s57, s55
    s_lshl_b32 s56, s57, 11
    s_mul_i32 s57, s57, 0x20000
    s_add_u32 m0, s53, 16384
    s_nop 0
    buffer_load_dwordx4 v248, s[32:35], s57 offen offset:0 lds
    buffer_load_dwordx4 v249, s[32:35], s57 offen offset:1024 lds
    buffer_load_dwordx4 v250, s[32:35], s57 offen offset:2048 lds
    buffer_load_dwordx4 v251, s[32:35], s57 offen offset:3072 lds
    s_add_u32 m0, s53, 32768
    s_nop 0
    buffer_load_dwordx4 v248, s[36:39], s57 offen offset:0 lds
    buffer_load_dwordx4 v249, s[36:39], s57 offen offset:1024 lds
    buffer_load_dwordx4 v250, s[36:39], s57 offen offset:2048 lds
    buffer_load_dwordx4 v251, s[36:39], s57 offen offset:3072 lds
    s_mov_b32 s62, s53
    s_mov_b32 s63, s56
    s_add_u32 s53, s53, 49152
    s_cmp_ge_u32 s53, s61
    s_cselect_b32 s53, s60, s53
    s_sub_u32 s54, s54, 1
    s_cbranch_scc0 M_Q_loop4
    s_waitcnt vmcnt(8)
    s_barrier
    s_mov_b32 m0, s62
    s_nop 0
    buffer_load_dwordx4 v246, s[28:31], s63 offen offset:0 sc1 lds
    buffer_load_dwordx4 v246, s[28:31], s63 offen offset:1024 sc1 lds
    buffer_load_dwordx4 v247, s[28:31], s63 offen offset:2048 sc1 lds
    buffer_load_dwordx4 v247, s[28:31], s63 offen offset:3072 sc1 lds
    s_waitcnt vmcnt(0)
    s_barrier
    s_branch M_fin
M_Qidle:
    s_waitcnt vmcnt(0)
    s_barrier
    v_and_b32 v2, 255, v0
    s_and_b32 s64, s2, 63
    s_lshl_b32 s64, s64, 8
    v_add_lshl_u32 v243, v2, s64, 6
    s_waitcnt vmcnt(0)
    s_barrier
    s_barrier
    s_barrier
    s_branch M_Qjoin
M_fin:
M_end:
    s_endpgm

.section .rodata,"a"
.p2align 6
.amdhsa_kernel adaLN_cond__sliding_local_dilated__glu_gated_swiglu__prompt_kernel
  .amdhsa_next_free_vgpr 252
  .amdhsa_next_free_sgpr 102
  .amdhsa_accum_offset 252
  .amdhsa_group_segment_fixed_size 0
  .amdhsa_kernarg_size 96
  .amdhsa_user_sgpr_count 2
  .amdhsa_user_sgpr_kernarg_segment_ptr 1
  .amdhsa_system_sgpr_workgroup_id_x 1
  .amdhsa_float_denorm_mode_32 3
.end_amdhsa_kernel
```
